```python
import torch

def _softmax(x, axis=-1):
    return torch.softmax(x, dim=axis)
def _gelu(x):
    return torch.nn.functional.gelu(x, approximate="tanh")
def _silu(x):
    return torch.nn.functional.silu(x)
def _sigmoid(x):
    return torch.sigmoid(x)
def _layernorm(x, axis=-1, eps=1e-5):
    m = x.mean(dim=axis, keepdim=True)
    v = x.var(dim=axis, keepdim=True, unbiased=False)
    return (x - m) / torch.sqrt(v + eps)
def _scatter_add(tgt, idx, src, axis=0):
    return tgt.clone().index_add_(axis, idx, src)
def _segment_sum(src, seg, n):
    out = torch.zeros((n,) + src.shape[1:], dtype=src.dtype)
    return out.index_add_(0, seg, src)
def _pad(x, pw):
    flat = tuple(v for pair in reversed(pw) for v in pair)
    return torch.nn.functional.pad(x, flat)

kernel_name = 'standalone__deep_cross_pnn__recsys'

def setup_inputs():

    _w = (lambda a: (lambda t: t.to(torch.bfloat16) if t.is_floating_point() else t)(torch.as_tensor(a)))
    B, F, D, V = 16384, 100, 128, min(1000, 100000)
    H = 4 * D
    return {
        "idx": _w((lambda lo, hi, *s: torch.randint(lo, hi, s))(0, V, B, F).to(torch.int64)),
        "table": _w((lambda *s: torch.randn(*s, dtype=torch.bfloat16) * 1.6)(V, D) * (D ** -0.5)),
        "w_p": _w((lambda *s: torch.randn(*s, dtype=torch.bfloat16) * 0.05)(F * F) * ((F * F) ** -0.5)),
        "w1": _w((lambda *s: torch.randn(*s, dtype=torch.bfloat16) * 1.6)(F * D, H) * ((F * D) ** -0.5)),
        "b1": _w((lambda *s: torch.randn(*s, dtype=torch.bfloat16) * 12.8)(H) * 0.01),
        "w2": _w((lambda *s: torch.randn(*s, dtype=torch.bfloat16) * 0.05)(H) * (H ** -0.5)),
        "b2": _w((lambda *s: torch.randn(*s, dtype=torch.bfloat16) * 1.6)(1) * 0.01),
    }

def reference(idx, table, w_p, w1, b1, w2, b2):
    emb = table[idx]
    B = emb.shape[0]; F = emb.shape[1]; D = emb.shape[2]
    ip = torch.einsum('bid,bjd->bij', emb, emb)
    ip = ip.reshape(B, F * F)
    logit_p = ip @ w_p
    z = emb.reshape(B, F * D)
    h = _gelu(z @ w1 + b1)
    logit_d = h @ w2 + b2
    return logit_p + logit_d
```

```asm
; @launch kernel=k1_kernel grid=(256,1,1) block=(512,1,1) lds=163840
; @launch kernel=k3_kernel grid=(256,1,1) block=(256,1,1) lds=4096
.amdgcn_target "amdgcn-amd-amdhsa--gfx950"
.text
.globl k1_kernel
.p2align 8
.type k1_kernel,@function
k1_kernel:

    s_cmp_ge_u32 s2, 256
    s_cbranch_scc1 k1_kernel_end
    s_load_dwordx8 s[4:11], s[0:1], 0
    s_load_dwordx2 s[12:13], s[0:1], 72
    s_load_dwordx2 s[52:53], s[0:1], 64

    v_cmp_gt_u32 vcc, 18, v0
    s_and_saveexec_b64 s[48:49], vcc
    s_cbranch_execz k1_kernel_ncp
    s_getpc_b64 s[46:47]
k1_kernel_pc:
    s_bfe_u32 s38, s2, 0x40003
    s_lshl_b32 s38, s38, 7
    v_lshl_add_u32 v2, v0, 11, s38
    v_min_u32 v2, k1_kernel_last-k1_kernel_pc, v2
    global_load_dword v250, v2, s[46:47]
k1_kernel_ncp:
    s_mov_b64 exec, s[48:49]

    v_lshrrev_b32 v1, 6, v0
    v_and_b32 v255, 63, v0
    s_bfe_u32 s36, s2, 0x10003
    v_readfirstlane_b32 s3, v1
    s_lshr_b32 s37, s2, 4
    s_lshl_b32 s37, s37, 3
    s_and_b32 s38, s2, 7
    s_or_b32 s37, s37, s38
    v_lshlrev_b32 v254, 4, v255
    v_mov_b32 v252, 144144
    v_mov_b32 v253, 1
    v_mov_b32 v40, 0
    v_lshl_add_u32 v41, v0, 2, v252
    v_cmp_gt_u32 vcc, 8, v0
    s_and_saveexec_b64 s[46:47], vcc
    ds_write_b32 v41, v40
    s_mov_b64 exec, s[46:47]
    v_mul_u32_u24 v6, 57, v255
    v_lshrrev_b32 v6, 9, v6
    v_mul_u32_u24 v5, 9, v6
    v_sub_u32 v5, v255, v5
    v_cmp_gt_u32 s[40:41], 8, v5
    s_lshl_b32 s38, s36, 7
    v_lshl_add_u32 v5, v5, 4, s38
    v_lshl_add_u32 v83, v6, 8, v5
    s_and_b32 s56, s3, 3
    s_bitset0_b32 s41, 31
    s_lshr_b32 s42, s2, 3
    s_mul_i32 s42, s42, 36
    s_lshr_b32 s42, s42, 5
    s_lshl_b32 s42, s42, 2
    s_add_u32 s42, s42, s56
    s_mov_b32 s43, s42
    s_mov_b32 s50, s36
    s_lshl_b32 s72, s37, 7
    s_lshl_b32 s73, s3, 5
    s_add_u32 s72, s72, s73
    s_mul_i32 s74, s72, 400
    s_mul_i32 s45, s36, 6400
    s_add_u32 s74, s74, s45
    s_lshl_b32 s38, s3, 10
    s_add_u32 m0, s38, 144384

    s_mov_b32 s18, 6553600
    s_mov_b32 s19, 0x00020000
    s_mov_b32 s22, 256000
    s_mov_b32 s23, 0x00020000
    s_mov_b32 s26, 20000
    s_mov_b32 s27, 0x00020000
    s_mov_b32 s30, 13107200
    s_mov_b32 s31, 0x00020000
    s_mov_b32 s34, 268435456
    s_mov_b32 s35, 0x00020000
    s_mov_b32 s14, 268435456
    s_mov_b32 s15, 0x00020000
    s_mov_b32 s54, 256
    s_mov_b32 s55, 0x00020000

    v_bfe_u32 v5, v255, 2, 2
    v_mul_u32_u24 v5, 200, v5
    v_and_b32 v6, 3, v255
    v_lshl_add_u32 v5, v6, 5, v5
    v_and_b32 v6, 32, v255
    v_lshl_add_u32 v5, v6, 2, v5
    v_and_b32 v6, 16, v255
    v_add_u32 v5, v5, v6
    s_movk_i32 s39, 19200
    s_cmp_ge_u32 s3, 4
    s_waitcnt lgkmcnt(0)
    s_barrier
    s_cbranch_scc1 k1_kernel_dma

    s_mov_b32 s24, s8
    s_and_b32 s25, s9, 0xffff
    buffer_load_dwordx4 v254, s[24:27], s38 offen lds
    s_add_u32 s38, s38, 4096
    s_add_u32 m0, s38, 144384
    s_mov_b32 s16, s4
    s_and_b32 s17, s5, 0xffff
    buffer_load_dwordx4 v254, s[24:27], s38 offen lds
    s_add_u32 s38, s38, 4096
    s_add_u32 m0, s38, 144384
    s_nop 0
    buffer_load_dwordx4 v254, s[24:27], s38 offen lds
    s_add_u32 s38, s38, 4096
    s_add_u32 m0, s38, 144384
    s_nop 0
    buffer_load_dwordx4 v254, s[24:27], s38 offen lds
    s_add_u32 s38, s38, 4096
    s_min_u32 s38, s38, 18432
    s_add_u32 m0, s38, 144384
    s_nop 0
    buffer_load_dwordx4 v254, s[24:27], s38 offen lds
    buffer_load_dwordx4 v[212:215], v5, s[24:27], s39 offen
    buffer_load_dwordx4 v[216:219], v254, s[16:19], s74 offen offset:0
    buffer_load_dwordx4 v[220:223], v254, s[16:19], s74 offen offset:800
    buffer_load_dwordx4 v[224:227], v254, s[16:19], s74 offen offset:1600
    s_branch k1_kernel_main
k1_kernel_dma:
    s_mov_b32 s20, s6
    s_and_b32 s21, s7, 0xffff
    s_mov_b64 exec, s[40:41]
k1_kernel_dml:

    s_min_u32 s38, s42, 142
    s_mul_i32 m0, s38, 1008
    s_mul_i32 s39, s38, 1792
    s_add_u32 s42, s42, 4
    buffer_load_dwordx4 v83, s[20:23], s39 offen lds
    s_cmp_ge_u32 s42, 144
    s_cselect_b32 s38, 144, 0
    s_sub_u32 s42, s42, s38
    s_cmp_lg_u32 s42, s43
    s_cbranch_scc1 k1_kernel_dml
    s_mov_b64 exec, -1

    s_mov_b32 s16, s4
    s_and_b32 s17, s5, 0xffff
    s_mov_b32 s20, s6
    s_and_b32 s21, s7, 0xffff
    s_mov_b32 s28, s10
    s_and_b32 s29, s11, 0xffff
    s_mov_b32 s32, s12
    s_and_b32 s33, s13, 0xffff
    s_and_b32 s13, s13, 0xffff
    s_and_b32 s53, s53, 0xffff
k1_kernel_aux:

    s_setprio 0
    v_mov_b32 v8, v255
    v_mov_b32 v9, v254
    v_mov_b32 v10, v253
    v_mov_b32 v11, v252
    s_mov_b32 s51, s2
    s_mov_b32 s64, 0
    s_mov_b32 s65, 0

k1_kernel_unit:

    s_bfe_u32 s36, s51, 0x10003

    s_lshr_b32 s38, s51, 4
    s_and_b32 s39, s51, 7
    s_sub_u32 s57, 2, s36
    s_lshl_b32 s57, s39, s57
    s_lshl_b32 s37, s36, 5
    s_add_u32 s57, s57, s37
    s_add_u32 s57, s57, s56
    s_mul_i32 s37, s38, 48
    s_add_u32 s37, s37, s57
    s_lshl_b32 s38, s38, 1
    s_lshr_b32 s39, s39, 2
    s_add_u32 s38, s38, s39
    s_add_u32 s38, s38, 768
    s_and_b32 s57, s57, 7
    s_cmp_eq_u32 s57, 2
    s_cselect_b32 s38, s38, 1000
    s_lshl_b32 s39, s36, 1
    s_and_b32 s39, s39, s56
    s_cselect_b32 s57, s38, s37

    s_lshr_b32 s37, s51, 4
    s_lshl_b32 s37, s37, 3
    s_and_b32 s38, s51, 7
    s_or_b32 s37, s37, s38
    s_and_b32 s58, s56, 1
    s_lshl_b32 s59, s37, 1
    s_add_u32 s58, s58, s59
    s_lshr_b32 s59, s56, 1
    s_lshl_b32 s60, s36, 1
    s_add_u32 s59, s59, s60
    s_mul_i32 s60, s58, 25600
    s_mul_i32 s61, s59, 96
    s_add_u32 s60, s60, s61
    s_movk_i32 s61, 400
    v_lshrrev_b32 v1, 3, v8
    v_and_b32 v2, 7, v8
    v_mul_u32_u24 v0, s61, v1
    v_cmp_gt_u32 s[48:49], 7, v2
    v_lshl_add_u32 v0, v2, 4, v0
    v_and_b32 v5, 15, v8
    v_and_b32 v6, 48, v8
    v_lshl_add_u32 v7, v5, 8, v6
    s_lshl_b32 s44, s56, 15
    s_xor_b32 s38, s50, 1
    s_lshl_b32 s38, s38, 7
    s_add_u32 s44, s44, s38

    s_mov_b64 exec, s[48:49]
    buffer_load_dwordx4 v[224:227], v0, s[16:19], s60 offen
    s_add_u32 s60, s60, 3200
    buffer_load_dwordx4 v[228:231], v0, s[16:19], s60 offen
    s_add_u32 s60, s60, 3200
    buffer_load_dwordx4 v[232:235], v0, s[16:19], s60 offen
    s_add_u32 s60, s60, 3200
    buffer_load_dwordx4 v[236:239], v0, s[16:19], s60 offen
    s_add_u32 s60, s60, 3200
    buffer_load_dwordx4 v[240:243], v0, s[16:19], s60 offen
    s_add_u32 s60, s60, 3200
    buffer_load_dwordx4 v[244:247], v0, s[16:19], s60 offen
    s_add_u32 s60, s60, 3200
    buffer_load_dwordx4 v[248:251], v0, s[16:19], s60 offen
    s_add_u32 s60, s60, 3200
    buffer_load_dwordx4 v[252:255], v0, s[16:19], s60 offen
    s_add_u32 s60, s60, 3200
    s_mov_b64 exec, -1

    s_lshr_b32 s78, s57, 5
    s_bfe_u32 s79, s57, 0x20003
    s_bfe_u32 s80, s57, 0x20001
    s_and_b32 s81, s57, 1
    s_lshl_b32 s77, s78, 2
    s_lshl_b32 s83, s81, 1
    s_add_u32 s77, s77, s83
    s_lshl_b32 s77, s77, 7
    s_lshl_b32 s83, s79, 5
    s_add_u32 s77, s77, s83
    s_lshl_b32 s83, s80, 3
    s_add_u32 s77, s77, s83
    s_lshl_b32 s77, s77, 10
    s_lshl_b32 s82, s78, 12
    s_lshl_b32 s83, s79, 10
    s_add_u32 s82, s82, s83
    s_lshl_b32 s83, s80, 8
    s_add_u32 s82, s82, s83
    s_lshl_b32 s83, s81, 7
    s_add_u32 s82, s82, s83
    s_mov_b32 s84, 205312
    v_lshrrev_b32 v3, 2, v8
    v_and_b32 v4, 3, v8
    v_mul_lo_u32 v14, v3, s84
    v_lshl_add_u32 v14, v4, 4, v14
    s_lshl_b32 s61, s56, 12
    s_add_u32 s61, s61, 147456
    v_and_b32 v3, 3, v3
    v_lshlrev_b32 v36, 6, v8
    v_lshl_add_u32 v36, v3, 4, v36
    v_add_u32 v36, s61, v36
    v_xor_b32 v37, 16, v36
    v_xor_b32 v38, 32, v36
    v_xor_b32 v39, 48, v36
    v_and_b32 v3, 48, v8
    v_xor_b32 v15, v3, v9
    v_add_u32 v15, s61, v15
    s_mov_b32 s84, 0x05040100
    s_mov_b32 s85, 0x07060302
    s_cmp_eq_u32 s64, 0
    s_cbranch_scc1 k1_kernel_nsig0
    s_waitcnt vmcnt(0)

k1_kernel_nsig0:

    s_waitcnt vmcnt(8)
    s_cmp_lg_u32 s64, 0
    s_cbranch_scc1 k1_kernel_nsig

    s_mov_b64 exec, 1
    ds_add_u32 v11, v10 offset:16
    s_mov_b64 exec, -1

k1_kernel_nsig:
    s_setprio 1

    s_lshl_b32 s61, s56, 12
    s_add_u32 s61, s61, 147456
    v_lshlrev_b32 v86, 2, v8
    v_add_u32 v86, s61, v86
    v_and_b32 v85, 0xffffff80, v86
    v_and_b32 v123, 32, v8
    s_add_u32 s61, s61, 256
    v_mul_u32_u24 v31, 56, v8
    v_add_u32 v31, s61, v31
    v_mul_u32_u24 v34, 56, v1
    v_lshl_add_u32 v34, v2, 3, v34
    v_add_u32 v34, s61, v34
    v_add_u32 v2, s59, v2
    v_subrev_u32 v3, 5, v2
    v_min_u32 v2, v2, v3
    v_mov_b32 v13, 0
    v_mul_u32_u24 v2, 0x10001, v2
    v_lshlrev_b32 v2, 12, v2
    v_add_u32 v32, 67108864, v2
    v_add_u32 v33, 201328640, v2
    v_mov_b32 v71, 0xf00
    s_lshr_b32 s62, s58, 7
    s_mul_i32 s62, s62, 25
    s_mul_i32 s63, s59, 6
    s_add_u32 s62, s62, s63
    s_lshl_b32 s62, s62, 3
    s_bfe_u32 s63, s58, 0x30004
    s_add_u32 s62, s62, s63
    s_lshl_b32 s62, s62, 13
    s_bfe_u32 s63, s58, 0x30001
    s_lshl_b32 s63, s63, 10
    s_add_u32 s62, s62, s63
    s_and_b32 s63, s58, 1
    s_lshl_b32 s63, s63, 9
    s_add_u32 s62, s62, s63
    s_add_u32 s62, s62, 16777216
    v_and_b32 v30, 31, v8
    v_lshrrev_b32 v3, 5, v8
    v_lshlrev_b32 v30, 4, v30
    v_lshl_add_u32 v30, v3, 3, v30
    s_cmp_eq_u32 s59, 3
    s_cselect_b32 s63, 0xf00, 0
    s_movk_i32 s66, 0x7c
    s_mov_b32 s67, 0x001f001f
    s_mov_b32 s75, 0x06040200
    v_mov_b32 v54, 0x08040201
    v_mov_b32 v55, 0x80402010

k1_kernel_wf3:

    ds_read_b32 v12, v11 offset:12
    s_waitcnt lgkmcnt(0)
    v_readfirstlane_b32 s45, v12
    s_cmp_lt_u32 s45, 4
    s_cbranch_scc1 k1_kernel_wf3

    s_mov_b64 exec, s[48:49]

    s_waitcnt vmcnt(7)
    v_lshl_or_b32 v224, v225, 16, v224
    v_lshl_or_b32 v225, v227, 16, v226
    v_add_u32 v224, v32, v224
    v_add_u32 v225, v33, v225
    ds_write_b64 v34, v[224:225] offset:0

    s_waitcnt vmcnt(6)
    v_lshl_or_b32 v228, v229, 16, v228
    v_lshl_or_b32 v229, v231, 16, v230
    v_add_u32 v228, v32, v228
    v_add_u32 v229, v33, v229
    ds_write_b64 v34, v[228:229] offset:448

    s_waitcnt vmcnt(5)
    v_lshl_or_b32 v232, v233, 16, v232
    v_lshl_or_b32 v233, v235, 16, v234
    v_add_u32 v232, v32, v232
    v_add_u32 v233, v33, v233
    ds_write_b64 v34, v[232:233] offset:896

    s_waitcnt vmcnt(4)
    v_lshl_or_b32 v236, v237, 16, v236
    v_lshl_or_b32 v237, v239, 16, v238
    v_add_u32 v236, v32, v236
    v_add_u32 v237, v33, v237
    ds_write_b64 v34, v[236:237] offset:1344

    s_waitcnt vmcnt(3)
    v_lshl_or_b32 v240, v241, 16, v240
    v_lshl_or_b32 v241, v243, 16, v242
    v_add_u32 v240, v32, v240
    v_add_u32 v241, v33, v241
    ds_write_b64 v34, v[240:241] offset:1792

    s_waitcnt vmcnt(2)
    v_lshl_or_b32 v244, v245, 16, v244
    v_lshl_or_b32 v245, v247, 16, v246
    v_add_u32 v244, v32, v244
    v_add_u32 v245, v33, v245
    ds_write_b64 v34, v[244:245] offset:2240

    s_waitcnt vmcnt(1)
    v_lshl_or_b32 v248, v249, 16, v248
    v_lshl_or_b32 v249, v251, 16, v250
    v_add_u32 v248, v32, v248
    v_add_u32 v249, v33, v249
    ds_write_b64 v34, v[248:249] offset:2688

    s_waitcnt vmcnt(0)
    v_lshl_or_b32 v252, v253, 16, v252
    v_lshl_or_b32 v253, v255, 16, v254
    v_add_u32 v252, v32, v252
    v_add_u32 v253, v33, v253
    ds_write_b64 v34, v[252:253] offset:3136

    s_mov_b64 exec, -1
    ds_read_b64 v[40:41], v31 offset:0
    ds_read_b64 v[42:43], v31 offset:8
    ds_read_b64 v[44:45], v31 offset:16
    ds_read_b64 v[46:47], v31 offset:24
    ds_read_b64 v[48:49], v31 offset:32
    ds_read_b64 v[50:51], v31 offset:40
    ds_read_b64 v[52:53], v31 offset:48

    s_waitcnt lgkmcnt(6)
    v_and_b32 v72, s67, v40
    v_and_b32 v73, s67, v41
    v_lshl_or_b32 v72, v73, 10, v72
    v_lshlrev_b32_sdwa v73, 5, v72 dst_sel:DWORD dst_unused:UNUSED_PAD src0_sel:DWORD src1_sel:WORD_1
    v_or_b32_sdwa v64, v73, v72 dst_sel:DWORD dst_unused:UNUSED_PAD src0_sel:DWORD src1_sel:WORD_0
    v_perm_b32 v72, v41, v40, s75
    v_lshrrev_b32 v73, 3, v72
    v_and_b32 v72, 0x07070707, v72
    v_and_b32 v0, 0x03030303, v73
    v_perm_b32 v16, v55, v54, v72
    v_add_u32 v23, v54, v16

    s_waitcnt lgkmcnt(5)
    v_and_b32 v72, s67, v42
    v_and_b32 v73, s67, v43
    v_lshl_or_b32 v72, v73, 10, v72
    v_lshlrev_b32_sdwa v73, 5, v72 dst_sel:DWORD dst_unused:UNUSED_PAD src0_sel:DWORD src1_sel:WORD_1
    v_or_b32_sdwa v65, v73, v72 dst_sel:DWORD dst_unused:UNUSED_PAD src0_sel:DWORD src1_sel:WORD_0
    v_perm_b32 v72, v43, v42, s75
    v_lshrrev_b32 v73, 3, v72
    v_and_b32 v72, 0x07070707, v72
    v_and_b32 v1, 0x03030303, v73
    v_perm_b32 v17, v55, v54, v72
    v_add_u32 v24, v54, v17

    s_waitcnt lgkmcnt(4)
    v_and_b32 v72, s67, v44
    v_and_b32 v73, s67, v45
    v_lshl_or_b32 v72, v73, 10, v72
    v_lshlrev_b32_sdwa v73, 5, v72 dst_sel:DWORD dst_unused:UNUSED_PAD src0_sel:DWORD src1_sel:WORD_1
    v_or_b32_sdwa v66, v73, v72 dst_sel:DWORD dst_unused:UNUSED_PAD src0_sel:DWORD src1_sel:WORD_0
    v_perm_b32 v72, v45, v44, s75
    v_lshrrev_b32 v73, 3, v72
    v_and_b32 v72, 0x07070707, v72
    v_and_b32 v2, 0x03030303, v73
    v_perm_b32 v18, v55, v54, v72
    v_add_u32 v25, v54, v18

    s_waitcnt lgkmcnt(3)
    v_and_b32 v72, s67, v46
    v_and_b32 v73, s67, v47
    v_lshl_or_b32 v72, v73, 10, v72
    v_lshlrev_b32_sdwa v73, 5, v72 dst_sel:DWORD dst_unused:UNUSED_PAD src0_sel:DWORD src1_sel:WORD_1
    v_or_b32_sdwa v67, v73, v72 dst_sel:DWORD dst_unused:UNUSED_PAD src0_sel:DWORD src1_sel:WORD_0
    v_perm_b32 v72, v47, v46, s75
    v_lshrrev_b32 v73, 3, v72
    v_and_b32 v72, 0x07070707, v72
    v_and_b32 v3, 0x03030303, v73
    v_perm_b32 v19, v55, v54, v72
    v_add_u32 v26, v54, v19

    s_waitcnt lgkmcnt(2)
    v_and_b32 v72, s67, v48
    v_and_b32 v73, s67, v49
    v_lshl_or_b32 v72, v73, 10, v72
    v_lshlrev_b32_sdwa v73, 5, v72 dst_sel:DWORD dst_unused:UNUSED_PAD src0_sel:DWORD src1_sel:WORD_1
    v_or_b32_sdwa v68, v73, v72 dst_sel:DWORD dst_unused:UNUSED_PAD src0_sel:DWORD src1_sel:WORD_0
    v_perm_b32 v72, v49, v48, s75
    v_lshrrev_b32 v73, 3, v72
    v_and_b32 v72, 0x07070707, v72
    v_and_b32 v4, 0x03030303, v73
    v_perm_b32 v20, v55, v54, v72
    v_add_u32 v27, v54, v20

    s_waitcnt lgkmcnt(1)
    v_and_b32 v72, s67, v50
    v_and_b32 v73, s67, v51
    v_lshl_or_b32 v72, v73, 10, v72
    v_lshlrev_b32_sdwa v73, 5, v72 dst_sel:DWORD dst_unused:UNUSED_PAD src0_sel:DWORD src1_sel:WORD_1
    v_or_b32_sdwa v69, v73, v72 dst_sel:DWORD dst_unused:UNUSED_PAD src0_sel:DWORD src1_sel:WORD_0
    v_perm_b32 v72, v51, v50, s75
    v_lshrrev_b32 v73, 3, v72
    v_and_b32 v72, 0x07070707, v72
    v_and_b32 v5, 0x03030303, v73
    v_perm_b32 v21, v55, v54, v72
    v_add_u32 v28, v54, v21

    s_waitcnt lgkmcnt(0)
    v_and_b32 v72, s67, v52
    v_and_b32 v73, s67, v53
    v_lshl_or_b32 v72, v73, 10, v72
    v_lshlrev_b32_sdwa v73, 5, v72 dst_sel:DWORD dst_unused:UNUSED_PAD src0_sel:DWORD src1_sel:WORD_1
    v_or_b32_sdwa v70, v73, v72 dst_sel:DWORD dst_unused:UNUSED_PAD src0_sel:DWORD src1_sel:WORD_0
    v_perm_b32 v72, v53, v52, s75
    v_lshrrev_b32 v73, 3, v72
    v_and_b32 v72, 0x07070707, v72
    v_and_b32 v6, 0x03030303, v73
    v_perm_b32 v22, v55, v54, v72
    v_add_u32 v29, v54, v22

    ds_write_b32 v86, v13
    v_lshrrev_b32 v71, 4, v71
    v_or_b32 v71, 0xf00, v71
    v_lshlrev_b32 v74, 22, v64
    v_lshrrev_b32 v75, 10, v64
    v_lshl_or_b32 v75, v65, 10, v75

    v_ffbl_b32 v84, v71
    v_mul_u32_u24 v72, 5, v84
    v_lshrrev_b64 v[72:73], v72, v[74:75]
    v_and_or_b32 v72, v72, s66, v85
    ds_add_rtn_u32 v87, v72, v10
    ds_wrxchg_rtn_b32 v116, v86, v13
    v_and_b32 v117, 15, v71
    v_bcnt_u32_b32 v118, v117, 0
    v_cmp_eq_u32 vcc, 4, v118

    s_nop 1

    v_cndmask_b32 v119, v71, v117, vcc
    s_waitcnt lgkmcnt(0)
    v_cmp_gt_u32 s[68:69], 2, v116
    v_cmp_gt_u32 s[70:71], 2, v87

    s_nop 0
    v_lshrrev_b64 v[76:77], v123, s[68:69]
    v_perm_b32 v121, v76, v76, v1
    v_perm_b32 v122, v76, v76, v0
    v_and_b32 v121, v121, v17
    v_and_b32 v122, v122, v16
    v_msad_u8 v120, v24, v121, 0
    v_lshlrev_b32 v120, 4, v120
    v_msad_u8 v120, v23, v122, v120
    v_lshlrev_b32 v120, 4, v120

    v_and_b32 v120, v120, v119
    v_cmp_eq_u32 vcc, 0, v120
    v_ffbl_b32 v118, v120
    s_or_b64 vcc, vcc, s[70:71]
    v_cndmask_b32 v118, v118, v84, vcc
    v_lshlrev_b32 v72, v118, v10
    v_lshl_add_u32 v73, v118, 1, v31
    v_xor_b32 v71, v71, v72

    v_subrev_u32 v73, 8, v73
    ds_read_u16 v80, v73 offset:0
    s_setprio 0

    v_ffbl_b32 v84, v71
    v_mul_u32_u24 v72, 5, v84
    v_lshrrev_b64 v[72:73], v72, v[74:75]
    v_and_or_b32 v72, v72, s66, v85
    ds_add_rtn_u32 v87, v72, v10
    ds_wrxchg_rtn_b32 v116, v86, v13
    v_and_b32 v117, 15, v71
    v_bcnt_u32_b32 v118, v117, 0
    v_cmp_eq_u32 vcc, 3, v118

    s_lshl_b32 s45, s2, 8
    s_add_u32 s45, s45, 14680064
    buffer_store_dword v13, v13, s[12:15], s45 offen sc1
    buffer_load_dwordx4 v[128:131], v9, s[28:31], s77 offen offset:0

    v_cndmask_b32 v119, v71, v117, vcc
    s_waitcnt lgkmcnt(0)
    v_cmp_gt_u32 s[68:69], 2, v116
    v_cmp_gt_u32 s[70:71], 2, v87

    s_nop 0
    v_lshrrev_b64 v[76:77], v123, s[68:69]
    v_perm_b32 v121, v76, v76, v1
    v_perm_b32 v122, v76, v76, v0
    v_and_b32 v121, v121, v17
    v_and_b32 v122, v122, v16
    v_msad_u8 v120, v24, v121, 0
    v_lshlrev_b32 v120, 4, v120
    v_msad_u8 v120, v23, v122, v120
    v_lshlrev_b32 v120, 4, v120

    v_and_b32 v120, v120, v119
    v_cmp_eq_u32 vcc, 0, v120
    v_ffbl_b32 v118, v120
    s_or_b64 vcc, vcc, s[70:71]
    v_cndmask_b32 v118, v118, v84, vcc
    v_lshlrev_b32 v72, v118, v10
    v_lshl_add_u32 v73, v118, 1, v31
    v_xor_b32 v71, v71, v72

    v_subrev_u32 v73, 8, v73
    ds_read_u16 v81, v73 offset:0

    v_ffbl_b32 v84, v71
    v_mul_u32_u24 v72, 5, v84
    v_lshrrev_b64 v[72:73], v72, v[74:75]
    v_and_or_b32 v72, v72, s66, v85
    ds_add_rtn_u32 v87, v72, v10
    ds_wrxchg_rtn_b32 v116, v86, v13
    v_and_b32 v117, 15, v71
    v_bcnt_u32_b32 v118, v117, 0
    v_cmp_eq_u32 vcc, 2, v118

    buffer_load_dwordx4 v[132:135], v9, s[28:31], s77 offen offset:1024

    v_cndmask_b32 v119, v71, v117, vcc
    s_waitcnt lgkmcnt(0)
    v_cmp_gt_u32 s[68:69], 2, v116
    v_cmp_gt_u32 s[70:71], 2, v87

    s_nop 0
    v_lshrrev_b64 v[76:77], v123, s[68:69]
    v_perm_b32 v121, v76, v76, v1
    v_perm_b32 v122, v76, v76, v0
    v_and_b32 v121, v121, v17
    v_and_b32 v122, v122, v16
    v_msad_u8 v120, v24, v121, 0
    v_lshlrev_b32 v120, 4, v120
    v_msad_u8 v120, v23, v122, v120
    v_lshlrev_b32 v120, 4, v120

    v_and_b32 v120, v120, v119
    v_cmp_eq_u32 vcc, 0, v120
    v_ffbl_b32 v118, v120
    s_or_b64 vcc, vcc, s[70:71]
    v_cndmask_b32 v118, v118, v84, vcc
    v_lshlrev_b32 v72, v118, v10
    v_lshl_add_u32 v73, v118, 1, v31
    v_xor_b32 v71, v71, v72

    v_subrev_u32 v73, 8, v73
    ds_read_u16 v82, v73 offset:0

    v_ffbl_b32 v84, v71
    v_mul_u32_u24 v72, 5, v84
    v_lshrrev_b64 v[72:73], v72, v[74:75]
    v_and_or_b32 v72, v72, s66, v85
    ds_add_rtn_u32 v87, v72, v10
    ds_wrxchg_rtn_b32 v116, v86, v13
    v_and_b32 v117, 15, v71
    v_bcnt_u32_b32 v118, v117, 0
    v_cmp_eq_u32 vcc, 1, v118

    buffer_load_dwordx4 v[136:139], v9, s[28:31], s77 offen offset:2048

    v_cndmask_b32 v119, v71, v117, vcc
    s_waitcnt lgkmcnt(0)
    v_cmp_gt_u32 s[68:69], 2, v116
    v_cmp_gt_u32 s[70:71], 2, v87

    s_nop 0
    v_lshrrev_b64 v[76:77], v123, s[68:69]
    v_perm_b32 v121, v76, v76, v1
    v_perm_b32 v122, v76, v76, v0
    v_and_b32 v121, v121, v17
    v_and_b32 v122, v122, v16
    v_msad_u8 v120, v24, v121, 0
    v_lshlrev_b32 v120, 4, v120
    v_msad_u8 v120, v23, v122, v120
    v_lshlrev_b32 v120, 4, v120

    v_and_b32 v120, v120, v119
    v_cmp_eq_u32 vcc, 0, v120
    v_ffbl_b32 v118, v120
    s_or_b64 vcc, vcc, s[70:71]
    v_cndmask_b32 v118, v118, v84, vcc
    v_lshlrev_b32 v72, v118, v10
    v_lshl_add_u32 v73, v118, 1, v31
    v_xor_b32 v71, v71, v72

    v_subrev_u32 v73, 8, v73
    ds_read_u16 v83, v73 offset:0
    v_lshrrev_b32 v71, 4, v71
    v_or_b32 v71, 0xf00, v71
    v_lshlrev_b32 v74, 22, v65
    v_lshl_or_b32 v74, v64, 2, v74
    v_lshrrev_b32 v75, 10, v65
    v_lshl_or_b32 v75, v66, 10, v75

    v_ffbl_b32 v84, v71
    v_mul_u32_u24 v72, 5, v84
    v_lshrrev_b64 v[72:73], v72, v[74:75]
    v_and_or_b32 v72, v72, s66, v85
    ds_add_rtn_u32 v87, v72, v10
    ds_wrxchg_rtn_b32 v116, v86, v13
    v_and_b32 v117, 15, v71
    v_bcnt_u32_b32 v118, v117, 0
    v_cmp_eq_u32 vcc, 4, v118

    buffer_load_dwordx4 v[140:143], v9, s[28:31], s77 offen offset:3072
    s_add_u32 s77, s77, 4096

    v_cndmask_b32 v119, v71, v117, vcc
    s_waitcnt lgkmcnt(0)
    v_cmp_gt_u32 s[68:69], 2, v116
    v_cmp_gt_u32 s[70:71], 2, v87

    v_lshl_or_b32 v78, v81, 16, v80
    v_lshl_or_b32 v79, v83, 16, v82
    buffer_store_dwordx2 v[78:79], v30, s[32:35], s62 offen sc1
    s_add_u32 s62, s62, 65536
    v_lshrrev_b64 v[76:77], v123, s[68:69]
    v_perm_b32 v121, v76, v76, v2
    v_perm_b32 v122, v76, v76, v1
    v_perm_b32 v77, v76, v76, v0
    v_and_b32 v121, v121, v18
    v_and_b32 v122, v122, v17
    v_and_b32 v77, v77, v16
    v_msad_u8 v120, v25, v121, 0
    v_lshlrev_b32 v120, 4, v120
    v_msad_u8 v120, v24, v122, v120
    v_lshlrev_b32 v120, 4, v120
    v_msad_u8 v120, v23, v77, v120

    v_and_b32 v120, v120, v119
    v_cmp_eq_u32 vcc, 0, v120
    v_ffbl_b32 v118, v120
    s_or_b64 vcc, vcc, s[70:71]
    v_cndmask_b32 v118, v118, v84, vcc
    v_lshlrev_b32 v72, v118, v10
    v_lshl_add_u32 v73, v118, 1, v31
    v_xor_b32 v71, v71, v72

    ds_read_u16 v80, v73 offset:0

    v_ffbl_b32 v84, v71
    v_mul_u32_u24 v72, 5, v84
    v_lshrrev_b64 v[72:73], v72, v[74:75]
    v_and_or_b32 v72, v72, s66, v85
    ds_add_rtn_u32 v87, v72, v10
    ds_wrxchg_rtn_b32 v116, v86, v13
    v_and_b32 v117, 15, v71
    v_bcnt_u32_b32 v118, v117, 0
    v_cmp_eq_u32 vcc, 3, v118

    buffer_load_dwordx4 v[144:147], v9, s[28:31], s77 offen offset:0
    s_add_u32 s47, s44, 12288
    buffer_load_dwordx4 v[56:59], v7, s[20:23], s47 offen offset:0
    buffer_load_dwordx4 v[60:63], v7, s[20:23], s47 offen offset:64

    v_cndmask_b32 v119, v71, v117, vcc
    s_waitcnt lgkmcnt(0)
    v_cmp_gt_u32 s[68:69], 2, v116
    v_cmp_gt_u32 s[70:71], 2, v87

    s_nop 0
    v_lshrrev_b64 v[76:77], v123, s[68:69]
    v_perm_b32 v121, v76, v76, v2
    v_perm_b32 v122, v76, v76, v1
    v_perm_b32 v77, v76, v76, v0
    v_and_b32 v121, v121, v18
    v_and_b32 v122, v122, v17
    v_and_b32 v77, v77, v16
    v_msad_u8 v120, v25, v121, 0
    v_lshlrev_b32 v120, 4, v120
    v_msad_u8 v120, v24, v122, v120
    v_lshlrev_b32 v120, 4, v120
    v_msad_u8 v120, v23, v77, v120

    v_and_b32 v120, v120, v119
    v_cmp_eq_u32 vcc, 0, v120
    v_ffbl_b32 v118, v120
    s_or_b64 vcc, vcc, s[70:71]
    v_cndmask_b32 v118, v118, v84, vcc
    v_lshlrev_b32 v72, v118, v10
    v_lshl_add_u32 v73, v118, 1, v31
    v_xor_b32 v71, v71, v72

    ds_read_u16 v81, v73 offset:0

    v_ffbl_b32 v84, v71
    v_mul_u32_u24 v72, 5, v84
    v_lshrrev_b64 v[72:73], v72, v[74:75]
    v_and_or_b32 v72, v72, s66, v85
    ds_add_rtn_u32 v87, v72, v10
    ds_wrxchg_rtn_b32 v116, v86, v13
    v_and_b32 v117, 15, v71
    v_bcnt_u32_b32 v118, v117, 0
    v_cmp_eq_u32 vcc, 2, v118

    buffer_load_dwordx4 v[148:151], v9, s[28:31], s77 offen offset:1024
    s_add_u32 s47, s44, 16384
    buffer_load_dwordx4 v[88:91], v7, s[20:23], s47 offen offset:0
    buffer_load_dwordx4 v[92:95], v7, s[20:23], s47 offen offset:64

    v_cndmask_b32 v119, v71, v117, vcc
    s_waitcnt lgkmcnt(0)
    v_cmp_gt_u32 s[68:69], 2, v116
    v_cmp_gt_u32 s[70:71], 2, v87

    s_nop 0
    v_lshrrev_b64 v[76:77], v123, s[68:69]
    v_perm_b32 v121, v76, v76, v2
    v_perm_b32 v122, v76, v76, v1
    v_perm_b32 v77, v76, v76, v0
    v_and_b32 v121, v121, v18
    v_and_b32 v122, v122, v17
    v_and_b32 v77, v77, v16
    v_msad_u8 v120, v25, v121, 0
    v_lshlrev_b32 v120, 4, v120
    v_msad_u8 v120, v24, v122, v120
    v_lshlrev_b32 v120, 4, v120
    v_msad_u8 v120, v23, v77, v120

    v_and_b32 v120, v120, v119
    v_cmp_eq_u32 vcc, 0, v120
    v_ffbl_b32 v118, v120
    s_or_b64 vcc, vcc, s[70:71]
    v_cndmask_b32 v118, v118, v84, vcc
    v_lshlrev_b32 v72, v118, v10
    v_lshl_add_u32 v73, v118, 1, v31
    v_xor_b32 v71, v71, v72

    ds_read_u16 v82, v73 offset:0

    v_ffbl_b32 v84, v71
    v_mul_u32_u24 v72, 5, v84
    v_lshrrev_b64 v[72:73], v72, v[74:75]
    v_and_or_b32 v72, v72, s66, v85
    ds_add_rtn_u32 v87, v72, v10
    ds_wrxchg_rtn_b32 v116, v86, v13
    v_and_b32 v117, 15, v71
    v_bcnt_u32_b32 v118, v117, 0
    v_cmp_eq_u32 vcc, 1, v118

    buffer_load_dwordx4 v[152:155], v9, s[28:31], s77 offen offset:2048
    s_add_u32 s47, s44, 20480
    buffer_load_dwordx4 v[96:99], v7, s[20:23], s47 offen offset:0
    buffer_load_dwordx4 v[100:103], v7, s[20:23], s47 offen offset:64

    v_cndmask_b32 v119, v71, v117, vcc
    s_waitcnt lgkmcnt(0)
    v_cmp_gt_u32 s[68:69], 2, v116
    v_cmp_gt_u32 s[70:71], 2, v87

    s_nop 0
    v_lshrrev_b64 v[76:77], v123, s[68:69]
    v_perm_b32 v121, v76, v76, v2
    v_perm_b32 v122, v76, v76, v1
    v_perm_b32 v77, v76, v76, v0
    v_and_b32 v121, v121, v18
    v_and_b32 v122, v122, v17
    v_and_b32 v77, v77, v16
    v_msad_u8 v120, v25, v121, 0
    v_lshlrev_b32 v120, 4, v120
    v_msad_u8 v120, v24, v122, v120
    v_lshlrev_b32 v120, 4, v120
    v_msad_u8 v120, v23, v77, v120

    v_and_b32 v120, v120, v119
    v_cmp_eq_u32 vcc, 0, v120
    v_ffbl_b32 v118, v120
    s_or_b64 vcc, vcc, s[70:71]
    v_cndmask_b32 v118, v118, v84, vcc
    v_lshlrev_b32 v72, v118, v10
    v_lshl_add_u32 v73, v118, 1, v31
    v_xor_b32 v71, v71, v72

    ds_read_u16 v83, v73 offset:0
    v_lshrrev_b32 v71, 4, v71
    v_or_b32 v71, 0xf00, v71
    v_lshlrev_b32 v74, 22, v66
    v_lshl_or_b32 v74, v65, 2, v74
    v_lshrrev_b32 v75, 10, v66
    v_lshl_or_b32 v75, v67, 10, v75

    v_ffbl_b32 v84, v71
    v_mul_u32_u24 v72, 5, v84
    v_lshrrev_b64 v[72:73], v72, v[74:75]
    v_and_or_b32 v72, v72, s66, v85
    ds_add_rtn_u32 v87, v72, v10
    ds_wrxchg_rtn_b32 v116, v86, v13
    v_and_b32 v117, 15, v71
    v_bcnt_u32_b32 v118, v117, 0
    v_cmp_eq_u32 vcc, 4, v118

    buffer_load_dwordx4 v[156:159], v9, s[28:31], s77 offen offset:3072
    s_add_u32 s77, s77, 126976
    s_add_u32 s47, s44, 24576
    buffer_load_dwordx4 v[104:107], v7, s[20:23], s47 offen offset:0
    buffer_load_dwordx4 v[108:111], v7, s[20:23], s47 offen offset:64

    v_cndmask_b32 v119, v71, v117, vcc
    s_waitcnt lgkmcnt(0)
    v_cmp_gt_u32 s[68:69], 2, v116
    v_cmp_gt_u32 s[70:71], 2, v87

    v_lshl_or_b32 v78, v81, 16, v80
    v_lshl_or_b32 v79, v83, 16, v82
    buffer_store_dwordx2 v[78:79], v30, s[32:35], s62 offen sc1
    s_add_u32 s62, s62, 65536
    v_lshrrev_b64 v[76:77], v123, s[68:69]
    v_perm_b32 v121, v76, v76, v3
    v_perm_b32 v122, v76, v76, v2
    v_perm_b32 v77, v76, v76, v1
    v_and_b32 v121, v121, v19
    v_and_b32 v122, v122, v18
    v_and_b32 v77, v77, v17
    v_msad_u8 v120, v26, v121, 0
    v_lshlrev_b32 v120, 4, v120
    v_msad_u8 v120, v25, v122, v120
    v_lshlrev_b32 v120, 4, v120
    v_msad_u8 v120, v24, v77, v120

    v_and_b32 v120, v120, v119
    v_cmp_eq_u32 vcc, 0, v120
    v_ffbl_b32 v118, v120
    s_or_b64 vcc, vcc, s[70:71]
    v_cndmask_b32 v118, v118, v84, vcc
    v_lshlrev_b32 v72, v118, v10
    v_lshl_add_u32 v73, v118, 1, v31
    v_xor_b32 v71, v71, v72

    ds_read_u16 v80, v73 offset:8

    v_ffbl_b32 v84, v71
    v_mul_u32_u24 v72, 5, v84
    v_lshrrev_b64 v[72:73], v72, v[74:75]
    v_and_or_b32 v72, v72, s66, v85
    ds_add_rtn_u32 v87, v72, v10
    ds_wrxchg_rtn_b32 v116, v86, v13
    v_and_b32 v117, 15, v71
    v_bcnt_u32_b32 v118, v117, 0
    v_cmp_eq_u32 vcc, 3, v118

    buffer_load_dwordx4 v[160:163], v9, s[28:31], s77 offen offset:0
    s_add_u32 s47, s44, 28672
    buffer_load_dwordx4 v[112:115], v7, s[20:23], s47 offen offset:0
    buffer_load_dwordx4 v[124:127], v7, s[20:23], s47 offen offset:64

    v_cndmask_b32 v119, v71, v117, vcc
    s_waitcnt lgkmcnt(0)
    v_cmp_gt_u32 s[68:69], 2, v116
    v_cmp_gt_u32 s[70:71], 2, v87

    s_nop 0
    v_lshrrev_b64 v[76:77], v123, s[68:69]
    v_perm_b32 v121, v76, v76, v3
    v_perm_b32 v122, v76, v76, v2
    v_perm_b32 v77, v76, v76, v1
    v_and_b32 v121, v121, v19
    v_and_b32 v122, v122, v18
    v_and_b32 v77, v77, v17
    v_msad_u8 v120, v26, v121, 0
    v_lshlrev_b32 v120, 4, v120
    v_msad_u8 v120, v25, v122, v120
    v_lshlrev_b32 v120, 4, v120
    v_msad_u8 v120, v24, v77, v120

    v_and_b32 v120, v120, v119
    v_cmp_eq_u32 vcc, 0, v120
    v_ffbl_b32 v118, v120
    s_or_b64 vcc, vcc, s[70:71]
    v_cndmask_b32 v118, v118, v84, vcc
    v_lshlrev_b32 v72, v118, v10
    v_lshl_add_u32 v73, v118, 1, v31
    v_xor_b32 v71, v71, v72

    ds_read_u16 v81, v73 offset:8

    v_ffbl_b32 v84, v71
    v_mul_u32_u24 v72, 5, v84
    v_lshrrev_b64 v[72:73], v72, v[74:75]
    v_and_or_b32 v72, v72, s66, v85
    ds_add_rtn_u32 v87, v72, v10
    ds_wrxchg_rtn_b32 v116, v86, v13
    v_and_b32 v117, 15, v71
    v_bcnt_u32_b32 v118, v117, 0
    v_cmp_eq_u32 vcc, 2, v118

    buffer_load_dwordx4 v[164:167], v9, s[28:31], s77 offen offset:1024

    v_cndmask_b32 v119, v71, v117, vcc
    s_waitcnt lgkmcnt(0)
    v_cmp_gt_u32 s[68:69], 2, v116
    v_cmp_gt_u32 s[70:71], 2, v87

    s_nop 0
    v_lshrrev_b64 v[76:77], v123, s[68:69]
    v_perm_b32 v121, v76, v76, v3
    v_perm_b32 v122, v76, v76, v2
    v_perm_b32 v77, v76, v76, v1
    v_and_b32 v121, v121, v19
    v_and_b32 v122, v122, v18
    v_and_b32 v77, v77, v17
    v_msad_u8 v120, v26, v121, 0
    v_lshlrev_b32 v120, 4, v120
    v_msad_u8 v120, v25, v122, v120
    v_lshlrev_b32 v120, 4, v120
    v_msad_u8 v120, v24, v77, v120

    v_and_b32 v120, v120, v119
    v_cmp_eq_u32 vcc, 0, v120
    v_ffbl_b32 v118, v120
    s_or_b64 vcc, vcc, s[70:71]
    v_cndmask_b32 v118, v118, v84, vcc
    v_lshlrev_b32 v72, v118, v10
    v_lshl_add_u32 v73, v118, 1, v31
    v_xor_b32 v71, v71, v72

    ds_read_u16 v82, v73 offset:8

    v_ffbl_b32 v84, v71
    v_mul_u32_u24 v72, 5, v84
    v_lshrrev_b64 v[72:73], v72, v[74:75]
    v_and_or_b32 v72, v72, s66, v85
    ds_add_rtn_u32 v87, v72, v10
    ds_wrxchg_rtn_b32 v116, v86, v13
    v_and_b32 v117, 15, v71
    v_bcnt_u32_b32 v118, v117, 0
    v_cmp_eq_u32 vcc, 1, v118

    buffer_load_dwordx4 v[168:171], v9, s[28:31], s77 offen offset:2048

    v_cndmask_b32 v119, v71, v117, vcc
    s_waitcnt lgkmcnt(0)
    v_cmp_gt_u32 s[68:69], 2, v116
    v_cmp_gt_u32 s[70:71], 2, v87

    s_nop 0
    v_lshrrev_b64 v[76:77], v123, s[68:69]
    v_perm_b32 v121, v76, v76, v3
    v_perm_b32 v122, v76, v76, v2
    v_perm_b32 v77, v76, v76, v1
    v_and_b32 v121, v121, v19
    v_and_b32 v122, v122, v18
    v_and_b32 v77, v77, v17
    v_msad_u8 v120, v26, v121, 0
    v_lshlrev_b32 v120, 4, v120
    v_msad_u8 v120, v25, v122, v120
    v_lshlrev_b32 v120, 4, v120
    v_msad_u8 v120, v24, v77, v120

    v_and_b32 v120, v120, v119
    v_cmp_eq_u32 vcc, 0, v120
    v_ffbl_b32 v118, v120
    s_or_b64 vcc, vcc, s[70:71]
    v_cndmask_b32 v118, v118, v84, vcc
    v_lshlrev_b32 v72, v118, v10
    v_lshl_add_u32 v73, v118, 1, v31
    v_xor_b32 v71, v71, v72

    ds_read_u16 v83, v73 offset:8
    v_lshrrev_b32 v71, 4, v71
    v_or_b32 v71, 0xf00, v71
    v_lshlrev_b32 v74, 22, v67
    v_lshl_or_b32 v74, v66, 2, v74
    v_lshrrev_b32 v75, 10, v67
    v_lshl_or_b32 v75, v68, 10, v75

    v_ffbl_b32 v84, v71
    v_mul_u32_u24 v72, 5, v84
    v_lshrrev_b64 v[72:73], v72, v[74:75]
    v_and_or_b32 v72, v72, s66, v85
    ds_add_rtn_u32 v87, v72, v10
    ds_wrxchg_rtn_b32 v116, v86, v13
    v_and_b32 v117, 15, v71
    v_bcnt_u32_b32 v118, v117, 0
    v_cmp_eq_u32 vcc, 4, v118

    buffer_load_dwordx4 v[172:175], v9, s[28:31], s77 offen offset:3072
    s_add_u32 s77, s77, 4096

    v_cndmask_b32 v119, v71, v117, vcc
    s_waitcnt lgkmcnt(0)
    v_cmp_gt_u32 s[68:69], 2, v116
    v_cmp_gt_u32 s[70:71], 2, v87

    v_lshl_or_b32 v78, v81, 16, v80
    v_lshl_or_b32 v79, v83, 16, v82
    buffer_store_dwordx2 v[78:79], v30, s[32:35], s62 offen sc1
    s_add_u32 s62, s62, 65536
    v_lshrrev_b64 v[76:77], v123, s[68:69]
    v_perm_b32 v121, v76, v76, v4
    v_perm_b32 v122, v76, v76, v3
    v_perm_b32 v77, v76, v76, v2
    v_and_b32 v121, v121, v20
    v_and_b32 v122, v122, v19
    v_and_b32 v77, v77, v18
    v_msad_u8 v120, v27, v121, 0
    v_lshlrev_b32 v120, 4, v120
    v_msad_u8 v120, v26, v122, v120
    v_lshlrev_b32 v120, 4, v120
    v_msad_u8 v120, v25, v77, v120

    v_and_b32 v120, v120, v119
    v_cmp_eq_u32 vcc, 0, v120
    v_ffbl_b32 v118, v120
    s_or_b64 vcc, vcc, s[70:71]
    v_cndmask_b32 v118, v118, v84, vcc
    v_lshlrev_b32 v72, v118, v10
    v_lshl_add_u32 v73, v118, 1, v31
    v_xor_b32 v71, v71, v72

    ds_read_u16 v80, v73 offset:16

    v_ffbl_b32 v84, v71
    v_mul_u32_u24 v72, 5, v84
    v_lshrrev_b64 v[72:73], v72, v[74:75]
    v_and_or_b32 v72, v72, s66, v85
    ds_add_rtn_u32 v87, v72, v10
    ds_wrxchg_rtn_b32 v116, v86, v13
    v_and_b32 v117, 15, v71
    v_bcnt_u32_b32 v118, v117, 0
    v_cmp_eq_u32 vcc, 3, v118

    buffer_load_dwordx4 v[176:179], v9, s[28:31], s77 offen offset:0

    v_cndmask_b32 v119, v71, v117, vcc
    s_waitcnt lgkmcnt(0)
    v_cmp_gt_u32 s[68:69], 2, v116
    v_cmp_gt_u32 s[70:71], 2, v87

    s_nop 0
    v_lshrrev_b64 v[76:77], v123, s[68:69]
    v_perm_b32 v121, v76, v76, v4
    v_perm_b32 v122, v76, v76, v3
    v_perm_b32 v77, v76, v76, v2
    v_and_b32 v121, v121, v20
    v_and_b32 v122, v122, v19
    v_and_b32 v77, v77, v18
    v_msad_u8 v120, v27, v121, 0
    v_lshlrev_b32 v120, 4, v120
    v_msad_u8 v120, v26, v122, v120
    v_lshlrev_b32 v120, 4, v120
    v_msad_u8 v120, v25, v77, v120

    v_and_b32 v120, v120, v119
    v_cmp_eq_u32 vcc, 0, v120
    v_ffbl_b32 v118, v120
    s_or_b64 vcc, vcc, s[70:71]
    v_cndmask_b32 v118, v118, v84, vcc
    v_lshlrev_b32 v72, v118, v10
    v_lshl_add_u32 v73, v118, 1, v31
    v_xor_b32 v71, v71, v72

    ds_read_u16 v81, v73 offset:16

    v_ffbl_b32 v84, v71
    v_mul_u32_u24 v72, 5, v84
    v_lshrrev_b64 v[72:73], v72, v[74:75]
    v_and_or_b32 v72, v72, s66, v85
    ds_add_rtn_u32 v87, v72, v10
    ds_wrxchg_rtn_b32 v116, v86, v13
    v_and_b32 v117, 15, v71
    v_bcnt_u32_b32 v118, v117, 0
    v_cmp_eq_u32 vcc, 2, v118

    buffer_load_dwordx4 v[180:183], v9, s[28:31], s77 offen offset:1024

    v_cndmask_b32 v119, v71, v117, vcc
    s_waitcnt lgkmcnt(0)
    v_cmp_gt_u32 s[68:69], 2, v116
    v_cmp_gt_u32 s[70:71], 2, v87

    s_nop 0
    v_lshrrev_b64 v[76:77], v123, s[68:69]
    v_perm_b32 v121, v76, v76, v4
    v_perm_b32 v122, v76, v76, v3
    v_perm_b32 v77, v76, v76, v2
    v_and_b32 v121, v121, v20
    v_and_b32 v122, v122, v19
    v_and_b32 v77, v77, v18
    v_msad_u8 v120, v27, v121, 0
    v_lshlrev_b32 v120, 4, v120
    v_msad_u8 v120, v26, v122, v120
    v_lshlrev_b32 v120, 4, v120
    v_msad_u8 v120, v25, v77, v120

    v_and_b32 v120, v120, v119
    v_cmp_eq_u32 vcc, 0, v120
    v_ffbl_b32 v118, v120
    s_or_b64 vcc, vcc, s[70:71]
    v_cndmask_b32 v118, v118, v84, vcc
    v_lshlrev_b32 v72, v118, v10
    v_lshl_add_u32 v73, v118, 1, v31
    v_xor_b32 v71, v71, v72

    ds_read_u16 v82, v73 offset:16

    v_ffbl_b32 v84, v71
    v_mul_u32_u24 v72, 5, v84
    v_lshrrev_b64 v[72:73], v72, v[74:75]
    v_and_or_b32 v72, v72, s66, v85
    ds_add_rtn_u32 v87, v72, v10
    ds_wrxchg_rtn_b32 v116, v86, v13
    v_and_b32 v117, 15, v71
    v_bcnt_u32_b32 v118, v117, 0
    v_cmp_eq_u32 vcc, 1, v118

    buffer_load_dwordx4 v[184:187], v9, s[28:31], s77 offen offset:2048

    v_cndmask_b32 v119, v71, v117, vcc
    s_waitcnt lgkmcnt(0)
    v_cmp_gt_u32 s[68:69], 2, v116
    v_cmp_gt_u32 s[70:71], 2, v87

    s_nop 0
    v_lshrrev_b64 v[76:77], v123, s[68:69]
    v_perm_b32 v121, v76, v76, v4
    v_perm_b32 v122, v76, v76, v3
    v_perm_b32 v77, v76, v76, v2
    v_and_b32 v121, v121, v20
    v_and_b32 v122, v122, v19
    v_and_b32 v77, v77, v18
    v_msad_u8 v120, v27, v121, 0
    v_lshlrev_b32 v120, 4, v120
    v_msad_u8 v120, v26, v122, v120
    v_lshlrev_b32 v120, 4, v120
    v_msad_u8 v120, v25, v77, v120

    v_and_b32 v120, v120, v119
    v_cmp_eq_u32 vcc, 0, v120
    v_ffbl_b32 v118, v120
    s_or_b64 vcc, vcc, s[70:71]
    v_cndmask_b32 v118, v118, v84, vcc
    v_lshlrev_b32 v72, v118, v10
    v_lshl_add_u32 v73, v118, 1, v31
    v_xor_b32 v71, v71, v72

    ds_read_u16 v83, v73 offset:16
    v_lshrrev_b32 v71, 4, v71
    v_or_b32 v71, 0xf00, v71
    v_lshlrev_b32 v74, 22, v68
    v_lshl_or_b32 v74, v67, 2, v74
    v_lshrrev_b32 v75, 10, v68
    v_lshl_or_b32 v75, v69, 10, v75

    v_ffbl_b32 v84, v71
    v_mul_u32_u24 v72, 5, v84
    v_lshrrev_b64 v[72:73], v72, v[74:75]
    v_and_or_b32 v72, v72, s66, v85
    ds_add_rtn_u32 v87, v72, v10
    ds_wrxchg_rtn_b32 v116, v86, v13
    v_and_b32 v117, 15, v71
    v_bcnt_u32_b32 v118, v117, 0
    v_cmp_eq_u32 vcc, 4, v118

    buffer_load_dwordx4 v[188:191], v9, s[28:31], s77 offen offset:3072

    v_cndmask_b32 v119, v71, v117, vcc
    s_waitcnt lgkmcnt(0)
    v_cmp_gt_u32 s[68:69], 2, v116
    v_cmp_gt_u32 s[70:71], 2, v87

    v_lshl_or_b32 v78, v81, 16, v80
    v_lshl_or_b32 v79, v83, 16, v82
    buffer_store_dwordx2 v[78:79], v30, s[32:35], s62 offen sc1
    s_add_u32 s62, s62, 65536
    v_lshrrev_b64 v[76:77], v123, s[68:69]
    v_perm_b32 v121, v76, v76, v5
    v_perm_b32 v122, v76, v76, v4
    v_perm_b32 v77, v76, v76, v3
    v_and_b32 v121, v121, v21
    v_and_b32 v122, v122, v20
    v_and_b32 v77, v77, v19
    v_msad_u8 v120, v28, v121, 0
    v_lshlrev_b32 v120, 4, v120
    v_msad_u8 v120, v27, v122, v120
    v_lshlrev_b32 v120, 4, v120
    v_msad_u8 v120, v26, v77, v120

    v_and_b32 v120, v120, v119
    v_cmp_eq_u32 vcc, 0, v120
    v_ffbl_b32 v118, v120
    s_or_b64 vcc, vcc, s[70:71]
    v_cndmask_b32 v118, v118, v84, vcc
    v_lshlrev_b32 v72, v118, v10
    v_lshl_add_u32 v73, v118, 1, v31
    v_xor_b32 v71, v71, v72

    ds_read_u16 v80, v73 offset:24
    s_setprio 1

    s_cmp_ge_u32 s57, 800
    s_cbranch_scc1 k1_kernel_norl
    s_waitcnt vmcnt(0)

    v_perm_b32 v192, v132, v128, s84
    v_perm_b32 v193, v140, v136, s84
    v_perm_b32 v194, v148, v144, s84
    v_perm_b32 v195, v156, v152, s84
    v_perm_b32 v196, v132, v128, s85
    v_perm_b32 v197, v140, v136, s85
    v_perm_b32 v198, v148, v144, s85
    v_perm_b32 v199, v156, v152, s85
    v_perm_b32 v200, v133, v129, s84
    v_perm_b32 v201, v141, v137, s84
    v_perm_b32 v202, v149, v145, s84
    v_perm_b32 v203, v157, v153, s84
    v_perm_b32 v204, v133, v129, s85
    v_perm_b32 v205, v141, v137, s85
    v_perm_b32 v206, v149, v145, s85
    v_perm_b32 v207, v157, v153, s85
    ds_write_b128 v36, v[192:195]
    ds_write_b128 v37, v[196:199]
    ds_write_b128 v38, v[200:203]
    ds_write_b128 v39, v[204:207]
    ds_read_b128 v[224:227], v15 offset:0
    ds_read_b128 v[228:231], v15 offset:1024
    ds_read_b128 v[232:235], v15 offset:2048
    ds_read_b128 v[236:239], v15 offset:3072
    v_perm_b32 v208, v164, v160, s84
    v_perm_b32 v209, v172, v168, s84
    v_perm_b32 v210, v180, v176, s84
    v_perm_b32 v211, v188, v184, s84
    v_perm_b32 v212, v164, v160, s85
    v_perm_b32 v213, v172, v168, s85
    v_perm_b32 v214, v180, v176, s85
    v_perm_b32 v215, v188, v184, s85
    v_perm_b32 v216, v165, v161, s84
    v_perm_b32 v217, v173, v169, s84
    v_perm_b32 v218, v181, v177, s84
    v_perm_b32 v219, v189, v185, s84
    v_perm_b32 v220, v165, v161, s85
    v_perm_b32 v221, v173, v169, s85
    v_perm_b32 v222, v181, v177, s85
    v_perm_b32 v223, v189, v185, s85
    s_waitcnt lgkmcnt(0)
    s_add_u32 s83, s82, 0
    buffer_store_dwordx4 v[224:227], v14, s[32:35], s83 offen sc1
    s_add_u32 s83, s82, 3284992
    buffer_store_dwordx4 v[228:231], v14, s[32:35], s83 offen sc1
    s_add_u32 s83, s82, 6569984
    buffer_store_dwordx4 v[232:235], v14, s[32:35], s83 offen sc1
    s_add_u32 s83, s82, 9854976
    buffer_store_dwordx4 v[236:239], v14, s[32:35], s83 offen sc1
    ds_write_b128 v36, v[208:211]
    ds_write_b128 v37, v[212:215]
    ds_write_b128 v38, v[216:219]
    ds_write_b128 v39, v[220:223]
    ds_read_b128 v[240:243], v15 offset:0
    ds_read_b128 v[244:247], v15 offset:1024
    ds_read_b128 v[248:251], v15 offset:2048
    ds_read_b128 v[252:255], v15 offset:3072
    v_perm_b32 v192, v134, v130, s84
    v_perm_b32 v193, v142, v138, s84
    v_perm_b32 v194, v150, v146, s84
    v_perm_b32 v195, v158, v154, s84
    v_perm_b32 v196, v134, v130, s85
    v_perm_b32 v197, v142, v138, s85
    v_perm_b32 v198, v150, v146, s85
    v_perm_b32 v199, v158, v154, s85
    v_perm_b32 v200, v135, v131, s84
    v_perm_b32 v201, v143, v139, s84
    v_perm_b32 v202, v151, v147, s84
    v_perm_b32 v203, v159, v155, s84
    v_perm_b32 v204, v135, v131, s85
    v_perm_b32 v205, v143, v139, s85
    v_perm_b32 v206, v151, v147, s85
    v_perm_b32 v207, v159, v155, s85
    s_waitcnt lgkmcnt(0)
    s_add_u32 s83, s82, 64
    buffer_store_dwordx4 v[240:243], v14, s[32:35], s83 offen sc1
    s_add_u32 s83, s82, 3285056
    buffer_store_dwordx4 v[244:247], v14, s[32:35], s83 offen sc1
    s_add_u32 s83, s82, 6570048
    buffer_store_dwordx4 v[248:251], v14, s[32:35], s83 offen sc1
    s_add_u32 s83, s82, 9855040
    buffer_store_dwordx4 v[252:255], v14, s[32:35], s83 offen sc1
    ds_write_b128 v36, v[192:195]
    ds_write_b128 v37, v[196:199]
    ds_write_b128 v38, v[200:203]
    ds_write_b128 v39, v[204:207]
    ds_read_b128 v[224:227], v15 offset:0
    ds_read_b128 v[228:231], v15 offset:1024
    ds_read_b128 v[232:235], v15 offset:2048
    ds_read_b128 v[236:239], v15 offset:3072
    v_perm_b32 v208, v166, v162, s84
    v_perm_b32 v209, v174, v170, s84
    v_perm_b32 v210, v182, v178, s84
    v_perm_b32 v211, v190, v186, s84
    v_perm_b32 v212, v166, v162, s85
    v_perm_b32 v213, v174, v170, s85
    v_perm_b32 v214, v182, v178, s85
    v_perm_b32 v215, v190, v186, s85
    v_perm_b32 v216, v167, v163, s84
    v_perm_b32 v217, v175, v171, s84
    v_perm_b32 v218, v183, v179, s84
    v_perm_b32 v219, v191, v187, s84
    v_perm_b32 v220, v167, v163, s85
    v_perm_b32 v221, v175, v171, s85
    v_perm_b32 v222, v183, v179, s85
    v_perm_b32 v223, v191, v187, s85
    s_waitcnt lgkmcnt(0)
    s_add_u32 s83, s82, 102656
    buffer_store_dwordx4 v[224:227], v14, s[32:35], s83 offen sc1
    s_add_u32 s83, s82, 3387648
    buffer_store_dwordx4 v[228:231], v14, s[32:35], s83 offen sc1
    s_add_u32 s83, s82, 6672640
    buffer_store_dwordx4 v[232:235], v14, s[32:35], s83 offen sc1
    s_add_u32 s83, s82, 9957632
    buffer_store_dwordx4 v[236:239], v14, s[32:35], s83 offen sc1
    ds_write_b128 v36, v[208:211]
    ds_write_b128 v37, v[212:215]
    ds_write_b128 v38, v[216:219]
    ds_write_b128 v39, v[220:223]
    ds_read_b128 v[240:243], v15 offset:0
    ds_read_b128 v[244:247], v15 offset:1024
    ds_read_b128 v[248:251], v15 offset:2048
    ds_read_b128 v[252:255], v15 offset:3072
    ds_write_b64 v31, v[40:41] offset:0
    ds_write_b64 v31, v[42:43] offset:8
    ds_write_b64 v31, v[44:45] offset:16
    ds_write_b64 v31, v[46:47] offset:24
    ds_write_b64 v31, v[48:49] offset:32
    ds_write_b64 v31, v[50:51] offset:40
    ds_write_b64 v31, v[52:53] offset:48
    s_waitcnt lgkmcnt(7)
    s_add_u32 s83, s82, 102720
    buffer_store_dwordx4 v[240:243], v14, s[32:35], s83 offen sc1
    s_add_u32 s83, s82, 3387712
    buffer_store_dwordx4 v[244:247], v14, s[32:35], s83 offen sc1
    s_add_u32 s83, s82, 6672704
    buffer_store_dwordx4 v[248:251], v14, s[32:35], s83 offen sc1
    s_add_u32 s83, s82, 9957696
    buffer_store_dwordx4 v[252:255], v14, s[32:35], s83 offen sc1
k1_kernel_norl:
k1_kernel_rld:
    ds_write_b32 v86, v13
    s_setprio 0

    v_ffbl_b32 v84, v71
    v_mul_u32_u24 v72, 5, v84
    v_lshrrev_b64 v[72:73], v72, v[74:75]
    v_and_or_b32 v72, v72, s66, v85
    ds_add_rtn_u32 v87, v72, v10
    ds_wrxchg_rtn_b32 v116, v86, v13
    v_and_b32 v117, 15, v71
    v_bcnt_u32_b32 v118, v117, 0
    v_cmp_eq_u32 vcc, 3, v118

    s_add_u32 s47, s44, 0
    buffer_load_dwordx4 v[32:35], v7, s[20:23], s47 offen offset:0
    buffer_load_dwordx4 v[36:39], v7, s[20:23], s47 offen offset:64
    s_add_u32 s47, s44, 4096
    buffer_load_dwordx4 v[40:43], v7, s[20:23], s47 offen offset:0
    buffer_load_dwordx4 v[44:47], v7, s[20:23], s47 offen offset:64

    v_cndmask_b32 v119, v71, v117, vcc
    s_waitcnt lgkmcnt(0)
    v_cmp_gt_u32 s[68:69], 2, v116
    v_cmp_gt_u32 s[70:71], 2, v87

    s_nop 0
    v_lshrrev_b64 v[76:77], v123, s[68:69]
    v_perm_b32 v121, v76, v76, v5
    v_perm_b32 v122, v76, v76, v4
    v_perm_b32 v77, v76, v76, v3
    v_and_b32 v121, v121, v21
    v_and_b32 v122, v122, v20
    v_and_b32 v77, v77, v19
    v_msad_u8 v120, v28, v121, 0
    v_lshlrev_b32 v120, 4, v120
    v_msad_u8 v120, v27, v122, v120
    v_lshlrev_b32 v120, 4, v120
    v_msad_u8 v120, v26, v77, v120

    v_and_b32 v120, v120, v119
    v_cmp_eq_u32 vcc, 0, v120
    v_ffbl_b32 v118, v120
    s_or_b64 vcc, vcc, s[70:71]
    v_cndmask_b32 v118, v118, v84, vcc
    v_lshlrev_b32 v72, v118, v10
    v_lshl_add_u32 v73, v118, 1, v31
    v_xor_b32 v71, v71, v72

    ds_read_u16 v81, v73 offset:24

    v_ffbl_b32 v84, v71
    v_mul_u32_u24 v72, 5, v84
    v_lshrrev_b64 v[72:73], v72, v[74:75]
    v_and_or_b32 v72, v72, s66, v85
    ds_add_rtn_u32 v87, v72, v10
    ds_wrxchg_rtn_b32 v116, v86, v13
    v_and_b32 v117, 15, v71
    v_bcnt_u32_b32 v118, v117, 0
    v_cmp_eq_u32 vcc, 2, v118

    s_add_u32 s47, s44, 8192
    buffer_load_dwordx4 v[48:51], v7, s[20:23], s47 offen offset:0
    buffer_load_dwordx4 v[52:55], v7, s[20:23], s47 offen offset:64
    s_add_u32 s47, s44, 131072
    buffer_load_dwordx4 v[136:139], v7, s[20:23], s47 offen offset:0
    buffer_load_dwordx4 v[140:143], v7, s[20:23], s47 offen offset:64

    v_cndmask_b32 v119, v71, v117, vcc
    s_waitcnt lgkmcnt(0)
    v_cmp_gt_u32 s[68:69], 2, v116
    v_cmp_gt_u32 s[70:71], 2, v87

    s_nop 0
    v_lshrrev_b64 v[76:77], v123, s[68:69]
    v_perm_b32 v121, v76, v76, v5
    v_perm_b32 v122, v76, v76, v4
    v_perm_b32 v77, v76, v76, v3
    v_and_b32 v121, v121, v21
    v_and_b32 v122, v122, v20
    v_and_b32 v77, v77, v19
    v_msad_u8 v120, v28, v121, 0
    v_lshlrev_b32 v120, 4, v120
    v_msad_u8 v120, v27, v122, v120
    v_lshlrev_b32 v120, 4, v120
    v_msad_u8 v120, v26, v77, v120

    v_and_b32 v120, v120, v119
    v_cmp_eq_u32 vcc, 0, v120
    v_ffbl_b32 v118, v120
    s_or_b64 vcc, vcc, s[70:71]
    v_cndmask_b32 v118, v118, v84, vcc
    v_lshlrev_b32 v72, v118, v10
    v_lshl_add_u32 v73, v118, 1, v31
    v_xor_b32 v71, v71, v72

    ds_read_u16 v82, v73 offset:24

    v_ffbl_b32 v84, v71
    v_mul_u32_u24 v72, 5, v84
    v_lshrrev_b64 v[72:73], v72, v[74:75]
    v_and_or_b32 v72, v72, s66, v85
    ds_add_rtn_u32 v87, v72, v10
    ds_wrxchg_rtn_b32 v116, v86, v13
    v_and_b32 v117, 15, v71
    v_bcnt_u32_b32 v118, v117, 0
    v_cmp_eq_u32 vcc, 1, v118

    s_add_u32 s47, s44, 135168
    buffer_load_dwordx4 v[152:155], v7, s[20:23], s47 offen offset:0
    buffer_load_dwordx4 v[156:159], v7, s[20:23], s47 offen offset:64
    s_add_u32 s47, s44, 139264
    buffer_load_dwordx4 v[168:171], v7, s[20:23], s47 offen offset:0
    buffer_load_dwordx4 v[172:175], v7, s[20:23], s47 offen offset:64

    v_cndmask_b32 v119, v71, v117, vcc
    s_waitcnt lgkmcnt(0)
    v_cmp_gt_u32 s[68:69], 2, v116
    v_cmp_gt_u32 s[70:71], 2, v87

    s_nop 0
    v_lshrrev_b64 v[76:77], v123, s[68:69]
    v_perm_b32 v121, v76, v76, v5
    v_perm_b32 v122, v76, v76, v4
    v_perm_b32 v77, v76, v76, v3
    v_and_b32 v121, v121, v21
    v_and_b32 v122, v122, v20
    v_and_b32 v77, v77, v19
    v_msad_u8 v120, v28, v121, 0
    v_lshlrev_b32 v120, 4, v120
    v_msad_u8 v120, v27, v122, v120
    v_lshlrev_b32 v120, 4, v120
    v_msad_u8 v120, v26, v77, v120

    v_and_b32 v120, v120, v119
    v_cmp_eq_u32 vcc, 0, v120
    v_ffbl_b32 v118, v120
    s_or_b64 vcc, vcc, s[70:71]
    v_cndmask_b32 v118, v118, v84, vcc
    v_lshlrev_b32 v72, v118, v10
    v_lshl_add_u32 v73, v118, 1, v31
    v_xor_b32 v71, v71, v72

    ds_read_u16 v83, v73 offset:24
    v_lshrrev_b32 v71, 4, v71
    v_or_b32 v71, s63, v71
    v_lshlrev_b32 v74, 22, v69
    v_lshl_or_b32 v74, v68, 2, v74
    v_lshrrev_b32 v75, 10, v69
    v_lshl_or_b32 v75, v70, 10, v75

    v_ffbl_b32 v84, v71
    v_mul_u32_u24 v72, 5, v84
    v_lshrrev_b64 v[72:73], v72, v[74:75]
    v_and_or_b32 v72, v72, s66, v85
    ds_add_rtn_u32 v87, v72, v10
    ds_wrxchg_rtn_b32 v116, v86, v13
    v_and_b32 v117, 15, v71
    v_bcnt_u32_b32 v118, v117, 0
    v_cmp_eq_u32 vcc, 4, v118

    s_add_u32 s47, s44, 143360
    buffer_load_dwordx4 v[184:187], v7, s[20:23], s47 offen offset:0
    buffer_load_dwordx4 v[188:191], v7, s[20:23], s47 offen offset:64
    s_add_u32 s47, s44, 147456
    buffer_load_dwordx4 v[200:203], v7, s[20:23], s47 offen offset:0
    buffer_load_dwordx4 v[204:207], v7, s[20:23], s47 offen offset:64

    v_cndmask_b32 v119, v71, v117, vcc
    s_waitcnt lgkmcnt(0)
    v_cmp_gt_u32 s[68:69], 2, v116
    v_cmp_gt_u32 s[70:71], 2, v87

    v_lshl_or_b32 v78, v81, 16, v80
    v_lshl_or_b32 v79, v83, 16, v82
    buffer_store_dwordx2 v[78:79], v30, s[32:35], s62 offen sc1
    s_add_u32 s62, s62, 65536
    v_lshrrev_b64 v[76:77], v123, s[68:69]
    v_perm_b32 v121, v76, v76, v6
    v_perm_b32 v122, v76, v76, v5
    v_perm_b32 v77, v76, v76, v4
    v_and_b32 v121, v121, v22
    v_and_b32 v122, v122, v21
    v_and_b32 v77, v77, v20
    v_msad_u8 v120, v29, v121, 0
    v_lshlrev_b32 v120, 4, v120
    v_msad_u8 v120, v28, v122, v120
    v_lshlrev_b32 v120, 4, v120
    v_msad_u8 v120, v27, v77, v120

    v_and_b32 v120, v120, v119
    v_cmp_eq_u32 vcc, 0, v120
    v_ffbl_b32 v118, v120
    s_or_b64 vcc, vcc, s[70:71]
    v_cndmask_b32 v118, v118, v84, vcc
    v_lshlrev_b32 v72, v118, v10
    v_lshl_add_u32 v73, v118, 1, v31
    v_xor_b32 v71, v71, v72

    ds_read_u16 v80, v73 offset:32
    s_setprio 1

    v_ffbl_b32 v84, v71
    v_mul_u32_u24 v72, 5, v84
    v_lshrrev_b64 v[72:73], v72, v[74:75]
    v_and_or_b32 v72, v72, s66, v85
    ds_add_rtn_u32 v87, v72, v10
    ds_wrxchg_rtn_b32 v116, v86, v13
    v_and_b32 v117, 15, v71
    v_bcnt_u32_b32 v118, v117, 0
    v_cmp_eq_u32 vcc, 3, v118

    s_add_u32 s47, s44, 151552
    buffer_load_dwordx4 v[216:219], v7, s[20:23], s47 offen offset:0
    buffer_load_dwordx4 v[220:223], v7, s[20:23], s47 offen offset:64
    s_add_u32 s47, s44, 155648
    buffer_load_dwordx4 v[232:235], v7, s[20:23], s47 offen offset:0
    buffer_load_dwordx4 v[236:239], v7, s[20:23], s47 offen offset:64

    v_cndmask_b32 v119, v71, v117, vcc
    s_waitcnt lgkmcnt(0)
    v_cmp_gt_u32 s[68:69], 2, v116
    v_cmp_gt_u32 s[70:71], 2, v87

    s_nop 0
    v_lshrrev_b64 v[76:77], v123, s[68:69]
    v_perm_b32 v121, v76, v76, v6
    v_perm_b32 v122, v76, v76, v5
    v_perm_b32 v77, v76, v76, v4
    v_and_b32 v121, v121, v22
    v_and_b32 v122, v122, v21
    v_and_b32 v77, v77, v20
    v_msad_u8 v120, v29, v121, 0
    v_lshlrev_b32 v120, 4, v120
    v_msad_u8 v120, v28, v122, v120
    v_lshlrev_b32 v120, 4, v120
    v_msad_u8 v120, v27, v77, v120

    v_and_b32 v120, v120, v119
    v_cmp_eq_u32 vcc, 0, v120
    v_ffbl_b32 v118, v120
    s_or_b64 vcc, vcc, s[70:71]
    v_cndmask_b32 v118, v118, v84, vcc
    v_lshlrev_b32 v72, v118, v10
    v_lshl_add_u32 v73, v118, 1, v31
    v_xor_b32 v71, v71, v72

    ds_read_u16 v81, v73 offset:32

    v_ffbl_b32 v84, v71
    v_mul_u32_u24 v72, 5, v84
    v_lshrrev_b64 v[72:73], v72, v[74:75]
    v_and_or_b32 v72, v72, s66, v85
    ds_add_rtn_u32 v87, v72, v10
    ds_wrxchg_rtn_b32 v116, v86, v13
    v_and_b32 v117, 15, v71
    v_bcnt_u32_b32 v118, v117, 0
    v_cmp_eq_u32 vcc, 2, v118

    s_add_u32 s47, s44, 159744
    buffer_load_dwordx4 v[248:251], v7, s[20:23], s47 offen offset:0
    buffer_load_dwordx4 v[252:255], v7, s[20:23], s47 offen offset:64

    v_cndmask_b32 v119, v71, v117, vcc
    s_waitcnt lgkmcnt(0)
    v_cmp_gt_u32 s[68:69], 2, v116
    v_cmp_gt_u32 s[70:71], 2, v87

    s_nop 0
    v_lshrrev_b64 v[76:77], v123, s[68:69]
    v_perm_b32 v121, v76, v76, v6
    v_perm_b32 v122, v76, v76, v5
    v_perm_b32 v77, v76, v76, v4
    v_and_b32 v121, v121, v22
    v_and_b32 v122, v122, v21
    v_and_b32 v77, v77, v20
    v_msad_u8 v120, v29, v121, 0
    v_lshlrev_b32 v120, 4, v120
    v_msad_u8 v120, v28, v122, v120
    v_lshlrev_b32 v120, 4, v120
    v_msad_u8 v120, v27, v77, v120

    v_and_b32 v120, v120, v119
    v_cmp_eq_u32 vcc, 0, v120
    v_ffbl_b32 v118, v120
    s_or_b64 vcc, vcc, s[70:71]
    v_cndmask_b32 v118, v118, v84, vcc
    v_lshlrev_b32 v72, v118, v10
    v_lshl_add_u32 v73, v118, 1, v31
    v_xor_b32 v71, v71, v72

    ds_read_u16 v82, v73 offset:32

    v_ffbl_b32 v84, v71
    v_mul_u32_u24 v72, 5, v84
    v_lshrrev_b64 v[72:73], v72, v[74:75]
    v_and_or_b32 v72, v72, s66, v85
    ds_add_rtn_u32 v87, v72, v10
    ds_wrxchg_rtn_b32 v116, v86, v13
    v_and_b32 v117, 15, v71
    v_bcnt_u32_b32 v118, v117, 0
    v_cmp_eq_u32 vcc, 1, v118

    s_nop 1

    v_cndmask_b32 v119, v71, v117, vcc
    s_waitcnt lgkmcnt(0)
    v_cmp_gt_u32 s[68:69], 2, v116
    v_cmp_gt_u32 s[70:71], 2, v87

    s_nop 0
    v_lshrrev_b64 v[76:77], v123, s[68:69]
    v_perm_b32 v121, v76, v76, v6
    v_perm_b32 v122, v76, v76, v5
    v_perm_b32 v77, v76, v76, v4
    v_and_b32 v121, v121, v22
    v_and_b32 v122, v122, v21
    v_and_b32 v77, v77, v20
    v_msad_u8 v120, v29, v121, 0
    v_lshlrev_b32 v120, 4, v120
    v_msad_u8 v120, v28, v122, v120
    v_lshlrev_b32 v120, 4, v120
    v_msad_u8 v120, v27, v77, v120

    v_and_b32 v120, v120, v119
    v_cmp_eq_u32 vcc, 0, v120
    v_ffbl_b32 v118, v120
    s_or_b64 vcc, vcc, s[70:71]
    v_cndmask_b32 v118, v118, v84, vcc
    v_lshlrev_b32 v72, v118, v10
    v_lshl_add_u32 v73, v118, 1, v31
    v_xor_b32 v71, v71, v72

    ds_read_u16 v83, v73 offset:32
    s_cmp_lg_u32 s59, 3
    s_cbranch_scc1 k1_kernel_sdone
    v_lshrrev_b32 v71, 4, v71
    v_lshlrev_b32 v74, 22, v70
    v_lshl_or_b32 v74, v69, 2, v74
    v_lshrrev_b32 v75, 10, v70

    v_ffbl_b32 v84, v71
    v_mul_u32_u24 v72, 5, v84
    v_lshrrev_b64 v[72:73], v72, v[74:75]
    v_and_or_b32 v72, v72, s66, v85
    ds_add_rtn_u32 v87, v72, v10
    ds_wrxchg_rtn_b32 v116, v86, v13
    v_and_b32 v117, 15, v71
    v_bcnt_u32_b32 v118, v117, 0
    v_cmp_eq_u32 vcc, 4, v118

    s_nop 1

    v_cndmask_b32 v119, v71, v117, vcc
    s_waitcnt lgkmcnt(0)
    v_cmp_gt_u32 s[68:69], 2, v116
    v_cmp_gt_u32 s[70:71], 2, v87

    v_lshl_or_b32 v78, v81, 16, v80
    v_lshl_or_b32 v79, v83, 16, v82
    buffer_store_dwordx2 v[78:79], v30, s[32:35], s62 offen sc1
    s_add_u32 s62, s62, 65536
    v_lshrrev_b64 v[76:77], v123, s[68:69]
    v_perm_b32 v121, v76, v76, v6
    v_perm_b32 v122, v76, v76, v5
    v_and_b32 v121, v121, v22
    v_and_b32 v122, v122, v21
    v_msad_u8 v120, v29, v121, 0
    v_lshlrev_b32 v120, 4, v120
    v_msad_u8 v120, v28, v122, v120

    v_and_b32 v120, v120, v119
    v_cmp_eq_u32 vcc, 0, v120
    v_ffbl_b32 v118, v120
    s_or_b64 vcc, vcc, s[70:71]
    v_cndmask_b32 v118, v118, v84, vcc
    v_lshlrev_b32 v72, v118, v10
    v_lshl_add_u32 v73, v118, 1, v31
    v_xor_b32 v71, v71, v72

    ds_read_u16 v80, v73 offset:40

    v_ffbl_b32 v84, v71
    v_mul_u32_u24 v72, 5, v84
    v_lshrrev_b64 v[72:73], v72, v[74:75]
    v_and_or_b32 v72, v72, s66, v85
    ds_add_rtn_u32 v87, v72, v10
    ds_wrxchg_rtn_b32 v116, v86, v13
    v_and_b32 v117, 15, v71
    v_bcnt_u32_b32 v118, v117, 0
    v_cmp_eq_u32 vcc, 3, v118

    s_nop 1

    v_cndmask_b32 v119, v71, v117, vcc
    s_waitcnt lgkmcnt(0)
    v_cmp_gt_u32 s[68:69], 2, v116
    v_cmp_gt_u32 s[70:71], 2, v87

    s_nop 0
    v_lshrrev_b64 v[76:77], v123, s[68:69]
    v_perm_b32 v121, v76, v76, v6
    v_perm_b32 v122, v76, v76, v5
    v_and_b32 v121, v121, v22
    v_and_b32 v122, v122, v21
    v_msad_u8 v120, v29, v121, 0
    v_lshlrev_b32 v120, 4, v120
    v_msad_u8 v120, v28, v122, v120

    v_and_b32 v120, v120, v119
    v_cmp_eq_u32 vcc, 0, v120
    v_ffbl_b32 v118, v120
    s_or_b64 vcc, vcc, s[70:71]
    v_cndmask_b32 v118, v118, v84, vcc
    v_lshlrev_b32 v72, v118, v10
    v_lshl_add_u32 v73, v118, 1, v31
    v_xor_b32 v71, v71, v72

    ds_read_u16 v81, v73 offset:40

    v_ffbl_b32 v84, v71
    v_mul_u32_u24 v72, 5, v84
    v_lshrrev_b64 v[72:73], v72, v[74:75]
    v_and_or_b32 v72, v72, s66, v85
    ds_add_rtn_u32 v87, v72, v10
    ds_wrxchg_rtn_b32 v116, v86, v13
    v_and_b32 v117, 15, v71
    v_bcnt_u32_b32 v118, v117, 0
    v_cmp_eq_u32 vcc, 2, v118

    s_nop 1

    v_cndmask_b32 v119, v71, v117, vcc
    s_waitcnt lgkmcnt(0)
    v_cmp_gt_u32 s[68:69], 2, v116
    v_cmp_gt_u32 s[70:71], 2, v87

    s_nop 0
    v_lshrrev_b64 v[76:77], v123, s[68:69]
    v_perm_b32 v121, v76, v76, v6
    v_perm_b32 v122, v76, v76, v5
    v_and_b32 v121, v121, v22
    v_and_b32 v122, v122, v21
    v_msad_u8 v120, v29, v121, 0
    v_lshlrev_b32 v120, 4, v120
    v_msad_u8 v120, v28, v122, v120

    v_and_b32 v120, v120, v119
    v_cmp_eq_u32 vcc, 0, v120
    v_ffbl_b32 v118, v120
    s_or_b64 vcc, vcc, s[70:71]
    v_cndmask_b32 v118, v118, v84, vcc
    v_lshlrev_b32 v72, v118, v10
    v_lshl_add_u32 v73, v118, 1, v31
    v_xor_b32 v71, v71, v72

    ds_read_u16 v82, v73 offset:40

    v_ffbl_b32 v84, v71
    v_mul_u32_u24 v72, 5, v84
    v_lshrrev_b64 v[72:73], v72, v[74:75]
    v_and_or_b32 v72, v72, s66, v85
    ds_add_rtn_u32 v87, v72, v10
    ds_wrxchg_rtn_b32 v116, v86, v13
    v_and_b32 v117, 15, v71
    v_bcnt_u32_b32 v118, v117, 0
    v_cmp_eq_u32 vcc, 1, v118

    s_nop 1

    v_cndmask_b32 v119, v71, v117, vcc
    s_waitcnt lgkmcnt(0)
    v_cmp_gt_u32 s[68:69], 2, v116
    v_cmp_gt_u32 s[70:71], 2, v87

    s_nop 0
    v_lshrrev_b64 v[76:77], v123, s[68:69]
    v_perm_b32 v121, v76, v76, v6
    v_perm_b32 v122, v76, v76, v5
    v_and_b32 v121, v121, v22
    v_and_b32 v122, v122, v21
    v_msad_u8 v120, v29, v121, 0
    v_lshlrev_b32 v120, 4, v120
    v_msad_u8 v120, v28, v122, v120

    v_and_b32 v120, v120, v119
    v_cmp_eq_u32 vcc, 0, v120
    v_ffbl_b32 v118, v120
    s_or_b64 vcc, vcc, s[70:71]
    v_cndmask_b32 v118, v118, v84, vcc
    v_lshlrev_b32 v72, v118, v10
    v_lshl_add_u32 v73, v118, 1, v31
    v_xor_b32 v71, v71, v72

    ds_read_u16 v83, v73 offset:40
k1_kernel_sdone:
    s_waitcnt lgkmcnt(0)
    v_lshl_or_b32 v78, v81, 16, v80
    v_lshl_or_b32 v79, v83, 16, v82
    buffer_store_dwordx2 v[78:79], v30, s[32:35], s62 offen sc1
    s_add_u32 s62, s62, 65536
k1_kernel_udone:
    s_setprio 0

    s_waitcnt vmcnt(0)

    s_mov_b64 exec, 1
    ds_add_rtn_u32 v12, v11, v10 offset:20
    v_mov_b32 v0, s51
    s_waitcnt lgkmcnt(0)
    v_readfirstlane_b32 s45, v12
    s_and_b32 s45, s45, 3
    s_cmp_eq_u32 s45, 3
    s_cbranch_scc0 k1_kernel_wdec
    s_mov_b64 exec, 0xff
    s_lshr_b32 s38, s51, 5
    s_lshl_b32 s39, 1, s51

    v_cmp_eq_u32 vcc, s38, v8
    v_mov_b32 v2, s39
    v_lshlrev_b32 v0, 2, v8
    v_cndmask_b32 v2, 0, v2, vcc
    v_mov_b32 v1, v2
    buffer_atomic_or v1, v0, s[52:55], 0 offen sc0
    s_lshl_b32 s45, s2, 8
    s_add_u32 s45, s45, 14680064
    s_waitcnt vmcnt(0)
    v_or_b32 v1, v1, v2
    v_cmp_ne_u32 vcc, -1, v1
    s_cbranch_vccnz k1_kernel_poll0
    s_mov_b64 exec, -1
    v_lshlrev_b32 v0, 8, v8
    s_mov_b32 s38, 14680064

    buffer_store_dword v10, v0, s[12:15], s38 offen sc1
    s_add_u32 s38, s38, 16384
    buffer_store_dword v10, v0, s[12:15], s38 offen sc1
    s_add_u32 s38, s38, 16384
    buffer_store_dword v10, v0, s[12:15], s38 offen sc1
    s_add_u32 s38, s38, 16384
    buffer_store_dword v10, v0, s[12:15], s38 offen sc1
    buffer_inv sc1
    s_waitcnt vmcnt(0)
    s_branch k1_kernel_go
k1_kernel_poll0:
    buffer_inv sc1
k1_kernel_poll:

    buffer_load_dword v1, v13, s[12:15], s45 offen sc1
    s_add_u32 s65, s65, 1
    s_waitcnt vmcnt(0)
    v_cmp_eq_u32 vcc, 1, v1
    s_cbranch_vccnz k1_kernel_go
    s_cmp_lt_u32 s65, 200
    s_cbranch_scc1 k1_kernel_poll
    buffer_load_dword v1, v0, s[52:55], 0 offen sc1
    s_waitcnt vmcnt(0)
    v_cmp_ne_u32 vcc, -1, v1
    s_cbranch_vccz k1_kernel_go
    s_ff1_i32_b64 s38, vcc
    s_nop 3
    v_readlane_b32 s39, v1, s38
    s_ff0_i32_b32 s39, s39
    s_lshl_b32 s38, s38, 5
    s_add_u32 s38, s38, s39
    s_andn2_b32 s39, s64, 255
    s_add_u32 s39, s39, 256
    s_or_b32 s38, s38, s39
    s_branch k1_kernel_dec

k1_kernel_go:

    s_mov_b32 s38, 0x80000000

k1_kernel_dec:

    v_mov_b32 v1, s38
    s_mov_b64 exec, 1
    ds_write_b32 v11, v1 offset:24

k1_kernel_wdec:

    s_mov_b64 exec, -1
    ds_read_b32 v12, v11 offset:24
    s_waitcnt lgkmcnt(0)
    v_readfirstlane_b32 s45, v12
    s_cmp_lg_u32 s45, s64
    s_cbranch_scc1 k1_kernel_gotd
    s_sleep 2
    s_branch k1_kernel_wdec

k1_kernel_gotd:

    s_mov_b32 s64, s45
    s_and_b32 s51, s45, 255
    s_mov_b32 s65, 0x10000
    s_bitcmp0_b32 s45, 31
    s_cbranch_scc1 k1_kernel_unit

k1_kernel_k2:

    s_setprio 0
    s_load_dwordx4 s[8:11], s[0:1], 32
    v_mbcnt_lo_u32_b32 v0, -1, 0
    v_mbcnt_hi_u32_b32 v0, -1, v0
    s_mul_i32 s35, s3, 18432
    v_and_b32 v1, 15, v0
    v_lshrrev_b32 v2, 4, v0
    v_mul_u32_u24 v71, 144, v1
    v_lshl_add_u32 v71, v2, 4, v71
    v_add_u32 v71, s35, v71

    ds_read_b128 v[128:131], v71 offset:0
    ds_read_b128 v[132:135], v71 offset:64
    ds_read_b128 v[144:147], v71 offset:2304
    ds_read_b128 v[148:151], v71 offset:2368
    ds_read_b128 v[160:163], v71 offset:4608
    ds_read_b128 v[164:167], v71 offset:4672
    ds_read_b128 v[176:179], v71 offset:6912
    ds_read_b128 v[180:183], v71 offset:6976
    ds_read_b128 v[192:195], v71 offset:9216
    ds_read_b128 v[196:199], v71 offset:9280
    ds_read_b128 v[208:211], v71 offset:11520
    ds_read_b128 v[212:215], v71 offset:11584
    ds_read_b128 v[224:227], v71 offset:13824
    ds_read_b128 v[228:231], v71 offset:13888
    ds_read_b128 v[240:243], v71 offset:16128
    ds_read_b128 v[244:247], v71 offset:16192

    s_lshr_b32 s33, s2, 1
    s_and_b32 s34, s2, 1
    s_mov_b32 s32, 0x8000
    v_lshlrev_b32 v69, 4, v0
    s_mul_i32 s21, s33, 102656
    s_lshl_b32 s35, s50, 11
    s_xor_b32 s19, s35, 2048
    s_add_u32 s19, s19, s21
    s_add_u32 s21, s21, s35
    s_mul_i32 s20, s34, 1638400
    s_add_u32 s20, s20, 16777216
    s_lshl_b32 s35, s3, 13
    s_add_u32 s20, s20, s35
    v_lshlrev_b32 v70, 13, v2
    v_lshl_add_u32 v70, v1, 3, v70
    s_lshl_b32 s35, s3, 10
    v_add_u32 v70, s35, v70
    v_lshrrev_b32 v4, 3, v0
    v_xor_b32 v4, v4, v2
    v_and_b32 v4, 1, v4
    v_bfe_u32 v5, v0, 2, 1
    v_lshl_or_b32 v4, v4, 1, v5
    v_mov_b32 v6, 0x3f80
    v_cmp_eq_u32 vcc, 0, v4
    s_nop 1
    v_cndmask_b32 v64, 0, v6, vcc
    v_cndmask_b32 v65, 0, v6, vcc
    v_cmp_eq_u32 vcc, 1, v4
    s_nop 1
    v_cndmask_b32 v66, 0, v6, vcc
    v_cndmask_b32 v67, 0, v6, vcc
    v_and_b32 v5, 3, v0
    v_mul_u32_u24 v68, 0x5555, v5

    s_cmp_lt_u32 s3, 4
    s_cbranch_scc1 k1_kernel_k2n
    buffer_load_dwordx4 v[0:3], v69, s[12:15], s21 offen offset:0
    buffer_load_dwordx4 v[4:7], v69, s[12:15], s21 offen offset:1024
    buffer_load_dwordx4 v[8:11], v69, s[12:15], s19 offen offset:0
    buffer_load_dwordx4 v[12:15], v69, s[12:15], s19 offen offset:1024
    s_add_u32 s21, s21, 4096
    s_add_u32 s19, s19, 4096
    buffer_load_dwordx4 v[16:19], v69, s[12:15], s21 offen offset:0
    buffer_load_dwordx4 v[20:23], v69, s[12:15], s21 offen offset:1024
    buffer_load_dwordx4 v[24:27], v69, s[12:15], s19 offen offset:0
    buffer_load_dwordx4 v[28:31], v69, s[12:15], s19 offen offset:1024
    s_add_u32 s21, s21, 4096
    s_add_u32 s19, s19, 4096
    s_mov_b32 s44, s21
    s_mov_b32 s45, s19
    s_add_u32 s21, s21, 4096
    s_add_u32 s19, s19, 4096
    buffer_load_dwordx4 v[72:75], v69, s[12:15], s21 offen offset:0
    buffer_load_dwordx4 v[76:79], v69, s[12:15], s21 offen offset:1024
    buffer_load_dwordx4 v[80:83], v69, s[12:15], s19 offen offset:0
    buffer_load_dwordx4 v[84:87], v69, s[12:15], s19 offen offset:1024
    s_add_u32 s21, s21, 4096
    s_add_u32 s19, s19, 4096
    buffer_load_dwordx4 v[116:119], v69, s[12:15], s20 offen offset:0 sc1
    buffer_load_dwordx4 v[120:123], v69, s[12:15], s20 offen offset:1024 sc1
k1_kernel_k2n:

    s_and_b32 s35, s3, 3
    s_lshl_b32 s35, s35, 14
    s_add_u32 s35, s35, 98304
    v_add_u32 v71, s35, v69
    s_lshl_b32 s35, s33, 3
    s_waitcnt lgkmcnt(0)
    s_add_u32 s8, s8, s35
    s_addc_u32 s9, s9, 0
    s_add_u32 s10, s10, s35
    s_addc_u32 s11, s11, 0
    s_barrier

    s_load_dwordx2 s[36:37], s[8:9], 0
    s_load_dwordx2 s[38:39], s[10:11], 0
    s_cmp_lt_u32 s3, 4
    s_cbranch_scc1 k1_kernel_k2m

    s_waitcnt vmcnt(10)
    ds_write_b128 v71, v[32:35] offset:0
    ds_write_b128 v71, v[36:39] offset:1024
    ds_write_b128 v71, v[40:43] offset:2048
    ds_write_b128 v71, v[44:47] offset:3072
    v_mfma_f32_16x16x32_bf16 v[32:35], v[0:3], v[128:131], 0
    v_mfma_f32_16x16x32_bf16 v[36:39], v[0:3], v[144:147], 0
    ds_write_b128 v71, v[48:51] offset:4096
    v_mfma_f32_16x16x32_bf16 v[40:43], v[0:3], v[160:163], 0
    v_mfma_f32_16x16x32_bf16 v[44:47], v[0:3], v[176:179], 0
    ds_write_b128 v71, v[52:55] offset:5120
    v_mfma_f32_16x16x32_bf16 v[32:35], v[4:7], v[132:135], v[32:35]
    v_mfma_f32_16x16x32_bf16 v[36:39], v[4:7], v[148:151], v[36:39]
    ds_write_b128 v71, v[56:59] offset:6144
    v_mfma_f32_16x16x32_bf16 v[40:43], v[4:7], v[164:167], v[40:43]
    v_mfma_f32_16x16x32_bf16 v[44:47], v[4:7], v[180:183], v[44:47]
    ds_write_b128 v71, v[60:63] offset:7168
    v_mfma_f32_16x16x32_bf16 v[32:35], v[8:11], v[136:139], v[32:35]
    v_mfma_f32_16x16x32_bf16 v[36:39], v[8:11], v[152:155], v[36:39]
    ds_write_b128 v71, v[88:91] offset:8192
    v_mfma_f32_16x16x32_bf16 v[40:43], v[8:11], v[168:171], v[40:43]
    v_mfma_f32_16x16x32_bf16 v[44:47], v[8:11], v[184:187], v[44:47]
    ds_write_b128 v71, v[92:95] offset:9216
    v_mfma_f32_16x16x32_bf16 v[32:35], v[12:15], v[140:143], v[32:35]
    v_mfma_f32_16x16x32_bf16 v[36:39], v[12:15], v[156:159], v[36:39]
    ds_write_b128 v71, v[96:99] offset:10240
    v_mfma_f32_16x16x32_bf16 v[40:43], v[12:15], v[172:175], v[40:43]
    v_mfma_f32_16x16x32_bf16 v[44:47], v[12:15], v[188:191], v[44:47]
    ds_write_b128 v71, v[100:103] offset:11264
    v_mfma_f32_16x16x32_bf16 v[48:51], v[0:3], v[192:195], 0
    v_mfma_f32_16x16x32_bf16 v[52:55], v[0:3], v[208:211], 0
    ds_write_b128 v71, v[104:107] offset:12288
    v_mfma_f32_16x16x32_bf16 v[56:59], v[0:3], v[224:227], 0
    v_mfma_f32_16x16x32_bf16 v[60:63], v[0:3], v[240:243], 0
    ds_write_b128 v71, v[108:111] offset:13312
    v_mfma_f32_16x16x32_bf16 v[48:51], v[4:7], v[196:199], v[48:51]
    v_mfma_f32_16x16x32_bf16 v[52:55], v[4:7], v[212:215], v[52:55]
    ds_write_b128 v71, v[112:115] offset:14336
    v_mfma_f32_16x16x32_bf16 v[56:59], v[4:7], v[228:231], v[56:59]
    v_mfma_f32_16x16x32_bf16 v[60:63], v[4:7], v[244:247], v[60:63]
    ds_write_b128 v71, v[124:127] offset:15360
    v_mfma_f32_16x16x32_bf16 v[48:51], v[8:11], v[200:203], v[48:51]
    v_mfma_f32_16x16x32_bf16 v[52:55], v[8:11], v[216:219], v[52:55]
    v_mfma_f32_16x16x32_bf16 v[56:59], v[8:11], v[232:235], v[56:59]
    v_mfma_f32_16x16x32_bf16 v[60:63], v[8:11], v[248:251], v[60:63]
    s_waitcnt lgkmcnt(0)
    s_barrier
    v_mfma_f32_16x16x32_bf16 v[48:51], v[12:15], v[204:207], v[48:51]
    v_mfma_f32_16x16x32_bf16 v[52:55], v[12:15], v[220:223], v[52:55]
    v_mfma_f32_16x16x32_bf16 v[56:59], v[12:15], v[236:239], v[56:59]
    v_mfma_f32_16x16x32_bf16 v[60:63], v[12:15], v[252:255], v[60:63]
    buffer_load_dwordx4 v[124:127], v69, s[12:15], s20 offen offset:2048 sc1
    buffer_load_dwordx4 v[0:3], v69, s[12:15], s44 offen offset:0
    buffer_load_dwordx4 v[4:7], v69, s[12:15], s44 offen offset:1024
    buffer_load_dwordx4 v[8:11], v69, s[12:15], s45 offen offset:0
    buffer_load_dwordx4 v[12:15], v69, s[12:15], s45 offen offset:1024
    s_waitcnt vmcnt(11)
    s_lshl_b32 s24, s36, 16
    s_and_b32 s25, s36, 0xffff0000
    s_lshl_b32 s26, s37, 16
    s_and_b32 s27, s37, 0xffff0000

    v_mfma_f32_16x16x32_bf16 v[88:91], v[16:19], v[128:131], 0
    v_mfma_f32_16x16x32_bf16 v[92:95], v[16:19], v[144:147], 0
    v_mfma_f32_16x16x32_bf16 v[88:91], v[20:23], v[132:135], v[88:91]
    v_mfma_f32_16x16x32_bf16 v[92:95], v[20:23], v[148:151], v[92:95]
    v_mfma_f32_16x16x32_bf16 v[88:91], v[24:27], v[136:139], v[88:91]
    v_cvt_pk_bf16_f32 v32, v32, v33
    v_mfma_f32_16x16x32_bf16 v[92:95], v[24:27], v[152:155], v[92:95]
    v_cvt_pk_bf16_f32 v33, v34, v35
    v_mfma_f32_16x16x32_bf16 v[88:91], v[28:31], v[140:143], v[88:91]
    ds_write_b64 v70, v[32:33] offset:0
    v_mfma_f32_16x16x32_bf16 v[92:95], v[28:31], v[156:159], v[92:95]
    v_cvt_pk_bf16_f32 v36, v36, v37
    v_mfma_f32_16x16x32_bf16 v[96:99], v[16:19], v[160:163], 0
    v_cvt_pk_bf16_f32 v37, v38, v39
    v_mfma_f32_16x16x32_bf16 v[100:103], v[16:19], v[176:179], 0
    ds_write_b64 v70, v[36:37] offset:128
    v_mfma_f32_16x16x32_bf16 v[96:99], v[20:23], v[164:167], v[96:99]
    v_cvt_pk_bf16_f32 v88, v88, v89
    v_cvt_pk_bf16_f32 v40, v40, v41
    v_mfma_f32_16x16x32_bf16 v[100:103], v[20:23], v[180:183], v[100:103]
    v_cvt_pk_bf16_f32 v89, v90, v91
    v_cvt_pk_bf16_f32 v41, v42, v43
    v_mfma_f32_16x16x32_bf16 v[96:99], v[24:27], v[168:171], v[96:99]
    ds_write_b64 v70, v[88:89] offset:32768
    ds_write_b64 v70, v[40:41] offset:256
    v_mfma_f32_16x16x32_bf16 v[100:103], v[24:27], v[184:187], v[100:103]
    v_cvt_pk_bf16_f32 v92, v92, v93
    v_cvt_pk_bf16_f32 v44, v44, v45
    v_mfma_f32_16x16x32_bf16 v[96:99], v[28:31], v[172:175], v[96:99]
    v_cvt_pk_bf16_f32 v93, v94, v95
    v_cvt_pk_bf16_f32 v45, v46, v47
    v_mfma_f32_16x16x32_bf16 v[100:103], v[28:31], v[188:191], v[100:103]
    ds_write_b64 v70, v[92:93] offset:32896
    ds_write_b64 v70, v[44:45] offset:384
    v_mfma_f32_16x16x32_bf16 v[104:107], v[16:19], v[192:195], 0
    v_cvt_pk_bf16_f32 v48, v48, v49
    v_mfma_f32_16x16x32_bf16 v[108:111], v[16:19], v[208:211], 0
    v_cvt_pk_bf16_f32 v49, v50, v51
    v_mfma_f32_16x16x32_bf16 v[104:107], v[20:23], v[196:199], v[104:107]
    v_cvt_pk_bf16_f32 v96, v96, v97
    ds_write_b64 v70, v[48:49] offset:512
    v_mfma_f32_16x16x32_bf16 v[108:111], v[20:23], v[212:215], v[108:111]
    v_cvt_pk_bf16_f32 v97, v98, v99
    v_cvt_pk_bf16_f32 v52, v52, v53
    v_mfma_f32_16x16x32_bf16 v[104:107], v[24:27], v[200:203], v[104:107]
    ds_write_b64 v70, v[96:97] offset:33024
    v_cvt_pk_bf16_f32 v53, v54, v55
    v_mfma_f32_16x16x32_bf16 v[108:111], v[24:27], v[216:219], v[108:111]
    v_cvt_pk_bf16_f32 v100, v100, v101
    ds_write_b64 v70, v[52:53] offset:640
    v_mfma_f32_16x16x32_bf16 v[104:107], v[28:31], v[204:207], v[104:107]
    v_cvt_pk_bf16_f32 v101, v102, v103
    v_cvt_pk_bf16_f32 v56, v56, v57
    v_mfma_f32_16x16x32_bf16 v[108:111], v[28:31], v[220:223], v[108:111]
    ds_write_b64 v70, v[100:101] offset:33152
    v_cvt_pk_bf16_f32 v57, v58, v59
    v_mfma_f32_16x16x32_bf16 v[88:91], v[16:19], v[224:227], 0
    ds_write_b64 v70, v[56:57] offset:768
    v_mfma_f32_16x16x32_bf16 v[92:95], v[16:19], v[240:243], 0
    v_cvt_pk_bf16_f32 v60, v60, v61
    v_mfma_f32_16x16x32_bf16 v[88:91], v[20:23], v[228:231], v[88:91]
    v_cvt_pk_bf16_f32 v104, v104, v105
    v_cvt_pk_bf16_f32 v61, v62, v63
    v_mfma_f32_16x16x32_bf16 v[92:95], v[20:23], v[244:247], v[92:95]
    v_cvt_pk_bf16_f32 v105, v106, v107
    ds_write_b64 v70, v[60:61] offset:896
    v_mfma_f32_16x16x32_bf16 v[88:91], v[24:27], v[232:235], v[88:91]
    ds_write_b64 v70, v[104:105] offset:33280
    v_mfma_f32_16x16x32_bf16 v[92:95], v[24:27], v[248:251], v[92:95]
    v_cvt_pk_bf16_f32 v108, v108, v109
    v_mfma_f32_16x16x32_bf16 v[88:91], v[28:31], v[236:239], v[88:91]
    v_cvt_pk_bf16_f32 v109, v110, v111
    v_mfma_f32_16x16x32_bf16 v[92:95], v[28:31], v[252:255], v[92:95]
    ds_write_b64 v70, v[108:109] offset:33408
    v_add_u32 v70, 0x8000, v70
    s_waitcnt vmcnt(0)
    v_mfma_f32_16x16x32_bf16 v[96:99], v[0:3], v[128:131], 0
    v_mfma_f32_16x16x32_bf16 v[100:103], v[0:3], v[144:147], 0
    v_mfma_f32_16x16x32_bf16 v[96:99], v[4:7], v[132:135], v[96:99]
    v_cvt_pk_bf16_f32 v88, v88, v89
    v_mfma_f32_16x16x32_bf16 v[100:103], v[4:7], v[148:151], v[100:103]
    v_cvt_pk_bf16_f32 v89, v90, v91
    v_mfma_f32_16x16x32_bf16 v[96:99], v[8:11], v[136:139], v[96:99]
    ds_write_b64 v70, v[88:89] offset:768
    v_mov_b32 v16, s24
    v_mov_b32 v40, s24
    v_mfma_f32_16x16x32_bf16 v[100:103], v[8:11], v[152:155], v[100:103]
    v_cvt_pk_bf16_f32 v92, v92, v93
    v_mov_b32 v17, s25
    v_mov_b32 v41, s25
    v_mfma_f32_16x16x32_bf16 v[96:99], v[12:15], v[140:143], v[96:99]
    v_cvt_pk_bf16_f32 v93, v94, v95
    v_mov_b32 v18, s26
    v_mov_b32 v42, s26
    v_mfma_f32_16x16x32_bf16 v[100:103], v[12:15], v[156:159], v[100:103]
    ds_write_b64 v70, v[92:93] offset:896
    v_mov_b32 v19, s27
    v_mov_b32 v43, s27
    v_mfma_f32_16x16x32_bf16 v[104:107], v[0:3], v[160:163], 0
    v_mov_b32 v20, s24
    v_mov_b32 v44, s24
    v_mfma_f32_16x16x32_bf16 v[108:111], v[0:3], v[176:179], 0
    v_mov_b32 v21, s25
    v_mov_b32 v45, s25
    v_mfma_f32_16x16x32_bf16 v[104:107], v[4:7], v[164:167], v[104:107]
    v_cvt_pk_bf16_f32 v96, v96, v97
    v_mov_b32 v22, s26
    v_mov_b32 v46, s26
    v_mfma_f32_16x16x32_bf16 v[108:111], v[4:7], v[180:183], v[108:111]
    v_cvt_pk_bf16_f32 v97, v98, v99
    v_mov_b32 v23, s27
    v_mov_b32 v47, s27
    v_mfma_f32_16x16x32_bf16 v[104:107], v[8:11], v[168:171], v[104:107]
    ds_write_b64 v70, v[96:97] offset:32768
    v_mov_b32 v24, s24
    v_mov_b32 v48, s24
    v_mfma_f32_16x16x32_bf16 v[108:111], v[8:11], v[184:187], v[108:111]
    v_cvt_pk_bf16_f32 v100, v100, v101
    v_mov_b32 v25, s25
    v_mov_b32 v49, s25
    v_mfma_f32_16x16x32_bf16 v[104:107], v[12:15], v[172:175], v[104:107]
    v_cvt_pk_bf16_f32 v101, v102, v103
    v_mov_b32 v26, s26
    v_mov_b32 v50, s26
    v_mfma_f32_16x16x32_bf16 v[108:111], v[12:15], v[188:191], v[108:111]
    ds_write_b64 v70, v[100:101] offset:32896
    v_mov_b32 v27, s27
    v_mov_b32 v51, s27
    v_mfma_f32_16x16x32_bf16 v[88:91], v[0:3], v[192:195], 0
    v_mov_b32 v28, s24
    v_mov_b32 v52, s24
    v_mfma_f32_16x16x32_bf16 v[92:95], v[0:3], v[208:211], 0
    v_mov_b32 v29, s25
    v_mov_b32 v53, s25
    v_mfma_f32_16x16x32_bf16 v[88:91], v[4:7], v[196:199], v[88:91]
    v_cvt_pk_bf16_f32 v104, v104, v105
    v_mov_b32 v30, s26
    v_mov_b32 v54, s26
    v_mfma_f32_16x16x32_bf16 v[92:95], v[4:7], v[212:215], v[92:95]
    v_cvt_pk_bf16_f32 v105, v106, v107
    v_mov_b32 v31, s27
    v_mov_b32 v55, s27
    v_mfma_f32_16x16x32_bf16 v[88:91], v[8:11], v[200:203], v[88:91]
    ds_write_b64 v70, v[104:105] offset:33024
    v_mov_b32 v32, s24
    v_mov_b32 v56, s24
    v_mfma_f32_16x16x32_bf16 v[92:95], v[8:11], v[216:219], v[92:95]
    v_cvt_pk_bf16_f32 v108, v108, v109
    v_mov_b32 v33, s25
    v_mov_b32 v57, s25
    v_mfma_f32_16x16x32_bf16 v[88:91], v[12:15], v[204:207], v[88:91]
    v_cvt_pk_bf16_f32 v109, v110, v111
    v_mov_b32 v34, s26
    v_mov_b32 v58, s26
    v_mfma_f32_16x16x32_bf16 v[92:95], v[12:15], v[220:223], v[92:95]
    ds_write_b64 v70, v[108:109] offset:33152
    v_mov_b32 v35, s27
    v_mov_b32 v59, s27
    v_mfma_f32_16x16x32_bf16 v[96:99], v[0:3], v[224:227], 0
    v_mov_b32 v36, s24
    v_mov_b32 v60, s24
    v_mfma_f32_16x16x32_bf16 v[100:103], v[0:3], v[240:243], 0
    v_mov_b32 v37, s25
    v_mov_b32 v61, s25
    v_mfma_f32_16x16x32_bf16 v[96:99], v[4:7], v[228:231], v[96:99]
    v_cvt_pk_bf16_f32 v88, v88, v89
    v_mov_b32 v38, s26
    v_mov_b32 v62, s26
    v_mfma_f32_16x16x32_bf16 v[100:103], v[4:7], v[244:247], v[100:103]
    v_cvt_pk_bf16_f32 v89, v90, v91
    v_mov_b32 v39, s27
    v_mov_b32 v63, s27
    v_mfma_f32_16x16x32_bf16 v[96:99], v[8:11], v[232:235], v[96:99]
    ds_write_b64 v70, v[88:89] offset:33280
    s_nop 0
    v_mfma_f32_16x16x32_bf16 v[100:103], v[8:11], v[248:251], v[100:103]
    v_cvt_pk_bf16_f32 v92, v92, v93
    s_nop 0
    v_mfma_f32_16x16x32_bf16 v[96:99], v[12:15], v[236:239], v[96:99]
    v_cvt_pk_bf16_f32 v93, v94, v95
    s_nop 0
    v_mfma_f32_16x16x32_bf16 v[100:103], v[12:15], v[252:255], v[100:103]
    ds_write_b64 v70, v[92:93] offset:33408
    s_nop 0
    v_mov_b32 v0, s24
    v_mov_b32 v1, s25
    v_mov_b32 v2, s26
    v_mov_b32 v3, s27
    v_mov_b32 v4, s24
    v_mov_b32 v5, s25
    v_mov_b32 v6, s26
    v_mov_b32 v7, s27
    v_mov_b32 v8, s24
    v_mov_b32 v9, s25
    v_mov_b32 v10, s26
    v_mov_b32 v11, s27
    v_mov_b32 v12, s24
    v_mov_b32 v13, s25
    v_mov_b32 v14, s26
    v_mov_b32 v15, s27
    s_nop 7
    v_cvt_pk_bf16_f32 v96, v96, v97
    v_cvt_pk_bf16_f32 v97, v98, v99
    ds_write_b64 v70, v[96:97] offset:33536
    v_cvt_pk_bf16_f32 v100, v100, v101
    v_cvt_pk_bf16_f32 v101, v102, v103
    ds_write_b64 v70, v[100:101] offset:33664
    v_add_u32 v70, 0x10000, v70
    s_branch k1_kernel_k2j
k1_kernel_k2m:
    buffer_load_dwordx4 v[0:3], v69, s[12:15], s21 offen offset:0
    buffer_load_dwordx4 v[4:7], v69, s[12:15], s21 offen offset:1024
    buffer_load_dwordx4 v[8:11], v69, s[12:15], s19 offen offset:0
    buffer_load_dwordx4 v[12:15], v69, s[12:15], s19 offen offset:1024
    s_add_u32 s21, s21, 4096
    s_add_u32 s19, s19, 4096
    buffer_load_dwordx4 v[16:19], v69, s[12:15], s21 offen offset:0
    buffer_load_dwordx4 v[20:23], v69, s[12:15], s21 offen offset:1024
    buffer_load_dwordx4 v[24:27], v69, s[12:15], s19 offen offset:0
    buffer_load_dwordx4 v[28:31], v69, s[12:15], s19 offen offset:1024
    s_add_u32 s21, s21, 4096
    s_add_u32 s19, s19, 4096
    s_mov_b32 s44, s21
    s_mov_b32 s45, s19
    s_add_u32 s21, s21, 4096
    s_add_u32 s19, s19, 4096
    buffer_load_dwordx4 v[72:75], v69, s[12:15], s21 offen offset:0
    buffer_load_dwordx4 v[76:79], v69, s[12:15], s21 offen offset:1024
    buffer_load_dwordx4 v[80:83], v69, s[12:15], s19 offen offset:0
    buffer_load_dwordx4 v[84:87], v69, s[12:15], s19 offen offset:1024
    s_add_u32 s21, s21, 4096
    s_add_u32 s19, s19, 4096
    buffer_load_dwordx4 v[116:119], v69, s[12:15], s20 offen offset:0 sc1
    buffer_load_dwordx4 v[120:123], v69, s[12:15], s20 offen offset:1024 sc1
    buffer_load_dwordx4 v[124:127], v69, s[12:15], s20 offen offset:2048 sc1
    buffer_load_dwordx4 v[32:35], v69, s[12:15], s44 offen offset:0
    buffer_load_dwordx4 v[36:39], v69, s[12:15], s44 offen offset:1024
    buffer_load_dwordx4 v[40:43], v69, s[12:15], s45 offen offset:0
    buffer_load_dwordx4 v[44:47], v69, s[12:15], s45 offen offset:1024
    s_waitcnt lgkmcnt(0)
    s_barrier
    ds_read_b128 v[136:139], v71 offset:0
    ds_read_b128 v[140:143], v71 offset:1024
    ds_read_b128 v[152:155], v71 offset:2048
    ds_read_b128 v[156:159], v71 offset:3072
    ds_read_b128 v[168:171], v71 offset:4096
    ds_read_b128 v[172:175], v71 offset:5120
    ds_read_b128 v[184:187], v71 offset:6144
    ds_read_b128 v[188:191], v71 offset:7168
    ds_read_b128 v[200:203], v71 offset:8192
    ds_read_b128 v[204:207], v71 offset:9216
    ds_read_b128 v[216:219], v71 offset:10240
    ds_read_b128 v[220:223], v71 offset:11264
    ds_read_b128 v[232:235], v71 offset:12288
    ds_read_b128 v[236:239], v71 offset:13312
    ds_read_b128 v[248:251], v71 offset:14336
    ds_read_b128 v[252:255], v71 offset:15360
    s_waitcnt vmcnt(15)
    v_mfma_f32_16x16x32_bf16 v[48:51], v[0:3], v[128:131], 0
    v_mfma_f32_16x16x32_bf16 v[52:55], v[0:3], v[144:147], 0
    v_mfma_f32_16x16x32_bf16 v[56:59], v[0:3], v[160:163], 0
    v_mfma_f32_16x16x32_bf16 v[60:63], v[0:3], v[176:179], 0
    v_mfma_f32_16x16x32_bf16 v[88:91], v[0:3], v[192:195], 0
    v_mfma_f32_16x16x32_bf16 v[92:95], v[0:3], v[208:211], 0
    v_mfma_f32_16x16x32_bf16 v[96:99], v[0:3], v[224:227], 0
    v_mfma_f32_16x16x32_bf16 v[100:103], v[0:3], v[240:243], 0
    v_mfma_f32_16x16x32_bf16 v[48:51], v[4:7], v[132:135], v[48:51]
    v_mfma_f32_16x16x32_bf16 v[52:55], v[4:7], v[148:151], v[52:55]
    v_mfma_f32_16x16x32_bf16 v[56:59], v[4:7], v[164:167], v[56:59]
    v_mfma_f32_16x16x32_bf16 v[60:63], v[4:7], v[180:183], v[60:63]
    v_mfma_f32_16x16x32_bf16 v[88:91], v[4:7], v[196:199], v[88:91]
    v_mfma_f32_16x16x32_bf16 v[92:95], v[4:7], v[212:215], v[92:95]
    v_mfma_f32_16x16x32_bf16 v[96:99], v[4:7], v[228:231], v[96:99]
    v_mfma_f32_16x16x32_bf16 v[100:103], v[4:7], v[244:247], v[100:103]

    s_lshl_b32 s24, s36, 16
    s_and_b32 s25, s36, 0xffff0000
    s_lshl_b32 s26, s37, 16
    s_and_b32 s27, s37, 0xffff0000

    s_waitcnt lgkmcnt(12)
    v_mfma_f32_16x16x32_bf16 v[48:51], v[8:11], v[136:139], v[48:51]
    v_mfma_f32_16x16x32_bf16 v[52:55], v[8:11], v[152:155], v[52:55]
    v_mfma_f32_16x16x32_bf16 v[48:51], v[12:15], v[140:143], v[48:51]
    v_mfma_f32_16x16x32_bf16 v[52:55], v[12:15], v[156:159], v[52:55]
    s_waitcnt lgkmcnt(8)
    v_mfma_f32_16x16x32_bf16 v[56:59], v[8:11], v[168:171], v[56:59]
    v_mfma_f32_16x16x32_bf16 v[60:63], v[8:11], v[184:187], v[60:63]
    v_mfma_f32_16x16x32_bf16 v[56:59], v[12:15], v[172:175], v[56:59]
    v_mfma_f32_16x16x32_bf16 v[60:63], v[12:15], v[188:191], v[60:63]
    s_waitcnt lgkmcnt(4)
    v_mfma_f32_16x16x32_bf16 v[88:91], v[8:11], v[200:203], v[88:91]
    v_mfma_f32_16x16x32_bf16 v[92:95], v[8:11], v[216:219], v[92:95]
    v_mfma_f32_16x16x32_bf16 v[88:91], v[12:15], v[204:207], v[88:91]
    v_mfma_f32_16x16x32_bf16 v[92:95], v[12:15], v[220:223], v[92:95]
    v_cvt_pk_bf16_f32 v48, v48, v49
    v_cvt_pk_bf16_f32 v49, v50, v51
    ds_write_b64 v70, v[48:49] offset:0
    v_cvt_pk_bf16_f32 v52, v52, v53
    v_cvt_pk_bf16_f32 v53, v54, v55
    ds_write_b64 v70, v[52:53] offset:128
    s_waitcnt lgkmcnt(2)
    v_mfma_f32_16x16x32_bf16 v[96:99], v[8:11], v[232:235], v[96:99]
    v_mfma_f32_16x16x32_bf16 v[100:103], v[8:11], v[248:251], v[100:103]
    v_mfma_f32_16x16x32_bf16 v[96:99], v[12:15], v[236:239], v[96:99]
    v_mfma_f32_16x16x32_bf16 v[100:103], v[12:15], v[252:255], v[100:103]
    v_cvt_pk_bf16_f32 v56, v56, v57
    v_cvt_pk_bf16_f32 v57, v58, v59
    ds_write_b64 v70, v[56:57] offset:256
    v_cvt_pk_bf16_f32 v60, v60, v61
    v_cvt_pk_bf16_f32 v61, v62, v63
    ds_write_b64 v70, v[60:61] offset:384
    s_nop 3
    v_cvt_pk_bf16_f32 v88, v88, v89
    v_cvt_pk_bf16_f32 v89, v90, v91
    ds_write_b64 v70, v[88:89] offset:512
    v_cvt_pk_bf16_f32 v92, v92, v93
    v_cvt_pk_bf16_f32 v93, v94, v95
    ds_write_b64 v70, v[92:93] offset:640
    s_nop 3
    v_cvt_pk_bf16_f32 v96, v96, v97
    v_cvt_pk_bf16_f32 v97, v98, v99
    ds_write_b64 v70, v[96:97] offset:768
    v_cvt_pk_bf16_f32 v100, v100, v101
    v_cvt_pk_bf16_f32 v101, v102, v103
    ds_write_b64 v70, v[100:101] offset:896
    v_add_u32 v70, 0x8000, v70
    s_waitcnt vmcnt(11)
    v_mfma_f32_16x16x32_bf16 v[104:107], v[16:19], v[128:131], 0
    v_mfma_f32_16x16x32_bf16 v[108:111], v[16:19], v[144:147], 0
    v_mfma_f32_16x16x32_bf16 v[104:107], v[20:23], v[132:135], v[104:107]
    v_mfma_f32_16x16x32_bf16 v[108:111], v[20:23], v[148:151], v[108:111]
    v_mfma_f32_16x16x32_bf16 v[104:107], v[24:27], v[136:139], v[104:107]
    v_mov_b32 v48, s24
    v_mfma_f32_16x16x32_bf16 v[108:111], v[24:27], v[152:155], v[108:111]
    v_mov_b32 v49, s25
    v_mfma_f32_16x16x32_bf16 v[104:107], v[28:31], v[140:143], v[104:107]
    v_mov_b32 v50, s26
    v_mfma_f32_16x16x32_bf16 v[108:111], v[28:31], v[156:159], v[108:111]
    v_mov_b32 v51, s27
    v_mfma_f32_16x16x32_bf16 v[88:91], v[16:19], v[160:163], 0
    v_mov_b32 v52, s24
    v_mfma_f32_16x16x32_bf16 v[92:95], v[16:19], v[176:179], 0
    v_mov_b32 v53, s25
    v_mfma_f32_16x16x32_bf16 v[88:91], v[20:23], v[164:167], v[88:91]
    v_cvt_pk_bf16_f32 v104, v104, v105
    v_mov_b32 v54, s26
    v_mfma_f32_16x16x32_bf16 v[92:95], v[20:23], v[180:183], v[92:95]
    v_cvt_pk_bf16_f32 v105, v106, v107
    v_mov_b32 v55, s27
    v_mfma_f32_16x16x32_bf16 v[88:91], v[24:27], v[168:171], v[88:91]
    ds_write_b64 v70, v[104:105] offset:0
    v_mov_b32 v56, s24
    v_mfma_f32_16x16x32_bf16 v[92:95], v[24:27], v[184:187], v[92:95]
    v_cvt_pk_bf16_f32 v108, v108, v109
    v_mov_b32 v57, s25
    v_mfma_f32_16x16x32_bf16 v[88:91], v[28:31], v[172:175], v[88:91]
    v_cvt_pk_bf16_f32 v109, v110, v111
    v_mov_b32 v58, s26
    v_mfma_f32_16x16x32_bf16 v[92:95], v[28:31], v[188:191], v[92:95]
    ds_write_b64 v70, v[108:109] offset:128
    v_mov_b32 v59, s27
    v_mfma_f32_16x16x32_bf16 v[96:99], v[16:19], v[192:195], 0
    v_mov_b32 v60, s24
    v_mfma_f32_16x16x32_bf16 v[100:103], v[16:19], v[208:211], 0
    v_mov_b32 v61, s25
    v_mfma_f32_16x16x32_bf16 v[96:99], v[20:23], v[196:199], v[96:99]
    v_cvt_pk_bf16_f32 v88, v88, v89
    v_mov_b32 v62, s26
    v_mfma_f32_16x16x32_bf16 v[100:103], v[20:23], v[212:215], v[100:103]
    v_cvt_pk_bf16_f32 v89, v90, v91
    v_mov_b32 v63, s27
    v_mfma_f32_16x16x32_bf16 v[96:99], v[24:27], v[200:203], v[96:99]
    ds_write_b64 v70, v[88:89] offset:256
    v_mov_b32 v0, s24
    v_mfma_f32_16x16x32_bf16 v[100:103], v[24:27], v[216:219], v[100:103]
    v_cvt_pk_bf16_f32 v92, v92, v93
    v_mov_b32 v1, s25
    v_mfma_f32_16x16x32_bf16 v[96:99], v[28:31], v[204:207], v[96:99]
    v_cvt_pk_bf16_f32 v93, v94, v95
    v_mov_b32 v2, s26
    v_mfma_f32_16x16x32_bf16 v[100:103], v[28:31], v[220:223], v[100:103]
    ds_write_b64 v70, v[92:93] offset:384
    v_mov_b32 v3, s27
    v_mfma_f32_16x16x32_bf16 v[104:107], v[16:19], v[224:227], 0
    v_mov_b32 v4, s24
    v_mfma_f32_16x16x32_bf16 v[108:111], v[16:19], v[240:243], 0
    v_mov_b32 v5, s25
    v_mfma_f32_16x16x32_bf16 v[104:107], v[20:23], v[228:231], v[104:107]
    v_cvt_pk_bf16_f32 v96, v96, v97
    v_mov_b32 v6, s26
    v_mfma_f32_16x16x32_bf16 v[108:111], v[20:23], v[244:247], v[108:111]
    v_cvt_pk_bf16_f32 v97, v98, v99
    v_mov_b32 v7, s27
    v_mfma_f32_16x16x32_bf16 v[104:107], v[24:27], v[232:235], v[104:107]
    ds_write_b64 v70, v[96:97] offset:512
    v_mov_b32 v8, s24
    v_mfma_f32_16x16x32_bf16 v[108:111], v[24:27], v[248:251], v[108:111]
    v_cvt_pk_bf16_f32 v100, v100, v101
    v_mov_b32 v9, s25
    v_mfma_f32_16x16x32_bf16 v[104:107], v[28:31], v[236:239], v[104:107]
    v_cvt_pk_bf16_f32 v101, v102, v103
    v_mov_b32 v10, s26
    v_mfma_f32_16x16x32_bf16 v[108:111], v[28:31], v[252:255], v[108:111]
    ds_write_b64 v70, v[100:101] offset:640
    v_mov_b32 v11, s27
    s_waitcnt vmcnt(0)
    v_mfma_f32_16x16x32_bf16 v[88:91], v[32:35], v[128:131], 0
    v_mfma_f32_16x16x32_bf16 v[92:95], v[32:35], v[144:147], 0
    v_mfma_f32_16x16x32_bf16 v[88:91], v[36:39], v[132:135], v[88:91]
    v_cvt_pk_bf16_f32 v104, v104, v105
    v_mfma_f32_16x16x32_bf16 v[92:95], v[36:39], v[148:151], v[92:95]
    v_cvt_pk_bf16_f32 v105, v106, v107
    v_mfma_f32_16x16x32_bf16 v[88:91], v[40:43], v[136:139], v[88:91]
    ds_write_b64 v70, v[104:105] offset:768
    v_mov_b32 v12, s24
    v_mfma_f32_16x16x32_bf16 v[92:95], v[40:43], v[152:155], v[92:95]
    v_cvt_pk_bf16_f32 v108, v108, v109
    v_mov_b32 v13, s25
    v_mfma_f32_16x16x32_bf16 v[88:91], v[44:47], v[140:143], v[88:91]
    v_cvt_pk_bf16_f32 v109, v110, v111
    v_mov_b32 v14, s26
    v_mfma_f32_16x16x32_bf16 v[92:95], v[44:47], v[156:159], v[92:95]
    ds_write_b64 v70, v[108:109] offset:896
    v_mov_b32 v15, s27
    v_mfma_f32_16x16x32_bf16 v[96:99], v[32:35], v[160:163], 0
    v_mov_b32 v16, s24
    v_mfma_f32_16x16x32_bf16 v[100:103], v[32:35], v[176:179], 0
    v_mov_b32 v17, s25
    v_mfma_f32_16x16x32_bf16 v[96:99], v[36:39], v[164:167], v[96:99]
    v_cvt_pk_bf16_f32 v88, v88, v89
    v_mov_b32 v18, s26
    v_mfma_f32_16x16x32_bf16 v[100:103], v[36:39], v[180:183], v[100:103]
    v_cvt_pk_bf16_f32 v89, v90, v91
    v_mov_b32 v19, s27
    v_mfma_f32_16x16x32_bf16 v[96:99], v[40:43], v[168:171], v[96:99]
    ds_write_b64 v70, v[88:89] offset:32768
    v_mov_b32 v20, s24
    v_mfma_f32_16x16x32_bf16 v[100:103], v[40:43], v[184:187], v[100:103]
    v_cvt_pk_bf16_f32 v92, v92, v93
    v_mov_b32 v21, s25
    v_mfma_f32_16x16x32_bf16 v[96:99], v[44:47], v[172:175], v[96:99]
    v_cvt_pk_bf16_f32 v93, v94, v95
    v_mov_b32 v22, s26
    v_mfma_f32_16x16x32_bf16 v[100:103], v[44:47], v[188:191], v[100:103]
    ds_write_b64 v70, v[92:93] offset:32896
    v_mov_b32 v23, s27
    v_mfma_f32_16x16x32_bf16 v[104:107], v[32:35], v[192:195], 0
    v_mov_b32 v24, s24
    v_mfma_f32_16x16x32_bf16 v[108:111], v[32:35], v[208:211], 0
    v_mov_b32 v25, s25
    v_mfma_f32_16x16x32_bf16 v[104:107], v[36:39], v[196:199], v[104:107]
    v_cvt_pk_bf16_f32 v96, v96, v97
    v_mov_b32 v26, s26
    v_mfma_f32_16x16x32_bf16 v[108:111], v[36:39], v[212:215], v[108:111]
    v_cvt_pk_bf16_f32 v97, v98, v99
    v_mov_b32 v27, s27
    v_mfma_f32_16x16x32_bf16 v[104:107], v[40:43], v[200:203], v[104:107]
    ds_write_b64 v70, v[96:97] offset:33024
    v_mov_b32 v28, s24
    v_mfma_f32_16x16x32_bf16 v[108:111], v[40:43], v[216:219], v[108:111]
    v_cvt_pk_bf16_f32 v100, v100, v101
    v_mov_b32 v29, s25
    v_mfma_f32_16x16x32_bf16 v[104:107], v[44:47], v[204:207], v[104:107]
    v_cvt_pk_bf16_f32 v101, v102, v103
    v_mov_b32 v30, s26
    v_mfma_f32_16x16x32_bf16 v[108:111], v[44:47], v[220:223], v[108:111]
    ds_write_b64 v70, v[100:101] offset:33152
    v_mov_b32 v31, s27
    v_mfma_f32_16x16x32_bf16 v[88:91], v[32:35], v[224:227], 0
    s_nop 0
    v_mfma_f32_16x16x32_bf16 v[92:95], v[32:35], v[240:243], 0
    s_nop 0
    v_mfma_f32_16x16x32_bf16 v[88:91], v[36:39], v[228:231], v[88:91]
    v_cvt_pk_bf16_f32 v104, v104, v105
    s_nop 0
    v_mfma_f32_16x16x32_bf16 v[92:95], v[36:39], v[244:247], v[92:95]
    v_cvt_pk_bf16_f32 v105, v106, v107
    s_nop 0
    v_mfma_f32_16x16x32_bf16 v[88:91], v[40:43], v[232:235], v[88:91]
    ds_write_b64 v70, v[104:105] offset:33280
    s_nop 0
    v_mfma_f32_16x16x32_bf16 v[92:95], v[40:43], v[248:251], v[92:95]
    v_cvt_pk_bf16_f32 v108, v108, v109
    s_nop 0
    v_mfma_f32_16x16x32_bf16 v[88:91], v[44:47], v[236:239], v[88:91]
    v_cvt_pk_bf16_f32 v109, v110, v111
    s_nop 0
    v_mfma_f32_16x16x32_bf16 v[92:95], v[44:47], v[252:255], v[92:95]
    ds_write_b64 v70, v[108:109] offset:33408
    s_nop 0
    v_mov_b32 v32, s24
    v_mov_b32 v33, s25
    v_mov_b32 v34, s26
    v_mov_b32 v35, s27
    v_mov_b32 v36, s24
    v_mov_b32 v37, s25
    v_mov_b32 v38, s26
    v_mov_b32 v39, s27
    v_mov_b32 v40, s24
    v_mov_b32 v41, s25
    v_mov_b32 v42, s26
    v_mov_b32 v43, s27
    v_mov_b32 v44, s24
    v_mov_b32 v45, s25
    v_mov_b32 v46, s26
    v_mov_b32 v47, s27
    s_nop 7
    v_cvt_pk_bf16_f32 v88, v88, v89
    v_cvt_pk_bf16_f32 v89, v90, v91
    ds_write_b64 v70, v[88:89] offset:33536
    v_cvt_pk_bf16_f32 v92, v92, v93
    v_cvt_pk_bf16_f32 v93, v94, v95
    ds_write_b64 v70, v[92:93] offset:33664
    v_add_u32 v70, 0x10000, v70
k1_kernel_k2j:

    s_mov_b32 s22, 0
    s_mov_b32 s23, 3
    s_waitcnt lgkmcnt(0)
    s_barrier

    v_lshlrev_b32_sdwa v88, 3, v116 dst_sel:DWORD dst_unused:UNUSED_PAD src0_sel:DWORD src1_sel:WORD_0
    v_lshlrev_b32_sdwa v90, 3, v116 dst_sel:DWORD dst_unused:UNUSED_PAD src0_sel:DWORD src1_sel:WORD_1
    v_lshlrev_b32_sdwa v92, 3, v117 dst_sel:DWORD dst_unused:UNUSED_PAD src0_sel:DWORD src1_sel:WORD_0
    v_lshlrev_b32_sdwa v94, 3, v117 dst_sel:DWORD dst_unused:UNUSED_PAD src0_sel:DWORD src1_sel:WORD_1
    ds_read_b64 v[88:89], v88
    ds_read_b64 v[90:91], v90
    ds_read_b64 v[92:93], v92
    ds_read_b64 v[94:95], v94
    v_lshlrev_b32_sdwa v96, 3, v118 dst_sel:DWORD dst_unused:UNUSED_PAD src0_sel:DWORD src1_sel:WORD_0
    v_lshlrev_b32_sdwa v98, 3, v118 dst_sel:DWORD dst_unused:UNUSED_PAD src0_sel:DWORD src1_sel:WORD_1
    v_lshlrev_b32_sdwa v100, 3, v119 dst_sel:DWORD dst_unused:UNUSED_PAD src0_sel:DWORD src1_sel:WORD_0
    v_lshlrev_b32_sdwa v102, 3, v119 dst_sel:DWORD dst_unused:UNUSED_PAD src0_sel:DWORD src1_sel:WORD_1
    ds_read_b64 v[96:97], v96
    ds_read_b64 v[98:99], v98
    ds_read_b64 v[100:101], v100
    ds_read_b64 v[102:103], v102
    buffer_load_dwordx4 v[116:119], v69, s[12:15], s20 offen offset:3072 sc1
    s_add_u32 s20, s20, 4096
k1_kernel_gloop:
    s_setprio 3
    s_waitcnt vmcnt(6)
    v_lshlrev_b32_sdwa v104, 3, v120 dst_sel:DWORD dst_unused:UNUSED_PAD src0_sel:DWORD src1_sel:WORD_0
    v_lshlrev_b32_sdwa v106, 3, v120 dst_sel:DWORD dst_unused:UNUSED_PAD src0_sel:DWORD src1_sel:WORD_1
    ds_read_b64 v[104:105], v104
    ds_read_b64 v[106:107], v106
    v_lshlrev_b32_sdwa v108, 3, v121 dst_sel:DWORD dst_unused:UNUSED_PAD src0_sel:DWORD src1_sel:WORD_0
    v_lshlrev_b32_sdwa v110, 3, v121 dst_sel:DWORD dst_unused:UNUSED_PAD src0_sel:DWORD src1_sel:WORD_1
    ds_read_b64 v[108:109], v108
    ds_read_b64 v[110:111], v110
    s_waitcnt lgkmcnt(8)
    v_smfmac_f32_16x16x64_bf16 v[0:3], v[64:67], v[88:95], v68
    s_waitcnt vmcnt(5)
    v_mfma_f32_16x16x32_bf16 v[112:115], v[72:75], v[128:131], 0
    v_lshlrev_b32_sdwa v88, 3, v122 dst_sel:DWORD dst_unused:UNUSED_PAD src0_sel:DWORD src1_sel:WORD_0
    v_lshlrev_b32_sdwa v90, 3, v122 dst_sel:DWORD dst_unused:UNUSED_PAD src0_sel:DWORD src1_sel:WORD_1
    ds_read_b64 v[88:89], v88
    ds_read_b64 v[90:91], v90
    s_waitcnt vmcnt(4)
    v_mfma_f32_16x16x32_bf16 v[112:115], v[76:79], v[132:135], v[112:115]
    v_lshlrev_b32_sdwa v92, 3, v123 dst_sel:DWORD dst_unused:UNUSED_PAD src0_sel:DWORD src1_sel:WORD_0
    v_lshlrev_b32_sdwa v94, 3, v123 dst_sel:DWORD dst_unused:UNUSED_PAD src0_sel:DWORD src1_sel:WORD_1
    ds_read_b64 v[92:93], v92
    ds_read_b64 v[94:95], v94
    buffer_load_dwordx4 v[120:123], v69, s[12:15], s20 offen offset:0 sc1
    s_waitcnt lgkmcnt(8)
    v_smfmac_f32_16x16x64_bf16 v[4:7], v[64:67], v[96:103], v68
    s_waitcnt vmcnt(4)
    v_mfma_f32_16x16x32_bf16 v[112:115], v[80:83], v[136:139], v[112:115]
    s_waitcnt vmcnt(2)
    v_lshlrev_b32_sdwa v96, 3, v124 dst_sel:DWORD dst_unused:UNUSED_PAD src0_sel:DWORD src1_sel:WORD_0
    v_lshlrev_b32_sdwa v98, 3, v124 dst_sel:DWORD dst_unused:UNUSED_PAD src0_sel:DWORD src1_sel:WORD_1
    ds_read_b64 v[96:97], v96
    ds_read_b64 v[98:99], v98
    s_waitcnt vmcnt(3)
    v_mfma_f32_16x16x32_bf16 v[112:115], v[84:87], v[140:143], v[112:115]
    v_lshlrev_b32_sdwa v100, 3, v125 dst_sel:DWORD dst_unused:UNUSED_PAD src0_sel:DWORD src1_sel:WORD_0
    v_lshlrev_b32_sdwa v102, 3, v125 dst_sel:DWORD dst_unused:UNUSED_PAD src0_sel:DWORD src1_sel:WORD_1
    ds_read_b64 v[100:101], v100
    ds_read_b64 v[102:103], v102
    s_waitcnt lgkmcnt(8)
    v_smfmac_f32_16x16x64_bf16 v[8:11], v[64:67], v[104:111], v68
    s_nop 1
    v_cvt_pk_bf16_f32 v112, v112, v113
    v_cvt_pk_bf16_f32 v113, v114, v115
    ds_write_b64 v70, v[112:113] offset:0
    v_mfma_f32_16x16x32_bf16 v[112:115], v[72:75], v[144:147], 0
    v_mfma_f32_16x16x32_bf16 v[112:115], v[76:79], v[148:151], v[112:115]
    v_lshlrev_b32_sdwa v104, 3, v126 dst_sel:DWORD dst_unused:UNUSED_PAD src0_sel:DWORD src1_sel:WORD_0
    v_lshlrev_b32_sdwa v106, 3, v126 dst_sel:DWORD dst_unused:UNUSED_PAD src0_sel:DWORD src1_sel:WORD_1
    ds_read_b64 v[104:105], v104
    ds_read_b64 v[106:107], v106
    v_mfma_f32_16x16x32_bf16 v[112:115], v[80:83], v[152:155], v[112:115]
    v_mfma_f32_16x16x32_bf16 v[112:115], v[84:87], v[156:159], v[112:115]
    v_lshlrev_b32_sdwa v108, 3, v127 dst_sel:DWORD dst_unused:UNUSED_PAD src0_sel:DWORD src1_sel:WORD_0
    v_lshlrev_b32_sdwa v110, 3, v127 dst_sel:DWORD dst_unused:UNUSED_PAD src0_sel:DWORD src1_sel:WORD_1
    ds_read_b64 v[108:109], v108
    ds_read_b64 v[110:111], v110
    buffer_load_dwordx4 v[124:127], v69, s[12:15], s20 offen offset:1024 sc1
    s_waitcnt lgkmcnt(9)
    v_smfmac_f32_16x16x64_bf16 v[12:15], v[64:67], v[88:95], v68
    s_nop 0
    v_cvt_pk_bf16_f32 v112, v112, v113
    v_cvt_pk_bf16_f32 v113, v114, v115
    ds_write_b64 v70, v[112:113] offset:128
    v_mfma_f32_16x16x32_bf16 v[112:115], v[72:75], v[160:163], 0
    s_waitcnt vmcnt(2)
    v_lshlrev_b32_sdwa v88, 3, v116 dst_sel:DWORD dst_unused:UNUSED_PAD src0_sel:DWORD src1_sel:WORD_0
    v_lshlrev_b32_sdwa v90, 3, v116 dst_sel:DWORD dst_unused:UNUSED_PAD src0_sel:DWORD src1_sel:WORD_1
    ds_read_b64 v[88:89], v88
    ds_read_b64 v[90:91], v90
    v_mfma_f32_16x16x32_bf16 v[112:115], v[76:79], v[164:167], v[112:115]
    v_lshlrev_b32_sdwa v92, 3, v117 dst_sel:DWORD dst_unused:UNUSED_PAD src0_sel:DWORD src1_sel:WORD_0
    v_lshlrev_b32_sdwa v94, 3, v117 dst_sel:DWORD dst_unused:UNUSED_PAD src0_sel:DWORD src1_sel:WORD_1
    ds_read_b64 v[92:93], v92
    ds_read_b64 v[94:95], v94
    s_waitcnt lgkmcnt(10)
    v_smfmac_f32_16x16x64_bf16 v[16:19], v[64:67], v[96:103], v68
    v_mfma_f32_16x16x32_bf16 v[112:115], v[80:83], v[168:171], v[112:115]
    v_lshlrev_b32_sdwa v96, 3, v118 dst_sel:DWORD dst_unused:UNUSED_PAD src0_sel:DWORD src1_sel:WORD_0
    v_lshlrev_b32_sdwa v98, 3, v118 dst_sel:DWORD dst_unused:UNUSED_PAD src0_sel:DWORD src1_sel:WORD_1
    ds_read_b64 v[96:97], v96
    ds_read_b64 v[98:99], v98
    v_mfma_f32_16x16x32_bf16 v[112:115], v[84:87], v[172:175], v[112:115]
    v_lshlrev_b32_sdwa v100, 3, v119 dst_sel:DWORD dst_unused:UNUSED_PAD src0_sel:DWORD src1_sel:WORD_0
    v_lshlrev_b32_sdwa v102, 3, v119 dst_sel:DWORD dst_unused:UNUSED_PAD src0_sel:DWORD src1_sel:WORD_1
    ds_read_b64 v[100:101], v100
    ds_read_b64 v[102:103], v102
    buffer_load_dwordx4 v[116:119], v69, s[12:15], s20 offen offset:2048 sc1
    s_waitcnt lgkmcnt(9)
    v_smfmac_f32_16x16x64_bf16 v[20:23], v[64:67], v[104:111], v68
    s_nop 0
    v_cvt_pk_bf16_f32 v112, v112, v113
    v_cvt_pk_bf16_f32 v113, v114, v115
    ds_write_b64 v70, v[112:113] offset:256
    v_mfma_f32_16x16x32_bf16 v[112:115], v[72:75], v[176:179], 0
    v_mfma_f32_16x16x32_bf16 v[112:115], v[76:79], v[180:183], v[112:115]
    s_waitcnt vmcnt(2)
    v_lshlrev_b32_sdwa v104, 3, v120 dst_sel:DWORD dst_unused:UNUSED_PAD src0_sel:DWORD src1_sel:WORD_0
    v_lshlrev_b32_sdwa v106, 3, v120 dst_sel:DWORD dst_unused:UNUSED_PAD src0_sel:DWORD src1_sel:WORD_1
    ds_read_b64 v[104:105], v104
    ds_read_b64 v[106:107], v106
    v_mfma_f32_16x16x32_bf16 v[112:115], v[80:83], v[184:187], v[112:115]
    v_mfma_f32_16x16x32_bf16 v[112:115], v[84:87], v[188:191], v[112:115]
    v_lshlrev_b32_sdwa v108, 3, v121 dst_sel:DWORD dst_unused:UNUSED_PAD src0_sel:DWORD src1_sel:WORD_0
    v_lshlrev_b32_sdwa v110, 3, v121 dst_sel:DWORD dst_unused:UNUSED_PAD src0_sel:DWORD src1_sel:WORD_1
    ds_read_b64 v[108:109], v108
    ds_read_b64 v[110:111], v110
    s_waitcnt lgkmcnt(9)
    v_smfmac_f32_16x16x64_bf16 v[24:27], v[64:67], v[88:95], v68
    s_nop 1
    v_cvt_pk_bf16_f32 v112, v112, v113
    v_cvt_pk_bf16_f32 v113, v114, v115
    ds_write_b64 v70, v[112:113] offset:384
    v_mfma_f32_16x16x32_bf16 v[112:115], v[72:75], v[192:195], 0
    v_lshlrev_b32_sdwa v88, 3, v122 dst_sel:DWORD dst_unused:UNUSED_PAD src0_sel:DWORD src1_sel:WORD_0
    v_lshlrev_b32_sdwa v90, 3, v122 dst_sel:DWORD dst_unused:UNUSED_PAD src0_sel:DWORD src1_sel:WORD_1
    ds_read_b64 v[88:89], v88
    ds_read_b64 v[90:91], v90
    v_mfma_f32_16x16x32_bf16 v[112:115], v[76:79], v[196:199], v[112:115]
    v_lshlrev_b32_sdwa v92, 3, v123 dst_sel:DWORD dst_unused:UNUSED_PAD src0_sel:DWORD src1_sel:WORD_0
    v_lshlrev_b32_sdwa v94, 3, v123 dst_sel:DWORD dst_unused:UNUSED_PAD src0_sel:DWORD src1_sel:WORD_1
    ds_read_b64 v[92:93], v92
    ds_read_b64 v[94:95], v94
    buffer_load_dwordx4 v[120:123], v69, s[12:15], s20 offen offset:3072 sc1
    s_add_u32 s20, s20, 61440
    s_waitcnt lgkmcnt(10)
    v_smfmac_f32_16x16x64_bf16 v[28:31], v[64:67], v[96:103], v68
    s_setprio 2
    v_mfma_f32_16x16x32_bf16 v[112:115], v[80:83], v[200:203], v[112:115]
    s_waitcnt vmcnt(2)
    v_lshlrev_b32_sdwa v96, 3, v124 dst_sel:DWORD dst_unused:UNUSED_PAD src0_sel:DWORD src1_sel:WORD_0
    v_lshlrev_b32_sdwa v98, 3, v124 dst_sel:DWORD dst_unused:UNUSED_PAD src0_sel:DWORD src1_sel:WORD_1
    ds_read_b64 v[96:97], v96
    ds_read_b64 v[98:99], v98
    v_mfma_f32_16x16x32_bf16 v[112:115], v[84:87], v[204:207], v[112:115]
    v_lshlrev_b32_sdwa v100, 3, v125 dst_sel:DWORD dst_unused:UNUSED_PAD src0_sel:DWORD src1_sel:WORD_0
    v_lshlrev_b32_sdwa v102, 3, v125 dst_sel:DWORD dst_unused:UNUSED_PAD src0_sel:DWORD src1_sel:WORD_1
    ds_read_b64 v[100:101], v100
    ds_read_b64 v[102:103], v102
    s_waitcnt lgkmcnt(9)
    v_smfmac_f32_16x16x64_bf16 v[32:35], v[64:67], v[104:111], v68
    s_nop 1
    v_cvt_pk_bf16_f32 v112, v112, v113
    v_cvt_pk_bf16_f32 v113, v114, v115
    ds_write_b64 v70, v[112:113] offset:512
    v_mfma_f32_16x16x32_bf16 v[112:115], v[72:75], v[208:211], 0
    v_lshlrev_b32_sdwa v104, 3, v126 dst_sel:DWORD dst_unused:UNUSED_PAD src0_sel:DWORD src1_sel:WORD_0
    v_lshlrev_b32_sdwa v106, 3, v126 dst_sel:DWORD dst_unused:UNUSED_PAD src0_sel:DWORD src1_sel:WORD_1
    ds_read_b64 v[104:105], v104
    ds_read_b64 v[106:107], v106
    v_mfma_f32_16x16x32_bf16 v[112:115], v[76:79], v[212:215], v[112:115]
    v_lshlrev_b32_sdwa v108, 3, v127 dst_sel:DWORD dst_unused:UNUSED_PAD src0_sel:DWORD src1_sel:WORD_0
    v_lshlrev_b32_sdwa v110, 3, v127 dst_sel:DWORD dst_unused:UNUSED_PAD src0_sel:DWORD src1_sel:WORD_1
    ds_read_b64 v[108:109], v108
    ds_read_b64 v[110:111], v110
    buffer_load_dwordx4 v[124:127], v69, s[12:15], s20 offen offset:0 sc1
    s_waitcnt lgkmcnt(9)
    v_smfmac_f32_16x16x64_bf16 v[36:39], v[64:67], v[88:95], v68
    v_mfma_f32_16x16x32_bf16 v[112:115], v[80:83], v[216:219], v[112:115]
    s_waitcnt vmcnt(2)
    v_lshlrev_b32_sdwa v88, 3, v116 dst_sel:DWORD dst_unused:UNUSED_PAD src0_sel:DWORD src1_sel:WORD_0
    v_lshlrev_b32_sdwa v90, 3, v116 dst_sel:DWORD dst_unused:UNUSED_PAD src0_sel:DWORD src1_sel:WORD_1
    ds_read_b64 v[88:89], v88
    ds_read_b64 v[90:91], v90
    v_mfma_f32_16x16x32_bf16 v[112:115], v[84:87], v[220:223], v[112:115]
    v_lshlrev_b32_sdwa v92, 3, v117 dst_sel:DWORD dst_unused:UNUSED_PAD src0_sel:DWORD src1_sel:WORD_0
    v_lshlrev_b32_sdwa v94, 3, v117 dst_sel:DWORD dst_unused:UNUSED_PAD src0_sel:DWORD src1_sel:WORD_1
    ds_read_b64 v[92:93], v92
    ds_read_b64 v[94:95], v94
    s_waitcnt lgkmcnt(9)
    v_smfmac_f32_16x16x64_bf16 v[40:43], v[64:67], v[96:103], v68
    s_nop 1
    v_cvt_pk_bf16_f32 v112, v112, v113
    v_cvt_pk_bf16_f32 v113, v114, v115
    ds_write_b64 v70, v[112:113] offset:640
    v_mfma_f32_16x16x32_bf16 v[112:115], v[72:75], v[224:227], 0
    v_mfma_f32_16x16x32_bf16 v[112:115], v[76:79], v[228:231], v[112:115]
    v_lshlrev_b32_sdwa v96, 3, v118 dst_sel:DWORD dst_unused:UNUSED_PAD src0_sel:DWORD src1_sel:WORD_0
    v_lshlrev_b32_sdwa v98, 3, v118 dst_sel:DWORD dst_unused:UNUSED_PAD src0_sel:DWORD src1_sel:WORD_1
    ds_read_b64 v[96:97], v96
    ds_read_b64 v[98:99], v98
    v_mfma_f32_16x16x32_bf16 v[112:115], v[80:83], v[232:235], v[112:115]
    v_mfma_f32_16x16x32_bf16 v[112:115], v[84:87], v[236:239], v[112:115]
    v_lshlrev_b32_sdwa v100, 3, v119 dst_sel:DWORD dst_unused:UNUSED_PAD src0_sel:DWORD src1_sel:WORD_0
    v_lshlrev_b32_sdwa v102, 3, v119 dst_sel:DWORD dst_unused:UNUSED_PAD src0_sel:DWORD src1_sel:WORD_1
    ds_read_b64 v[100:101], v100
    ds_read_b64 v[102:103], v102
    buffer_load_dwordx4 v[116:119], v69, s[12:15], s20 offen offset:1024 sc1
    s_waitcnt lgkmcnt(9)
    v_smfmac_f32_16x16x64_bf16 v[44:47], v[64:67], v[104:111], v68
    s_nop 0
    v_cvt_pk_bf16_f32 v112, v112, v113
    v_cvt_pk_bf16_f32 v113, v114, v115
    ds_write_b64 v70, v[112:113] offset:768
    s_setprio 1
    v_mfma_f32_16x16x32_bf16 v[112:115], v[72:75], v[240:243], 0
    buffer_load_dwordx4 v[72:75], v69, s[12:15], s21 offen offset:0
    s_waitcnt vmcnt(3)
    v_lshlrev_b32_sdwa v104, 3, v120 dst_sel:DWORD dst_unused:UNUSED_PAD src0_sel:DWORD src1_sel:WORD_0
    v_lshlrev_b32_sdwa v106, 3, v120 dst_sel:DWORD dst_unused:UNUSED_PAD src0_sel:DWORD src1_sel:WORD_1
    ds_read_b64 v[104:105], v104
    ds_read_b64 v[106:107], v106
    v_mfma_f32_16x16x32_bf16 v[112:115], v[76:79], v[244:247], v[112:115]
    buffer_load_dwordx4 v[76:79], v69, s[12:15], s21 offen offset:1024
    v_lshlrev_b32_sdwa v108, 3, v121 dst_sel:DWORD dst_unused:UNUSED_PAD src0_sel:DWORD src1_sel:WORD_0
    v_lshlrev_b32_sdwa v110, 3, v121 dst_sel:DWORD dst_unused:UNUSED_PAD src0_sel:DWORD src1_sel:WORD_1
    ds_read_b64 v[108:109], v108
    ds_read_b64 v[110:111], v110
    s_waitcnt lgkmcnt(10)
    v_smfmac_f32_16x16x64_bf16 v[48:51], v[64:67], v[88:95], v68
    v_mfma_f32_16x16x32_bf16 v[112:115], v[80:83], v[248:251], v[112:115]
    buffer_load_dwordx4 v[80:83], v69, s[12:15], s19 offen offset:0
    v_lshlrev_b32_sdwa v88, 3, v122 dst_sel:DWORD dst_unused:UNUSED_PAD src0_sel:DWORD src1_sel:WORD_0
    v_lshlrev_b32_sdwa v90, 3, v122 dst_sel:DWORD dst_unused:UNUSED_PAD src0_sel:DWORD src1_sel:WORD_1
    ds_read_b64 v[88:89], v88
    ds_read_b64 v[90:91], v90
    v_mfma_f32_16x16x32_bf16 v[112:115], v[84:87], v[252:255], v[112:115]
    buffer_load_dwordx4 v[84:87], v69, s[12:15], s19 offen offset:1024
    s_add_u32 s21, s21, 4096
    s_add_u32 s19, s19, 4096
    v_lshlrev_b32_sdwa v92, 3, v123 dst_sel:DWORD dst_unused:UNUSED_PAD src0_sel:DWORD src1_sel:WORD_0
    v_lshlrev_b32_sdwa v94, 3, v123 dst_sel:DWORD dst_unused:UNUSED_PAD src0_sel:DWORD src1_sel:WORD_1
    ds_read_b64 v[92:93], v92
    ds_read_b64 v[94:95], v94
    buffer_load_dwordx4 v[120:123], v69, s[12:15], s20 offen offset:2048 sc1
    s_waitcnt lgkmcnt(9)
    v_smfmac_f32_16x16x64_bf16 v[52:55], v[64:67], v[96:103], v68
    v_cvt_pk_bf16_f32 v112, v112, v113
    v_cvt_pk_bf16_f32 v113, v114, v115
    ds_write_b64 v70, v[112:113] offset:896
    s_add_u32 s23, s23, 1
    s_cmp_eq_u32 s23, 5
    s_cselect_b32 s35, 4294836224, s32
    s_cselect_b32 s23, 0, s23
    v_add_u32 v70, s35, v70
    s_waitcnt vmcnt(6)
    v_lshlrev_b32_sdwa v96, 3, v124 dst_sel:DWORD dst_unused:UNUSED_PAD src0_sel:DWORD src1_sel:WORD_0
    v_lshlrev_b32_sdwa v98, 3, v124 dst_sel:DWORD dst_unused:UNUSED_PAD src0_sel:DWORD src1_sel:WORD_1
    ds_read_b64 v[96:97], v96
    ds_read_b64 v[98:99], v98
    v_lshlrev_b32_sdwa v100, 3, v125 dst_sel:DWORD dst_unused:UNUSED_PAD src0_sel:DWORD src1_sel:WORD_0
    v_lshlrev_b32_sdwa v102, 3, v125 dst_sel:DWORD dst_unused:UNUSED_PAD src0_sel:DWORD src1_sel:WORD_1
    ds_read_b64 v[100:101], v100
    ds_read_b64 v[102:103], v102
    s_waitcnt lgkmcnt(9)
    v_smfmac_f32_16x16x64_bf16 v[56:59], v[64:67], v[104:111], v68
    s_setprio 0
    v_lshlrev_b32_sdwa v104, 3, v126 dst_sel:DWORD dst_unused:UNUSED_PAD src0_sel:DWORD src1_sel:WORD_0
    v_lshlrev_b32_sdwa v106, 3, v126 dst_sel:DWORD dst_unused:UNUSED_PAD src0_sel:DWORD src1_sel:WORD_1
    ds_read_b64 v[104:105], v104
    ds_read_b64 v[106:107], v106
    v_lshlrev_b32_sdwa v108, 3, v127 dst_sel:DWORD dst_unused:UNUSED_PAD src0_sel:DWORD src1_sel:WORD_0
    v_lshlrev_b32_sdwa v110, 3, v127 dst_sel:DWORD dst_unused:UNUSED_PAD src0_sel:DWORD src1_sel:WORD_1
    ds_read_b64 v[108:109], v108
    ds_read_b64 v[110:111], v110
    buffer_load_dwordx4 v[124:127], v69, s[12:15], s20 offen offset:3072 sc1
    s_add_u32 s20, s20, 4096
    s_waitcnt lgkmcnt(9)
    v_smfmac_f32_16x16x64_bf16 v[60:63], v[64:67], v[88:95], v68
    s_waitcnt lgkmcnt(8)
    s_barrier

    s_cmp_eq_u32 s22, 7
    s_cbranch_scc1 k1_kernel_fin

    s_setprio 3
    s_waitcnt vmcnt(6)
    v_lshlrev_b32_sdwa v88, 3, v116 dst_sel:DWORD dst_unused:UNUSED_PAD src0_sel:DWORD src1_sel:WORD_0
    v_lshlrev_b32_sdwa v90, 3, v116 dst_sel:DWORD dst_unused:UNUSED_PAD src0_sel:DWORD src1_sel:WORD_1
    ds_read_b64 v[88:89], v88
    ds_read_b64 v[90:91], v90
    v_lshlrev_b32_sdwa v92, 3, v117 dst_sel:DWORD dst_unused:UNUSED_PAD src0_sel:DWORD src1_sel:WORD_0
    v_lshlrev_b32_sdwa v94, 3, v117 dst_sel:DWORD dst_unused:UNUSED_PAD src0_sel:DWORD src1_sel:WORD_1
    ds_read_b64 v[92:93], v92
    ds_read_b64 v[94:95], v94
    s_waitcnt lgkmcnt(8)
    v_smfmac_f32_16x16x64_bf16 v[0:3], v[64:67], v[96:103], v68
    s_waitcnt vmcnt(5)
    v_mfma_f32_16x16x32_bf16 v[112:115], v[72:75], v[128:131], 0
    v_lshlrev_b32_sdwa v96, 3, v118 dst_sel:DWORD dst_unused:UNUSED_PAD src0_sel:DWORD src1_sel:WORD_0
    v_lshlrev_b32_sdwa v98, 3, v118 dst_sel:DWORD dst_unused:UNUSED_PAD src0_sel:DWORD src1_sel:WORD_1
    ds_read_b64 v[96:97], v96
    ds_read_b64 v[98:99], v98
    s_waitcnt vmcnt(4)
    v_mfma_f32_16x16x32_bf16 v[112:115], v[76:79], v[132:135], v[112:115]
    v_lshlrev_b32_sdwa v100, 3, v119 dst_sel:DWORD dst_unused:UNUSED_PAD src0_sel:DWORD src1_sel:WORD_0
    v_lshlrev_b32_sdwa v102, 3, v119 dst_sel:DWORD dst_unused:UNUSED_PAD src0_sel:DWORD src1_sel:WORD_1
    ds_read_b64 v[100:101], v100
    ds_read_b64 v[102:103], v102
    buffer_load_dwordx4 v[116:119], v69, s[12:15], s20 offen offset:0 sc1
    s_waitcnt lgkmcnt(8)
    v_smfmac_f32_16x16x64_bf16 v[4:7], v[64:67], v[104:111], v68
    s_waitcnt vmcnt(4)
    v_mfma_f32_16x16x32_bf16 v[112:115], v[80:83], v[136:139], v[112:115]
    s_waitcnt vmcnt(2)
    v_lshlrev_b32_sdwa v104, 3, v120 dst_sel:DWORD dst_unused:UNUSED_PAD src0_sel:DWORD src1_sel:WORD_0
    v_lshlrev_b32_sdwa v106, 3, v120 dst_sel:DWORD dst_unused:UNUSED_PAD src0_sel:DWORD src1_sel:WORD_1
    ds_read_b64 v[104:105], v104
    ds_read_b64 v[106:107], v106
    s_waitcnt vmcnt(3)
    v_mfma_f32_16x16x32_bf16 v[112:115], v[84:87], v[140:143], v[112:115]
    v_lshlrev_b32_sdwa v108, 3, v121 dst_sel:DWORD dst_unused:UNUSED_PAD src0_sel:DWORD src1_sel:WORD_0
    v_lshlrev_b32_sdwa v110, 3, v121 dst_sel:DWORD dst_unused:UNUSED_PAD src0_sel:DWORD src1_sel:WORD_1
    ds_read_b64 v[108:109], v108
    ds_read_b64 v[110:111], v110
    s_waitcnt lgkmcnt(8)
    v_smfmac_f32_16x16x64_bf16 v[8:11], v[64:67], v[88:95], v68
    s_nop 1
    v_cvt_pk_bf16_f32 v112, v112, v113
    v_cvt_pk_bf16_f32 v113, v114, v115
    ds_write_b64 v70, v[112:113] offset:0
    v_mfma_f32_16x16x32_bf16 v[112:115], v[72:75], v[144:147], 0
    v_mfma_f32_16x16x32_bf16 v[112:115], v[76:79], v[148:151], v[112:115]
    v_lshlrev_b32_sdwa v88, 3, v122 dst_sel:DWORD dst_unused:UNUSED_PAD src0_sel:DWORD src1_sel:WORD_0
    v_lshlrev_b32_sdwa v90, 3, v122 dst_sel:DWORD dst_unused:UNUSED_PAD src0_sel:DWORD src1_sel:WORD_1
    ds_read_b64 v[88:89], v88
    ds_read_b64 v[90:91], v90
    v_mfma_f32_16x16x32_bf16 v[112:115], v[80:83], v[152:155], v[112:115]
    v_mfma_f32_16x16x32_bf16 v[112:115], v[84:87], v[156:159], v[112:115]
    v_lshlrev_b32_sdwa v92, 3, v123 dst_sel:DWORD dst_unused:UNUSED_PAD src0_sel:DWORD src1_sel:WORD_0
    v_lshlrev_b32_sdwa v94, 3, v123 dst_sel:DWORD dst_unused:UNUSED_PAD src0_sel:DWORD src1_sel:WORD_1
    ds_read_b64 v[92:93], v92
    ds_read_b64 v[94:95], v94
    buffer_load_dwordx4 v[120:123], v69, s[12:15], s20 offen offset:1024 sc1
    s_waitcnt lgkmcnt(9)
    v_smfmac_f32_16x16x64_bf16 v[12:15], v[64:67], v[96:103], v68
    s_nop 0
    v_cvt_pk_bf16_f32 v112, v112, v113
    v_cvt_pk_bf16_f32 v113, v114, v115
    ds_write_b64 v70, v[112:113] offset:128
    v_mfma_f32_16x16x32_bf16 v[112:115], v[72:75], v[160:163], 0
    s_waitcnt vmcnt(2)
    v_lshlrev_b32_sdwa v96, 3, v124 dst_sel:DWORD dst_unused:UNUSED_PAD src0_sel:DWORD src1_sel:WORD_0
    v_lshlrev_b32_sdwa v98, 3, v124 dst_sel:DWORD dst_unused:UNUSED_PAD src0_sel:DWORD src1_sel:WORD_1
    ds_read_b64 v[96:97], v96
    ds_read_b64 v[98:99], v98
    v_mfma_f32_16x16x32_bf16 v[112:115], v[76:79], v[164:167], v[112:115]
    v_lshlrev_b32_sdwa v100, 3, v125 dst_sel:DWORD dst_unused:UNUSED_PAD src0_sel:DWORD src1_sel:WORD_0
    v_lshlrev_b32_sdwa v102, 3, v125 dst_sel:DWORD dst_unused:UNUSED_PAD src0_sel:DWORD src1_sel:WORD_1
    ds_read_b64 v[100:101], v100
    ds_read_b64 v[102:103], v102
    s_waitcnt lgkmcnt(10)
    v_smfmac_f32_16x16x64_bf16 v[16:19], v[64:67], v[104:111], v68
    v_mfma_f32_16x16x32_bf16 v[112:115], v[80:83], v[168:171], v[112:115]
    v_lshlrev_b32_sdwa v104, 3, v126 dst_sel:DWORD dst_unused:UNUSED_PAD src0_sel:DWORD src1_sel:WORD_0
    v_lshlrev_b32_sdwa v106, 3, v126 dst_sel:DWORD dst_unused:UNUSED_PAD src0_sel:DWORD src1_sel:WORD_1
    ds_read_b64 v[104:105], v104
    ds_read_b64 v[106:107], v106
    v_mfma_f32_16x16x32_bf16 v[112:115], v[84:87], v[172:175], v[112:115]
    v_lshlrev_b32_sdwa v108, 3, v127 dst_sel:DWORD dst_unused:UNUSED_PAD src0_sel:DWORD src1_sel:WORD_0
    v_lshlrev_b32_sdwa v110, 3, v127 dst_sel:DWORD dst_unused:UNUSED_PAD src0_sel:DWORD src1_sel:WORD_1
    ds_read_b64 v[108:109], v108
    ds_read_b64 v[110:111], v110
    buffer_load_dwordx4 v[124:127], v69, s[12:15], s20 offen offset:2048 sc1
    s_waitcnt lgkmcnt(9)
    v_smfmac_f32_16x16x64_bf16 v[20:23], v[64:67], v[88:95], v68
    s_nop 0
    v_cvt_pk_bf16_f32 v112, v112, v113
    v_cvt_pk_bf16_f32 v113, v114, v115
    ds_write_b64 v70, v[112:113] offset:256
    v_mfma_f32_16x16x32_bf16 v[112:115], v[72:75], v[176:179], 0
    v_mfma_f32_16x16x32_bf16 v[112:115], v[76:79], v[180:183], v[112:115]
    s_waitcnt vmcnt(2)
    v_lshlrev_b32_sdwa v88, 3, v116 dst_sel:DWORD dst_unused:UNUSED_PAD src0_sel:DWORD src1_sel:WORD_0
    v_lshlrev_b32_sdwa v90, 3, v116 dst_sel:DWORD dst_unused:UNUSED_PAD src0_sel:DWORD src1_sel:WORD_1
    ds_read_b64 v[88:89], v88
    ds_read_b64 v[90:91], v90
    v_mfma_f32_16x16x32_bf16 v[112:115], v[80:83], v[184:187], v[112:115]
    v_mfma_f32_16x16x32_bf16 v[112:115], v[84:87], v[188:191], v[112:115]
    v_lshlrev_b32_sdwa v92, 3, v117 dst_sel:DWORD dst_unused:UNUSED_PAD src0_sel:DWORD src1_sel:WORD_0
    v_lshlrev_b32_sdwa v94, 3, v117 dst_sel:DWORD dst_unused:UNUSED_PAD src0_sel:DWORD src1_sel:WORD_1
    ds_read_b64 v[92:93], v92
    ds_read_b64 v[94:95], v94
    s_waitcnt lgkmcnt(9)
    v_smfmac_f32_16x16x64_bf16 v[24:27], v[64:67], v[96:103], v68
    s_nop 1
    v_cvt_pk_bf16_f32 v112, v112, v113
    v_cvt_pk_bf16_f32 v113, v114, v115
    ds_write_b64 v70, v[112:113] offset:384
    v_mfma_f32_16x16x32_bf16 v[112:115], v[72:75], v[192:195], 0
    v_lshlrev_b32_sdwa v96, 3, v118 dst_sel:DWORD dst_unused:UNUSED_PAD src0_sel:DWORD src1_sel:WORD_0
    v_lshlrev_b32_sdwa v98, 3, v118 dst_sel:DWORD dst_unused:UNUSED_PAD src0_sel:DWORD src1_sel:WORD_1
    ds_read_b64 v[96:97], v96
    ds_read_b64 v[98:99], v98
    v_mfma_f32_16x16x32_bf16 v[112:115], v[76:79], v[196:199], v[112:115]
    v_lshlrev_b32_sdwa v100, 3, v119 dst_sel:DWORD dst_unused:UNUSED_PAD src0_sel:DWORD src1_sel:WORD_0
    v_lshlrev_b32_sdwa v102, 3, v119 dst_sel:DWORD dst_unused:UNUSED_PAD src0_sel:DWORD src1_sel:WORD_1
    ds_read_b64 v[100:101], v100
    ds_read_b64 v[102:103], v102
    buffer_load_dwordx4 v[116:119], v69, s[12:15], s20 offen offset:3072 sc1
    s_add_u32 s20, s20, 61440
    s_waitcnt lgkmcnt(10)
    v_smfmac_f32_16x16x64_bf16 v[28:31], v[64:67], v[104:111], v68
    s_setprio 2
    v_mfma_f32_16x16x32_bf16 v[112:115], v[80:83], v[200:203], v[112:115]
    s_waitcnt vmcnt(2)
    v_lshlrev_b32_sdwa v104, 3, v120 dst_sel:DWORD dst_unused:UNUSED_PAD src0_sel:DWORD src1_sel:WORD_0
    v_lshlrev_b32_sdwa v106, 3, v120 dst_sel:DWORD dst_unused:UNUSED_PAD src0_sel:DWORD src1_sel:WORD_1
    ds_read_b64 v[104:105], v104
    ds_read_b64 v[106:107], v106
    v_mfma_f32_16x16x32_bf16 v[112:115], v[84:87], v[204:207], v[112:115]
    v_lshlrev_b32_sdwa v108, 3, v121 dst_sel:DWORD dst_unused:UNUSED_PAD src0_sel:DWORD src1_sel:WORD_0
    v_lshlrev_b32_sdwa v110, 3, v121 dst_sel:DWORD dst_unused:UNUSED_PAD src0_sel:DWORD src1_sel:WORD_1
    ds_read_b64 v[108:109], v108
    ds_read_b64 v[110:111], v110
    s_waitcnt lgkmcnt(9)
    v_smfmac_f32_16x16x64_bf16 v[32:35], v[64:67], v[88:95], v68
    s_nop 1
    v_cvt_pk_bf16_f32 v112, v112, v113
    v_cvt_pk_bf16_f32 v113, v114, v115
    ds_write_b64 v70, v[112:113] offset:512
    v_mfma_f32_16x16x32_bf16 v[112:115], v[72:75], v[208:211], 0
    v_lshlrev_b32_sdwa v88, 3, v122 dst_sel:DWORD dst_unused:UNUSED_PAD src0_sel:DWORD src1_sel:WORD_0
    v_lshlrev_b32_sdwa v90, 3, v122 dst_sel:DWORD dst_unused:UNUSED_PAD src0_sel:DWORD src1_sel:WORD_1
    ds_read_b64 v[88:89], v88
    ds_read_b64 v[90:91], v90
    v_mfma_f32_16x16x32_bf16 v[112:115], v[76:79], v[212:215], v[112:115]
    v_lshlrev_b32_sdwa v92, 3, v123 dst_sel:DWORD dst_unused:UNUSED_PAD src0_sel:DWORD src1_sel:WORD_0
    v_lshlrev_b32_sdwa v94, 3, v123 dst_sel:DWORD dst_unused:UNUSED_PAD src0_sel:DWORD src1_sel:WORD_1
    ds_read_b64 v[92:93], v92
    ds_read_b64 v[94:95], v94
    buffer_load_dwordx4 v[120:123], v69, s[12:15], s20 offen offset:0 sc1
    s_waitcnt lgkmcnt(9)
    v_smfmac_f32_16x16x64_bf16 v[36:39], v[64:67], v[96:103], v68
    v_mfma_f32_16x16x32_bf16 v[112:115], v[80:83], v[216:219], v[112:115]
    s_waitcnt vmcnt(2)
    v_lshlrev_b32_sdwa v96, 3, v124 dst_sel:DWORD dst_unused:UNUSED_PAD src0_sel:DWORD src1_sel:WORD_0
    v_lshlrev_b32_sdwa v98, 3, v124 dst_sel:DWORD dst_unused:UNUSED_PAD src0_sel:DWORD src1_sel:WORD_1
    ds_read_b64 v[96:97], v96
    ds_read_b64 v[98:99], v98
    v_mfma_f32_16x16x32_bf16 v[112:115], v[84:87], v[220:223], v[112:115]
    v_lshlrev_b32_sdwa v100, 3, v125 dst_sel:DWORD dst_unused:UNUSED_PAD src0_sel:DWORD src1_sel:WORD_0
    v_lshlrev_b32_sdwa v102, 3, v125 dst_sel:DWORD dst_unused:UNUSED_PAD src0_sel:DWORD src1_sel:WORD_1
    ds_read_b64 v[100:101], v100
    ds_read_b64 v[102:103], v102
    s_waitcnt lgkmcnt(9)
    v_smfmac_f32_16x16x64_bf16 v[40:43], v[64:67], v[104:111], v68
    s_nop 1
    v_cvt_pk_bf16_f32 v112, v112, v113
    v_cvt_pk_bf16_f32 v113, v114, v115
    ds_write_b64 v70, v[112:113] offset:640
    v_mfma_f32_16x16x32_bf16 v[112:115], v[72:75], v[224:227], 0
    v_mfma_f32_16x16x32_bf16 v[112:115], v[76:79], v[228:231], v[112:115]
    v_lshlrev_b32_sdwa v104, 3, v126 dst_sel:DWORD dst_unused:UNUSED_PAD src0_sel:DWORD src1_sel:WORD_0
    v_lshlrev_b32_sdwa v106, 3, v126 dst_sel:DWORD dst_unused:UNUSED_PAD src0_sel:DWORD src1_sel:WORD_1
    ds_read_b64 v[104:105], v104
    ds_read_b64 v[106:107], v106
    v_mfma_f32_16x16x32_bf16 v[112:115], v[80:83], v[232:235], v[112:115]
    v_mfma_f32_16x16x32_bf16 v[112:115], v[84:87], v[236:239], v[112:115]
    v_lshlrev_b32_sdwa v108, 3, v127 dst_sel:DWORD dst_unused:UNUSED_PAD src0_sel:DWORD src1_sel:WORD_0
    v_lshlrev_b32_sdwa v110, 3, v127 dst_sel:DWORD dst_unused:UNUSED_PAD src0_sel:DWORD src1_sel:WORD_1
    ds_read_b64 v[108:109], v108
    ds_read_b64 v[110:111], v110
    buffer_load_dwordx4 v[124:127], v69, s[12:15], s20 offen offset:1024 sc1
    s_waitcnt lgkmcnt(9)
    v_smfmac_f32_16x16x64_bf16 v[44:47], v[64:67], v[88:95], v68
    s_nop 0
    v_cvt_pk_bf16_f32 v112, v112, v113
    v_cvt_pk_bf16_f32 v113, v114, v115
    ds_write_b64 v70, v[112:113] offset:768
    s_setprio 1
    v_mfma_f32_16x16x32_bf16 v[112:115], v[72:75], v[240:243], 0
    buffer_load_dwordx4 v[72:75], v69, s[12:15], s21 offen offset:0
    s_waitcnt vmcnt(3)
    v_lshlrev_b32_sdwa v88, 3, v116 dst_sel:DWORD dst_unused:UNUSED_PAD src0_sel:DWORD src1_sel:WORD_0
    v_lshlrev_b32_sdwa v90, 3, v116 dst_sel:DWORD dst_unused:UNUSED_PAD src0_sel:DWORD src1_sel:WORD_1
    ds_read_b64 v[88:89], v88
    ds_read_b64 v[90:91], v90
    v_mfma_f32_16x16x32_bf16 v[112:115], v[76:79], v[244:247], v[112:115]
    buffer_load_dwordx4 v[76:79], v69, s[12:15], s21 offen offset:1024
    v_lshlrev_b32_sdwa v92, 3, v117 dst_sel:DWORD dst_unused:UNUSED_PAD src0_sel:DWORD src1_sel:WORD_0
    v_lshlrev_b32_sdwa v94, 3, v117 dst_sel:DWORD dst_unused:UNUSED_PAD src0_sel:DWORD src1_sel:WORD_1
    ds_read_b64 v[92:93], v92
    ds_read_b64 v[94:95], v94
    s_waitcnt lgkmcnt(10)
    v_smfmac_f32_16x16x64_bf16 v[48:51], v[64:67], v[96:103], v68
    v_mfma_f32_16x16x32_bf16 v[112:115], v[80:83], v[248:251], v[112:115]
    buffer_load_dwordx4 v[80:83], v69, s[12:15], s19 offen offset:0
    v_lshlrev_b32_sdwa v96, 3, v118 dst_sel:DWORD dst_unused:UNUSED_PAD src0_sel:DWORD src1_sel:WORD_0
    v_lshlrev_b32_sdwa v98, 3, v118 dst_sel:DWORD dst_unused:UNUSED_PAD src0_sel:DWORD src1_sel:WORD_1
    ds_read_b64 v[96:97], v96
    ds_read_b64 v[98:99], v98
    v_mfma_f32_16x16x32_bf16 v[112:115], v[84:87], v[252:255], v[112:115]
    buffer_load_dwordx4 v[84:87], v69, s[12:15], s19 offen offset:1024
    s_add_u32 s21, s21, 4096
    s_add_u32 s19, s19, 4096
    v_lshlrev_b32_sdwa v100, 3, v119 dst_sel:DWORD dst_unused:UNUSED_PAD src0_sel:DWORD src1_sel:WORD_0
    v_lshlrev_b32_sdwa v102, 3, v119 dst_sel:DWORD dst_unused:UNUSED_PAD src0_sel:DWORD src1_sel:WORD_1
    ds_read_b64 v[100:101], v100
    ds_read_b64 v[102:103], v102
    buffer_load_dwordx4 v[116:119], v69, s[12:15], s20 offen offset:2048 sc1
    s_waitcnt lgkmcnt(9)
    v_smfmac_f32_16x16x64_bf16 v[52:55], v[64:67], v[104:111], v68
    v_cvt_pk_bf16_f32 v112, v112, v113
    v_cvt_pk_bf16_f32 v113, v114, v115
    ds_write_b64 v70, v[112:113] offset:896
    s_add_u32 s23, s23, 1
    s_cmp_eq_u32 s23, 5
    s_cselect_b32 s35, 4294836224, s32
    s_cselect_b32 s23, 0, s23
    v_add_u32 v70, s35, v70
    s_waitcnt vmcnt(6)
    v_lshlrev_b32_sdwa v104, 3, v120 dst_sel:DWORD dst_unused:UNUSED_PAD src0_sel:DWORD src1_sel:WORD_0
    v_lshlrev_b32_sdwa v106, 3, v120 dst_sel:DWORD dst_unused:UNUSED_PAD src0_sel:DWORD src1_sel:WORD_1
    ds_read_b64 v[104:105], v104
    ds_read_b64 v[106:107], v106
    v_lshlrev_b32_sdwa v108, 3, v121 dst_sel:DWORD dst_unused:UNUSED_PAD src0_sel:DWORD src1_sel:WORD_0
    v_lshlrev_b32_sdwa v110, 3, v121 dst_sel:DWORD dst_unused:UNUSED_PAD src0_sel:DWORD src1_sel:WORD_1
    ds_read_b64 v[108:109], v108
    ds_read_b64 v[110:111], v110
    s_waitcnt lgkmcnt(9)
    v_smfmac_f32_16x16x64_bf16 v[56:59], v[64:67], v[88:95], v68
    s_setprio 0
    v_lshlrev_b32_sdwa v88, 3, v122 dst_sel:DWORD dst_unused:UNUSED_PAD src0_sel:DWORD src1_sel:WORD_0
    v_lshlrev_b32_sdwa v90, 3, v122 dst_sel:DWORD dst_unused:UNUSED_PAD src0_sel:DWORD src1_sel:WORD_1
    ds_read_b64 v[88:89], v88
    ds_read_b64 v[90:91], v90
    v_lshlrev_b32_sdwa v92, 3, v123 dst_sel:DWORD dst_unused:UNUSED_PAD src0_sel:DWORD src1_sel:WORD_0
    v_lshlrev_b32_sdwa v94, 3, v123 dst_sel:DWORD dst_unused:UNUSED_PAD src0_sel:DWORD src1_sel:WORD_1
    ds_read_b64 v[92:93], v92
    ds_read_b64 v[94:95], v94
    buffer_load_dwordx4 v[120:123], v69, s[12:15], s20 offen offset:3072 sc1
    s_add_u32 s20, s20, 4096
    s_waitcnt lgkmcnt(9)
    v_smfmac_f32_16x16x64_bf16 v[60:63], v[64:67], v[96:103], v68
    s_waitcnt lgkmcnt(8)
    s_barrier
    s_setprio 3
    s_waitcnt vmcnt(6)
    v_lshlrev_b32_sdwa v96, 3, v124 dst_sel:DWORD dst_unused:UNUSED_PAD src0_sel:DWORD src1_sel:WORD_0
    v_lshlrev_b32_sdwa v98, 3, v124 dst_sel:DWORD dst_unused:UNUSED_PAD src0_sel:DWORD src1_sel:WORD_1
    ds_read_b64 v[96:97], v96
    ds_read_b64 v[98:99], v98
    v_lshlrev_b32_sdwa v100, 3, v125 dst_sel:DWORD dst_unused:UNUSED_PAD src0_sel:DWORD src1_sel:WORD_0
    v_lshlrev_b32_sdwa v102, 3, v125 dst_sel:DWORD dst_unused:UNUSED_PAD src0_sel:DWORD src1_sel:WORD_1
    ds_read_b64 v[100:101], v100
    ds_read_b64 v[102:103], v102
    s_waitcnt lgkmcnt(8)
    v_smfmac_f32_16x16x64_bf16 v[0:3], v[64:67], v[104:111], v68
    s_waitcnt vmcnt(5)
    v_mfma_f32_16x16x32_bf16 v[112:115], v[72:75], v[128:131], 0
    v_lshlrev_b32_sdwa v104, 3, v126 dst_sel:DWORD dst_unused:UNUSED_PAD src0_sel:DWORD src1_sel:WORD_0
    v_lshlrev_b32_sdwa v106, 3, v126 dst_sel:DWORD dst_unused:UNUSED_PAD src0_sel:DWORD src1_sel:WORD_1
    ds_read_b64 v[104:105], v104
    ds_read_b64 v[106:107], v106
    s_waitcnt vmcnt(4)
    v_mfma_f32_16x16x32_bf16 v[112:115], v[76:79], v[132:135], v[112:115]
    v_lshlrev_b32_sdwa v108, 3, v127 dst_sel:DWORD dst_unused:UNUSED_PAD src0_sel:DWORD src1_sel:WORD_0
    v_lshlrev_b32_sdwa v110, 3, v127 dst_sel:DWORD dst_unused:UNUSED_PAD src0_sel:DWORD src1_sel:WORD_1
    ds_read_b64 v[108:109], v108
    ds_read_b64 v[110:111], v110
    buffer_load_dwordx4 v[124:127], v69, s[12:15], s20 offen offset:0 sc1
    s_waitcnt lgkmcnt(8)
    v_smfmac_f32_16x16x64_bf16 v[4:7], v[64:67], v[88:95], v68
    s_waitcnt vmcnt(4)
    v_mfma_f32_16x16x32_bf16 v[112:115], v[80:83], v[136:139], v[112:115]
    s_waitcnt vmcnt(2)
    v_lshlrev_b32_sdwa v88, 3, v116 dst_sel:DWORD dst_unused:UNUSED_PAD src0_sel:DWORD src1_sel:WORD_0
    v_lshlrev_b32_sdwa v90, 3, v116 dst_sel:DWORD dst_unused:UNUSED_PAD src0_sel:DWORD src1_sel:WORD_1
    ds_read_b64 v[88:89], v88
    ds_read_b64 v[90:91], v90
    s_waitcnt vmcnt(3)
    v_mfma_f32_16x16x32_bf16 v[112:115], v[84:87], v[140:143], v[112:115]
    v_lshlrev_b32_sdwa v92, 3, v117 dst_sel:DWORD dst_unused:UNUSED_PAD src0_sel:DWORD src1_sel:WORD_0
    v_lshlrev_b32_sdwa v94, 3, v117 dst_sel:DWORD dst_unused:UNUSED_PAD src0_sel:DWORD src1_sel:WORD_1
    ds_read_b64 v[92:93], v92
    ds_read_b64 v[94:95], v94
    s_waitcnt lgkmcnt(8)
    v_smfmac_f32_16x16x64_bf16 v[8:11], v[64:67], v[96:103], v68
    s_nop 1
    v_cvt_pk_bf16_f32 v112, v112, v113
    v_cvt_pk_bf16_f32 v113, v114, v115
    ds_write_b64 v70, v[112:113] offset:0
    v_mfma_f32_16x16x32_bf16 v[112:115], v[72:75], v[144:147], 0
    v_mfma_f32_16x16x32_bf16 v[112:115], v[76:79], v[148:151], v[112:115]
    v_lshlrev_b32_sdwa v96, 3, v118 dst_sel:DWORD dst_unused:UNUSED_PAD src0_sel:DWORD src1_sel:WORD_0
    v_lshlrev_b32_sdwa v98, 3, v118 dst_sel:DWORD dst_unused:UNUSED_PAD src0_sel:DWORD src1_sel:WORD_1
    ds_read_b64 v[96:97], v96
    ds_read_b64 v[98:99], v98
    v_mfma_f32_16x16x32_bf16 v[112:115], v[80:83], v[152:155], v[112:115]
    v_mfma_f32_16x16x32_bf16 v[112:115], v[84:87], v[156:159], v[112:115]
    v_lshlrev_b32_sdwa v100, 3, v119 dst_sel:DWORD dst_unused:UNUSED_PAD src0_sel:DWORD src1_sel:WORD_0
    v_lshlrev_b32_sdwa v102, 3, v119 dst_sel:DWORD dst_unused:UNUSED_PAD src0_sel:DWORD src1_sel:WORD_1
    ds_read_b64 v[100:101], v100
    ds_read_b64 v[102:103], v102
    buffer_load_dwordx4 v[116:119], v69, s[12:15], s20 offen offset:1024 sc1
    s_waitcnt lgkmcnt(9)
    v_smfmac_f32_16x16x64_bf16 v[12:15], v[64:67], v[104:111], v68
    s_nop 0
    v_cvt_pk_bf16_f32 v112, v112, v113
    v_cvt_pk_bf16_f32 v113, v114, v115
    ds_write_b64 v70, v[112:113] offset:128
    v_mfma_f32_16x16x32_bf16 v[112:115], v[72:75], v[160:163], 0
    s_waitcnt vmcnt(2)
    v_lshlrev_b32_sdwa v104, 3, v120 dst_sel:DWORD dst_unused:UNUSED_PAD src0_sel:DWORD src1_sel:WORD_0
    v_lshlrev_b32_sdwa v106, 3, v120 dst_sel:DWORD dst_unused:UNUSED_PAD src0_sel:DWORD src1_sel:WORD_1
    ds_read_b64 v[104:105], v104
    ds_read_b64 v[106:107], v106
    v_mfma_f32_16x16x32_bf16 v[112:115], v[76:79], v[164:167], v[112:115]
    v_lshlrev_b32_sdwa v108, 3, v121 dst_sel:DWORD dst_unused:UNUSED_PAD src0_sel:DWORD src1_sel:WORD_0
    v_lshlrev_b32_sdwa v110, 3, v121 dst_sel:DWORD dst_unused:UNUSED_PAD src0_sel:DWORD src1_sel:WORD_1
    ds_read_b64 v[108:109], v108
    ds_read_b64 v[110:111], v110
    s_waitcnt lgkmcnt(10)
    v_smfmac_f32_16x16x64_bf16 v[16:19], v[64:67], v[88:95], v68
    v_mfma_f32_16x16x32_bf16 v[112:115], v[80:83], v[168:171], v[112:115]
    v_lshlrev_b32_sdwa v88, 3, v122 dst_sel:DWORD dst_unused:UNUSED_PAD src0_sel:DWORD src1_sel:WORD_0
    v_lshlrev_b32_sdwa v90, 3, v122 dst_sel:DWORD dst_unused:UNUSED_PAD src0_sel:DWORD src1_sel:WORD_1
    ds_read_b64 v[88:89], v88
    ds_read_b64 v[90:91], v90
    v_mfma_f32_16x16x32_bf16 v[112:115], v[84:87], v[172:175], v[112:115]
    v_lshlrev_b32_sdwa v92, 3, v123 dst_sel:DWORD dst_unused:UNUSED_PAD src0_sel:DWORD src1_sel:WORD_0
    v_lshlrev_b32_sdwa v94, 3, v123 dst_sel:DWORD dst_unused:UNUSED_PAD src0_sel:DWORD src1_sel:WORD_1
    ds_read_b64 v[92:93], v92
    ds_read_b64 v[94:95], v94
    buffer_load_dwordx4 v[120:123], v69, s[12:15], s20 offen offset:2048 sc1
    s_waitcnt lgkmcnt(9)
    v_smfmac_f32_16x16x64_bf16 v[20:23], v[64:67], v[96:103], v68
    s_nop 0
    v_cvt_pk_bf16_f32 v112, v112, v113
    v_cvt_pk_bf16_f32 v113, v114, v115
    ds_write_b64 v70, v[112:113] offset:256
    v_mfma_f32_16x16x32_bf16 v[112:115], v[72:75], v[176:179], 0
    v_mfma_f32_16x16x32_bf16 v[112:115], v[76:79], v[180:183], v[112:115]
    s_waitcnt vmcnt(2)
    v_lshlrev_b32_sdwa v96, 3, v124 dst_sel:DWORD dst_unused:UNUSED_PAD src0_sel:DWORD src1_sel:WORD_0
    v_lshlrev_b32_sdwa v98, 3, v124 dst_sel:DWORD dst_unused:UNUSED_PAD src0_sel:DWORD src1_sel:WORD_1
    ds_read_b64 v[96:97], v96
    ds_read_b64 v[98:99], v98
    v_mfma_f32_16x16x32_bf16 v[112:115], v[80:83], v[184:187], v[112:115]
    v_mfma_f32_16x16x32_bf16 v[112:115], v[84:87], v[188:191], v[112:115]
    v_lshlrev_b32_sdwa v100, 3, v125 dst_sel:DWORD dst_unused:UNUSED_PAD src0_sel:DWORD src1_sel:WORD_0
    v_lshlrev_b32_sdwa v102, 3, v125 dst_sel:DWORD dst_unused:UNUSED_PAD src0_sel:DWORD src1_sel:WORD_1
    ds_read_b64 v[100:101], v100
    ds_read_b64 v[102:103], v102
    s_waitcnt lgkmcnt(9)
    v_smfmac_f32_16x16x64_bf16 v[24:27], v[64:67], v[104:111], v68
    s_nop 1
    v_cvt_pk_bf16_f32 v112, v112, v113
    v_cvt_pk_bf16_f32 v113, v114, v115
    ds_write_b64 v70, v[112:113] offset:384
    v_mfma_f32_16x16x32_bf16 v[112:115], v[72:75], v[192:195], 0
    v_lshlrev_b32_sdwa v104, 3, v126 dst_sel:DWORD dst_unused:UNUSED_PAD src0_sel:DWORD src1_sel:WORD_0
    v_lshlrev_b32_sdwa v106, 3, v126 dst_sel:DWORD dst_unused:UNUSED_PAD src0_sel:DWORD src1_sel:WORD_1
    ds_read_b64 v[104:105], v104
    ds_read_b64 v[106:107], v106
    v_mfma_f32_16x16x32_bf16 v[112:115], v[76:79], v[196:199], v[112:115]
    v_lshlrev_b32_sdwa v108, 3, v127 dst_sel:DWORD dst_unused:UNUSED_PAD src0_sel:DWORD src1_sel:WORD_0
    v_lshlrev_b32_sdwa v110, 3, v127 dst_sel:DWORD dst_unused:UNUSED_PAD src0_sel:DWORD src1_sel:WORD_1
    ds_read_b64 v[108:109], v108
    ds_read_b64 v[110:111], v110
    buffer_load_dwordx4 v[124:127], v69, s[12:15], s20 offen offset:3072 sc1
    s_add_u32 s20, s20, 61440
    s_waitcnt lgkmcnt(10)
    v_smfmac_f32_16x16x64_bf16 v[28:31], v[64:67], v[88:95], v68
    s_setprio 2
    v_mfma_f32_16x16x32_bf16 v[112:115], v[80:83], v[200:203], v[112:115]
    s_waitcnt vmcnt(2)
    v_lshlrev_b32_sdwa v88, 3, v116 dst_sel:DWORD dst_unused:UNUSED_PAD src0_sel:DWORD src1_sel:WORD_0
    v_lshlrev_b32_sdwa v90, 3, v116 dst_sel:DWORD dst_unused:UNUSED_PAD src0_sel:DWORD src1_sel:WORD_1
    ds_read_b64 v[88:89], v88
    ds_read_b64 v[90:91], v90
    v_mfma_f32_16x16x32_bf16 v[112:115], v[84:87], v[204:207], v[112:115]
    v_lshlrev_b32_sdwa v92, 3, v117 dst_sel:DWORD dst_unused:UNUSED_PAD src0_sel:DWORD src1_sel:WORD_0
    v_lshlrev_b32_sdwa v94, 3, v117 dst_sel:DWORD dst_unused:UNUSED_PAD src0_sel:DWORD src1_sel:WORD_1
    ds_read_b64 v[92:93], v92
    ds_read_b64 v[94:95], v94
    s_waitcnt lgkmcnt(9)
    v_smfmac_f32_16x16x64_bf16 v[32:35], v[64:67], v[96:103], v68
    s_nop 1
    v_cvt_pk_bf16_f32 v112, v112, v113
    v_cvt_pk_bf16_f32 v113, v114, v115
    ds_write_b64 v70, v[112:113] offset:512
    v_mfma_f32_16x16x32_bf16 v[112:115], v[72:75], v[208:211], 0
    v_lshlrev_b32_sdwa v96, 3, v118 dst_sel:DWORD dst_unused:UNUSED_PAD src0_sel:DWORD src1_sel:WORD_0
    v_lshlrev_b32_sdwa v98, 3, v118 dst_sel:DWORD dst_unused:UNUSED_PAD src0_sel:DWORD src1_sel:WORD_1
    ds_read_b64 v[96:97], v96
    ds_read_b64 v[98:99], v98
    v_mfma_f32_16x16x32_bf16 v[112:115], v[76:79], v[212:215], v[112:115]
    v_lshlrev_b32_sdwa v100, 3, v119 dst_sel:DWORD dst_unused:UNUSED_PAD src0_sel:DWORD src1_sel:WORD_0
    v_lshlrev_b32_sdwa v102, 3, v119 dst_sel:DWORD dst_unused:UNUSED_PAD src0_sel:DWORD src1_sel:WORD_1
    ds_read_b64 v[100:101], v100
    ds_read_b64 v[102:103], v102
    buffer_load_dwordx4 v[116:119], v69, s[12:15], s20 offen offset:0 sc1
    s_waitcnt lgkmcnt(9)
    v_smfmac_f32_16x16x64_bf16 v[36:39], v[64:67], v[104:111], v68
    v_mfma_f32_16x16x32_bf16 v[112:115], v[80:83], v[216:219], v[112:115]
    s_waitcnt vmcnt(2)
    v_lshlrev_b32_sdwa v104, 3, v120 dst_sel:DWORD dst_unused:UNUSED_PAD src0_sel:DWORD src1_sel:WORD_0
    v_lshlrev_b32_sdwa v106, 3, v120 dst_sel:DWORD dst_unused:UNUSED_PAD src0_sel:DWORD src1_sel:WORD_1
    ds_read_b64 v[104:105], v104
    ds_read_b64 v[106:107], v106
    v_mfma_f32_16x16x32_bf16 v[112:115], v[84:87], v[220:223], v[112:115]
    v_lshlrev_b32_sdwa v108, 3, v121 dst_sel:DWORD dst_unused:UNUSED_PAD src0_sel:DWORD src1_sel:WORD_0
    v_lshlrev_b32_sdwa v110, 3, v121 dst_sel:DWORD dst_unused:UNUSED_PAD src0_sel:DWORD src1_sel:WORD_1
    ds_read_b64 v[108:109], v108
    ds_read_b64 v[110:111], v110
    s_waitcnt lgkmcnt(9)
    v_smfmac_f32_16x16x64_bf16 v[40:43], v[64:67], v[88:95], v68
    s_nop 1
    v_cvt_pk_bf16_f32 v112, v112, v113
    v_cvt_pk_bf16_f32 v113, v114, v115
    ds_write_b64 v70, v[112:113] offset:640
    v_mfma_f32_16x16x32_bf16 v[112:115], v[72:75], v[224:227], 0
    v_mfma_f32_16x16x32_bf16 v[112:115], v[76:79], v[228:231], v[112:115]
    v_lshlrev_b32_sdwa v88, 3, v122 dst_sel:DWORD dst_unused:UNUSED_PAD src0_sel:DWORD src1_sel:WORD_0
    v_lshlrev_b32_sdwa v90, 3, v122 dst_sel:DWORD dst_unused:UNUSED_PAD src0_sel:DWORD src1_sel:WORD_1
    ds_read_b64 v[88:89], v88
    ds_read_b64 v[90:91], v90
    v_mfma_f32_16x16x32_bf16 v[112:115], v[80:83], v[232:235], v[112:115]
    v_mfma_f32_16x16x32_bf16 v[112:115], v[84:87], v[236:239], v[112:115]
    v_lshlrev_b32_sdwa v92, 3, v123 dst_sel:DWORD dst_unused:UNUSED_PAD src0_sel:DWORD src1_sel:WORD_0
    v_lshlrev_b32_sdwa v94, 3, v123 dst_sel:DWORD dst_unused:UNUSED_PAD src0_sel:DWORD src1_sel:WORD_1
    ds_read_b64 v[92:93], v92
    ds_read_b64 v[94:95], v94
    buffer_load_dwordx4 v[120:123], v69, s[12:15], s20 offen offset:1024 sc1
    s_waitcnt lgkmcnt(9)
    v_smfmac_f32_16x16x64_bf16 v[44:47], v[64:67], v[96:103], v68
    s_nop 0
    v_cvt_pk_bf16_f32 v112, v112, v113
    v_cvt_pk_bf16_f32 v113, v114, v115
    ds_write_b64 v70, v[112:113] offset:768
    s_setprio 1
    v_mfma_f32_16x16x32_bf16 v[112:115], v[72:75], v[240:243], 0
    buffer_load_dwordx4 v[72:75], v69, s[12:15], s21 offen offset:0
    s_waitcnt vmcnt(3)
    v_lshlrev_b32_sdwa v96, 3, v124 dst_sel:DWORD dst_unused:UNUSED_PAD src0_sel:DWORD src1_sel:WORD_0
    v_lshlrev_b32_sdwa v98, 3, v124 dst_sel:DWORD dst_unused:UNUSED_PAD src0_sel:DWORD src1_sel:WORD_1
    ds_read_b64 v[96:97], v96
    ds_read_b64 v[98:99], v98
    v_mfma_f32_16x16x32_bf16 v[112:115], v[76:79], v[244:247], v[112:115]
    buffer_load_dwordx4 v[76:79], v69, s[12:15], s21 offen offset:1024
    v_lshlrev_b32_sdwa v100, 3, v125 dst_sel:DWORD dst_unused:UNUSED_PAD src0_sel:DWORD src1_sel:WORD_0
    v_lshlrev_b32_sdwa v102, 3, v125 dst_sel:DWORD dst_unused:UNUSED_PAD src0_sel:DWORD src1_sel:WORD_1
    ds_read_b64 v[100:101], v100
    ds_read_b64 v[102:103], v102
    s_waitcnt lgkmcnt(10)
    v_smfmac_f32_16x16x64_bf16 v[48:51], v[64:67], v[104:111], v68
    v_mfma_f32_16x16x32_bf16 v[112:115], v[80:83], v[248:251], v[112:115]
    buffer_load_dwordx4 v[80:83], v69, s[12:15], s19 offen offset:0
    v_lshlrev_b32_sdwa v104, 3, v126 dst_sel:DWORD dst_unused:UNUSED_PAD src0_sel:DWORD src1_sel:WORD_0
    v_lshlrev_b32_sdwa v106, 3, v126 dst_sel:DWORD dst_unused:UNUSED_PAD src0_sel:DWORD src1_sel:WORD_1
    ds_read_b64 v[104:105], v104
    ds_read_b64 v[106:107], v106
    v_mfma_f32_16x16x32_bf16 v[112:115], v[84:87], v[252:255], v[112:115]
    buffer_load_dwordx4 v[84:87], v69, s[12:15], s19 offen offset:1024
    s_add_u32 s21, s21, 4096
    s_add_u32 s19, s19, 4096
    v_lshlrev_b32_sdwa v108, 3, v127 dst_sel:DWORD dst_unused:UNUSED_PAD src0_sel:DWORD src1_sel:WORD_0
    v_lshlrev_b32_sdwa v110, 3, v127 dst_sel:DWORD dst_unused:UNUSED_PAD src0_sel:DWORD src1_sel:WORD_1
    ds_read_b64 v[108:109], v108
    ds_read_b64 v[110:111], v110
    buffer_load_dwordx4 v[124:127], v69, s[12:15], s20 offen offset:2048 sc1
    s_waitcnt lgkmcnt(9)
    v_smfmac_f32_16x16x64_bf16 v[52:55], v[64:67], v[88:95], v68
    v_cvt_pk_bf16_f32 v112, v112, v113
    v_cvt_pk_bf16_f32 v113, v114, v115
    ds_write_b64 v70, v[112:113] offset:896
    s_add_u32 s23, s23, 1
    s_cmp_eq_u32 s23, 5
    s_cselect_b32 s35, 4294836224, s32
    s_cselect_b32 s23, 0, s23
    v_add_u32 v70, s35, v70
    s_waitcnt vmcnt(6)
    v_lshlrev_b32_sdwa v88, 3, v116 dst_sel:DWORD dst_unused:UNUSED_PAD src0_sel:DWORD src1_sel:WORD_0
    v_lshlrev_b32_sdwa v90, 3, v116 dst_sel:DWORD dst_unused:UNUSED_PAD src0_sel:DWORD src1_sel:WORD_1
    ds_read_b64 v[88:89], v88
    ds_read_b64 v[90:91], v90
    v_lshlrev_b32_sdwa v92, 3, v117 dst_sel:DWORD dst_unused:UNUSED_PAD src0_sel:DWORD src1_sel:WORD_0
    v_lshlrev_b32_sdwa v94, 3, v117 dst_sel:DWORD dst_unused:UNUSED_PAD src0_sel:DWORD src1_sel:WORD_1
    ds_read_b64 v[92:93], v92
    ds_read_b64 v[94:95], v94
    s_waitcnt lgkmcnt(9)
    v_smfmac_f32_16x16x64_bf16 v[56:59], v[64:67], v[96:103], v68
    s_setprio 0
    v_lshlrev_b32_sdwa v96, 3, v118 dst_sel:DWORD dst_unused:UNUSED_PAD src0_sel:DWORD src1_sel:WORD_0
    v_lshlrev_b32_sdwa v98, 3, v118 dst_sel:DWORD dst_unused:UNUSED_PAD src0_sel:DWORD src1_sel:WORD_1
    ds_read_b64 v[96:97], v96
    ds_read_b64 v[98:99], v98
    v_lshlrev_b32_sdwa v100, 3, v119 dst_sel:DWORD dst_unused:UNUSED_PAD src0_sel:DWORD src1_sel:WORD_0
    v_lshlrev_b32_sdwa v102, 3, v119 dst_sel:DWORD dst_unused:UNUSED_PAD src0_sel:DWORD src1_sel:WORD_1
    ds_read_b64 v[100:101], v100
    ds_read_b64 v[102:103], v102
    buffer_load_dwordx4 v[116:119], v69, s[12:15], s20 offen offset:3072 sc1
    s_add_u32 s20, s20, 4096
    s_waitcnt lgkmcnt(9)
    v_smfmac_f32_16x16x64_bf16 v[60:63], v[64:67], v[104:111], v68
    s_waitcnt lgkmcnt(8)
    s_barrier

    s_add_u32 s22, s22, 1
    s_branch k1_kernel_gloop

k1_kernel_fin:

    s_add_u32 s40, s20, 61440
    s_add_u32 s41, s20, 65536
    s_add_u32 s44, s20, 126976
    s_add_u32 s45, s20, 131072

    s_lshl_b32 s28, s38, 16
    s_and_b32 s29, s38, 0xffff0000
    s_lshl_b32 s30, s39, 16
    s_and_b32 s31, s39, 0xffff0000
    s_lshl_b32 s35, s33, 16
    s_lshl_b32 s42, s34, 15
    s_add_u32 s35, s35, s42
    s_lshl_b32 s42, s3, 12
    s_add_u32 s35, s35, s42
    s_add_u32 s35, s35, 20971520

    s_setprio 3
    v_mov_b32 v128, 0xbdd2d3e8
    v_mov_b32 v129, 0xbdd2d3e8
    v_mov_b32 v130, 0xc0135761
    v_mov_b32 v131, 0xc0135761
    v_mov_b32 v132, 1.0
    v_mov_b32 v133, 1.0
    v_mov_b32 v134, s28
    v_mov_b32 v135, s29
    s_waitcnt vmcnt(6)
    v_lshlrev_b32_sdwa v88, 3, v116 dst_sel:DWORD dst_unused:UNUSED_PAD src0_sel:DWORD src1_sel:WORD_0
    v_lshlrev_b32_sdwa v90, 3, v116 dst_sel:DWORD dst_unused:UNUSED_PAD src0_sel:DWORD src1_sel:WORD_1
    ds_read_b64 v[88:89], v88
    ds_read_b64 v[90:91], v90
    v_lshlrev_b32_sdwa v92, 3, v117 dst_sel:DWORD dst_unused:UNUSED_PAD src0_sel:DWORD src1_sel:WORD_0
    v_lshlrev_b32_sdwa v94, 3, v117 dst_sel:DWORD dst_unused:UNUSED_PAD src0_sel:DWORD src1_sel:WORD_1
    ds_read_b64 v[92:93], v92
    ds_read_b64 v[94:95], v94
    s_waitcnt lgkmcnt(8)
    v_smfmac_f32_16x16x64_bf16 v[0:3], v[64:67], v[96:103], v68
    v_mov_b32 v136, s30
    v_mov_b32 v137, s31
    v_lshrrev_b32 v70, 2, v69
    v_and_b32 v71, 128, v70
    v_add_u32 v70, v70, v71
    v_rcp_f32 v134, v134
    v_rcp_f32 v135, v135
    v_rcp_f32 v136, v136
    v_lshlrev_b32_sdwa v96, 3, v118 dst_sel:DWORD dst_unused:UNUSED_PAD src0_sel:DWORD src1_sel:WORD_0
    v_lshlrev_b32_sdwa v98, 3, v118 dst_sel:DWORD dst_unused:UNUSED_PAD src0_sel:DWORD src1_sel:WORD_1
    ds_read_b64 v[96:97], v96
    ds_read_b64 v[98:99], v98
    v_lshlrev_b32_sdwa v100, 3, v119 dst_sel:DWORD dst_unused:UNUSED_PAD src0_sel:DWORD src1_sel:WORD_0
    v_lshlrev_b32_sdwa v102, 3, v119 dst_sel:DWORD dst_unused:UNUSED_PAD src0_sel:DWORD src1_sel:WORD_1
    ds_read_b64 v[100:101], v100
    ds_read_b64 v[102:103], v102
    buffer_load_dwordx4 v[116:119], v69, s[12:15], s40 offen offset:0 sc1
    s_waitcnt lgkmcnt(8)
    v_smfmac_f32_16x16x64_bf16 v[4:7], v[64:67], v[104:111], v68
    v_rcp_f32 v137, v137
    v_mov_b32 v132, 0x7f7fffff
    v_mov_b32 v133, 0xff7fffff
    v_med3_f32 v134, v134, v132, v133
    v_med3_f32 v135, v135, v132, v133
    v_med3_f32 v136, v136, v132, v133
    v_med3_f32 v137, v137, v132, v133
    s_waitcnt vmcnt(2)
    v_lshlrev_b32_sdwa v104, 3, v120 dst_sel:DWORD dst_unused:UNUSED_PAD src0_sel:DWORD src1_sel:WORD_0
    v_lshlrev_b32_sdwa v106, 3, v120 dst_sel:DWORD dst_unused:UNUSED_PAD src0_sel:DWORD src1_sel:WORD_1
    ds_read_b64 v[104:105], v104
    ds_read_b64 v[106:107], v106
    v_lshlrev_b32_sdwa v108, 3, v121 dst_sel:DWORD dst_unused:UNUSED_PAD src0_sel:DWORD src1_sel:WORD_0
    v_lshlrev_b32_sdwa v110, 3, v121 dst_sel:DWORD dst_unused:UNUSED_PAD src0_sel:DWORD src1_sel:WORD_1
    ds_read_b64 v[108:109], v108
    ds_read_b64 v[110:111], v110
    s_waitcnt lgkmcnt(8)
    v_smfmac_f32_16x16x64_bf16 v[8:11], v[64:67], v[88:95], v68
    v_lshlrev_b32_sdwa v88, 3, v122 dst_sel:DWORD dst_unused:UNUSED_PAD src0_sel:DWORD src1_sel:WORD_0
    v_lshlrev_b32_sdwa v90, 3, v122 dst_sel:DWORD dst_unused:UNUSED_PAD src0_sel:DWORD src1_sel:WORD_1
    ds_read_b64 v[88:89], v88
    ds_read_b64 v[90:91], v90
    v_lshlrev_b32_sdwa v92, 3, v123 dst_sel:DWORD dst_unused:UNUSED_PAD src0_sel:DWORD src1_sel:WORD_0
    v_lshlrev_b32_sdwa v94, 3, v123 dst_sel:DWORD dst_unused:UNUSED_PAD src0_sel:DWORD src1_sel:WORD_1
    ds_read_b64 v[92:93], v92
    ds_read_b64 v[94:95], v94
    buffer_load_dwordx4 v[120:123], v69, s[12:15], s44 offen offset:0 sc1
    s_waitcnt lgkmcnt(8)
    v_smfmac_f32_16x16x64_bf16 v[12:15], v[64:67], v[96:103], v68
    s_waitcnt vmcnt(2)
    v_lshlrev_b32_sdwa v96, 3, v124 dst_sel:DWORD dst_unused:UNUSED_PAD src0_sel:DWORD src1_sel:WORD_0
    v_lshlrev_b32_sdwa v98, 3, v124 dst_sel:DWORD dst_unused:UNUSED_PAD src0_sel:DWORD src1_sel:WORD_1
    ds_read_b64 v[96:97], v96
    ds_read_b64 v[98:99], v98
    v_lshlrev_b32_sdwa v100, 3, v125 dst_sel:DWORD dst_unused:UNUSED_PAD src0_sel:DWORD src1_sel:WORD_0
    v_lshlrev_b32_sdwa v102, 3, v125 dst_sel:DWORD dst_unused:UNUSED_PAD src0_sel:DWORD src1_sel:WORD_1
    ds_read_b64 v[100:101], v100
    ds_read_b64 v[102:103], v102
    s_waitcnt lgkmcnt(8)
    v_smfmac_f32_16x16x64_bf16 v[16:19], v[64:67], v[104:111], v68
    v_lshlrev_b32_sdwa v104, 3, v126 dst_sel:DWORD dst_unused:UNUSED_PAD src0_sel:DWORD src1_sel:WORD_0
    v_lshlrev_b32_sdwa v106, 3, v126 dst_sel:DWORD dst_unused:UNUSED_PAD src0_sel:DWORD src1_sel:WORD_1
    ds_read_b64 v[104:105], v104
    ds_read_b64 v[106:107], v106
    v_lshlrev_b32_sdwa v108, 3, v127 dst_sel:DWORD dst_unused:UNUSED_PAD src0_sel:DWORD src1_sel:WORD_0
    v_lshlrev_b32_sdwa v110, 3, v127 dst_sel:DWORD dst_unused:UNUSED_PAD src0_sel:DWORD src1_sel:WORD_1
    ds_read_b64 v[108:109], v108
    ds_read_b64 v[110:111], v110
    buffer_load_dwordx4 v[124:127], v69, s[12:15], s40 offen offset:1024 sc1
    s_waitcnt lgkmcnt(8)
    v_smfmac_f32_16x16x64_bf16 v[20:23], v[64:67], v[88:95], v68
    s_waitcnt vmcnt(2)
    v_lshlrev_b32_sdwa v88, 3, v116 dst_sel:DWORD dst_unused:UNUSED_PAD src0_sel:DWORD src1_sel:WORD_0
    v_lshlrev_b32_sdwa v90, 3, v116 dst_sel:DWORD dst_unused:UNUSED_PAD src0_sel:DWORD src1_sel:WORD_1
    ds_read_b64 v[88:89], v88
    ds_read_b64 v[90:91], v90
    v_lshlrev_b32_sdwa v92, 3, v117 dst_sel:DWORD dst_unused:UNUSED_PAD src0_sel:DWORD src1_sel:WORD_0
    v_lshlrev_b32_sdwa v94, 3, v117 dst_sel:DWORD dst_unused:UNUSED_PAD src0_sel:DWORD src1_sel:WORD_1
    ds_read_b64 v[92:93], v92
    ds_read_b64 v[94:95], v94
    s_waitcnt lgkmcnt(8)
    v_smfmac_f32_16x16x64_bf16 v[24:27], v[64:67], v[96:103], v68
    v_lshlrev_b32_sdwa v96, 3, v118 dst_sel:DWORD dst_unused:UNUSED_PAD src0_sel:DWORD src1_sel:WORD_0
    v_lshlrev_b32_sdwa v98, 3, v118 dst_sel:DWORD dst_unused:UNUSED_PAD src0_sel:DWORD src1_sel:WORD_1
    ds_read_b64 v[96:97], v96
    ds_read_b64 v[98:99], v98
    v_lshlrev_b32_sdwa v100, 3, v119 dst_sel:DWORD dst_unused:UNUSED_PAD src0_sel:DWORD src1_sel:WORD_0
    v_lshlrev_b32_sdwa v102, 3, v119 dst_sel:DWORD dst_unused:UNUSED_PAD src0_sel:DWORD src1_sel:WORD_1
    ds_read_b64 v[100:101], v100
    ds_read_b64 v[102:103], v102
    buffer_load_dwordx4 v[116:119], v69, s[12:15], s44 offen offset:1024 sc1
    s_waitcnt lgkmcnt(8)
    v_smfmac_f32_16x16x64_bf16 v[28:31], v[64:67], v[104:111], v68
    s_waitcnt vmcnt(2)
    v_lshlrev_b32_sdwa v104, 3, v120 dst_sel:DWORD dst_unused:UNUSED_PAD src0_sel:DWORD src1_sel:WORD_0
    v_lshlrev_b32_sdwa v106, 3, v120 dst_sel:DWORD dst_unused:UNUSED_PAD src0_sel:DWORD src1_sel:WORD_1
    ds_read_b64 v[104:105], v104
    ds_read_b64 v[106:107], v106
    v_lshlrev_b32_sdwa v108, 3, v121 dst_sel:DWORD dst_unused:UNUSED_PAD src0_sel:DWORD src1_sel:WORD_0
    v_lshlrev_b32_sdwa v110, 3, v121 dst_sel:DWORD dst_unused:UNUSED_PAD src0_sel:DWORD src1_sel:WORD_1
    ds_read_b64 v[108:109], v108
    ds_read_b64 v[110:111], v110
    s_waitcnt lgkmcnt(8)
    v_smfmac_f32_16x16x64_bf16 v[0:3], v[64:67], v[88:95], v68
    v_lshlrev_b32_sdwa v88, 3, v122 dst_sel:DWORD dst_unused:UNUSED_PAD src0_sel:DWORD src1_sel:WORD_0
    v_lshlrev_b32_sdwa v90, 3, v122 dst_sel:DWORD dst_unused:UNUSED_PAD src0_sel:DWORD src1_sel:WORD_1
    ds_read_b64 v[88:89], v88
    ds_read_b64 v[90:91], v90
    v_lshlrev_b32_sdwa v92, 3, v123 dst_sel:DWORD dst_unused:UNUSED_PAD src0_sel:DWORD src1_sel:WORD_0
    v_lshlrev_b32_sdwa v94, 3, v123 dst_sel:DWORD dst_unused:UNUSED_PAD src0_sel:DWORD src1_sel:WORD_1
    ds_read_b64 v[92:93], v92
    ds_read_b64 v[94:95], v94
    buffer_load_dwordx4 v[120:123], v69, s[12:15], s40 offen offset:2048 sc1
    s_waitcnt lgkmcnt(8)
    v_smfmac_f32_16x16x64_bf16 v[4:7], v[64:67], v[96:103], v68
    s_waitcnt vmcnt(2)
    v_lshlrev_b32_sdwa v96, 3, v124 dst_sel:DWORD dst_unused:UNUSED_PAD src0_sel:DWORD src1_sel:WORD_0
    v_lshlrev_b32_sdwa v98, 3, v124 dst_sel:DWORD dst_unused:UNUSED_PAD src0_sel:DWORD src1_sel:WORD_1
    ds_read_b64 v[96:97], v96
    ds_read_b64 v[98:99], v98
    v_lshlrev_b32_sdwa v100, 3, v125 dst_sel:DWORD dst_unused:UNUSED_PAD src0_sel:DWORD src1_sel:WORD_0
    v_lshlrev_b32_sdwa v102, 3, v125 dst_sel:DWORD dst_unused:UNUSED_PAD src0_sel:DWORD src1_sel:WORD_1
    ds_read_b64 v[100:101], v100
    ds_read_b64 v[102:103], v102
    s_waitcnt lgkmcnt(8)
    v_smfmac_f32_16x16x64_bf16 v[0:3], v[64:67], v[104:111], v68
    v_lshlrev_b32_sdwa v104, 3, v126 dst_sel:DWORD dst_unused:UNUSED_PAD src0_sel:DWORD src1_sel:WORD_0
    v_lshlrev_b32_sdwa v106, 3, v126 dst_sel:DWORD dst_unused:UNUSED_PAD src0_sel:DWORD src1_sel:WORD_1
    ds_read_b64 v[104:105], v104
    ds_read_b64 v[106:107], v106
    v_lshlrev_b32_sdwa v108, 3, v127 dst_sel:DWORD dst_unused:UNUSED_PAD src0_sel:DWORD src1_sel:WORD_0
    v_lshlrev_b32_sdwa v110, 3, v127 dst_sel:DWORD dst_unused:UNUSED_PAD src0_sel:DWORD src1_sel:WORD_1
    ds_read_b64 v[108:109], v108
    ds_read_b64 v[110:111], v110
    buffer_load_dwordx4 v[124:127], v69, s[12:15], s44 offen offset:2048 sc1
    s_waitcnt lgkmcnt(8)
    v_smfmac_f32_16x16x64_bf16 v[4:7], v[64:67], v[88:95], v68
    s_waitcnt vmcnt(2)
    v_lshlrev_b32_sdwa v88, 3, v116 dst_sel:DWORD dst_unused:UNUSED_PAD src0_sel:DWORD src1_sel:WORD_0
    v_lshlrev_b32_sdwa v90, 3, v116 dst_sel:DWORD dst_unused:UNUSED_PAD src0_sel:DWORD src1_sel:WORD_1
    ds_read_b64 v[88:89], v88
    ds_read_b64 v[90:91], v90
    v_lshlrev_b32_sdwa v92, 3, v117 dst_sel:DWORD dst_unused:UNUSED_PAD src0_sel:DWORD src1_sel:WORD_0
    v_lshlrev_b32_sdwa v94, 3, v117 dst_sel:DWORD dst_unused:UNUSED_PAD src0_sel:DWORD src1_sel:WORD_1
    ds_read_b64 v[92:93], v92
    ds_read_b64 v[94:95], v94
    s_waitcnt lgkmcnt(8)
    v_smfmac_f32_16x16x64_bf16 v[8:11], v[64:67], v[96:103], v68
    v_pk_mul_f32 v[140:141], v[0:1], v[0:1]
    v_pk_mul_f32 v[142:143], v[2:3], v[2:3]
    v_pk_fma_f32 v[140:141], v[140:141], v[128:129], v[130:131]
    v_pk_fma_f32 v[142:143], v[142:143], v[128:129], v[130:131]
    v_pk_mul_f32 v[140:141], v[140:141], v[0:1]
    v_pk_mul_f32 v[142:143], v[142:143], v[2:3]
    v_exp_f32 v140, v140
    v_pk_mul_f32 v[146:147], v[4:5], v[4:5]
    v_lshlrev_b32_sdwa v96, 3, v118 dst_sel:DWORD dst_unused:UNUSED_PAD src0_sel:DWORD src1_sel:WORD_0
    v_lshlrev_b32_sdwa v98, 3, v118 dst_sel:DWORD dst_unused:UNUSED_PAD src0_sel:DWORD src1_sel:WORD_1
    ds_read_b64 v[96:97], v96
    ds_read_b64 v[98:99], v98
    v_lshlrev_b32_sdwa v100, 3, v119 dst_sel:DWORD dst_unused:UNUSED_PAD src0_sel:DWORD src1_sel:WORD_0
    v_lshlrev_b32_sdwa v102, 3, v119 dst_sel:DWORD dst_unused:UNUSED_PAD src0_sel:DWORD src1_sel:WORD_1
    ds_read_b64 v[100:101], v100
    ds_read_b64 v[102:103], v102
    buffer_load_dwordx4 v[116:119], v69, s[12:15], s40 offen offset:3072 sc1
    s_waitcnt lgkmcnt(8)
    v_smfmac_f32_16x16x64_bf16 v[12:15], v[64:67], v[104:111], v68
    v_exp_f32 v141, v141
    v_pk_fma_f32 v[146:147], v[146:147], v[128:129], v[130:131]
    v_pk_mul_f32 v[148:149], v[6:7], v[6:7]
    v_exp_f32 v142, v142
    v_pk_fma_f32 v[140:141], v[140:141], v[134:135], v[134:135]
    v_pk_mul_f32 v[146:147], v[146:147], v[4:5]
    v_rcp_f32 v140, v140
    v_pk_fma_f32 v[148:149], v[148:149], v[128:129], v[130:131]
    s_waitcnt vmcnt(2)
    v_lshlrev_b32_sdwa v104, 3, v120 dst_sel:DWORD dst_unused:UNUSED_PAD src0_sel:DWORD src1_sel:WORD_0
    v_lshlrev_b32_sdwa v106, 3, v120 dst_sel:DWORD dst_unused:UNUSED_PAD src0_sel:DWORD src1_sel:WORD_1
    ds_read_b64 v[104:105], v104
    ds_read_b64 v[106:107], v106
    v_lshlrev_b32_sdwa v108, 3, v121 dst_sel:DWORD dst_unused:UNUSED_PAD src0_sel:DWORD src1_sel:WORD_0
    v_lshlrev_b32_sdwa v110, 3, v121 dst_sel:DWORD dst_unused:UNUSED_PAD src0_sel:DWORD src1_sel:WORD_1
    ds_read_b64 v[108:109], v108
    ds_read_b64 v[110:111], v110
    s_waitcnt lgkmcnt(8)
    v_smfmac_f32_16x16x64_bf16 v[8:11], v[64:67], v[88:95], v68
    v_rcp_f32 v141, v141
    v_pk_mul_f32 v[148:149], v[148:149], v[6:7]
    v_exp_f32 v143, v143
    v_pk_mul_f32 v[144:145], v[0:1], v[140:141]
    v_exp_f32 v146, v146
    v_pk_fma_f32 v[142:143], v[142:143], v[136:137], v[136:137]
    v_exp_f32 v147, v147
    v_rcp_f32 v142, v142
    v_lshlrev_b32_sdwa v88, 3, v122 dst_sel:DWORD dst_unused:UNUSED_PAD src0_sel:DWORD src1_sel:WORD_0
    v_lshlrev_b32_sdwa v90, 3, v122 dst_sel:DWORD dst_unused:UNUSED_PAD src0_sel:DWORD src1_sel:WORD_1
    ds_read_b64 v[88:89], v88
    ds_read_b64 v[90:91], v90
    v_lshlrev_b32_sdwa v92, 3, v123 dst_sel:DWORD dst_unused:UNUSED_PAD src0_sel:DWORD src1_sel:WORD_0
    v_lshlrev_b32_sdwa v94, 3, v123 dst_sel:DWORD dst_unused:UNUSED_PAD src0_sel:DWORD src1_sel:WORD_1
    ds_read_b64 v[92:93], v92
    ds_read_b64 v[94:95], v94
    buffer_load_dwordx4 v[120:123], v69, s[12:15], s44 offen offset:3072 sc1
    s_waitcnt lgkmcnt(8)
    v_smfmac_f32_16x16x64_bf16 v[12:15], v[64:67], v[96:103], v68
    v_rcp_f32 v143, v143
    v_pk_fma_f32 v[146:147], v[146:147], v[134:135], v[134:135]
    v_pk_mul_f32 v[152:153], v[8:9], v[8:9]
    v_rcp_f32 v146, v146
    v_pk_fma_f32 v[144:145], v[2:3], v[142:143], v[144:145]
    v_pk_fma_f32 v[152:153], v[152:153], v[128:129], v[130:131]
    v_rcp_f32 v147, v147
    v_add_f32 v144, v144, v145
    s_waitcnt vmcnt(2)
    v_lshlrev_b32_sdwa v96, 3, v124 dst_sel:DWORD dst_unused:UNUSED_PAD src0_sel:DWORD src1_sel:WORD_0
    v_lshlrev_b32_sdwa v98, 3, v124 dst_sel:DWORD dst_unused:UNUSED_PAD src0_sel:DWORD src1_sel:WORD_1
    ds_read_b64 v[96:97], v96
    ds_read_b64 v[98:99], v98
    v_lshlrev_b32_sdwa v100, 3, v125 dst_sel:DWORD dst_unused:UNUSED_PAD src0_sel:DWORD src1_sel:WORD_0
    v_lshlrev_b32_sdwa v102, 3, v125 dst_sel:DWORD dst_unused:UNUSED_PAD src0_sel:DWORD src1_sel:WORD_1
    ds_read_b64 v[100:101], v100
    ds_read_b64 v[102:103], v102
    s_waitcnt lgkmcnt(8)
    v_smfmac_f32_16x16x64_bf16 v[16:19], v[64:67], v[104:111], v68
    v_exp_f32 v148, v148
    buffer_store_dword v144, v70, s[12:15], s35 offen offset:0 sc1
    v_pk_mul_f32 v[150:151], v[4:5], v[146:147]
    v_exp_f32 v149, v149
    v_pk_mul_f32 v[152:153], v[152:153], v[8:9]
    v_pk_mul_f32 v[154:155], v[10:11], v[10:11]
    v_exp_f32 v152, v152
    v_pk_fma_f32 v[148:149], v[148:149], v[136:137], v[136:137]
    v_lshlrev_b32_sdwa v104, 3, v126 dst_sel:DWORD dst_unused:UNUSED_PAD src0_sel:DWORD src1_sel:WORD_0
    v_lshlrev_b32_sdwa v106, 3, v126 dst_sel:DWORD dst_unused:UNUSED_PAD src0_sel:DWORD src1_sel:WORD_1
    ds_read_b64 v[104:105], v104
    ds_read_b64 v[106:107], v106
    v_lshlrev_b32_sdwa v108, 3, v127 dst_sel:DWORD dst_unused:UNUSED_PAD src0_sel:DWORD src1_sel:WORD_0
    v_lshlrev_b32_sdwa v110, 3, v127 dst_sel:DWORD dst_unused:UNUSED_PAD src0_sel:DWORD src1_sel:WORD_1
    ds_read_b64 v[108:109], v108
    ds_read_b64 v[110:111], v110
    buffer_load_dwordx4 v[124:127], v69, s[12:15], s20 offen offset:0 sc1
    s_waitcnt lgkmcnt(8)
    v_smfmac_f32_16x16x64_bf16 v[20:23], v[64:67], v[88:95], v68
    v_rcp_f32 v148, v148
    v_pk_fma_f32 v[154:155], v[154:155], v[128:129], v[130:131]
    v_pk_mul_f32 v[158:159], v[12:13], v[12:13]
    v_rcp_f32 v149, v149
    v_pk_mul_f32 v[154:155], v[154:155], v[10:11]
    v_pk_fma_f32 v[158:159], v[158:159], v[128:129], v[130:131]
    v_exp_f32 v153, v153
    v_pk_fma_f32 v[150:151], v[6:7], v[148:149], v[150:151]
    s_waitcnt vmcnt(3)
    v_lshlrev_b32_sdwa v88, 3, v116 dst_sel:DWORD dst_unused:UNUSED_PAD src0_sel:DWORD src1_sel:WORD_0
    v_lshlrev_b32_sdwa v90, 3, v116 dst_sel:DWORD dst_unused:UNUSED_PAD src0_sel:DWORD src1_sel:WORD_1
    ds_read_b64 v[88:89], v88
    ds_read_b64 v[90:91], v90
    v_lshlrev_b32_sdwa v92, 3, v117 dst_sel:DWORD dst_unused:UNUSED_PAD src0_sel:DWORD src1_sel:WORD_0
    v_lshlrev_b32_sdwa v94, 3, v117 dst_sel:DWORD dst_unused:UNUSED_PAD src0_sel:DWORD src1_sel:WORD_1
    ds_read_b64 v[92:93], v92
    ds_read_b64 v[94:95], v94
    s_waitcnt lgkmcnt(8)
    v_smfmac_f32_16x16x64_bf16 v[16:19], v[64:67], v[96:103], v68
    v_exp_f32 v154, v154
    v_add_f32 v150, v150, v151
    v_pk_fma_f32 v[152:153], v[152:153], v[134:135], v[134:135]
    v_exp_f32 v155, v155
    buffer_store_dword v150, v70, s[12:15], s35 offen offset:128 sc1
    v_pk_mul_f32 v[158:159], v[158:159], v[12:13]
    v_rcp_f32 v152, v152
    v_pk_fma_f32 v[154:155], v[154:155], v[136:137], v[136:137]
    v_lshlrev_b32_sdwa v96, 3, v118 dst_sel:DWORD dst_unused:UNUSED_PAD src0_sel:DWORD src1_sel:WORD_0
    v_lshlrev_b32_sdwa v98, 3, v118 dst_sel:DWORD dst_unused:UNUSED_PAD src0_sel:DWORD src1_sel:WORD_1
    ds_read_b64 v[96:97], v96
    ds_read_b64 v[98:99], v98
    v_lshlrev_b32_sdwa v100, 3, v119 dst_sel:DWORD dst_unused:UNUSED_PAD src0_sel:DWORD src1_sel:WORD_0
    v_lshlrev_b32_sdwa v102, 3, v119 dst_sel:DWORD dst_unused:UNUSED_PAD src0_sel:DWORD src1_sel:WORD_1
    ds_read_b64 v[100:101], v100
    ds_read_b64 v[102:103], v102
    buffer_load_dwordx4 v[116:119], v69, s[12:15], s41 offen offset:0 sc1
    s_waitcnt lgkmcnt(8)
    v_smfmac_f32_16x16x64_bf16 v[20:23], v[64:67], v[104:111], v68
    v_rcp_f32 v153, v153
    v_pk_mul_f32 v[160:161], v[14:15], v[14:15]
    v_pk_mul_f32 v[164:165], v[16:17], v[16:17]
    v_rcp_f32 v154, v154
    v_pk_mul_f32 v[156:157], v[8:9], v[152:153]
    v_pk_fma_f32 v[160:161], v[160:161], v[128:129], v[130:131]
    v_rcp_f32 v155, v155
    v_pk_mul_f32 v[160:161], v[160:161], v[14:15]
    s_waitcnt vmcnt(4)
    v_lshlrev_b32_sdwa v104, 3, v120 dst_sel:DWORD dst_unused:UNUSED_PAD src0_sel:DWORD src1_sel:WORD_0
    v_lshlrev_b32_sdwa v106, 3, v120 dst_sel:DWORD dst_unused:UNUSED_PAD src0_sel:DWORD src1_sel:WORD_1
    ds_read_b64 v[104:105], v104
    ds_read_b64 v[106:107], v106
    v_lshlrev_b32_sdwa v108, 3, v121 dst_sel:DWORD dst_unused:UNUSED_PAD src0_sel:DWORD src1_sel:WORD_0
    v_lshlrev_b32_sdwa v110, 3, v121 dst_sel:DWORD dst_unused:UNUSED_PAD src0_sel:DWORD src1_sel:WORD_1
    ds_read_b64 v[108:109], v108
    ds_read_b64 v[110:111], v110
    s_waitcnt lgkmcnt(8)
    v_smfmac_f32_16x16x64_bf16 v[24:27], v[64:67], v[88:95], v68
    v_exp_f32 v158, v158
    v_pk_fma_f32 v[156:157], v[10:11], v[154:155], v[156:157]
    v_pk_fma_f32 v[164:165], v[164:165], v[128:129], v[130:131]
    v_exp_f32 v159, v159
    v_add_f32 v156, v156, v157
    v_pk_mul_f32 v[164:165], v[164:165], v[16:17]
    v_exp_f32 v160, v160
    buffer_store_dword v156, v70, s[12:15], s35 offen offset:512 sc1
    v_lshlrev_b32_sdwa v88, 3, v122 dst_sel:DWORD dst_unused:UNUSED_PAD src0_sel:DWORD src1_sel:WORD_0
    v_lshlrev_b32_sdwa v90, 3, v122 dst_sel:DWORD dst_unused:UNUSED_PAD src0_sel:DWORD src1_sel:WORD_1
    ds_read_b64 v[88:89], v88
    ds_read_b64 v[90:91], v90
    v_lshlrev_b32_sdwa v92, 3, v123 dst_sel:DWORD dst_unused:UNUSED_PAD src0_sel:DWORD src1_sel:WORD_0
    v_lshlrev_b32_sdwa v94, 3, v123 dst_sel:DWORD dst_unused:UNUSED_PAD src0_sel:DWORD src1_sel:WORD_1
    ds_read_b64 v[92:93], v92
    ds_read_b64 v[94:95], v94
    buffer_load_dwordx4 v[120:123], v69, s[12:15], s45 offen offset:0 sc1
    s_waitcnt lgkmcnt(8)
    v_smfmac_f32_16x16x64_bf16 v[28:31], v[64:67], v[96:103], v68
    v_exp_f32 v161, v161
    v_pk_fma_f32 v[158:159], v[158:159], v[134:135], v[134:135]
    v_pk_mul_f32 v[166:167], v[18:19], v[18:19]
    v_rcp_f32 v158, v158
    v_pk_fma_f32 v[160:161], v[160:161], v[136:137], v[136:137]
    v_pk_fma_f32 v[166:167], v[166:167], v[128:129], v[130:131]
    v_rcp_f32 v159, v159
    v_pk_mul_f32 v[166:167], v[166:167], v[18:19]
    s_waitcnt vmcnt(4)
    v_lshlrev_b32_sdwa v96, 3, v124 dst_sel:DWORD dst_unused:UNUSED_PAD src0_sel:DWORD src1_sel:WORD_0
    v_lshlrev_b32_sdwa v98, 3, v124 dst_sel:DWORD dst_unused:UNUSED_PAD src0_sel:DWORD src1_sel:WORD_1
    ds_read_b64 v[96:97], v96
    ds_read_b64 v[98:99], v98
    v_lshlrev_b32_sdwa v100, 3, v125 dst_sel:DWORD dst_unused:UNUSED_PAD src0_sel:DWORD src1_sel:WORD_0
    v_lshlrev_b32_sdwa v102, 3, v125 dst_sel:DWORD dst_unused:UNUSED_PAD src0_sel:DWORD src1_sel:WORD_1
    ds_read_b64 v[100:101], v100
    ds_read_b64 v[102:103], v102
    s_waitcnt lgkmcnt(8)
    v_smfmac_f32_16x16x64_bf16 v[24:27], v[64:67], v[104:111], v68
    v_rcp_f32 v160, v160
    v_pk_mul_f32 v[162:163], v[12:13], v[158:159]
    v_pk_mul_f32 v[170:171], v[20:21], v[20:21]
    v_rcp_f32 v161, v161
    v_pk_fma_f32 v[170:171], v[170:171], v[128:129], v[130:131]
    v_pk_mul_f32 v[172:173], v[22:23], v[22:23]
    v_exp_f32 v164, v164
    v_pk_fma_f32 v[162:163], v[14:15], v[160:161], v[162:163]
    v_lshlrev_b32_sdwa v104, 3, v126 dst_sel:DWORD dst_unused:UNUSED_PAD src0_sel:DWORD src1_sel:WORD_0
    v_lshlrev_b32_sdwa v106, 3, v126 dst_sel:DWORD dst_unused:UNUSED_PAD src0_sel:DWORD src1_sel:WORD_1
    ds_read_b64 v[104:105], v104
    ds_read_b64 v[106:107], v106
    v_lshlrev_b32_sdwa v108, 3, v127 dst_sel:DWORD dst_unused:UNUSED_PAD src0_sel:DWORD src1_sel:WORD_0
    v_lshlrev_b32_sdwa v110, 3, v127 dst_sel:DWORD dst_unused:UNUSED_PAD src0_sel:DWORD src1_sel:WORD_1
    ds_read_b64 v[108:109], v108
    ds_read_b64 v[110:111], v110
    buffer_load_dwordx4 v[124:127], v69, s[12:15], s20 offen offset:1024 sc1
    s_waitcnt lgkmcnt(8)
    v_smfmac_f32_16x16x64_bf16 v[28:31], v[64:67], v[88:95], v68
    s_setprio 2
    v_exp_f32 v165, v165
    v_add_f32 v162, v162, v163
    v_pk_mul_f32 v[170:171], v[170:171], v[20:21]
    v_exp_f32 v166, v166
    buffer_store_dword v162, v70, s[12:15], s35 offen offset:640 sc1
    v_pk_fma_f32 v[164:165], v[164:165], v[134:135], v[134:135]
    v_exp_f32 v167, v167
    v_pk_fma_f32 v[172:173], v[172:173], v[128:129], v[130:131]
    s_waitcnt vmcnt(4)
    v_lshlrev_b32_sdwa v88, 3, v116 dst_sel:DWORD dst_unused:UNUSED_PAD src0_sel:DWORD src1_sel:WORD_0
    v_lshlrev_b32_sdwa v90, 3, v116 dst_sel:DWORD dst_unused:UNUSED_PAD src0_sel:DWORD src1_sel:WORD_1
    ds_read_b64 v[88:89], v88
    ds_read_b64 v[90:91], v90
    v_lshlrev_b32_sdwa v92, 3, v117 dst_sel:DWORD dst_unused:UNUSED_PAD src0_sel:DWORD src1_sel:WORD_0
    v_lshlrev_b32_sdwa v94, 3, v117 dst_sel:DWORD dst_unused:UNUSED_PAD src0_sel:DWORD src1_sel:WORD_1
    ds_read_b64 v[92:93], v92
    ds_read_b64 v[94:95], v94
    s_waitcnt lgkmcnt(8)
    v_smfmac_f32_16x16x64_bf16 v[32:35], v[64:67], v[96:103], v68
    v_rcp_f32 v164, v164
    v_pk_fma_f32 v[166:167], v[166:167], v[136:137], v[136:137]
    v_pk_mul_f32 v[172:173], v[172:173], v[22:23]
    v_rcp_f32 v165, v165
    v_pk_mul_f32 v[140:141], v[24:25], v[24:25]
    v_pk_mul_f32 v[142:143], v[26:27], v[26:27]
    v_rcp_f32 v166, v166
    v_pk_mul_f32 v[168:169], v[16:17], v[164:165]
    v_lshlrev_b32_sdwa v96, 3, v118 dst_sel:DWORD dst_unused:UNUSED_PAD src0_sel:DWORD src1_sel:WORD_0
    v_lshlrev_b32_sdwa v98, 3, v118 dst_sel:DWORD dst_unused:UNUSED_PAD src0_sel:DWORD src1_sel:WORD_1
    ds_read_b64 v[96:97], v96
    ds_read_b64 v[98:99], v98
    v_lshlrev_b32_sdwa v100, 3, v119 dst_sel:DWORD dst_unused:UNUSED_PAD src0_sel:DWORD src1_sel:WORD_0
    v_lshlrev_b32_sdwa v102, 3, v119 dst_sel:DWORD dst_unused:UNUSED_PAD src0_sel:DWORD src1_sel:WORD_1
    ds_read_b64 v[100:101], v100
    ds_read_b64 v[102:103], v102
    buffer_load_dwordx4 v[116:119], v69, s[12:15], s41 offen offset:1024 sc1
    s_waitcnt lgkmcnt(8)
    v_smfmac_f32_16x16x64_bf16 v[36:39], v[64:67], v[104:111], v68
    v_rcp_f32 v167, v167
    v_pk_fma_f32 v[140:141], v[140:141], v[128:129], v[130:131]
    v_pk_fma_f32 v[142:143], v[142:143], v[128:129], v[130:131]
    v_exp_f32 v170, v170
    v_pk_fma_f32 v[168:169], v[18:19], v[166:167], v[168:169]
    v_pk_mul_f32 v[140:141], v[140:141], v[24:25]
    v_exp_f32 v171, v171
    v_add_f32 v168, v168, v169
    s_waitcnt vmcnt(3)
    v_lshlrev_b32_sdwa v104, 3, v120 dst_sel:DWORD dst_unused:UNUSED_PAD src0_sel:DWORD src1_sel:WORD_0
    v_lshlrev_b32_sdwa v106, 3, v120 dst_sel:DWORD dst_unused:UNUSED_PAD src0_sel:DWORD src1_sel:WORD_1
    ds_read_b64 v[104:105], v104
    ds_read_b64 v[106:107], v106
    v_lshlrev_b32_sdwa v108, 3, v121 dst_sel:DWORD dst_unused:UNUSED_PAD src0_sel:DWORD src1_sel:WORD_0
    v_lshlrev_b32_sdwa v110, 3, v121 dst_sel:DWORD dst_unused:UNUSED_PAD src0_sel:DWORD src1_sel:WORD_1
    ds_read_b64 v[108:109], v108
    ds_read_b64 v[110:111], v110
    s_waitcnt lgkmcnt(8)
    v_smfmac_f32_16x16x64_bf16 v[32:35], v[64:67], v[88:95], v68
    v_exp_f32 v172, v172
    buffer_store_dword v168, v70, s[12:15], s35 offen offset:1024 sc1
    v_pk_fma_f32 v[170:171], v[170:171], v[134:135], v[134:135]
    v_exp_f32 v173, v173
    v_pk_mul_f32 v[142:143], v[142:143], v[26:27]
    v_pk_mul_f32 v[146:147], v[28:29], v[28:29]
    v_rcp_f32 v170, v170
    v_pk_fma_f32 v[172:173], v[172:173], v[136:137], v[136:137]
    v_lshlrev_b32_sdwa v88, 3, v122 dst_sel:DWORD dst_unused:UNUSED_PAD src0_sel:DWORD src1_sel:WORD_0
    v_lshlrev_b32_sdwa v90, 3, v122 dst_sel:DWORD dst_unused:UNUSED_PAD src0_sel:DWORD src1_sel:WORD_1
    ds_read_b64 v[88:89], v88
    ds_read_b64 v[90:91], v90
    v_lshlrev_b32_sdwa v92, 3, v123 dst_sel:DWORD dst_unused:UNUSED_PAD src0_sel:DWORD src1_sel:WORD_0
    v_lshlrev_b32_sdwa v94, 3, v123 dst_sel:DWORD dst_unused:UNUSED_PAD src0_sel:DWORD src1_sel:WORD_1
    ds_read_b64 v[92:93], v92
    ds_read_b64 v[94:95], v94
    buffer_load_dwordx4 v[120:123], v69, s[12:15], s45 offen offset:1024 sc1
    s_waitcnt lgkmcnt(8)
    v_smfmac_f32_16x16x64_bf16 v[36:39], v[64:67], v[96:103], v68
    v_rcp_f32 v171, v171
    v_pk_fma_f32 v[146:147], v[146:147], v[128:129], v[130:131]
    v_pk_mul_f32 v[148:149], v[30:31], v[30:31]
    v_rcp_f32 v172, v172
    v_pk_mul_f32 v[174:175], v[20:21], v[170:171]
    v_pk_mul_f32 v[146:147], v[146:147], v[28:29]
    v_rcp_f32 v173, v173
    v_pk_fma_f32 v[148:149], v[148:149], v[128:129], v[130:131]
    s_waitcnt vmcnt(4)
    v_lshlrev_b32_sdwa v96, 3, v124 dst_sel:DWORD dst_unused:UNUSED_PAD src0_sel:DWORD src1_sel:WORD_0
    v_lshlrev_b32_sdwa v98, 3, v124 dst_sel:DWORD dst_unused:UNUSED_PAD src0_sel:DWORD src1_sel:WORD_1
    ds_read_b64 v[96:97], v96
    ds_read_b64 v[98:99], v98
    v_lshlrev_b32_sdwa v100, 3, v125 dst_sel:DWORD dst_unused:UNUSED_PAD src0_sel:DWORD src1_sel:WORD_0
    v_lshlrev_b32_sdwa v102, 3, v125 dst_sel:DWORD dst_unused:UNUSED_PAD src0_sel:DWORD src1_sel:WORD_1
    ds_read_b64 v[100:101], v100
    ds_read_b64 v[102:103], v102
    s_waitcnt lgkmcnt(8)
    v_smfmac_f32_16x16x64_bf16 v[32:35], v[64:67], v[104:111], v68
    v_exp_f32 v140, v140
    v_pk_fma_f32 v[174:175], v[22:23], v[172:173], v[174:175]
    v_pk_mul_f32 v[148:149], v[148:149], v[30:31]
    v_exp_f32 v141, v141
    v_add_f32 v174, v174, v175
    v_exp_f32 v142, v142
    buffer_store_dword v174, v70, s[12:15], s35 offen offset:1152 sc1
    v_pk_fma_f32 v[140:141], v[140:141], v[134:135], v[134:135]
    v_lshlrev_b32_sdwa v104, 3, v126 dst_sel:DWORD dst_unused:UNUSED_PAD src0_sel:DWORD src1_sel:WORD_0
    v_lshlrev_b32_sdwa v106, 3, v126 dst_sel:DWORD dst_unused:UNUSED_PAD src0_sel:DWORD src1_sel:WORD_1
    ds_read_b64 v[104:105], v104
    ds_read_b64 v[106:107], v106
    v_lshlrev_b32_sdwa v108, 3, v127 dst_sel:DWORD dst_unused:UNUSED_PAD src0_sel:DWORD src1_sel:WORD_0
    v_lshlrev_b32_sdwa v110, 3, v127 dst_sel:DWORD dst_unused:UNUSED_PAD src0_sel:DWORD src1_sel:WORD_1
    ds_read_b64 v[108:109], v108
    ds_read_b64 v[110:111], v110
    buffer_load_dwordx4 v[124:127], v69, s[12:15], s20 offen offset:2048 sc1
    s_waitcnt lgkmcnt(8)
    v_smfmac_f32_16x16x64_bf16 v[36:39], v[64:67], v[88:95], v68
    v_rcp_f32 v140, v140
    v_pk_mul_f32 v[152:153], v[32:33], v[32:33]
    v_pk_mul_f32 v[154:155], v[34:35], v[34:35]
    v_rcp_f32 v141, v141
    v_pk_fma_f32 v[152:153], v[152:153], v[128:129], v[130:131]
    v_pk_fma_f32 v[154:155], v[154:155], v[128:129], v[130:131]
    v_exp_f32 v143, v143
    v_pk_mul_f32 v[144:145], v[24:25], v[140:141]
    s_waitcnt vmcnt(4)
    v_lshlrev_b32_sdwa v88, 3, v116 dst_sel:DWORD dst_unused:UNUSED_PAD src0_sel:DWORD src1_sel:WORD_0
    v_lshlrev_b32_sdwa v90, 3, v116 dst_sel:DWORD dst_unused:UNUSED_PAD src0_sel:DWORD src1_sel:WORD_1
    ds_read_b64 v[88:89], v88
    ds_read_b64 v[90:91], v90
    v_lshlrev_b32_sdwa v92, 3, v117 dst_sel:DWORD dst_unused:UNUSED_PAD src0_sel:DWORD src1_sel:WORD_0
    v_lshlrev_b32_sdwa v94, 3, v117 dst_sel:DWORD dst_unused:UNUSED_PAD src0_sel:DWORD src1_sel:WORD_1
    ds_read_b64 v[92:93], v92
    ds_read_b64 v[94:95], v94
    s_waitcnt lgkmcnt(8)
    v_smfmac_f32_16x16x64_bf16 v[40:43], v[64:67], v[96:103], v68
    v_exp_f32 v146, v146
    v_pk_fma_f32 v[142:143], v[142:143], v[136:137], v[136:137]
    v_pk_mul_f32 v[152:153], v[152:153], v[32:33]
    v_rcp_f32 v142, v142
    v_pk_mul_f32 v[154:155], v[154:155], v[34:35]
    v_pk_mul_f32 v[158:159], v[36:37], v[36:37]
    v_rcp_f32 v143, v143
    v_pk_fma_f32 v[158:159], v[158:159], v[128:129], v[130:131]
    v_lshlrev_b32_sdwa v96, 3, v118 dst_sel:DWORD dst_unused:UNUSED_PAD src0_sel:DWORD src1_sel:WORD_0
    v_lshlrev_b32_sdwa v98, 3, v118 dst_sel:DWORD dst_unused:UNUSED_PAD src0_sel:DWORD src1_sel:WORD_1
    ds_read_b64 v[96:97], v96
    ds_read_b64 v[98:99], v98
    v_lshlrev_b32_sdwa v100, 3, v119 dst_sel:DWORD dst_unused:UNUSED_PAD src0_sel:DWORD src1_sel:WORD_0
    v_lshlrev_b32_sdwa v102, 3, v119 dst_sel:DWORD dst_unused:UNUSED_PAD src0_sel:DWORD src1_sel:WORD_1
    ds_read_b64 v[100:101], v100
    ds_read_b64 v[102:103], v102
    buffer_load_dwordx4 v[116:119], v69, s[12:15], s41 offen offset:2048 sc1
    s_waitcnt lgkmcnt(8)
    v_smfmac_f32_16x16x64_bf16 v[44:47], v[64:67], v[104:111], v68
    v_exp_f32 v147, v147
    v_pk_fma_f32 v[144:145], v[26:27], v[142:143], v[144:145]
    v_pk_mul_f32 v[158:159], v[158:159], v[36:37]
    v_exp_f32 v148, v148
    v_add_f32 v144, v144, v145
    v_pk_fma_f32 v[146:147], v[146:147], v[134:135], v[134:135]
    v_exp_f32 v149, v149
    buffer_store_dword v144, v70, s[12:15], s35 offen offset:1536 sc1
    s_waitcnt vmcnt(4)
    v_lshlrev_b32_sdwa v104, 3, v120 dst_sel:DWORD dst_unused:UNUSED_PAD src0_sel:DWORD src1_sel:WORD_0
    v_lshlrev_b32_sdwa v106, 3, v120 dst_sel:DWORD dst_unused:UNUSED_PAD src0_sel:DWORD src1_sel:WORD_1
    ds_read_b64 v[104:105], v104
    ds_read_b64 v[106:107], v106
    v_lshlrev_b32_sdwa v108, 3, v121 dst_sel:DWORD dst_unused:UNUSED_PAD src0_sel:DWORD src1_sel:WORD_0
    v_lshlrev_b32_sdwa v110, 3, v121 dst_sel:DWORD dst_unused:UNUSED_PAD src0_sel:DWORD src1_sel:WORD_1
    ds_read_b64 v[108:109], v108
    ds_read_b64 v[110:111], v110
    s_waitcnt lgkmcnt(8)
    v_smfmac_f32_16x16x64_bf16 v[40:43], v[64:67], v[88:95], v68
    v_rcp_f32 v146, v146
    v_pk_fma_f32 v[148:149], v[148:149], v[136:137], v[136:137]
    v_pk_mul_f32 v[160:161], v[38:39], v[38:39]
    v_rcp_f32 v147, v147
    v_pk_fma_f32 v[160:161], v[160:161], v[128:129], v[130:131]
    v_rcp_f32 v148, v148
    v_pk_mul_f32 v[150:151], v[28:29], v[146:147]
    v_pk_mul_f32 v[160:161], v[160:161], v[38:39]
    v_lshlrev_b32_sdwa v88, 3, v122 dst_sel:DWORD dst_unused:UNUSED_PAD src0_sel:DWORD src1_sel:WORD_0
    v_lshlrev_b32_sdwa v90, 3, v122 dst_sel:DWORD dst_unused:UNUSED_PAD src0_sel:DWORD src1_sel:WORD_1
    ds_read_b64 v[88:89], v88
    ds_read_b64 v[90:91], v90
    v_lshlrev_b32_sdwa v92, 3, v123 dst_sel:DWORD dst_unused:UNUSED_PAD src0_sel:DWORD src1_sel:WORD_0
    v_lshlrev_b32_sdwa v94, 3, v123 dst_sel:DWORD dst_unused:UNUSED_PAD src0_sel:DWORD src1_sel:WORD_1
    ds_read_b64 v[92:93], v92
    ds_read_b64 v[94:95], v94
    buffer_load_dwordx4 v[120:123], v69, s[12:15], s45 offen offset:2048 sc1
    s_waitcnt lgkmcnt(8)
    v_smfmac_f32_16x16x64_bf16 v[44:47], v[64:67], v[96:103], v68
    v_rcp_f32 v149, v149
    v_exp_f32 v152, v152
    v_exp_f32 v153, v153
    v_pk_fma_f32 v[150:151], v[30:31], v[148:149], v[150:151]
    v_exp_f32 v154, v154
    v_add_f32 v150, v150, v151
    v_pk_fma_f32 v[152:153], v[152:153], v[134:135], v[134:135]
    v_exp_f32 v155, v155
    s_waitcnt vmcnt(3)
    v_lshlrev_b32_sdwa v96, 3, v124 dst_sel:DWORD dst_unused:UNUSED_PAD src0_sel:DWORD src1_sel:WORD_0
    v_lshlrev_b32_sdwa v98, 3, v124 dst_sel:DWORD dst_unused:UNUSED_PAD src0_sel:DWORD src1_sel:WORD_1
    ds_read_b64 v[96:97], v96
    ds_read_b64 v[98:99], v98
    v_lshlrev_b32_sdwa v100, 3, v125 dst_sel:DWORD dst_unused:UNUSED_PAD src0_sel:DWORD src1_sel:WORD_0
    v_lshlrev_b32_sdwa v102, 3, v125 dst_sel:DWORD dst_unused:UNUSED_PAD src0_sel:DWORD src1_sel:WORD_1
    ds_read_b64 v[100:101], v100
    ds_read_b64 v[102:103], v102
    s_waitcnt lgkmcnt(8)
    v_smfmac_f32_16x16x64_bf16 v[40:43], v[64:67], v[104:111], v68
    v_rcp_f32 v152, v152
    buffer_store_dword v150, v70, s[12:15], s35 offen offset:1664 sc1
    v_pk_fma_f32 v[154:155], v[154:155], v[136:137], v[136:137]
    v_rcp_f32 v153, v153
    v_rcp_f32 v154, v154
    v_rcp_f32 v155, v155
    v_pk_mul_f32 v[156:157], v[32:33], v[152:153]
    v_exp_f32 v158, v158
    v_lshlrev_b32_sdwa v104, 3, v126 dst_sel:DWORD dst_unused:UNUSED_PAD src0_sel:DWORD src1_sel:WORD_0
    v_lshlrev_b32_sdwa v106, 3, v126 dst_sel:DWORD dst_unused:UNUSED_PAD src0_sel:DWORD src1_sel:WORD_1
    ds_read_b64 v[104:105], v104
    ds_read_b64 v[106:107], v106
    v_lshlrev_b32_sdwa v108, 3, v127 dst_sel:DWORD dst_unused:UNUSED_PAD src0_sel:DWORD src1_sel:WORD_0
    v_lshlrev_b32_sdwa v110, 3, v127 dst_sel:DWORD dst_unused:UNUSED_PAD src0_sel:DWORD src1_sel:WORD_1
    ds_read_b64 v[108:109], v108
    ds_read_b64 v[110:111], v110
    buffer_load_dwordx4 v[124:127], v69, s[12:15], s20 offen offset:3072 sc1
    s_waitcnt lgkmcnt(8)
    v_smfmac_f32_16x16x64_bf16 v[44:47], v[64:67], v[88:95], v68
    v_exp_f32 v159, v159
    v_pk_fma_f32 v[156:157], v[34:35], v[154:155], v[156:157]
    v_pk_mul_f32 v[164:165], v[40:41], v[40:41]
    v_exp_f32 v160, v160
    v_add_f32 v156, v156, v157
    v_pk_fma_f32 v[158:159], v[158:159], v[134:135], v[134:135]
    v_exp_f32 v161, v161
    buffer_store_dword v156, v70, s[12:15], s35 offen offset:2048 sc1
    s_waitcnt vmcnt(5)
    v_lshlrev_b32_sdwa v88, 3, v116 dst_sel:DWORD dst_unused:UNUSED_PAD src0_sel:DWORD src1_sel:WORD_0
    v_lshlrev_b32_sdwa v90, 3, v116 dst_sel:DWORD dst_unused:UNUSED_PAD src0_sel:DWORD src1_sel:WORD_1
    ds_read_b64 v[88:89], v88
    ds_read_b64 v[90:91], v90
    v_lshlrev_b32_sdwa v92, 3, v117 dst_sel:DWORD dst_unused:UNUSED_PAD src0_sel:DWORD src1_sel:WORD_0
    v_lshlrev_b32_sdwa v94, 3, v117 dst_sel:DWORD dst_unused:UNUSED_PAD src0_sel:DWORD src1_sel:WORD_1
    ds_read_b64 v[92:93], v92
    ds_read_b64 v[94:95], v94
    s_waitcnt lgkmcnt(8)
    v_smfmac_f32_16x16x64_bf16 v[48:51], v[64:67], v[96:103], v68
    v_rcp_f32 v158, v158
    v_pk_fma_f32 v[160:161], v[160:161], v[136:137], v[136:137]
    v_pk_fma_f32 v[164:165], v[164:165], v[128:129], v[130:131]
    v_rcp_f32 v159, v159
    v_pk_mul_f32 v[164:165], v[164:165], v[40:41]
    v_pk_mul_f32 v[166:167], v[42:43], v[42:43]
    v_rcp_f32 v160, v160
    v_pk_mul_f32 v[162:163], v[36:37], v[158:159]
    v_lshlrev_b32_sdwa v96, 3, v118 dst_sel:DWORD dst_unused:UNUSED_PAD src0_sel:DWORD src1_sel:WORD_0
    v_lshlrev_b32_sdwa v98, 3, v118 dst_sel:DWORD dst_unused:UNUSED_PAD src0_sel:DWORD src1_sel:WORD_1
    ds_read_b64 v[96:97], v96
    ds_read_b64 v[98:99], v98
    v_lshlrev_b32_sdwa v100, 3, v119 dst_sel:DWORD dst_unused:UNUSED_PAD src0_sel:DWORD src1_sel:WORD_0
    v_lshlrev_b32_sdwa v102, 3, v119 dst_sel:DWORD dst_unused:UNUSED_PAD src0_sel:DWORD src1_sel:WORD_1
    ds_read_b64 v[100:101], v100
    ds_read_b64 v[102:103], v102
    buffer_load_dwordx4 v[116:119], v69, s[12:15], s41 offen offset:3072 sc1
    s_waitcnt lgkmcnt(8)
    v_smfmac_f32_16x16x64_bf16 v[52:55], v[64:67], v[104:111], v68
    s_setprio 1
    v_rcp_f32 v161, v161
    v_pk_fma_f32 v[166:167], v[166:167], v[128:129], v[130:131]
    v_pk_mul_f32 v[170:171], v[44:45], v[44:45]
    v_exp_f32 v164, v164
    v_pk_fma_f32 v[162:163], v[38:39], v[160:161], v[162:163]
    v_pk_mul_f32 v[166:167], v[166:167], v[42:43]
    v_exp_f32 v165, v165
    v_add_f32 v162, v162, v163
    s_waitcnt vmcnt(4)
    v_lshlrev_b32_sdwa v104, 3, v120 dst_sel:DWORD dst_unused:UNUSED_PAD src0_sel:DWORD src1_sel:WORD_0
    v_lshlrev_b32_sdwa v106, 3, v120 dst_sel:DWORD dst_unused:UNUSED_PAD src0_sel:DWORD src1_sel:WORD_1
    ds_read_b64 v[104:105], v104
    ds_read_b64 v[106:107], v106
    v_lshlrev_b32_sdwa v108, 3, v121 dst_sel:DWORD dst_unused:UNUSED_PAD src0_sel:DWORD src1_sel:WORD_0
    v_lshlrev_b32_sdwa v110, 3, v121 dst_sel:DWORD dst_unused:UNUSED_PAD src0_sel:DWORD src1_sel:WORD_1
    ds_read_b64 v[108:109], v108
    ds_read_b64 v[110:111], v110
    s_waitcnt lgkmcnt(8)
    v_smfmac_f32_16x16x64_bf16 v[48:51], v[64:67], v[88:95], v68
    v_exp_f32 v166, v166
    buffer_store_dword v162, v70, s[12:15], s35 offen offset:2176 sc1
    v_pk_fma_f32 v[164:165], v[164:165], v[134:135], v[134:135]
    v_exp_f32 v167, v167
    v_pk_fma_f32 v[170:171], v[170:171], v[128:129], v[130:131]
    v_pk_mul_f32 v[172:173], v[46:47], v[46:47]
    v_rcp_f32 v164, v164
    v_pk_fma_f32 v[166:167], v[166:167], v[136:137], v[136:137]
    v_lshlrev_b32_sdwa v88, 3, v122 dst_sel:DWORD dst_unused:UNUSED_PAD src0_sel:DWORD src1_sel:WORD_0
    v_lshlrev_b32_sdwa v90, 3, v122 dst_sel:DWORD dst_unused:UNUSED_PAD src0_sel:DWORD src1_sel:WORD_1
    ds_read_b64 v[88:89], v88
    ds_read_b64 v[90:91], v90
    v_lshlrev_b32_sdwa v92, 3, v123 dst_sel:DWORD dst_unused:UNUSED_PAD src0_sel:DWORD src1_sel:WORD_0
    v_lshlrev_b32_sdwa v94, 3, v123 dst_sel:DWORD dst_unused:UNUSED_PAD src0_sel:DWORD src1_sel:WORD_1
    ds_read_b64 v[92:93], v92
    ds_read_b64 v[94:95], v94
    buffer_load_dwordx4 v[120:123], v69, s[12:15], s45 offen offset:3072 sc1
    s_waitcnt lgkmcnt(8)
    v_smfmac_f32_16x16x64_bf16 v[52:55], v[64:67], v[96:103], v68
    v_rcp_f32 v165, v165
    v_pk_mul_f32 v[170:171], v[170:171], v[44:45]
    v_pk_fma_f32 v[172:173], v[172:173], v[128:129], v[130:131]
    v_rcp_f32 v166, v166
    v_pk_mul_f32 v[168:169], v[40:41], v[164:165]
    v_pk_mul_f32 v[172:173], v[172:173], v[46:47]
    v_rcp_f32 v167, v167
    v_exp_f32 v170, v170
    s_waitcnt vmcnt(4)
    v_lshlrev_b32_sdwa v96, 3, v124 dst_sel:DWORD dst_unused:UNUSED_PAD src0_sel:DWORD src1_sel:WORD_0
    v_lshlrev_b32_sdwa v98, 3, v124 dst_sel:DWORD dst_unused:UNUSED_PAD src0_sel:DWORD src1_sel:WORD_1
    ds_read_b64 v[96:97], v96
    ds_read_b64 v[98:99], v98
    v_lshlrev_b32_sdwa v100, 3, v125 dst_sel:DWORD dst_unused:UNUSED_PAD src0_sel:DWORD src1_sel:WORD_0
    v_lshlrev_b32_sdwa v102, 3, v125 dst_sel:DWORD dst_unused:UNUSED_PAD src0_sel:DWORD src1_sel:WORD_1
    ds_read_b64 v[100:101], v100
    ds_read_b64 v[102:103], v102
    s_waitcnt lgkmcnt(8)
    v_smfmac_f32_16x16x64_bf16 v[48:51], v[64:67], v[104:111], v68
    v_exp_f32 v171, v171
    v_pk_fma_f32 v[168:169], v[42:43], v[166:167], v[168:169]
    v_exp_f32 v172, v172
    v_add_f32 v168, v168, v169
    v_pk_fma_f32 v[170:171], v[170:171], v[134:135], v[134:135]
    v_exp_f32 v173, v173
    buffer_store_dword v168, v70, s[12:15], s35 offen offset:2560 sc1
    v_rcp_f32 v170, v170
    v_lshlrev_b32_sdwa v104, 3, v126 dst_sel:DWORD dst_unused:UNUSED_PAD src0_sel:DWORD src1_sel:WORD_0
    v_lshlrev_b32_sdwa v106, 3, v126 dst_sel:DWORD dst_unused:UNUSED_PAD src0_sel:DWORD src1_sel:WORD_1
    ds_read_b64 v[104:105], v104
    ds_read_b64 v[106:107], v106
    v_lshlrev_b32_sdwa v108, 3, v127 dst_sel:DWORD dst_unused:UNUSED_PAD src0_sel:DWORD src1_sel:WORD_0
    v_lshlrev_b32_sdwa v110, 3, v127 dst_sel:DWORD dst_unused:UNUSED_PAD src0_sel:DWORD src1_sel:WORD_1
    ds_read_b64 v[108:109], v108
    ds_read_b64 v[110:111], v110
    s_waitcnt lgkmcnt(8)
    v_smfmac_f32_16x16x64_bf16 v[52:55], v[64:67], v[88:95], v68
    v_rcp_f32 v171, v171
    v_pk_fma_f32 v[172:173], v[172:173], v[136:137], v[136:137]
    v_pk_mul_f32 v[140:141], v[48:49], v[48:49]
    v_rcp_f32 v172, v172
    v_pk_mul_f32 v[174:175], v[44:45], v[170:171]
    v_pk_fma_f32 v[140:141], v[140:141], v[128:129], v[130:131]
    v_rcp_f32 v173, v173
    v_pk_mul_f32 v[140:141], v[140:141], v[48:49]
    s_waitcnt vmcnt(3)
    v_lshlrev_b32_sdwa v88, 3, v116 dst_sel:DWORD dst_unused:UNUSED_PAD src0_sel:DWORD src1_sel:WORD_0
    v_lshlrev_b32_sdwa v90, 3, v116 dst_sel:DWORD dst_unused:UNUSED_PAD src0_sel:DWORD src1_sel:WORD_1
    ds_read_b64 v[88:89], v88
    ds_read_b64 v[90:91], v90
    v_lshlrev_b32_sdwa v92, 3, v117 dst_sel:DWORD dst_unused:UNUSED_PAD src0_sel:DWORD src1_sel:WORD_0
    v_lshlrev_b32_sdwa v94, 3, v117 dst_sel:DWORD dst_unused:UNUSED_PAD src0_sel:DWORD src1_sel:WORD_1
    ds_read_b64 v[92:93], v92
    ds_read_b64 v[94:95], v94
    s_waitcnt lgkmcnt(8)
    v_smfmac_f32_16x16x64_bf16 v[56:59], v[64:67], v[96:103], v68
    v_exp_f32 v140, v140
    v_pk_fma_f32 v[174:175], v[46:47], v[172:173], v[174:175]
    v_pk_mul_f32 v[142:143], v[50:51], v[50:51]
    v_exp_f32 v141, v141
    v_add_f32 v174, v174, v175
    v_pk_fma_f32 v[142:143], v[142:143], v[128:129], v[130:131]
    buffer_store_dword v174, v70, s[12:15], s35 offen offset:2688 sc1
    v_pk_fma_f32 v[140:141], v[140:141], v[134:135], v[134:135]
    v_lshlrev_b32_sdwa v96, 3, v118 dst_sel:DWORD dst_unused:UNUSED_PAD src0_sel:DWORD src1_sel:WORD_0
    v_lshlrev_b32_sdwa v98, 3, v118 dst_sel:DWORD dst_unused:UNUSED_PAD src0_sel:DWORD src1_sel:WORD_1
    ds_read_b64 v[96:97], v96
    ds_read_b64 v[98:99], v98
    v_lshlrev_b32_sdwa v100, 3, v119 dst_sel:DWORD dst_unused:UNUSED_PAD src0_sel:DWORD src1_sel:WORD_0
    v_lshlrev_b32_sdwa v102, 3, v119 dst_sel:DWORD dst_unused:UNUSED_PAD src0_sel:DWORD src1_sel:WORD_1
    ds_read_b64 v[100:101], v100
    ds_read_b64 v[102:103], v102
    s_waitcnt lgkmcnt(8)
    v_smfmac_f32_16x16x64_bf16 v[60:63], v[64:67], v[104:111], v68
    v_rcp_f32 v140, v140
    v_pk_mul_f32 v[142:143], v[142:143], v[50:51]
    v_pk_mul_f32 v[146:147], v[52:53], v[52:53]
    v_rcp_f32 v141, v141
    v_pk_fma_f32 v[146:147], v[146:147], v[128:129], v[130:131]
    v_pk_mul_f32 v[148:149], v[54:55], v[54:55]
    v_exp_f32 v142, v142
    v_pk_mul_f32 v[144:145], v[48:49], v[140:141]
    s_waitcnt vmcnt(2)
    v_lshlrev_b32_sdwa v104, 3, v120 dst_sel:DWORD dst_unused:UNUSED_PAD src0_sel:DWORD src1_sel:WORD_0
    v_lshlrev_b32_sdwa v106, 3, v120 dst_sel:DWORD dst_unused:UNUSED_PAD src0_sel:DWORD src1_sel:WORD_1
    ds_read_b64 v[104:105], v104
    ds_read_b64 v[106:107], v106
    v_lshlrev_b32_sdwa v108, 3, v121 dst_sel:DWORD dst_unused:UNUSED_PAD src0_sel:DWORD src1_sel:WORD_0
    v_lshlrev_b32_sdwa v110, 3, v121 dst_sel:DWORD dst_unused:UNUSED_PAD src0_sel:DWORD src1_sel:WORD_1
    ds_read_b64 v[108:109], v108
    ds_read_b64 v[110:111], v110
    s_waitcnt lgkmcnt(8)
    v_smfmac_f32_16x16x64_bf16 v[56:59], v[64:67], v[88:95], v68
    v_exp_f32 v143, v143
    v_pk_mul_f32 v[146:147], v[146:147], v[52:53]
    v_pk_fma_f32 v[148:149], v[148:149], v[128:129], v[130:131]
    v_exp_f32 v146, v146
    v_pk_fma_f32 v[142:143], v[142:143], v[136:137], v[136:137]
    v_pk_mul_f32 v[148:149], v[148:149], v[54:55]
    v_rcp_f32 v142, v142
    v_rcp_f32 v143, v143
    v_lshlrev_b32_sdwa v88, 3, v122 dst_sel:DWORD dst_unused:UNUSED_PAD src0_sel:DWORD src1_sel:WORD_0
    v_lshlrev_b32_sdwa v90, 3, v122 dst_sel:DWORD dst_unused:UNUSED_PAD src0_sel:DWORD src1_sel:WORD_1
    ds_read_b64 v[88:89], v88
    ds_read_b64 v[90:91], v90
    v_lshlrev_b32_sdwa v92, 3, v123 dst_sel:DWORD dst_unused:UNUSED_PAD src0_sel:DWORD src1_sel:WORD_0
    v_lshlrev_b32_sdwa v94, 3, v123 dst_sel:DWORD dst_unused:UNUSED_PAD src0_sel:DWORD src1_sel:WORD_1
    ds_read_b64 v[92:93], v92
    ds_read_b64 v[94:95], v94
    s_waitcnt lgkmcnt(8)
    v_smfmac_f32_16x16x64_bf16 v[60:63], v[64:67], v[96:103], v68
    s_setprio 0
    v_exp_f32 v147, v147
    v_pk_fma_f32 v[144:145], v[50:51], v[142:143], v[144:145]
    v_exp_f32 v148, v148
    v_add_f32 v144, v144, v145
    v_pk_fma_f32 v[146:147], v[146:147], v[134:135], v[134:135]
    v_exp_f32 v149, v149
    buffer_store_dword v144, v70, s[12:15], s35 offen offset:3072 sc1
    v_rcp_f32 v146, v146
    s_waitcnt lgkmcnt(4)
    v_smfmac_f32_16x16x64_bf16 v[56:59], v[64:67], v[104:111], v68
    v_rcp_f32 v147, v147
    v_pk_fma_f32 v[148:149], v[148:149], v[136:137], v[136:137]
    s_waitcnt lgkmcnt(0)
    v_smfmac_f32_16x16x64_bf16 v[60:63], v[64:67], v[88:95], v68
    v_rcp_f32 v148, v148
    v_pk_mul_f32 v[150:151], v[52:53], v[146:147]
    v_rcp_f32 v149, v149
    s_nop 0
    s_nop 0
    v_pk_fma_f32 v[150:151], v[54:55], v[148:149], v[150:151]
    s_nop 0
    v_add_f32 v150, v150, v151
    v_pk_mul_f32 v[152:153], v[56:57], v[56:57]
    buffer_store_dword v150, v70, s[12:15], s35 offen offset:3200 sc1
    v_pk_fma_f32 v[152:153], v[152:153], v[128:129], v[130:131]
    v_pk_mul_f32 v[154:155], v[58:59], v[58:59]
    v_pk_mul_f32 v[152:153], v[152:153], v[56:57]
    v_pk_fma_f32 v[154:155], v[154:155], v[128:129], v[130:131]
    v_exp_f32 v152, v152
    v_pk_mul_f32 v[154:155], v[154:155], v[58:59]
    v_pk_mul_f32 v[158:159], v[60:61], v[60:61]
    v_exp_f32 v153, v153
    v_pk_fma_f32 v[158:159], v[158:159], v[128:129], v[130:131]
    v_pk_mul_f32 v[160:161], v[62:63], v[62:63]
    v_exp_f32 v154, v154
    v_pk_fma_f32 v[152:153], v[152:153], v[134:135], v[134:135]
    v_pk_mul_f32 v[158:159], v[158:159], v[60:61]
    v_rcp_f32 v152, v152
    v_pk_fma_f32 v[160:161], v[160:161], v[128:129], v[130:131]
    v_rcp_f32 v153, v153
    v_pk_mul_f32 v[160:161], v[160:161], v[62:63]
    v_exp_f32 v155, v155
    v_pk_mul_f32 v[156:157], v[56:57], v[152:153]
    v_exp_f32 v158, v158
    v_pk_fma_f32 v[154:155], v[154:155], v[136:137], v[136:137]
    v_exp_f32 v159, v159
    v_rcp_f32 v154, v154
    v_rcp_f32 v155, v155
    v_pk_fma_f32 v[158:159], v[158:159], v[134:135], v[134:135]
    v_exp_f32 v160, v160
    v_pk_fma_f32 v[156:157], v[58:59], v[154:155], v[156:157]
    v_rcp_f32 v158, v158
    v_add_f32 v156, v156, v157
    v_rcp_f32 v159, v159
    buffer_store_dword v156, v70, s[12:15], s35 offen offset:3584 sc1
    v_exp_f32 v161, v161
    v_pk_mul_f32 v[162:163], v[60:61], v[158:159]
    s_nop 0
    v_pk_fma_f32 v[160:161], v[160:161], v[136:137], v[136:137]
    s_nop 0
    v_rcp_f32 v160, v160
    v_rcp_f32 v161, v161
    s_nop 0
    s_nop 0
    v_pk_fma_f32 v[162:163], v[62:63], v[160:161], v[162:163]
    s_nop 0
    v_add_f32 v162, v162, v163
    s_nop 0
    buffer_store_dword v162, v70, s[12:15], s35 offen offset:3712 sc1
k1_kernel_end:
    s_endpgm
k1_kernel_main:
    s_setprio 3
    s_mov_b32 s16, s4
    s_and_b32 s17, s5, 0xffff
    s_mov_b32 s20, s6
    s_and_b32 s21, s7, 0xffff
    s_mov_b32 s28, s10
    s_and_b32 s29, s11, 0xffff
    s_mov_b32 s32, s12
    s_and_b32 s33, s13, 0xffff
    s_and_b32 s13, s13, 0xffff
    s_and_b32 s53, s53, 0xffff

    v_and_b32 v5, 15, v255
    v_lshrrev_b32 v6, 4, v255
    v_and_b32 v7, 3, v255
    v_bfe_u32 v8, v255, 2, 2
    v_lshl_add_u32 v9, v7, 2, v8
    v_cmp_eq_u32 s[46:47], 0, v7
    s_movk_i32 s45, 200
    v_mov_b32 v10, 144384
    v_mad_u32_u24 v11, v9, s45, v10
    v_and_b32 v188, 48, v255
    v_add_u32 v128, v11, v188
    v_mul_u32_u24 v12, 6400, v6
    v_add_u32 v132, v11, v12
    v_and_b32 v12, 16, v255
    v_add_u32 v10, v10, v12
    v_add_u32 v11, v11, v12
    v_and_b32 v12, 32, v255
    v_mul_u32_u24 v12, 100, v12
    v_add_u32 v131, v11, v12
    v_and_b32 v12, 8, v255
    v_lshl_add_u32 v13, v7, 1, v12
    v_and_b32 v14, 1, v8
    v_add_u32 v13, v13, v14
    v_lshrrev_b32 v14, 5, v255
    v_lshl_add_u32 v14, v13, 1, v14
    v_mad_u32_u24 v129, v14, s45, v10
    v_lshl_add_u32 v130, v12, 2, v129
    v_lshlrev_b32 v15, 2, v6
    v_sub_u32 v13, v13, v15
    v_lshrrev_b32 v14, 1, v9
    v_sub_u32 v14, v14, v15
    v_sub_u32 v15, v5, v15
    v_and_b32 v12, 1, v9
    v_lshlrev_b32 v12, 4, v12
    v_mov_b32 v16, 0x3f80
    v_lshlrev_b32 v12, v12, v16
    v_mov_b32 v17, 0x3f800000

    v_cmp_eq_u32 vcc, 0, v13
    v_cndmask_b32 v120, 0, v16, vcc
    v_cmp_eq_u32 vcc, 0, v14
    v_cndmask_b32 v112, 0, v12, vcc
    v_cmp_eq_u32 vcc, -8, v14
    v_cndmask_b32 v116, 0, v12, vcc
    v_cmp_eq_u32 vcc, 0, v15
    v_cndmask_b32 v176, 0, v17, vcc
    v_lshlrev_b32 v124, 16, v120

    v_cmp_eq_u32 vcc, 1, v13
    v_cndmask_b32 v121, 0, v16, vcc
    v_cmp_eq_u32 vcc, 1, v14
    v_cndmask_b32 v113, 0, v12, vcc
    v_cmp_eq_u32 vcc, -7, v14
    v_cndmask_b32 v117, 0, v12, vcc
    v_cmp_eq_u32 vcc, 1, v15
    v_cndmask_b32 v177, 0, v17, vcc
    v_lshlrev_b32 v125, 16, v121

    v_cmp_eq_u32 vcc, 2, v13
    v_cndmask_b32 v122, 0, v16, vcc
    v_cmp_eq_u32 vcc, 2, v14
    v_cndmask_b32 v114, 0, v12, vcc
    v_cmp_eq_u32 vcc, -6, v14
    v_cndmask_b32 v118, 0, v12, vcc
    v_cmp_eq_u32 vcc, 2, v15
    v_cndmask_b32 v178, 0, v17, vcc
    v_lshlrev_b32 v126, 16, v122

    v_cmp_eq_u32 vcc, 3, v13
    v_cndmask_b32 v123, 0, v16, vcc
    v_cmp_eq_u32 vcc, 3, v14
    v_cndmask_b32 v115, 0, v12, vcc
    v_cmp_eq_u32 vcc, -5, v14
    v_cndmask_b32 v119, 0, v12, vcc
    v_cmp_eq_u32 vcc, 3, v15
    v_cndmask_b32 v179, 0, v17, vcc
    v_lshlrev_b32 v127, 16, v123

    s_mul_i32 s45, s3, 36864
    s_add_u32 s45, s45, 128
    s_movk_i32 s57, 144
    v_mov_b32 v10, s45
    v_mad_u32_u24 v189, v5, s57, v10
    v_mad_u32_u24 v191, v255, s57, v10
    v_add_u32 v191, 12, v191
    v_cmp_lt_u32 vcc, 24, v255
    v_subrev_u32 v11, 25, v255
    v_cndmask_b32 v11, v255, v11, vcc
    v_add_u32 v12, 2304, v10
    v_cndmask_b32 v10, v10, v12, vcc
    v_and_b32 v12, 3, v11
    v_mad_u32_u24 v10, v12, s57, v10
    v_lshrrev_b32 v11, 2, v11
    v_lshl_add_u32 v190, v11, 1, v10
    v_cmp_gt_u32 s[48:49], 50, v255
    v_mov_b32 v192, 0xdddddddd
    v_mov_b32 v193, 1000
    s_mov_b32 s60, 0xff00ff00
    s_mov_b32 s61, 0xff00ff00
    s_mov_b32 s62, -1
    s_mov_b32 s63, 0xffff

    s_waitcnt vmcnt(4)

    s_mov_b64 exec, 1
    ds_add_u32 v252, v253 offset:0
    s_mov_b64 exec, -1

k1_kernel_wf1:

    ds_read_b32 v251, v252 offset:0
    s_waitcnt lgkmcnt(0)
    v_readfirstlane_b32 s45, v251
    s_cmp_lt_u32 s45, 4
    s_cbranch_scc1 k1_kernel_wf1

    v_mov_b32 v72, 0
    v_mov_b32 v73, 0
    v_mov_b32 v74, 0
    v_mov_b32 v75, 0
    s_mov_b64 exec, s[62:63]
    ds_read_b64 v[72:73], v132 offset:192
    ds_read_b64 v[74:75], v132 offset:3392
    s_mov_b64 exec, -1
    ds_read_b64 v[76:77], v128 offset:16160
    ds_read_b64 v[78:79], v128 offset:16168
    ds_read_b64 v[80:81], v128 offset:0
    ds_read_b64 v[82:83], v128 offset:8
    ds_read_b64 v[84:85], v131 offset:0
    ds_read_b64 v[86:87], v131 offset:8
    s_waitcnt vmcnt(3)
    s_waitcnt lgkmcnt(4)
    v_mfma_f32_16x16x32_bf16 v[64:67], v[112:115], v[72:75], 0
    ds_read_b64 v[88:89], v128 offset:3232
    ds_read_b64 v[90:91], v128 offset:3240
    v_mfma_f32_16x16x32_bf16 v[68:71], v[116:119], v[72:75], 0
    v_mfma_f32_16x16x32_bf16 v[60:63], v[112:115], v[76:79], 0
    v_mfma_f32_16x16x32_bf16 v[64:67], v[212:215], v[112:115], v[64:67]
    v_mov_b32 v92, 0
    v_mov_b32 v93, 0
    v_mov_b32 v94, 0
    v_mov_b32 v95, 0
    s_mov_b64 exec, s[60:61]
    ds_read_b64 v[92:93], v129 offset:3232
    ds_read_b64 v[94:95], v129 offset:3240
    s_mov_b64 exec, -1
    v_mfma_f32_16x16x32_bf16 v[68:71], v[212:215], v[116:119], v[68:71]
    s_waitcnt lgkmcnt(4)
    v_mfma_f32_16x16x32_bf16 v[0:3], v[112:115], v[80:83], 0
    ds_read_b64 v[72:73], v128 offset:64
    ds_read_b64 v[74:75], v128 offset:72
    v_mfma_f32_16x16x32_bf16 v[4:7], v[116:119], v[80:83], 0
    v_mfma_f32_16x16x32_bf16 v[4:7], v[84:87], v[116:119], v[4:7]
    v_cndmask_b32 v70, 0, v70, s[46:47]
    ds_read_b64 v[76:77], v131 offset:6400
    ds_read_b64 v[78:79], v131 offset:6408
    s_waitcnt lgkmcnt(4)
    v_mfma_f32_16x16x32_bf16 v[96:99], v[120:123], v[88:91], 0
    ds_read_b64 v[80:81], v128 offset:9632
    ds_read_b64 v[82:83], v128 offset:9640
    v_mfma_f32_16x16x32_bf16 v[100:103], v[124:127], v[88:91], 0
    v_mfma_f32_16x16x32_bf16 v[96:99], v[92:95], v[112:115], v[96:99]
    v_mfma_f32_16x16x32_bf16 v[100:103], v[92:95], v[116:119], v[100:103]
    ds_read_b64 v[84:85], v129 offset:3296
    ds_read_b64 v[86:87], v129 offset:3304
    s_waitcnt lgkmcnt(4)
    v_mfma_f32_16x16x32_bf16 v[12:15], v[112:115], v[72:75], 0
    ds_read_b64 v[88:89], v128 offset:6464
    ds_read_b64 v[90:91], v128 offset:6472
    v_mfma_f32_16x16x32_bf16 v[16:19], v[116:119], v[72:75], 0
    v_cvt_pk_bf16_f32 v8, v96, v97
    v_cvt_pk_bf16_f32 v9, v98, v99
    v_mfma_f32_16x16x32_bf16 v[12:15], v[76:79], v[112:115], v[12:15]
    v_cvt_pk_bf16_f32 v10, v100, v101
    v_cvt_pk_bf16_f32 v11, v102, v103
    v_mfma_f32_16x16x32_bf16 v[16:19], v[76:79], v[116:119], v[16:19]
    ds_read_b64 v[92:93], v128 offset:9696
    ds_read_b64 v[94:95], v128 offset:9704
    s_waitcnt lgkmcnt(4)
    v_mfma_f32_16x16x32_bf16 v[96:99], v[120:123], v[80:83], 0
    ds_read_b64 v[72:73], v128 offset:128
    ds_read_b64 v[74:75], v128 offset:136
    v_mfma_f32_16x16x32_bf16 v[100:103], v[124:127], v[80:83], 0
    v_mfma_f32_16x16x32_bf16 v[96:99], v[84:87], v[112:115], v[96:99]
    v_mfma_f32_16x16x32_bf16 v[100:103], v[84:87], v[116:119], v[100:103]
    ds_read_b64 v[76:77], v129 offset:12800
    ds_read_b64 v[78:79], v129 offset:12808
    s_waitcnt lgkmcnt(4)
    v_mfma_f32_16x16x32_bf16 v[24:27], v[112:115], v[88:91], 0
    ds_read_b64 v[80:81], v128 offset:3328
    ds_read_b64 v[82:83], v128 offset:3336
    v_mfma_f32_16x16x32_bf16 v[28:31], v[112:115], v[92:95], 0
    v_cvt_pk_bf16_f32 v20, v96, v97
    v_cvt_pk_bf16_f32 v21, v98, v99
    s_nop 3
    v_cvt_pk_bf16_f32 v22, v100, v101
    v_cvt_pk_bf16_f32 v23, v102, v103
    ds_read_b64 v[84:85], v131 offset:12832
    ds_read_b64 v[86:87], v131 offset:12840
    s_waitcnt lgkmcnt(4)
    v_mfma_f32_16x16x32_bf16 v[96:99], v[120:123], v[72:75], 0
    ds_read_b64 v[88:89], v128 offset:6528
    ds_read_b64 v[90:91], v128 offset:6536
    v_mfma_f32_16x16x32_bf16 v[100:103], v[124:127], v[72:75], 0
    v_mfma_f32_16x16x32_bf16 v[96:99], v[76:79], v[112:115], v[96:99]
    v_mfma_f32_16x16x32_bf16 v[100:103], v[76:79], v[116:119], v[100:103]
    ds_read_b64 v[92:93], v129 offset:12864
    ds_read_b64 v[94:95], v129 offset:12872
    s_waitcnt lgkmcnt(4)
    v_mfma_f32_16x16x32_bf16 v[36:39], v[112:115], v[80:83], 0
    ds_read_b64 v[72:73], v128 offset:9728
    ds_read_b64 v[74:75], v128 offset:9736
    v_mfma_f32_16x16x32_bf16 v[40:43], v[116:119], v[80:83], 0
    v_cvt_pk_bf16_f32 v32, v96, v97
    v_cvt_pk_bf16_f32 v33, v98, v99
    v_mfma_f32_16x16x32_bf16 v[36:39], v[84:87], v[112:115], v[36:39]
    v_cvt_pk_bf16_f32 v34, v100, v101
    v_cvt_pk_bf16_f32 v35, v102, v103
    v_mfma_f32_16x16x32_bf16 v[40:43], v[84:87], v[116:119], v[40:43]
    ds_read_b64 v[76:77], v131 offset:12896
    ds_read_b64 v[78:79], v131 offset:12904
    s_waitcnt lgkmcnt(4)
    v_mfma_f32_16x16x32_bf16 v[96:99], v[120:123], v[88:91], 0
    ds_read_b64 v[80:81], v128 offset:12928
    ds_read_b64 v[82:83], v128 offset:12936
    v_mfma_f32_16x16x32_bf16 v[100:103], v[124:127], v[88:91], 0
    v_mfma_f32_16x16x32_bf16 v[96:99], v[92:95], v[112:115], v[96:99]
    v_mfma_f32_16x16x32_bf16 v[100:103], v[92:95], v[116:119], v[100:103]
    v_mov_b32 v84, 0
    v_mov_b32 v85, 0
    v_mov_b32 v86, 0
    v_mov_b32 v87, 0
    s_mov_b64 exec, s[60:61]
    ds_read_b64 v[84:85], v129 offset:12928
    ds_read_b64 v[86:87], v129 offset:12936
    s_mov_b64 exec, -1
    s_waitcnt lgkmcnt(4)
    v_mfma_f32_16x16x32_bf16 v[48:51], v[112:115], v[72:75], 0
    v_mfma_f32_16x16x32_bf16 v[52:55], v[116:119], v[72:75], 0
    v_cvt_pk_bf16_f32 v44, v96, v97
    v_cvt_pk_bf16_f32 v45, v98, v99
    v_mfma_f32_16x16x32_bf16 v[48:51], v[76:79], v[112:115], v[48:51]
    v_cvt_pk_bf16_f32 v46, v100, v101
    v_cvt_pk_bf16_f32 v47, v102, v103
    v_mfma_f32_16x16x32_bf16 v[52:55], v[76:79], v[116:119], v[52:55]
    s_waitcnt lgkmcnt(0)

    s_mov_b64 exec, 1
    ds_add_u32 v252, v253 offset:12
    s_mov_b64 exec, -1

    v_mfma_f32_16x16x32_bf16 v[96:99], v[120:123], v[80:83], 0
    v_mfma_f32_16x16x32_bf16 v[100:103], v[124:127], v[80:83], 0
    v_mfma_f32_16x16x32_bf16 v[96:99], v[84:87], v[112:115], v[96:99]
    v_mfma_f32_16x16x32_bf16 v[100:103], v[84:87], v[116:119], v[100:103]
    s_nop 7
    v_cvt_pk_bf16_f32 v56, v96, v97
    v_cvt_pk_bf16_f32 v57, v98, v99
    v_cvt_pk_bf16_f32 v58, v100, v101
    v_cvt_pk_bf16_f32 v59, v102, v103
    s_waitcnt vmcnt(0)
    ds_write_b32 v191, v193 offset:0
    ds_write_b32 v191, v193 offset:9216
    s_mov_b64 exec, s[48:49]
    ds_write_b16 v190, v216 offset:0
    ds_write_b16 v190, v217 offset:576
    ds_write_b16 v190, v218 offset:1152
    ds_write_b16 v190, v219 offset:1728
    ds_write_b16 v190, v220 offset:4608
    ds_write_b16 v190, v221 offset:5184
    ds_write_b16 v190, v222 offset:5760
    ds_write_b16 v190, v223 offset:6336
    ds_write_b16 v190, v224 offset:9216
    ds_write_b16 v190, v225 offset:9792
    ds_write_b16 v190, v226 offset:10368
    ds_write_b16 v190, v227 offset:10944
    s_mov_b64 exec, -1
    ds_read_b128 v[180:183], v189
    v_add_u32 v189, 2304, v189
    v_mov_b32 v128, 0
    v_mov_b32 v129, 0
    v_mov_b32 v130, 0
    v_mov_b32 v131, 0
    v_mov_b32 v132, 0
    v_mov_b32 v133, 0
    v_mov_b32 v134, 0
    v_mov_b32 v135, 0
    v_mov_b32 v136, 0
    v_mov_b32 v137, 0
    v_mov_b32 v138, 0
    v_mov_b32 v139, 0
    v_mov_b32 v140, 0
    v_mov_b32 v141, 0
    v_mov_b32 v142, 0
    v_mov_b32 v143, 0
    v_mov_b32 v144, 0
    v_mov_b32 v145, 0
    v_mov_b32 v146, 0
    v_mov_b32 v147, 0
    v_mov_b32 v148, 0
    v_mov_b32 v149, 0
    v_mov_b32 v150, 0
    v_mov_b32 v151, 0
    v_mov_b32 v152, 0
    v_mov_b32 v153, 0
    v_mov_b32 v154, 0
    v_mov_b32 v155, 0
    v_mov_b32 v156, 0
    v_mov_b32 v157, 0
    v_mov_b32 v158, 0
    v_mov_b32 v159, 0
    v_mov_b32 v160, 0
    v_mov_b32 v161, 0
    v_mov_b32 v162, 0
    v_mov_b32 v163, 0
    v_mov_b32 v164, 0
    v_mov_b32 v165, 0
    v_mov_b32 v166, 0
    v_mov_b32 v167, 0
    v_mov_b32 v168, 0
    v_mov_b32 v169, 0
    v_mov_b32 v170, 0
    v_mov_b32 v171, 0
    v_mov_b32 v172, 0
    v_mov_b32 v173, 0
    v_mov_b32 v174, 0
    v_mov_b32 v175, 0
    v_mov_b32 v184, 0
    v_mov_b32 v185, 0
    v_mov_b32 v186, 0
    v_mov_b32 v187, 0
    s_mov_b32 m0, 0
k1_kernel_wf2:

    ds_read_b32 v251, v252 offset:16
    s_waitcnt lgkmcnt(0)
    v_readfirstlane_b32 s45, v251
    s_cmp_lt_u32 s45, 4
    s_cbranch_scc1 k1_kernel_wf2

    s_setprio 2
    v_mad_u32_u16 v76, v180, s57, v188 op_sel:[0,0,0,0]
    ds_read_b128 v[72:75], v76 offset:0
    ds_read_b128 v[76:79], v76 offset:64
    v_mad_u32_u16 v84, v180, s57, v188 op_sel:[1,0,0,0]
    ds_read_b128 v[80:83], v84 offset:0
    ds_read_b128 v[84:87], v84 offset:64
    v_mad_u32_u16 v92, v181, s57, v188 op_sel:[0,0,0,0]
    ds_read_b128 v[88:91], v92 offset:0
    ds_read_b128 v[92:95], v92 offset:64
    v_mad_u32_u16 v100, v181, s57, v188 op_sel:[1,0,0,0]
    ds_read_b128 v[96:99], v100 offset:0
    ds_read_b128 v[100:103], v100 offset:64
    v_mad_u32_u16 v108, v182, s57, v188 op_sel:[0,0,0,0]
    ds_read_b128 v[104:107], v108 offset:0
    ds_read_b128 v[108:111], v108 offset:64
    v_mad_u32_u16 v116, v182, s57, v188 op_sel:[1,0,0,0]
    ds_read_b128 v[112:115], v116 offset:0
    ds_read_b128 v[116:119], v116 offset:64
    s_waitcnt lgkmcnt(6)
    buffer_load_dwordx4 v[228:231], v254, s[16:19], s74 offen offset:2400
    s_add_u32 s74, s74, 3200
    buffer_load_dwordx4 v[232:235], v254, s[16:19], s74 offen offset:0
    buffer_load_dwordx4 v[236:239], v254, s[16:19], s74 offen offset:800
    buffer_load_dwordx4 v[240:243], v254, s[16:19], s74 offen offset:1600
    buffer_load_dwordx4 v[244:247], v254, s[16:19], s74 offen offset:2400
    s_add_u32 s74, s74, 3200
    s_movk_i32 s58, 5
k1_kernel_loop:
    v_mfma_f32_16x16x32_bf16 v[128:131], v[72:75], v[72:75], 0
    v_mad_u32_u16 v124, v183, s57, v188 op_sel:[0,0,0,0]
    ds_read_b128 v[120:123], v124 offset:0
    v_mfma_f32_16x16x32_bf16 v[128:131], v[76:79], v[76:79], v[128:131]
    ds_read_b128 v[124:127], v124 offset:64
    ds_read_b128 v[180:183], v189
    v_mfma_f32_16x16x32_bf16 v[132:135], v[80:83], v[72:75], 0
    v_add_u32 v189, 2304, v189
    v_fmac_f32 v185, v168, v60
    v_mfma_f32_16x16x32_bf16 v[132:135], v[84:87], v[76:79], v[132:135]
    v_fmac_f32 v184, v169, v61
    v_fmac_f32 v185, v170, v62
    v_mfma_f32_16x16x32_bf16 v[136:139], v[80:83], v[80:83], 0
    v_fmac_f32 v184, v171, v63
    v_fma_f32 v186, v172, v176, v184
    v_mfma_f32_16x16x32_bf16 v[136:139], v[84:87], v[84:87], v[136:139]
    v_fmac_f32 v186, v173, v177
    v_fmac_f32 v186, v174, v178
    v_mfma_f32_16x16x32_bf16 v[140:143], v[88:91], v[80:83], 0
    v_fmac_f32 v186, v175, v179
    v_fmac_f32 v185, v160, v69
    v_mfma_f32_16x16x32_bf16 v[140:143], v[92:95], v[84:87], v[140:143]
    v_fmac_f32 v185, v164, v70
    v_add_f32 v186, v186, v185
    v_mfma_f32_16x16x32_bf16 v[144:147], v[88:91], v[72:75], 0
    v_fmac_f32 v184, v128, v0
    v_fmac_f32 v185, v129, v1
    v_mfma_f32_16x16x32_bf16 v[144:147], v[92:95], v[76:79], v[144:147]
    s_waitcnt lgkmcnt(7)
    v_add_f32_dpp v186, v186, v186 row_shr:1 row_mask:0xf bank_mask:0xf bound_ctrl:0
    v_smfmac_f32_16x16x64_bf16 v[172:175], v[8:11], v[136:143], v192
    v_fmac_f32 v184, v130, v2
    v_mfma_f32_16x16x32_bf16 v[148:151], v[96:99], v[72:75], 0
    v_add_f32_dpp v186, v186, v186 row_shr:2 row_mask:0xf bank_mask:0xf bound_ctrl:0
    v_fmac_f32 v185, v131, v3
    v_mfma_f32_16x16x32_bf16 v[148:151], v[100:103], v[76:79], v[148:151]
    v_fmac_f32 v184, v132, v4
    v_fmac_f32 v185, v133, v5
    v_mfma_f32_16x16x32_bf16 v[152:155], v[80:83], v[96:99], 0
    v_add_f32_dpp v186, v186, v186 row_shr:4 row_mask:0xf bank_mask:0xf bound_ctrl:0
    v_fmac_f32 v184, v134, v6
    v_mfma_f32_16x16x32_bf16 v[152:155], v[84:87], v[100:103], v[152:155]
    v_fmac_f32 v185, v135, v7
    v_fmac_f32 v184, v144, v12
    v_mfma_f32_16x16x32_bf16 v[156:159], v[88:91], v[96:99], 0
    v_add_f32_dpp v186, v186, v186 row_shr:8 row_mask:0xf bank_mask:0xf bound_ctrl:0
    v_fmac_f32 v185, v145, v13
    v_mfma_f32_16x16x32_bf16 v[156:159], v[92:95], v[100:103], v[156:159]
    v_fmac_f32 v184, v146, v14
    v_fmac_f32 v185, v147, v15
    v_mfma_f32_16x16x32_bf16 v[128:131], v[88:91], v[88:91], 0
    v_add_f32_dpp v186, v186, v186 row_bcast:15 row_mask:0xa bank_mask:0xf
    v_fmac_f32 v184, v148, v16
    v_mfma_f32_16x16x32_bf16 v[128:131], v[92:95], v[92:95], v[128:131]
    v_fmac_f32 v185, v149, v17
    v_fmac_f32 v184, v150, v18
    v_smfmac_f32_16x16x64_bf16 v[172:175], v[20:23], v[152:159], v192
    v_add_f32_dpp v186, v186, v186 row_bcast:31 row_mask:0xc bank_mask:0xf
    v_mfma_f32_16x16x32_bf16 v[132:135], v[96:99], v[96:99], 0
    s_waitcnt lgkmcnt(0)
    v_fmac_f32 v185, v151, v19
    v_mfma_f32_16x16x32_bf16 v[132:135], v[100:103], v[100:103], v[132:135]
    v_readlane_b32 s76, v186, 63
    v_fmac_f32 v184, v128, v24
    v_mfma_f32_16x16x32_bf16 v[136:139], v[104:107], v[72:75], 0
    v_fmac_f32 v185, v129, v25
    v_fmac_f32 v184, v130, v26
    v_mfma_f32_16x16x32_bf16 v[136:139], v[108:111], v[76:79], v[136:139]
    v_writelane_b32 v187, s76, m0
    v_fmac_f32 v185, v131, v27
    v_mfma_f32_16x16x32_bf16 v[140:143], v[112:115], v[72:75], 0
    v_fmac_f32 v184, v132, v28
    v_fmac_f32 v185, v133, v29
    v_mfma_f32_16x16x32_bf16 v[140:143], v[116:119], v[76:79], v[140:143]
    s_add_u32 m0, m0, 1
    v_fmac_f32 v184, v134, v30
    v_mfma_f32_16x16x32_bf16 v[160:163], v[120:123], v[72:75], 0
    v_fmac_f32 v185, v135, v31
    v_mfma_f32_16x16x32_bf16 v[160:163], v[124:127], v[76:79], v[160:163]
    v_mad_u32_u16 v76, v180, s57, v188 op_sel:[0,0,0,0]
    ds_read_b128 v[72:75], v76 offset:0
    v_smfmac_f32_16x16x64_bf16 v[172:175], v[32:35], v[136:143], v192
    ds_read_b128 v[76:79], v76 offset:64
    v_mfma_f32_16x16x32_bf16 v[144:147], v[104:107], v[80:83], 0
    v_mfma_f32_16x16x32_bf16 v[144:147], v[108:111], v[84:87], v[144:147]
    v_fmac_f32 v184, v160, v64
    v_mfma_f32_16x16x32_bf16 v[148:151], v[112:115], v[80:83], 0
    v_mfma_f32_16x16x32_bf16 v[148:151], v[116:119], v[84:87], v[148:151]
    v_mfma_f32_16x16x32_bf16 v[164:167], v[120:123], v[80:83], 0
    v_fmac_f32 v185, v144, v36
    v_fmac_f32 v184, v145, v37
    v_mfma_f32_16x16x32_bf16 v[164:167], v[124:127], v[84:87], v[164:167]
    v_mad_u32_u16 v84, v180, s57, v188 op_sel:[1,0,0,0]
    ds_read_b128 v[80:83], v84 offset:0
    v_mfma_f32_16x16x32_bf16 v[152:155], v[104:107], v[88:91], 0
    ds_read_b128 v[84:87], v84 offset:64
    v_fmac_f32 v185, v146, v38
    v_mfma_f32_16x16x32_bf16 v[152:155], v[108:111], v[92:95], v[152:155]
    v_fmac_f32 v184, v147, v39
    v_fmac_f32 v185, v148, v40
    v_mfma_f32_16x16x32_bf16 v[156:159], v[112:115], v[88:91], 0
    v_fmac_f32 v184, v149, v41
    v_fmac_f32 v185, v150, v42
    v_mfma_f32_16x16x32_bf16 v[156:159], v[116:119], v[92:95], v[156:159]
    v_fmac_f32 v184, v151, v43
    v_fmac_f32 v185, v164, v65
    v_mfma_f32_16x16x32_bf16 v[168:171], v[120:123], v[88:91], 0
    v_mfma_f32_16x16x32_bf16 v[168:171], v[124:127], v[92:95], v[168:171]
    v_mad_u32_u16 v92, v181, s57, v188 op_sel:[0,0,0,0]
    ds_read_b128 v[88:91], v92 offset:0
    v_smfmac_f32_16x16x64_bf16 v[172:175], v[44:47], v[152:159], v192
    ds_read_b128 v[92:95], v92 offset:64
    v_mfma_f32_16x16x32_bf16 v[144:147], v[104:107], v[96:99], 0
    v_mfma_f32_16x16x32_bf16 v[144:147], v[108:111], v[100:103], v[144:147]
    v_fmac_f32 v184, v168, v66
    v_mfma_f32_16x16x32_bf16 v[148:151], v[112:115], v[96:99], 0
    v_mfma_f32_16x16x32_bf16 v[148:151], v[116:119], v[100:103], v[148:151]
    v_mfma_f32_16x16x32_bf16 v[160:163], v[120:123], v[96:99], 0
    v_fmac_f32 v185, v144, v48
    v_fmac_f32 v184, v145, v49
    v_mfma_f32_16x16x32_bf16 v[160:163], v[124:127], v[100:103], v[160:163]
    v_mad_u32_u16 v100, v181, s57, v188 op_sel:[1,0,0,0]
    ds_read_b128 v[96:99], v100 offset:0
    v_mfma_f32_16x16x32_bf16 v[152:155], v[104:107], v[104:107], 0
    ds_read_b128 v[100:103], v100 offset:64
    v_fmac_f32 v185, v146, v50
    v_mfma_f32_16x16x32_bf16 v[152:155], v[108:111], v[108:111], v[152:155]
    v_fmac_f32 v184, v147, v51
    v_fmac_f32 v185, v148, v52
    v_mfma_f32_16x16x32_bf16 v[156:159], v[112:115], v[104:107], 0
    v_fmac_f32 v184, v149, v53
    v_fmac_f32 v185, v150, v54
    v_mfma_f32_16x16x32_bf16 v[156:159], v[116:119], v[108:111], v[156:159]
    v_fmac_f32 v184, v151, v55
    v_fmac_f32 v185, v160, v67
    v_mfma_f32_16x16x32_bf16 v[164:167], v[120:123], v[104:107], 0
    v_mfma_f32_16x16x32_bf16 v[164:167], v[124:127], v[108:111], v[164:167]
    v_mad_u32_u16 v108, v182, s57, v188 op_sel:[0,0,0,0]
    ds_read_b128 v[104:107], v108 offset:0
    v_smfmac_f32_16x16x64_bf16 v[172:175], v[56:59], v[152:159], v192
    ds_read_b128 v[108:111], v108 offset:64
    v_mfma_f32_16x16x32_bf16 v[168:171], v[112:115], v[112:115], 0
    v_mfma_f32_16x16x32_bf16 v[168:171], v[116:119], v[116:119], v[168:171]
    v_fmac_f32 v184, v164, v68
    v_mfma_f32_16x16x32_bf16 v[160:163], v[120:123], v[112:115], 0
    v_mfma_f32_16x16x32_bf16 v[160:163], v[124:127], v[116:119], v[160:163]
    v_mad_u32_u16 v116, v182, s57, v188 op_sel:[1,0,0,0]
    ds_read_b128 v[112:115], v116 offset:0
    v_mfma_f32_16x16x32_bf16 v[164:167], v[120:123], v[120:123], 0
    ds_read_b128 v[116:119], v116 offset:64
    s_waitcnt lgkmcnt(6)
    v_mfma_f32_16x16x32_bf16 v[164:167], v[124:127], v[124:127], v[164:167]

    s_cmp_lt_u32 m0, s58
    s_cbranch_scc1 k1_kernel_loop
    s_cmp_lt_u32 m0, 32
    s_cbranch_scc1 k1_kernel_mid

    s_nop 7
    v_fmac_f32 v185, v168, v60
    v_fmac_f32 v184, v169, v61
    v_fmac_f32 v185, v170, v62
    v_fmac_f32 v184, v171, v63
    v_fma_f32 v186, v172, v176, v184
    v_fmac_f32 v186, v173, v177
    v_fmac_f32 v186, v174, v178
    v_fmac_f32 v186, v175, v179
    v_fmac_f32 v185, v160, v69
    v_fmac_f32 v185, v164, v70
    v_add_f32 v186, v186, v185
    s_nop 1
    v_add_f32_dpp v186, v186, v186 row_shr:1 row_mask:0xf bank_mask:0xf bound_ctrl:0
    s_nop 1
    v_add_f32_dpp v186, v186, v186 row_shr:2 row_mask:0xf bank_mask:0xf bound_ctrl:0
    s_nop 1
    v_add_f32_dpp v186, v186, v186 row_shr:4 row_mask:0xf bank_mask:0xf bound_ctrl:0
    s_nop 1
    v_add_f32_dpp v186, v186, v186 row_shr:8 row_mask:0xf bank_mask:0xf bound_ctrl:0
    s_nop 1
    v_add_f32_dpp v186, v186, v186 row_bcast:15 row_mask:0xa bank_mask:0xf
    s_nop 1
    v_add_f32_dpp v186, v186, v186 row_bcast:31 row_mask:0xc bank_mask:0xf
    s_nop 1
    v_readlane_b32 s76, v186, 63
    s_nop 1
    v_writelane_b32 v187, s76, m0
    s_nop 1
    s_add_u32 m0, m0, 1
    s_nop 1

    v_subrev_f32_dpp v186, v187, v187 wave_shr:1 row_mask:0xf bank_mask:0xf
    v_add_u32 v40, -1, v255
    v_cmp_gt_u32 vcc, 32, v40
    s_lshl_b32 s74, s72, 2
    s_lshl_b32 s76, s36, 16
    s_add_u32 s74, s74, s76
    s_add_u32 s74, s74, 29360128
    v_lshlrev_b32 v40, 2, v40
    s_lshl_b32 s76, s36, 6
    v_xor_b32 v40, s76, v40
    s_and_saveexec_b64 s[46:47], vcc
    buffer_store_dword v186, v40, s[32:35], s74 offen
    s_mov_b64 exec, s[46:47]

    s_branch k1_kernel_k2
k1_kernel_mid:

    s_waitcnt vmcnt(0)
    s_cmp_eq_u32 m0, 15
    s_cbranch_scc1 k1_kernel_mid2
    s_movk_i32 s58, 15
    s_mul_i32 s45, s36, 12800
    s_sub_u32 s74, s74, s45

    ds_write_b32 v191, v193 offset:18432
    ds_write_b32 v191, v193 offset:27648
    s_mov_b64 exec, s[48:49]
    ds_write_b16 v190, v228 offset:13824
    ds_write_b16 v190, v229 offset:14400
    ds_write_b16 v190, v230 offset:14976
    ds_write_b16 v190, v231 offset:15552
    ds_write_b16 v190, v232 offset:18432
    ds_write_b16 v190, v233 offset:19008
    ds_write_b16 v190, v234 offset:19584
    ds_write_b16 v190, v235 offset:20160
    ds_write_b16 v190, v236 offset:23040
    ds_write_b16 v190, v237 offset:23616
    ds_write_b16 v190, v238 offset:24192
    ds_write_b16 v190, v239 offset:24768
    ds_write_b16 v190, v240 offset:27648
    ds_write_b16 v190, v241 offset:28224
    ds_write_b16 v190, v242 offset:28800
    ds_write_b16 v190, v243 offset:29376
    ds_write_b16 v190, v244 offset:32256
    ds_write_b16 v190, v245 offset:32832
    ds_write_b16 v190, v246 offset:33408
    ds_write_b16 v190, v247 offset:33984
    s_mov_b64 exec, -1
    buffer_load_dwordx4 v[216:219], v254, s[16:19], s74 offen offset:0
    buffer_load_dwordx4 v[220:223], v254, s[16:19], s74 offen offset:800
    buffer_load_dwordx4 v[224:227], v254, s[16:19], s74 offen offset:1600
    buffer_load_dwordx4 v[228:231], v254, s[16:19], s74 offen offset:2400
    s_add_u32 s74, s74, 3200
    buffer_load_dwordx4 v[232:235], v254, s[16:19], s74 offen offset:0
    buffer_load_dwordx4 v[236:239], v254, s[16:19], s74 offen offset:800
    buffer_load_dwordx4 v[240:243], v254, s[16:19], s74 offen offset:1600
    buffer_load_dwordx4 v[244:247], v254, s[16:19], s74 offen offset:2400
    s_add_u32 s74, s74, 3200
    s_branch k1_kernel_loop
k1_kernel_mid2:
    s_movk_i32 s58, 32
    v_subrev_u32 v189, 36864, v189
    s_mov_b64 exec, s[48:49]
    ds_write_b16 v190, v216 offset:0
    ds_write_b16 v190, v217 offset:576
    ds_write_b16 v190, v218 offset:1152
    ds_write_b16 v190, v219 offset:1728
    ds_write_b16 v190, v220 offset:4608
    ds_write_b16 v190, v221 offset:5184
    ds_write_b16 v190, v222 offset:5760
    ds_write_b16 v190, v223 offset:6336
    ds_write_b16 v190, v224 offset:9216
    ds_write_b16 v190, v225 offset:9792
    ds_write_b16 v190, v226 offset:10368
    ds_write_b16 v190, v227 offset:10944
    ds_write_b16 v190, v228 offset:13824
    ds_write_b16 v190, v229 offset:14400
    ds_write_b16 v190, v230 offset:14976
    ds_write_b16 v190, v231 offset:15552
    ds_write_b16 v190, v232 offset:18432
    ds_write_b16 v190, v233 offset:19008
    ds_write_b16 v190, v234 offset:19584
    ds_write_b16 v190, v235 offset:20160
    ds_write_b16 v190, v236 offset:23040
    ds_write_b16 v190, v237 offset:23616
    ds_write_b16 v190, v238 offset:24192
    ds_write_b16 v190, v239 offset:24768
    ds_write_b16 v190, v240 offset:27648
    ds_write_b16 v190, v241 offset:28224
    ds_write_b16 v190, v242 offset:28800
    ds_write_b16 v190, v243 offset:29376
    ds_write_b16 v190, v244 offset:32256
    ds_write_b16 v190, v245 offset:32832
    ds_write_b16 v190, v246 offset:33408
    ds_write_b16 v190, v247 offset:33984
    s_mov_b64 exec, -1
    s_branch k1_kernel_loop
k1_kernel_last:
    s_endpgm
.globl k3_kernel
.p2align 8
.type k3_kernel,@function
k3_kernel:

    s_cmp_ge_u32 s2, 256
    s_cbranch_scc1 k3_kernel_end
    s_load_dwordx4 s[4:7], s[0:1], 48
    s_load_dwordx2 s[8:9], s[0:1], 72
    v_and_b32 v1, 15, v0
    v_lshrrev_b32 v2, 4, v0
    v_lshlrev_b32 v3, 4, v1
    v_lshl_add_u32 v3, v2, 19, v3
    s_lshl_b32 s3, s2, 8
    s_add_u32 s20, s3, 20971520
    s_waitcnt lgkmcnt(0)

    s_mov_b32 s12, s8
    s_and_b32 s13, s9, 0xffff
    s_mov_b32 s14, 268435456
    s_mov_b32 s15, 0x00020000
    s_mov_b32 s16, s6
    s_and_b32 s17, s7, 0xffff
    s_mov_b32 s18, 32768
    s_mov_b32 s19, 0x00020000
    s_mov_b32 s24, s4
    s_and_b32 s25, s5, 0xffff
    s_mov_b32 s26, 2
    s_mov_b32 s27, 0x00020000
    buffer_load_dwordx4 v[8:11], v3, s[12:15], s20 offen
    s_add_u32 s20, s20, 65536
    buffer_load_dwordx4 v[12:15], v3, s[12:15], s20 offen
    s_add_u32 s20, s20, 65536
    buffer_load_dwordx4 v[16:19], v3, s[12:15], s20 offen
    s_add_u32 s20, s20, 65536
    buffer_load_dwordx4 v[20:23], v3, s[12:15], s20 offen
    s_add_u32 s20, s20, 65536
    buffer_load_dwordx4 v[24:27], v3, s[12:15], s20 offen
    s_add_u32 s20, s20, 65536
    buffer_load_dwordx4 v[28:31], v3, s[12:15], s20 offen
    s_add_u32 s20, s20, 65536
    buffer_load_dwordx4 v[32:35], v3, s[12:15], s20 offen
    s_add_u32 s20, s20, 65536
    buffer_load_dwordx4 v[36:39], v3, s[12:15], s20 offen
    s_add_u32 s20, s20, 65536

    v_lshlrev_b32 v4, 2, v0
    s_add_u32 s21, s3, 29360128
    s_add_u32 s22, s21, 65536
    v_mov_b32 v5, 0
    buffer_load_dword v40, v4, s[12:15], s21 offen
    buffer_load_dword v41, v4, s[12:15], s22 offen
    buffer_load_ushort v42, v5, s[24:27], 0 offen
    v_lshlrev_b32 v6, 4, v0

    s_waitcnt vmcnt(9)
    v_add_f32 v8, v8, v12
    v_add_f32 v9, v9, v13
    v_add_f32 v10, v10, v14
    v_add_f32 v11, v11, v15
    s_waitcnt vmcnt(8)
    v_add_f32 v8, v8, v16
    v_add_f32 v9, v9, v17
    v_add_f32 v10, v10, v18
    v_add_f32 v11, v11, v19
    s_waitcnt vmcnt(7)
    v_add_f32 v8, v8, v20
    v_add_f32 v9, v9, v21
    v_add_f32 v10, v10, v22
    v_add_f32 v11, v11, v23
    s_waitcnt vmcnt(6)
    v_add_f32 v8, v8, v24
    v_add_f32 v9, v9, v25
    v_add_f32 v10, v10, v26
    v_add_f32 v11, v11, v27
    s_waitcnt vmcnt(5)
    v_add_f32 v8, v8, v28
    v_add_f32 v9, v9, v29
    v_add_f32 v10, v10, v30
    v_add_f32 v11, v11, v31
    s_waitcnt vmcnt(4)
    v_add_f32 v8, v8, v32
    v_add_f32 v9, v9, v33
    v_add_f32 v10, v10, v34
    v_add_f32 v11, v11, v35
    s_waitcnt vmcnt(3)
    v_add_f32 v8, v8, v36
    v_add_f32 v9, v9, v37
    v_add_f32 v10, v10, v38
    v_add_f32 v11, v11, v39

    ds_write_b128 v6, v[8:11]
    s_waitcnt lgkmcnt(0)
    s_barrier
    v_cmp_gt_u32 vcc, 64, v0
    s_and_saveexec_b64 s[30:31], vcc
    s_cbranch_execz k3_kernel_end

    ds_read_b32 v12, v4 offset:0
    ds_read_b32 v13, v4 offset:256
    ds_read_b32 v14, v4 offset:512
    ds_read_b32 v15, v4 offset:768
    ds_read_b32 v16, v4 offset:1024
    ds_read_b32 v17, v4 offset:1280
    ds_read_b32 v18, v4 offset:1536
    ds_read_b32 v19, v4 offset:1792
    ds_read_b32 v20, v4 offset:2048
    ds_read_b32 v21, v4 offset:2304
    ds_read_b32 v22, v4 offset:2560
    ds_read_b32 v23, v4 offset:2816
    ds_read_b32 v24, v4 offset:3072
    ds_read_b32 v25, v4 offset:3328
    ds_read_b32 v26, v4 offset:3584
    ds_read_b32 v27, v4 offset:3840
    s_waitcnt lgkmcnt(0)
    v_add_f32 v12, v12, v20
    v_add_f32 v13, v13, v21
    v_add_f32 v14, v14, v22
    v_add_f32 v15, v15, v23
    v_add_f32 v16, v16, v24
    v_add_f32 v17, v17, v25
    v_add_f32 v18, v18, v26
    v_add_f32 v19, v19, v27
    v_add_f32 v12, v12, v16
    v_add_f32 v13, v13, v17
    v_add_f32 v14, v14, v18
    v_add_f32 v15, v15, v19
    v_add_f32 v12, v12, v14
    v_add_f32 v13, v13, v15
    v_add_f32 v12, v12, v13

    s_waitcnt vmcnt(0)
    v_add_f32 v40, v40, v41
    v_cvt_pk_bf16_f32 v12, v12, v40
    v_lshlrev_b32 v42, 16, v42
    v_lshlrev_b32 v13, 16, v12
    v_and_b32 v14, 0xffff0000, v12
    v_add_f32 v13, v13, v42
    v_cvt_pk_bf16_f32 v13, v13, v13
    v_lshlrev_b32 v13, 16, v13
    v_add_f32 v13, v13, v14
    v_cvt_pk_bf16_f32 v13, v13, v13
    v_lshlrev_b32 v4, 1, v0
    s_lshl_b32 s3, s2, 7
    buffer_store_short v13, v4, s[16:19], s3 offen

k3_kernel_end:
    s_endpgm
.section .rodata,"a"
.p2align 6
.amdhsa_kernel k1_kernel
  .amdhsa_next_free_vgpr 256
  .amdhsa_next_free_sgpr 96
  .amdhsa_accum_offset 256
  .amdhsa_group_segment_fixed_size 0
  .amdhsa_kernarg_size 80
  .amdhsa_user_sgpr_count 2
  .amdhsa_user_sgpr_kernarg_segment_ptr 1
  .amdhsa_system_sgpr_workgroup_id_x 1
.end_amdhsa_kernel
.p2align 6
.amdhsa_kernel k3_kernel
  .amdhsa_next_free_vgpr 48
  .amdhsa_next_free_sgpr 96
  .amdhsa_accum_offset 48
  .amdhsa_group_segment_fixed_size 0
  .amdhsa_kernarg_size 80
  .amdhsa_user_sgpr_count 2
  .amdhsa_user_sgpr_kernarg_segment_ptr 1
  .amdhsa_system_sgpr_workgroup_id_x 1
.end_amdhsa_kernel
```

```asm
; @launch grid=(256,1,1) block=(512,1,1) lds=163840
.amdgcn_target "amdgcn-amd-amdhsa--gfx950"
.text
.globl standalone__deep_cross_pnn__recsys_kernel
.p2align 8
.type standalone__deep_cross_pnn__recsys_kernel,@function
standalone__deep_cross_pnn__recsys_kernel:

    s_cmp_ge_u32 s2, 256
    s_cbranch_scc1 k1_kernel_end

    s_load_dwordx8 s[4:11], s[0:1], 0
    s_load_dwordx2 s[12:13], s[0:1], 72
    s_load_dwordx2 s[52:53], s[0:1], 64

    v_cmp_gt_u32 vcc, 18, v0
    s_and_saveexec_b64 s[48:49], vcc
    s_cbranch_execz k1_kernel_ncp
    s_getpc_b64 s[46:47]
k1_kernel_pc:
    s_bfe_u32 s38, s2, 0x40003
    s_lshl_b32 s38, s38, 7
    v_lshl_add_u32 v2, v0, 11, s38
    v_min_u32 v2, k1_kernel_last-k1_kernel_pc, v2
    global_load_dword v250, v2, s[46:47]
k1_kernel_ncp:
    s_mov_b64 exec, s[48:49]

    v_lshrrev_b32 v1, 6, v0
    v_and_b32 v255, 63, v0
    s_bfe_u32 s36, s2, 0x10003
    v_readfirstlane_b32 s3, v1
    s_lshr_b32 s37, s2, 4
    s_lshl_b32 s37, s37, 3
    s_and_b32 s38, s2, 7
    s_or_b32 s37, s37, s38
    v_lshlrev_b32 v254, 4, v255
    v_mov_b32 v252, 144144
    v_mov_b32 v253, 1
    v_mov_b32 v40, 0
    v_lshl_add_u32 v41, v0, 2, v252
    v_cmp_gt_u32 vcc, 8, v0
    s_and_saveexec_b64 s[46:47], vcc
    ds_write_b32 v41, v40
    s_mov_b64 exec, s[46:47]
    v_mul_u32_u24 v6, 57, v255
    v_lshrrev_b32 v6, 9, v6
    v_mul_u32_u24 v5, 9, v6
    v_sub_u32 v5, v255, v5
    v_cmp_gt_u32 s[40:41], 8, v5
    s_lshl_b32 s38, s36, 7
    v_lshl_add_u32 v5, v5, 4, s38
    v_lshl_add_u32 v83, v6, 8, v5
    s_and_b32 s56, s3, 3
    s_bitset0_b32 s41, 31
    s_lshr_b32 s42, s2, 3
    s_mul_i32 s42, s42, 36
    s_lshr_b32 s42, s42, 5
    s_lshl_b32 s42, s42, 2
    s_add_u32 s42, s42, s56
    s_mov_b32 s43, s42
    s_mov_b32 s50, s36
    s_lshl_b32 s72, s37, 7
    s_lshl_b32 s73, s3, 5
    s_add_u32 s72, s72, s73
    s_mul_i32 s74, s72, 400
    s_mul_i32 s45, s36, 6400
    s_add_u32 s74, s74, s45
    s_lshl_b32 s38, s3, 10
    s_add_u32 m0, s38, 144384

    s_mov_b32 s18, 6553600
    s_mov_b32 s19, 0x00020000
    s_mov_b32 s22, 256000
    s_mov_b32 s23, 0x00020000
    s_mov_b32 s26, 20000
    s_mov_b32 s27, 0x00020000
    s_mov_b32 s30, 13107200
    s_mov_b32 s31, 0x00020000
    s_mov_b32 s34, 268435456
    s_mov_b32 s35, 0x00020000
    s_mov_b32 s14, 268435456
    s_mov_b32 s15, 0x00020000
    s_mov_b32 s54, 256
    s_mov_b32 s55, 0x00020000

    v_bfe_u32 v5, v255, 2, 2
    v_mul_u32_u24 v5, 200, v5
    v_and_b32 v6, 3, v255
    v_lshl_add_u32 v5, v6, 5, v5
    v_and_b32 v6, 32, v255
    v_lshl_add_u32 v5, v6, 2, v5
    v_and_b32 v6, 16, v255
    v_add_u32 v5, v5, v6
    s_movk_i32 s39, 19200
    s_cmp_ge_u32 s3, 4
    s_waitcnt lgkmcnt(0)
    s_barrier
    s_cbranch_scc1 k1_kernel_dma

    s_mov_b32 s24, s8
    s_and_b32 s25, s9, 0xffff
    buffer_load_dwordx4 v254, s[24:27], s38 offen lds
    s_add_u32 s38, s38, 4096
    s_add_u32 m0, s38, 144384
    s_mov_b32 s16, s4
    s_and_b32 s17, s5, 0xffff
    buffer_load_dwordx4 v254, s[24:27], s38 offen lds
    s_add_u32 s38, s38, 4096
    s_add_u32 m0, s38, 144384
    s_nop 0
    buffer_load_dwordx4 v254, s[24:27], s38 offen lds
    s_add_u32 s38, s38, 4096
    s_add_u32 m0, s38, 144384
    s_nop 0
    buffer_load_dwordx4 v254, s[24:27], s38 offen lds
    s_add_u32 s38, s38, 4096
    s_min_u32 s38, s38, 18432
    s_add_u32 m0, s38, 144384
    s_nop 0
    buffer_load_dwordx4 v254, s[24:27], s38 offen lds
    buffer_load_dwordx4 v[212:215], v5, s[24:27], s39 offen
    buffer_load_dwordx4 v[216:219], v254, s[16:19], s74 offen offset:0
    buffer_load_dwordx4 v[220:223], v254, s[16:19], s74 offen offset:800
    buffer_load_dwordx4 v[224:227], v254, s[16:19], s74 offen offset:1600
    s_branch k1_kernel_main
k1_kernel_dma:
    s_mov_b32 s20, s6
    s_and_b32 s21, s7, 0xffff
    s_mov_b64 exec, s[40:41]
k1_kernel_dml:

    s_min_u32 s38, s42, 142
    s_mul_i32 m0, s38, 1008
    s_mul_i32 s39, s38, 1792
    s_add_u32 s42, s42, 4
    buffer_load_dwordx4 v83, s[20:23], s39 offen lds
    s_cmp_ge_u32 s42, 144
    s_cselect_b32 s38, 144, 0
    s_sub_u32 s42, s42, s38
    s_cmp_lg_u32 s42, s43
    s_cbranch_scc1 k1_kernel_dml
    s_mov_b64 exec, -1

    s_mov_b32 s16, s4
    s_and_b32 s17, s5, 0xffff
    s_mov_b32 s20, s6
    s_and_b32 s21, s7, 0xffff
    s_mov_b32 s28, s10
    s_and_b32 s29, s11, 0xffff
    s_mov_b32 s32, s12
    s_and_b32 s33, s13, 0xffff
    s_and_b32 s13, s13, 0xffff
    s_and_b32 s53, s53, 0xffff
k1_kernel_aux:

    s_setprio 0
    v_mov_b32 v8, v255
    v_mov_b32 v9, v254
    v_mov_b32 v10, v253
    v_mov_b32 v11, v252
    s_mov_b32 s51, s2
    s_mov_b32 s64, 0
    s_mov_b32 s65, 0

k1_kernel_unit:

    s_bfe_u32 s36, s51, 0x10003

    s_lshr_b32 s38, s51, 4
    s_and_b32 s39, s51, 7
    s_sub_u32 s57, 2, s36
    s_lshl_b32 s57, s39, s57
    s_lshl_b32 s37, s36, 5
    s_add_u32 s57, s57, s37
    s_add_u32 s57, s57, s56
    s_mul_i32 s37, s38, 48
    s_add_u32 s37, s37, s57
    s_lshl_b32 s38, s38, 1
    s_lshr_b32 s39, s39, 2
    s_add_u32 s38, s38, s39
    s_add_u32 s38, s38, 768
    s_and_b32 s57, s57, 7
    s_cmp_eq_u32 s57, 2
    s_cselect_b32 s38, s38, 1000
    s_lshl_b32 s39, s36, 1
    s_and_b32 s39, s39, s56
    s_cselect_b32 s57, s38, s37

    s_lshr_b32 s37, s51, 4
    s_lshl_b32 s37, s37, 3
    s_and_b32 s38, s51, 7
    s_or_b32 s37, s37, s38
    s_and_b32 s58, s56, 1
    s_lshl_b32 s59, s37, 1
    s_add_u32 s58, s58, s59
    s_lshr_b32 s59, s56, 1
    s_lshl_b32 s60, s36, 1
    s_add_u32 s59, s59, s60
    s_mul_i32 s60, s58, 25600
    s_mul_i32 s61, s59, 96
    s_add_u32 s60, s60, s61
    s_movk_i32 s61, 400
    v_lshrrev_b32 v1, 3, v8
    v_and_b32 v2, 7, v8
    v_mul_u32_u24 v0, s61, v1
    v_cmp_gt_u32 s[48:49], 7, v2
    v_lshl_add_u32 v0, v2, 4, v0
    v_and_b32 v5, 15, v8
    v_and_b32 v6, 48, v8
    v_lshl_add_u32 v7, v5, 8, v6
    s_lshl_b32 s44, s56, 15
    s_xor_b32 s38, s50, 1
    s_lshl_b32 s38, s38, 7
    s_add_u32 s44, s44, s38

    s_mov_b64 exec, s[48:49]
    buffer_load_dwordx4 v[224:227], v0, s[16:19], s60 offen
    s_add_u32 s60, s60, 3200
    buffer_load_dwordx4 v[228:231], v0, s[16:19], s60 offen
    s_add_u32 s60, s60, 3200
    buffer_load_dwordx4 v[232:235], v0, s[16:19], s60 offen
    s_add_u32 s60, s60, 3200
    buffer_load_dwordx4 v[236:239], v0, s[16:19], s60 offen
    s_add_u32 s60, s60, 3200
    buffer_load_dwordx4 v[240:243], v0, s[16:19], s60 offen
    s_add_u32 s60, s60, 3200
    buffer_load_dwordx4 v[244:247], v0, s[16:19], s60 offen
    s_add_u32 s60, s60, 3200
    buffer_load_dwordx4 v[248:251], v0, s[16:19], s60 offen
    s_add_u32 s60, s60, 3200
    buffer_load_dwordx4 v[252:255], v0, s[16:19], s60 offen
    s_add_u32 s60, s60, 3200
    s_mov_b64 exec, -1

    s_lshr_b32 s78, s57, 5
    s_bfe_u32 s79, s57, 0x20003
    s_bfe_u32 s80, s57, 0x20001
    s_and_b32 s81, s57, 1
    s_lshl_b32 s77, s78, 2
    s_lshl_b32 s83, s81, 1
    s_add_u32 s77, s77, s83
    s_lshl_b32 s77, s77, 7
    s_lshl_b32 s83, s79, 5
    s_add_u32 s77, s77, s83
    s_lshl_b32 s83, s80, 3
    s_add_u32 s77, s77, s83
    s_lshl_b32 s77, s77, 10
    s_lshl_b32 s82, s78, 12
    s_lshl_b32 s83, s79, 10
    s_add_u32 s82, s82, s83
    s_lshl_b32 s83, s80, 8
    s_add_u32 s82, s82, s83
    s_lshl_b32 s83, s81, 7
    s_add_u32 s82, s82, s83
    s_mov_b32 s84, 205312
    v_lshrrev_b32 v3, 2, v8
    v_and_b32 v4, 3, v8
    v_mul_lo_u32 v14, v3, s84
    v_lshl_add_u32 v14, v4, 4, v14
    s_lshl_b32 s61, s56, 12
    s_add_u32 s61, s61, 147456
    v_and_b32 v3, 3, v3
    v_lshlrev_b32 v36, 6, v8
    v_lshl_add_u32 v36, v3, 4, v36
    v_add_u32 v36, s61, v36
    v_xor_b32 v37, 16, v36
    v_xor_b32 v38, 32, v36
    v_xor_b32 v39, 48, v36
    v_and_b32 v3, 48, v8
    v_xor_b32 v15, v3, v9
    v_add_u32 v15, s61, v15
    s_mov_b32 s84, 0x05040100
    s_mov_b32 s85, 0x07060302
    s_cmp_eq_u32 s64, 0
    s_cbranch_scc1 k1_kernel_nsig0
    s_waitcnt vmcnt(0)

k1_kernel_nsig0:

    s_waitcnt vmcnt(8)
    s_cmp_lg_u32 s64, 0
    s_cbranch_scc1 k1_kernel_nsig

    s_mov_b64 exec, 1
    ds_add_u32 v11, v10 offset:16
    s_mov_b64 exec, -1

k1_kernel_nsig:
    s_setprio 1

    s_lshl_b32 s61, s56, 12
    s_add_u32 s61, s61, 147456
    v_lshlrev_b32 v86, 2, v8
    v_add_u32 v86, s61, v86
    v_and_b32 v85, 0xffffff80, v86
    v_and_b32 v123, 32, v8
    s_add_u32 s61, s61, 256
    v_mul_u32_u24 v31, 56, v8
    v_add_u32 v31, s61, v31
    v_mul_u32_u24 v34, 56, v1
    v_lshl_add_u32 v34, v2, 3, v34
    v_add_u32 v34, s61, v34
    v_add_u32 v2, s59, v2
    v_subrev_u32 v3, 5, v2
    v_min_u32 v2, v2, v3
    v_mov_b32 v13, 0
    v_mul_u32_u24 v2, 0x10001, v2
    v_lshlrev_b32 v2, 12, v2
    v_add_u32 v32, 67108864, v2
    v_add_u32 v33, 201328640, v2
    v_mov_b32 v71, 0xf00
    s_lshr_b32 s62, s58, 7
    s_mul_i32 s62, s62, 25
    s_mul_i32 s63, s59, 6
    s_add_u32 s62, s62, s63
    s_lshl_b32 s62, s62, 3
    s_bfe_u32 s63, s58, 0x30004
    s_add_u32 s62, s62, s63
    s_lshl_b32 s62, s62, 13
    s_bfe_u32 s63, s58, 0x30001
    s_lshl_b32 s63, s63, 10
    s_add_u32 s62, s62, s63
    s_and_b32 s63, s58, 1
    s_lshl_b32 s63, s63, 9
    s_add_u32 s62, s62, s63
    s_add_u32 s62, s62, 16777216
    v_and_b32 v30, 31, v8
    v_lshrrev_b32 v3, 5, v8
    v_lshlrev_b32 v30, 4, v30
    v_lshl_add_u32 v30, v3, 3, v30
    s_cmp_eq_u32 s59, 3
    s_cselect_b32 s63, 0xf00, 0
    s_movk_i32 s66, 0x7c
    s_mov_b32 s67, 0x001f001f
    s_mov_b32 s75, 0x06040200
    v_mov_b32 v54, 0x08040201
    v_mov_b32 v55, 0x80402010

    s_lshl_b32 s72, s2, 15
    s_lshl_b32 s73, s56, 13
    s_add_u32 s72, s72, s73
    s_add_u32 s72, s72, 20971520
    s_lshl_b32 s73, s36, 9
    s_lshl2_add_u32 s73, s37, s73
    s_add_u32 s73, s73, s56
    s_lshl_b32 s73, s73, 7
    s_add_u32 s73, s73, 29360128
    v_mov_b32 v192, -1
    v_mov_b32 v193, -1
    v_mov_b32 v194, -1
    v_mov_b32 v195, -1
    v_lshlrev_b32 v196, 1, v8

k1_kernel_wf3:

    ds_read_b32 v12, v11 offset:12
    s_waitcnt lgkmcnt(0)
    v_readfirstlane_b32 s45, v12
    s_cmp_lt_u32 s45, 4
    s_cbranch_scc1 k1_kernel_wf3

    s_mov_b64 exec, s[48:49]

    s_waitcnt vmcnt(7)
    v_lshl_or_b32 v224, v225, 16, v224
    v_lshl_or_b32 v225, v227, 16, v226
    v_add_u32 v224, v32, v224
    v_add_u32 v225, v33, v225
    ds_write_b64 v34, v[224:225] offset:0

    s_waitcnt vmcnt(6)
    v_lshl_or_b32 v228, v229, 16, v228
    v_lshl_or_b32 v229, v231, 16, v230
    v_add_u32 v228, v32, v228
    v_add_u32 v229, v33, v229
    ds_write_b64 v34, v[228:229] offset:448

    s_waitcnt vmcnt(5)
    v_lshl_or_b32 v232, v233, 16, v232
    v_lshl_or_b32 v233, v235, 16, v234
    v_add_u32 v232, v32, v232
    v_add_u32 v233, v33, v233
    ds_write_b64 v34, v[232:233] offset:896

    s_waitcnt vmcnt(4)
    v_lshl_or_b32 v236, v237, 16, v236
    v_lshl_or_b32 v237, v239, 16, v238
    v_add_u32 v236, v32, v236
    v_add_u32 v237, v33, v237
    ds_write_b64 v34, v[236:237] offset:1344

    s_waitcnt vmcnt(3)
    v_lshl_or_b32 v240, v241, 16, v240
    v_lshl_or_b32 v241, v243, 16, v242
    v_add_u32 v240, v32, v240
    v_add_u32 v241, v33, v241
    ds_write_b64 v34, v[240:241] offset:1792

    s_waitcnt vmcnt(2)
    v_lshl_or_b32 v244, v245, 16, v244
    v_lshl_or_b32 v245, v247, 16, v246
    v_add_u32 v244, v32, v244
    v_add_u32 v245, v33, v245
    ds_write_b64 v34, v[244:245] offset:2240

    s_waitcnt vmcnt(1)
    v_lshl_or_b32 v248, v249, 16, v248
    v_lshl_or_b32 v249, v251, 16, v250
    v_add_u32 v248, v32, v248
    v_add_u32 v249, v33, v249
    ds_write_b64 v34, v[248:249] offset:2688

    s_waitcnt vmcnt(0)
    v_lshl_or_b32 v252, v253, 16, v252
    v_lshl_or_b32 v253, v255, 16, v254
    v_add_u32 v252, v32, v252
    v_add_u32 v253, v33, v253
    ds_write_b64 v34, v[252:253] offset:3136

    s_mov_b64 exec, -1
    ds_read_b64 v[40:41], v31 offset:0
    ds_read_b64 v[42:43], v31 offset:8
    ds_read_b64 v[44:45], v31 offset:16
    ds_read_b64 v[46:47], v31 offset:24
    ds_read_b64 v[48:49], v31 offset:32
    ds_read_b64 v[50:51], v31 offset:40
    ds_read_b64 v[52:53], v31 offset:48

    s_waitcnt lgkmcnt(6)
    v_and_b32 v72, s67, v40
    v_and_b32 v73, s67, v41
    v_lshl_or_b32 v72, v73, 10, v72
    v_lshlrev_b32_sdwa v73, 5, v72 dst_sel:DWORD dst_unused:UNUSED_PAD src0_sel:DWORD src1_sel:WORD_1
    v_or_b32_sdwa v64, v73, v72 dst_sel:DWORD dst_unused:UNUSED_PAD src0_sel:DWORD src1_sel:WORD_0
    v_perm_b32 v72, v41, v40, s75
    v_lshrrev_b32 v73, 3, v72
    v_and_b32 v72, 0x07070707, v72
    v_and_b32 v0, 0x03030303, v73
    v_perm_b32 v16, v55, v54, v72
    v_add_u32 v23, v54, v16

    s_waitcnt lgkmcnt(5)
    v_and_b32 v72, s67, v42
    v_and_b32 v73, s67, v43
    v_lshl_or_b32 v72, v73, 10, v72
    v_lshlrev_b32_sdwa v73, 5, v72 dst_sel:DWORD dst_unused:UNUSED_PAD src0_sel:DWORD src1_sel:WORD_1
    v_or_b32_sdwa v65, v73, v72 dst_sel:DWORD dst_unused:UNUSED_PAD src0_sel:DWORD src1_sel:WORD_0
    v_perm_b32 v72, v43, v42, s75
    v_lshrrev_b32 v73, 3, v72
    v_and_b32 v72, 0x07070707, v72
    v_and_b32 v1, 0x03030303, v73
    v_perm_b32 v17, v55, v54, v72
    v_add_u32 v24, v54, v17

    s_waitcnt lgkmcnt(4)
    v_and_b32 v72, s67, v44
    v_and_b32 v73, s67, v45
    v_lshl_or_b32 v72, v73, 10, v72
    v_lshlrev_b32_sdwa v73, 5, v72 dst_sel:DWORD dst_unused:UNUSED_PAD src0_sel:DWORD src1_sel:WORD_1
    v_or_b32_sdwa v66, v73, v72 dst_sel:DWORD dst_unused:UNUSED_PAD src0_sel:DWORD src1_sel:WORD_0
    v_perm_b32 v72, v45, v44, s75
    v_lshrrev_b32 v73, 3, v72
    v_and_b32 v72, 0x07070707, v72
    v_and_b32 v2, 0x03030303, v73
    v_perm_b32 v18, v55, v54, v72
    v_add_u32 v25, v54, v18

    s_waitcnt lgkmcnt(3)
    v_and_b32 v72, s67, v46
    v_and_b32 v73, s67, v47
    v_lshl_or_b32 v72, v73, 10, v72
    v_lshlrev_b32_sdwa v73, 5, v72 dst_sel:DWORD dst_unused:UNUSED_PAD src0_sel:DWORD src1_sel:WORD_1
    v_or_b32_sdwa v67, v73, v72 dst_sel:DWORD dst_unused:UNUSED_PAD src0_sel:DWORD src1_sel:WORD_0
    v_perm_b32 v72, v47, v46, s75
    v_lshrrev_b32 v73, 3, v72
    v_and_b32 v72, 0x07070707, v72
    v_and_b32 v3, 0x03030303, v73
    v_perm_b32 v19, v55, v54, v72
    v_add_u32 v26, v54, v19

    s_waitcnt lgkmcnt(2)
    v_and_b32 v72, s67, v48
    v_and_b32 v73, s67, v49
    v_lshl_or_b32 v72, v73, 10, v72
    v_lshlrev_b32_sdwa v73, 5, v72 dst_sel:DWORD dst_unused:UNUSED_PAD src0_sel:DWORD src1_sel:WORD_1
    v_or_b32_sdwa v68, v73, v72 dst_sel:DWORD dst_unused:UNUSED_PAD src0_sel:DWORD src1_sel:WORD_0
    v_perm_b32 v72, v49, v48, s75
    v_lshrrev_b32 v73, 3, v72
    v_and_b32 v72, 0x07070707, v72
    v_and_b32 v4, 0x03030303, v73
    v_perm_b32 v20, v55, v54, v72
    v_add_u32 v27, v54, v20

    s_waitcnt lgkmcnt(1)
    v_and_b32 v72, s67, v50
    v_and_b32 v73, s67, v51
    v_lshl_or_b32 v72, v73, 10, v72
    v_lshlrev_b32_sdwa v73, 5, v72 dst_sel:DWORD dst_unused:UNUSED_PAD src0_sel:DWORD src1_sel:WORD_1
    v_or_b32_sdwa v69, v73, v72 dst_sel:DWORD dst_unused:UNUSED_PAD src0_sel:DWORD src1_sel:WORD_0
    v_perm_b32 v72, v51, v50, s75
    v_lshrrev_b32 v73, 3, v72
    v_and_b32 v72, 0x07070707, v72
    v_and_b32 v5, 0x03030303, v73
    v_perm_b32 v21, v55, v54, v72
    v_add_u32 v28, v54, v21

    s_waitcnt lgkmcnt(0)
    v_and_b32 v72, s67, v52
    v_and_b32 v73, s67, v53
    v_lshl_or_b32 v72, v73, 10, v72
    v_lshlrev_b32_sdwa v73, 5, v72 dst_sel:DWORD dst_unused:UNUSED_PAD src0_sel:DWORD src1_sel:WORD_1
    v_or_b32_sdwa v70, v73, v72 dst_sel:DWORD dst_unused:UNUSED_PAD src0_sel:DWORD src1_sel:WORD_0
    v_perm_b32 v72, v53, v52, s75
    v_lshrrev_b32 v73, 3, v72
    v_and_b32 v72, 0x07070707, v72
    v_and_b32 v6, 0x03030303, v73
    v_perm_b32 v22, v55, v54, v72
    v_add_u32 v29, v54, v22

    ds_write_b32 v86, v13
    v_lshrrev_b32 v71, 4, v71
    v_or_b32 v71, 0xf00, v71
    v_lshlrev_b32 v74, 22, v64
    v_lshrrev_b32 v75, 10, v64
    v_lshl_or_b32 v75, v65, 10, v75

    v_ffbl_b32 v84, v71
    v_mul_u32_u24 v72, 5, v84
    v_lshrrev_b64 v[72:73], v72, v[74:75]
    v_and_or_b32 v72, v72, s66, v85
    ds_add_rtn_u32 v87, v72, v10
    ds_wrxchg_rtn_b32 v116, v86, v13
    v_and_b32 v117, 15, v71
    v_bcnt_u32_b32 v118, v117, 0
    v_cmp_eq_u32 vcc, 4, v118

    s_nop 1

    v_cndmask_b32 v119, v71, v117, vcc
    s_waitcnt lgkmcnt(0)
    v_cmp_gt_u32 s[68:69], 2, v116
    v_cmp_gt_u32 s[70:71], 2, v87

    s_nop 0
    v_lshrrev_b64 v[76:77], v123, s[68:69]
    v_perm_b32 v121, v76, v76, v1
    v_perm_b32 v122, v76, v76, v0
    v_and_b32 v121, v121, v17
    v_and_b32 v122, v122, v16
    v_msad_u8 v120, v24, v121, 0
    v_lshlrev_b32 v120, 4, v120
    v_msad_u8 v120, v23, v122, v120
    v_lshlrev_b32 v120, 4, v120

    v_and_b32 v120, v120, v119
    v_cmp_eq_u32 vcc, 0, v120
    v_ffbl_b32 v118, v120
    s_or_b64 vcc, vcc, s[70:71]
    v_cndmask_b32 v118, v118, v84, vcc
    v_lshlrev_b32 v72, v118, v10
    v_lshl_add_u32 v73, v118, 1, v31
    v_xor_b32 v71, v71, v72

    v_subrev_u32 v73, 8, v73
    ds_read_u16 v80, v73 offset:0
    s_setprio 0

    v_ffbl_b32 v84, v71
    v_mul_u32_u24 v72, 5, v84
    v_lshrrev_b64 v[72:73], v72, v[74:75]
    v_and_or_b32 v72, v72, s66, v85
    ds_add_rtn_u32 v87, v72, v10
    ds_wrxchg_rtn_b32 v116, v86, v13
    v_and_b32 v117, 15, v71
    v_bcnt_u32_b32 v118, v117, 0
    v_cmp_eq_u32 vcc, 3, v118

    s_lshl_b32 s45, s2, 8
    s_add_u32 s45, s45, 14680064
    buffer_store_dword v13, v13, s[12:15], s45 offen sc1
    buffer_load_dwordx4 v[128:131], v9, s[28:31], s77 offen offset:0

    v_cndmask_b32 v119, v71, v117, vcc
    s_waitcnt lgkmcnt(0)
    v_cmp_gt_u32 s[68:69], 2, v116
    v_cmp_gt_u32 s[70:71], 2, v87

    s_nop 0
    v_lshrrev_b64 v[76:77], v123, s[68:69]
    v_perm_b32 v121, v76, v76, v1
    v_perm_b32 v122, v76, v76, v0
    v_and_b32 v121, v121, v17
    v_and_b32 v122, v122, v16
    v_msad_u8 v120, v24, v121, 0
    v_lshlrev_b32 v120, 4, v120
    v_msad_u8 v120, v23, v122, v120
    v_lshlrev_b32 v120, 4, v120

    v_and_b32 v120, v120, v119
    v_cmp_eq_u32 vcc, 0, v120
    v_ffbl_b32 v118, v120
    s_or_b64 vcc, vcc, s[70:71]
    v_cndmask_b32 v118, v118, v84, vcc
    v_lshlrev_b32 v72, v118, v10
    v_lshl_add_u32 v73, v118, 1, v31
    v_xor_b32 v71, v71, v72

    v_subrev_u32 v73, 8, v73
    ds_read_u16 v81, v73 offset:0

    v_ffbl_b32 v84, v71
    v_mul_u32_u24 v72, 5, v84
    v_lshrrev_b64 v[72:73], v72, v[74:75]
    v_and_or_b32 v72, v72, s66, v85
    ds_add_rtn_u32 v87, v72, v10
    ds_wrxchg_rtn_b32 v116, v86, v13
    v_and_b32 v117, 15, v71
    v_bcnt_u32_b32 v118, v117, 0
    v_cmp_eq_u32 vcc, 2, v118

    buffer_load_dwordx4 v[132:135], v9, s[28:31], s77 offen offset:1024

    v_cndmask_b32 v119, v71, v117, vcc
    s_waitcnt lgkmcnt(0)
    v_cmp_gt_u32 s[68:69], 2, v116
    v_cmp_gt_u32 s[70:71], 2, v87

    s_nop 0
    v_lshrrev_b64 v[76:77], v123, s[68:69]
    v_perm_b32 v121, v76, v76, v1
    v_perm_b32 v122, v76, v76, v0
    v_and_b32 v121, v121, v17
    v_and_b32 v122, v122, v16
    v_msad_u8 v120, v24, v121, 0
    v_lshlrev_b32 v120, 4, v120
    v_msad_u8 v120, v23, v122, v120
    v_lshlrev_b32 v120, 4, v120

    v_and_b32 v120, v120, v119
    v_cmp_eq_u32 vcc, 0, v120
    v_ffbl_b32 v118, v120
    s_or_b64 vcc, vcc, s[70:71]
    v_cndmask_b32 v118, v118, v84, vcc
    v_lshlrev_b32 v72, v118, v10
    v_lshl_add_u32 v73, v118, 1, v31
    v_xor_b32 v71, v71, v72

    v_subrev_u32 v73, 8, v73
    ds_read_u16 v82, v73 offset:0

    v_ffbl_b32 v84, v71
    v_mul_u32_u24 v72, 5, v84
    v_lshrrev_b64 v[72:73], v72, v[74:75]
    v_and_or_b32 v72, v72, s66, v85
    ds_add_rtn_u32 v87, v72, v10
    ds_wrxchg_rtn_b32 v116, v86, v13
    v_and_b32 v117, 15, v71
    v_bcnt_u32_b32 v118, v117, 0
    v_cmp_eq_u32 vcc, 1, v118

    buffer_load_dwordx4 v[136:139], v9, s[28:31], s77 offen offset:2048

    v_cndmask_b32 v119, v71, v117, vcc
    s_waitcnt lgkmcnt(0)
    v_cmp_gt_u32 s[68:69], 2, v116
    v_cmp_gt_u32 s[70:71], 2, v87

    s_nop 0
    v_lshrrev_b64 v[76:77], v123, s[68:69]
    v_perm_b32 v121, v76, v76, v1
    v_perm_b32 v122, v76, v76, v0
    v_and_b32 v121, v121, v17
    v_and_b32 v122, v122, v16
    v_msad_u8 v120, v24, v121, 0
    v_lshlrev_b32 v120, 4, v120
    v_msad_u8 v120, v23, v122, v120
    v_lshlrev_b32 v120, 4, v120

    v_and_b32 v120, v120, v119
    v_cmp_eq_u32 vcc, 0, v120
    v_ffbl_b32 v118, v120
    s_or_b64 vcc, vcc, s[70:71]
    v_cndmask_b32 v118, v118, v84, vcc
    v_lshlrev_b32 v72, v118, v10
    v_lshl_add_u32 v73, v118, 1, v31
    v_xor_b32 v71, v71, v72

    v_subrev_u32 v73, 8, v73
    ds_read_u16 v83, v73 offset:0
    v_lshrrev_b32 v71, 4, v71
    v_or_b32 v71, 0xf00, v71
    v_lshlrev_b32 v74, 22, v65
    v_lshl_or_b32 v74, v64, 2, v74
    v_lshrrev_b32 v75, 10, v65
    v_lshl_or_b32 v75, v66, 10, v75

    v_ffbl_b32 v84, v71
    v_mul_u32_u24 v72, 5, v84
    v_lshrrev_b64 v[72:73], v72, v[74:75]
    v_and_or_b32 v72, v72, s66, v85
    ds_add_rtn_u32 v87, v72, v10
    ds_wrxchg_rtn_b32 v116, v86, v13
    v_and_b32 v117, 15, v71
    v_bcnt_u32_b32 v118, v117, 0
    v_cmp_eq_u32 vcc, 4, v118

    buffer_load_dwordx4 v[140:143], v9, s[28:31], s77 offen offset:3072
    s_add_u32 s77, s77, 4096

    v_cndmask_b32 v119, v71, v117, vcc
    s_waitcnt lgkmcnt(0)
    v_cmp_gt_u32 s[68:69], 2, v116
    v_cmp_gt_u32 s[70:71], 2, v87

    v_lshl_or_b32 v78, v81, 16, v80
    v_lshl_or_b32 v79, v83, 16, v82
    buffer_store_dwordx2 v[78:79], v30, s[32:35], s62 offen sc1
    s_add_u32 s62, s62, 65536
    v_lshrrev_b64 v[76:77], v123, s[68:69]
    v_perm_b32 v121, v76, v76, v2
    v_perm_b32 v122, v76, v76, v1
    v_perm_b32 v77, v76, v76, v0
    v_and_b32 v121, v121, v18
    v_and_b32 v122, v122, v17
    v_and_b32 v77, v77, v16
    v_msad_u8 v120, v25, v121, 0
    v_lshlrev_b32 v120, 4, v120
    v_msad_u8 v120, v24, v122, v120
    v_lshlrev_b32 v120, 4, v120
    v_msad_u8 v120, v23, v77, v120

    v_and_b32 v120, v120, v119
    v_cmp_eq_u32 vcc, 0, v120
    v_ffbl_b32 v118, v120
    s_or_b64 vcc, vcc, s[70:71]
    v_cndmask_b32 v118, v118, v84, vcc
    v_lshlrev_b32 v72, v118, v10
    v_lshl_add_u32 v73, v118, 1, v31
    v_xor_b32 v71, v71, v72

    ds_read_u16 v80, v73 offset:0

    v_ffbl_b32 v84, v71
    v_mul_u32_u24 v72, 5, v84
    v_lshrrev_b64 v[72:73], v72, v[74:75]
    v_and_or_b32 v72, v72, s66, v85
    ds_add_rtn_u32 v87, v72, v10
    ds_wrxchg_rtn_b32 v116, v86, v13
    v_and_b32 v117, 15, v71
    v_bcnt_u32_b32 v118, v117, 0
    v_cmp_eq_u32 vcc, 3, v118

    buffer_load_dwordx4 v[144:147], v9, s[28:31], s77 offen offset:0
    s_add_u32 s47, s44, 12288
    buffer_load_dwordx4 v[56:59], v7, s[20:23], s47 offen offset:0
    buffer_load_dwordx4 v[60:63], v7, s[20:23], s47 offen offset:64

    v_cndmask_b32 v119, v71, v117, vcc
    s_waitcnt lgkmcnt(0)
    v_cmp_gt_u32 s[68:69], 2, v116
    v_cmp_gt_u32 s[70:71], 2, v87

    s_nop 0
    v_lshrrev_b64 v[76:77], v123, s[68:69]
    v_perm_b32 v121, v76, v76, v2
    v_perm_b32 v122, v76, v76, v1
    v_perm_b32 v77, v76, v76, v0
    v_and_b32 v121, v121, v18
    v_and_b32 v122, v122, v17
    v_and_b32 v77, v77, v16
    v_msad_u8 v120, v25, v121, 0
    v_lshlrev_b32 v120, 4, v120
    v_msad_u8 v120, v24, v122, v120
    v_lshlrev_b32 v120, 4, v120
    v_msad_u8 v120, v23, v77, v120

    v_and_b32 v120, v120, v119
    v_cmp_eq_u32 vcc, 0, v120
    v_ffbl_b32 v118, v120
    s_or_b64 vcc, vcc, s[70:71]
    v_cndmask_b32 v118, v118, v84, vcc
    v_lshlrev_b32 v72, v118, v10
    v_lshl_add_u32 v73, v118, 1, v31
    v_xor_b32 v71, v71, v72

    ds_read_u16 v81, v73 offset:0

    v_ffbl_b32 v84, v71
    v_mul_u32_u24 v72, 5, v84
    v_lshrrev_b64 v[72:73], v72, v[74:75]
    v_and_or_b32 v72, v72, s66, v85
    ds_add_rtn_u32 v87, v72, v10
    ds_wrxchg_rtn_b32 v116, v86, v13
    v_and_b32 v117, 15, v71
    v_bcnt_u32_b32 v118, v117, 0
    v_cmp_eq_u32 vcc, 2, v118

    buffer_load_dwordx4 v[148:151], v9, s[28:31], s77 offen offset:1024
    s_add_u32 s47, s44, 16384
    buffer_load_dwordx4 v[88:91], v7, s[20:23], s47 offen offset:0
    buffer_load_dwordx4 v[92:95], v7, s[20:23], s47 offen offset:64

    v_cndmask_b32 v119, v71, v117, vcc
    s_waitcnt lgkmcnt(0)
    v_cmp_gt_u32 s[68:69], 2, v116
    v_cmp_gt_u32 s[70:71], 2, v87

    s_nop 0
    v_lshrrev_b64 v[76:77], v123, s[68:69]
    v_perm_b32 v121, v76, v76, v2
    v_perm_b32 v122, v76, v76, v1
    v_perm_b32 v77, v76, v76, v0
    v_and_b32 v121, v121, v18
    v_and_b32 v122, v122, v17
    v_and_b32 v77, v77, v16
    v_msad_u8 v120, v25, v121, 0
    v_lshlrev_b32 v120, 4, v120
    v_msad_u8 v120, v24, v122, v120
    v_lshlrev_b32 v120, 4, v120
    v_msad_u8 v120, v23, v77, v120

    v_and_b32 v120, v120, v119
    v_cmp_eq_u32 vcc, 0, v120
    v_ffbl_b32 v118, v120
    s_or_b64 vcc, vcc, s[70:71]
    v_cndmask_b32 v118, v118, v84, vcc
    v_lshlrev_b32 v72, v118, v10
    v_lshl_add_u32 v73, v118, 1, v31
    v_xor_b32 v71, v71, v72

    ds_read_u16 v82, v73 offset:0

    v_ffbl_b32 v84, v71
    v_mul_u32_u24 v72, 5, v84
    v_lshrrev_b64 v[72:73], v72, v[74:75]
    v_and_or_b32 v72, v72, s66, v85
    ds_add_rtn_u32 v87, v72, v10
    ds_wrxchg_rtn_b32 v116, v86, v13
    v_and_b32 v117, 15, v71
    v_bcnt_u32_b32 v118, v117, 0
    v_cmp_eq_u32 vcc, 1, v118

    buffer_load_dwordx4 v[152:155], v9, s[28:31], s77 offen offset:2048
    s_add_u32 s47, s44, 20480
    buffer_load_dwordx4 v[96:99], v7, s[20:23], s47 offen offset:0
    buffer_load_dwordx4 v[100:103], v7, s[20:23], s47 offen offset:64

    v_cndmask_b32 v119, v71, v117, vcc
    s_waitcnt lgkmcnt(0)
    v_cmp_gt_u32 s[68:69], 2, v116
    v_cmp_gt_u32 s[70:71], 2, v87

    s_nop 0
    v_lshrrev_b64 v[76:77], v123, s[68:69]
    v_perm_b32 v121, v76, v76, v2
    v_perm_b32 v122, v76, v76, v1
    v_perm_b32 v77, v76, v76, v0
    v_and_b32 v121, v121, v18
    v_and_b32 v122, v122, v17
    v_and_b32 v77, v77, v16
    v_msad_u8 v120, v25, v121, 0
    v_lshlrev_b32 v120, 4, v120
    v_msad_u8 v120, v24, v122, v120
    v_lshlrev_b32 v120, 4, v120
    v_msad_u8 v120, v23, v77, v120

    v_and_b32 v120, v120, v119
    v_cmp_eq_u32 vcc, 0, v120
    v_ffbl_b32 v118, v120
    s_or_b64 vcc, vcc, s[70:71]
    v_cndmask_b32 v118, v118, v84, vcc
    v_lshlrev_b32 v72, v118, v10
    v_lshl_add_u32 v73, v118, 1, v31
    v_xor_b32 v71, v71, v72

    ds_read_u16 v83, v73 offset:0
    v_lshrrev_b32 v71, 4, v71
    v_or_b32 v71, 0xf00, v71
    v_lshlrev_b32 v74, 22, v66
    v_lshl_or_b32 v74, v65, 2, v74
    v_lshrrev_b32 v75, 10, v66
    v_lshl_or_b32 v75, v67, 10, v75

    v_ffbl_b32 v84, v71
    v_mul_u32_u24 v72, 5, v84
    v_lshrrev_b64 v[72:73], v72, v[74:75]
    v_and_or_b32 v72, v72, s66, v85
    ds_add_rtn_u32 v87, v72, v10
    ds_wrxchg_rtn_b32 v116, v86, v13
    v_and_b32 v117, 15, v71
    v_bcnt_u32_b32 v118, v117, 0
    v_cmp_eq_u32 vcc, 4, v118

    buffer_load_dwordx4 v[156:159], v9, s[28:31], s77 offen offset:3072
    s_add_u32 s77, s77, 126976
    s_cmp_lg_u32 s64, 0
    s_cbranch_scc1 k1_kernel_nc8
    buffer_store_short v192, v196, s[12:15], s73 offen sc1
k1_kernel_nc8:
    s_add_u32 s47, s44, 24576
    buffer_load_dwordx4 v[104:107], v7, s[20:23], s47 offen offset:0
    buffer_load_dwordx4 v[108:111], v7, s[20:23], s47 offen offset:64

    v_cndmask_b32 v119, v71, v117, vcc
    s_waitcnt lgkmcnt(0)
    v_cmp_gt_u32 s[68:69], 2, v116
    v_cmp_gt_u32 s[70:71], 2, v87

    v_lshl_or_b32 v78, v81, 16, v80
    v_lshl_or_b32 v79, v83, 16, v82
    buffer_store_dwordx2 v[78:79], v30, s[32:35], s62 offen sc1
    s_add_u32 s62, s62, 65536
    v_lshrrev_b64 v[76:77], v123, s[68:69]
    v_perm_b32 v121, v76, v76, v3
    v_perm_b32 v122, v76, v76, v2
    v_perm_b32 v77, v76, v76, v1
    v_and_b32 v121, v121, v19
    v_and_b32 v122, v122, v18
    v_and_b32 v77, v77, v17
    v_msad_u8 v120, v26, v121, 0
    v_lshlrev_b32 v120, 4, v120
    v_msad_u8 v120, v25, v122, v120
    v_lshlrev_b32 v120, 4, v120
    v_msad_u8 v120, v24, v77, v120

    v_and_b32 v120, v120, v119
    v_cmp_eq_u32 vcc, 0, v120
    v_ffbl_b32 v118, v120
    s_or_b64 vcc, vcc, s[70:71]
    v_cndmask_b32 v118, v118, v84, vcc
    v_lshlrev_b32 v72, v118, v10
    v_lshl_add_u32 v73, v118, 1, v31
    v_xor_b32 v71, v71, v72

    ds_read_u16 v80, v73 offset:8

    v_ffbl_b32 v84, v71
    v_mul_u32_u24 v72, 5, v84
    v_lshrrev_b64 v[72:73], v72, v[74:75]
    v_and_or_b32 v72, v72, s66, v85
    ds_add_rtn_u32 v87, v72, v10
    ds_wrxchg_rtn_b32 v116, v86, v13
    v_and_b32 v117, 15, v71
    v_bcnt_u32_b32 v118, v117, 0
    v_cmp_eq_u32 vcc, 3, v118

    buffer_load_dwordx4 v[160:163], v9, s[28:31], s77 offen offset:0
    s_add_u32 s47, s44, 28672
    buffer_load_dwordx4 v[112:115], v7, s[20:23], s47 offen offset:0
    buffer_load_dwordx4 v[124:127], v7, s[20:23], s47 offen offset:64

    v_cndmask_b32 v119, v71, v117, vcc
    s_waitcnt lgkmcnt(0)
    v_cmp_gt_u32 s[68:69], 2, v116
    v_cmp_gt_u32 s[70:71], 2, v87

    s_nop 0
    v_lshrrev_b64 v[76:77], v123, s[68:69]
    v_perm_b32 v121, v76, v76, v3
    v_perm_b32 v122, v76, v76, v2
    v_perm_b32 v77, v76, v76, v1
    v_and_b32 v121, v121, v19
    v_and_b32 v122, v122, v18
    v_and_b32 v77, v77, v17
    v_msad_u8 v120, v26, v121, 0
    v_lshlrev_b32 v120, 4, v120
    v_msad_u8 v120, v25, v122, v120
    v_lshlrev_b32 v120, 4, v120
    v_msad_u8 v120, v24, v77, v120

    v_and_b32 v120, v120, v119
    v_cmp_eq_u32 vcc, 0, v120
    v_ffbl_b32 v118, v120
    s_or_b64 vcc, vcc, s[70:71]
    v_cndmask_b32 v118, v118, v84, vcc
    v_lshlrev_b32 v72, v118, v10
    v_lshl_add_u32 v73, v118, 1, v31
    v_xor_b32 v71, v71, v72

    ds_read_u16 v81, v73 offset:8

    v_ffbl_b32 v84, v71
    v_mul_u32_u24 v72, 5, v84
    v_lshrrev_b64 v[72:73], v72, v[74:75]
    v_and_or_b32 v72, v72, s66, v85
    ds_add_rtn_u32 v87, v72, v10
    ds_wrxchg_rtn_b32 v116, v86, v13
    v_and_b32 v117, 15, v71
    v_bcnt_u32_b32 v118, v117, 0
    v_cmp_eq_u32 vcc, 2, v118

    buffer_load_dwordx4 v[164:167], v9, s[28:31], s77 offen offset:1024

    v_cndmask_b32 v119, v71, v117, vcc
    s_waitcnt lgkmcnt(0)
    v_cmp_gt_u32 s[68:69], 2, v116
    v_cmp_gt_u32 s[70:71], 2, v87

    s_nop 0
    v_lshrrev_b64 v[76:77], v123, s[68:69]
    v_perm_b32 v121, v76, v76, v3
    v_perm_b32 v122, v76, v76, v2
    v_perm_b32 v77, v76, v76, v1
    v_and_b32 v121, v121, v19
    v_and_b32 v122, v122, v18
    v_and_b32 v77, v77, v17
    v_msad_u8 v120, v26, v121, 0
    v_lshlrev_b32 v120, 4, v120
    v_msad_u8 v120, v25, v122, v120
    v_lshlrev_b32 v120, 4, v120
    v_msad_u8 v120, v24, v77, v120

    v_and_b32 v120, v120, v119
    v_cmp_eq_u32 vcc, 0, v120
    v_ffbl_b32 v118, v120
    s_or_b64 vcc, vcc, s[70:71]
    v_cndmask_b32 v118, v118, v84, vcc
    v_lshlrev_b32 v72, v118, v10
    v_lshl_add_u32 v73, v118, 1, v31
    v_xor_b32 v71, v71, v72

    ds_read_u16 v82, v73 offset:8

    v_ffbl_b32 v84, v71
    v_mul_u32_u24 v72, 5, v84
    v_lshrrev_b64 v[72:73], v72, v[74:75]
    v_and_or_b32 v72, v72, s66, v85
    ds_add_rtn_u32 v87, v72, v10
    ds_wrxchg_rtn_b32 v116, v86, v13
    v_and_b32 v117, 15, v71
    v_bcnt_u32_b32 v118, v117, 0
    v_cmp_eq_u32 vcc, 1, v118

    buffer_load_dwordx4 v[168:171], v9, s[28:31], s77 offen offset:2048

    v_cndmask_b32 v119, v71, v117, vcc
    s_waitcnt lgkmcnt(0)
    v_cmp_gt_u32 s[68:69], 2, v116
    v_cmp_gt_u32 s[70:71], 2, v87

    s_nop 0
    v_lshrrev_b64 v[76:77], v123, s[68:69]
    v_perm_b32 v121, v76, v76, v3
    v_perm_b32 v122, v76, v76, v2
    v_perm_b32 v77, v76, v76, v1
    v_and_b32 v121, v121, v19
    v_and_b32 v122, v122, v18
    v_and_b32 v77, v77, v17
    v_msad_u8 v120, v26, v121, 0
    v_lshlrev_b32 v120, 4, v120
    v_msad_u8 v120, v25, v122, v120
    v_lshlrev_b32 v120, 4, v120
    v_msad_u8 v120, v24, v77, v120

    v_and_b32 v120, v120, v119
    v_cmp_eq_u32 vcc, 0, v120
    v_ffbl_b32 v118, v120
    s_or_b64 vcc, vcc, s[70:71]
    v_cndmask_b32 v118, v118, v84, vcc
    v_lshlrev_b32 v72, v118, v10
    v_lshl_add_u32 v73, v118, 1, v31
    v_xor_b32 v71, v71, v72

    ds_read_u16 v83, v73 offset:8
    v_lshrrev_b32 v71, 4, v71
    v_or_b32 v71, 0xf00, v71
    v_lshlrev_b32 v74, 22, v67
    v_lshl_or_b32 v74, v66, 2, v74
    v_lshrrev_b32 v75, 10, v67
    v_lshl_or_b32 v75, v68, 10, v75

    v_ffbl_b32 v84, v71
    v_mul_u32_u24 v72, 5, v84
    v_lshrrev_b64 v[72:73], v72, v[74:75]
    v_and_or_b32 v72, v72, s66, v85
    ds_add_rtn_u32 v87, v72, v10
    ds_wrxchg_rtn_b32 v116, v86, v13
    v_and_b32 v117, 15, v71
    v_bcnt_u32_b32 v118, v117, 0
    v_cmp_eq_u32 vcc, 4, v118

    buffer_load_dwordx4 v[172:175], v9, s[28:31], s77 offen offset:3072
    s_add_u32 s77, s77, 4096

    v_cndmask_b32 v119, v71, v117, vcc
    s_waitcnt lgkmcnt(0)
    v_cmp_gt_u32 s[68:69], 2, v116
    v_cmp_gt_u32 s[70:71], 2, v87

    v_lshl_or_b32 v78, v81, 16, v80
    v_lshl_or_b32 v79, v83, 16, v82
    buffer_store_dwordx2 v[78:79], v30, s[32:35], s62 offen sc1
    s_add_u32 s62, s62, 65536
    v_lshrrev_b64 v[76:77], v123, s[68:69]
    v_perm_b32 v121, v76, v76, v4
    v_perm_b32 v122, v76, v76, v3
    v_perm_b32 v77, v76, v76, v2
    v_and_b32 v121, v121, v20
    v_and_b32 v122, v122, v19
    v_and_b32 v77, v77, v18
    v_msad_u8 v120, v27, v121, 0
    v_lshlrev_b32 v120, 4, v120
    v_msad_u8 v120, v26, v122, v120
    v_lshlrev_b32 v120, 4, v120
    v_msad_u8 v120, v25, v77, v120

    v_and_b32 v120, v120, v119
    v_cmp_eq_u32 vcc, 0, v120
    v_ffbl_b32 v118, v120
    s_or_b64 vcc, vcc, s[70:71]
    v_cndmask_b32 v118, v118, v84, vcc
    v_lshlrev_b32 v72, v118, v10
    v_lshl_add_u32 v73, v118, 1, v31
    v_xor_b32 v71, v71, v72

    ds_read_u16 v80, v73 offset:16

    v_ffbl_b32 v84, v71
    v_mul_u32_u24 v72, 5, v84
    v_lshrrev_b64 v[72:73], v72, v[74:75]
    v_and_or_b32 v72, v72, s66, v85
    ds_add_rtn_u32 v87, v72, v10
    ds_wrxchg_rtn_b32 v116, v86, v13
    v_and_b32 v117, 15, v71
    v_bcnt_u32_b32 v118, v117, 0
    v_cmp_eq_u32 vcc, 3, v118

    buffer_load_dwordx4 v[176:179], v9, s[28:31], s77 offen offset:0

    v_cndmask_b32 v119, v71, v117, vcc
    s_waitcnt lgkmcnt(0)
    v_cmp_gt_u32 s[68:69], 2, v116
    v_cmp_gt_u32 s[70:71], 2, v87

    s_nop 0
    v_lshrrev_b64 v[76:77], v123, s[68:69]
    v_perm_b32 v121, v76, v76, v4
    v_perm_b32 v122, v76, v76, v3
    v_perm_b32 v77, v76, v76, v2
    v_and_b32 v121, v121, v20
    v_and_b32 v122, v122, v19
    v_and_b32 v77, v77, v18
    v_msad_u8 v120, v27, v121, 0
    v_lshlrev_b32 v120, 4, v120
    v_msad_u8 v120, v26, v122, v120
    v_lshlrev_b32 v120, 4, v120
    v_msad_u8 v120, v25, v77, v120

    v_and_b32 v120, v120, v119
    v_cmp_eq_u32 vcc, 0, v120
    v_ffbl_b32 v118, v120
    s_or_b64 vcc, vcc, s[70:71]
    v_cndmask_b32 v118, v118, v84, vcc
    v_lshlrev_b32 v72, v118, v10
    v_lshl_add_u32 v73, v118, 1, v31
    v_xor_b32 v71, v71, v72

    ds_read_u16 v81, v73 offset:16

    v_ffbl_b32 v84, v71
    v_mul_u32_u24 v72, 5, v84
    v_lshrrev_b64 v[72:73], v72, v[74:75]
    v_and_or_b32 v72, v72, s66, v85
    ds_add_rtn_u32 v87, v72, v10
    ds_wrxchg_rtn_b32 v116, v86, v13
    v_and_b32 v117, 15, v71
    v_bcnt_u32_b32 v118, v117, 0
    v_cmp_eq_u32 vcc, 2, v118

    buffer_load_dwordx4 v[180:183], v9, s[28:31], s77 offen offset:1024

    v_cndmask_b32 v119, v71, v117, vcc
    s_waitcnt lgkmcnt(0)
    v_cmp_gt_u32 s[68:69], 2, v116
    v_cmp_gt_u32 s[70:71], 2, v87

    s_nop 0
    v_lshrrev_b64 v[76:77], v123, s[68:69]
    v_perm_b32 v121, v76, v76, v4
    v_perm_b32 v122, v76, v76, v3
    v_perm_b32 v77, v76, v76, v2
    v_and_b32 v121, v121, v20
    v_and_b32 v122, v122, v19
    v_and_b32 v77, v77, v18
    v_msad_u8 v120, v27, v121, 0
    v_lshlrev_b32 v120, 4, v120
    v_msad_u8 v120, v26, v122, v120
    v_lshlrev_b32 v120, 4, v120
    v_msad_u8 v120, v25, v77, v120

    v_and_b32 v120, v120, v119
    v_cmp_eq_u32 vcc, 0, v120
    v_ffbl_b32 v118, v120
    s_or_b64 vcc, vcc, s[70:71]
    v_cndmask_b32 v118, v118, v84, vcc
    v_lshlrev_b32 v72, v118, v10
    v_lshl_add_u32 v73, v118, 1, v31
    v_xor_b32 v71, v71, v72

    ds_read_u16 v82, v73 offset:16

    v_ffbl_b32 v84, v71
    v_mul_u32_u24 v72, 5, v84
    v_lshrrev_b64 v[72:73], v72, v[74:75]
    v_and_or_b32 v72, v72, s66, v85
    ds_add_rtn_u32 v87, v72, v10
    ds_wrxchg_rtn_b32 v116, v86, v13
    v_and_b32 v117, 15, v71
    v_bcnt_u32_b32 v118, v117, 0
    v_cmp_eq_u32 vcc, 1, v118

    buffer_load_dwordx4 v[184:187], v9, s[28:31], s77 offen offset:2048

    v_cndmask_b32 v119, v71, v117, vcc
    s_waitcnt lgkmcnt(0)
    v_cmp_gt_u32 s[68:69], 2, v116
    v_cmp_gt_u32 s[70:71], 2, v87

    s_nop 0
    v_lshrrev_b64 v[76:77], v123, s[68:69]
    v_perm_b32 v121, v76, v76, v4
    v_perm_b32 v122, v76, v76, v3
    v_perm_b32 v77, v76, v76, v2
    v_and_b32 v121, v121, v20
    v_and_b32 v122, v122, v19
    v_and_b32 v77, v77, v18
    v_msad_u8 v120, v27, v121, 0
    v_lshlrev_b32 v120, 4, v120
    v_msad_u8 v120, v26, v122, v120
    v_lshlrev_b32 v120, 4, v120
    v_msad_u8 v120, v25, v77, v120

    v_and_b32 v120, v120, v119
    v_cmp_eq_u32 vcc, 0, v120
    v_ffbl_b32 v118, v120
    s_or_b64 vcc, vcc, s[70:71]
    v_cndmask_b32 v118, v118, v84, vcc
    v_lshlrev_b32 v72, v118, v10
    v_lshl_add_u32 v73, v118, 1, v31
    v_xor_b32 v71, v71, v72

    ds_read_u16 v83, v73 offset:16
    v_lshrrev_b32 v71, 4, v71
    v_or_b32 v71, 0xf00, v71
    v_lshlrev_b32 v74, 22, v68
    v_lshl_or_b32 v74, v67, 2, v74
    v_lshrrev_b32 v75, 10, v68
    v_lshl_or_b32 v75, v69, 10, v75

    v_ffbl_b32 v84, v71
    v_mul_u32_u24 v72, 5, v84
    v_lshrrev_b64 v[72:73], v72, v[74:75]
    v_and_or_b32 v72, v72, s66, v85
    ds_add_rtn_u32 v87, v72, v10
    ds_wrxchg_rtn_b32 v116, v86, v13
    v_and_b32 v117, 15, v71
    v_bcnt_u32_b32 v118, v117, 0
    v_cmp_eq_u32 vcc, 4, v118

    buffer_load_dwordx4 v[188:191], v9, s[28:31], s77 offen offset:3072

    v_cndmask_b32 v119, v71, v117, vcc
    s_waitcnt lgkmcnt(0)
    v_cmp_gt_u32 s[68:69], 2, v116
    v_cmp_gt_u32 s[70:71], 2, v87

    v_lshl_or_b32 v78, v81, 16, v80
    v_lshl_or_b32 v79, v83, 16, v82
    buffer_store_dwordx2 v[78:79], v30, s[32:35], s62 offen sc1
    s_add_u32 s62, s62, 65536
    v_lshrrev_b64 v[76:77], v123, s[68:69]
    v_perm_b32 v121, v76, v76, v5
    v_perm_b32 v122, v76, v76, v4
    v_perm_b32 v77, v76, v76, v3
    v_and_b32 v121, v121, v21
    v_and_b32 v122, v122, v20
    v_and_b32 v77, v77, v19
    v_msad_u8 v120, v28, v121, 0
    v_lshlrev_b32 v120, 4, v120
    v_msad_u8 v120, v27, v122, v120
    v_lshlrev_b32 v120, 4, v120
    v_msad_u8 v120, v26, v77, v120

    v_and_b32 v120, v120, v119
    v_cmp_eq_u32 vcc, 0, v120
    v_ffbl_b32 v118, v120
    s_or_b64 vcc, vcc, s[70:71]
    v_cndmask_b32 v118, v118, v84, vcc
    v_lshlrev_b32 v72, v118, v10
    v_lshl_add_u32 v73, v118, 1, v31
    v_xor_b32 v71, v71, v72

    ds_read_u16 v80, v73 offset:24
    s_setprio 1

    s_cmp_ge_u32 s57, 800
    s_cbranch_scc1 k1_kernel_norl
    s_waitcnt vmcnt(0)

    v_perm_b32 v192, v132, v128, s84
    v_perm_b32 v193, v140, v136, s84
    v_perm_b32 v194, v148, v144, s84
    v_perm_b32 v195, v156, v152, s84
    v_perm_b32 v196, v132, v128, s85
    v_perm_b32 v197, v140, v136, s85
    v_perm_b32 v198, v148, v144, s85
    v_perm_b32 v199, v156, v152, s85
    v_perm_b32 v200, v133, v129, s84
    v_perm_b32 v201, v141, v137, s84
    v_perm_b32 v202, v149, v145, s84
    v_perm_b32 v203, v157, v153, s84
    v_perm_b32 v204, v133, v129, s85
    v_perm_b32 v205, v141, v137, s85
    v_perm_b32 v206, v149, v145, s85
    v_perm_b32 v207, v157, v153, s85
    ds_write_b128 v36, v[192:195]
    ds_write_b128 v37, v[196:199]
    ds_write_b128 v38, v[200:203]
    ds_write_b128 v39, v[204:207]
    ds_read_b128 v[224:227], v15 offset:0
    ds_read_b128 v[228:231], v15 offset:1024
    ds_read_b128 v[232:235], v15 offset:2048
    ds_read_b128 v[236:239], v15 offset:3072
    v_perm_b32 v208, v164, v160, s84
    v_perm_b32 v209, v172, v168, s84
    v_perm_b32 v210, v180, v176, s84
    v_perm_b32 v211, v188, v184, s84
    v_perm_b32 v212, v164, v160, s85
    v_perm_b32 v213, v172, v168, s85
    v_perm_b32 v214, v180, v176, s85
    v_perm_b32 v215, v188, v184, s85
    v_perm_b32 v216, v165, v161, s84
    v_perm_b32 v217, v173, v169, s84
    v_perm_b32 v218, v181, v177, s84
    v_perm_b32 v219, v189, v185, s84
    v_perm_b32 v220, v165, v161, s85
    v_perm_b32 v221, v173, v169, s85
    v_perm_b32 v222, v181, v177, s85
    v_perm_b32 v223, v189, v185, s85
    s_waitcnt lgkmcnt(0)
    s_add_u32 s83, s82, 0
    buffer_store_dwordx4 v[224:227], v14, s[32:35], s83 offen sc1
    s_add_u32 s83, s82, 3284992
    buffer_store_dwordx4 v[228:231], v14, s[32:35], s83 offen sc1
    s_add_u32 s83, s82, 6569984
    buffer_store_dwordx4 v[232:235], v14, s[32:35], s83 offen sc1
    s_add_u32 s83, s82, 9854976
    buffer_store_dwordx4 v[236:239], v14, s[32:35], s83 offen sc1
    ds_write_b128 v36, v[208:211]
    ds_write_b128 v37, v[212:215]
    ds_write_b128 v38, v[216:219]
    ds_write_b128 v39, v[220:223]
    ds_read_b128 v[240:243], v15 offset:0
    ds_read_b128 v[244:247], v15 offset:1024
    ds_read_b128 v[248:251], v15 offset:2048
    ds_read_b128 v[252:255], v15 offset:3072
    v_perm_b32 v192, v134, v130, s84
    v_perm_b32 v193, v142, v138, s84
    v_perm_b32 v194, v150, v146, s84
    v_perm_b32 v195, v158, v154, s84
    v_perm_b32 v196, v134, v130, s85
    v_perm_b32 v197, v142, v138, s85
    v_perm_b32 v198, v150, v146, s85
    v_perm_b32 v199, v158, v154, s85
    v_perm_b32 v200, v135, v131, s84
    v_perm_b32 v201, v143, v139, s84
    v_perm_b32 v202, v151, v147, s84
    v_perm_b32 v203, v159, v155, s84
    v_perm_b32 v204, v135, v131, s85
    v_perm_b32 v205, v143, v139, s85
    v_perm_b32 v206, v151, v147, s85
    v_perm_b32 v207, v159, v155, s85
    s_waitcnt lgkmcnt(0)
    s_add_u32 s83, s82, 64
    buffer_store_dwordx4 v[240:243], v14, s[32:35], s83 offen sc1
    s_add_u32 s83, s82, 3285056
    buffer_store_dwordx4 v[244:247], v14, s[32:35], s83 offen sc1
    s_add_u32 s83, s82, 6570048
    buffer_store_dwordx4 v[248:251], v14, s[32:35], s83 offen sc1
    s_add_u32 s83, s82, 9855040
    buffer_store_dwordx4 v[252:255], v14, s[32:35], s83 offen sc1
    ds_write_b128 v36, v[192:195]
    ds_write_b128 v37, v[196:199]
    ds_write_b128 v38, v[200:203]
    ds_write_b128 v39, v[204:207]
    ds_read_b128 v[224:227], v15 offset:0
    ds_read_b128 v[228:231], v15 offset:1024
    ds_read_b128 v[232:235], v15 offset:2048
    ds_read_b128 v[236:239], v15 offset:3072
    v_perm_b32 v208, v166, v162, s84
    v_perm_b32 v209, v174, v170, s84
    v_perm_b32 v210, v182, v178, s84
    v_perm_b32 v211, v190, v186, s84
    v_perm_b32 v212, v166, v162, s85
    v_perm_b32 v213, v174, v170, s85
    v_perm_b32 v214, v182, v178, s85
    v_perm_b32 v215, v190, v186, s85
    v_perm_b32 v216, v167, v163, s84
    v_perm_b32 v217, v175, v171, s84
    v_perm_b32 v218, v183, v179, s84
    v_perm_b32 v219, v191, v187, s84
    v_perm_b32 v220, v167, v163, s85
    v_perm_b32 v221, v175, v171, s85
    v_perm_b32 v222, v183, v179, s85
    v_perm_b32 v223, v191, v187, s85
    s_waitcnt lgkmcnt(0)
    s_add_u32 s83, s82, 102656
    buffer_store_dwordx4 v[224:227], v14, s[32:35], s83 offen sc1
    s_add_u32 s83, s82, 3387648
    buffer_store_dwordx4 v[228:231], v14, s[32:35], s83 offen sc1
    s_add_u32 s83, s82, 6672640
    buffer_store_dwordx4 v[232:235], v14, s[32:35], s83 offen sc1
    s_add_u32 s83, s82, 9957632
    buffer_store_dwordx4 v[236:239], v14, s[32:35], s83 offen sc1
    ds_write_b128 v36, v[208:211]
    ds_write_b128 v37, v[212:215]
    ds_write_b128 v38, v[216:219]
    ds_write_b128 v39, v[220:223]
    ds_read_b128 v[240:243], v15 offset:0
    ds_read_b128 v[244:247], v15 offset:1024
    ds_read_b128 v[248:251], v15 offset:2048
    ds_read_b128 v[252:255], v15 offset:3072
    ds_write_b64 v31, v[40:41] offset:0
    ds_write_b64 v31, v[42:43] offset:8
    ds_write_b64 v31, v[44:45] offset:16
    ds_write_b64 v31, v[46:47] offset:24
    ds_write_b64 v31, v[48:49] offset:32
    ds_write_b64 v31, v[50:51] offset:40
    ds_write_b64 v31, v[52:53] offset:48
    s_waitcnt lgkmcnt(7)
    s_add_u32 s83, s82, 102720
    buffer_store_dwordx4 v[240:243], v14, s[32:35], s83 offen sc1
    s_add_u32 s83, s82, 3387712
    buffer_store_dwordx4 v[244:247], v14, s[32:35], s83 offen sc1
    s_add_u32 s83, s82, 6672704
    buffer_store_dwordx4 v[248:251], v14, s[32:35], s83 offen sc1
    s_add_u32 s83, s82, 9957696
    buffer_store_dwordx4 v[252:255], v14, s[32:35], s83 offen sc1
k1_kernel_norl:
k1_kernel_rld:
    ds_write_b32 v86, v13
    s_setprio 0

    v_ffbl_b32 v84, v71
    v_mul_u32_u24 v72, 5, v84
    v_lshrrev_b64 v[72:73], v72, v[74:75]
    v_and_or_b32 v72, v72, s66, v85
    ds_add_rtn_u32 v87, v72, v10
    ds_wrxchg_rtn_b32 v116, v86, v13
    v_and_b32 v117, 15, v71
    v_bcnt_u32_b32 v118, v117, 0
    v_cmp_eq_u32 vcc, 3, v118

    s_add_u32 s47, s44, 0
    buffer_load_dwordx4 v[32:35], v7, s[20:23], s47 offen offset:0
    buffer_load_dwordx4 v[36:39], v7, s[20:23], s47 offen offset:64
    s_add_u32 s47, s44, 4096
    buffer_load_dwordx4 v[40:43], v7, s[20:23], s47 offen offset:0
    buffer_load_dwordx4 v[44:47], v7, s[20:23], s47 offen offset:64

    v_cndmask_b32 v119, v71, v117, vcc
    s_waitcnt lgkmcnt(0)
    v_cmp_gt_u32 s[68:69], 2, v116
    v_cmp_gt_u32 s[70:71], 2, v87

    s_nop 0
    v_lshrrev_b64 v[76:77], v123, s[68:69]
    v_perm_b32 v121, v76, v76, v5
    v_perm_b32 v122, v76, v76, v4
    v_perm_b32 v77, v76, v76, v3
    v_and_b32 v121, v121, v21
    v_and_b32 v122, v122, v20
    v_and_b32 v77, v77, v19
    v_msad_u8 v120, v28, v121, 0
    v_lshlrev_b32 v120, 4, v120
    v_msad_u8 v120, v27, v122, v120
    v_lshlrev_b32 v120, 4, v120
    v_msad_u8 v120, v26, v77, v120

    v_and_b32 v120, v120, v119
    v_cmp_eq_u32 vcc, 0, v120
    v_ffbl_b32 v118, v120
    s_or_b64 vcc, vcc, s[70:71]
    v_cndmask_b32 v118, v118, v84, vcc
    v_lshlrev_b32 v72, v118, v10
    v_lshl_add_u32 v73, v118, 1, v31
    v_xor_b32 v71, v71, v72

    ds_read_u16 v81, v73 offset:24

    v_ffbl_b32 v84, v71
    v_mul_u32_u24 v72, 5, v84
    v_lshrrev_b64 v[72:73], v72, v[74:75]
    v_and_or_b32 v72, v72, s66, v85
    ds_add_rtn_u32 v87, v72, v10
    ds_wrxchg_rtn_b32 v116, v86, v13
    v_and_b32 v117, 15, v71
    v_bcnt_u32_b32 v118, v117, 0
    v_cmp_eq_u32 vcc, 2, v118

    s_add_u32 s47, s44, 8192
    buffer_load_dwordx4 v[48:51], v7, s[20:23], s47 offen offset:0
    buffer_load_dwordx4 v[52:55], v7, s[20:23], s47 offen offset:64
    s_add_u32 s47, s44, 131072
    buffer_load_dwordx4 v[136:139], v7, s[20:23], s47 offen offset:0
    buffer_load_dwordx4 v[140:143], v7, s[20:23], s47 offen offset:64

    v_cndmask_b32 v119, v71, v117, vcc
    s_waitcnt lgkmcnt(0)
    v_cmp_gt_u32 s[68:69], 2, v116
    v_cmp_gt_u32 s[70:71], 2, v87

    s_nop 0
    v_lshrrev_b64 v[76:77], v123, s[68:69]
    v_perm_b32 v121, v76, v76, v5
    v_perm_b32 v122, v76, v76, v4
    v_perm_b32 v77, v76, v76, v3
    v_and_b32 v121, v121, v21
    v_and_b32 v122, v122, v20
    v_and_b32 v77, v77, v19
    v_msad_u8 v120, v28, v121, 0
    v_lshlrev_b32 v120, 4, v120
    v_msad_u8 v120, v27, v122, v120
    v_lshlrev_b32 v120, 4, v120
    v_msad_u8 v120, v26, v77, v120

    v_and_b32 v120, v120, v119
    v_cmp_eq_u32 vcc, 0, v120
    v_ffbl_b32 v118, v120
    s_or_b64 vcc, vcc, s[70:71]
    v_cndmask_b32 v118, v118, v84, vcc
    v_lshlrev_b32 v72, v118, v10
    v_lshl_add_u32 v73, v118, 1, v31
    v_xor_b32 v71, v71, v72

    ds_read_u16 v82, v73 offset:24

    v_ffbl_b32 v84, v71
    v_mul_u32_u24 v72, 5, v84
    v_lshrrev_b64 v[72:73], v72, v[74:75]
    v_and_or_b32 v72, v72, s66, v85
    ds_add_rtn_u32 v87, v72, v10
    ds_wrxchg_rtn_b32 v116, v86, v13
    v_and_b32 v117, 15, v71
    v_bcnt_u32_b32 v118, v117, 0
    v_cmp_eq_u32 vcc, 1, v118

    s_add_u32 s47, s44, 135168
    buffer_load_dwordx4 v[152:155], v7, s[20:23], s47 offen offset:0
    buffer_load_dwordx4 v[156:159], v7, s[20:23], s47 offen offset:64
    s_add_u32 s47, s44, 139264
    buffer_load_dwordx4 v[168:171], v7, s[20:23], s47 offen offset:0
    buffer_load_dwordx4 v[172:175], v7, s[20:23], s47 offen offset:64

    v_cndmask_b32 v119, v71, v117, vcc
    s_waitcnt lgkmcnt(0)
    v_cmp_gt_u32 s[68:69], 2, v116
    v_cmp_gt_u32 s[70:71], 2, v87

    s_nop 0
    v_lshrrev_b64 v[76:77], v123, s[68:69]
    v_perm_b32 v121, v76, v76, v5
    v_perm_b32 v122, v76, v76, v4
    v_perm_b32 v77, v76, v76, v3
    v_and_b32 v121, v121, v21
    v_and_b32 v122, v122, v20
    v_and_b32 v77, v77, v19
    v_msad_u8 v120, v28, v121, 0
    v_lshlrev_b32 v120, 4, v120
    v_msad_u8 v120, v27, v122, v120
    v_lshlrev_b32 v120, 4, v120
    v_msad_u8 v120, v26, v77, v120

    v_and_b32 v120, v120, v119
    v_cmp_eq_u32 vcc, 0, v120
    v_ffbl_b32 v118, v120
    s_or_b64 vcc, vcc, s[70:71]
    v_cndmask_b32 v118, v118, v84, vcc
    v_lshlrev_b32 v72, v118, v10
    v_lshl_add_u32 v73, v118, 1, v31
    v_xor_b32 v71, v71, v72

    ds_read_u16 v83, v73 offset:24
    v_lshrrev_b32 v71, 4, v71
    v_or_b32 v71, s63, v71
    v_lshlrev_b32 v74, 22, v69
    v_lshl_or_b32 v74, v68, 2, v74
    v_lshrrev_b32 v75, 10, v69
    v_lshl_or_b32 v75, v70, 10, v75

    v_ffbl_b32 v84, v71
    v_mul_u32_u24 v72, 5, v84
    v_lshrrev_b64 v[72:73], v72, v[74:75]
    v_and_or_b32 v72, v72, s66, v85
    ds_add_rtn_u32 v87, v72, v10
    ds_wrxchg_rtn_b32 v116, v86, v13
    v_and_b32 v117, 15, v71
    v_bcnt_u32_b32 v118, v117, 0
    v_cmp_eq_u32 vcc, 4, v118

    s_add_u32 s47, s44, 143360
    buffer_load_dwordx4 v[184:187], v7, s[20:23], s47 offen offset:0
    buffer_load_dwordx4 v[188:191], v7, s[20:23], s47 offen offset:64
    s_add_u32 s47, s44, 147456
    buffer_load_dwordx4 v[200:203], v7, s[20:23], s47 offen offset:0
    buffer_load_dwordx4 v[204:207], v7, s[20:23], s47 offen offset:64

    v_cndmask_b32 v119, v71, v117, vcc
    s_waitcnt lgkmcnt(0)
    v_cmp_gt_u32 s[68:69], 2, v116
    v_cmp_gt_u32 s[70:71], 2, v87

    v_lshl_or_b32 v78, v81, 16, v80
    v_lshl_or_b32 v79, v83, 16, v82
    buffer_store_dwordx2 v[78:79], v30, s[32:35], s62 offen sc1
    s_add_u32 s62, s62, 65536
    v_lshrrev_b64 v[76:77], v123, s[68:69]
    v_perm_b32 v121, v76, v76, v6
    v_perm_b32 v122, v76, v76, v5
    v_perm_b32 v77, v76, v76, v4
    v_and_b32 v121, v121, v22
    v_and_b32 v122, v122, v21
    v_and_b32 v77, v77, v20
    v_msad_u8 v120, v29, v121, 0
    v_lshlrev_b32 v120, 4, v120
    v_msad_u8 v120, v28, v122, v120
    v_lshlrev_b32 v120, 4, v120
    v_msad_u8 v120, v27, v77, v120

    v_and_b32 v120, v120, v119
    v_cmp_eq_u32 vcc, 0, v120
    v_ffbl_b32 v118, v120
    s_or_b64 vcc, vcc, s[70:71]
    v_cndmask_b32 v118, v118, v84, vcc
    v_lshlrev_b32 v72, v118, v10
    v_lshl_add_u32 v73, v118, 1, v31
    v_xor_b32 v71, v71, v72

    ds_read_u16 v80, v73 offset:32
    s_setprio 1

    v_ffbl_b32 v84, v71
    v_mul_u32_u24 v72, 5, v84
    v_lshrrev_b64 v[72:73], v72, v[74:75]
    v_and_or_b32 v72, v72, s66, v85
    ds_add_rtn_u32 v87, v72, v10
    ds_wrxchg_rtn_b32 v116, v86, v13
    v_and_b32 v117, 15, v71
    v_bcnt_u32_b32 v118, v117, 0
    v_cmp_eq_u32 vcc, 3, v118

    s_add_u32 s47, s44, 151552
    buffer_load_dwordx4 v[216:219], v7, s[20:23], s47 offen offset:0
    buffer_load_dwordx4 v[220:223], v7, s[20:23], s47 offen offset:64
    s_add_u32 s47, s44, 155648
    buffer_load_dwordx4 v[232:235], v7, s[20:23], s47 offen offset:0
    buffer_load_dwordx4 v[236:239], v7, s[20:23], s47 offen offset:64

    v_cndmask_b32 v119, v71, v117, vcc
    s_waitcnt lgkmcnt(0)
    v_cmp_gt_u32 s[68:69], 2, v116
    v_cmp_gt_u32 s[70:71], 2, v87

    s_nop 0
    v_lshrrev_b64 v[76:77], v123, s[68:69]
    v_perm_b32 v121, v76, v76, v6
    v_perm_b32 v122, v76, v76, v5
    v_perm_b32 v77, v76, v76, v4
    v_and_b32 v121, v121, v22
    v_and_b32 v122, v122, v21
    v_and_b32 v77, v77, v20
    v_msad_u8 v120, v29, v121, 0
    v_lshlrev_b32 v120, 4, v120
    v_msad_u8 v120, v28, v122, v120
    v_lshlrev_b32 v120, 4, v120
    v_msad_u8 v120, v27, v77, v120

    v_and_b32 v120, v120, v119
    v_cmp_eq_u32 vcc, 0, v120
    v_ffbl_b32 v118, v120
    s_or_b64 vcc, vcc, s[70:71]
    v_cndmask_b32 v118, v118, v84, vcc
    v_lshlrev_b32 v72, v118, v10
    v_lshl_add_u32 v73, v118, 1, v31
    v_xor_b32 v71, v71, v72

    ds_read_u16 v81, v73 offset:32

    v_ffbl_b32 v84, v71
    v_mul_u32_u24 v72, 5, v84
    v_lshrrev_b64 v[72:73], v72, v[74:75]
    v_and_or_b32 v72, v72, s66, v85
    ds_add_rtn_u32 v87, v72, v10
    ds_wrxchg_rtn_b32 v116, v86, v13
    v_and_b32 v117, 15, v71
    v_bcnt_u32_b32 v118, v117, 0
    v_cmp_eq_u32 vcc, 2, v118

    s_add_u32 s47, s44, 159744
    buffer_load_dwordx4 v[248:251], v7, s[20:23], s47 offen offset:0
    buffer_load_dwordx4 v[252:255], v7, s[20:23], s47 offen offset:64

    v_cndmask_b32 v119, v71, v117, vcc
    s_waitcnt lgkmcnt(0)
    v_cmp_gt_u32 s[68:69], 2, v116
    v_cmp_gt_u32 s[70:71], 2, v87

    s_nop 0
    v_lshrrev_b64 v[76:77], v123, s[68:69]
    v_perm_b32 v121, v76, v76, v6
    v_perm_b32 v122, v76, v76, v5
    v_perm_b32 v77, v76, v76, v4
    v_and_b32 v121, v121, v22
    v_and_b32 v122, v122, v21
    v_and_b32 v77, v77, v20
    v_msad_u8 v120, v29, v121, 0
    v_lshlrev_b32 v120, 4, v120
    v_msad_u8 v120, v28, v122, v120
    v_lshlrev_b32 v120, 4, v120
    v_msad_u8 v120, v27, v77, v120

    v_and_b32 v120, v120, v119
    v_cmp_eq_u32 vcc, 0, v120
    v_ffbl_b32 v118, v120
    s_or_b64 vcc, vcc, s[70:71]
    v_cndmask_b32 v118, v118, v84, vcc
    v_lshlrev_b32 v72, v118, v10
    v_lshl_add_u32 v73, v118, 1, v31
    v_xor_b32 v71, v71, v72

    ds_read_u16 v82, v73 offset:32

    v_ffbl_b32 v84, v71
    v_mul_u32_u24 v72, 5, v84
    v_lshrrev_b64 v[72:73], v72, v[74:75]
    v_and_or_b32 v72, v72, s66, v85
    ds_add_rtn_u32 v87, v72, v10
    ds_wrxchg_rtn_b32 v116, v86, v13
    v_and_b32 v117, 15, v71
    v_bcnt_u32_b32 v118, v117, 0
    v_cmp_eq_u32 vcc, 1, v118

    s_nop 1

    v_cndmask_b32 v119, v71, v117, vcc
    s_waitcnt lgkmcnt(0)
    v_cmp_gt_u32 s[68:69], 2, v116
    v_cmp_gt_u32 s[70:71], 2, v87

    s_nop 0
    v_lshrrev_b64 v[76:77], v123, s[68:69]
    v_perm_b32 v121, v76, v76, v6
    v_perm_b32 v122, v76, v76, v5
    v_perm_b32 v77, v76, v76, v4
    v_and_b32 v121, v121, v22
    v_and_b32 v122, v122, v21
    v_and_b32 v77, v77, v20
    v_msad_u8 v120, v29, v121, 0
    v_lshlrev_b32 v120, 4, v120
    v_msad_u8 v120, v28, v122, v120
    v_lshlrev_b32 v120, 4, v120
    v_msad_u8 v120, v27, v77, v120

    v_and_b32 v120, v120, v119
    v_cmp_eq_u32 vcc, 0, v120
    v_ffbl_b32 v118, v120
    s_or_b64 vcc, vcc, s[70:71]
    v_cndmask_b32 v118, v118, v84, vcc
    v_lshlrev_b32 v72, v118, v10
    v_lshl_add_u32 v73, v118, 1, v31
    v_xor_b32 v71, v71, v72

    ds_read_u16 v83, v73 offset:32
    s_cmp_lg_u32 s59, 3
    s_cbranch_scc1 k1_kernel_sdone
    v_lshrrev_b32 v71, 4, v71
    v_lshlrev_b32 v74, 22, v70
    v_lshl_or_b32 v74, v69, 2, v74
    v_lshrrev_b32 v75, 10, v70

    v_ffbl_b32 v84, v71
    v_mul_u32_u24 v72, 5, v84
    v_lshrrev_b64 v[72:73], v72, v[74:75]
    v_and_or_b32 v72, v72, s66, v85
    ds_add_rtn_u32 v87, v72, v10
    ds_wrxchg_rtn_b32 v116, v86, v13
    v_and_b32 v117, 15, v71
    v_bcnt_u32_b32 v118, v117, 0
    v_cmp_eq_u32 vcc, 4, v118

    s_nop 1

    v_cndmask_b32 v119, v71, v117, vcc
    s_waitcnt lgkmcnt(0)
    v_cmp_gt_u32 s[68:69], 2, v116
    v_cmp_gt_u32 s[70:71], 2, v87

    v_lshl_or_b32 v78, v81, 16, v80
    v_lshl_or_b32 v79, v83, 16, v82
    buffer_store_dwordx2 v[78:79], v30, s[32:35], s62 offen sc1
    s_add_u32 s62, s62, 65536
    v_lshrrev_b64 v[76:77], v123, s[68:69]
    v_perm_b32 v121, v76, v76, v6
    v_perm_b32 v122, v76, v76, v5
    v_and_b32 v121, v121, v22
    v_and_b32 v122, v122, v21
    v_msad_u8 v120, v29, v121, 0
    v_lshlrev_b32 v120, 4, v120
    v_msad_u8 v120, v28, v122, v120

    v_and_b32 v120, v120, v119
    v_cmp_eq_u32 vcc, 0, v120
    v_ffbl_b32 v118, v120
    s_or_b64 vcc, vcc, s[70:71]
    v_cndmask_b32 v118, v118, v84, vcc
    v_lshlrev_b32 v72, v118, v10
    v_lshl_add_u32 v73, v118, 1, v31
    v_xor_b32 v71, v71, v72

    ds_read_u16 v80, v73 offset:40

    v_ffbl_b32 v84, v71
    v_mul_u32_u24 v72, 5, v84
    v_lshrrev_b64 v[72:73], v72, v[74:75]
    v_and_or_b32 v72, v72, s66, v85
    ds_add_rtn_u32 v87, v72, v10
    ds_wrxchg_rtn_b32 v116, v86, v13
    v_and_b32 v117, 15, v71
    v_bcnt_u32_b32 v118, v117, 0
    v_cmp_eq_u32 vcc, 3, v118

    s_nop 1

    v_cndmask_b32 v119, v71, v117, vcc
    s_waitcnt lgkmcnt(0)
    v_cmp_gt_u32 s[68:69], 2, v116
    v_cmp_gt_u32 s[70:71], 2, v87

    s_nop 0
    v_lshrrev_b64 v[76:77], v123, s[68:69]
    v_perm_b32 v121, v76, v76, v6
    v_perm_b32 v122, v76, v76, v5
    v_and_b32 v121, v121, v22
    v_and_b32 v122, v122, v21
    v_msad_u8 v120, v29, v121, 0
    v_lshlrev_b32 v120, 4, v120
    v_msad_u8 v120, v28, v122, v120

    v_and_b32 v120, v120, v119
    v_cmp_eq_u32 vcc, 0, v120
    v_ffbl_b32 v118, v120
    s_or_b64 vcc, vcc, s[70:71]
    v_cndmask_b32 v118, v118, v84, vcc
    v_lshlrev_b32 v72, v118, v10
    v_lshl_add_u32 v73, v118, 1, v31
    v_xor_b32 v71, v71, v72

    ds_read_u16 v81, v73 offset:40

    v_ffbl_b32 v84, v71
    v_mul_u32_u24 v72, 5, v84
    v_lshrrev_b64 v[72:73], v72, v[74:75]
    v_and_or_b32 v72, v72, s66, v85
    ds_add_rtn_u32 v87, v72, v10
    ds_wrxchg_rtn_b32 v116, v86, v13
    v_and_b32 v117, 15, v71
    v_bcnt_u32_b32 v118, v117, 0
    v_cmp_eq_u32 vcc, 2, v118

    s_nop 1

    v_cndmask_b32 v119, v71, v117, vcc
    s_waitcnt lgkmcnt(0)
    v_cmp_gt_u32 s[68:69], 2, v116
    v_cmp_gt_u32 s[70:71], 2, v87

    s_nop 0
    v_lshrrev_b64 v[76:77], v123, s[68:69]
    v_perm_b32 v121, v76, v76, v6
    v_perm_b32 v122, v76, v76, v5
    v_and_b32 v121, v121, v22
    v_and_b32 v122, v122, v21
    v_msad_u8 v120, v29, v121, 0
    v_lshlrev_b32 v120, 4, v120
    v_msad_u8 v120, v28, v122, v120

    v_and_b32 v120, v120, v119
    v_cmp_eq_u32 vcc, 0, v120
    v_ffbl_b32 v118, v120
    s_or_b64 vcc, vcc, s[70:71]
    v_cndmask_b32 v118, v118, v84, vcc
    v_lshlrev_b32 v72, v118, v10
    v_lshl_add_u32 v73, v118, 1, v31
    v_xor_b32 v71, v71, v72

    ds_read_u16 v82, v73 offset:40

    v_ffbl_b32 v84, v71
    v_mul_u32_u24 v72, 5, v84
    v_lshrrev_b64 v[72:73], v72, v[74:75]
    v_and_or_b32 v72, v72, s66, v85
    ds_add_rtn_u32 v87, v72, v10
    ds_wrxchg_rtn_b32 v116, v86, v13
    v_and_b32 v117, 15, v71
    v_bcnt_u32_b32 v118, v117, 0
    v_cmp_eq_u32 vcc, 1, v118

    s_nop 1

    v_cndmask_b32 v119, v71, v117, vcc
    s_waitcnt lgkmcnt(0)
    v_cmp_gt_u32 s[68:69], 2, v116
    v_cmp_gt_u32 s[70:71], 2, v87

    s_nop 0
    v_lshrrev_b64 v[76:77], v123, s[68:69]
    v_perm_b32 v121, v76, v76, v6
    v_perm_b32 v122, v76, v76, v5
    v_and_b32 v121, v121, v22
    v_and_b32 v122, v122, v21
    v_msad_u8 v120, v29, v121, 0
    v_lshlrev_b32 v120, 4, v120
    v_msad_u8 v120, v28, v122, v120

    v_and_b32 v120, v120, v119
    v_cmp_eq_u32 vcc, 0, v120
    v_ffbl_b32 v118, v120
    s_or_b64 vcc, vcc, s[70:71]
    v_cndmask_b32 v118, v118, v84, vcc
    v_lshlrev_b32 v72, v118, v10
    v_lshl_add_u32 v73, v118, 1, v31
    v_xor_b32 v71, v71, v72

    ds_read_u16 v83, v73 offset:40
k1_kernel_sdone:
    s_waitcnt lgkmcnt(0)
    v_lshl_or_b32 v78, v81, 16, v80
    v_lshl_or_b32 v79, v83, 16, v82
    buffer_store_dwordx2 v[78:79], v30, s[32:35], s62 offen sc1
    s_add_u32 s62, s62, 65536
k1_kernel_udone:
    s_setprio 0

    s_mov_b64 exec, 1
    ds_add_rtn_u32 v12, v11, v10 offset:28
    s_waitcnt lgkmcnt(0)
    v_readfirstlane_b32 s45, v12
    s_cmp_ge_u32 s45, 2
    s_cbranch_scc1 k1_kernel_ncl
    s_mov_b64 exec, -1
    s_mul_i32 s45, s45, 16384
    s_min_u32 s45, s45, 16384
    s_lshl_b32 s72, s2, 15
    s_add_u32 s72, s72, s45
    s_add_u32 s72, s72, 20971520
    v_mov_b32 v192, -1
    v_mov_b32 v193, -1
    v_mov_b32 v194, -1
    v_mov_b32 v195, -1
    buffer_store_dwordx4 v[192:195], v9, s[12:15], s72 offen offset:0 sc1
    buffer_store_dwordx4 v[192:195], v9, s[12:15], s72 offen offset:1024 sc1
    buffer_store_dwordx4 v[192:195], v9, s[12:15], s72 offen offset:2048 sc1
    buffer_store_dwordx4 v[192:195], v9, s[12:15], s72 offen offset:3072 sc1
    s_add_u32 s72, s72, 4096
    buffer_store_dwordx4 v[192:195], v9, s[12:15], s72 offen offset:0 sc1
    buffer_store_dwordx4 v[192:195], v9, s[12:15], s72 offen offset:1024 sc1
    buffer_store_dwordx4 v[192:195], v9, s[12:15], s72 offen offset:2048 sc1
    buffer_store_dwordx4 v[192:195], v9, s[12:15], s72 offen offset:3072 sc1
    s_add_u32 s72, s72, 4096
    buffer_store_dwordx4 v[192:195], v9, s[12:15], s72 offen offset:0 sc1
    buffer_store_dwordx4 v[192:195], v9, s[12:15], s72 offen offset:1024 sc1
    buffer_store_dwordx4 v[192:195], v9, s[12:15], s72 offen offset:2048 sc1
    buffer_store_dwordx4 v[192:195], v9, s[12:15], s72 offen offset:3072 sc1
    s_add_u32 s72, s72, 4096
    buffer_store_dwordx4 v[192:195], v9, s[12:15], s72 offen offset:0 sc1
    buffer_store_dwordx4 v[192:195], v9, s[12:15], s72 offen offset:1024 sc1
    buffer_store_dwordx4 v[192:195], v9, s[12:15], s72 offen offset:2048 sc1
    buffer_store_dwordx4 v[192:195], v9, s[12:15], s72 offen offset:3072 sc1
    s_add_u32 s72, s72, 4096
k1_kernel_ncl:

    s_waitcnt vmcnt(0)

    s_mov_b64 exec, 1
    ds_add_rtn_u32 v12, v11, v10 offset:20
    v_mov_b32 v0, s51
    s_waitcnt lgkmcnt(0)
    v_readfirstlane_b32 s45, v12
    s_and_b32 s45, s45, 3
    s_cmp_eq_u32 s45, 3
    s_cbranch_scc0 k1_kernel_wdec
    s_movk_i32 s38, 0xff
    s_cmp_eq_u32 s64, 0
    s_cselect_b32 exec_lo, 0xffff, s38
    s_lshr_b32 s38, s51, 5
    s_lshl_b32 s39, 1, s51

    v_and_b32 v2, 7, v8
    v_cmp_eq_u32 vcc, s38, v2
    v_mov_b32 v2, s39
    v_lshlrev_b32 v0, 2, v8
    v_cndmask_b32 v2, 0, v2, vcc
    v_mov_b32 v1, v2
    buffer_atomic_or v1, v0, s[52:55], 0 offen sc0
    s_lshl_b32 s45, s2, 8
    s_add_u32 s45, s45, 14680064
    s_mov_b64 exec, 0xff
    s_waitcnt vmcnt(0)
    v_or_b32 v1, v1, v2
    v_cmp_ne_u32 vcc, -1, v1
    s_cbranch_vccnz k1_kernel_poll0
    s_mov_b64 exec, -1
    v_lshlrev_b32 v0, 8, v8
    s_mov_b32 s38, 14680064

    buffer_store_dword v10, v0, s[12:15], s38 offen sc1
    s_add_u32 s38, s38, 16384
    buffer_store_dword v10, v0, s[12:15], s38 offen sc1
    s_add_u32 s38, s38, 16384
    buffer_store_dword v10, v0, s[12:15], s38 offen sc1
    s_add_u32 s38, s38, 16384
    buffer_store_dword v10, v0, s[12:15], s38 offen sc1
    buffer_inv sc1
    s_waitcnt vmcnt(0)
    s_branch k1_kernel_go
k1_kernel_poll0:
    buffer_inv sc1
k1_kernel_poll:

    buffer_load_dword v1, v13, s[12:15], s45 offen sc1
    s_add_u32 s65, s65, 1
    s_waitcnt vmcnt(0)
    v_cmp_eq_u32 vcc, 1, v1
    s_cbranch_vccnz k1_kernel_go
    s_cmp_lt_u32 s65, 200
    s_cbranch_scc1 k1_kernel_poll
    buffer_load_dword v1, v0, s[52:55], 0 offen sc1
    s_waitcnt vmcnt(0)
    v_cmp_ne_u32 vcc, -1, v1
    s_cbranch_vccz k1_kernel_go
    s_ff1_i32_b64 s38, vcc
    s_nop 3
    v_readlane_b32 s39, v1, s38
    s_ff0_i32_b32 s39, s39
    s_lshl_b32 s38, s38, 5
    s_add_u32 s38, s38, s39
    s_andn2_b32 s39, s64, 255
    s_add_u32 s39, s39, 256
    s_or_b32 s38, s38, s39
    s_branch k1_kernel_dec

k1_kernel_go:

    s_mov_b32 s38, 0x80000000

k1_kernel_dec:

    v_mov_b32 v1, s38
    s_mov_b64 exec, 1
    ds_write_b32 v11, v1 offset:24

k1_kernel_wdec:

    s_mov_b64 exec, -1
    ds_read_b32 v12, v11 offset:24
    s_waitcnt lgkmcnt(0)
    v_readfirstlane_b32 s45, v12
    s_cmp_lg_u32 s45, s64
    s_cbranch_scc1 k1_kernel_gotd
    s_sleep 2
    s_branch k1_kernel_wdec

k1_kernel_gotd:

    s_mov_b32 s64, s45
    s_and_b32 s51, s45, 255
    s_mov_b32 s65, 0x10000
    s_bitcmp0_b32 s45, 31
    s_cbranch_scc1 k1_kernel_unit

k1_kernel_k2:

    s_setprio 0
    s_load_dwordx4 s[8:11], s[0:1], 32
    s_load_dwordx2 s[56:57], s[0:1], 48
    s_load_dwordx2 s[60:61], s[0:1], 56
    v_mbcnt_lo_u32_b32 v0, -1, 0
    v_mbcnt_hi_u32_b32 v0, -1, v0
    s_mul_i32 s35, s3, 18432
    v_and_b32 v1, 15, v0
    v_lshrrev_b32 v2, 4, v0
    v_mul_u32_u24 v71, 144, v1
    v_lshl_add_u32 v71, v2, 4, v71
    v_add_u32 v71, s35, v71

    ds_read_b128 v[128:131], v71 offset:0
    ds_read_b128 v[132:135], v71 offset:64
    ds_read_b128 v[144:147], v71 offset:2304
    ds_read_b128 v[148:151], v71 offset:2368
    ds_read_b128 v[160:163], v71 offset:4608
    ds_read_b128 v[164:167], v71 offset:4672
    ds_read_b128 v[176:179], v71 offset:6912
    ds_read_b128 v[180:183], v71 offset:6976
    ds_read_b128 v[192:195], v71 offset:9216
    ds_read_b128 v[196:199], v71 offset:9280
    ds_read_b128 v[208:211], v71 offset:11520
    ds_read_b128 v[212:215], v71 offset:11584
    ds_read_b128 v[224:227], v71 offset:13824
    ds_read_b128 v[228:231], v71 offset:13888
    ds_read_b128 v[240:243], v71 offset:16128
    ds_read_b128 v[244:247], v71 offset:16192

    s_lshr_b32 s33, s2, 1
    s_and_b32 s34, s2, 1
    s_mov_b32 s32, 0x8000
    v_lshlrev_b32 v69, 4, v0
    s_mul_i32 s21, s33, 102656
    s_lshl_b32 s35, s50, 11
    s_xor_b32 s19, s35, 2048
    s_add_u32 s19, s19, s21
    s_add_u32 s21, s21, s35
    s_mul_i32 s20, s34, 1638400
    s_add_u32 s20, s20, 16777216
    s_lshl_b32 s35, s3, 13
    s_add_u32 s20, s20, s35
    v_lshlrev_b32 v70, 13, v2
    v_lshl_add_u32 v70, v1, 3, v70
    s_lshl_b32 s35, s3, 10
    v_add_u32 v70, s35, v70
    v_lshrrev_b32 v4, 3, v0
    v_xor_b32 v4, v4, v2
    v_and_b32 v4, 1, v4
    v_bfe_u32 v5, v0, 2, 1
    v_lshl_or_b32 v4, v4, 1, v5
    v_mov_b32 v6, 0x3f80
    v_cmp_eq_u32 vcc, 0, v4
    s_nop 1
    v_cndmask_b32 v64, 0, v6, vcc
    v_cndmask_b32 v65, 0, v6, vcc
    v_cmp_eq_u32 vcc, 1, v4
    s_nop 1
    v_cndmask_b32 v66, 0, v6, vcc
    v_cndmask_b32 v67, 0, v6, vcc
    v_and_b32 v5, 3, v0
    v_mul_u32_u24 v68, 0x5555, v5

    s_cmp_lt_u32 s3, 4
    s_cbranch_scc1 k1_kernel_k2n
    buffer_load_dwordx4 v[0:3], v69, s[12:15], s21 offen offset:0
    buffer_load_dwordx4 v[4:7], v69, s[12:15], s21 offen offset:1024
    buffer_load_dwordx4 v[8:11], v69, s[12:15], s19 offen offset:0
    buffer_load_dwordx4 v[12:15], v69, s[12:15], s19 offen offset:1024
    s_add_u32 s21, s21, 4096
    s_add_u32 s19, s19, 4096
    buffer_load_dwordx4 v[16:19], v69, s[12:15], s21 offen offset:0
    buffer_load_dwordx4 v[20:23], v69, s[12:15], s21 offen offset:1024
    buffer_load_dwordx4 v[24:27], v69, s[12:15], s19 offen offset:0
    buffer_load_dwordx4 v[28:31], v69, s[12:15], s19 offen offset:1024
    s_add_u32 s21, s21, 4096
    s_add_u32 s19, s19, 4096
    s_mov_b32 s44, s21
    s_mov_b32 s45, s19
    s_add_u32 s21, s21, 4096
    s_add_u32 s19, s19, 4096
    buffer_load_dwordx4 v[72:75], v69, s[12:15], s21 offen offset:0
    buffer_load_dwordx4 v[76:79], v69, s[12:15], s21 offen offset:1024
    buffer_load_dwordx4 v[80:83], v69, s[12:15], s19 offen offset:0
    buffer_load_dwordx4 v[84:87], v69, s[12:15], s19 offen offset:1024
    s_add_u32 s21, s21, 4096
    s_add_u32 s19, s19, 4096
    buffer_load_dwordx4 v[116:119], v69, s[12:15], s20 offen offset:0 sc1
    buffer_load_dwordx4 v[120:123], v69, s[12:15], s20 offen offset:1024 sc1
k1_kernel_k2n:

    s_and_b32 s35, s3, 3
    s_lshl_b32 s35, s35, 14
    s_add_u32 s35, s35, 98304
    v_add_u32 v71, s35, v69
    s_lshl_b32 s35, s33, 3
    s_waitcnt lgkmcnt(0)
    s_add_u32 s8, s8, s35
    s_addc_u32 s9, s9, 0
    s_add_u32 s10, s10, s35
    s_addc_u32 s11, s11, 0
    s_barrier

    s_load_dwordx2 s[36:37], s[8:9], 0
    s_load_dwordx2 s[38:39], s[10:11], 0
    s_cmp_lt_u32 s3, 4
    s_cbranch_scc1 k1_kernel_k2m

    s_waitcnt vmcnt(10)
    ds_write_b128 v71, v[32:35] offset:0
    ds_write_b128 v71, v[36:39] offset:1024
    ds_write_b128 v71, v[40:43] offset:2048
    ds_write_b128 v71, v[44:47] offset:3072
    v_mfma_f32_16x16x32_bf16 v[32:35], v[0:3], v[128:131], 0
    v_mfma_f32_16x16x32_bf16 v[36:39], v[0:3], v[144:147], 0
    ds_write_b128 v71, v[48:51] offset:4096
    v_mfma_f32_16x16x32_bf16 v[40:43], v[0:3], v[160:163], 0
    v_mfma_f32_16x16x32_bf16 v[44:47], v[0:3], v[176:179], 0
    ds_write_b128 v71, v[52:55] offset:5120
    v_mfma_f32_16x16x32_bf16 v[32:35], v[4:7], v[132:135], v[32:35]
    v_mfma_f32_16x16x32_bf16 v[36:39], v[4:7], v[148:151], v[36:39]
    ds_write_b128 v71, v[56:59] offset:6144
    v_mfma_f32_16x16x32_bf16 v[40:43], v[4:7], v[164:167], v[40:43]
    v_mfma_f32_16x16x32_bf16 v[44:47], v[4:7], v[180:183], v[44:47]
    ds_write_b128 v71, v[60:63] offset:7168
    v_mfma_f32_16x16x32_bf16 v[32:35], v[8:11], v[136:139], v[32:35]
    v_mfma_f32_16x16x32_bf16 v[36:39], v[8:11], v[152:155], v[36:39]
    ds_write_b128 v71, v[88:91] offset:8192
    v_mfma_f32_16x16x32_bf16 v[40:43], v[8:11], v[168:171], v[40:43]
    v_mfma_f32_16x16x32_bf16 v[44:47], v[8:11], v[184:187], v[44:47]
    ds_write_b128 v71, v[92:95] offset:9216
    v_mfma_f32_16x16x32_bf16 v[32:35], v[12:15], v[140:143], v[32:35]
    v_mfma_f32_16x16x32_bf16 v[36:39], v[12:15], v[156:159], v[36:39]
    ds_write_b128 v71, v[96:99] offset:10240
    v_mfma_f32_16x16x32_bf16 v[40:43], v[12:15], v[172:175], v[40:43]
    v_mfma_f32_16x16x32_bf16 v[44:47], v[12:15], v[188:191], v[44:47]
    ds_write_b128 v71, v[100:103] offset:11264
    v_mfma_f32_16x16x32_bf16 v[48:51], v[0:3], v[192:195], 0
    v_mfma_f32_16x16x32_bf16 v[52:55], v[0:3], v[208:211], 0
    ds_write_b128 v71, v[104:107] offset:12288
    v_mfma_f32_16x16x32_bf16 v[56:59], v[0:3], v[224:227], 0
    v_mfma_f32_16x16x32_bf16 v[60:63], v[0:3], v[240:243], 0
    ds_write_b128 v71, v[108:111] offset:13312
    v_mfma_f32_16x16x32_bf16 v[48:51], v[4:7], v[196:199], v[48:51]
    v_mfma_f32_16x16x32_bf16 v[52:55], v[4:7], v[212:215], v[52:55]
    ds_write_b128 v71, v[112:115] offset:14336
    v_mfma_f32_16x16x32_bf16 v[56:59], v[4:7], v[228:231], v[56:59]
    v_mfma_f32_16x16x32_bf16 v[60:63], v[4:7], v[244:247], v[60:63]
    ds_write_b128 v71, v[124:127] offset:15360
    v_mfma_f32_16x16x32_bf16 v[48:51], v[8:11], v[200:203], v[48:51]
    v_mfma_f32_16x16x32_bf16 v[52:55], v[8:11], v[216:219], v[52:55]
    v_mfma_f32_16x16x32_bf16 v[56:59], v[8:11], v[232:235], v[56:59]
    v_mfma_f32_16x16x32_bf16 v[60:63], v[8:11], v[248:251], v[60:63]
    s_waitcnt lgkmcnt(0)
    s_barrier
    v_mfma_f32_16x16x32_bf16 v[48:51], v[12:15], v[204:207], v[48:51]
    v_mfma_f32_16x16x32_bf16 v[52:55], v[12:15], v[220:223], v[52:55]
    v_mfma_f32_16x16x32_bf16 v[56:59], v[12:15], v[236:239], v[56:59]
    v_mfma_f32_16x16x32_bf16 v[60:63], v[12:15], v[252:255], v[60:63]
    buffer_load_dwordx4 v[124:127], v69, s[12:15], s20 offen offset:2048 sc1
    buffer_load_dwordx4 v[0:3], v69, s[12:15], s44 offen offset:0
    buffer_load_dwordx4 v[4:7], v69, s[12:15], s44 offen offset:1024
    buffer_load_dwordx4 v[8:11], v69, s[12:15], s45 offen offset:0
    buffer_load_dwordx4 v[12:15], v69, s[12:15], s45 offen offset:1024
    s_waitcnt vmcnt(11)
    s_lshl_b32 s24, s36, 16
    s_and_b32 s25, s36, 0xffff0000
    s_lshl_b32 s26, s37, 16
    s_and_b32 s27, s37, 0xffff0000

    v_mfma_f32_16x16x32_bf16 v[88:91], v[16:19], v[128:131], 0
    v_mfma_f32_16x16x32_bf16 v[92:95], v[16:19], v[144:147], 0
    v_mfma_f32_16x16x32_bf16 v[88:91], v[20:23], v[132:135], v[88:91]
    v_mfma_f32_16x16x32_bf16 v[92:95], v[20:23], v[148:151], v[92:95]
    v_mfma_f32_16x16x32_bf16 v[88:91], v[24:27], v[136:139], v[88:91]
    v_cvt_pk_bf16_f32 v32, v32, v33
    v_mfma_f32_16x16x32_bf16 v[92:95], v[24:27], v[152:155], v[92:95]
    v_cvt_pk_bf16_f32 v33, v34, v35
    v_mfma_f32_16x16x32_bf16 v[88:91], v[28:31], v[140:143], v[88:91]
    ds_write_b64 v70, v[32:33] offset:0
    v_mfma_f32_16x16x32_bf16 v[92:95], v[28:31], v[156:159], v[92:95]
    v_cvt_pk_bf16_f32 v36, v36, v37
    v_mfma_f32_16x16x32_bf16 v[96:99], v[16:19], v[160:163], 0
    v_cvt_pk_bf16_f32 v37, v38, v39
    v_mfma_f32_16x16x32_bf16 v[100:103], v[16:19], v[176:179], 0
    ds_write_b64 v70, v[36:37] offset:128
    v_mfma_f32_16x16x32_bf16 v[96:99], v[20:23], v[164:167], v[96:99]
    v_cvt_pk_bf16_f32 v88, v88, v89
    v_cvt_pk_bf16_f32 v40, v40, v41
    v_mfma_f32_16x16x32_bf16 v[100:103], v[20:23], v[180:183], v[100:103]
    v_cvt_pk_bf16_f32 v89, v90, v91
    v_cvt_pk_bf16_f32 v41, v42, v43
    v_mfma_f32_16x16x32_bf16 v[96:99], v[24:27], v[168:171], v[96:99]
    ds_write_b64 v70, v[88:89] offset:32768
    ds_write_b64 v70, v[40:41] offset:256
    v_mfma_f32_16x16x32_bf16 v[100:103], v[24:27], v[184:187], v[100:103]
    v_cvt_pk_bf16_f32 v92, v92, v93
    v_cvt_pk_bf16_f32 v44, v44, v45
    v_mfma_f32_16x16x32_bf16 v[96:99], v[28:31], v[172:175], v[96:99]
    v_cvt_pk_bf16_f32 v93, v94, v95
    v_cvt_pk_bf16_f32 v45, v46, v47
    v_mfma_f32_16x16x32_bf16 v[100:103], v[28:31], v[188:191], v[100:103]
    ds_write_b64 v70, v[92:93] offset:32896
    ds_write_b64 v70, v[44:45] offset:384
    v_mfma_f32_16x16x32_bf16 v[104:107], v[16:19], v[192:195], 0
    v_cvt_pk_bf16_f32 v48, v48, v49
    v_mfma_f32_16x16x32_bf16 v[108:111], v[16:19], v[208:211], 0
    v_cvt_pk_bf16_f32 v49, v50, v51
    v_mfma_f32_16x16x32_bf16 v[104:107], v[20:23], v[196:199], v[104:107]
    v_cvt_pk_bf16_f32 v96, v96, v97
    ds_write_b64 v70, v[48:49] offset:512
    v_mfma_f32_16x16x32_bf16 v[108:111], v[20:23], v[212:215], v[108:111]
    v_cvt_pk_bf16_f32 v97, v98, v99
    v_cvt_pk_bf16_f32 v52, v52, v53
    v_mfma_f32_16x16x32_bf16 v[104:107], v[24:27], v[200:203], v[104:107]
    ds_write_b64 v70, v[96:97] offset:33024
    v_cvt_pk_bf16_f32 v53, v54, v55
    v_mfma_f32_16x16x32_bf16 v[108:111], v[24:27], v[216:219], v[108:111]
    v_cvt_pk_bf16_f32 v100, v100, v101
    ds_write_b64 v70, v[52:53] offset:640
    v_mfma_f32_16x16x32_bf16 v[104:107], v[28:31], v[204:207], v[104:107]
    v_cvt_pk_bf16_f32 v101, v102, v103
    v_cvt_pk_bf16_f32 v56, v56, v57
    v_mfma_f32_16x16x32_bf16 v[108:111], v[28:31], v[220:223], v[108:111]
    ds_write_b64 v70, v[100:101] offset:33152
    v_cvt_pk_bf16_f32 v57, v58, v59
    v_mfma_f32_16x16x32_bf16 v[88:91], v[16:19], v[224:227], 0
    ds_write_b64 v70, v[56:57] offset:768
    v_mfma_f32_16x16x32_bf16 v[92:95], v[16:19], v[240:243], 0
    v_cvt_pk_bf16_f32 v60, v60, v61
    v_mfma_f32_16x16x32_bf16 v[88:91], v[20:23], v[228:231], v[88:91]
    v_cvt_pk_bf16_f32 v104, v104, v105
    v_cvt_pk_bf16_f32 v61, v62, v63
    v_mfma_f32_16x16x32_bf16 v[92:95], v[20:23], v[244:247], v[92:95]
    v_cvt_pk_bf16_f32 v105, v106, v107
    ds_write_b64 v70, v[60:61] offset:896
    v_mfma_f32_16x16x32_bf16 v[88:91], v[24:27], v[232:235], v[88:91]
    ds_write_b64 v70, v[104:105] offset:33280
    v_mfma_f32_16x16x32_bf16 v[92:95], v[24:27], v[248:251], v[92:95]
    v_cvt_pk_bf16_f32 v108, v108, v109
    v_mfma_f32_16x16x32_bf16 v[88:91], v[28:31], v[236:239], v[88:91]
    v_cvt_pk_bf16_f32 v109, v110, v111
    v_mfma_f32_16x16x32_bf16 v[92:95], v[28:31], v[252:255], v[92:95]
    ds_write_b64 v70, v[108:109] offset:33408
    v_add_u32 v70, 0x8000, v70
    s_waitcnt vmcnt(0)
    v_mfma_f32_16x16x32_bf16 v[96:99], v[0:3], v[128:131], 0
    v_mfma_f32_16x16x32_bf16 v[100:103], v[0:3], v[144:147], 0
    v_mfma_f32_16x16x32_bf16 v[96:99], v[4:7], v[132:135], v[96:99]
    v_cvt_pk_bf16_f32 v88, v88, v89
    v_mfma_f32_16x16x32_bf16 v[100:103], v[4:7], v[148:151], v[100:103]
    v_cvt_pk_bf16_f32 v89, v90, v91
    v_mfma_f32_16x16x32_bf16 v[96:99], v[8:11], v[136:139], v[96:99]
    ds_write_b64 v70, v[88:89] offset:768
    v_mov_b32 v16, s24
    v_mov_b32 v40, s24
    v_mfma_f32_16x16x32_bf16 v[100:103], v[8:11], v[152:155], v[100:103]
    v_cvt_pk_bf16_f32 v92, v92, v93
    v_mov_b32 v17, s25
    v_mov_b32 v41, s25
    v_mfma_f32_16x16x32_bf16 v[96:99], v[12:15], v[140:143], v[96:99]
    v_cvt_pk_bf16_f32 v93, v94, v95
    v_mov_b32 v18, s26
    v_mov_b32 v42, s26
    v_mfma_f32_16x16x32_bf16 v[100:103], v[12:15], v[156:159], v[100:103]
    ds_write_b64 v70, v[92:93] offset:896
    v_mov_b32 v19, s27
    v_mov_b32 v43, s27
    v_mfma_f32_16x16x32_bf16 v[104:107], v[0:3], v[160:163], 0
    v_mov_b32 v20, s24
    v_mov_b32 v44, s24
    v_mfma_f32_16x16x32_bf16 v[108:111], v[0:3], v[176:179], 0
    v_mov_b32 v21, s25
    v_mov_b32 v45, s25
    v_mfma_f32_16x16x32_bf16 v[104:107], v[4:7], v[164:167], v[104:107]
    v_cvt_pk_bf16_f32 v96, v96, v97
    v_mov_b32 v22, s26
    v_mov_b32 v46, s26
    v_mfma_f32_16x16x32_bf16 v[108:111], v[4:7], v[180:183], v[108:111]
    v_cvt_pk_bf16_f32 v97, v98, v99
    v_mov_b32 v23, s27
    v_mov_b32 v47, s27
    v_mfma_f32_16x16x32_bf16 v[104:107], v[8:11], v[168:171], v[104:107]
    ds_write_b64 v70, v[96:97] offset:32768
    v_mov_b32 v24, s24
    v_mov_b32 v48, s24
    v_mfma_f32_16x16x32_bf16 v[108:111], v[8:11], v[184:187], v[108:111]
    v_cvt_pk_bf16_f32 v100, v100, v101
    v_mov_b32 v25, s25
    v_mov_b32 v49, s25
    v_mfma_f32_16x16x32_bf16 v[104:107], v[12:15], v[172:175], v[104:107]
    v_cvt_pk_bf16_f32 v101, v102, v103
    v_mov_b32 v26, s26
    v_mov_b32 v50, s26
    v_mfma_f32_16x16x32_bf16 v[108:111], v[12:15], v[188:191], v[108:111]
    ds_write_b64 v70, v[100:101] offset:32896
    v_mov_b32 v27, s27
    v_mov_b32 v51, s27
    v_mfma_f32_16x16x32_bf16 v[88:91], v[0:3], v[192:195], 0
    v_mov_b32 v28, s24
    v_mov_b32 v52, s24
    v_mfma_f32_16x16x32_bf16 v[92:95], v[0:3], v[208:211], 0
    v_mov_b32 v29, s25
    v_mov_b32 v53, s25
    v_mfma_f32_16x16x32_bf16 v[88:91], v[4:7], v[196:199], v[88:91]
    v_cvt_pk_bf16_f32 v104, v104, v105
    v_mov_b32 v30, s26
    v_mov_b32 v54, s26
    v_mfma_f32_16x16x32_bf16 v[92:95], v[4:7], v[212:215], v[92:95]
    v_cvt_pk_bf16_f32 v105, v106, v107
    v_mov_b32 v31, s27
    v_mov_b32 v55, s27
    v_mfma_f32_16x16x32_bf16 v[88:91], v[8:11], v[200:203], v[88:91]
    ds_write_b64 v70, v[104:105] offset:33024
    v_mov_b32 v32, s24
    v_mov_b32 v56, s24
    v_mfma_f32_16x16x32_bf16 v[92:95], v[8:11], v[216:219], v[92:95]
    v_cvt_pk_bf16_f32 v108, v108, v109
    v_mov_b32 v33, s25
    v_mov_b32 v57, s25
    v_mfma_f32_16x16x32_bf16 v[88:91], v[12:15], v[204:207], v[88:91]
    v_cvt_pk_bf16_f32 v109, v110, v111
    v_mov_b32 v34, s26
    v_mov_b32 v58, s26
    v_mfma_f32_16x16x32_bf16 v[92:95], v[12:15], v[220:223], v[92:95]
    ds_write_b64 v70, v[108:109] offset:33152
    v_mov_b32 v35, s27
    v_mov_b32 v59, s27
    v_mfma_f32_16x16x32_bf16 v[96:99], v[0:3], v[224:227], 0
    v_mov_b32 v36, s24
    v_mov_b32 v60, s24
    v_mfma_f32_16x16x32_bf16 v[100:103], v[0:3], v[240:243], 0
    v_mov_b32 v37, s25
    v_mov_b32 v61, s25
    v_mfma_f32_16x16x32_bf16 v[96:99], v[4:7], v[228:231], v[96:99]
    v_cvt_pk_bf16_f32 v88, v88, v89
    v_mov_b32 v38, s26
    v_mov_b32 v62, s26
    v_mfma_f32_16x16x32_bf16 v[100:103], v[4:7], v[244:247], v[100:103]
    v_cvt_pk_bf16_f32 v89, v90, v91
    v_mov_b32 v39, s27
    v_mov_b32 v63, s27
    v_mfma_f32_16x16x32_bf16 v[96:99], v[8:11], v[232:235], v[96:99]
    ds_write_b64 v70, v[88:89] offset:33280
    s_nop 0
    v_mfma_f32_16x16x32_bf16 v[100:103], v[8:11], v[248:251], v[100:103]
    v_cvt_pk_bf16_f32 v92, v92, v93
    s_nop 0
    v_mfma_f32_16x16x32_bf16 v[96:99], v[12:15], v[236:239], v[96:99]
    v_cvt_pk_bf16_f32 v93, v94, v95
    s_nop 0
    v_mfma_f32_16x16x32_bf16 v[100:103], v[12:15], v[252:255], v[100:103]
    ds_write_b64 v70, v[92:93] offset:33408
    s_nop 0
    v_mov_b32 v0, s24
    v_mov_b32 v1, s25
    v_mov_b32 v2, s26
    v_mov_b32 v3, s27
    v_mov_b32 v4, s24
    v_mov_b32 v5, s25
    v_mov_b32 v6, s26
    v_mov_b32 v7, s27
    v_mov_b32 v8, s24
    v_mov_b32 v9, s25
    v_mov_b32 v10, s26
    v_mov_b32 v11, s27
    v_mov_b32 v12, s24
    v_mov_b32 v13, s25
    v_mov_b32 v14, s26
    v_mov_b32 v15, s27
    s_nop 7
    v_cvt_pk_bf16_f32 v96, v96, v97
    v_cvt_pk_bf16_f32 v97, v98, v99
    ds_write_b64 v70, v[96:97] offset:33536
    v_cvt_pk_bf16_f32 v100, v100, v101
    v_cvt_pk_bf16_f32 v101, v102, v103
    ds_write_b64 v70, v[100:101] offset:33664
    v_add_u32 v70, 0x10000, v70
    s_branch k1_kernel_k2j
k1_kernel_k2m:
    buffer_load_dwordx4 v[0:3], v69, s[12:15], s21 offen offset:0
    buffer_load_dwordx4 v[4:7], v69, s[12:15], s21 offen offset:1024
    buffer_load_dwordx4 v[8:11], v69, s[12:15], s19 offen offset:0
    buffer_load_dwordx4 v[12:15], v69, s[12:15], s19 offen offset:1024
    s_add_u32 s21, s21, 4096
    s_add_u32 s19, s19, 4096
    buffer_load_dwordx4 v[16:19], v69, s[12:15], s21 offen offset:0
    buffer_load_dwordx4 v[20:23], v69, s[12:15], s21 offen offset:1024
    buffer_load_dwordx4 v[24:27], v69, s[12:15], s19 offen offset:0
    buffer_load_dwordx4 v[28:31], v69, s[12:15], s19 offen offset:1024
    s_add_u32 s21, s21, 4096
    s_add_u32 s19, s19, 4096
    s_mov_b32 s44, s21
    s_mov_b32 s45, s19
    s_add_u32 s21, s21, 4096
    s_add_u32 s19, s19, 4096
    buffer_load_dwordx4 v[72:75], v69, s[12:15], s21 offen offset:0
    buffer_load_dwordx4 v[76:79], v69, s[12:15], s21 offen offset:1024
    buffer_load_dwordx4 v[80:83], v69, s[12:15], s19 offen offset:0
    buffer_load_dwordx4 v[84:87], v69, s[12:15], s19 offen offset:1024
    s_add_u32 s21, s21, 4096
    s_add_u32 s19, s19, 4096
    buffer_load_dwordx4 v[116:119], v69, s[12:15], s20 offen offset:0 sc1
    buffer_load_dwordx4 v[120:123], v69, s[12:15], s20 offen offset:1024 sc1
    buffer_load_dwordx4 v[124:127], v69, s[12:15], s20 offen offset:2048 sc1
    buffer_load_dwordx4 v[32:35], v69, s[12:15], s44 offen offset:0
    buffer_load_dwordx4 v[36:39], v69, s[12:15], s44 offen offset:1024
    buffer_load_dwordx4 v[40:43], v69, s[12:15], s45 offen offset:0
    buffer_load_dwordx4 v[44:47], v69, s[12:15], s45 offen offset:1024
    s_mov_b32 exec_lo, -2
    s_mov_b32 exec_hi, 1
    buffer_store_dword v112, v113, s[12:15], s74 offen sc1
    s_mov_b64 exec, -1
    s_waitcnt lgkmcnt(0)
    s_barrier
    ds_read_b128 v[136:139], v71 offset:0
    ds_read_b128 v[140:143], v71 offset:1024
    ds_read_b128 v[152:155], v71 offset:2048
    ds_read_b128 v[156:159], v71 offset:3072
    ds_read_b128 v[168:171], v71 offset:4096
    ds_read_b128 v[172:175], v71 offset:5120
    ds_read_b128 v[184:187], v71 offset:6144
    ds_read_b128 v[188:191], v71 offset:7168
    ds_read_b128 v[200:203], v71 offset:8192
    ds_read_b128 v[204:207], v71 offset:9216
    ds_read_b128 v[216:219], v71 offset:10240
    ds_read_b128 v[220:223], v71 offset:11264
    ds_read_b128 v[232:235], v71 offset:12288
    ds_read_b128 v[236:239], v71 offset:13312
    ds_read_b128 v[248:251], v71 offset:14336
    ds_read_b128 v[252:255], v71 offset:15360
    s_waitcnt vmcnt(16)
    v_mfma_f32_16x16x32_bf16 v[48:51], v[0:3], v[128:131], 0
    v_mfma_f32_16x16x32_bf16 v[52:55], v[0:3], v[144:147], 0
    v_mfma_f32_16x16x32_bf16 v[56:59], v[0:3], v[160:163], 0
    v_mfma_f32_16x16x32_bf16 v[60:63], v[0:3], v[176:179], 0
    v_mfma_f32_16x16x32_bf16 v[88:91], v[0:3], v[192:195], 0
    v_mfma_f32_16x16x32_bf16 v[92:95], v[0:3], v[208:211], 0
    v_mfma_f32_16x16x32_bf16 v[96:99], v[0:3], v[224:227], 0
    v_mfma_f32_16x16x32_bf16 v[100:103], v[0:3], v[240:243], 0
    v_mfma_f32_16x16x32_bf16 v[48:51], v[4:7], v[132:135], v[48:51]
    v_mfma_f32_16x16x32_bf16 v[52:55], v[4:7], v[148:151], v[52:55]
    v_mfma_f32_16x16x32_bf16 v[56:59], v[4:7], v[164:167], v[56:59]
    v_mfma_f32_16x16x32_bf16 v[60:63], v[4:7], v[180:183], v[60:63]
    v_mfma_f32_16x16x32_bf16 v[88:91], v[4:7], v[196:199], v[88:91]
    v_mfma_f32_16x16x32_bf16 v[92:95], v[4:7], v[212:215], v[92:95]
    v_mfma_f32_16x16x32_bf16 v[96:99], v[4:7], v[228:231], v[96:99]
    v_mfma_f32_16x16x32_bf16 v[100:103], v[4:7], v[244:247], v[100:103]

    s_lshl_b32 s24, s36, 16
    s_and_b32 s25, s36, 0xffff0000
    s_lshl_b32 s26, s37, 16
    s_and_b32 s27, s37, 0xffff0000

    s_waitcnt lgkmcnt(12)
    v_mfma_f32_16x16x32_bf16 v[48:51], v[8:11], v[136:139], v[48:51]
    v_mfma_f32_16x16x32_bf16 v[52:55], v[8:11], v[152:155], v[52:55]
    v_mfma_f32_16x16x32_bf16 v[48:51], v[12:15], v[140:143], v[48:51]
    v_mfma_f32_16x16x32_bf16 v[52:55], v[12:15], v[156:159], v[52:55]
    s_waitcnt lgkmcnt(8)
    v_mfma_f32_16x16x32_bf16 v[56:59], v[8:11], v[168:171], v[56:59]
    v_mfma_f32_16x16x32_bf16 v[60:63], v[8:11], v[184:187], v[60:63]
    v_mfma_f32_16x16x32_bf16 v[56:59], v[12:15], v[172:175], v[56:59]
    v_mfma_f32_16x16x32_bf16 v[60:63], v[12:15], v[188:191], v[60:63]
    s_waitcnt lgkmcnt(4)
    v_mfma_f32_16x16x32_bf16 v[88:91], v[8:11], v[200:203], v[88:91]
    v_mfma_f32_16x16x32_bf16 v[92:95], v[8:11], v[216:219], v[92:95]
    v_mfma_f32_16x16x32_bf16 v[88:91], v[12:15], v[204:207], v[88:91]
    v_mfma_f32_16x16x32_bf16 v[92:95], v[12:15], v[220:223], v[92:95]
    v_cvt_pk_bf16_f32 v48, v48, v49
    v_cvt_pk_bf16_f32 v49, v50, v51
    ds_write_b64 v70, v[48:49] offset:0
    v_cvt_pk_bf16_f32 v52, v52, v53
    v_cvt_pk_bf16_f32 v53, v54, v55
    ds_write_b64 v70, v[52:53] offset:128
    s_waitcnt lgkmcnt(2)
    v_mfma_f32_16x16x32_bf16 v[96:99], v[8:11], v[232:235], v[96:99]
    v_mfma_f32_16x16x32_bf16 v[100:103], v[8:11], v[248:251], v[100:103]
    v_mfma_f32_16x16x32_bf16 v[96:99], v[12:15], v[236:239], v[96:99]
    v_mfma_f32_16x16x32_bf16 v[100:103], v[12:15], v[252:255], v[100:103]
    v_cvt_pk_bf16_f32 v56, v56, v57
    v_cvt_pk_bf16_f32 v57, v58, v59
    ds_write_b64 v70, v[56:57] offset:256
    v_cvt_pk_bf16_f32 v60, v60, v61
    v_cvt_pk_bf16_f32 v61, v62, v63
    ds_write_b64 v70, v[60:61] offset:384
    s_nop 3
    v_cvt_pk_bf16_f32 v88, v88, v89
    v_cvt_pk_bf16_f32 v89, v90, v91
    ds_write_b64 v70, v[88:89] offset:512
    v_cvt_pk_bf16_f32 v92, v92, v93
    v_cvt_pk_bf16_f32 v93, v94, v95
    ds_write_b64 v70, v[92:93] offset:640
    s_nop 3
    v_cvt_pk_bf16_f32 v96, v96, v97
    v_cvt_pk_bf16_f32 v97, v98, v99
    ds_write_b64 v70, v[96:97] offset:768
    v_cvt_pk_bf16_f32 v100, v100, v101
    v_cvt_pk_bf16_f32 v101, v102, v103
    ds_write_b64 v70, v[100:101] offset:896
    v_add_u32 v70, 0x8000, v70
    s_waitcnt vmcnt(12)
    v_mfma_f32_16x16x32_bf16 v[104:107], v[16:19], v[128:131], 0
    v_mfma_f32_16x16x32_bf16 v[108:111], v[16:19], v[144:147], 0
    v_mfma_f32_16x16x32_bf16 v[104:107], v[20:23], v[132:135], v[104:107]
    v_mfma_f32_16x16x32_bf16 v[108:111], v[20:23], v[148:151], v[108:111]
    v_mfma_f32_16x16x32_bf16 v[104:107], v[24:27], v[136:139], v[104:107]
    v_mov_b32 v48, s24
    v_mfma_f32_16x16x32_bf16 v[108:111], v[24:27], v[152:155], v[108:111]
    v_mov_b32 v49, s25
    v_mfma_f32_16x16x32_bf16 v[104:107], v[28:31], v[140:143], v[104:107]
    v_mov_b32 v50, s26
    v_mfma_f32_16x16x32_bf16 v[108:111], v[28:31], v[156:159], v[108:111]
    v_mov_b32 v51, s27
    v_mfma_f32_16x16x32_bf16 v[88:91], v[16:19], v[160:163], 0
    v_mov_b32 v52, s24
    v_mfma_f32_16x16x32_bf16 v[92:95], v[16:19], v[176:179], 0
    v_mov_b32 v53, s25
    v_mfma_f32_16x16x32_bf16 v[88:91], v[20:23], v[164:167], v[88:91]
    v_cvt_pk_bf16_f32 v104, v104, v105
    v_mov_b32 v54, s26
    v_mfma_f32_16x16x32_bf16 v[92:95], v[20:23], v[180:183], v[92:95]
    v_cvt_pk_bf16_f32 v105, v106, v107
    v_mov_b32 v55, s27
    v_mfma_f32_16x16x32_bf16 v[88:91], v[24:27], v[168:171], v[88:91]
    ds_write_b64 v70, v[104:105] offset:0
    v_mov_b32 v56, s24
    v_mfma_f32_16x16x32_bf16 v[92:95], v[24:27], v[184:187], v[92:95]
    v_cvt_pk_bf16_f32 v108, v108, v109
    v_mov_b32 v57, s25
    v_mfma_f32_16x16x32_bf16 v[88:91], v[28:31], v[172:175], v[88:91]
    v_cvt_pk_bf16_f32 v109, v110, v111
    v_mov_b32 v58, s26
    v_mfma_f32_16x16x32_bf16 v[92:95], v[28:31], v[188:191], v[92:95]
    ds_write_b64 v70, v[108:109] offset:128
    v_mov_b32 v59, s27
    v_mfma_f32_16x16x32_bf16 v[96:99], v[16:19], v[192:195], 0
    v_mov_b32 v60, s24
    v_mfma_f32_16x16x32_bf16 v[100:103], v[16:19], v[208:211], 0
    v_mov_b32 v61, s25
    v_mfma_f32_16x16x32_bf16 v[96:99], v[20:23], v[196:199], v[96:99]
    v_cvt_pk_bf16_f32 v88, v88, v89
    v_mov_b32 v62, s26
    v_mfma_f32_16x16x32_bf16 v[100:103], v[20:23], v[212:215], v[100:103]
    v_cvt_pk_bf16_f32 v89, v90, v91
    v_mov_b32 v63, s27
    v_mfma_f32_16x16x32_bf16 v[96:99], v[24:27], v[200:203], v[96:99]
    ds_write_b64 v70, v[88:89] offset:256
    v_mov_b32 v0, s24
    v_mfma_f32_16x16x32_bf16 v[100:103], v[24:27], v[216:219], v[100:103]
    v_cvt_pk_bf16_f32 v92, v92, v93
    v_mov_b32 v1, s25
    v_mfma_f32_16x16x32_bf16 v[96:99], v[28:31], v[204:207], v[96:99]
    v_cvt_pk_bf16_f32 v93, v94, v95
    v_mov_b32 v2, s26
    v_mfma_f32_16x16x32_bf16 v[100:103], v[28:31], v[220:223], v[100:103]
    ds_write_b64 v70, v[92:93] offset:384
    v_mov_b32 v3, s27
    v_mfma_f32_16x16x32_bf16 v[104:107], v[16:19], v[224:227], 0
    v_mov_b32 v4, s24
    v_mfma_f32_16x16x32_bf16 v[108:111], v[16:19], v[240:243], 0
    v_mov_b32 v5, s25
    v_mfma_f32_16x16x32_bf16 v[104:107], v[20:23], v[228:231], v[104:107]
    v_cvt_pk_bf16_f32 v96, v96, v97
    v_mov_b32 v6, s26
    v_mfma_f32_16x16x32_bf16 v[108:111], v[20:23], v[244:247], v[108:111]
    v_cvt_pk_bf16_f32 v97, v98, v99
    v_mov_b32 v7, s27
    v_mfma_f32_16x16x32_bf16 v[104:107], v[24:27], v[232:235], v[104:107]
    ds_write_b64 v70, v[96:97] offset:512
    v_mov_b32 v8, s24
    v_mfma_f32_16x16x32_bf16 v[108:111], v[24:27], v[248:251], v[108:111]
    v_cvt_pk_bf16_f32 v100, v100, v101
    v_mov_b32 v9, s25
    v_mfma_f32_16x16x32_bf16 v[104:107], v[28:31], v[236:239], v[104:107]
    v_cvt_pk_bf16_f32 v101, v102, v103
    v_mov_b32 v10, s26
    v_mfma_f32_16x16x32_bf16 v[108:111], v[28:31], v[252:255], v[108:111]
    ds_write_b64 v70, v[100:101] offset:640
    v_mov_b32 v11, s27
    s_waitcnt vmcnt(1)
    v_mfma_f32_16x16x32_bf16 v[88:91], v[32:35], v[128:131], 0
    v_mfma_f32_16x16x32_bf16 v[92:95], v[32:35], v[144:147], 0
    v_mfma_f32_16x16x32_bf16 v[88:91], v[36:39], v[132:135], v[88:91]
    v_cvt_pk_bf16_f32 v104, v104, v105
    v_mfma_f32_16x16x32_bf16 v[92:95], v[36:39], v[148:151], v[92:95]
    v_cvt_pk_bf16_f32 v105, v106, v107
    v_mfma_f32_16x16x32_bf16 v[88:91], v[40:43], v[136:139], v[88:91]
    ds_write_b64 v70, v[104:105] offset:768
    v_mov_b32 v12, s24
    v_mfma_f32_16x16x32_bf16 v[92:95], v[40:43], v[152:155], v[92:95]
    v_cvt_pk_bf16_f32 v108, v108, v109
    v_mov_b32 v13, s25
    v_mfma_f32_16x16x32_bf16 v[88:91], v[44:47], v[140:143], v[88:91]
    v_cvt_pk_bf16_f32 v109, v110, v111
    v_mov_b32 v14, s26
    v_mfma_f32_16x16x32_bf16 v[92:95], v[44:47], v[156:159], v[92:95]
    ds_write_b64 v70, v[108:109] offset:896
    v_mov_b32 v15, s27
    v_mfma_f32_16x16x32_bf16 v[96:99], v[32:35], v[160:163], 0
    v_mov_b32 v16, s24
    v_mfma_f32_16x16x32_bf16 v[100:103], v[32:35], v[176:179], 0
    v_mov_b32 v17, s25
    v_mfma_f32_16x16x32_bf16 v[96:99], v[36:39], v[164:167], v[96:99]
    v_cvt_pk_bf16_f32 v88, v88, v89
    v_mov_b32 v18, s26
    v_mfma_f32_16x16x32_bf16 v[100:103], v[36:39], v[180:183], v[100:103]
    v_cvt_pk_bf16_f32 v89, v90, v91
    v_mov_b32 v19, s27
    v_mfma_f32_16x16x32_bf16 v[96:99], v[40:43], v[168:171], v[96:99]
    ds_write_b64 v70, v[88:89] offset:32768
    v_mov_b32 v20, s24
    v_mfma_f32_16x16x32_bf16 v[100:103], v[40:43], v[184:187], v[100:103]
    v_cvt_pk_bf16_f32 v92, v92, v93
    v_mov_b32 v21, s25
    v_mfma_f32_16x16x32_bf16 v[96:99], v[44:47], v[172:175], v[96:99]
    v_cvt_pk_bf16_f32 v93, v94, v95
    v_mov_b32 v22, s26
    v_mfma_f32_16x16x32_bf16 v[100:103], v[44:47], v[188:191], v[100:103]
    ds_write_b64 v70, v[92:93] offset:32896
    v_mov_b32 v23, s27
    v_mfma_f32_16x16x32_bf16 v[104:107], v[32:35], v[192:195], 0
    v_mov_b32 v24, s24
    v_mfma_f32_16x16x32_bf16 v[108:111], v[32:35], v[208:211], 0
    v_mov_b32 v25, s25
    v_mfma_f32_16x16x32_bf16 v[104:107], v[36:39], v[196:199], v[104:107]
    v_cvt_pk_bf16_f32 v96, v96, v97
    v_mov_b32 v26, s26
    v_mfma_f32_16x16x32_bf16 v[108:111], v[36:39], v[212:215], v[108:111]
    v_cvt_pk_bf16_f32 v97, v98, v99
    v_mov_b32 v27, s27
    v_mfma_f32_16x16x32_bf16 v[104:107], v[40:43], v[200:203], v[104:107]
    ds_write_b64 v70, v[96:97] offset:33024
    v_mov_b32 v28, s24
    v_mfma_f32_16x16x32_bf16 v[108:111], v[40:43], v[216:219], v[108:111]
    v_cvt_pk_bf16_f32 v100, v100, v101
    v_mov_b32 v29, s25
    v_mfma_f32_16x16x32_bf16 v[104:107], v[44:47], v[204:207], v[104:107]
    v_cvt_pk_bf16_f32 v101, v102, v103
    v_mov_b32 v30, s26
    v_mfma_f32_16x16x32_bf16 v[108:111], v[44:47], v[220:223], v[108:111]
    ds_write_b64 v70, v[100:101] offset:33152
    v_mov_b32 v31, s27
    v_mfma_f32_16x16x32_bf16 v[88:91], v[32:35], v[224:227], 0
    s_nop 0
    v_mfma_f32_16x16x32_bf16 v[92:95], v[32:35], v[240:243], 0
    s_nop 0
    v_mfma_f32_16x16x32_bf16 v[88:91], v[36:39], v[228:231], v[88:91]
    v_cvt_pk_bf16_f32 v104, v104, v105
    s_nop 0
    v_mfma_f32_16x16x32_bf16 v[92:95], v[36:39], v[244:247], v[92:95]
    v_cvt_pk_bf16_f32 v105, v106, v107
    s_nop 0
    v_mfma_f32_16x16x32_bf16 v[88:91], v[40:43], v[232:235], v[88:91]
    ds_write_b64 v70, v[104:105] offset:33280
    s_nop 0
    v_mfma_f32_16x16x32_bf16 v[92:95], v[40:43], v[248:251], v[92:95]
    v_cvt_pk_bf16_f32 v108, v108, v109
    s_nop 0
    v_mfma_f32_16x16x32_bf16 v[88:91], v[44:47], v[236:239], v[88:91]
    v_cvt_pk_bf16_f32 v109, v110, v111
    s_nop 0
    v_mfma_f32_16x16x32_bf16 v[92:95], v[44:47], v[252:255], v[92:95]
    ds_write_b64 v70, v[108:109] offset:33408
    s_nop 0
    v_mov_b32 v32, s24
    v_mov_b32 v33, s25
    v_mov_b32 v34, s26
    v_mov_b32 v35, s27
    v_mov_b32 v36, s24
    v_mov_b32 v37, s25
    v_mov_b32 v38, s26
    v_mov_b32 v39, s27
    v_mov_b32 v40, s24
    v_mov_b32 v41, s25
    v_mov_b32 v42, s26
    v_mov_b32 v43, s27
    v_mov_b32 v44, s24
    v_mov_b32 v45, s25
    v_mov_b32 v46, s26
    v_mov_b32 v47, s27
    s_nop 7
    v_cvt_pk_bf16_f32 v88, v88, v89
    v_cvt_pk_bf16_f32 v89, v90, v91
    ds_write_b64 v70, v[88:89] offset:33536
    v_cvt_pk_bf16_f32 v92, v92, v93
    v_cvt_pk_bf16_f32 v93, v94, v95
    ds_write_b64 v70, v[92:93] offset:33664
    v_add_u32 v70, 0x10000, v70
k1_kernel_k2j:

    s_mov_b32 s22, 0
    s_mov_b32 s23, 3
    s_waitcnt lgkmcnt(0)
    s_barrier

    v_lshlrev_b32_sdwa v88, 3, v116 dst_sel:DWORD dst_unused:UNUSED_PAD src0_sel:DWORD src1_sel:WORD_0
    v_lshlrev_b32_sdwa v90, 3, v116 dst_sel:DWORD dst_unused:UNUSED_PAD src0_sel:DWORD src1_sel:WORD_1
    v_lshlrev_b32_sdwa v92, 3, v117 dst_sel:DWORD dst_unused:UNUSED_PAD src0_sel:DWORD src1_sel:WORD_0
    v_lshlrev_b32_sdwa v94, 3, v117 dst_sel:DWORD dst_unused:UNUSED_PAD src0_sel:DWORD src1_sel:WORD_1
    ds_read_b64 v[88:89], v88
    ds_read_b64 v[90:91], v90
    ds_read_b64 v[92:93], v92
    ds_read_b64 v[94:95], v94
    v_lshlrev_b32_sdwa v96, 3, v118 dst_sel:DWORD dst_unused:UNUSED_PAD src0_sel:DWORD src1_sel:WORD_0
    v_lshlrev_b32_sdwa v98, 3, v118 dst_sel:DWORD dst_unused:UNUSED_PAD src0_sel:DWORD src1_sel:WORD_1
    v_lshlrev_b32_sdwa v100, 3, v119 dst_sel:DWORD dst_unused:UNUSED_PAD src0_sel:DWORD src1_sel:WORD_0
    v_lshlrev_b32_sdwa v102, 3, v119 dst_sel:DWORD dst_unused:UNUSED_PAD src0_sel:DWORD src1_sel:WORD_1
    ds_read_b64 v[96:97], v96
    ds_read_b64 v[98:99], v98
    ds_read_b64 v[100:101], v100
    ds_read_b64 v[102:103], v102
    buffer_load_dwordx4 v[116:119], v69, s[12:15], s20 offen offset:3072 sc1
    s_add_u32 s20, s20, 4096
k1_kernel_gloop:
    s_setprio 3
    s_waitcnt vmcnt(6)
    v_lshlrev_b32_sdwa v104, 3, v120 dst_sel:DWORD dst_unused:UNUSED_PAD src0_sel:DWORD src1_sel:WORD_0
    v_lshlrev_b32_sdwa v106, 3, v120 dst_sel:DWORD dst_unused:UNUSED_PAD src0_sel:DWORD src1_sel:WORD_1
    ds_read_b64 v[104:105], v104
    ds_read_b64 v[106:107], v106
    v_lshlrev_b32_sdwa v108, 3, v121 dst_sel:DWORD dst_unused:UNUSED_PAD src0_sel:DWORD src1_sel:WORD_0
    v_lshlrev_b32_sdwa v110, 3, v121 dst_sel:DWORD dst_unused:UNUSED_PAD src0_sel:DWORD src1_sel:WORD_1
    ds_read_b64 v[108:109], v108
    ds_read_b64 v[110:111], v110
    s_waitcnt lgkmcnt(8)
    v_smfmac_f32_16x16x64_bf16 v[0:3], v[64:67], v[88:95], v68
    s_waitcnt vmcnt(5)
    v_mfma_f32_16x16x32_bf16 v[112:115], v[72:75], v[128:131], 0
    v_lshlrev_b32_sdwa v88, 3, v122 dst_sel:DWORD dst_unused:UNUSED_PAD src0_sel:DWORD src1_sel:WORD_0
    v_lshlrev_b32_sdwa v90, 3, v122 dst_sel:DWORD dst_unused:UNUSED_PAD src0_sel:DWORD src1_sel:WORD_1
    ds_read_b64 v[88:89], v88
    ds_read_b64 v[90:91], v90
    s_waitcnt vmcnt(4)
    v_mfma_f32_16x16x32_bf16 v[112:115], v[76:79], v[132:135], v[112:115]
    v_lshlrev_b32_sdwa v92, 3, v123 dst_sel:DWORD dst_unused:UNUSED_PAD src0_sel:DWORD src1_sel:WORD_0
    v_lshlrev_b32_sdwa v94, 3, v123 dst_sel:DWORD dst_unused:UNUSED_PAD src0_sel:DWORD src1_sel:WORD_1
    ds_read_b64 v[92:93], v92
    ds_read_b64 v[94:95], v94
    buffer_load_dwordx4 v[120:123], v69, s[12:15], s20 offen offset:0 sc1
    s_waitcnt lgkmcnt(8)
    v_smfmac_f32_16x16x64_bf16 v[4:7], v[64:67], v[96:103], v68
    s_waitcnt vmcnt(4)
    v_mfma_f32_16x16x32_bf16 v[112:115], v[80:83], v[136:139], v[112:115]
    s_waitcnt vmcnt(2)
    v_lshlrev_b32_sdwa v96, 3, v124 dst_sel:DWORD dst_unused:UNUSED_PAD src0_sel:DWORD src1_sel:WORD_0
    v_lshlrev_b32_sdwa v98, 3, v124 dst_sel:DWORD dst_unused:UNUSED_PAD src0_sel:DWORD src1_sel:WORD_1
    ds_read_b64 v[96:97], v96
    ds_read_b64 v[98:99], v98
    s_waitcnt vmcnt(3)
    v_mfma_f32_16x16x32_bf16 v[112:115], v[84:87], v[140:143], v[112:115]
    v_lshlrev_b32_sdwa v100, 3, v125 dst_sel:DWORD dst_unused:UNUSED_PAD src0_sel:DWORD src1_sel:WORD_0
    v_lshlrev_b32_sdwa v102, 3, v125 dst_sel:DWORD dst_unused:UNUSED_PAD src0_sel:DWORD src1_sel:WORD_1
    ds_read_b64 v[100:101], v100
    ds_read_b64 v[102:103], v102
    s_waitcnt lgkmcnt(8)
    v_smfmac_f32_16x16x64_bf16 v[8:11], v[64:67], v[104:111], v68
    s_nop 1
    v_cvt_pk_bf16_f32 v112, v112, v113
    v_cvt_pk_bf16_f32 v113, v114, v115
    ds_write_b64 v70, v[112:113] offset:0
    v_mfma_f32_16x16x32_bf16 v[112:115], v[72:75], v[144:147], 0
    v_mfma_f32_16x16x32_bf16 v[112:115], v[76:79], v[148:151], v[112:115]
    v_lshlrev_b32_sdwa v104, 3, v126 dst_sel:DWORD dst_unused:UNUSED_PAD src0_sel:DWORD src1_sel:WORD_0
    v_lshlrev_b32_sdwa v106, 3, v126 dst_sel:DWORD dst_unused:UNUSED_PAD src0_sel:DWORD src1_sel:WORD_1
    ds_read_b64 v[104:105], v104
    ds_read_b64 v[106:107], v106
    v_mfma_f32_16x16x32_bf16 v[112:115], v[80:83], v[152:155], v[112:115]
    v_mfma_f32_16x16x32_bf16 v[112:115], v[84:87], v[156:159], v[112:115]
    v_lshlrev_b32_sdwa v108, 3, v127 dst_sel:DWORD dst_unused:UNUSED_PAD src0_sel:DWORD src1_sel:WORD_0
    v_lshlrev_b32_sdwa v110, 3, v127 dst_sel:DWORD dst_unused:UNUSED_PAD src0_sel:DWORD src1_sel:WORD_1
    ds_read_b64 v[108:109], v108
    ds_read_b64 v[110:111], v110
    buffer_load_dwordx4 v[124:127], v69, s[12:15], s20 offen offset:1024 sc1
    s_waitcnt lgkmcnt(9)
    v_smfmac_f32_16x16x64_bf16 v[12:15], v[64:67], v[88:95], v68
    s_nop 0
    v_cvt_pk_bf16_f32 v112, v112, v113
    v_cvt_pk_bf16_f32 v113, v114, v115
    ds_write_b64 v70, v[112:113] offset:128
    v_mfma_f32_16x16x32_bf16 v[112:115], v[72:75], v[160:163], 0
    s_waitcnt vmcnt(2)
    v_lshlrev_b32_sdwa v88, 3, v116 dst_sel:DWORD dst_unused:UNUSED_PAD src0_sel:DWORD src1_sel:WORD_0
    v_lshlrev_b32_sdwa v90, 3, v116 dst_sel:DWORD dst_unused:UNUSED_PAD src0_sel:DWORD src1_sel:WORD_1
    ds_read_b64 v[88:89], v88
    ds_read_b64 v[90:91], v90
    v_mfma_f32_16x16x32_bf16 v[112:115], v[76:79], v[164:167], v[112:115]
    v_lshlrev_b32_sdwa v92, 3, v117 dst_sel:DWORD dst_unused:UNUSED_PAD src0_sel:DWORD src1_sel:WORD_0
    v_lshlrev_b32_sdwa v94, 3, v117 dst_sel:DWORD dst_unused:UNUSED_PAD src0_sel:DWORD src1_sel:WORD_1
    ds_read_b64 v[92:93], v92
    ds_read_b64 v[94:95], v94
    s_waitcnt lgkmcnt(10)
    v_smfmac_f32_16x16x64_bf16 v[16:19], v[64:67], v[96:103], v68
    v_mfma_f32_16x16x32_bf16 v[112:115], v[80:83], v[168:171], v[112:115]
    v_lshlrev_b32_sdwa v96, 3, v118 dst_sel:DWORD dst_unused:UNUSED_PAD src0_sel:DWORD src1_sel:WORD_0
    v_lshlrev_b32_sdwa v98, 3, v118 dst_sel:DWORD dst_unused:UNUSED_PAD src0_sel:DWORD src1_sel:WORD_1
    ds_read_b64 v[96:97], v96
    ds_read_b64 v[98:99], v98
    v_mfma_f32_16x16x32_bf16 v[112:115], v[84:87], v[172:175], v[112:115]
    v_lshlrev_b32_sdwa v100, 3, v119 dst_sel:DWORD dst_unused:UNUSED_PAD src0_sel:DWORD src1_sel:WORD_0
    v_lshlrev_b32_sdwa v102, 3, v119 dst_sel:DWORD dst_unused:UNUSED_PAD src0_sel:DWORD src1_sel:WORD_1
    ds_read_b64 v[100:101], v100
    ds_read_b64 v[102:103], v102
    buffer_load_dwordx4 v[116:119], v69, s[12:15], s20 offen offset:2048 sc1
    s_waitcnt lgkmcnt(9)
    v_smfmac_f32_16x16x64_bf16 v[20:23], v[64:67], v[104:111], v68
    s_nop 0
    v_cvt_pk_bf16_f32 v112, v112, v113
    v_cvt_pk_bf16_f32 v113, v114, v115
    ds_write_b64 v70, v[112:113] offset:256
    v_mfma_f32_16x16x32_bf16 v[112:115], v[72:75], v[176:179], 0
    v_mfma_f32_16x16x32_bf16 v[112:115], v[76:79], v[180:183], v[112:115]
    s_waitcnt vmcnt(2)
    v_lshlrev_b32_sdwa v104, 3, v120 dst_sel:DWORD dst_unused:UNUSED_PAD src0_sel:DWORD src1_sel:WORD_0
    v_lshlrev_b32_sdwa v106, 3, v120 dst_sel:DWORD dst_unused:UNUSED_PAD src0_sel:DWORD src1_sel:WORD_1
    ds_read_b64 v[104:105], v104
    ds_read_b64 v[106:107], v106
    v_mfma_f32_16x16x32_bf16 v[112:115], v[80:83], v[184:187], v[112:115]
    v_mfma_f32_16x16x32_bf16 v[112:115], v[84:87], v[188:191], v[112:115]
    v_lshlrev_b32_sdwa v108, 3, v121 dst_sel:DWORD dst_unused:UNUSED_PAD src0_sel:DWORD src1_sel:WORD_0
    v_lshlrev_b32_sdwa v110, 3, v121 dst_sel:DWORD dst_unused:UNUSED_PAD src0_sel:DWORD src1_sel:WORD_1
    ds_read_b64 v[108:109], v108
    ds_read_b64 v[110:111], v110
    s_waitcnt lgkmcnt(9)
    v_smfmac_f32_16x16x64_bf16 v[24:27], v[64:67], v[88:95], v68
    s_nop 1
    v_cvt_pk_bf16_f32 v112, v112, v113
    v_cvt_pk_bf16_f32 v113, v114, v115
    ds_write_b64 v70, v[112:113] offset:384
    v_mfma_f32_16x16x32_bf16 v[112:115], v[72:75], v[192:195], 0
    v_lshlrev_b32_sdwa v88, 3, v122 dst_sel:DWORD dst_unused:UNUSED_PAD src0_sel:DWORD src1_sel:WORD_0
    v_lshlrev_b32_sdwa v90, 3, v122 dst_sel:DWORD dst_unused:UNUSED_PAD src0_sel:DWORD src1_sel:WORD_1
    ds_read_b64 v[88:89], v88
    ds_read_b64 v[90:91], v90
    v_mfma_f32_16x16x32_bf16 v[112:115], v[76:79], v[196:199], v[112:115]
    v_lshlrev_b32_sdwa v92, 3, v123 dst_sel:DWORD dst_unused:UNUSED_PAD src0_sel:DWORD src1_sel:WORD_0
    v_lshlrev_b32_sdwa v94, 3, v123 dst_sel:DWORD dst_unused:UNUSED_PAD src0_sel:DWORD src1_sel:WORD_1
    ds_read_b64 v[92:93], v92
    ds_read_b64 v[94:95], v94
    buffer_load_dwordx4 v[120:123], v69, s[12:15], s20 offen offset:3072 sc1
    s_add_u32 s20, s20, 61440
    s_waitcnt lgkmcnt(10)
    v_smfmac_f32_16x16x64_bf16 v[28:31], v[64:67], v[96:103], v68
    s_setprio 2
    v_mfma_f32_16x16x32_bf16 v[112:115], v[80:83], v[200:203], v[112:115]
    s_waitcnt vmcnt(2)
    v_lshlrev_b32_sdwa v96, 3, v124 dst_sel:DWORD dst_unused:UNUSED_PAD src0_sel:DWORD src1_sel:WORD_0
    v_lshlrev_b32_sdwa v98, 3, v124 dst_sel:DWORD dst_unused:UNUSED_PAD src0_sel:DWORD src1_sel:WORD_1
    ds_read_b64 v[96:97], v96
    ds_read_b64 v[98:99], v98
    v_mfma_f32_16x16x32_bf16 v[112:115], v[84:87], v[204:207], v[112:115]
    v_lshlrev_b32_sdwa v100, 3, v125 dst_sel:DWORD dst_unused:UNUSED_PAD src0_sel:DWORD src1_sel:WORD_0
    v_lshlrev_b32_sdwa v102, 3, v125 dst_sel:DWORD dst_unused:UNUSED_PAD src0_sel:DWORD src1_sel:WORD_1
    ds_read_b64 v[100:101], v100
    ds_read_b64 v[102:103], v102
    s_waitcnt lgkmcnt(9)
    v_smfmac_f32_16x16x64_bf16 v[32:35], v[64:67], v[104:111], v68
    s_nop 1
    v_cvt_pk_bf16_f32 v112, v112, v113
    v_cvt_pk_bf16_f32 v113, v114, v115
    ds_write_b64 v70, v[112:113] offset:512
    v_mfma_f32_16x16x32_bf16 v[112:115], v[72:75], v[208:211], 0
    v_lshlrev_b32_sdwa v104, 3, v126 dst_sel:DWORD dst_unused:UNUSED_PAD src0_sel:DWORD src1_sel:WORD_0
    v_lshlrev_b32_sdwa v106, 3, v126 dst_sel:DWORD dst_unused:UNUSED_PAD src0_sel:DWORD src1_sel:WORD_1
    ds_read_b64 v[104:105], v104
    ds_read_b64 v[106:107], v106
    v_mfma_f32_16x16x32_bf16 v[112:115], v[76:79], v[212:215], v[112:115]
    v_lshlrev_b32_sdwa v108, 3, v127 dst_sel:DWORD dst_unused:UNUSED_PAD src0_sel:DWORD src1_sel:WORD_0
    v_lshlrev_b32_sdwa v110, 3, v127 dst_sel:DWORD dst_unused:UNUSED_PAD src0_sel:DWORD src1_sel:WORD_1
    ds_read_b64 v[108:109], v108
    ds_read_b64 v[110:111], v110
    buffer_load_dwordx4 v[124:127], v69, s[12:15], s20 offen offset:0 sc1
    s_waitcnt lgkmcnt(9)
    v_smfmac_f32_16x16x64_bf16 v[36:39], v[64:67], v[88:95], v68
    v_mfma_f32_16x16x32_bf16 v[112:115], v[80:83], v[216:219], v[112:115]
    s_waitcnt vmcnt(2)
    v_lshlrev_b32_sdwa v88, 3, v116 dst_sel:DWORD dst_unused:UNUSED_PAD src0_sel:DWORD src1_sel:WORD_0
    v_lshlrev_b32_sdwa v90, 3, v116 dst_sel:DWORD dst_unused:UNUSED_PAD src0_sel:DWORD src1_sel:WORD_1
    ds_read_b64 v[88:89], v88
    ds_read_b64 v[90:91], v90
    v_mfma_f32_16x16x32_bf16 v[112:115], v[84:87], v[220:223], v[112:115]
    v_lshlrev_b32_sdwa v92, 3, v117 dst_sel:DWORD dst_unused:UNUSED_PAD src0_sel:DWORD src1_sel:WORD_0
    v_lshlrev_b32_sdwa v94, 3, v117 dst_sel:DWORD dst_unused:UNUSED_PAD src0_sel:DWORD src1_sel:WORD_1
    ds_read_b64 v[92:93], v92
    ds_read_b64 v[94:95], v94
    s_waitcnt lgkmcnt(9)
    v_smfmac_f32_16x16x64_bf16 v[40:43], v[64:67], v[96:103], v68
    s_nop 1
    v_cvt_pk_bf16_f32 v112, v112, v113
    v_cvt_pk_bf16_f32 v113, v114, v115
    ds_write_b64 v70, v[112:113] offset:640
    v_mfma_f32_16x16x32_bf16 v[112:115], v[72:75], v[224:227], 0
    v_mfma_f32_16x16x32_bf16 v[112:115], v[76:79], v[228:231], v[112:115]
    v_lshlrev_b32_sdwa v96, 3, v118 dst_sel:DWORD dst_unused:UNUSED_PAD src0_sel:DWORD src1_sel:WORD_0
    v_lshlrev_b32_sdwa v98, 3, v118 dst_sel:DWORD dst_unused:UNUSED_PAD src0_sel:DWORD src1_sel:WORD_1
    ds_read_b64 v[96:97], v96
    ds_read_b64 v[98:99], v98
    v_mfma_f32_16x16x32_bf16 v[112:115], v[80:83], v[232:235], v[112:115]
    v_mfma_f32_16x16x32_bf16 v[112:115], v[84:87], v[236:239], v[112:115]
    v_lshlrev_b32_sdwa v100, 3, v119 dst_sel:DWORD dst_unused:UNUSED_PAD src0_sel:DWORD src1_sel:WORD_0
    v_lshlrev_b32_sdwa v102, 3, v119 dst_sel:DWORD dst_unused:UNUSED_PAD src0_sel:DWORD src1_sel:WORD_1
    ds_read_b64 v[100:101], v100
    ds_read_b64 v[102:103], v102
    buffer_load_dwordx4 v[116:119], v69, s[12:15], s20 offen offset:1024 sc1
    s_waitcnt lgkmcnt(9)
    v_smfmac_f32_16x16x64_bf16 v[44:47], v[64:67], v[104:111], v68
    s_nop 0
    v_cvt_pk_bf16_f32 v112, v112, v113
    v_cvt_pk_bf16_f32 v113, v114, v115
    ds_write_b64 v70, v[112:113] offset:768
    s_setprio 1
    v_mfma_f32_16x16x32_bf16 v[112:115], v[72:75], v[240:243], 0
    buffer_load_dwordx4 v[72:75], v69, s[12:15], s21 offen offset:0
    s_waitcnt vmcnt(3)
    v_lshlrev_b32_sdwa v104, 3, v120 dst_sel:DWORD dst_unused:UNUSED_PAD src0_sel:DWORD src1_sel:WORD_0
    v_lshlrev_b32_sdwa v106, 3, v120 dst_sel:DWORD dst_unused:UNUSED_PAD src0_sel:DWORD src1_sel:WORD_1
    ds_read_b64 v[104:105], v104
    ds_read_b64 v[106:107], v106
    v_mfma_f32_16x16x32_bf16 v[112:115], v[76:79], v[244:247], v[112:115]
    buffer_load_dwordx4 v[76:79], v69, s[12:15], s21 offen offset:1024
    v_lshlrev_b32_sdwa v108, 3, v121 dst_sel:DWORD dst_unused:UNUSED_PAD src0_sel:DWORD src1_sel:WORD_0
    v_lshlrev_b32_sdwa v110, 3, v121 dst_sel:DWORD dst_unused:UNUSED_PAD src0_sel:DWORD src1_sel:WORD_1
    ds_read_b64 v[108:109], v108
    ds_read_b64 v[110:111], v110
    s_waitcnt lgkmcnt(10)
    v_smfmac_f32_16x16x64_bf16 v[48:51], v[64:67], v[88:95], v68
    v_mfma_f32_16x16x32_bf16 v[112:115], v[80:83], v[248:251], v[112:115]
    buffer_load_dwordx4 v[80:83], v69, s[12:15], s19 offen offset:0
    v_lshlrev_b32_sdwa v88, 3, v122 dst_sel:DWORD dst_unused:UNUSED_PAD src0_sel:DWORD src1_sel:WORD_0
    v_lshlrev_b32_sdwa v90, 3, v122 dst_sel:DWORD dst_unused:UNUSED_PAD src0_sel:DWORD src1_sel:WORD_1
    ds_read_b64 v[88:89], v88
    ds_read_b64 v[90:91], v90
    v_mfma_f32_16x16x32_bf16 v[112:115], v[84:87], v[252:255], v[112:115]
    buffer_load_dwordx4 v[84:87], v69, s[12:15], s19 offen offset:1024
    s_add_u32 s21, s21, 4096
    s_add_u32 s19, s19, 4096
    v_lshlrev_b32_sdwa v92, 3, v123 dst_sel:DWORD dst_unused:UNUSED_PAD src0_sel:DWORD src1_sel:WORD_0
    v_lshlrev_b32_sdwa v94, 3, v123 dst_sel:DWORD dst_unused:UNUSED_PAD src0_sel:DWORD src1_sel:WORD_1
    ds_read_b64 v[92:93], v92
    ds_read_b64 v[94:95], v94
    buffer_load_dwordx4 v[120:123], v69, s[12:15], s20 offen offset:2048 sc1
    s_waitcnt lgkmcnt(9)
    v_smfmac_f32_16x16x64_bf16 v[52:55], v[64:67], v[96:103], v68
    v_cvt_pk_bf16_f32 v112, v112, v113
    v_cvt_pk_bf16_f32 v113, v114, v115
    ds_write_b64 v70, v[112:113] offset:896
    s_add_u32 s23, s23, 1
    s_cmp_eq_u32 s23, 5
    s_cselect_b32 s35, 4294836224, s32
    s_cselect_b32 s23, 0, s23
    v_add_u32 v70, s35, v70
    s_waitcnt vmcnt(6)
    v_lshlrev_b32_sdwa v96, 3, v124 dst_sel:DWORD dst_unused:UNUSED_PAD src0_sel:DWORD src1_sel:WORD_0
    v_lshlrev_b32_sdwa v98, 3, v124 dst_sel:DWORD dst_unused:UNUSED_PAD src0_sel:DWORD src1_sel:WORD_1
    ds_read_b64 v[96:97], v96
    ds_read_b64 v[98:99], v98
    v_lshlrev_b32_sdwa v100, 3, v125 dst_sel:DWORD dst_unused:UNUSED_PAD src0_sel:DWORD src1_sel:WORD_0
    v_lshlrev_b32_sdwa v102, 3, v125 dst_sel:DWORD dst_unused:UNUSED_PAD src0_sel:DWORD src1_sel:WORD_1
    ds_read_b64 v[100:101], v100
    ds_read_b64 v[102:103], v102
    s_waitcnt lgkmcnt(9)
    v_smfmac_f32_16x16x64_bf16 v[56:59], v[64:67], v[104:111], v68
    s_setprio 0
    v_lshlrev_b32_sdwa v104, 3, v126 dst_sel:DWORD dst_unused:UNUSED_PAD src0_sel:DWORD src1_sel:WORD_0
    v_lshlrev_b32_sdwa v106, 3, v126 dst_sel:DWORD dst_unused:UNUSED_PAD src0_sel:DWORD src1_sel:WORD_1
    ds_read_b64 v[104:105], v104
    ds_read_b64 v[106:107], v106
    v_lshlrev_b32_sdwa v108, 3, v127 dst_sel:DWORD dst_unused:UNUSED_PAD src0_sel:DWORD src1_sel:WORD_0
    v_lshlrev_b32_sdwa v110, 3, v127 dst_sel:DWORD dst_unused:UNUSED_PAD src0_sel:DWORD src1_sel:WORD_1
    ds_read_b64 v[108:109], v108
    ds_read_b64 v[110:111], v110
    buffer_load_dwordx4 v[124:127], v69, s[12:15], s20 offen offset:3072 sc1
    s_add_u32 s20, s20, 4096
    s_waitcnt lgkmcnt(9)
    v_smfmac_f32_16x16x64_bf16 v[60:63], v[64:67], v[88:95], v68
    s_waitcnt lgkmcnt(8)
    s_barrier

    s_cmp_eq_u32 s22, 7
    s_cbranch_scc1 k1_kernel_fin

    s_setprio 3
    s_waitcnt vmcnt(6)
    v_lshlrev_b32_sdwa v88, 3, v116 dst_sel:DWORD dst_unused:UNUSED_PAD src0_sel:DWORD src1_sel:WORD_0
    v_lshlrev_b32_sdwa v90, 3, v116 dst_sel:DWORD dst_unused:UNUSED_PAD src0_sel:DWORD src1_sel:WORD_1
    ds_read_b64 v[88:89], v88
    ds_read_b64 v[90:91], v90
    v_lshlrev_b32_sdwa v92, 3, v117 dst_sel:DWORD dst_unused:UNUSED_PAD src0_sel:DWORD src1_sel:WORD_0
    v_lshlrev_b32_sdwa v94, 3, v117 dst_sel:DWORD dst_unused:UNUSED_PAD src0_sel:DWORD src1_sel:WORD_1
    ds_read_b64 v[92:93], v92
    ds_read_b64 v[94:95], v94
    s_waitcnt lgkmcnt(8)
    v_smfmac_f32_16x16x64_bf16 v[0:3], v[64:67], v[96:103], v68
    s_waitcnt vmcnt(5)
    v_mfma_f32_16x16x32_bf16 v[112:115], v[72:75], v[128:131], 0
    v_lshlrev_b32_sdwa v96, 3, v118 dst_sel:DWORD dst_unused:UNUSED_PAD src0_sel:DWORD src1_sel:WORD_0
    v_lshlrev_b32_sdwa v98, 3, v118 dst_sel:DWORD dst_unused:UNUSED_PAD src0_sel:DWORD src1_sel:WORD_1
    ds_read_b64 v[96:97], v96
    ds_read_b64 v[98:99], v98
    s_waitcnt vmcnt(4)
    v_mfma_f32_16x16x32_bf16 v[112:115], v[76:79], v[132:135], v[112:115]
    v_lshlrev_b32_sdwa v100, 3, v119 dst_sel:DWORD dst_unused:UNUSED_PAD src0_sel:DWORD src1_sel:WORD_0
    v_lshlrev_b32_sdwa v102, 3, v119 dst_sel:DWORD dst_unused:UNUSED_PAD src0_sel:DWORD src1_sel:WORD_1
    ds_read_b64 v[100:101], v100
    ds_read_b64 v[102:103], v102
    buffer_load_dwordx4 v[116:119], v69, s[12:15], s20 offen offset:0 sc1
    s_waitcnt lgkmcnt(8)
    v_smfmac_f32_16x16x64_bf16 v[4:7], v[64:67], v[104:111], v68
    s_waitcnt vmcnt(4)
    v_mfma_f32_16x16x32_bf16 v[112:115], v[80:83], v[136:139], v[112:115]
    s_waitcnt vmcnt(2)
    v_lshlrev_b32_sdwa v104, 3, v120 dst_sel:DWORD dst_unused:UNUSED_PAD src0_sel:DWORD src1_sel:WORD_0
    v_lshlrev_b32_sdwa v106, 3, v120 dst_sel:DWORD dst_unused:UNUSED_PAD src0_sel:DWORD src1_sel:WORD_1
    ds_read_b64 v[104:105], v104
    ds_read_b64 v[106:107], v106
    s_waitcnt vmcnt(3)
    v_mfma_f32_16x16x32_bf16 v[112:115], v[84:87], v[140:143], v[112:115]
    v_lshlrev_b32_sdwa v108, 3, v121 dst_sel:DWORD dst_unused:UNUSED_PAD src0_sel:DWORD src1_sel:WORD_0
    v_lshlrev_b32_sdwa v110, 3, v121 dst_sel:DWORD dst_unused:UNUSED_PAD src0_sel:DWORD src1_sel:WORD_1
    ds_read_b64 v[108:109], v108
    ds_read_b64 v[110:111], v110
    s_waitcnt lgkmcnt(8)
    v_smfmac_f32_16x16x64_bf16 v[8:11], v[64:67], v[88:95], v68
    s_nop 1
    v_cvt_pk_bf16_f32 v112, v112, v113
    v_cvt_pk_bf16_f32 v113, v114, v115
    ds_write_b64 v70, v[112:113] offset:0
    v_mfma_f32_16x16x32_bf16 v[112:115], v[72:75], v[144:147], 0
    v_mfma_f32_16x16x32_bf16 v[112:115], v[76:79], v[148:151], v[112:115]
    v_lshlrev_b32_sdwa v88, 3, v122 dst_sel:DWORD dst_unused:UNUSED_PAD src0_sel:DWORD src1_sel:WORD_0
    v_lshlrev_b32_sdwa v90, 3, v122 dst_sel:DWORD dst_unused:UNUSED_PAD src0_sel:DWORD src1_sel:WORD_1
    ds_read_b64 v[88:89], v88
    ds_read_b64 v[90:91], v90
    v_mfma_f32_16x16x32_bf16 v[112:115], v[80:83], v[152:155], v[112:115]
    v_mfma_f32_16x16x32_bf16 v[112:115], v[84:87], v[156:159], v[112:115]
    v_lshlrev_b32_sdwa v92, 3, v123 dst_sel:DWORD dst_unused:UNUSED_PAD src0_sel:DWORD src1_sel:WORD_0
    v_lshlrev_b32_sdwa v94, 3, v123 dst_sel:DWORD dst_unused:UNUSED_PAD src0_sel:DWORD src1_sel:WORD_1
    ds_read_b64 v[92:93], v92
    ds_read_b64 v[94:95], v94
    buffer_load_dwordx4 v[120:123], v69, s[12:15], s20 offen offset:1024 sc1
    s_waitcnt lgkmcnt(9)
    v_smfmac_f32_16x16x64_bf16 v[12:15], v[64:67], v[96:103], v68
    s_nop 0
    v_cvt_pk_bf16_f32 v112, v112, v113
    v_cvt_pk_bf16_f32 v113, v114, v115
    ds_write_b64 v70, v[112:113] offset:128
    v_mfma_f32_16x16x32_bf16 v[112:115], v[72:75], v[160:163], 0
    s_waitcnt vmcnt(2)
    v_lshlrev_b32_sdwa v96, 3, v124 dst_sel:DWORD dst_unused:UNUSED_PAD src0_sel:DWORD src1_sel:WORD_0
    v_lshlrev_b32_sdwa v98, 3, v124 dst_sel:DWORD dst_unused:UNUSED_PAD src0_sel:DWORD src1_sel:WORD_1
    ds_read_b64 v[96:97], v96
    ds_read_b64 v[98:99], v98
    v_mfma_f32_16x16x32_bf16 v[112:115], v[76:79], v[164:167], v[112:115]
    v_lshlrev_b32_sdwa v100, 3, v125 dst_sel:DWORD dst_unused:UNUSED_PAD src0_sel:DWORD src1_sel:WORD_0
    v_lshlrev_b32_sdwa v102, 3, v125 dst_sel:DWORD dst_unused:UNUSED_PAD src0_sel:DWORD src1_sel:WORD_1
    ds_read_b64 v[100:101], v100
    ds_read_b64 v[102:103], v102
    s_waitcnt lgkmcnt(10)
    v_smfmac_f32_16x16x64_bf16 v[16:19], v[64:67], v[104:111], v68
    v_mfma_f32_16x16x32_bf16 v[112:115], v[80:83], v[168:171], v[112:115]
    v_lshlrev_b32_sdwa v104, 3, v126 dst_sel:DWORD dst_unused:UNUSED_PAD src0_sel:DWORD src1_sel:WORD_0
    v_lshlrev_b32_sdwa v106, 3, v126 dst_sel:DWORD dst_unused:UNUSED_PAD src0_sel:DWORD src1_sel:WORD_1
    ds_read_b64 v[104:105], v104
    ds_read_b64 v[106:107], v106
    v_mfma_f32_16x16x32_bf16 v[112:115], v[84:87], v[172:175], v[112:115]
    v_lshlrev_b32_sdwa v108, 3, v127 dst_sel:DWORD dst_unused:UNUSED_PAD src0_sel:DWORD src1_sel:WORD_0
    v_lshlrev_b32_sdwa v110, 3, v127 dst_sel:DWORD dst_unused:UNUSED_PAD src0_sel:DWORD src1_sel:WORD_1
    ds_read_b64 v[108:109], v108
    ds_read_b64 v[110:111], v110
    buffer_load_dwordx4 v[124:127], v69, s[12:15], s20 offen offset:2048 sc1
    s_waitcnt lgkmcnt(9)
    v_smfmac_f32_16x16x64_bf16 v[20:23], v[64:67], v[88:95], v68
    s_nop 0
    v_cvt_pk_bf16_f32 v112, v112, v113
    v_cvt_pk_bf16_f32 v113, v114, v115
    ds_write_b64 v70, v[112:113] offset:256
    v_mfma_f32_16x16x32_bf16 v[112:115], v[72:75], v[176:179], 0
    v_mfma_f32_16x16x32_bf16 v[112:115], v[76:79], v[180:183], v[112:115]
    s_waitcnt vmcnt(2)
    v_lshlrev_b32_sdwa v88, 3, v116 dst_sel:DWORD dst_unused:UNUSED_PAD src0_sel:DWORD src1_sel:WORD_0
    v_lshlrev_b32_sdwa v90, 3, v116 dst_sel:DWORD dst_unused:UNUSED_PAD src0_sel:DWORD src1_sel:WORD_1
    ds_read_b64 v[88:89], v88
    ds_read_b64 v[90:91], v90
    v_mfma_f32_16x16x32_bf16 v[112:115], v[80:83], v[184:187], v[112:115]
    v_mfma_f32_16x16x32_bf16 v[112:115], v[84:87], v[188:191], v[112:115]
    v_lshlrev_b32_sdwa v92, 3, v117 dst_sel:DWORD dst_unused:UNUSED_PAD src0_sel:DWORD src1_sel:WORD_0
    v_lshlrev_b32_sdwa v94, 3, v117 dst_sel:DWORD dst_unused:UNUSED_PAD src0_sel:DWORD src1_sel:WORD_1
    ds_read_b64 v[92:93], v92
    ds_read_b64 v[94:95], v94
    s_waitcnt lgkmcnt(9)
    v_smfmac_f32_16x16x64_bf16 v[24:27], v[64:67], v[96:103], v68
    s_nop 1
    v_cvt_pk_bf16_f32 v112, v112, v113
    v_cvt_pk_bf16_f32 v113, v114, v115
    ds_write_b64 v70, v[112:113] offset:384
    v_mfma_f32_16x16x32_bf16 v[112:115], v[72:75], v[192:195], 0
    v_lshlrev_b32_sdwa v96, 3, v118 dst_sel:DWORD dst_unused:UNUSED_PAD src0_sel:DWORD src1_sel:WORD_0
    v_lshlrev_b32_sdwa v98, 3, v118 dst_sel:DWORD dst_unused:UNUSED_PAD src0_sel:DWORD src1_sel:WORD_1
    ds_read_b64 v[96:97], v96
    ds_read_b64 v[98:99], v98
    v_mfma_f32_16x16x32_bf16 v[112:115], v[76:79], v[196:199], v[112:115]
    v_lshlrev_b32_sdwa v100, 3, v119 dst_sel:DWORD dst_unused:UNUSED_PAD src0_sel:DWORD src1_sel:WORD_0
    v_lshlrev_b32_sdwa v102, 3, v119 dst_sel:DWORD dst_unused:UNUSED_PAD src0_sel:DWORD src1_sel:WORD_1
    ds_read_b64 v[100:101], v100
    ds_read_b64 v[102:103], v102
    buffer_load_dwordx4 v[116:119], v69, s[12:15], s20 offen offset:3072 sc1
    s_add_u32 s20, s20, 61440
    s_waitcnt lgkmcnt(10)
    v_smfmac_f32_16x16x64_bf16 v[28:31], v[64:67], v[104:111], v68
    s_setprio 2
    v_mfma_f32_16x16x32_bf16 v[112:115], v[80:83], v[200:203], v[112:115]
    s_waitcnt vmcnt(2)
    v_lshlrev_b32_sdwa v104, 3, v120 dst_sel:DWORD dst_unused:UNUSED_PAD src0_sel:DWORD src1_sel:WORD_0
    v_lshlrev_b32_sdwa v106, 3, v120 dst_sel:DWORD dst_unused:UNUSED_PAD src0_sel:DWORD src1_sel:WORD_1
    ds_read_b64 v[104:105], v104
    ds_read_b64 v[106:107], v106
    v_mfma_f32_16x16x32_bf16 v[112:115], v[84:87], v[204:207], v[112:115]
    v_lshlrev_b32_sdwa v108, 3, v121 dst_sel:DWORD dst_unused:UNUSED_PAD src0_sel:DWORD src1_sel:WORD_0
    v_lshlrev_b32_sdwa v110, 3, v121 dst_sel:DWORD dst_unused:UNUSED_PAD src0_sel:DWORD src1_sel:WORD_1
    ds_read_b64 v[108:109], v108
    ds_read_b64 v[110:111], v110
    s_waitcnt lgkmcnt(9)
    v_smfmac_f32_16x16x64_bf16 v[32:35], v[64:67], v[88:95], v68
    s_nop 1
    v_cvt_pk_bf16_f32 v112, v112, v113
    v_cvt_pk_bf16_f32 v113, v114, v115
    ds_write_b64 v70, v[112:113] offset:512
    v_mfma_f32_16x16x32_bf16 v[112:115], v[72:75], v[208:211], 0
    v_lshlrev_b32_sdwa v88, 3, v122 dst_sel:DWORD dst_unused:UNUSED_PAD src0_sel:DWORD src1_sel:WORD_0
    v_lshlrev_b32_sdwa v90, 3, v122 dst_sel:DWORD dst_unused:UNUSED_PAD src0_sel:DWORD src1_sel:WORD_1
    ds_read_b64 v[88:89], v88
    ds_read_b64 v[90:91], v90
    v_mfma_f32_16x16x32_bf16 v[112:115], v[76:79], v[212:215], v[112:115]
    v_lshlrev_b32_sdwa v92, 3, v123 dst_sel:DWORD dst_unused:UNUSED_PAD src0_sel:DWORD src1_sel:WORD_0
    v_lshlrev_b32_sdwa v94, 3, v123 dst_sel:DWORD dst_unused:UNUSED_PAD src0_sel:DWORD src1_sel:WORD_1
    ds_read_b64 v[92:93], v92
    ds_read_b64 v[94:95], v94
    buffer_load_dwordx4 v[120:123], v69, s[12:15], s20 offen offset:0 sc1
    s_waitcnt lgkmcnt(9)
    v_smfmac_f32_16x16x64_bf16 v[36:39], v[64:67], v[96:103], v68
    v_mfma_f32_16x16x32_bf16 v[112:115], v[80:83], v[216:219], v[112:115]
    s_waitcnt vmcnt(2)
    v_lshlrev_b32_sdwa v96, 3, v124 dst_sel:DWORD dst_unused:UNUSED_PAD src0_sel:DWORD src1_sel:WORD_0
    v_lshlrev_b32_sdwa v98, 3, v124 dst_sel:DWORD dst_unused:UNUSED_PAD src0_sel:DWORD src1_sel:WORD_1
    ds_read_b64 v[96:97], v96
    ds_read_b64 v[98:99], v98
    v_mfma_f32_16x16x32_bf16 v[112:115], v[84:87], v[220:223], v[112:115]
    v_lshlrev_b32_sdwa v100, 3, v125 dst_sel:DWORD dst_unused:UNUSED_PAD src0_sel:DWORD src1_sel:WORD_0
    v_lshlrev_b32_sdwa v102, 3, v125 dst_sel:DWORD dst_unused:UNUSED_PAD src0_sel:DWORD src1_sel:WORD_1
    ds_read_b64 v[100:101], v100
    ds_read_b64 v[102:103], v102
    s_waitcnt lgkmcnt(9)
    v_smfmac_f32_16x16x64_bf16 v[40:43], v[64:67], v[104:111], v68
    s_nop 1
    v_cvt_pk_bf16_f32 v112, v112, v113
    v_cvt_pk_bf16_f32 v113, v114, v115
    ds_write_b64 v70, v[112:113] offset:640
    v_mfma_f32_16x16x32_bf16 v[112:115], v[72:75], v[224:227], 0
    v_mfma_f32_16x16x32_bf16 v[112:115], v[76:79], v[228:231], v[112:115]
    v_lshlrev_b32_sdwa v104, 3, v126 dst_sel:DWORD dst_unused:UNUSED_PAD src0_sel:DWORD src1_sel:WORD_0
    v_lshlrev_b32_sdwa v106, 3, v126 dst_sel:DWORD dst_unused:UNUSED_PAD src0_sel:DWORD src1_sel:WORD_1
    ds_read_b64 v[104:105], v104
    ds_read_b64 v[106:107], v106
    v_mfma_f32_16x16x32_bf16 v[112:115], v[80:83], v[232:235], v[112:115]
    v_mfma_f32_16x16x32_bf16 v[112:115], v[84:87], v[236:239], v[112:115]
    v_lshlrev_b32_sdwa v108, 3, v127 dst_sel:DWORD dst_unused:UNUSED_PAD src0_sel:DWORD src1_sel:WORD_0
    v_lshlrev_b32_sdwa v110, 3, v127 dst_sel:DWORD dst_unused:UNUSED_PAD src0_sel:DWORD src1_sel:WORD_1
    ds_read_b64 v[108:109], v108
    ds_read_b64 v[110:111], v110
    buffer_load_dwordx4 v[124:127], v69, s[12:15], s20 offen offset:1024 sc1
    s_waitcnt lgkmcnt(9)
    v_smfmac_f32_16x16x64_bf16 v[44:47], v[64:67], v[88:95], v68
    s_nop 0
    v_cvt_pk_bf16_f32 v112, v112, v113
    v_cvt_pk_bf16_f32 v113, v114, v115
    ds_write_b64 v70, v[112:113] offset:768
    s_setprio 1
    v_mfma_f32_16x16x32_bf16 v[112:115], v[72:75], v[240:243], 0
    buffer_load_dwordx4 v[72:75], v69, s[12:15], s21 offen offset:0
    s_waitcnt vmcnt(3)
    v_lshlrev_b32_sdwa v88, 3, v116 dst_sel:DWORD dst_unused:UNUSED_PAD src0_sel:DWORD src1_sel:WORD_0
    v_lshlrev_b32_sdwa v90, 3, v116 dst_sel:DWORD dst_unused:UNUSED_PAD src0_sel:DWORD src1_sel:WORD_1
    ds_read_b64 v[88:89], v88
    ds_read_b64 v[90:91], v90
    v_mfma_f32_16x16x32_bf16 v[112:115], v[76:79], v[244:247], v[112:115]
    buffer_load_dwordx4 v[76:79], v69, s[12:15], s21 offen offset:1024
    v_lshlrev_b32_sdwa v92, 3, v117 dst_sel:DWORD dst_unused:UNUSED_PAD src0_sel:DWORD src1_sel:WORD_0
    v_lshlrev_b32_sdwa v94, 3, v117 dst_sel:DWORD dst_unused:UNUSED_PAD src0_sel:DWORD src1_sel:WORD_1
    ds_read_b64 v[92:93], v92
    ds_read_b64 v[94:95], v94
    s_waitcnt lgkmcnt(10)
    v_smfmac_f32_16x16x64_bf16 v[48:51], v[64:67], v[96:103], v68
    v_mfma_f32_16x16x32_bf16 v[112:115], v[80:83], v[248:251], v[112:115]
    buffer_load_dwordx4 v[80:83], v69, s[12:15], s19 offen offset:0
    v_lshlrev_b32_sdwa v96, 3, v118 dst_sel:DWORD dst_unused:UNUSED_PAD src0_sel:DWORD src1_sel:WORD_0
    v_lshlrev_b32_sdwa v98, 3, v118 dst_sel:DWORD dst_unused:UNUSED_PAD src0_sel:DWORD src1_sel:WORD_1
    ds_read_b64 v[96:97], v96
    ds_read_b64 v[98:99], v98
    v_mfma_f32_16x16x32_bf16 v[112:115], v[84:87], v[252:255], v[112:115]
    buffer_load_dwordx4 v[84:87], v69, s[12:15], s19 offen offset:1024
    s_add_u32 s21, s21, 4096
    s_add_u32 s19, s19, 4096
    v_lshlrev_b32_sdwa v100, 3, v119 dst_sel:DWORD dst_unused:UNUSED_PAD src0_sel:DWORD src1_sel:WORD_0
    v_lshlrev_b32_sdwa v102, 3, v119 dst_sel:DWORD dst_unused:UNUSED_PAD src0_sel:DWORD src1_sel:WORD_1
    ds_read_b64 v[100:101], v100
    ds_read_b64 v[102:103], v102
    buffer_load_dwordx4 v[116:119], v69, s[12:15], s20 offen offset:2048 sc1
    s_waitcnt lgkmcnt(9)
    v_smfmac_f32_16x16x64_bf16 v[52:55], v[64:67], v[104:111], v68
    v_cvt_pk_bf16_f32 v112, v112, v113
    v_cvt_pk_bf16_f32 v113, v114, v115
    ds_write_b64 v70, v[112:113] offset:896
    s_add_u32 s23, s23, 1
    s_cmp_eq_u32 s23, 5
    s_cselect_b32 s35, 4294836224, s32
    s_cselect_b32 s23, 0, s23
    v_add_u32 v70, s35, v70
    s_waitcnt vmcnt(6)
    v_lshlrev_b32_sdwa v104, 3, v120 dst_sel:DWORD dst_unused:UNUSED_PAD src0_sel:DWORD src1_sel:WORD_0
    v_lshlrev_b32_sdwa v106, 3, v120 dst_sel:DWORD dst_unused:UNUSED_PAD src0_sel:DWORD src1_sel:WORD_1
    ds_read_b64 v[104:105], v104
    ds_read_b64 v[106:107], v106
    v_lshlrev_b32_sdwa v108, 3, v121 dst_sel:DWORD dst_unused:UNUSED_PAD src0_sel:DWORD src1_sel:WORD_0
    v_lshlrev_b32_sdwa v110, 3, v121 dst_sel:DWORD dst_unused:UNUSED_PAD src0_sel:DWORD src1_sel:WORD_1
    ds_read_b64 v[108:109], v108
    ds_read_b64 v[110:111], v110
    s_waitcnt lgkmcnt(9)
    v_smfmac_f32_16x16x64_bf16 v[56:59], v[64:67], v[88:95], v68
    s_setprio 0
    v_lshlrev_b32_sdwa v88, 3, v122 dst_sel:DWORD dst_unused:UNUSED_PAD src0_sel:DWORD src1_sel:WORD_0
    v_lshlrev_b32_sdwa v90, 3, v122 dst_sel:DWORD dst_unused:UNUSED_PAD src0_sel:DWORD src1_sel:WORD_1
    ds_read_b64 v[88:89], v88
    ds_read_b64 v[90:91], v90
    v_lshlrev_b32_sdwa v92, 3, v123 dst_sel:DWORD dst_unused:UNUSED_PAD src0_sel:DWORD src1_sel:WORD_0
    v_lshlrev_b32_sdwa v94, 3, v123 dst_sel:DWORD dst_unused:UNUSED_PAD src0_sel:DWORD src1_sel:WORD_1
    ds_read_b64 v[92:93], v92
    ds_read_b64 v[94:95], v94
    buffer_load_dwordx4 v[120:123], v69, s[12:15], s20 offen offset:3072 sc1
    s_add_u32 s20, s20, 4096
    s_waitcnt lgkmcnt(9)
    v_smfmac_f32_16x16x64_bf16 v[60:63], v[64:67], v[96:103], v68
    s_waitcnt lgkmcnt(8)
    s_barrier
    s_setprio 3
    s_waitcnt vmcnt(6)
    v_lshlrev_b32_sdwa v96, 3, v124 dst_sel:DWORD dst_unused:UNUSED_PAD src0_sel:DWORD src1_sel:WORD_0
    v_lshlrev_b32_sdwa v98, 3, v124 dst_sel:DWORD dst_unused:UNUSED_PAD src0_sel:DWORD src1_sel:WORD_1
    ds_read_b64 v[96:97], v96
    ds_read_b64 v[98:99], v98
    v_lshlrev_b32_sdwa v100, 3, v125 dst_sel:DWORD dst_unused:UNUSED_PAD src0_sel:DWORD src1_sel:WORD_0
    v_lshlrev_b32_sdwa v102, 3, v125 dst_sel:DWORD dst_unused:UNUSED_PAD src0_sel:DWORD src1_sel:WORD_1
    ds_read_b64 v[100:101], v100
    ds_read_b64 v[102:103], v102
    s_waitcnt lgkmcnt(8)
    v_smfmac_f32_16x16x64_bf16 v[0:3], v[64:67], v[104:111], v68
    s_waitcnt vmcnt(5)
    v_mfma_f32_16x16x32_bf16 v[112:115], v[72:75], v[128:131], 0
    v_lshlrev_b32_sdwa v104, 3, v126 dst_sel:DWORD dst_unused:UNUSED_PAD src0_sel:DWORD src1_sel:WORD_0
    v_lshlrev_b32_sdwa v106, 3, v126 dst_sel:DWORD dst_unused:UNUSED_PAD src0_sel:DWORD src1_sel:WORD_1
    ds_read_b64 v[104:105], v104
    ds_read_b64 v[106:107], v106
    s_waitcnt vmcnt(4)
    v_mfma_f32_16x16x32_bf16 v[112:115], v[76:79], v[132:135], v[112:115]
    v_lshlrev_b32_sdwa v108, 3, v127 dst_sel:DWORD dst_unused:UNUSED_PAD src0_sel:DWORD src1_sel:WORD_0
    v_lshlrev_b32_sdwa v110, 3, v127 dst_sel:DWORD dst_unused:UNUSED_PAD src0_sel:DWORD src1_sel:WORD_1
    ds_read_b64 v[108:109], v108
    ds_read_b64 v[110:111], v110
    buffer_load_dwordx4 v[124:127], v69, s[12:15], s20 offen offset:0 sc1
    s_waitcnt lgkmcnt(8)
    v_smfmac_f32_16x16x64_bf16 v[4:7], v[64:67], v[88:95], v68
    s_waitcnt vmcnt(4)
    v_mfma_f32_16x16x32_bf16 v[112:115], v[80:83], v[136:139], v[112:115]
    s_waitcnt vmcnt(2)
    v_lshlrev_b32_sdwa v88, 3, v116 dst_sel:DWORD dst_unused:UNUSED_PAD src0_sel:DWORD src1_sel:WORD_0
    v_lshlrev_b32_sdwa v90, 3, v116 dst_sel:DWORD dst_unused:UNUSED_PAD src0_sel:DWORD src1_sel:WORD_1
    ds_read_b64 v[88:89], v88
    ds_read_b64 v[90:91], v90
    s_waitcnt vmcnt(3)
    v_mfma_f32_16x16x32_bf16 v[112:115], v[84:87], v[140:143], v[112:115]
    v_lshlrev_b32_sdwa v92, 3, v117 dst_sel:DWORD dst_unused:UNUSED_PAD src0_sel:DWORD src1_sel:WORD_0
    v_lshlrev_b32_sdwa v94, 3, v117 dst_sel:DWORD dst_unused:UNUSED_PAD src0_sel:DWORD src1_sel:WORD_1
    ds_read_b64 v[92:93], v92
    ds_read_b64 v[94:95], v94
    s_waitcnt lgkmcnt(8)
    v_smfmac_f32_16x16x64_bf16 v[8:11], v[64:67], v[96:103], v68
    s_nop 1
    v_cvt_pk_bf16_f32 v112, v112, v113
    v_cvt_pk_bf16_f32 v113, v114, v115
    ds_write_b64 v70, v[112:113] offset:0
    v_mfma_f32_16x16x32_bf16 v[112:115], v[72:75], v[144:147], 0
    v_mfma_f32_16x16x32_bf16 v[112:115], v[76:79], v[148:151], v[112:115]
    v_lshlrev_b32_sdwa v96, 3, v118 dst_sel:DWORD dst_unused:UNUSED_PAD src0_sel:DWORD src1_sel:WORD_0
    v_lshlrev_b32_sdwa v98, 3, v118 dst_sel:DWORD dst_unused:UNUSED_PAD src0_sel:DWORD src1_sel:WORD_1
    ds_read_b64 v[96:97], v96
    ds_read_b64 v[98:99], v98
    v_mfma_f32_16x16x32_bf16 v[112:115], v[80:83], v[152:155], v[112:115]
    v_mfma_f32_16x16x32_bf16 v[112:115], v[84:87], v[156:159], v[112:115]
    v_lshlrev_b32_sdwa v100, 3, v119 dst_sel:DWORD dst_unused:UNUSED_PAD src0_sel:DWORD src1_sel:WORD_0
    v_lshlrev_b32_sdwa v102, 3, v119 dst_sel:DWORD dst_unused:UNUSED_PAD src0_sel:DWORD src1_sel:WORD_1
    ds_read_b64 v[100:101], v100
    ds_read_b64 v[102:103], v102
    buffer_load_dwordx4 v[116:119], v69, s[12:15], s20 offen offset:1024 sc1
    s_waitcnt lgkmcnt(9)
    v_smfmac_f32_16x16x64_bf16 v[12:15], v[64:67], v[104:111], v68
    s_nop 0
    v_cvt_pk_bf16_f32 v112, v112, v113
    v_cvt_pk_bf16_f32 v113, v114, v115
    ds_write_b64 v70, v[112:113] offset:128
    v_mfma_f32_16x16x32_bf16 v[112:115], v[72:75], v[160:163], 0
    s_waitcnt vmcnt(2)
    v_lshlrev_b32_sdwa v104, 3, v120 dst_sel:DWORD dst_unused:UNUSED_PAD src0_sel:DWORD src1_sel:WORD_0
    v_lshlrev_b32_sdwa v106, 3, v120 dst_sel:DWORD dst_unused:UNUSED_PAD src0_sel:DWORD src1_sel:WORD_1
    ds_read_b64 v[104:105], v104
    ds_read_b64 v[106:107], v106
    v_mfma_f32_16x16x32_bf16 v[112:115], v[76:79], v[164:167], v[112:115]
    v_lshlrev_b32_sdwa v108, 3, v121 dst_sel:DWORD dst_unused:UNUSED_PAD src0_sel:DWORD src1_sel:WORD_0
    v_lshlrev_b32_sdwa v110, 3, v121 dst_sel:DWORD dst_unused:UNUSED_PAD src0_sel:DWORD src1_sel:WORD_1
    ds_read_b64 v[108:109], v108
    ds_read_b64 v[110:111], v110
    s_waitcnt lgkmcnt(10)
    v_smfmac_f32_16x16x64_bf16 v[16:19], v[64:67], v[88:95], v68
    v_mfma_f32_16x16x32_bf16 v[112:115], v[80:83], v[168:171], v[112:115]
    v_lshlrev_b32_sdwa v88, 3, v122 dst_sel:DWORD dst_unused:UNUSED_PAD src0_sel:DWORD src1_sel:WORD_0
    v_lshlrev_b32_sdwa v90, 3, v122 dst_sel:DWORD dst_unused:UNUSED_PAD src0_sel:DWORD src1_sel:WORD_1
    ds_read_b64 v[88:89], v88
    ds_read_b64 v[90:91], v90
    v_mfma_f32_16x16x32_bf16 v[112:115], v[84:87], v[172:175], v[112:115]
    v_lshlrev_b32_sdwa v92, 3, v123 dst_sel:DWORD dst_unused:UNUSED_PAD src0_sel:DWORD src1_sel:WORD_0
    v_lshlrev_b32_sdwa v94, 3, v123 dst_sel:DWORD dst_unused:UNUSED_PAD src0_sel:DWORD src1_sel:WORD_1
    ds_read_b64 v[92:93], v92
    ds_read_b64 v[94:95], v94
    buffer_load_dwordx4 v[120:123], v69, s[12:15], s20 offen offset:2048 sc1
    s_waitcnt lgkmcnt(9)
    v_smfmac_f32_16x16x64_bf16 v[20:23], v[64:67], v[96:103], v68
    s_nop 0
    v_cvt_pk_bf16_f32 v112, v112, v113
    v_cvt_pk_bf16_f32 v113, v114, v115
    ds_write_b64 v70, v[112:113] offset:256
    v_mfma_f32_16x16x32_bf16 v[112:115], v[72:75], v[176:179], 0
    v_mfma_f32_16x16x32_bf16 v[112:115], v[76:79], v[180:183], v[112:115]
    s_waitcnt vmcnt(2)
    v_lshlrev_b32_sdwa v96, 3, v124 dst_sel:DWORD dst_unused:UNUSED_PAD src0_sel:DWORD src1_sel:WORD_0
    v_lshlrev_b32_sdwa v98, 3, v124 dst_sel:DWORD dst_unused:UNUSED_PAD src0_sel:DWORD src1_sel:WORD_1
    ds_read_b64 v[96:97], v96
    ds_read_b64 v[98:99], v98
    v_mfma_f32_16x16x32_bf16 v[112:115], v[80:83], v[184:187], v[112:115]
    v_mfma_f32_16x16x32_bf16 v[112:115], v[84:87], v[188:191], v[112:115]
    v_lshlrev_b32_sdwa v100, 3, v125 dst_sel:DWORD dst_unused:UNUSED_PAD src0_sel:DWORD src1_sel:WORD_0
    v_lshlrev_b32_sdwa v102, 3, v125 dst_sel:DWORD dst_unused:UNUSED_PAD src0_sel:DWORD src1_sel:WORD_1
    ds_read_b64 v[100:101], v100
    ds_read_b64 v[102:103], v102
    s_waitcnt lgkmcnt(9)
    v_smfmac_f32_16x16x64_bf16 v[24:27], v[64:67], v[104:111], v68
    s_nop 1
    v_cvt_pk_bf16_f32 v112, v112, v113
    v_cvt_pk_bf16_f32 v113, v114, v115
    ds_write_b64 v70, v[112:113] offset:384
    v_mfma_f32_16x16x32_bf16 v[112:115], v[72:75], v[192:195], 0
    v_lshlrev_b32_sdwa v104, 3, v126 dst_sel:DWORD dst_unused:UNUSED_PAD src0_sel:DWORD src1_sel:WORD_0
    v_lshlrev_b32_sdwa v106, 3, v126 dst_sel:DWORD dst_unused:UNUSED_PAD src0_sel:DWORD src1_sel:WORD_1
    ds_read_b64 v[104:105], v104
    ds_read_b64 v[106:107], v106
    v_mfma_f32_16x16x32_bf16 v[112:115], v[76:79], v[196:199], v[112:115]
    v_lshlrev_b32_sdwa v108, 3, v127 dst_sel:DWORD dst_unused:UNUSED_PAD src0_sel:DWORD src1_sel:WORD_0
    v_lshlrev_b32_sdwa v110, 3, v127 dst_sel:DWORD dst_unused:UNUSED_PAD src0_sel:DWORD src1_sel:WORD_1
    ds_read_b64 v[108:109], v108
    ds_read_b64 v[110:111], v110
    buffer_load_dwordx4 v[124:127], v69, s[12:15], s20 offen offset:3072 sc1
    s_add_u32 s20, s20, 61440
    s_waitcnt lgkmcnt(10)
    v_smfmac_f32_16x16x64_bf16 v[28:31], v[64:67], v[88:95], v68
    s_setprio 2
    v_mfma_f32_16x16x32_bf16 v[112:115], v[80:83], v[200:203], v[112:115]
    s_waitcnt vmcnt(2)
    v_lshlrev_b32_sdwa v88, 3, v116 dst_sel:DWORD dst_unused:UNUSED_PAD src0_sel:DWORD src1_sel:WORD_0
    v_lshlrev_b32_sdwa v90, 3, v116 dst_sel:DWORD dst_unused:UNUSED_PAD src0_sel:DWORD src1_sel:WORD_1
    ds_read_b64 v[88:89], v88
    ds_read_b64 v[90:91], v90
    v_mfma_f32_16x16x32_bf16 v[112:115], v[84:87], v[204:207], v[112:115]
    v_lshlrev_b32_sdwa v92, 3, v117 dst_sel:DWORD dst_unused:UNUSED_PAD src0_sel:DWORD src1_sel:WORD_0
    v_lshlrev_b32_sdwa v94, 3, v117 dst_sel:DWORD dst_unused:UNUSED_PAD src0_sel:DWORD src1_sel:WORD_1
    ds_read_b64 v[92:93], v92
    ds_read_b64 v[94:95], v94
    s_waitcnt lgkmcnt(9)
    v_smfmac_f32_16x16x64_bf16 v[32:35], v[64:67], v[96:103], v68
    s_nop 1
    v_cvt_pk_bf16_f32 v112, v112, v113
    v_cvt_pk_bf16_f32 v113, v114, v115
    ds_write_b64 v70, v[112:113] offset:512
    v_mfma_f32_16x16x32_bf16 v[112:115], v[72:75], v[208:211], 0
    v_lshlrev_b32_sdwa v96, 3, v118 dst_sel:DWORD dst_unused:UNUSED_PAD src0_sel:DWORD src1_sel:WORD_0
    v_lshlrev_b32_sdwa v98, 3, v118 dst_sel:DWORD dst_unused:UNUSED_PAD src0_sel:DWORD src1_sel:WORD_1
    ds_read_b64 v[96:97], v96
    ds_read_b64 v[98:99], v98
    v_mfma_f32_16x16x32_bf16 v[112:115], v[76:79], v[212:215], v[112:115]
    v_lshlrev_b32_sdwa v100, 3, v119 dst_sel:DWORD dst_unused:UNUSED_PAD src0_sel:DWORD src1_sel:WORD_0
    v_lshlrev_b32_sdwa v102, 3, v119 dst_sel:DWORD dst_unused:UNUSED_PAD src0_sel:DWORD src1_sel:WORD_1
    ds_read_b64 v[100:101], v100
    ds_read_b64 v[102:103], v102
    buffer_load_dwordx4 v[116:119], v69, s[12:15], s20 offen offset:0 sc1
    s_waitcnt lgkmcnt(9)
    v_smfmac_f32_16x16x64_bf16 v[36:39], v[64:67], v[104:111], v68
    v_mfma_f32_16x16x32_bf16 v[112:115], v[80:83], v[216:219], v[112:115]
    s_waitcnt vmcnt(2)
    v_lshlrev_b32_sdwa v104, 3, v120 dst_sel:DWORD dst_unused:UNUSED_PAD src0_sel:DWORD src1_sel:WORD_0
    v_lshlrev_b32_sdwa v106, 3, v120 dst_sel:DWORD dst_unused:UNUSED_PAD src0_sel:DWORD src1_sel:WORD_1
    ds_read_b64 v[104:105], v104
    ds_read_b64 v[106:107], v106
    v_mfma_f32_16x16x32_bf16 v[112:115], v[84:87], v[220:223], v[112:115]
    v_lshlrev_b32_sdwa v108, 3, v121 dst_sel:DWORD dst_unused:UNUSED_PAD src0_sel:DWORD src1_sel:WORD_0
    v_lshlrev_b32_sdwa v110, 3, v121 dst_sel:DWORD dst_unused:UNUSED_PAD src0_sel:DWORD src1_sel:WORD_1
    ds_read_b64 v[108:109], v108
    ds_read_b64 v[110:111], v110
    s_waitcnt lgkmcnt(9)
    v_smfmac_f32_16x16x64_bf16 v[40:43], v[64:67], v[88:95], v68
    s_nop 1
    v_cvt_pk_bf16_f32 v112, v112, v113
    v_cvt_pk_bf16_f32 v113, v114, v115
    ds_write_b64 v70, v[112:113] offset:640
    v_mfma_f32_16x16x32_bf16 v[112:115], v[72:75], v[224:227], 0
    v_mfma_f32_16x16x32_bf16 v[112:115], v[76:79], v[228:231], v[112:115]
    v_lshlrev_b32_sdwa v88, 3, v122 dst_sel:DWORD dst_unused:UNUSED_PAD src0_sel:DWORD src1_sel:WORD_0
    v_lshlrev_b32_sdwa v90, 3, v122 dst_sel:DWORD dst_unused:UNUSED_PAD src0_sel:DWORD src1_sel:WORD_1
    ds_read_b64 v[88:89], v88
    ds_read_b64 v[90:91], v90
    v_mfma_f32_16x16x32_bf16 v[112:115], v[80:83], v[232:235], v[112:115]
    v_mfma_f32_16x16x32_bf16 v[112:115], v[84:87], v[236:239], v[112:115]
    v_lshlrev_b32_sdwa v92, 3, v123 dst_sel:DWORD dst_unused:UNUSED_PAD src0_sel:DWORD src1_sel:WORD_0
    v_lshlrev_b32_sdwa v94, 3, v123 dst_sel:DWORD dst_unused:UNUSED_PAD src0_sel:DWORD src1_sel:WORD_1
    ds_read_b64 v[92:93], v92
    ds_read_b64 v[94:95], v94
    buffer_load_dwordx4 v[120:123], v69, s[12:15], s20 offen offset:1024 sc1
    s_waitcnt lgkmcnt(9)
    v_smfmac_f32_16x16x64_bf16 v[44:47], v[64:67], v[96:103], v68
    s_nop 0
    v_cvt_pk_bf16_f32 v112, v112, v113
    v_cvt_pk_bf16_f32 v113, v114, v115
    ds_write_b64 v70, v[112:113] offset:768
    s_setprio 1
    v_mfma_f32_16x16x32_bf16 v[112:115], v[72:75], v[240:243], 0
    buffer_load_dwordx4 v[72:75], v69, s[12:15], s21 offen offset:0
    s_waitcnt vmcnt(3)
    v_lshlrev_b32_sdwa v96, 3, v124 dst_sel:DWORD dst_unused:UNUSED_PAD src0_sel:DWORD src1_sel:WORD_0
    v_lshlrev_b32_sdwa v98, 3, v124 dst_sel:DWORD dst_unused:UNUSED_PAD src0_sel:DWORD src1_sel:WORD_1
    ds_read_b64 v[96:97], v96
    ds_read_b64 v[98:99], v98
    v_mfma_f32_16x16x32_bf16 v[112:115], v[76:79], v[244:247], v[112:115]
    buffer_load_dwordx4 v[76:79], v69, s[12:15], s21 offen offset:1024
    v_lshlrev_b32_sdwa v100, 3, v125 dst_sel:DWORD dst_unused:UNUSED_PAD src0_sel:DWORD src1_sel:WORD_0
    v_lshlrev_b32_sdwa v102, 3, v125 dst_sel:DWORD dst_unused:UNUSED_PAD src0_sel:DWORD src1_sel:WORD_1
    ds_read_b64 v[100:101], v100
    ds_read_b64 v[102:103], v102
    s_waitcnt lgkmcnt(10)
    v_smfmac_f32_16x16x64_bf16 v[48:51], v[64:67], v[104:111], v68
    v_mfma_f32_16x16x32_bf16 v[112:115], v[80:83], v[248:251], v[112:115]
    buffer_load_dwordx4 v[80:83], v69, s[12:15], s19 offen offset:0
    v_lshlrev_b32_sdwa v104, 3, v126 dst_sel:DWORD dst_unused:UNUSED_PAD src0_sel:DWORD src1_sel:WORD_0
    v_lshlrev_b32_sdwa v106, 3, v126 dst_sel:DWORD dst_unused:UNUSED_PAD src0_sel:DWORD src1_sel:WORD_1
    ds_read_b64 v[104:105], v104
    ds_read_b64 v[106:107], v106
    v_mfma_f32_16x16x32_bf16 v[112:115], v[84:87], v[252:255], v[112:115]
    buffer_load_dwordx4 v[84:87], v69, s[12:15], s19 offen offset:1024
    s_add_u32 s21, s21, 4096
    s_add_u32 s19, s19, 4096
    v_lshlrev_b32_sdwa v108, 3, v127 dst_sel:DWORD dst_unused:UNUSED_PAD src0_sel:DWORD src1_sel:WORD_0
    v_lshlrev_b32_sdwa v110, 3, v127 dst_sel:DWORD dst_unused:UNUSED_PAD src0_sel:DWORD src1_sel:WORD_1
    ds_read_b64 v[108:109], v108
    ds_read_b64 v[110:111], v110
    buffer_load_dwordx4 v[124:127], v69, s[12:15], s20 offen offset:2048 sc1
    s_waitcnt lgkmcnt(9)
    v_smfmac_f32_16x16x64_bf16 v[52:55], v[64:67], v[88:95], v68
    v_cvt_pk_bf16_f32 v112, v112, v113
    v_cvt_pk_bf16_f32 v113, v114, v115
    ds_write_b64 v70, v[112:113] offset:896
    s_add_u32 s23, s23, 1
    s_cmp_eq_u32 s23, 5
    s_cselect_b32 s35, 4294836224, s32
    s_cselect_b32 s23, 0, s23
    v_add_u32 v70, s35, v70
    s_waitcnt vmcnt(6)
    v_lshlrev_b32_sdwa v88, 3, v116 dst_sel:DWORD dst_unused:UNUSED_PAD src0_sel:DWORD src1_sel:WORD_0
    v_lshlrev_b32_sdwa v90, 3, v116 dst_sel:DWORD dst_unused:UNUSED_PAD src0_sel:DWORD src1_sel:WORD_1
    ds_read_b64 v[88:89], v88
    ds_read_b64 v[90:91], v90
    v_lshlrev_b32_sdwa v92, 3, v117 dst_sel:DWORD dst_unused:UNUSED_PAD src0_sel:DWORD src1_sel:WORD_0
    v_lshlrev_b32_sdwa v94, 3, v117 dst_sel:DWORD dst_unused:UNUSED_PAD src0_sel:DWORD src1_sel:WORD_1
    ds_read_b64 v[92:93], v92
    ds_read_b64 v[94:95], v94
    s_waitcnt lgkmcnt(9)
    v_smfmac_f32_16x16x64_bf16 v[56:59], v[64:67], v[96:103], v68
    s_setprio 0
    v_lshlrev_b32_sdwa v96, 3, v118 dst_sel:DWORD dst_unused:UNUSED_PAD src0_sel:DWORD src1_sel:WORD_0
    v_lshlrev_b32_sdwa v98, 3, v118 dst_sel:DWORD dst_unused:UNUSED_PAD src0_sel:DWORD src1_sel:WORD_1
    ds_read_b64 v[96:97], v96
    ds_read_b64 v[98:99], v98
    v_lshlrev_b32_sdwa v100, 3, v119 dst_sel:DWORD dst_unused:UNUSED_PAD src0_sel:DWORD src1_sel:WORD_0
    v_lshlrev_b32_sdwa v102, 3, v119 dst_sel:DWORD dst_unused:UNUSED_PAD src0_sel:DWORD src1_sel:WORD_1
    ds_read_b64 v[100:101], v100
    ds_read_b64 v[102:103], v102
    buffer_load_dwordx4 v[116:119], v69, s[12:15], s20 offen offset:3072 sc1
    s_add_u32 s20, s20, 4096
    s_waitcnt lgkmcnt(9)
    v_smfmac_f32_16x16x64_bf16 v[60:63], v[64:67], v[104:111], v68
    s_waitcnt lgkmcnt(8)
    s_barrier

    s_add_u32 s22, s22, 1
    s_branch k1_kernel_gloop

k1_kernel_fin:

    s_add_u32 s40, s20, 61440
    s_add_u32 s41, s20, 65536
    s_add_u32 s44, s20, 126976
    s_add_u32 s45, s20, 131072

    s_lshl_b32 s28, s38, 16
    s_and_b32 s29, s38, 0xffff0000
    s_lshl_b32 s30, s39, 16
    s_and_b32 s31, s39, 0xffff0000
    s_lshl_b32 s35, s33, 16
    s_lshl_b32 s42, s34, 15
    s_add_u32 s35, s35, s42
    s_lshl_b32 s42, s3, 12
    s_add_u32 s35, s35, s42
    s_add_u32 s35, s35, 20971520

    s_and_b32 s57, s57, 0xffff
    s_mov_b32 s58, 2
    s_mov_b32 s59, 0x00020000
    s_and_b32 s61, s61, 0xffff
    s_mov_b32 s62, 32768
    s_mov_b32 s63, 0x00020000
    s_xor_b32 s64, s34, 1
    s_lshl_b32 s64, s64, 7
    s_add_u32 s64, s64, s33
    s_lshl_b32 s65, s3, 20
    s_add_u32 s66, s65, 1048576
    s_lshl_b32 s67, s3, 8
    s_lshl_b32 s68, s64, 7
    s_lshl_b32 s69, s64, 8
    s_add_u32 s69, s69, s65
    s_add_u32 s69, s69, 20971520
    s_mov_b32 s42, 0
    s_mov_b32 s43, 0

    s_setprio 3
    v_mov_b32 v128, 0xbdd2d3e8
    v_mov_b32 v129, 0xbdd2d3e8
    v_mov_b32 v130, 0xc0135761
    v_mov_b32 v131, 0xc0135761
    v_mov_b32 v132, 1.0
    v_mov_b32 v133, 1.0
    v_mov_b32 v134, s28
    v_mov_b32 v135, s29
    v_mov_b32 v136, s30
    s_waitcnt vmcnt(6)
    v_lshlrev_b32_sdwa v88, 3, v116 dst_sel:DWORD dst_unused:UNUSED_PAD src0_sel:DWORD src1_sel:WORD_0
    v_lshlrev_b32_sdwa v90, 3, v116 dst_sel:DWORD dst_unused:UNUSED_PAD src0_sel:DWORD src1_sel:WORD_1
    ds_read_b64 v[88:89], v88
    ds_read_b64 v[90:91], v90
    v_lshlrev_b32_sdwa v92, 3, v117 dst_sel:DWORD dst_unused:UNUSED_PAD src0_sel:DWORD src1_sel:WORD_0
    v_lshlrev_b32_sdwa v94, 3, v117 dst_sel:DWORD dst_unused:UNUSED_PAD src0_sel:DWORD src1_sel:WORD_1
    ds_read_b64 v[92:93], v92
    ds_read_b64 v[94:95], v94
    s_waitcnt lgkmcnt(8)
    v_smfmac_f32_16x16x64_bf16 v[0:3], v[64:67], v[96:103], v68
    v_mov_b32 v137, s31
    v_lshrrev_b32 v70, 2, v69
    v_and_b32 v71, 128, v70
    v_add_u32 v70, v70, v71
    v_rcp_f32 v134, v134
    v_rcp_f32 v135, v135
    v_rcp_f32 v136, v136
    v_rcp_f32 v137, v137
    v_mov_b32 v132, 0x7f7fffff
    v_lshlrev_b32_sdwa v96, 3, v118 dst_sel:DWORD dst_unused:UNUSED_PAD src0_sel:DWORD src1_sel:WORD_0
    v_lshlrev_b32_sdwa v98, 3, v118 dst_sel:DWORD dst_unused:UNUSED_PAD src0_sel:DWORD src1_sel:WORD_1
    ds_read_b64 v[96:97], v96
    ds_read_b64 v[98:99], v98
    v_lshlrev_b32_sdwa v100, 3, v119 dst_sel:DWORD dst_unused:UNUSED_PAD src0_sel:DWORD src1_sel:WORD_0
    v_lshlrev_b32_sdwa v102, 3, v119 dst_sel:DWORD dst_unused:UNUSED_PAD src0_sel:DWORD src1_sel:WORD_1
    ds_read_b64 v[100:101], v100
    ds_read_b64 v[102:103], v102
    buffer_load_dwordx4 v[116:119], v69, s[12:15], s40 offen offset:0 sc1
    s_waitcnt lgkmcnt(8)
    v_smfmac_f32_16x16x64_bf16 v[4:7], v[64:67], v[104:111], v68
    v_mov_b32 v133, 0xff7fffff
    v_med3_f32 v134, v134, v132, v133
    v_med3_f32 v135, v135, v132, v133
    v_med3_f32 v136, v136, v132, v133
    v_med3_f32 v137, v137, v132, v133
    s_waitcnt vmcnt(3)
    v_mov_b32 v73, 0
    v_lshrrev_b32 v76, 2, v69
    v_mov_b32 v79, 0
    v_and_b32 v75, 0xf0, v69
    s_waitcnt vmcnt(2)
    v_lshlrev_b32_sdwa v104, 3, v120 dst_sel:DWORD dst_unused:UNUSED_PAD src0_sel:DWORD src1_sel:WORD_0
    v_lshlrev_b32_sdwa v106, 3, v120 dst_sel:DWORD dst_unused:UNUSED_PAD src0_sel:DWORD src1_sel:WORD_1
    ds_read_b64 v[104:105], v104
    ds_read_b64 v[106:107], v106
    v_lshlrev_b32_sdwa v108, 3, v121 dst_sel:DWORD dst_unused:UNUSED_PAD src0_sel:DWORD src1_sel:WORD_0
    v_lshlrev_b32_sdwa v110, 3, v121 dst_sel:DWORD dst_unused:UNUSED_PAD src0_sel:DWORD src1_sel:WORD_1
    ds_read_b64 v[108:109], v108
    ds_read_b64 v[110:111], v110
    s_waitcnt lgkmcnt(8)
    v_smfmac_f32_16x16x64_bf16 v[8:11], v[64:67], v[88:95], v68
    v_lshrrev_b32 v80, 8, v69
    v_lshl_add_u32 v74, v80, 16, v75
    v_lshl_add_u32 v75, v80, 2, v75
    v_add_u32 v77, s67, v76
    v_lshrrev_b32 v78, 1, v75
    v_lshlrev_b32_sdwa v88, 3, v122 dst_sel:DWORD dst_unused:UNUSED_PAD src0_sel:DWORD src1_sel:WORD_0
    v_lshlrev_b32_sdwa v90, 3, v122 dst_sel:DWORD dst_unused:UNUSED_PAD src0_sel:DWORD src1_sel:WORD_1
    ds_read_b64 v[88:89], v88
    ds_read_b64 v[90:91], v90
    v_lshlrev_b32_sdwa v92, 3, v123 dst_sel:DWORD dst_unused:UNUSED_PAD src0_sel:DWORD src1_sel:WORD_0
    v_lshlrev_b32_sdwa v94, 3, v123 dst_sel:DWORD dst_unused:UNUSED_PAD src0_sel:DWORD src1_sel:WORD_1
    ds_read_b64 v[92:93], v92
    ds_read_b64 v[94:95], v94
    buffer_load_dwordx4 v[120:123], v69, s[12:15], s44 offen offset:0 sc1
    s_waitcnt lgkmcnt(8)
    v_smfmac_f32_16x16x64_bf16 v[12:15], v[64:67], v[96:103], v68
    s_waitcnt vmcnt(2)
    v_lshlrev_b32_sdwa v96, 3, v124 dst_sel:DWORD dst_unused:UNUSED_PAD src0_sel:DWORD src1_sel:WORD_0
    v_lshlrev_b32_sdwa v98, 3, v124 dst_sel:DWORD dst_unused:UNUSED_PAD src0_sel:DWORD src1_sel:WORD_1
    ds_read_b64 v[96:97], v96
    ds_read_b64 v[98:99], v98
    v_lshlrev_b32_sdwa v100, 3, v125 dst_sel:DWORD dst_unused:UNUSED_PAD src0_sel:DWORD src1_sel:WORD_0
    v_lshlrev_b32_sdwa v102, 3, v125 dst_sel:DWORD dst_unused:UNUSED_PAD src0_sel:DWORD src1_sel:WORD_1
    ds_read_b64 v[100:101], v100
    ds_read_b64 v[102:103], v102
    s_waitcnt lgkmcnt(8)
    v_smfmac_f32_16x16x64_bf16 v[16:19], v[64:67], v[104:111], v68
    v_lshlrev_b32_sdwa v104, 3, v126 dst_sel:DWORD dst_unused:UNUSED_PAD src0_sel:DWORD src1_sel:WORD_0
    v_lshlrev_b32_sdwa v106, 3, v126 dst_sel:DWORD dst_unused:UNUSED_PAD src0_sel:DWORD src1_sel:WORD_1
    ds_read_b64 v[104:105], v104
    ds_read_b64 v[106:107], v106
    v_lshlrev_b32_sdwa v108, 3, v127 dst_sel:DWORD dst_unused:UNUSED_PAD src0_sel:DWORD src1_sel:WORD_0
    v_lshlrev_b32_sdwa v110, 3, v127 dst_sel:DWORD dst_unused:UNUSED_PAD src0_sel:DWORD src1_sel:WORD_1
    ds_read_b64 v[108:109], v108
    ds_read_b64 v[110:111], v110
    buffer_load_dwordx4 v[124:127], v69, s[12:15], s40 offen offset:1024 sc1
    s_waitcnt lgkmcnt(8)
    v_smfmac_f32_16x16x64_bf16 v[20:23], v[64:67], v[88:95], v68
    s_waitcnt vmcnt(2)
    v_lshlrev_b32_sdwa v88, 3, v116 dst_sel:DWORD dst_unused:UNUSED_PAD src0_sel:DWORD src1_sel:WORD_0
    v_lshlrev_b32_sdwa v90, 3, v116 dst_sel:DWORD dst_unused:UNUSED_PAD src0_sel:DWORD src1_sel:WORD_1
    ds_read_b64 v[88:89], v88
    ds_read_b64 v[90:91], v90
    v_lshlrev_b32_sdwa v92, 3, v117 dst_sel:DWORD dst_unused:UNUSED_PAD src0_sel:DWORD src1_sel:WORD_0
    v_lshlrev_b32_sdwa v94, 3, v117 dst_sel:DWORD dst_unused:UNUSED_PAD src0_sel:DWORD src1_sel:WORD_1
    ds_read_b64 v[92:93], v92
    ds_read_b64 v[94:95], v94
    s_waitcnt lgkmcnt(8)
    v_smfmac_f32_16x16x64_bf16 v[24:27], v[64:67], v[96:103], v68
    v_lshlrev_b32_sdwa v96, 3, v118 dst_sel:DWORD dst_unused:UNUSED_PAD src0_sel:DWORD src1_sel:WORD_0
    v_lshlrev_b32_sdwa v98, 3, v118 dst_sel:DWORD dst_unused:UNUSED_PAD src0_sel:DWORD src1_sel:WORD_1
    ds_read_b64 v[96:97], v96
    ds_read_b64 v[98:99], v98
    v_lshlrev_b32_sdwa v100, 3, v119 dst_sel:DWORD dst_unused:UNUSED_PAD src0_sel:DWORD src1_sel:WORD_0
    v_lshlrev_b32_sdwa v102, 3, v119 dst_sel:DWORD dst_unused:UNUSED_PAD src0_sel:DWORD src1_sel:WORD_1
    ds_read_b64 v[100:101], v100
    ds_read_b64 v[102:103], v102
    buffer_load_dwordx4 v[116:119], v69, s[12:15], s44 offen offset:1024 sc1
    s_waitcnt lgkmcnt(8)
    v_smfmac_f32_16x16x64_bf16 v[28:31], v[64:67], v[104:111], v68
    s_waitcnt vmcnt(2)
    v_lshlrev_b32_sdwa v104, 3, v120 dst_sel:DWORD dst_unused:UNUSED_PAD src0_sel:DWORD src1_sel:WORD_0
    v_lshlrev_b32_sdwa v106, 3, v120 dst_sel:DWORD dst_unused:UNUSED_PAD src0_sel:DWORD src1_sel:WORD_1
    ds_read_b64 v[104:105], v104
    ds_read_b64 v[106:107], v106
    v_lshlrev_b32_sdwa v108, 3, v121 dst_sel:DWORD dst_unused:UNUSED_PAD src0_sel:DWORD src1_sel:WORD_0
    v_lshlrev_b32_sdwa v110, 3, v121 dst_sel:DWORD dst_unused:UNUSED_PAD src0_sel:DWORD src1_sel:WORD_1
    ds_read_b64 v[108:109], v108
    ds_read_b64 v[110:111], v110
    s_waitcnt lgkmcnt(8)
    v_smfmac_f32_16x16x64_bf16 v[0:3], v[64:67], v[88:95], v68
    v_lshlrev_b32_sdwa v88, 3, v122 dst_sel:DWORD dst_unused:UNUSED_PAD src0_sel:DWORD src1_sel:WORD_0
    v_lshlrev_b32_sdwa v90, 3, v122 dst_sel:DWORD dst_unused:UNUSED_PAD src0_sel:DWORD src1_sel:WORD_1
    ds_read_b64 v[88:89], v88
    ds_read_b64 v[90:91], v90
    v_lshlrev_b32_sdwa v92, 3, v123 dst_sel:DWORD dst_unused:UNUSED_PAD src0_sel:DWORD src1_sel:WORD_0
    v_lshlrev_b32_sdwa v94, 3, v123 dst_sel:DWORD dst_unused:UNUSED_PAD src0_sel:DWORD src1_sel:WORD_1
    ds_read_b64 v[92:93], v92
    ds_read_b64 v[94:95], v94
    buffer_load_dwordx4 v[120:123], v69, s[12:15], s40 offen offset:2048 sc1
    s_waitcnt lgkmcnt(8)
    v_smfmac_f32_16x16x64_bf16 v[4:7], v[64:67], v[96:103], v68
    s_waitcnt vmcnt(2)
    v_lshlrev_b32_sdwa v96, 3, v124 dst_sel:DWORD dst_unused:UNUSED_PAD src0_sel:DWORD src1_sel:WORD_0
    v_lshlrev_b32_sdwa v98, 3, v124 dst_sel:DWORD dst_unused:UNUSED_PAD src0_sel:DWORD src1_sel:WORD_1
    ds_read_b64 v[96:97], v96
    ds_read_b64 v[98:99], v98
    v_lshlrev_b32_sdwa v100, 3, v125 dst_sel:DWORD dst_unused:UNUSED_PAD src0_sel:DWORD src1_sel:WORD_0
    v_lshlrev_b32_sdwa v102, 3, v125 dst_sel:DWORD dst_unused:UNUSED_PAD src0_sel:DWORD src1_sel:WORD_1
    ds_read_b64 v[100:101], v100
    ds_read_b64 v[102:103], v102
    s_waitcnt lgkmcnt(8)
    v_smfmac_f32_16x16x64_bf16 v[0:3], v[64:67], v[104:111], v68
    v_lshlrev_b32_sdwa v104, 3, v126 dst_sel:DWORD dst_unused:UNUSED_PAD src0_sel:DWORD src1_sel:WORD_0
    v_lshlrev_b32_sdwa v106, 3, v126 dst_sel:DWORD dst_unused:UNUSED_PAD src0_sel:DWORD src1_sel:WORD_1
    ds_read_b64 v[104:105], v104
    ds_read_b64 v[106:107], v106
    v_lshlrev_b32_sdwa v108, 3, v127 dst_sel:DWORD dst_unused:UNUSED_PAD src0_sel:DWORD src1_sel:WORD_0
    v_lshlrev_b32_sdwa v110, 3, v127 dst_sel:DWORD dst_unused:UNUSED_PAD src0_sel:DWORD src1_sel:WORD_1
    ds_read_b64 v[108:109], v108
    ds_read_b64 v[110:111], v110
    buffer_load_dwordx4 v[124:127], v69, s[12:15], s44 offen offset:2048 sc1
    s_waitcnt lgkmcnt(8)
    v_smfmac_f32_16x16x64_bf16 v[4:7], v[64:67], v[88:95], v68
    s_waitcnt vmcnt(2)
    v_lshlrev_b32_sdwa v88, 3, v116 dst_sel:DWORD dst_unused:UNUSED_PAD src0_sel:DWORD src1_sel:WORD_0
    v_lshlrev_b32_sdwa v90, 3, v116 dst_sel:DWORD dst_unused:UNUSED_PAD src0_sel:DWORD src1_sel:WORD_1
    ds_read_b64 v[88:89], v88
    ds_read_b64 v[90:91], v90
    v_lshlrev_b32_sdwa v92, 3, v117 dst_sel:DWORD dst_unused:UNUSED_PAD src0_sel:DWORD src1_sel:WORD_0
    v_lshlrev_b32_sdwa v94, 3, v117 dst_sel:DWORD dst_unused:UNUSED_PAD src0_sel:DWORD src1_sel:WORD_1
    ds_read_b64 v[92:93], v92
    ds_read_b64 v[94:95], v94
    s_waitcnt lgkmcnt(8)
    v_smfmac_f32_16x16x64_bf16 v[8:11], v[64:67], v[96:103], v68
    v_pk_mul_f32 v[140:141], v[0:1], v[0:1]
    v_pk_mul_f32 v[142:143], v[2:3], v[2:3]
    v_pk_fma_f32 v[140:141], v[140:141], v[128:129], v[130:131]
    v_pk_fma_f32 v[142:143], v[142:143], v[128:129], v[130:131]
    v_pk_mul_f32 v[140:141], v[140:141], v[0:1]
    v_pk_mul_f32 v[142:143], v[142:143], v[2:3]
    v_exp_f32 v140, v140
    v_pk_mul_f32 v[146:147], v[4:5], v[4:5]
    v_pk_mul_f32 v[148:149], v[6:7], v[6:7]
    v_lshlrev_b32_sdwa v96, 3, v118 dst_sel:DWORD dst_unused:UNUSED_PAD src0_sel:DWORD src1_sel:WORD_0
    v_lshlrev_b32_sdwa v98, 3, v118 dst_sel:DWORD dst_unused:UNUSED_PAD src0_sel:DWORD src1_sel:WORD_1
    ds_read_b64 v[96:97], v96
    ds_read_b64 v[98:99], v98
    v_lshlrev_b32_sdwa v100, 3, v119 dst_sel:DWORD dst_unused:UNUSED_PAD src0_sel:DWORD src1_sel:WORD_0
    v_lshlrev_b32_sdwa v102, 3, v119 dst_sel:DWORD dst_unused:UNUSED_PAD src0_sel:DWORD src1_sel:WORD_1
    ds_read_b64 v[100:101], v100
    ds_read_b64 v[102:103], v102
    buffer_load_dwordx4 v[116:119], v69, s[12:15], s40 offen offset:3072 sc1
    s_waitcnt lgkmcnt(8)
    v_smfmac_f32_16x16x64_bf16 v[12:15], v[64:67], v[104:111], v68
    v_exp_f32 v141, v141
    v_pk_fma_f32 v[146:147], v[146:147], v[128:129], v[130:131]
    v_pk_fma_f32 v[148:149], v[148:149], v[128:129], v[130:131]
    v_exp_f32 v142, v142
    v_pk_fma_f32 v[140:141], v[140:141], v[134:135], v[134:135]
    v_pk_mul_f32 v[146:147], v[146:147], v[4:5]
    v_rcp_f32 v140, v140
    v_pk_mul_f32 v[148:149], v[148:149], v[6:7]
    v_rcp_f32 v141, v141
    s_waitcnt vmcnt(2)
    v_lshlrev_b32_sdwa v104, 3, v120 dst_sel:DWORD dst_unused:UNUSED_PAD src0_sel:DWORD src1_sel:WORD_0
    v_lshlrev_b32_sdwa v106, 3, v120 dst_sel:DWORD dst_unused:UNUSED_PAD src0_sel:DWORD src1_sel:WORD_1
    ds_read_b64 v[104:105], v104
    ds_read_b64 v[106:107], v106
    v_lshlrev_b32_sdwa v108, 3, v121 dst_sel:DWORD dst_unused:UNUSED_PAD src0_sel:DWORD src1_sel:WORD_0
    v_lshlrev_b32_sdwa v110, 3, v121 dst_sel:DWORD dst_unused:UNUSED_PAD src0_sel:DWORD src1_sel:WORD_1
    ds_read_b64 v[108:109], v108
    ds_read_b64 v[110:111], v110
    s_waitcnt lgkmcnt(8)
    v_smfmac_f32_16x16x64_bf16 v[8:11], v[64:67], v[88:95], v68
    v_exp_f32 v143, v143
    v_pk_mul_f32 v[144:145], v[0:1], v[140:141]
    v_exp_f32 v146, v146
    v_pk_fma_f32 v[142:143], v[142:143], v[136:137], v[136:137]
    v_exp_f32 v147, v147
    v_rcp_f32 v142, v142
    v_rcp_f32 v143, v143
    v_pk_fma_f32 v[146:147], v[146:147], v[134:135], v[134:135]
    v_exp_f32 v148, v148
    v_lshlrev_b32_sdwa v88, 3, v122 dst_sel:DWORD dst_unused:UNUSED_PAD src0_sel:DWORD src1_sel:WORD_0
    v_lshlrev_b32_sdwa v90, 3, v122 dst_sel:DWORD dst_unused:UNUSED_PAD src0_sel:DWORD src1_sel:WORD_1
    ds_read_b64 v[88:89], v88
    ds_read_b64 v[90:91], v90
    v_lshlrev_b32_sdwa v92, 3, v123 dst_sel:DWORD dst_unused:UNUSED_PAD src0_sel:DWORD src1_sel:WORD_0
    v_lshlrev_b32_sdwa v94, 3, v123 dst_sel:DWORD dst_unused:UNUSED_PAD src0_sel:DWORD src1_sel:WORD_1
    ds_read_b64 v[92:93], v92
    ds_read_b64 v[94:95], v94
    buffer_load_dwordx4 v[120:123], v69, s[12:15], s44 offen offset:3072 sc1
    s_waitcnt lgkmcnt(8)
    v_smfmac_f32_16x16x64_bf16 v[12:15], v[64:67], v[96:103], v68
    v_rcp_f32 v146, v146
    v_pk_fma_f32 v[144:145], v[2:3], v[142:143], v[144:145]
    v_pk_mul_f32 v[152:153], v[8:9], v[8:9]
    v_rcp_f32 v147, v147
    v_add_f32 v144, v144, v145
    v_pk_fma_f32 v[152:153], v[152:153], v[128:129], v[130:131]
    v_exp_f32 v149, v149
    v_min_u32 v144, -2, v144
    v_pk_mul_f32 v[150:151], v[4:5], v[146:147]
    s_waitcnt vmcnt(2)
    v_lshlrev_b32_sdwa v96, 3, v124 dst_sel:DWORD dst_unused:UNUSED_PAD src0_sel:DWORD src1_sel:WORD_0
    v_lshlrev_b32_sdwa v98, 3, v124 dst_sel:DWORD dst_unused:UNUSED_PAD src0_sel:DWORD src1_sel:WORD_1
    ds_read_b64 v[96:97], v96
    ds_read_b64 v[98:99], v98
    v_lshlrev_b32_sdwa v100, 3, v125 dst_sel:DWORD dst_unused:UNUSED_PAD src0_sel:DWORD src1_sel:WORD_0
    v_lshlrev_b32_sdwa v102, 3, v125 dst_sel:DWORD dst_unused:UNUSED_PAD src0_sel:DWORD src1_sel:WORD_1
    ds_read_b64 v[100:101], v100
    ds_read_b64 v[102:103], v102
    s_waitcnt lgkmcnt(8)
    v_smfmac_f32_16x16x64_bf16 v[16:19], v[64:67], v[104:111], v68
    buffer_store_dword v144, v70, s[12:15], s35 offen offset:0 sc1
    v_pk_fma_f32 v[148:149], v[148:149], v[136:137], v[136:137]
    v_pk_mul_f32 v[152:153], v[152:153], v[8:9]
    v_rcp_f32 v148, v148
    v_pk_mul_f32 v[154:155], v[10:11], v[10:11]
    v_pk_mul_f32 v[158:159], v[12:13], v[12:13]
    v_rcp_f32 v149, v149
    v_pk_fma_f32 v[154:155], v[154:155], v[128:129], v[130:131]
    v_pk_fma_f32 v[158:159], v[158:159], v[128:129], v[130:131]
    v_lshlrev_b32_sdwa v104, 3, v126 dst_sel:DWORD dst_unused:UNUSED_PAD src0_sel:DWORD src1_sel:WORD_0
    v_lshlrev_b32_sdwa v106, 3, v126 dst_sel:DWORD dst_unused:UNUSED_PAD src0_sel:DWORD src1_sel:WORD_1
    ds_read_b64 v[104:105], v104
    ds_read_b64 v[106:107], v106
    v_lshlrev_b32_sdwa v108, 3, v127 dst_sel:DWORD dst_unused:UNUSED_PAD src0_sel:DWORD src1_sel:WORD_0
    v_lshlrev_b32_sdwa v110, 3, v127 dst_sel:DWORD dst_unused:UNUSED_PAD src0_sel:DWORD src1_sel:WORD_1
    ds_read_b64 v[108:109], v108
    ds_read_b64 v[110:111], v110
    buffer_load_dwordx4 v[124:127], v69, s[12:15], s20 offen offset:0 sc1
    s_waitcnt lgkmcnt(8)
    v_smfmac_f32_16x16x64_bf16 v[20:23], v[64:67], v[88:95], v68
    v_exp_f32 v152, v152
    v_pk_fma_f32 v[150:151], v[6:7], v[148:149], v[150:151]
    v_pk_mul_f32 v[154:155], v[154:155], v[10:11]
    v_exp_f32 v153, v153
    v_add_f32 v150, v150, v151
    v_pk_mul_f32 v[158:159], v[158:159], v[12:13]
    v_exp_f32 v154, v154
    v_min_u32 v150, -2, v150
    v_pk_fma_f32 v[152:153], v[152:153], v[134:135], v[134:135]
    s_waitcnt vmcnt(3)
    v_lshlrev_b32_sdwa v88, 3, v116 dst_sel:DWORD dst_unused:UNUSED_PAD src0_sel:DWORD src1_sel:WORD_0
    v_lshlrev_b32_sdwa v90, 3, v116 dst_sel:DWORD dst_unused:UNUSED_PAD src0_sel:DWORD src1_sel:WORD_1
    ds_read_b64 v[88:89], v88
    ds_read_b64 v[90:91], v90
    v_lshlrev_b32_sdwa v92, 3, v117 dst_sel:DWORD dst_unused:UNUSED_PAD src0_sel:DWORD src1_sel:WORD_0
    v_lshlrev_b32_sdwa v94, 3, v117 dst_sel:DWORD dst_unused:UNUSED_PAD src0_sel:DWORD src1_sel:WORD_1
    ds_read_b64 v[92:93], v92
    ds_read_b64 v[94:95], v94
    s_waitcnt lgkmcnt(8)
    v_smfmac_f32_16x16x64_bf16 v[16:19], v[64:67], v[96:103], v68
    v_rcp_f32 v152, v152
    buffer_store_dword v150, v70, s[12:15], s35 offen offset:128 sc1
    v_pk_mul_f32 v[160:161], v[14:15], v[14:15]
    v_rcp_f32 v153, v153
    v_pk_fma_f32 v[160:161], v[160:161], v[128:129], v[130:131]
    v_exp_f32 v155, v155
    v_pk_mul_f32 v[156:157], v[8:9], v[152:153]
    v_pk_mul_f32 v[160:161], v[160:161], v[14:15]
    v_exp_f32 v158, v158
    v_lshlrev_b32_sdwa v96, 3, v118 dst_sel:DWORD dst_unused:UNUSED_PAD src0_sel:DWORD src1_sel:WORD_0
    v_lshlrev_b32_sdwa v98, 3, v118 dst_sel:DWORD dst_unused:UNUSED_PAD src0_sel:DWORD src1_sel:WORD_1
    ds_read_b64 v[96:97], v96
    ds_read_b64 v[98:99], v98
    v_lshlrev_b32_sdwa v100, 3, v119 dst_sel:DWORD dst_unused:UNUSED_PAD src0_sel:DWORD src1_sel:WORD_0
    v_lshlrev_b32_sdwa v102, 3, v119 dst_sel:DWORD dst_unused:UNUSED_PAD src0_sel:DWORD src1_sel:WORD_1
    ds_read_b64 v[100:101], v100
    ds_read_b64 v[102:103], v102
    buffer_load_dwordx4 v[116:119], v69, s[12:15], s41 offen offset:0 sc1
    s_waitcnt lgkmcnt(8)
    v_smfmac_f32_16x16x64_bf16 v[20:23], v[64:67], v[104:111], v68
    v_exp_f32 v159, v159
    v_pk_fma_f32 v[154:155], v[154:155], v[136:137], v[136:137]
    v_pk_mul_f32 v[164:165], v[16:17], v[16:17]
    v_rcp_f32 v154, v154
    v_pk_fma_f32 v[158:159], v[158:159], v[134:135], v[134:135]
    v_pk_fma_f32 v[164:165], v[164:165], v[128:129], v[130:131]
    v_rcp_f32 v155, v155
    v_pk_mul_f32 v[164:165], v[164:165], v[16:17]
    v_pk_mul_f32 v[166:167], v[18:19], v[18:19]
    s_waitcnt vmcnt(4)
    v_lshlrev_b32_sdwa v104, 3, v120 dst_sel:DWORD dst_unused:UNUSED_PAD src0_sel:DWORD src1_sel:WORD_0
    v_lshlrev_b32_sdwa v106, 3, v120 dst_sel:DWORD dst_unused:UNUSED_PAD src0_sel:DWORD src1_sel:WORD_1
    ds_read_b64 v[104:105], v104
    ds_read_b64 v[106:107], v106
    v_lshlrev_b32_sdwa v108, 3, v121 dst_sel:DWORD dst_unused:UNUSED_PAD src0_sel:DWORD src1_sel:WORD_0
    v_lshlrev_b32_sdwa v110, 3, v121 dst_sel:DWORD dst_unused:UNUSED_PAD src0_sel:DWORD src1_sel:WORD_1
    ds_read_b64 v[108:109], v108
    ds_read_b64 v[110:111], v110
    s_waitcnt lgkmcnt(8)
    v_smfmac_f32_16x16x64_bf16 v[24:27], v[64:67], v[88:95], v68
    v_rcp_f32 v158, v158
    v_pk_fma_f32 v[156:157], v[10:11], v[154:155], v[156:157]
    v_pk_fma_f32 v[166:167], v[166:167], v[128:129], v[130:131]
    v_rcp_f32 v159, v159
    v_add_f32 v156, v156, v157
    v_pk_mul_f32 v[166:167], v[166:167], v[18:19]
    v_exp_f32 v160, v160
    v_min_u32 v156, -2, v156
    v_pk_mul_f32 v[162:163], v[12:13], v[158:159]
    v_lshlrev_b32_sdwa v88, 3, v122 dst_sel:DWORD dst_unused:UNUSED_PAD src0_sel:DWORD src1_sel:WORD_0
    v_lshlrev_b32_sdwa v90, 3, v122 dst_sel:DWORD dst_unused:UNUSED_PAD src0_sel:DWORD src1_sel:WORD_1
    ds_read_b64 v[88:89], v88
    ds_read_b64 v[90:91], v90
    v_lshlrev_b32_sdwa v92, 3, v123 dst_sel:DWORD dst_unused:UNUSED_PAD src0_sel:DWORD src1_sel:WORD_0
    v_lshlrev_b32_sdwa v94, 3, v123 dst_sel:DWORD dst_unused:UNUSED_PAD src0_sel:DWORD src1_sel:WORD_1
    ds_read_b64 v[92:93], v92
    ds_read_b64 v[94:95], v94
    buffer_load_dwordx4 v[120:123], v69, s[12:15], s45 offen offset:0 sc1
    s_waitcnt lgkmcnt(8)
    v_smfmac_f32_16x16x64_bf16 v[28:31], v[64:67], v[96:103], v68
    v_exp_f32 v161, v161
    buffer_store_dword v156, v70, s[12:15], s35 offen offset:512 sc1
    v_pk_mul_f32 v[170:171], v[20:21], v[20:21]
    v_exp_f32 v164, v164
    v_pk_fma_f32 v[160:161], v[160:161], v[136:137], v[136:137]
    v_pk_fma_f32 v[170:171], v[170:171], v[128:129], v[130:131]
    v_rcp_f32 v160, v160
    v_pk_mul_f32 v[170:171], v[170:171], v[20:21]
    v_pk_mul_f32 v[172:173], v[22:23], v[22:23]
    s_waitcnt vmcnt(4)
    v_lshlrev_b32_sdwa v96, 3, v124 dst_sel:DWORD dst_unused:UNUSED_PAD src0_sel:DWORD src1_sel:WORD_0
    v_lshlrev_b32_sdwa v98, 3, v124 dst_sel:DWORD dst_unused:UNUSED_PAD src0_sel:DWORD src1_sel:WORD_1
    ds_read_b64 v[96:97], v96
    ds_read_b64 v[98:99], v98
    v_lshlrev_b32_sdwa v100, 3, v125 dst_sel:DWORD dst_unused:UNUSED_PAD src0_sel:DWORD src1_sel:WORD_0
    v_lshlrev_b32_sdwa v102, 3, v125 dst_sel:DWORD dst_unused:UNUSED_PAD src0_sel:DWORD src1_sel:WORD_1
    ds_read_b64 v[100:101], v100
    ds_read_b64 v[102:103], v102
    s_waitcnt lgkmcnt(8)
    v_smfmac_f32_16x16x64_bf16 v[24:27], v[64:67], v[104:111], v68
    v_rcp_f32 v161, v161
    v_pk_fma_f32 v[172:173], v[172:173], v[128:129], v[130:131]
    v_exp_f32 v165, v165
    v_pk_fma_f32 v[162:163], v[14:15], v[160:161], v[162:163]
    v_pk_mul_f32 v[172:173], v[172:173], v[22:23]
    v_exp_f32 v166, v166
    v_add_f32 v162, v162, v163
    v_pk_fma_f32 v[164:165], v[164:165], v[134:135], v[134:135]
    v_exp_f32 v167, v167
    v_lshlrev_b32_sdwa v104, 3, v126 dst_sel:DWORD dst_unused:UNUSED_PAD src0_sel:DWORD src1_sel:WORD_0
    v_lshlrev_b32_sdwa v106, 3, v126 dst_sel:DWORD dst_unused:UNUSED_PAD src0_sel:DWORD src1_sel:WORD_1
    ds_read_b64 v[104:105], v104
    ds_read_b64 v[106:107], v106
    v_lshlrev_b32_sdwa v108, 3, v127 dst_sel:DWORD dst_unused:UNUSED_PAD src0_sel:DWORD src1_sel:WORD_0
    v_lshlrev_b32_sdwa v110, 3, v127 dst_sel:DWORD dst_unused:UNUSED_PAD src0_sel:DWORD src1_sel:WORD_1
    ds_read_b64 v[108:109], v108
    ds_read_b64 v[110:111], v110
    buffer_load_dwordx4 v[124:127], v69, s[12:15], s20 offen offset:1024 sc1
    s_waitcnt lgkmcnt(8)
    v_smfmac_f32_16x16x64_bf16 v[28:31], v[64:67], v[88:95], v68
    s_setprio 2
    v_rcp_f32 v164, v164
    v_min_u32 v162, -2, v162
    v_pk_fma_f32 v[166:167], v[166:167], v[136:137], v[136:137]
    v_rcp_f32 v165, v165
    buffer_store_dword v162, v70, s[12:15], s35 offen offset:640 sc1
    v_pk_mul_f32 v[140:141], v[24:25], v[24:25]
    v_rcp_f32 v166, v166
    v_pk_mul_f32 v[168:169], v[16:17], v[164:165]
    v_pk_fma_f32 v[140:141], v[140:141], v[128:129], v[130:131]
    s_waitcnt vmcnt(4)
    v_lshlrev_b32_sdwa v88, 3, v116 dst_sel:DWORD dst_unused:UNUSED_PAD src0_sel:DWORD src1_sel:WORD_0
    v_lshlrev_b32_sdwa v90, 3, v116 dst_sel:DWORD dst_unused:UNUSED_PAD src0_sel:DWORD src1_sel:WORD_1
    ds_read_b64 v[88:89], v88
    ds_read_b64 v[90:91], v90
    v_lshlrev_b32_sdwa v92, 3, v117 dst_sel:DWORD dst_unused:UNUSED_PAD src0_sel:DWORD src1_sel:WORD_0
    v_lshlrev_b32_sdwa v94, 3, v117 dst_sel:DWORD dst_unused:UNUSED_PAD src0_sel:DWORD src1_sel:WORD_1
    ds_read_b64 v[92:93], v92
    ds_read_b64 v[94:95], v94
    s_waitcnt lgkmcnt(8)
    v_smfmac_f32_16x16x64_bf16 v[32:35], v[64:67], v[96:103], v68
    v_rcp_f32 v167, v167
    v_pk_mul_f32 v[140:141], v[140:141], v[24:25]
    v_pk_mul_f32 v[142:143], v[26:27], v[26:27]
    v_exp_f32 v170, v170
    v_pk_fma_f32 v[168:169], v[18:19], v[166:167], v[168:169]
    v_pk_fma_f32 v[142:143], v[142:143], v[128:129], v[130:131]
    v_exp_f32 v171, v171
    v_add_f32 v168, v168, v169
    v_pk_mul_f32 v[142:143], v[142:143], v[26:27]
    v_lshlrev_b32_sdwa v96, 3, v118 dst_sel:DWORD dst_unused:UNUSED_PAD src0_sel:DWORD src1_sel:WORD_0
    v_lshlrev_b32_sdwa v98, 3, v118 dst_sel:DWORD dst_unused:UNUSED_PAD src0_sel:DWORD src1_sel:WORD_1
    ds_read_b64 v[96:97], v96
    ds_read_b64 v[98:99], v98
    v_lshlrev_b32_sdwa v100, 3, v119 dst_sel:DWORD dst_unused:UNUSED_PAD src0_sel:DWORD src1_sel:WORD_0
    v_lshlrev_b32_sdwa v102, 3, v119 dst_sel:DWORD dst_unused:UNUSED_PAD src0_sel:DWORD src1_sel:WORD_1
    ds_read_b64 v[100:101], v100
    ds_read_b64 v[102:103], v102
    buffer_load_dwordx4 v[116:119], v69, s[12:15], s41 offen offset:1024 sc1
    s_waitcnt lgkmcnt(8)
    v_smfmac_f32_16x16x64_bf16 v[36:39], v[64:67], v[104:111], v68
    v_exp_f32 v172, v172
    v_min_u32 v168, -2, v168
    v_pk_fma_f32 v[170:171], v[170:171], v[134:135], v[134:135]
    v_exp_f32 v173, v173
    buffer_store_dword v168, v70, s[12:15], s35 offen offset:1024 sc1
    v_pk_mul_f32 v[146:147], v[28:29], v[28:29]
    v_rcp_f32 v170, v170
    v_pk_fma_f32 v[172:173], v[172:173], v[136:137], v[136:137]
    v_pk_fma_f32 v[146:147], v[146:147], v[128:129], v[130:131]
    s_waitcnt vmcnt(5)
    v_lshlrev_b32_sdwa v104, 3, v120 dst_sel:DWORD dst_unused:UNUSED_PAD src0_sel:DWORD src1_sel:WORD_0
    v_lshlrev_b32_sdwa v106, 3, v120 dst_sel:DWORD dst_unused:UNUSED_PAD src0_sel:DWORD src1_sel:WORD_1
    ds_read_b64 v[104:105], v104
    ds_read_b64 v[106:107], v106
    v_lshlrev_b32_sdwa v108, 3, v121 dst_sel:DWORD dst_unused:UNUSED_PAD src0_sel:DWORD src1_sel:WORD_0
    v_lshlrev_b32_sdwa v110, 3, v121 dst_sel:DWORD dst_unused:UNUSED_PAD src0_sel:DWORD src1_sel:WORD_1
    ds_read_b64 v[108:109], v108
    ds_read_b64 v[110:111], v110
    s_waitcnt lgkmcnt(8)
    v_smfmac_f32_16x16x64_bf16 v[32:35], v[64:67], v[88:95], v68
    v_rcp_f32 v171, v171
    v_pk_mul_f32 v[146:147], v[146:147], v[28:29]
    v_pk_mul_f32 v[148:149], v[30:31], v[30:31]
    v_rcp_f32 v172, v172
    v_pk_mul_f32 v[174:175], v[20:21], v[170:171]
    v_pk_fma_f32 v[148:149], v[148:149], v[128:129], v[130:131]
    v_rcp_f32 v173, v173
    v_pk_mul_f32 v[148:149], v[148:149], v[30:31]
    v_exp_f32 v140, v140
    v_lshlrev_b32_sdwa v88, 3, v122 dst_sel:DWORD dst_unused:UNUSED_PAD src0_sel:DWORD src1_sel:WORD_0
    v_lshlrev_b32_sdwa v90, 3, v122 dst_sel:DWORD dst_unused:UNUSED_PAD src0_sel:DWORD src1_sel:WORD_1
    ds_read_b64 v[88:89], v88
    ds_read_b64 v[90:91], v90
    v_lshlrev_b32_sdwa v92, 3, v123 dst_sel:DWORD dst_unused:UNUSED_PAD src0_sel:DWORD src1_sel:WORD_0
    v_lshlrev_b32_sdwa v94, 3, v123 dst_sel:DWORD dst_unused:UNUSED_PAD src0_sel:DWORD src1_sel:WORD_1
    ds_read_b64 v[92:93], v92
    ds_read_b64 v[94:95], v94
    buffer_load_dwordx4 v[120:123], v69, s[12:15], s45 offen offset:1024 sc1
    s_waitcnt lgkmcnt(8)
    v_smfmac_f32_16x16x64_bf16 v[36:39], v[64:67], v[96:103], v68
    v_exp_f32 v141, v141
    v_pk_fma_f32 v[174:175], v[22:23], v[172:173], v[174:175]
    v_exp_f32 v142, v142
    v_add_f32 v174, v174, v175
    v_pk_fma_f32 v[140:141], v[140:141], v[134:135], v[134:135]
    v_exp_f32 v143, v143
    v_min_u32 v174, -2, v174
    v_rcp_f32 v140, v140
    buffer_store_dword v174, v70, s[12:15], s35 offen offset:1152 sc1
    s_waitcnt vmcnt(5)
    v_lshlrev_b32_sdwa v96, 3, v124 dst_sel:DWORD dst_unused:UNUSED_PAD src0_sel:DWORD src1_sel:WORD_0
    v_lshlrev_b32_sdwa v98, 3, v124 dst_sel:DWORD dst_unused:UNUSED_PAD src0_sel:DWORD src1_sel:WORD_1
    ds_read_b64 v[96:97], v96
    ds_read_b64 v[98:99], v98
    v_lshlrev_b32_sdwa v100, 3, v125 dst_sel:DWORD dst_unused:UNUSED_PAD src0_sel:DWORD src1_sel:WORD_0
    v_lshlrev_b32_sdwa v102, 3, v125 dst_sel:DWORD dst_unused:UNUSED_PAD src0_sel:DWORD src1_sel:WORD_1
    ds_read_b64 v[100:101], v100
    ds_read_b64 v[102:103], v102
    s_waitcnt lgkmcnt(8)
    v_smfmac_f32_16x16x64_bf16 v[32:35], v[64:67], v[104:111], v68
    v_rcp_f32 v141, v141
    v_pk_fma_f32 v[142:143], v[142:143], v[136:137], v[136:137]
    v_exp_f32 v146, v146
    v_pk_mul_f32 v[144:145], v[24:25], v[140:141]
    v_rcp_f32 v142, v142
    v_rcp_f32 v143, v143
    v_exp_f32 v147, v147
    v_exp_f32 v148, v148
    v_pk_fma_f32 v[144:145], v[26:27], v[142:143], v[144:145]
    v_lshlrev_b32_sdwa v104, 3, v126 dst_sel:DWORD dst_unused:UNUSED_PAD src0_sel:DWORD src1_sel:WORD_0
    v_lshlrev_b32_sdwa v106, 3, v126 dst_sel:DWORD dst_unused:UNUSED_PAD src0_sel:DWORD src1_sel:WORD_1
    ds_read_b64 v[104:105], v104
    ds_read_b64 v[106:107], v106
    v_lshlrev_b32_sdwa v108, 3, v127 dst_sel:DWORD dst_unused:UNUSED_PAD src0_sel:DWORD src1_sel:WORD_0
    v_lshlrev_b32_sdwa v110, 3, v127 dst_sel:DWORD dst_unused:UNUSED_PAD src0_sel:DWORD src1_sel:WORD_1
    ds_read_b64 v[108:109], v108
    ds_read_b64 v[110:111], v110
    buffer_load_dwordx4 v[124:127], v69, s[12:15], s20 offen offset:2048 sc1
    s_waitcnt lgkmcnt(8)
    v_smfmac_f32_16x16x64_bf16 v[36:39], v[64:67], v[88:95], v68
    v_exp_f32 v149, v149
    v_add_f32 v144, v144, v145
    v_pk_fma_f32 v[146:147], v[146:147], v[134:135], v[134:135]
    v_min_u32 v144, -2, v144
    v_rcp_f32 v146, v146
    buffer_store_dword v144, v70, s[12:15], s35 offen offset:1536 sc1
    v_pk_fma_f32 v[148:149], v[148:149], v[136:137], v[136:137]
    v_rcp_f32 v147, v147
    v_pk_mul_f32 v[152:153], v[32:33], v[32:33]
    s_waitcnt vmcnt(5)
    v_lshlrev_b32_sdwa v88, 3, v116 dst_sel:DWORD dst_unused:UNUSED_PAD src0_sel:DWORD src1_sel:WORD_0
    v_lshlrev_b32_sdwa v90, 3, v116 dst_sel:DWORD dst_unused:UNUSED_PAD src0_sel:DWORD src1_sel:WORD_1
    ds_read_b64 v[88:89], v88
    ds_read_b64 v[90:91], v90
    v_lshlrev_b32_sdwa v92, 3, v117 dst_sel:DWORD dst_unused:UNUSED_PAD src0_sel:DWORD src1_sel:WORD_0
    v_lshlrev_b32_sdwa v94, 3, v117 dst_sel:DWORD dst_unused:UNUSED_PAD src0_sel:DWORD src1_sel:WORD_1
    ds_read_b64 v[92:93], v92
    ds_read_b64 v[94:95], v94
    s_waitcnt lgkmcnt(8)
    v_smfmac_f32_16x16x64_bf16 v[40:43], v[64:67], v[96:103], v68
    v_rcp_f32 v148, v148
    v_pk_mul_f32 v[150:151], v[28:29], v[146:147]
    v_pk_fma_f32 v[152:153], v[152:153], v[128:129], v[130:131]
    v_rcp_f32 v149, v149
    v_pk_mul_f32 v[152:153], v[152:153], v[32:33]
    v_pk_mul_f32 v[154:155], v[34:35], v[34:35]
    v_exp_f32 v152, v152
    v_pk_fma_f32 v[150:151], v[30:31], v[148:149], v[150:151]
    v_pk_fma_f32 v[154:155], v[154:155], v[128:129], v[130:131]
    v_lshlrev_b32_sdwa v96, 3, v118 dst_sel:DWORD dst_unused:UNUSED_PAD src0_sel:DWORD src1_sel:WORD_0
    v_lshlrev_b32_sdwa v98, 3, v118 dst_sel:DWORD dst_unused:UNUSED_PAD src0_sel:DWORD src1_sel:WORD_1
    ds_read_b64 v[96:97], v96
    ds_read_b64 v[98:99], v98
    v_lshlrev_b32_sdwa v100, 3, v119 dst_sel:DWORD dst_unused:UNUSED_PAD src0_sel:DWORD src1_sel:WORD_0
    v_lshlrev_b32_sdwa v102, 3, v119 dst_sel:DWORD dst_unused:UNUSED_PAD src0_sel:DWORD src1_sel:WORD_1
    ds_read_b64 v[100:101], v100
    ds_read_b64 v[102:103], v102
    buffer_load_dwordx4 v[116:119], v69, s[12:15], s41 offen offset:2048 sc1
    s_waitcnt lgkmcnt(8)
    v_smfmac_f32_16x16x64_bf16 v[44:47], v[64:67], v[104:111], v68
    v_exp_f32 v153, v153
    v_add_f32 v150, v150, v151
    v_pk_mul_f32 v[154:155], v[154:155], v[34:35]
    v_min_u32 v150, -2, v150
    v_exp_f32 v154, v154
    buffer_store_dword v150, v70, s[12:15], s35 offen offset:1664 sc1
    v_pk_fma_f32 v[152:153], v[152:153], v[134:135], v[134:135]
    v_exp_f32 v155, v155
    v_pk_mul_f32 v[158:159], v[36:37], v[36:37]
    s_waitcnt vmcnt(5)
    v_lshlrev_b32_sdwa v104, 3, v120 dst_sel:DWORD dst_unused:UNUSED_PAD src0_sel:DWORD src1_sel:WORD_0
    v_lshlrev_b32_sdwa v106, 3, v120 dst_sel:DWORD dst_unused:UNUSED_PAD src0_sel:DWORD src1_sel:WORD_1
    ds_read_b64 v[104:105], v104
    ds_read_b64 v[106:107], v106
    v_lshlrev_b32_sdwa v108, 3, v121 dst_sel:DWORD dst_unused:UNUSED_PAD src0_sel:DWORD src1_sel:WORD_0
    v_lshlrev_b32_sdwa v110, 3, v121 dst_sel:DWORD dst_unused:UNUSED_PAD src0_sel:DWORD src1_sel:WORD_1
    ds_read_b64 v[108:109], v108
    ds_read_b64 v[110:111], v110
    s_waitcnt lgkmcnt(8)
    v_smfmac_f32_16x16x64_bf16 v[40:43], v[64:67], v[88:95], v68
    v_rcp_f32 v152, v152
    v_pk_fma_f32 v[154:155], v[154:155], v[136:137], v[136:137]
    v_pk_fma_f32 v[158:159], v[158:159], v[128:129], v[130:131]
    v_rcp_f32 v153, v153
    v_pk_mul_f32 v[158:159], v[158:159], v[36:37]
    v_pk_mul_f32 v[160:161], v[38:39], v[38:39]
    v_rcp_f32 v154, v154
    v_pk_mul_f32 v[156:157], v[32:33], v[152:153]
    v_pk_fma_f32 v[160:161], v[160:161], v[128:129], v[130:131]
    v_lshlrev_b32_sdwa v88, 3, v122 dst_sel:DWORD dst_unused:UNUSED_PAD src0_sel:DWORD src1_sel:WORD_0
    v_lshlrev_b32_sdwa v90, 3, v122 dst_sel:DWORD dst_unused:UNUSED_PAD src0_sel:DWORD src1_sel:WORD_1
    ds_read_b64 v[88:89], v88
    ds_read_b64 v[90:91], v90
    v_lshlrev_b32_sdwa v92, 3, v123 dst_sel:DWORD dst_unused:UNUSED_PAD src0_sel:DWORD src1_sel:WORD_0
    v_lshlrev_b32_sdwa v94, 3, v123 dst_sel:DWORD dst_unused:UNUSED_PAD src0_sel:DWORD src1_sel:WORD_1
    ds_read_b64 v[92:93], v92
    ds_read_b64 v[94:95], v94
    buffer_load_dwordx4 v[120:123], v69, s[12:15], s45 offen offset:2048 sc1
    s_waitcnt lgkmcnt(8)
    v_smfmac_f32_16x16x64_bf16 v[44:47], v[64:67], v[96:103], v68
    v_rcp_f32 v155, v155
    v_pk_mul_f32 v[160:161], v[160:161], v[38:39]
    v_exp_f32 v158, v158
    v_pk_fma_f32 v[156:157], v[34:35], v[154:155], v[156:157]
    v_exp_f32 v159, v159
    v_add_f32 v156, v156, v157
    v_exp_f32 v160, v160
    v_min_u32 v156, -2, v156
    v_pk_fma_f32 v[158:159], v[158:159], v[134:135], v[134:135]
    s_waitcnt vmcnt(4)
    v_lshlrev_b32_sdwa v96, 3, v124 dst_sel:DWORD dst_unused:UNUSED_PAD src0_sel:DWORD src1_sel:WORD_0
    v_lshlrev_b32_sdwa v98, 3, v124 dst_sel:DWORD dst_unused:UNUSED_PAD src0_sel:DWORD src1_sel:WORD_1
    ds_read_b64 v[96:97], v96
    ds_read_b64 v[98:99], v98
    v_lshlrev_b32_sdwa v100, 3, v125 dst_sel:DWORD dst_unused:UNUSED_PAD src0_sel:DWORD src1_sel:WORD_0
    v_lshlrev_b32_sdwa v102, 3, v125 dst_sel:DWORD dst_unused:UNUSED_PAD src0_sel:DWORD src1_sel:WORD_1
    ds_read_b64 v[100:101], v100
    ds_read_b64 v[102:103], v102
    s_waitcnt lgkmcnt(8)
    v_smfmac_f32_16x16x64_bf16 v[40:43], v[64:67], v[104:111], v68
    v_rcp_f32 v158, v158
    buffer_store_dword v156, v70, s[12:15], s35 offen offset:2048 sc1
    v_rcp_f32 v159, v159
    v_exp_f32 v161, v161
    v_lshlrev_b32_sdwa v104, 3, v126 dst_sel:DWORD dst_unused:UNUSED_PAD src0_sel:DWORD src1_sel:WORD_0
    v_lshlrev_b32_sdwa v106, 3, v126 dst_sel:DWORD dst_unused:UNUSED_PAD src0_sel:DWORD src1_sel:WORD_1
    ds_read_b64 v[104:105], v104
    ds_read_b64 v[106:107], v106
    v_lshlrev_b32_sdwa v108, 3, v127 dst_sel:DWORD dst_unused:UNUSED_PAD src0_sel:DWORD src1_sel:WORD_0
    v_lshlrev_b32_sdwa v110, 3, v127 dst_sel:DWORD dst_unused:UNUSED_PAD src0_sel:DWORD src1_sel:WORD_1
    ds_read_b64 v[108:109], v108
    ds_read_b64 v[110:111], v110
    buffer_load_dwordx4 v[124:127], v69, s[12:15], s20 offen offset:3072 sc1
    s_waitcnt lgkmcnt(8)
    v_smfmac_f32_16x16x64_bf16 v[44:47], v[64:67], v[88:95], v68
    v_pk_fma_f32 v[160:161], v[160:161], v[136:137], v[136:137]
    v_pk_mul_f32 v[162:163], v[36:37], v[158:159]
    v_rcp_f32 v160, v160
    v_pk_mul_f32 v[164:165], v[40:41], v[40:41]
    v_pk_mul_f32 v[166:167], v[42:43], v[42:43]
    v_rcp_f32 v161, v161
    v_pk_fma_f32 v[164:165], v[164:165], v[128:129], v[130:131]
    v_pk_fma_f32 v[166:167], v[166:167], v[128:129], v[130:131]
    v_pk_fma_f32 v[162:163], v[38:39], v[160:161], v[162:163]
    s_waitcnt vmcnt(4)
    v_lshlrev_b32_sdwa v88, 3, v116 dst_sel:DWORD dst_unused:UNUSED_PAD src0_sel:DWORD src1_sel:WORD_0
    v_lshlrev_b32_sdwa v90, 3, v116 dst_sel:DWORD dst_unused:UNUSED_PAD src0_sel:DWORD src1_sel:WORD_1
    ds_read_b64 v[88:89], v88
    ds_read_b64 v[90:91], v90
    v_lshlrev_b32_sdwa v92, 3, v117 dst_sel:DWORD dst_unused:UNUSED_PAD src0_sel:DWORD src1_sel:WORD_0
    v_lshlrev_b32_sdwa v94, 3, v117 dst_sel:DWORD dst_unused:UNUSED_PAD src0_sel:DWORD src1_sel:WORD_1
    ds_read_b64 v[92:93], v92
    ds_read_b64 v[94:95], v94
    s_waitcnt lgkmcnt(8)
    v_smfmac_f32_16x16x64_bf16 v[48:51], v[64:67], v[96:103], v68
    v_add_f32 v162, v162, v163
    v_pk_mul_f32 v[164:165], v[164:165], v[40:41]
    v_min_u32 v162, -2, v162
    v_exp_f32 v164, v164
    buffer_store_dword v162, v70, s[12:15], s35 offen offset:2176 sc1
    v_pk_mul_f32 v[166:167], v[166:167], v[42:43]
    v_exp_f32 v165, v165
    v_pk_mul_f32 v[170:171], v[44:45], v[44:45]
    v_pk_mul_f32 v[172:173], v[46:47], v[46:47]
    v_lshlrev_b32_sdwa v96, 3, v118 dst_sel:DWORD dst_unused:UNUSED_PAD src0_sel:DWORD src1_sel:WORD_0
    v_lshlrev_b32_sdwa v98, 3, v118 dst_sel:DWORD dst_unused:UNUSED_PAD src0_sel:DWORD src1_sel:WORD_1
    ds_read_b64 v[96:97], v96
    ds_read_b64 v[98:99], v98
    v_lshlrev_b32_sdwa v100, 3, v119 dst_sel:DWORD dst_unused:UNUSED_PAD src0_sel:DWORD src1_sel:WORD_0
    v_lshlrev_b32_sdwa v102, 3, v119 dst_sel:DWORD dst_unused:UNUSED_PAD src0_sel:DWORD src1_sel:WORD_1
    ds_read_b64 v[100:101], v100
    ds_read_b64 v[102:103], v102
    buffer_load_dwordx4 v[116:119], v69, s[12:15], s41 offen offset:3072 sc1
    s_waitcnt lgkmcnt(8)
    v_smfmac_f32_16x16x64_bf16 v[52:55], v[64:67], v[104:111], v68
    s_setprio 1
    v_exp_f32 v166, v166
    v_pk_fma_f32 v[164:165], v[164:165], v[134:135], v[134:135]
    v_pk_fma_f32 v[170:171], v[170:171], v[128:129], v[130:131]
    v_rcp_f32 v164, v164
    v_pk_mul_f32 v[170:171], v[170:171], v[44:45]
    v_pk_fma_f32 v[172:173], v[172:173], v[128:129], v[130:131]
    v_rcp_f32 v165, v165
    v_pk_mul_f32 v[172:173], v[172:173], v[46:47]
    v_exp_f32 v167, v167
    s_waitcnt vmcnt(4)
    v_lshlrev_b32_sdwa v104, 3, v120 dst_sel:DWORD dst_unused:UNUSED_PAD src0_sel:DWORD src1_sel:WORD_0
    v_lshlrev_b32_sdwa v106, 3, v120 dst_sel:DWORD dst_unused:UNUSED_PAD src0_sel:DWORD src1_sel:WORD_1
    ds_read_b64 v[104:105], v104
    ds_read_b64 v[106:107], v106
    v_lshlrev_b32_sdwa v108, 3, v121 dst_sel:DWORD dst_unused:UNUSED_PAD src0_sel:DWORD src1_sel:WORD_0
    v_lshlrev_b32_sdwa v110, 3, v121 dst_sel:DWORD dst_unused:UNUSED_PAD src0_sel:DWORD src1_sel:WORD_1
    ds_read_b64 v[108:109], v108
    ds_read_b64 v[110:111], v110
    s_waitcnt lgkmcnt(8)
    v_smfmac_f32_16x16x64_bf16 v[48:51], v[64:67], v[88:95], v68
    v_exp_f32 v170, v170
    v_pk_fma_f32 v[166:167], v[166:167], v[136:137], v[136:137]
    v_pk_mul_f32 v[168:169], v[40:41], v[164:165]
    v_rcp_f32 v166, v166
    v_rcp_f32 v167, v167
    v_exp_f32 v171, v171
    v_exp_f32 v172, v172
    v_pk_fma_f32 v[168:169], v[42:43], v[166:167], v[168:169]
    v_pk_fma_f32 v[170:171], v[170:171], v[134:135], v[134:135]
    v_lshlrev_b32_sdwa v88, 3, v122 dst_sel:DWORD dst_unused:UNUSED_PAD src0_sel:DWORD src1_sel:WORD_0
    v_lshlrev_b32_sdwa v90, 3, v122 dst_sel:DWORD dst_unused:UNUSED_PAD src0_sel:DWORD src1_sel:WORD_1
    ds_read_b64 v[88:89], v88
    ds_read_b64 v[90:91], v90
    v_lshlrev_b32_sdwa v92, 3, v123 dst_sel:DWORD dst_unused:UNUSED_PAD src0_sel:DWORD src1_sel:WORD_0
    v_lshlrev_b32_sdwa v94, 3, v123 dst_sel:DWORD dst_unused:UNUSED_PAD src0_sel:DWORD src1_sel:WORD_1
    ds_read_b64 v[92:93], v92
    ds_read_b64 v[94:95], v94
    buffer_load_dwordx4 v[120:123], v69, s[12:15], s45 offen offset:3072 sc1
    s_waitcnt lgkmcnt(8)
    v_smfmac_f32_16x16x64_bf16 v[52:55], v[64:67], v[96:103], v68
    v_rcp_f32 v170, v170
    v_add_f32 v168, v168, v169
    v_rcp_f32 v171, v171
    v_min_u32 v168, -2, v168
    v_exp_f32 v173, v173
    buffer_store_dword v168, v70, s[12:15], s35 offen offset:2560 sc1
    v_pk_mul_f32 v[174:175], v[44:45], v[170:171]
    v_pk_fma_f32 v[172:173], v[172:173], v[136:137], v[136:137]
    s_waitcnt vmcnt(4)
    v_lshlrev_b32_sdwa v96, 3, v124 dst_sel:DWORD dst_unused:UNUSED_PAD src0_sel:DWORD src1_sel:WORD_0
    v_lshlrev_b32_sdwa v98, 3, v124 dst_sel:DWORD dst_unused:UNUSED_PAD src0_sel:DWORD src1_sel:WORD_1
    ds_read_b64 v[96:97], v96
    ds_read_b64 v[98:99], v98
    v_lshlrev_b32_sdwa v100, 3, v125 dst_sel:DWORD dst_unused:UNUSED_PAD src0_sel:DWORD src1_sel:WORD_0
    v_lshlrev_b32_sdwa v102, 3, v125 dst_sel:DWORD dst_unused:UNUSED_PAD src0_sel:DWORD src1_sel:WORD_1
    ds_read_b64 v[100:101], v100
    ds_read_b64 v[102:103], v102
    s_waitcnt lgkmcnt(8)
    v_smfmac_f32_16x16x64_bf16 v[48:51], v[64:67], v[104:111], v68
    buffer_load_dword v72, v76, s[52:55], 0 offen offset:32 sc1
    buffer_load_short_d16_hi v73, v79, s[56:59], 0 offen
    buffer_load_ushort v81, v78, s[60:63], s68 offen
    buffer_load_dword v82, v79, s[12:15], s69 offen sc1
    v_rcp_f32 v172, v172
    v_rcp_f32 v173, v173
    v_lshlrev_b32_sdwa v104, 3, v126 dst_sel:DWORD dst_unused:UNUSED_PAD src0_sel:DWORD src1_sel:WORD_0
    v_lshlrev_b32_sdwa v106, 3, v126 dst_sel:DWORD dst_unused:UNUSED_PAD src0_sel:DWORD src1_sel:WORD_1
    ds_read_b64 v[104:105], v104
    ds_read_b64 v[106:107], v106
    v_lshlrev_b32_sdwa v108, 3, v127 dst_sel:DWORD dst_unused:UNUSED_PAD src0_sel:DWORD src1_sel:WORD_0
    v_lshlrev_b32_sdwa v110, 3, v127 dst_sel:DWORD dst_unused:UNUSED_PAD src0_sel:DWORD src1_sel:WORD_1
    ds_read_b64 v[108:109], v108
    ds_read_b64 v[110:111], v110
    s_waitcnt lgkmcnt(8)
    v_smfmac_f32_16x16x64_bf16 v[52:55], v[64:67], v[88:95], v68
    v_pk_fma_f32 v[174:175], v[46:47], v[172:173], v[174:175]
    v_pk_mul_f32 v[140:141], v[48:49], v[48:49]
    v_add_f32 v174, v174, v175
    v_pk_fma_f32 v[140:141], v[140:141], v[128:129], v[130:131]
    v_min_u32 v174, -2, v174
    v_pk_mul_f32 v[140:141], v[140:141], v[48:49]
    buffer_store_dword v174, v70, s[12:15], s35 offen offset:2688 sc1
    v_exp_f32 v140, v140
    v_pk_mul_f32 v[142:143], v[50:51], v[50:51]
    s_waitcnt vmcnt(7)
    v_lshlrev_b32_sdwa v88, 3, v116 dst_sel:DWORD dst_unused:UNUSED_PAD src0_sel:DWORD src1_sel:WORD_0
    v_lshlrev_b32_sdwa v90, 3, v116 dst_sel:DWORD dst_unused:UNUSED_PAD src0_sel:DWORD src1_sel:WORD_1
    ds_read_b64 v[88:89], v88
    ds_read_b64 v[90:91], v90
    v_lshlrev_b32_sdwa v92, 3, v117 dst_sel:DWORD dst_unused:UNUSED_PAD src0_sel:DWORD src1_sel:WORD_0
    v_lshlrev_b32_sdwa v94, 3, v117 dst_sel:DWORD dst_unused:UNUSED_PAD src0_sel:DWORD src1_sel:WORD_1
    ds_read_b64 v[92:93], v92
    ds_read_b64 v[94:95], v94
    s_waitcnt lgkmcnt(8)
    v_smfmac_f32_16x16x64_bf16 v[56:59], v[64:67], v[96:103], v68
    v_exp_f32 v141, v141
    v_pk_fma_f32 v[142:143], v[142:143], v[128:129], v[130:131]
    v_pk_mul_f32 v[146:147], v[52:53], v[52:53]
    v_pk_fma_f32 v[140:141], v[140:141], v[134:135], v[134:135]
    v_pk_mul_f32 v[142:143], v[142:143], v[50:51]
    v_rcp_f32 v140, v140
    v_pk_fma_f32 v[146:147], v[146:147], v[128:129], v[130:131]
    v_pk_mul_f32 v[148:149], v[54:55], v[54:55]
    v_rcp_f32 v141, v141
    v_lshlrev_b32_sdwa v96, 3, v118 dst_sel:DWORD dst_unused:UNUSED_PAD src0_sel:DWORD src1_sel:WORD_0
    v_lshlrev_b32_sdwa v98, 3, v118 dst_sel:DWORD dst_unused:UNUSED_PAD src0_sel:DWORD src1_sel:WORD_1
    ds_read_b64 v[96:97], v96
    ds_read_b64 v[98:99], v98
    v_lshlrev_b32_sdwa v100, 3, v119 dst_sel:DWORD dst_unused:UNUSED_PAD src0_sel:DWORD src1_sel:WORD_0
    v_lshlrev_b32_sdwa v102, 3, v119 dst_sel:DWORD dst_unused:UNUSED_PAD src0_sel:DWORD src1_sel:WORD_1
    ds_read_b64 v[100:101], v100
    ds_read_b64 v[102:103], v102
    s_waitcnt lgkmcnt(8)
    v_smfmac_f32_16x16x64_bf16 v[60:63], v[64:67], v[104:111], v68
    v_exp_f32 v142, v142
    v_pk_mul_f32 v[144:145], v[48:49], v[140:141]
    v_pk_mul_f32 v[146:147], v[146:147], v[52:53]
    v_exp_f32 v143, v143
    v_pk_fma_f32 v[148:149], v[148:149], v[128:129], v[130:131]
    v_exp_f32 v146, v146
    v_pk_fma_f32 v[142:143], v[142:143], v[136:137], v[136:137]
    v_pk_mul_f32 v[148:149], v[148:149], v[54:55]
    v_rcp_f32 v142, v142
    s_waitcnt vmcnt(6)
    v_lshlrev_b32_sdwa v104, 3, v120 dst_sel:DWORD dst_unused:UNUSED_PAD src0_sel:DWORD src1_sel:WORD_0
    v_lshlrev_b32_sdwa v106, 3, v120 dst_sel:DWORD dst_unused:UNUSED_PAD src0_sel:DWORD src1_sel:WORD_1
    ds_read_b64 v[104:105], v104
    ds_read_b64 v[106:107], v106
    v_lshlrev_b32_sdwa v108, 3, v121 dst_sel:DWORD dst_unused:UNUSED_PAD src0_sel:DWORD src1_sel:WORD_0
    v_lshlrev_b32_sdwa v110, 3, v121 dst_sel:DWORD dst_unused:UNUSED_PAD src0_sel:DWORD src1_sel:WORD_1
    ds_read_b64 v[108:109], v108
    ds_read_b64 v[110:111], v110
    s_waitcnt lgkmcnt(8)
    v_smfmac_f32_16x16x64_bf16 v[56:59], v[64:67], v[88:95], v68
    v_rcp_f32 v143, v143
    v_exp_f32 v147, v147
    v_exp_f32 v148, v148
    v_pk_fma_f32 v[144:145], v[50:51], v[142:143], v[144:145]
    v_pk_fma_f32 v[146:147], v[146:147], v[134:135], v[134:135]
    v_exp_f32 v149, v149
    v_add_f32 v144, v144, v145
    v_rcp_f32 v146, v146
    v_min_u32 v144, -2, v144
    v_lshlrev_b32_sdwa v88, 3, v122 dst_sel:DWORD dst_unused:UNUSED_PAD src0_sel:DWORD src1_sel:WORD_0
    v_lshlrev_b32_sdwa v90, 3, v122 dst_sel:DWORD dst_unused:UNUSED_PAD src0_sel:DWORD src1_sel:WORD_1
    ds_read_b64 v[88:89], v88
    ds_read_b64 v[90:91], v90
    v_lshlrev_b32_sdwa v92, 3, v123 dst_sel:DWORD dst_unused:UNUSED_PAD src0_sel:DWORD src1_sel:WORD_0
    v_lshlrev_b32_sdwa v94, 3, v123 dst_sel:DWORD dst_unused:UNUSED_PAD src0_sel:DWORD src1_sel:WORD_1
    ds_read_b64 v[92:93], v92
    ds_read_b64 v[94:95], v94
    s_waitcnt lgkmcnt(8)
    v_smfmac_f32_16x16x64_bf16 v[60:63], v[64:67], v[96:103], v68
    s_setprio 0
    v_rcp_f32 v147, v147
    buffer_store_dword v144, v70, s[12:15], s35 offen offset:3072 sc1
    v_pk_fma_f32 v[148:149], v[148:149], v[136:137], v[136:137]
    v_pk_mul_f32 v[150:151], v[52:53], v[146:147]
    v_rcp_f32 v148, v148
    v_rcp_f32 v149, v149
    s_waitcnt lgkmcnt(4)
    v_smfmac_f32_16x16x64_bf16 v[56:59], v[64:67], v[104:111], v68
    v_pk_fma_f32 v[150:151], v[54:55], v[148:149], v[150:151]
    s_waitcnt lgkmcnt(0)
    v_smfmac_f32_16x16x64_bf16 v[60:63], v[64:67], v[88:95], v68
    v_add_f32 v150, v150, v151
    s_nop 0
    v_min_u32 v150, -2, v150
    s_nop 0
    buffer_store_dword v150, v70, s[12:15], s35 offen offset:3200 sc1
    s_nop 0
    s_nop 0
    s_nop 0
    s_nop 0
    v_pk_mul_f32 v[152:153], v[56:57], v[56:57]
    v_pk_mul_f32 v[154:155], v[58:59], v[58:59]
    v_pk_fma_f32 v[152:153], v[152:153], v[128:129], v[130:131]
    v_pk_fma_f32 v[154:155], v[154:155], v[128:129], v[130:131]
    v_pk_mul_f32 v[152:153], v[152:153], v[56:57]
    v_pk_mul_f32 v[154:155], v[154:155], v[58:59]
    v_exp_f32 v152, v152
    v_pk_mul_f32 v[158:159], v[60:61], v[60:61]
    v_pk_mul_f32 v[160:161], v[62:63], v[62:63]
    v_exp_f32 v153, v153
    v_pk_fma_f32 v[158:159], v[158:159], v[128:129], v[130:131]
    v_pk_fma_f32 v[160:161], v[160:161], v[128:129], v[130:131]
    v_exp_f32 v154, v154
    v_pk_fma_f32 v[152:153], v[152:153], v[134:135], v[134:135]
    v_pk_mul_f32 v[158:159], v[158:159], v[60:61]
    v_rcp_f32 v152, v152
    v_pk_mul_f32 v[160:161], v[160:161], v[62:63]
    v_rcp_f32 v153, v153
    v_exp_f32 v155, v155
    v_exp_f32 v158, v158
    v_pk_mul_f32 v[156:157], v[56:57], v[152:153]
    v_pk_fma_f32 v[154:155], v[154:155], v[136:137], v[136:137]
    v_exp_f32 v159, v159
    v_rcp_f32 v154, v154
    v_rcp_f32 v155, v155
    v_pk_fma_f32 v[158:159], v[158:159], v[134:135], v[134:135]
    v_exp_f32 v160, v160
    v_pk_fma_f32 v[156:157], v[58:59], v[154:155], v[156:157]
    v_rcp_f32 v158, v158
    v_add_f32 v156, v156, v157
    v_rcp_f32 v159, v159
    v_min_u32 v156, -2, v156
    v_exp_f32 v161, v161
    buffer_store_dword v156, v70, s[12:15], s35 offen offset:3584 sc1
    v_pk_mul_f32 v[162:163], v[60:61], v[158:159]
    v_pk_fma_f32 v[160:161], v[160:161], v[136:137], v[136:137]
    s_nop 0
    v_rcp_f32 v160, v160
    v_rcp_f32 v161, v161
    s_nop 0
    s_nop 0
    v_pk_fma_f32 v[162:163], v[62:63], v[160:161], v[162:163]
    s_nop 0
    v_add_f32 v162, v162, v163
    s_nop 0
    v_min_u32 v162, -2, v162
    s_nop 0
    buffer_store_dword v162, v70, s[12:15], s35 offen offset:3712 sc1
    s_waitcnt vmcnt(5)

    v_cmp_ne_u32 vcc, -1, v72
    s_and_b32 s45, vcc_lo, 0xff
    s_cbranch_scc1 k1_kernel_rslow

k1_kernel_rjob:

    s_lshl_b32 s67, s64, 8
    s_add_u32 s68, s67, 29360128
    s_add_u32 s69, s68, 65536
    s_add_u32 s67, s67, 20971520

k1_kernel_rgrp:

    s_add_u32 s70, s67, s65
    s_add_u32 s71, s70, 262144
    s_add_u32 s72, s70, 524288
    s_add_u32 s73, s70, 786432
    s_add_u32 s65, s65, 1048576

    buffer_load_dwordx4 v[0:3], v74, s[12:15], s70 offen sc1
    buffer_load_dwordx4 v[4:7], v74, s[12:15], s71 offen sc1
    buffer_load_dwordx4 v[8:11], v74, s[12:15], s72 offen sc1
    buffer_load_dwordx4 v[12:15], v74, s[12:15], s73 offen sc1
    buffer_load_dword v16, v75, s[12:15], s68 offen sc1
    buffer_load_dword v17, v75, s[12:15], s69 offen sc1
    s_branch k1_kernel_rchk
k1_kernel_rpoll:
    s_mov_b64 exec, s[74:75]
    s_cbranch_execz k1_kernel_rsk0
    buffer_load_dwordx4 v[0:3], v74, s[12:15], s70 offen sc1
k1_kernel_rsk0:
    s_mov_b64 exec, s[76:77]
    s_cbranch_execz k1_kernel_rsk1
    buffer_load_dwordx4 v[4:7], v74, s[12:15], s71 offen sc1
k1_kernel_rsk1:
    s_mov_b64 exec, s[78:79]
    s_cbranch_execz k1_kernel_rsk2
    buffer_load_dwordx4 v[8:11], v74, s[12:15], s72 offen sc1
k1_kernel_rsk2:
    s_mov_b64 exec, s[80:81]
    s_cbranch_execz k1_kernel_rsk3
    buffer_load_dwordx4 v[12:15], v74, s[12:15], s73 offen sc1
k1_kernel_rsk3:
    s_mov_b64 exec, -1
k1_kernel_rchk:
    s_waitcnt vmcnt(0)
k1_kernel_rchk0:
    v_max3_u32 v20, v0, v1, v2
    v_max3_u32 v21, v4, v5, v6
    v_max3_u32 v22, v8, v9, v10
    v_max3_u32 v23, v12, v13, v14
    v_max_u32 v20, v20, v3
    v_max_u32 v21, v21, v7
    v_max_u32 v22, v22, v11
    v_max_u32 v23, v23, v15
    v_cmp_eq_u32 s[74:75], -1, v20
    v_cmp_eq_u32 s[76:77], -1, v21
    v_cmp_eq_u32 s[78:79], -1, v22
    v_cmp_eq_u32 s[80:81], -1, v23

    v_pk_add_f32 v[26:27], v[0:1], v[4:5]
    v_pk_add_f32 v[28:29], v[2:3], v[6:7]
    v_pk_add_f32 v[30:31], v[8:9], v[12:13]
    v_pk_add_f32 v[32:33], v[10:11], v[14:15]
    s_or_b64 s[82:83], s[74:75], s[76:77]
    s_or_b64 s[84:85], s[78:79], s[80:81]
    v_pk_add_f32 v[26:27], v[26:27], v[30:31]
    v_pk_add_f32 v[28:29], v[28:29], v[32:33]
    s_or_b64 s[82:83], s[82:83], s[84:85]
    s_cbranch_scc1 k1_kernel_rpoll
    v_permlane32_swap_b32 v26, v28
    v_permlane32_swap_b32 v27, v29
    s_cmp_lt_u32 s65, s66
    s_nop 0
    v_pk_add_f32 v[26:27], v[26:27], v[28:29]
    s_nop 1
    v_permlane16_swap_b32 v26, v27
    s_nop 1
    v_add_f32 v26, v26, v27
    v_add_f32 v79, v79, v26
    s_cbranch_scc1 k1_kernel_rgrp
    s_cmp_lg_u32 s43, 0
    s_cbranch_scc1 k1_kernel_rpn
    ds_write_b32 v77, v79
    s_cmp_lg_u32 s3, 0
    s_waitcnt lgkmcnt(0)
    s_barrier
    s_cbranch_scc1 k1_kernel_rend

    ds_read2st64_b32 v[40:41], v77 offset0:0 offset1:1
    ds_read2st64_b32 v[42:43], v77 offset0:2 offset1:3
    ds_read2st64_b32 v[44:45], v77 offset0:4 offset1:5
    ds_read2st64_b32 v[46:47], v77 offset0:6 offset1:7

    s_waitcnt lgkmcnt(2)
    v_pk_add_f32 v[26:27], v[40:41], v[42:43]
    v_max3_u32 v20, v41, v42, v43
    s_waitcnt lgkmcnt(0)
    v_pk_add_f32 v[28:29], v[44:45], v[46:47]
    v_max3_u32 v20, v20, v44, v45
    v_pk_add_f32 v[26:27], v[26:27], v[28:29]
    v_max3_u32 v20, v20, v46, v47
    v_add_f32 v79, v26, v27
    v_cmp_eq_u32 vcc, -1, v20
    s_cbranch_vccnz k1_kernel_rnext

k1_kernel_rpn:

    v_max_u32 v20, v16, v17
    v_add_f32 v21, v16, v17
    v_cmp_eq_u32 vcc, -1, v20
    v_cvt_pk_bf16_f32 v21, v79, v21
    s_cbranch_vccnz k1_kernel_rpn2
    v_lshlrev_b32 v22, 16, v21
    v_and_b32 v21, 0xffff0000, v21
    v_add_f32 v22, v22, v73
    v_cvt_pk_bf16_f32 v22, v22, v22
    v_lshlrev_b32 v22, 16, v22
    v_add_f32 v22, v22, v21
    s_lshl_b32 s45, s64, 7
    v_cvt_pk_bf16_f32 v22, v22, v22
    buffer_store_short v22, v78, s[60:63], s45 offen

k1_kernel_rnext:

    v_cmp_ne_u32 vcc, 0, v72
    s_and_b32 s45, vcc_lo, 0xff00
    s_cbranch_scc1 k1_kernel_rmore

k1_kernel_rend:
    s_endpgm
k1_kernel_rpn2:
    buffer_load_dword v16, v75, s[12:15], s68 offen sc1
    buffer_load_dword v17, v75, s[12:15], s69 offen sc1
    s_waitcnt vmcnt(0)
    s_branch k1_kernel_rpn
k1_kernel_rmore:

    s_ff1_i32_b32 s45, s45
    s_mov_b32 s43, 1
    s_mov_b32 s65, 0
    s_mov_b32 s66, 8388608
    v_readlane_b32 s44, v72, s45
    v_mov_b32 v79, 0
    s_mov_b32 m0, s45
    s_ff1_i32_b32 s64, s44
    s_bitset0_b32 s44, s64
    s_sub_u32 s45, s45, 8
    s_lshl_b32 s45, s45, 5
    s_add_u32 s64, s64, s45
    v_writelane_b32 v72, s44, m0
    s_branch k1_kernel_rjob

k1_kernel_rslow:
    s_lshl_b32 s65, s3, 20
    buffer_load_dword v72, v76, s[52:55], 0 offen offset:32 sc1
    s_waitcnt vmcnt(0)

    v_cmp_ne_u32 vcc, -1, v72
    s_and_b32 s45, vcc_lo, 0xff
    s_cbranch_scc0 k1_kernel_rjob

    s_add_u32 s42, s42, 1
    s_cmp_lt_u32 s42, 200
    s_cbranch_scc1 k1_kernel_rslow
    s_lshl_b32 s44, 1, s64
    s_lshr_b32 s45, s64, 5
    s_lshl_b32 s45, s45, 2
    v_mov_b32 v20, s44
    s_mov_b64 exec, 1
    buffer_atomic_or v20, v76, s[52:55], s45 offen offset:64 sc0
    s_mov_b64 exec, -1
    s_waitcnt vmcnt(0)
    buffer_load_dword v72, v76, s[52:55], 0 offen offset:32 sc1
    s_waitcnt vmcnt(0)

    v_cmp_ne_u32 vcc, -1, v72
    s_and_b32 s45, vcc_lo, 0xff
    s_cbranch_scc0 k1_kernel_rjob

    v_mov_b32 v20, -1
    ds_write_b32 v77, v20
    s_waitcnt lgkmcnt(0)
    s_endpgm

k1_kernel_end:
    s_endpgm
k1_kernel_main:
    s_setprio 3
    s_mov_b32 s16, s4
    s_and_b32 s17, s5, 0xffff
    s_mov_b32 s20, s6
    s_and_b32 s21, s7, 0xffff
    s_mov_b32 s28, s10
    s_and_b32 s29, s11, 0xffff
    s_mov_b32 s32, s12
    s_and_b32 s33, s13, 0xffff
    s_and_b32 s13, s13, 0xffff
    s_and_b32 s53, s53, 0xffff

    v_and_b32 v5, 15, v255
    v_lshrrev_b32 v6, 4, v255
    v_and_b32 v7, 3, v255
    v_bfe_u32 v8, v255, 2, 2
    v_lshl_add_u32 v9, v7, 2, v8
    v_cmp_eq_u32 s[46:47], 0, v7
    s_movk_i32 s45, 200
    v_mov_b32 v10, 144384
    v_mad_u32_u24 v11, v9, s45, v10
    v_and_b32 v188, 48, v255
    v_add_u32 v128, v11, v188
    v_mul_u32_u24 v12, 6400, v6
    v_add_u32 v132, v11, v12
    v_and_b32 v12, 16, v255
    v_add_u32 v10, v10, v12
    v_add_u32 v11, v11, v12
    v_and_b32 v12, 32, v255
    v_mul_u32_u24 v12, 100, v12
    v_add_u32 v131, v11, v12
    v_and_b32 v12, 8, v255
    v_lshl_add_u32 v13, v7, 1, v12
    v_and_b32 v14, 1, v8
    v_add_u32 v13, v13, v14
    v_lshrrev_b32 v14, 5, v255
    v_lshl_add_u32 v14, v13, 1, v14
    v_mad_u32_u24 v129, v14, s45, v10
    v_lshl_add_u32 v130, v12, 2, v129
    v_lshlrev_b32 v15, 2, v6
    v_sub_u32 v13, v13, v15
    v_lshrrev_b32 v14, 1, v9
    v_sub_u32 v14, v14, v15
    v_sub_u32 v15, v5, v15
    v_and_b32 v12, 1, v9
    v_lshlrev_b32 v12, 4, v12
    v_mov_b32 v16, 0x3f80
    v_lshlrev_b32 v12, v12, v16
    v_mov_b32 v17, 0x3f800000

    v_cmp_eq_u32 vcc, 0, v13
    v_cndmask_b32 v120, 0, v16, vcc
    v_cmp_eq_u32 vcc, 0, v14
    v_cndmask_b32 v112, 0, v12, vcc
    v_cmp_eq_u32 vcc, -8, v14
    v_cndmask_b32 v116, 0, v12, vcc
    v_cmp_eq_u32 vcc, 0, v15
    v_cndmask_b32 v176, 0, v17, vcc
    v_lshlrev_b32 v124, 16, v120

    v_cmp_eq_u32 vcc, 1, v13
    v_cndmask_b32 v121, 0, v16, vcc
    v_cmp_eq_u32 vcc, 1, v14
    v_cndmask_b32 v113, 0, v12, vcc
    v_cmp_eq_u32 vcc, -7, v14
    v_cndmask_b32 v117, 0, v12, vcc
    v_cmp_eq_u32 vcc, 1, v15
    v_cndmask_b32 v177, 0, v17, vcc
    v_lshlrev_b32 v125, 16, v121

    v_cmp_eq_u32 vcc, 2, v13
    v_cndmask_b32 v122, 0, v16, vcc
    v_cmp_eq_u32 vcc, 2, v14
    v_cndmask_b32 v114, 0, v12, vcc
    v_cmp_eq_u32 vcc, -6, v14
    v_cndmask_b32 v118, 0, v12, vcc
    v_cmp_eq_u32 vcc, 2, v15
    v_cndmask_b32 v178, 0, v17, vcc
    v_lshlrev_b32 v126, 16, v122

    v_cmp_eq_u32 vcc, 3, v13
    v_cndmask_b32 v123, 0, v16, vcc
    v_cmp_eq_u32 vcc, 3, v14
    v_cndmask_b32 v115, 0, v12, vcc
    v_cmp_eq_u32 vcc, -5, v14
    v_cndmask_b32 v119, 0, v12, vcc
    v_cmp_eq_u32 vcc, 3, v15
    v_cndmask_b32 v179, 0, v17, vcc
    v_lshlrev_b32 v127, 16, v123

    s_mul_i32 s45, s3, 36864
    s_add_u32 s45, s45, 128
    s_movk_i32 s57, 144
    v_mov_b32 v10, s45
    v_mad_u32_u24 v189, v5, s57, v10
    v_mad_u32_u24 v191, v255, s57, v10
    v_add_u32 v191, 12, v191
    v_cmp_lt_u32 vcc, 24, v255
    v_subrev_u32 v11, 25, v255
    v_cndmask_b32 v11, v255, v11, vcc
    v_add_u32 v12, 2304, v10
    v_cndmask_b32 v10, v10, v12, vcc
    v_and_b32 v12, 3, v11
    v_mad_u32_u24 v10, v12, s57, v10
    v_lshrrev_b32 v11, 2, v11
    v_lshl_add_u32 v190, v11, 1, v10
    v_cmp_gt_u32 s[48:49], 50, v255
    v_mov_b32 v192, 0xdddddddd
    v_mov_b32 v193, 1000
    s_mov_b32 s60, 0xff00ff00
    s_mov_b32 s61, 0xff00ff00
    s_mov_b32 s62, -1
    s_mov_b32 s63, 0xffff

    s_waitcnt vmcnt(4)

    s_mov_b64 exec, 1
    ds_add_u32 v252, v253 offset:0
    s_mov_b64 exec, -1

k1_kernel_wf1:

    ds_read_b32 v251, v252 offset:0
    s_waitcnt lgkmcnt(0)
    v_readfirstlane_b32 s45, v251
    s_cmp_lt_u32 s45, 4
    s_cbranch_scc1 k1_kernel_wf1

    v_mov_b32 v72, 0
    v_mov_b32 v73, 0
    v_mov_b32 v74, 0
    v_mov_b32 v75, 0
    s_mov_b64 exec, s[62:63]
    ds_read_b64 v[72:73], v132 offset:192
    ds_read_b64 v[74:75], v132 offset:3392
    s_mov_b64 exec, -1
    ds_read_b64 v[76:77], v128 offset:16160
    ds_read_b64 v[78:79], v128 offset:16168
    ds_read_b64 v[80:81], v128 offset:0
    ds_read_b64 v[82:83], v128 offset:8
    ds_read_b64 v[84:85], v131 offset:0
    ds_read_b64 v[86:87], v131 offset:8
    s_waitcnt vmcnt(3)
    s_waitcnt lgkmcnt(4)
    v_mfma_f32_16x16x32_bf16 v[64:67], v[112:115], v[72:75], 0
    ds_read_b64 v[88:89], v128 offset:3232
    ds_read_b64 v[90:91], v128 offset:3240
    v_mfma_f32_16x16x32_bf16 v[68:71], v[116:119], v[72:75], 0
    v_mfma_f32_16x16x32_bf16 v[60:63], v[112:115], v[76:79], 0
    v_mfma_f32_16x16x32_bf16 v[64:67], v[212:215], v[112:115], v[64:67]
    v_mov_b32 v92, 0
    v_mov_b32 v93, 0
    v_mov_b32 v94, 0
    v_mov_b32 v95, 0
    s_mov_b64 exec, s[60:61]
    ds_read_b64 v[92:93], v129 offset:3232
    ds_read_b64 v[94:95], v129 offset:3240
    s_mov_b64 exec, -1
    v_mfma_f32_16x16x32_bf16 v[68:71], v[212:215], v[116:119], v[68:71]
    s_waitcnt lgkmcnt(4)
    v_mfma_f32_16x16x32_bf16 v[0:3], v[112:115], v[80:83], 0
    ds_read_b64 v[72:73], v128 offset:64
    ds_read_b64 v[74:75], v128 offset:72
    v_mfma_f32_16x16x32_bf16 v[4:7], v[116:119], v[80:83], 0
    v_mfma_f32_16x16x32_bf16 v[4:7], v[84:87], v[116:119], v[4:7]
    v_cndmask_b32 v70, 0, v70, s[46:47]
    ds_read_b64 v[76:77], v131 offset:6400
    ds_read_b64 v[78:79], v131 offset:6408
    s_waitcnt lgkmcnt(4)
    v_mfma_f32_16x16x32_bf16 v[96:99], v[120:123], v[88:91], 0
    ds_read_b64 v[80:81], v128 offset:9632
    ds_read_b64 v[82:83], v128 offset:9640
    v_mfma_f32_16x16x32_bf16 v[100:103], v[124:127], v[88:91], 0
    v_mfma_f32_16x16x32_bf16 v[96:99], v[92:95], v[112:115], v[96:99]
    v_mfma_f32_16x16x32_bf16 v[100:103], v[92:95], v[116:119], v[100:103]
    ds_read_b64 v[84:85], v129 offset:3296
    ds_read_b64 v[86:87], v129 offset:3304
    s_waitcnt lgkmcnt(4)
    v_mfma_f32_16x16x32_bf16 v[12:15], v[112:115], v[72:75], 0
    ds_read_b64 v[88:89], v128 offset:6464
    ds_read_b64 v[90:91], v128 offset:6472
    v_mfma_f32_16x16x32_bf16 v[16:19], v[116:119], v[72:75], 0
    v_cvt_pk_bf16_f32 v8, v96, v97
    v_cvt_pk_bf16_f32 v9, v98, v99
    v_mfma_f32_16x16x32_bf16 v[12:15], v[76:79], v[112:115], v[12:15]
    v_cvt_pk_bf16_f32 v10, v100, v101
    v_cvt_pk_bf16_f32 v11, v102, v103
    v_mfma_f32_16x16x32_bf16 v[16:19], v[76:79], v[116:119], v[16:19]
    ds_read_b64 v[92:93], v128 offset:9696
    ds_read_b64 v[94:95], v128 offset:9704
    s_waitcnt lgkmcnt(4)
    v_mfma_f32_16x16x32_bf16 v[96:99], v[120:123], v[80:83], 0
    ds_read_b64 v[72:73], v128 offset:128
    ds_read_b64 v[74:75], v128 offset:136
    v_mfma_f32_16x16x32_bf16 v[100:103], v[124:127], v[80:83], 0
    v_mfma_f32_16x16x32_bf16 v[96:99], v[84:87], v[112:115], v[96:99]
    v_mfma_f32_16x16x32_bf16 v[100:103], v[84:87], v[116:119], v[100:103]
    ds_read_b64 v[76:77], v129 offset:12800
    ds_read_b64 v[78:79], v129 offset:12808
    s_waitcnt lgkmcnt(4)
    v_mfma_f32_16x16x32_bf16 v[24:27], v[112:115], v[88:91], 0
    ds_read_b64 v[80:81], v128 offset:3328
    ds_read_b64 v[82:83], v128 offset:3336
    v_mfma_f32_16x16x32_bf16 v[28:31], v[112:115], v[92:95], 0
    v_cvt_pk_bf16_f32 v20, v96, v97
    v_cvt_pk_bf16_f32 v21, v98, v99
    s_nop 3
    v_cvt_pk_bf16_f32 v22, v100, v101
    v_cvt_pk_bf16_f32 v23, v102, v103
    ds_read_b64 v[84:85], v131 offset:12832
    ds_read_b64 v[86:87], v131 offset:12840
    s_waitcnt lgkmcnt(4)
    v_mfma_f32_16x16x32_bf16 v[96:99], v[120:123], v[72:75], 0
    ds_read_b64 v[88:89], v128 offset:6528
    ds_read_b64 v[90:91], v128 offset:6536
    v_mfma_f32_16x16x32_bf16 v[100:103], v[124:127], v[72:75], 0
    v_mfma_f32_16x16x32_bf16 v[96:99], v[76:79], v[112:115], v[96:99]
    v_mfma_f32_16x16x32_bf16 v[100:103], v[76:79], v[116:119], v[100:103]
    ds_read_b64 v[92:93], v129 offset:12864
    ds_read_b64 v[94:95], v129 offset:12872
    s_waitcnt lgkmcnt(4)
    v_mfma_f32_16x16x32_bf16 v[36:39], v[112:115], v[80:83], 0
    ds_read_b64 v[72:73], v128 offset:9728
    ds_read_b64 v[74:75], v128 offset:9736
    v_mfma_f32_16x16x32_bf16 v[40:43], v[116:119], v[80:83], 0
    v_cvt_pk_bf16_f32 v32, v96, v97
    v_cvt_pk_bf16_f32 v33, v98, v99
    v_mfma_f32_16x16x32_bf16 v[36:39], v[84:87], v[112:115], v[36:39]
    v_cvt_pk_bf16_f32 v34, v100, v101
    v_cvt_pk_bf16_f32 v35, v102, v103
    v_mfma_f32_16x16x32_bf16 v[40:43], v[84:87], v[116:119], v[40:43]
    ds_read_b64 v[76:77], v131 offset:12896
    ds_read_b64 v[78:79], v131 offset:12904
    s_waitcnt lgkmcnt(4)
    v_mfma_f32_16x16x32_bf16 v[96:99], v[120:123], v[88:91], 0
    ds_read_b64 v[80:81], v128 offset:12928
    ds_read_b64 v[82:83], v128 offset:12936
    v_mfma_f32_16x16x32_bf16 v[100:103], v[124:127], v[88:91], 0
    v_mfma_f32_16x16x32_bf16 v[96:99], v[92:95], v[112:115], v[96:99]
    v_mfma_f32_16x16x32_bf16 v[100:103], v[92:95], v[116:119], v[100:103]
    v_mov_b32 v84, 0
    v_mov_b32 v85, 0
    v_mov_b32 v86, 0
    v_mov_b32 v87, 0
    s_mov_b64 exec, s[60:61]
    ds_read_b64 v[84:85], v129 offset:12928
    ds_read_b64 v[86:87], v129 offset:12936
    s_mov_b64 exec, -1
    s_waitcnt lgkmcnt(4)
    v_mfma_f32_16x16x32_bf16 v[48:51], v[112:115], v[72:75], 0
    v_mfma_f32_16x16x32_bf16 v[52:55], v[116:119], v[72:75], 0
    v_cvt_pk_bf16_f32 v44, v96, v97
    v_cvt_pk_bf16_f32 v45, v98, v99
    v_mfma_f32_16x16x32_bf16 v[48:51], v[76:79], v[112:115], v[48:51]
    v_cvt_pk_bf16_f32 v46, v100, v101
    v_cvt_pk_bf16_f32 v47, v102, v103
    v_mfma_f32_16x16x32_bf16 v[52:55], v[76:79], v[116:119], v[52:55]
    s_waitcnt lgkmcnt(0)

    s_mov_b64 exec, 1
    ds_add_u32 v252, v253 offset:12
    s_mov_b64 exec, -1

    v_mfma_f32_16x16x32_bf16 v[96:99], v[120:123], v[80:83], 0
    v_mfma_f32_16x16x32_bf16 v[100:103], v[124:127], v[80:83], 0
    v_mfma_f32_16x16x32_bf16 v[96:99], v[84:87], v[112:115], v[96:99]
    v_mfma_f32_16x16x32_bf16 v[100:103], v[84:87], v[116:119], v[100:103]
    s_nop 7
    v_cvt_pk_bf16_f32 v56, v96, v97
    v_cvt_pk_bf16_f32 v57, v98, v99
    v_cvt_pk_bf16_f32 v58, v100, v101
    v_cvt_pk_bf16_f32 v59, v102, v103
    s_waitcnt vmcnt(0)
    ds_write_b32 v191, v193 offset:0
    ds_write_b32 v191, v193 offset:9216
    s_mov_b64 exec, s[48:49]
    ds_write_b16 v190, v216 offset:0
    ds_write_b16 v190, v217 offset:576
    ds_write_b16 v190, v218 offset:1152
    ds_write_b16 v190, v219 offset:1728
    ds_write_b16 v190, v220 offset:4608
    ds_write_b16 v190, v221 offset:5184
    ds_write_b16 v190, v222 offset:5760
    ds_write_b16 v190, v223 offset:6336
    ds_write_b16 v190, v224 offset:9216
    ds_write_b16 v190, v225 offset:9792
    ds_write_b16 v190, v226 offset:10368
    ds_write_b16 v190, v227 offset:10944
    s_mov_b64 exec, -1
    ds_read_b128 v[180:183], v189
    v_add_u32 v189, 2304, v189
    v_mov_b32 v128, 0
    v_mov_b32 v129, 0
    v_mov_b32 v130, 0
    v_mov_b32 v131, 0
    v_mov_b32 v132, 0
    v_mov_b32 v133, 0
    v_mov_b32 v134, 0
    v_mov_b32 v135, 0
    v_mov_b32 v136, 0
    v_mov_b32 v137, 0
    v_mov_b32 v138, 0
    v_mov_b32 v139, 0
    v_mov_b32 v140, 0
    v_mov_b32 v141, 0
    v_mov_b32 v142, 0
    v_mov_b32 v143, 0
    v_mov_b32 v144, 0
    v_mov_b32 v145, 0
    v_mov_b32 v146, 0
    v_mov_b32 v147, 0
    v_mov_b32 v148, 0
    v_mov_b32 v149, 0
    v_mov_b32 v150, 0
    v_mov_b32 v151, 0
    v_mov_b32 v152, 0
    v_mov_b32 v153, 0
    v_mov_b32 v154, 0
    v_mov_b32 v155, 0
    v_mov_b32 v156, 0
    v_mov_b32 v157, 0
    v_mov_b32 v158, 0
    v_mov_b32 v159, 0
    v_mov_b32 v160, 0
    v_mov_b32 v161, 0
    v_mov_b32 v162, 0
    v_mov_b32 v163, 0
    v_mov_b32 v164, 0
    v_mov_b32 v165, 0
    v_mov_b32 v166, 0
    v_mov_b32 v167, 0
    v_mov_b32 v168, 0
    v_mov_b32 v169, 0
    v_mov_b32 v170, 0
    v_mov_b32 v171, 0
    v_mov_b32 v172, 0
    v_mov_b32 v173, 0
    v_mov_b32 v174, 0
    v_mov_b32 v175, 0
    v_mov_b32 v184, 0
    v_mov_b32 v185, 0
    v_mov_b32 v186, 0
    v_mov_b32 v187, 0
    s_mov_b32 m0, 0
k1_kernel_wf2:

    ds_read_b32 v251, v252 offset:16
    s_waitcnt lgkmcnt(0)
    v_readfirstlane_b32 s45, v251
    s_cmp_lt_u32 s45, 4
    s_cbranch_scc1 k1_kernel_wf2

    s_setprio 2
    v_mad_u32_u16 v76, v180, s57, v188 op_sel:[0,0,0,0]
    ds_read_b128 v[72:75], v76 offset:0
    ds_read_b128 v[76:79], v76 offset:64
    v_mad_u32_u16 v84, v180, s57, v188 op_sel:[1,0,0,0]
    ds_read_b128 v[80:83], v84 offset:0
    ds_read_b128 v[84:87], v84 offset:64
    v_mad_u32_u16 v92, v181, s57, v188 op_sel:[0,0,0,0]
    ds_read_b128 v[88:91], v92 offset:0
    ds_read_b128 v[92:95], v92 offset:64
    v_mad_u32_u16 v100, v181, s57, v188 op_sel:[1,0,0,0]
    ds_read_b128 v[96:99], v100 offset:0
    ds_read_b128 v[100:103], v100 offset:64
    v_mad_u32_u16 v108, v182, s57, v188 op_sel:[0,0,0,0]
    ds_read_b128 v[104:107], v108 offset:0
    ds_read_b128 v[108:111], v108 offset:64
    v_mad_u32_u16 v116, v182, s57, v188 op_sel:[1,0,0,0]
    ds_read_b128 v[112:115], v116 offset:0
    ds_read_b128 v[116:119], v116 offset:64
    s_waitcnt lgkmcnt(6)
    buffer_load_dwordx4 v[228:231], v254, s[16:19], s74 offen offset:2400
    s_add_u32 s74, s74, 3200
    buffer_load_dwordx4 v[232:235], v254, s[16:19], s74 offen offset:0
    buffer_load_dwordx4 v[236:239], v254, s[16:19], s74 offen offset:800
    buffer_load_dwordx4 v[240:243], v254, s[16:19], s74 offen offset:1600
    buffer_load_dwordx4 v[244:247], v254, s[16:19], s74 offen offset:2400
    s_add_u32 s74, s74, 3200
    s_movk_i32 s58, 5
k1_kernel_loop:
    v_mfma_f32_16x16x32_bf16 v[128:131], v[72:75], v[72:75], 0
    v_mad_u32_u16 v124, v183, s57, v188 op_sel:[0,0,0,0]
    ds_read_b128 v[120:123], v124 offset:0
    v_mfma_f32_16x16x32_bf16 v[128:131], v[76:79], v[76:79], v[128:131]
    ds_read_b128 v[124:127], v124 offset:64
    ds_read_b128 v[180:183], v189
    v_mfma_f32_16x16x32_bf16 v[132:135], v[80:83], v[72:75], 0
    v_add_u32 v189, 2304, v189
    v_fmac_f32 v185, v168, v60
    v_mfma_f32_16x16x32_bf16 v[132:135], v[84:87], v[76:79], v[132:135]
    v_fmac_f32 v184, v169, v61
    v_fmac_f32 v185, v170, v62
    v_mfma_f32_16x16x32_bf16 v[136:139], v[80:83], v[80:83], 0
    v_fmac_f32 v184, v171, v63
    v_fma_f32 v186, v172, v176, v184
    v_mfma_f32_16x16x32_bf16 v[136:139], v[84:87], v[84:87], v[136:139]
    v_fmac_f32 v186, v173, v177
    v_fmac_f32 v186, v174, v178
    v_mfma_f32_16x16x32_bf16 v[140:143], v[88:91], v[80:83], 0
    v_fmac_f32 v186, v175, v179
    v_fmac_f32 v185, v160, v69
    v_mfma_f32_16x16x32_bf16 v[140:143], v[92:95], v[84:87], v[140:143]
    v_fmac_f32 v185, v164, v70
    v_add_f32 v186, v186, v185
    v_mfma_f32_16x16x32_bf16 v[144:147], v[88:91], v[72:75], 0
    v_fmac_f32 v184, v128, v0
    v_fmac_f32 v185, v129, v1
    v_mfma_f32_16x16x32_bf16 v[144:147], v[92:95], v[76:79], v[144:147]
    s_waitcnt lgkmcnt(7)
    v_add_f32_dpp v186, v186, v186 row_shr:1 row_mask:0xf bank_mask:0xf bound_ctrl:0
    v_smfmac_f32_16x16x64_bf16 v[172:175], v[8:11], v[136:143], v192
    v_fmac_f32 v184, v130, v2
    v_mfma_f32_16x16x32_bf16 v[148:151], v[96:99], v[72:75], 0
    v_add_f32_dpp v186, v186, v186 row_shr:2 row_mask:0xf bank_mask:0xf bound_ctrl:0
    v_fmac_f32 v185, v131, v3
    v_mfma_f32_16x16x32_bf16 v[148:151], v[100:103], v[76:79], v[148:151]
    v_fmac_f32 v184, v132, v4
    v_fmac_f32 v185, v133, v5
    v_mfma_f32_16x16x32_bf16 v[152:155], v[80:83], v[96:99], 0
    v_add_f32_dpp v186, v186, v186 row_shr:4 row_mask:0xf bank_mask:0xf bound_ctrl:0
    v_fmac_f32 v184, v134, v6
    v_mfma_f32_16x16x32_bf16 v[152:155], v[84:87], v[100:103], v[152:155]
    v_fmac_f32 v185, v135, v7
    v_fmac_f32 v184, v144, v12
    v_mfma_f32_16x16x32_bf16 v[156:159], v[88:91], v[96:99], 0
    v_add_f32_dpp v186, v186, v186 row_shr:8 row_mask:0xf bank_mask:0xf bound_ctrl:0
    v_fmac_f32 v185, v145, v13
    v_mfma_f32_16x16x32_bf16 v[156:159], v[92:95], v[100:103], v[156:159]
    v_fmac_f32 v184, v146, v14
    v_fmac_f32 v185, v147, v15
    v_mfma_f32_16x16x32_bf16 v[128:131], v[88:91], v[88:91], 0
    v_add_f32_dpp v186, v186, v186 row_bcast:15 row_mask:0xa bank_mask:0xf
    v_fmac_f32 v184, v148, v16
    v_mfma_f32_16x16x32_bf16 v[128:131], v[92:95], v[92:95], v[128:131]
    v_fmac_f32 v185, v149, v17
    v_fmac_f32 v184, v150, v18
    v_smfmac_f32_16x16x64_bf16 v[172:175], v[20:23], v[152:159], v192
    v_add_f32_dpp v186, v186, v186 row_bcast:31 row_mask:0xc bank_mask:0xf
    v_mfma_f32_16x16x32_bf16 v[132:135], v[96:99], v[96:99], 0
    s_waitcnt lgkmcnt(0)
    v_fmac_f32 v185, v151, v19
    v_mfma_f32_16x16x32_bf16 v[132:135], v[100:103], v[100:103], v[132:135]
    v_readlane_b32 s76, v186, 63
    v_fmac_f32 v184, v128, v24
    v_mfma_f32_16x16x32_bf16 v[136:139], v[104:107], v[72:75], 0
    v_fmac_f32 v185, v129, v25
    v_fmac_f32 v184, v130, v26
    v_mfma_f32_16x16x32_bf16 v[136:139], v[108:111], v[76:79], v[136:139]
    v_writelane_b32 v187, s76, m0
    v_fmac_f32 v185, v131, v27
    v_mfma_f32_16x16x32_bf16 v[140:143], v[112:115], v[72:75], 0
    v_fmac_f32 v184, v132, v28
    v_fmac_f32 v185, v133, v29
    v_mfma_f32_16x16x32_bf16 v[140:143], v[116:119], v[76:79], v[140:143]
    s_add_u32 m0, m0, 1
    v_fmac_f32 v184, v134, v30
    v_mfma_f32_16x16x32_bf16 v[160:163], v[120:123], v[72:75], 0
    v_fmac_f32 v185, v135, v31
    v_mfma_f32_16x16x32_bf16 v[160:163], v[124:127], v[76:79], v[160:163]
    v_mad_u32_u16 v76, v180, s57, v188 op_sel:[0,0,0,0]
    ds_read_b128 v[72:75], v76 offset:0
    v_smfmac_f32_16x16x64_bf16 v[172:175], v[32:35], v[136:143], v192
    ds_read_b128 v[76:79], v76 offset:64
    v_mfma_f32_16x16x32_bf16 v[144:147], v[104:107], v[80:83], 0
    v_mfma_f32_16x16x32_bf16 v[144:147], v[108:111], v[84:87], v[144:147]
    v_fmac_f32 v184, v160, v64
    v_mfma_f32_16x16x32_bf16 v[148:151], v[112:115], v[80:83], 0
    v_mfma_f32_16x16x32_bf16 v[148:151], v[116:119], v[84:87], v[148:151]
    v_mfma_f32_16x16x32_bf16 v[164:167], v[120:123], v[80:83], 0
    v_fmac_f32 v185, v144, v36
    v_fmac_f32 v184, v145, v37
    v_mfma_f32_16x16x32_bf16 v[164:167], v[124:127], v[84:87], v[164:167]
    v_mad_u32_u16 v84, v180, s57, v188 op_sel:[1,0,0,0]
    ds_read_b128 v[80:83], v84 offset:0
    v_mfma_f32_16x16x32_bf16 v[152:155], v[104:107], v[88:91], 0
    ds_read_b128 v[84:87], v84 offset:64
    v_fmac_f32 v185, v146, v38
    v_mfma_f32_16x16x32_bf16 v[152:155], v[108:111], v[92:95], v[152:155]
    v_fmac_f32 v184, v147, v39
    v_fmac_f32 v185, v148, v40
    v_mfma_f32_16x16x32_bf16 v[156:159], v[112:115], v[88:91], 0
    v_fmac_f32 v184, v149, v41
    v_fmac_f32 v185, v150, v42
    v_mfma_f32_16x16x32_bf16 v[156:159], v[116:119], v[92:95], v[156:159]
    v_fmac_f32 v184, v151, v43
    v_fmac_f32 v185, v164, v65
    v_mfma_f32_16x16x32_bf16 v[168:171], v[120:123], v[88:91], 0
    v_mfma_f32_16x16x32_bf16 v[168:171], v[124:127], v[92:95], v[168:171]
    v_mad_u32_u16 v92, v181, s57, v188 op_sel:[0,0,0,0]
    ds_read_b128 v[88:91], v92 offset:0
    v_smfmac_f32_16x16x64_bf16 v[172:175], v[44:47], v[152:159], v192
    ds_read_b128 v[92:95], v92 offset:64
    v_mfma_f32_16x16x32_bf16 v[144:147], v[104:107], v[96:99], 0
    v_mfma_f32_16x16x32_bf16 v[144:147], v[108:111], v[100:103], v[144:147]
    v_fmac_f32 v184, v168, v66
    v_mfma_f32_16x16x32_bf16 v[148:151], v[112:115], v[96:99], 0
    v_mfma_f32_16x16x32_bf16 v[148:151], v[116:119], v[100:103], v[148:151]
    v_mfma_f32_16x16x32_bf16 v[160:163], v[120:123], v[96:99], 0
    v_fmac_f32 v185, v144, v48
    v_fmac_f32 v184, v145, v49
    v_mfma_f32_16x16x32_bf16 v[160:163], v[124:127], v[100:103], v[160:163]
    v_mad_u32_u16 v100, v181, s57, v188 op_sel:[1,0,0,0]
    ds_read_b128 v[96:99], v100 offset:0
    v_mfma_f32_16x16x32_bf16 v[152:155], v[104:107], v[104:107], 0
    ds_read_b128 v[100:103], v100 offset:64
    v_fmac_f32 v185, v146, v50
    v_mfma_f32_16x16x32_bf16 v[152:155], v[108:111], v[108:111], v[152:155]
    v_fmac_f32 v184, v147, v51
    v_fmac_f32 v185, v148, v52
    v_mfma_f32_16x16x32_bf16 v[156:159], v[112:115], v[104:107], 0
    v_fmac_f32 v184, v149, v53
    v_fmac_f32 v185, v150, v54
    v_mfma_f32_16x16x32_bf16 v[156:159], v[116:119], v[108:111], v[156:159]
    v_fmac_f32 v184, v151, v55
    v_fmac_f32 v185, v160, v67
    v_mfma_f32_16x16x32_bf16 v[164:167], v[120:123], v[104:107], 0
    v_mfma_f32_16x16x32_bf16 v[164:167], v[124:127], v[108:111], v[164:167]
    v_mad_u32_u16 v108, v182, s57, v188 op_sel:[0,0,0,0]
    ds_read_b128 v[104:107], v108 offset:0
    v_smfmac_f32_16x16x64_bf16 v[172:175], v[56:59], v[152:159], v192
    ds_read_b128 v[108:111], v108 offset:64
    v_mfma_f32_16x16x32_bf16 v[168:171], v[112:115], v[112:115], 0
    v_mfma_f32_16x16x32_bf16 v[168:171], v[116:119], v[116:119], v[168:171]
    v_fmac_f32 v184, v164, v68
    v_mfma_f32_16x16x32_bf16 v[160:163], v[120:123], v[112:115], 0
    v_mfma_f32_16x16x32_bf16 v[160:163], v[124:127], v[116:119], v[160:163]
    v_mad_u32_u16 v116, v182, s57, v188 op_sel:[1,0,0,0]
    ds_read_b128 v[112:115], v116 offset:0
    v_mfma_f32_16x16x32_bf16 v[164:167], v[120:123], v[120:123], 0
    ds_read_b128 v[116:119], v116 offset:64
    s_waitcnt lgkmcnt(6)
    v_mfma_f32_16x16x32_bf16 v[164:167], v[124:127], v[124:127], v[164:167]

    s_cmp_lt_u32 m0, s58
    s_cbranch_scc1 k1_kernel_loop
    s_cmp_lt_u32 m0, 32
    s_cbranch_scc1 k1_kernel_mid

    s_nop 7
    v_fmac_f32 v185, v168, v60
    v_fmac_f32 v184, v169, v61
    v_fmac_f32 v185, v170, v62
    v_fmac_f32 v184, v171, v63
    v_fma_f32 v186, v172, v176, v184
    v_fmac_f32 v186, v173, v177
    v_fmac_f32 v186, v174, v178
    v_fmac_f32 v186, v175, v179
    v_fmac_f32 v185, v160, v69
    v_fmac_f32 v185, v164, v70
    v_add_f32 v186, v186, v185
    s_nop 1
    v_add_f32_dpp v186, v186, v186 row_shr:1 row_mask:0xf bank_mask:0xf bound_ctrl:0
    s_nop 1
    v_add_f32_dpp v186, v186, v186 row_shr:2 row_mask:0xf bank_mask:0xf bound_ctrl:0
    s_nop 1
    v_add_f32_dpp v186, v186, v186 row_shr:4 row_mask:0xf bank_mask:0xf bound_ctrl:0
    s_nop 1
    v_add_f32_dpp v186, v186, v186 row_shr:8 row_mask:0xf bank_mask:0xf bound_ctrl:0
    s_nop 1
    v_add_f32_dpp v186, v186, v186 row_bcast:15 row_mask:0xa bank_mask:0xf
    s_nop 1
    v_add_f32_dpp v186, v186, v186 row_bcast:31 row_mask:0xc bank_mask:0xf
    s_nop 1
    v_readlane_b32 s76, v186, 63
    s_nop 1
    v_writelane_b32 v187, s76, m0
    s_nop 1
    s_add_u32 m0, m0, 1
    s_nop 1

    v_subrev_f32_dpp v186, v187, v187 wave_shr:1 row_mask:0xf bank_mask:0xf
    v_add_u32 v40, -1, v255
    v_cmp_gt_u32 vcc, 32, v40
    s_lshl_b32 s74, s72, 2
    s_lshl_b32 s76, s36, 16
    s_add_u32 s74, s74, s76
    s_add_u32 s74, s74, 29360128
    v_lshlrev_b32 v40, 2, v40
    s_lshl_b32 s76, s36, 6
    v_xor_b32 v40, s76, v40

    v_min_u32 v112, -2, v186
    v_mov_b32 v113, v40
    s_branch k1_kernel_k2
k1_kernel_mid:

    s_waitcnt vmcnt(0)
    s_cmp_eq_u32 m0, 15
    s_cbranch_scc1 k1_kernel_mid2
    s_movk_i32 s58, 15
    s_mul_i32 s45, s36, 12800
    s_sub_u32 s74, s74, s45

    ds_write_b32 v191, v193 offset:18432
    ds_write_b32 v191, v193 offset:27648
    s_mov_b64 exec, s[48:49]
    ds_write_b16 v190, v228 offset:13824
    ds_write_b16 v190, v229 offset:14400
    ds_write_b16 v190, v230 offset:14976
    ds_write_b16 v190, v231 offset:15552
    ds_write_b16 v190, v232 offset:18432
    ds_write_b16 v190, v233 offset:19008
    ds_write_b16 v190, v234 offset:19584
    ds_write_b16 v190, v235 offset:20160
    ds_write_b16 v190, v236 offset:23040
    ds_write_b16 v190, v237 offset:23616
    ds_write_b16 v190, v238 offset:24192
    ds_write_b16 v190, v239 offset:24768
    ds_write_b16 v190, v240 offset:27648
    ds_write_b16 v190, v241 offset:28224
    ds_write_b16 v190, v242 offset:28800
    ds_write_b16 v190, v243 offset:29376
    ds_write_b16 v190, v244 offset:32256
    ds_write_b16 v190, v245 offset:32832
    ds_write_b16 v190, v246 offset:33408
    ds_write_b16 v190, v247 offset:33984
    s_mov_b64 exec, -1
    buffer_load_dwordx4 v[216:219], v254, s[16:19], s74 offen offset:0
    buffer_load_dwordx4 v[220:223], v254, s[16:19], s74 offen offset:800
    buffer_load_dwordx4 v[224:227], v254, s[16:19], s74 offen offset:1600
    buffer_load_dwordx4 v[228:231], v254, s[16:19], s74 offen offset:2400
    s_add_u32 s74, s74, 3200
    buffer_load_dwordx4 v[232:235], v254, s[16:19], s74 offen offset:0
    buffer_load_dwordx4 v[236:239], v254, s[16:19], s74 offen offset:800
    buffer_load_dwordx4 v[240:243], v254, s[16:19], s74 offen offset:1600
    buffer_load_dwordx4 v[244:247], v254, s[16:19], s74 offen offset:2400
    s_add_u32 s74, s74, 3200
    s_branch k1_kernel_loop
k1_kernel_mid2:
    s_movk_i32 s58, 32
    v_subrev_u32 v189, 36864, v189
    s_mov_b64 exec, s[48:49]
    ds_write_b16 v190, v216 offset:0
    ds_write_b16 v190, v217 offset:576
    ds_write_b16 v190, v218 offset:1152
    ds_write_b16 v190, v219 offset:1728
    ds_write_b16 v190, v220 offset:4608
    ds_write_b16 v190, v221 offset:5184
    ds_write_b16 v190, v222 offset:5760
    ds_write_b16 v190, v223 offset:6336
    ds_write_b16 v190, v224 offset:9216
    ds_write_b16 v190, v225 offset:9792
    ds_write_b16 v190, v226 offset:10368
    ds_write_b16 v190, v227 offset:10944
    ds_write_b16 v190, v228 offset:13824
    ds_write_b16 v190, v229 offset:14400
    ds_write_b16 v190, v230 offset:14976
    ds_write_b16 v190, v231 offset:15552
    ds_write_b16 v190, v232 offset:18432
    ds_write_b16 v190, v233 offset:19008
    ds_write_b16 v190, v234 offset:19584
    ds_write_b16 v190, v235 offset:20160
    ds_write_b16 v190, v236 offset:23040
    ds_write_b16 v190, v237 offset:23616
    ds_write_b16 v190, v238 offset:24192
    ds_write_b16 v190, v239 offset:24768
    ds_write_b16 v190, v240 offset:27648
    ds_write_b16 v190, v241 offset:28224
    ds_write_b16 v190, v242 offset:28800
    ds_write_b16 v190, v243 offset:29376
    ds_write_b16 v190, v244 offset:32256
    ds_write_b16 v190, v245 offset:32832
    ds_write_b16 v190, v246 offset:33408
    ds_write_b16 v190, v247 offset:33984
    s_mov_b64 exec, -1
    s_branch k1_kernel_loop
k1_kernel_last:
    s_endpgm
.section .rodata,"a"
.p2align 6
.amdhsa_kernel standalone__deep_cross_pnn__recsys_kernel
  .amdhsa_next_free_vgpr 256
  .amdhsa_next_free_sgpr 96
  .amdhsa_accum_offset 256
  .amdhsa_group_segment_fixed_size 0
  .amdhsa_kernarg_size 80
  .amdhsa_user_sgpr_count 2
  .amdhsa_user_sgpr_kernarg_segment_ptr 1
  .amdhsa_system_sgpr_workgroup_id_x 1
.end_amdhsa_kernel
```

```asm
; @launch grid=(256,1,1) block=(512,1,1) lds=163840
.amdgcn_target "amdgcn-amd-amdhsa--gfx950"
.text
.globl standalone__deep_cross_pnn__recsys_kernel
.p2align 8
.type standalone__deep_cross_pnn__recsys_kernel,@function
standalone__deep_cross_pnn__recsys_kernel:

    s_cmp_ge_u32 s2, 256
    s_cbranch_scc1 k1_kernel_end

    s_load_dwordx8 s[4:11], s[0:1], 0
    s_load_dwordx2 s[12:13], s[0:1], 72
    s_load_dwordx2 s[52:53], s[0:1], 64

    v_cmp_gt_u32 vcc, 18, v0
    s_and_saveexec_b64 s[48:49], vcc
    s_cbranch_execz k1_kernel_ncp
    s_getpc_b64 s[46:47]
k1_kernel_pc:
    s_bfe_u32 s38, s2, 0x40003
    s_lshl_b32 s38, s38, 7
    v_lshl_add_u32 v2, v0, 11, s38
    v_min_u32 v2, k1_kernel_last-k1_kernel_pc, v2
    global_load_dword v250, v2, s[46:47]
k1_kernel_ncp:
    s_mov_b64 exec, s[48:49]

    v_lshrrev_b32 v1, 6, v0
    v_and_b32 v255, 63, v0
    s_bfe_u32 s36, s2, 0x10003
    v_readfirstlane_b32 s3, v1
    s_lshr_b32 s37, s2, 4
    s_lshl_b32 s37, s37, 3
    s_and_b32 s38, s2, 7
    s_or_b32 s37, s37, s38
    v_lshlrev_b32 v254, 4, v255
    v_mov_b32 v252, 144144
    v_mov_b32 v253, 1
    v_mov_b32 v40, 0
    v_lshl_add_u32 v41, v0, 2, v252
    v_cmp_gt_u32 vcc, 8, v0
    s_and_saveexec_b64 s[46:47], vcc
    ds_write_b32 v41, v40
    s_mov_b64 exec, s[46:47]
    v_mul_u32_u24 v6, 57, v255
    v_lshrrev_b32 v6, 9, v6
    v_mul_u32_u24 v5, 9, v6
    v_sub_u32 v5, v255, v5
    v_cmp_gt_u32 s[40:41], 8, v5
    s_lshl_b32 s38, s36, 7
    v_lshl_add_u32 v5, v5, 4, s38
    v_lshl_add_u32 v83, v6, 8, v5
    s_and_b32 s56, s3, 3
    s_bitset0_b32 s41, 31
    s_lshr_b32 s42, s2, 3
    s_mul_i32 s42, s42, 36
    s_lshr_b32 s42, s42, 5
    s_lshl_b32 s42, s42, 2
    s_add_u32 s42, s42, s56
    s_mov_b32 s43, s42
    s_mov_b32 s50, s36
    s_lshl_b32 s72, s37, 7
    s_lshl_b32 s73, s3, 5
    s_add_u32 s72, s72, s73
    s_mul_i32 s74, s72, 400
    s_mul_i32 s45, s36, 11200
    s_add_u32 s74, s74, s45
    s_lshl_b32 s38, s3, 10
    s_add_u32 m0, s38, 144384

    s_mov_b32 s18, 6553600
    s_mov_b32 s19, 0x00020000
    s_mov_b32 s22, 256000
    s_mov_b32 s23, 0x00020000
    s_mov_b32 s26, 20000
    s_mov_b32 s27, 0x00020000
    s_mov_b32 s30, 13107200
    s_mov_b32 s31, 0x00020000
    s_mov_b32 s34, 268435456
    s_mov_b32 s35, 0x00020000
    s_mov_b32 s14, 268435456
    s_mov_b32 s15, 0x00020000
    s_mov_b32 s54, 256
    s_mov_b32 s55, 0x00020000

    v_bfe_u32 v5, v255, 2, 2
    v_mul_u32_u24 v5, 200, v5
    v_and_b32 v6, 3, v255
    v_lshl_add_u32 v5, v6, 5, v5
    v_and_b32 v6, 32, v255
    v_lshl_add_u32 v5, v6, 2, v5
    v_and_b32 v6, 16, v255
    v_add_u32 v5, v5, v6
    s_movk_i32 s39, 19200
    s_cmp_ge_u32 s3, 4
    s_waitcnt lgkmcnt(0)
    s_barrier
    s_cbranch_scc1 k1_kernel_dma

    s_mov_b32 s24, s8
    s_and_b32 s25, s9, 0xffff
    buffer_load_dwordx4 v254, s[24:27], s38 offen lds
    s_add_u32 s38, s38, 4096
    s_add_u32 m0, s38, 144384
    s_mov_b32 s16, s4
    s_and_b32 s17, s5, 0xffff
    buffer_load_dwordx4 v254, s[24:27], s38 offen lds
    s_add_u32 s38, s38, 4096
    s_add_u32 m0, s38, 144384
    v_cmp_lt_u32 vcc, 24, v255
    buffer_load_dwordx4 v254, s[24:27], s38 offen lds
    s_add_u32 s38, s38, 4096
    s_add_u32 m0, s38, 144384
    v_subbrev_co_u32 v249, vcc, 0, v255, vcc
    buffer_load_dwordx4 v254, s[24:27], s38 offen lds
    s_add_u32 s38, s38, 4096
    s_min_u32 s38, s38, 18432
    s_add_u32 m0, s38, 144384
    v_min_u32 v249, 49, v249
    v_lshlrev_b32 v249, 4, v249
    buffer_load_dwordx4 v254, s[24:27], s38 offen lds
    buffer_load_dwordx4 v[232:235], v5, s[24:27], s39 offen
    buffer_load_dwordx4 v[240:243], v249, s[16:19], s74 offen offset:0
    buffer_load_dwordx4 v[244:247], v249, s[16:19], s74 offen offset:800

    s_mul_i32 s77, s36, -3200
    s_mul_i32 s78, s72, 400
    s_addk_i32 s77, 1600
    s_add_u32 s79, s78, 11200
    s_add_u32 s74, s74, s77

    s_branch k1_kernel_main
k1_kernel_dma:
    s_mov_b32 s20, s6
    s_and_b32 s21, s7, 0xffff
    s_mov_b64 exec, s[40:41]
k1_kernel_dml:

    s_min_u32 s38, s42, 142
    s_mul_i32 m0, s38, 1008
    s_mul_i32 s39, s38, 1792
    s_add_u32 s42, s42, 4
    buffer_load_dwordx4 v83, s[20:23], s39 offen lds
    s_cmp_ge_u32 s42, 144
    s_cselect_b32 s38, 144, 0
    s_sub_u32 s42, s42, s38
    s_cmp_lg_u32 s42, s43
    s_cbranch_scc1 k1_kernel_dml
    s_mov_b64 exec, -1

    s_mov_b32 s16, s4
    s_and_b32 s17, s5, 0xffff
    s_mov_b32 s20, s6
    s_and_b32 s21, s7, 0xffff
    s_mov_b32 s28, s10
    s_and_b32 s29, s11, 0xffff
    s_mov_b32 s32, s12
    s_and_b32 s33, s13, 0xffff
    s_and_b32 s13, s13, 0xffff
    s_and_b32 s53, s53, 0xffff
k1_kernel_aux:

    s_setprio 0
    v_mov_b32 v8, v255
    v_mov_b32 v9, v254
    v_mov_b32 v10, v253
    v_mov_b32 v11, v252
    s_mov_b32 s51, s2
    s_mov_b32 s64, 0
    s_mov_b32 s65, 0

k1_kernel_unit:

    s_bfe_u32 s36, s51, 0x10003

    s_lshr_b32 s38, s51, 4
    s_and_b32 s39, s51, 7
    s_sub_u32 s57, 2, s36
    s_lshl_b32 s57, s39, s57
    s_lshl_b32 s37, s36, 5
    s_add_u32 s57, s57, s37
    s_add_u32 s57, s57, s56
    s_mul_i32 s37, s38, 48
    s_add_u32 s37, s37, s57
    s_lshl_b32 s38, s38, 1
    s_lshr_b32 s39, s39, 2
    s_add_u32 s38, s38, s39
    s_add_u32 s38, s38, 768
    s_and_b32 s57, s57, 7
    s_cmp_eq_u32 s57, 2
    s_cselect_b32 s38, s38, 1000
    s_lshl_b32 s39, s36, 1
    s_and_b32 s39, s39, s56
    s_cselect_b32 s57, s38, s37

    s_lshr_b32 s37, s51, 4
    s_lshl_b32 s37, s37, 3
    s_and_b32 s38, s51, 7
    s_or_b32 s37, s37, s38
    s_and_b32 s58, s56, 1
    s_lshl_b32 s59, s37, 1
    s_add_u32 s58, s58, s59
    s_lshr_b32 s59, s56, 1
    s_lshl_b32 s60, s36, 1
    s_add_u32 s59, s59, s60
    s_mul_i32 s60, s58, 25600
    s_mul_i32 s61, s59, 96
    s_add_u32 s60, s60, s61
    s_movk_i32 s61, 400
    v_lshrrev_b32 v1, 3, v8
    v_and_b32 v2, 7, v8
    v_mul_u32_u24 v0, s61, v1
    v_cmp_gt_u32 s[48:49], 7, v2
    v_lshl_add_u32 v0, v2, 4, v0
    v_and_b32 v5, 15, v8
    v_and_b32 v6, 48, v8
    v_lshl_add_u32 v7, v5, 8, v6
    s_lshl_b32 s44, s56, 15
    s_xor_b32 s38, s50, 1
    s_lshl_b32 s38, s38, 7
    s_add_u32 s44, s44, s38

    s_mov_b64 exec, s[48:49]
    buffer_load_dwordx4 v[224:227], v0, s[16:19], s60 offen
    s_add_u32 s60, s60, 3200
    buffer_load_dwordx4 v[228:231], v0, s[16:19], s60 offen
    s_add_u32 s60, s60, 3200
    buffer_load_dwordx4 v[232:235], v0, s[16:19], s60 offen
    s_add_u32 s60, s60, 3200
    buffer_load_dwordx4 v[236:239], v0, s[16:19], s60 offen
    s_add_u32 s60, s60, 3200
    buffer_load_dwordx4 v[240:243], v0, s[16:19], s60 offen
    s_add_u32 s60, s60, 3200
    buffer_load_dwordx4 v[244:247], v0, s[16:19], s60 offen
    s_add_u32 s60, s60, 3200
    buffer_load_dwordx4 v[248:251], v0, s[16:19], s60 offen
    s_add_u32 s60, s60, 3200
    buffer_load_dwordx4 v[252:255], v0, s[16:19], s60 offen
    s_add_u32 s60, s60, 3200
    s_mov_b64 exec, -1

    s_lshr_b32 s78, s57, 5
    s_bfe_u32 s79, s57, 0x20003
    s_bfe_u32 s80, s57, 0x20001
    s_and_b32 s81, s57, 1
    s_lshl_b32 s77, s78, 2
    s_lshl_b32 s83, s81, 1
    s_add_u32 s77, s77, s83
    s_lshl_b32 s77, s77, 7
    s_lshl_b32 s83, s79, 5
    s_add_u32 s77, s77, s83
    s_lshl_b32 s83, s80, 3
    s_add_u32 s77, s77, s83
    s_lshl_b32 s77, s77, 10
    s_lshl_b32 s82, s78, 12
    s_lshl_b32 s83, s79, 10
    s_add_u32 s82, s82, s83
    s_lshl_b32 s83, s80, 8
    s_add_u32 s82, s82, s83
    s_lshl_b32 s83, s81, 7
    s_add_u32 s82, s82, s83
    s_mov_b32 s84, 205312
    v_lshrrev_b32 v3, 2, v8
    v_and_b32 v4, 3, v8
    v_mul_lo_u32 v14, v3, s84
    v_lshl_add_u32 v14, v4, 4, v14
    s_lshl_b32 s61, s56, 12
    s_add_u32 s61, s61, 147456
    v_and_b32 v3, 3, v3
    v_lshlrev_b32 v36, 6, v8
    v_lshl_add_u32 v36, v3, 4, v36
    v_add_u32 v36, s61, v36
    v_xor_b32 v37, 16, v36
    v_xor_b32 v38, 32, v36
    v_xor_b32 v39, 48, v36
    v_and_b32 v3, 48, v8
    v_xor_b32 v15, v3, v9
    v_add_u32 v15, s61, v15
    s_mov_b32 s84, 0x05040100
    s_mov_b32 s85, 0x07060302
    s_cmp_eq_u32 s64, 0
    s_cbranch_scc1 k1_kernel_nsig0
    s_waitcnt vmcnt(0)

k1_kernel_nsig0:

    s_waitcnt vmcnt(8)
    s_cmp_lg_u32 s64, 0
    s_cbranch_scc1 k1_kernel_nsig

    s_mov_b64 exec, 1
    ds_add_u32 v11, v10 offset:16
    s_mov_b64 exec, -1

k1_kernel_nsig:
    s_setprio 3

    s_lshl_b32 s61, s56, 12
    s_add_u32 s61, s61, 147456
    v_lshlrev_b32 v86, 2, v8
    v_add_u32 v86, s61, v86
    v_and_b32 v85, 0xffffff80, v86
    v_and_b32 v123, 32, v8
    s_add_u32 s61, s61, 256
    v_mul_u32_u24 v31, 56, v8
    v_add_u32 v31, s61, v31
    v_mul_u32_u24 v34, 56, v1
    v_lshl_add_u32 v34, v2, 3, v34
    v_add_u32 v34, s61, v34
    v_add_u32 v2, s59, v2
    v_subrev_u32 v3, 5, v2
    v_min_u32 v2, v2, v3
    v_mov_b32 v13, 0
    v_mul_u32_u24 v2, 0x10001, v2
    v_lshlrev_b32 v2, 12, v2
    v_add_u32 v32, 67108864, v2
    v_add_u32 v33, 201328640, v2
    v_mov_b32 v71, 0xf00
    s_lshr_b32 s62, s58, 7
    s_mul_i32 s62, s62, 25
    s_mul_i32 s63, s59, 6
    s_add_u32 s62, s62, s63
    s_lshl_b32 s62, s62, 3
    s_bfe_u32 s63, s58, 0x30004
    s_add_u32 s62, s62, s63
    s_lshl_b32 s62, s62, 13
    s_bfe_u32 s63, s58, 0x30001
    s_lshl_b32 s63, s63, 10
    s_add_u32 s62, s62, s63
    s_and_b32 s63, s58, 1
    s_lshl_b32 s63, s63, 9
    s_add_u32 s62, s62, s63
    s_add_u32 s62, s62, 16777216
    v_and_b32 v30, 31, v8
    v_lshrrev_b32 v3, 5, v8
    v_lshlrev_b32 v30, 4, v30
    v_lshl_add_u32 v30, v3, 3, v30
    s_cmp_eq_u32 s59, 3
    s_cselect_b32 s63, 0xf00, 0
    s_movk_i32 s66, 0x7c
    s_mov_b32 s67, 0x001f001f
    s_mov_b32 s75, 0x06040200
    v_mov_b32 v54, 0x08040201
    v_mov_b32 v55, 0x80402010

    s_lshl_b32 s72, s2, 15
    s_lshl_b32 s73, s56, 13
    s_add_u32 s72, s72, s73
    s_add_u32 s72, s72, 20971520
    s_lshl_b32 s73, s36, 9
    s_lshl2_add_u32 s73, s37, s73
    s_add_u32 s73, s73, s56
    s_lshl_b32 s73, s73, 7
    s_add_u32 s73, s73, 29360128
    v_mov_b32 v192, -1
    v_mov_b32 v193, -1
    v_mov_b32 v194, -1
    v_mov_b32 v195, -1
    v_lshlrev_b32 v196, 1, v8

k1_kernel_wf3:

    ds_read_b32 v12, v11 offset:12
    s_waitcnt lgkmcnt(0)
    v_readfirstlane_b32 s45, v12
    s_cmp_lt_u32 s45, 4
    s_cbranch_scc1 k1_kernel_wf3

    s_mov_b64 exec, s[48:49]

    s_waitcnt vmcnt(7)
    v_lshl_or_b32 v224, v225, 16, v224
    v_lshl_or_b32 v225, v227, 16, v226
    v_add_u32 v224, v32, v224
    v_add_u32 v225, v33, v225
    ds_write_b64 v34, v[224:225] offset:0

    s_waitcnt vmcnt(6)
    v_lshl_or_b32 v228, v229, 16, v228
    v_lshl_or_b32 v229, v231, 16, v230
    v_add_u32 v228, v32, v228
    v_add_u32 v229, v33, v229
    ds_write_b64 v34, v[228:229] offset:448

    s_waitcnt vmcnt(5)
    v_lshl_or_b32 v232, v233, 16, v232
    v_lshl_or_b32 v233, v235, 16, v234
    v_add_u32 v232, v32, v232
    v_add_u32 v233, v33, v233
    ds_write_b64 v34, v[232:233] offset:896

    s_waitcnt vmcnt(4)
    v_lshl_or_b32 v236, v237, 16, v236
    v_lshl_or_b32 v237, v239, 16, v238
    v_add_u32 v236, v32, v236
    v_add_u32 v237, v33, v237
    ds_write_b64 v34, v[236:237] offset:1344

    s_waitcnt vmcnt(3)
    v_lshl_or_b32 v240, v241, 16, v240
    v_lshl_or_b32 v241, v243, 16, v242
    v_add_u32 v240, v32, v240
    v_add_u32 v241, v33, v241
    ds_write_b64 v34, v[240:241] offset:1792

    s_waitcnt vmcnt(2)
    v_lshl_or_b32 v244, v245, 16, v244
    v_lshl_or_b32 v245, v247, 16, v246
    v_add_u32 v244, v32, v244
    v_add_u32 v245, v33, v245
    ds_write_b64 v34, v[244:245] offset:2240

    s_waitcnt vmcnt(1)
    v_lshl_or_b32 v248, v249, 16, v248
    v_lshl_or_b32 v249, v251, 16, v250
    v_add_u32 v248, v32, v248
    v_add_u32 v249, v33, v249
    ds_write_b64 v34, v[248:249] offset:2688

    s_waitcnt vmcnt(0)
    v_lshl_or_b32 v252, v253, 16, v252
    v_lshl_or_b32 v253, v255, 16, v254
    v_add_u32 v252, v32, v252
    v_add_u32 v253, v33, v253
    ds_write_b64 v34, v[252:253] offset:3136

    s_mov_b64 exec, -1
    ds_read_b64 v[40:41], v31 offset:0
    ds_read_b64 v[42:43], v31 offset:8
    ds_read_b64 v[44:45], v31 offset:16
    ds_read_b64 v[46:47], v31 offset:24
    ds_read_b64 v[48:49], v31 offset:32
    ds_read_b64 v[50:51], v31 offset:40
    ds_read_b64 v[52:53], v31 offset:48

    s_waitcnt lgkmcnt(6)
    v_and_b32 v72, s67, v40
    v_and_b32 v73, s67, v41
    v_lshl_or_b32 v72, v73, 10, v72
    v_lshlrev_b32_sdwa v73, 5, v72 dst_sel:DWORD dst_unused:UNUSED_PAD src0_sel:DWORD src1_sel:WORD_1
    v_or_b32_sdwa v64, v73, v72 dst_sel:DWORD dst_unused:UNUSED_PAD src0_sel:DWORD src1_sel:WORD_0
    v_perm_b32 v72, v41, v40, s75
    v_lshrrev_b32 v73, 3, v72
    v_and_b32 v72, 0x07070707, v72
    v_and_b32 v0, 0x03030303, v73
    v_perm_b32 v16, v55, v54, v72
    v_add_u32 v23, v54, v16

    s_waitcnt lgkmcnt(5)
    v_and_b32 v72, s67, v42
    v_and_b32 v73, s67, v43
    v_lshl_or_b32 v72, v73, 10, v72
    v_lshlrev_b32_sdwa v73, 5, v72 dst_sel:DWORD dst_unused:UNUSED_PAD src0_sel:DWORD src1_sel:WORD_1
    v_or_b32_sdwa v65, v73, v72 dst_sel:DWORD dst_unused:UNUSED_PAD src0_sel:DWORD src1_sel:WORD_0
    v_perm_b32 v72, v43, v42, s75
    v_lshrrev_b32 v73, 3, v72
    v_and_b32 v72, 0x07070707, v72
    v_and_b32 v1, 0x03030303, v73
    v_perm_b32 v17, v55, v54, v72
    v_add_u32 v24, v54, v17

    s_waitcnt lgkmcnt(4)
    v_and_b32 v72, s67, v44
    v_and_b32 v73, s67, v45
    v_lshl_or_b32 v72, v73, 10, v72
    v_lshlrev_b32_sdwa v73, 5, v72 dst_sel:DWORD dst_unused:UNUSED_PAD src0_sel:DWORD src1_sel:WORD_1
    v_or_b32_sdwa v66, v73, v72 dst_sel:DWORD dst_unused:UNUSED_PAD src0_sel:DWORD src1_sel:WORD_0
    v_perm_b32 v72, v45, v44, s75
    v_lshrrev_b32 v73, 3, v72
    v_and_b32 v72, 0x07070707, v72
    v_and_b32 v2, 0x03030303, v73
    v_perm_b32 v18, v55, v54, v72
    v_add_u32 v25, v54, v18

    s_waitcnt lgkmcnt(3)
    v_and_b32 v72, s67, v46
    v_and_b32 v73, s67, v47
    v_lshl_or_b32 v72, v73, 10, v72
    v_lshlrev_b32_sdwa v73, 5, v72 dst_sel:DWORD dst_unused:UNUSED_PAD src0_sel:DWORD src1_sel:WORD_1
    v_or_b32_sdwa v67, v73, v72 dst_sel:DWORD dst_unused:UNUSED_PAD src0_sel:DWORD src1_sel:WORD_0
    v_perm_b32 v72, v47, v46, s75
    v_lshrrev_b32 v73, 3, v72
    v_and_b32 v72, 0x07070707, v72
    v_and_b32 v3, 0x03030303, v73
    v_perm_b32 v19, v55, v54, v72
    v_add_u32 v26, v54, v19

    s_waitcnt lgkmcnt(2)
    v_and_b32 v72, s67, v48
    v_and_b32 v73, s67, v49
    v_lshl_or_b32 v72, v73, 10, v72
    v_lshlrev_b32_sdwa v73, 5, v72 dst_sel:DWORD dst_unused:UNUSED_PAD src0_sel:DWORD src1_sel:WORD_1
    v_or_b32_sdwa v68, v73, v72 dst_sel:DWORD dst_unused:UNUSED_PAD src0_sel:DWORD src1_sel:WORD_0
    v_perm_b32 v72, v49, v48, s75
    v_lshrrev_b32 v73, 3, v72
    v_and_b32 v72, 0x07070707, v72
    v_and_b32 v4, 0x03030303, v73
    v_perm_b32 v20, v55, v54, v72
    v_add_u32 v27, v54, v20

    s_waitcnt lgkmcnt(1)
    v_and_b32 v72, s67, v50
    v_and_b32 v73, s67, v51
    v_lshl_or_b32 v72, v73, 10, v72
    v_lshlrev_b32_sdwa v73, 5, v72 dst_sel:DWORD dst_unused:UNUSED_PAD src0_sel:DWORD src1_sel:WORD_1
    v_or_b32_sdwa v69, v73, v72 dst_sel:DWORD dst_unused:UNUSED_PAD src0_sel:DWORD src1_sel:WORD_0
    v_perm_b32 v72, v51, v50, s75
    v_lshrrev_b32 v73, 3, v72
    v_and_b32 v72, 0x07070707, v72
    v_and_b32 v5, 0x03030303, v73
    v_perm_b32 v21, v55, v54, v72
    v_add_u32 v28, v54, v21

    s_waitcnt lgkmcnt(0)
    v_and_b32 v72, s67, v52
    v_and_b32 v73, s67, v53
    v_lshl_or_b32 v72, v73, 10, v72
    v_lshlrev_b32_sdwa v73, 5, v72 dst_sel:DWORD dst_unused:UNUSED_PAD src0_sel:DWORD src1_sel:WORD_1
    v_or_b32_sdwa v70, v73, v72 dst_sel:DWORD dst_unused:UNUSED_PAD src0_sel:DWORD src1_sel:WORD_0
    v_perm_b32 v72, v53, v52, s75
    v_lshrrev_b32 v73, 3, v72
    v_and_b32 v72, 0x07070707, v72
    v_and_b32 v6, 0x03030303, v73
    v_perm_b32 v22, v55, v54, v72
    v_add_u32 v29, v54, v22

    ds_write_b32 v86, v13
    v_lshrrev_b32 v71, 4, v71
    v_or_b32 v71, 0xf00, v71
    v_lshlrev_b32 v74, 22, v64
    v_lshrrev_b32 v75, 10, v64
    v_lshl_or_b32 v75, v65, 10, v75

    v_ffbl_b32 v84, v71
    v_mul_u32_u24 v72, 5, v84
    v_lshrrev_b64 v[72:73], v72, v[74:75]
    v_and_or_b32 v72, v72, s66, v85
    ds_add_rtn_u32 v87, v72, v10
    ds_wrxchg_rtn_b32 v116, v86, v13
    v_and_b32 v117, 15, v71
    v_bcnt_u32_b32 v118, v117, 0
    v_cmp_eq_u32 vcc, 4, v118

    s_nop 1

    v_cndmask_b32 v119, v71, v117, vcc
    s_waitcnt lgkmcnt(0)
    v_cmp_gt_u32 s[68:69], 2, v116
    v_cmp_gt_u32 s[70:71], 2, v87

    s_nop 0
    v_lshrrev_b64 v[76:77], v123, s[68:69]
    v_perm_b32 v121, v76, v76, v1
    v_perm_b32 v122, v76, v76, v0
    v_and_b32 v121, v121, v17
    v_and_b32 v122, v122, v16
    v_msad_u8 v120, v24, v121, 0
    v_lshlrev_b32 v120, 4, v120
    v_msad_u8 v120, v23, v122, v120
    v_lshlrev_b32 v120, 4, v120

    v_and_b32 v120, v120, v119
    v_cmp_eq_u32 vcc, 0, v120
    v_ffbl_b32 v118, v120
    s_or_b64 vcc, vcc, s[70:71]
    v_cndmask_b32 v118, v118, v84, vcc
    v_lshlrev_b32 v72, v118, v10
    v_lshl_add_u32 v73, v118, 1, v31
    v_xor_b32 v71, v71, v72

    v_subrev_u32 v73, 8, v73
    ds_read_u16 v80, v73 offset:0

    v_ffbl_b32 v84, v71
    v_mul_u32_u24 v72, 5, v84
    v_lshrrev_b64 v[72:73], v72, v[74:75]
    v_and_or_b32 v72, v72, s66, v85
    ds_add_rtn_u32 v87, v72, v10
    ds_wrxchg_rtn_b32 v116, v86, v13
    v_and_b32 v117, 15, v71
    v_bcnt_u32_b32 v118, v117, 0
    v_cmp_eq_u32 vcc, 3, v118

    s_lshl_b32 s45, s2, 8
    s_add_u32 s45, s45, 14680064
    buffer_store_dword v13, v13, s[12:15], s45 offen sc1
    buffer_load_dwordx4 v[128:131], v9, s[28:31], s77 offen offset:0

    v_cndmask_b32 v119, v71, v117, vcc
    s_waitcnt lgkmcnt(0)
    v_cmp_gt_u32 s[68:69], 2, v116
    v_cmp_gt_u32 s[70:71], 2, v87

    s_nop 0
    v_lshrrev_b64 v[76:77], v123, s[68:69]
    v_perm_b32 v121, v76, v76, v1
    v_perm_b32 v122, v76, v76, v0
    v_and_b32 v121, v121, v17
    v_and_b32 v122, v122, v16
    v_msad_u8 v120, v24, v121, 0
    v_lshlrev_b32 v120, 4, v120
    v_msad_u8 v120, v23, v122, v120
    v_lshlrev_b32 v120, 4, v120

    v_and_b32 v120, v120, v119
    v_cmp_eq_u32 vcc, 0, v120
    v_ffbl_b32 v118, v120
    s_or_b64 vcc, vcc, s[70:71]
    v_cndmask_b32 v118, v118, v84, vcc
    v_lshlrev_b32 v72, v118, v10
    v_lshl_add_u32 v73, v118, 1, v31
    v_xor_b32 v71, v71, v72

    v_subrev_u32 v73, 8, v73
    ds_read_u16 v81, v73 offset:0

    v_ffbl_b32 v84, v71
    v_mul_u32_u24 v72, 5, v84
    v_lshrrev_b64 v[72:73], v72, v[74:75]
    v_and_or_b32 v72, v72, s66, v85
    ds_add_rtn_u32 v87, v72, v10
    ds_wrxchg_rtn_b32 v116, v86, v13
    v_and_b32 v117, 15, v71
    v_bcnt_u32_b32 v118, v117, 0
    v_cmp_eq_u32 vcc, 2, v118

    buffer_load_dwordx4 v[132:135], v9, s[28:31], s77 offen offset:1024

    v_cndmask_b32 v119, v71, v117, vcc
    s_waitcnt lgkmcnt(0)
    v_cmp_gt_u32 s[68:69], 2, v116
    v_cmp_gt_u32 s[70:71], 2, v87

    s_nop 0
    v_lshrrev_b64 v[76:77], v123, s[68:69]
    v_perm_b32 v121, v76, v76, v1
    v_perm_b32 v122, v76, v76, v0
    v_and_b32 v121, v121, v17
    v_and_b32 v122, v122, v16
    v_msad_u8 v120, v24, v121, 0
    v_lshlrev_b32 v120, 4, v120
    v_msad_u8 v120, v23, v122, v120
    v_lshlrev_b32 v120, 4, v120

    v_and_b32 v120, v120, v119
    v_cmp_eq_u32 vcc, 0, v120
    v_ffbl_b32 v118, v120
    s_or_b64 vcc, vcc, s[70:71]
    v_cndmask_b32 v118, v118, v84, vcc
    v_lshlrev_b32 v72, v118, v10
    v_lshl_add_u32 v73, v118, 1, v31
    v_xor_b32 v71, v71, v72

    v_subrev_u32 v73, 8, v73
    ds_read_u16 v82, v73 offset:0

    v_ffbl_b32 v84, v71
    v_mul_u32_u24 v72, 5, v84
    v_lshrrev_b64 v[72:73], v72, v[74:75]
    v_and_or_b32 v72, v72, s66, v85
    ds_add_rtn_u32 v87, v72, v10
    ds_wrxchg_rtn_b32 v116, v86, v13
    v_and_b32 v117, 15, v71
    v_bcnt_u32_b32 v118, v117, 0
    v_cmp_eq_u32 vcc, 1, v118

    buffer_load_dwordx4 v[136:139], v9, s[28:31], s77 offen offset:2048

    v_cndmask_b32 v119, v71, v117, vcc
    s_waitcnt lgkmcnt(0)
    v_cmp_gt_u32 s[68:69], 2, v116
    v_cmp_gt_u32 s[70:71], 2, v87

    s_nop 0
    v_lshrrev_b64 v[76:77], v123, s[68:69]
    v_perm_b32 v121, v76, v76, v1
    v_perm_b32 v122, v76, v76, v0
    v_and_b32 v121, v121, v17
    v_and_b32 v122, v122, v16
    v_msad_u8 v120, v24, v121, 0
    v_lshlrev_b32 v120, 4, v120
    v_msad_u8 v120, v23, v122, v120
    v_lshlrev_b32 v120, 4, v120

    v_and_b32 v120, v120, v119
    v_cmp_eq_u32 vcc, 0, v120
    v_ffbl_b32 v118, v120
    s_or_b64 vcc, vcc, s[70:71]
    v_cndmask_b32 v118, v118, v84, vcc
    v_lshlrev_b32 v72, v118, v10
    v_lshl_add_u32 v73, v118, 1, v31
    v_xor_b32 v71, v71, v72

    v_subrev_u32 v73, 8, v73
    ds_read_u16 v83, v73 offset:0
    v_lshrrev_b32 v71, 4, v71
    v_or_b32 v71, 0xf00, v71
    v_lshlrev_b32 v74, 22, v65
    v_lshl_or_b32 v74, v64, 2, v74
    v_lshrrev_b32 v75, 10, v65
    v_lshl_or_b32 v75, v66, 10, v75
    s_setprio 0

    v_ffbl_b32 v84, v71
    v_mul_u32_u24 v72, 5, v84
    v_lshrrev_b64 v[72:73], v72, v[74:75]
    v_and_or_b32 v72, v72, s66, v85
    ds_add_rtn_u32 v87, v72, v10
    ds_wrxchg_rtn_b32 v116, v86, v13
    v_and_b32 v117, 15, v71
    v_bcnt_u32_b32 v118, v117, 0
    v_cmp_eq_u32 vcc, 4, v118

    buffer_load_dwordx4 v[140:143], v9, s[28:31], s77 offen offset:3072
    s_add_u32 s77, s77, 4096

    v_cndmask_b32 v119, v71, v117, vcc
    s_waitcnt lgkmcnt(0)
    v_cmp_gt_u32 s[68:69], 2, v116
    v_cmp_gt_u32 s[70:71], 2, v87

    v_lshl_or_b32 v78, v81, 16, v80
    v_lshl_or_b32 v79, v83, 16, v82
    buffer_store_dwordx2 v[78:79], v30, s[32:35], s62 offen sc1
    s_add_u32 s62, s62, 65536
    v_lshrrev_b64 v[76:77], v123, s[68:69]
    v_perm_b32 v121, v76, v76, v2
    v_perm_b32 v122, v76, v76, v1
    v_perm_b32 v77, v76, v76, v0
    v_and_b32 v121, v121, v18
    v_and_b32 v122, v122, v17
    v_and_b32 v77, v77, v16
    v_msad_u8 v120, v25, v121, 0
    v_lshlrev_b32 v120, 4, v120
    v_msad_u8 v120, v24, v122, v120
    v_lshlrev_b32 v120, 4, v120
    v_msad_u8 v120, v23, v77, v120

    v_and_b32 v120, v120, v119
    v_cmp_eq_u32 vcc, 0, v120
    v_ffbl_b32 v118, v120
    s_or_b64 vcc, vcc, s[70:71]
    v_cndmask_b32 v118, v118, v84, vcc
    v_lshlrev_b32 v72, v118, v10
    v_lshl_add_u32 v73, v118, 1, v31
    v_xor_b32 v71, v71, v72

    ds_read_u16 v80, v73 offset:0

    v_ffbl_b32 v84, v71
    v_mul_u32_u24 v72, 5, v84
    v_lshrrev_b64 v[72:73], v72, v[74:75]
    v_and_or_b32 v72, v72, s66, v85
    ds_add_rtn_u32 v87, v72, v10
    ds_wrxchg_rtn_b32 v116, v86, v13
    v_and_b32 v117, 15, v71
    v_bcnt_u32_b32 v118, v117, 0
    v_cmp_eq_u32 vcc, 3, v118

    buffer_load_dwordx4 v[144:147], v9, s[28:31], s77 offen offset:0
    s_add_u32 s47, s44, 12288
    buffer_load_dwordx4 v[56:59], v7, s[20:23], s47 offen offset:0
    buffer_load_dwordx4 v[60:63], v7, s[20:23], s47 offen offset:64

    v_cndmask_b32 v119, v71, v117, vcc
    s_waitcnt lgkmcnt(0)
    v_cmp_gt_u32 s[68:69], 2, v116
    v_cmp_gt_u32 s[70:71], 2, v87

    s_nop 0
    v_lshrrev_b64 v[76:77], v123, s[68:69]
    v_perm_b32 v121, v76, v76, v2
    v_perm_b32 v122, v76, v76, v1
    v_perm_b32 v77, v76, v76, v0
    v_and_b32 v121, v121, v18
    v_and_b32 v122, v122, v17
    v_and_b32 v77, v77, v16
    v_msad_u8 v120, v25, v121, 0
    v_lshlrev_b32 v120, 4, v120
    v_msad_u8 v120, v24, v122, v120
    v_lshlrev_b32 v120, 4, v120
    v_msad_u8 v120, v23, v77, v120

    v_and_b32 v120, v120, v119
    v_cmp_eq_u32 vcc, 0, v120
    v_ffbl_b32 v118, v120
    s_or_b64 vcc, vcc, s[70:71]
    v_cndmask_b32 v118, v118, v84, vcc
    v_lshlrev_b32 v72, v118, v10
    v_lshl_add_u32 v73, v118, 1, v31
    v_xor_b32 v71, v71, v72

    ds_read_u16 v81, v73 offset:0

    v_ffbl_b32 v84, v71
    v_mul_u32_u24 v72, 5, v84
    v_lshrrev_b64 v[72:73], v72, v[74:75]
    v_and_or_b32 v72, v72, s66, v85
    ds_add_rtn_u32 v87, v72, v10
    ds_wrxchg_rtn_b32 v116, v86, v13
    v_and_b32 v117, 15, v71
    v_bcnt_u32_b32 v118, v117, 0
    v_cmp_eq_u32 vcc, 2, v118

    buffer_load_dwordx4 v[148:151], v9, s[28:31], s77 offen offset:1024
    s_add_u32 s47, s44, 16384
    buffer_load_dwordx4 v[88:91], v7, s[20:23], s47 offen offset:0
    buffer_load_dwordx4 v[92:95], v7, s[20:23], s47 offen offset:64

    v_cndmask_b32 v119, v71, v117, vcc
    s_waitcnt lgkmcnt(0)
    v_cmp_gt_u32 s[68:69], 2, v116
    v_cmp_gt_u32 s[70:71], 2, v87

    s_nop 0
    v_lshrrev_b64 v[76:77], v123, s[68:69]
    v_perm_b32 v121, v76, v76, v2
    v_perm_b32 v122, v76, v76, v1
    v_perm_b32 v77, v76, v76, v0
    v_and_b32 v121, v121, v18
    v_and_b32 v122, v122, v17
    v_and_b32 v77, v77, v16
    v_msad_u8 v120, v25, v121, 0
    v_lshlrev_b32 v120, 4, v120
    v_msad_u8 v120, v24, v122, v120
    v_lshlrev_b32 v120, 4, v120
    v_msad_u8 v120, v23, v77, v120

    v_and_b32 v120, v120, v119
    v_cmp_eq_u32 vcc, 0, v120
    v_ffbl_b32 v118, v120
    s_or_b64 vcc, vcc, s[70:71]
    v_cndmask_b32 v118, v118, v84, vcc
    v_lshlrev_b32 v72, v118, v10
    v_lshl_add_u32 v73, v118, 1, v31
    v_xor_b32 v71, v71, v72

    ds_read_u16 v82, v73 offset:0

    v_ffbl_b32 v84, v71
    v_mul_u32_u24 v72, 5, v84
    v_lshrrev_b64 v[72:73], v72, v[74:75]
    v_and_or_b32 v72, v72, s66, v85
    ds_add_rtn_u32 v87, v72, v10
    ds_wrxchg_rtn_b32 v116, v86, v13
    v_and_b32 v117, 15, v71
    v_bcnt_u32_b32 v118, v117, 0
    v_cmp_eq_u32 vcc, 1, v118

    buffer_load_dwordx4 v[152:155], v9, s[28:31], s77 offen offset:2048
    s_add_u32 s47, s44, 20480
    buffer_load_dwordx4 v[96:99], v7, s[20:23], s47 offen offset:0
    buffer_load_dwordx4 v[100:103], v7, s[20:23], s47 offen offset:64

    v_cndmask_b32 v119, v71, v117, vcc
    s_waitcnt lgkmcnt(0)
    v_cmp_gt_u32 s[68:69], 2, v116
    v_cmp_gt_u32 s[70:71], 2, v87

    s_nop 0
    v_lshrrev_b64 v[76:77], v123, s[68:69]
    v_perm_b32 v121, v76, v76, v2
    v_perm_b32 v122, v76, v76, v1
    v_perm_b32 v77, v76, v76, v0
    v_and_b32 v121, v121, v18
    v_and_b32 v122, v122, v17
    v_and_b32 v77, v77, v16
    v_msad_u8 v120, v25, v121, 0
    v_lshlrev_b32 v120, 4, v120
    v_msad_u8 v120, v24, v122, v120
    v_lshlrev_b32 v120, 4, v120
    v_msad_u8 v120, v23, v77, v120

    v_and_b32 v120, v120, v119
    v_cmp_eq_u32 vcc, 0, v120
    v_ffbl_b32 v118, v120
    s_or_b64 vcc, vcc, s[70:71]
    v_cndmask_b32 v118, v118, v84, vcc
    v_lshlrev_b32 v72, v118, v10
    v_lshl_add_u32 v73, v118, 1, v31
    v_xor_b32 v71, v71, v72

    ds_read_u16 v83, v73 offset:0
    v_lshrrev_b32 v71, 4, v71
    v_or_b32 v71, 0xf00, v71
    v_lshlrev_b32 v74, 22, v66
    v_lshl_or_b32 v74, v65, 2, v74
    v_lshrrev_b32 v75, 10, v66
    v_lshl_or_b32 v75, v67, 10, v75

    v_ffbl_b32 v84, v71
    v_mul_u32_u24 v72, 5, v84
    v_lshrrev_b64 v[72:73], v72, v[74:75]
    v_and_or_b32 v72, v72, s66, v85
    ds_add_rtn_u32 v87, v72, v10
    ds_wrxchg_rtn_b32 v116, v86, v13
    v_and_b32 v117, 15, v71
    v_bcnt_u32_b32 v118, v117, 0
    v_cmp_eq_u32 vcc, 4, v118

    buffer_load_dwordx4 v[156:159], v9, s[28:31], s77 offen offset:3072
    s_add_u32 s77, s77, 126976
    s_cmp_lg_u32 s64, 0
    s_cbranch_scc1 k1_kernel_nc8
    buffer_store_short v192, v196, s[12:15], s73 offen sc1
k1_kernel_nc8:
    s_add_u32 s47, s44, 24576
    buffer_load_dwordx4 v[104:107], v7, s[20:23], s47 offen offset:0
    buffer_load_dwordx4 v[108:111], v7, s[20:23], s47 offen offset:64

    v_cndmask_b32 v119, v71, v117, vcc
    s_waitcnt lgkmcnt(0)
    v_cmp_gt_u32 s[68:69], 2, v116
    v_cmp_gt_u32 s[70:71], 2, v87

    v_lshl_or_b32 v78, v81, 16, v80
    v_lshl_or_b32 v79, v83, 16, v82
    buffer_store_dwordx2 v[78:79], v30, s[32:35], s62 offen sc1
    s_add_u32 s62, s62, 65536
    v_lshrrev_b64 v[76:77], v123, s[68:69]
    v_perm_b32 v121, v76, v76, v3
    v_perm_b32 v122, v76, v76, v2
    v_perm_b32 v77, v76, v76, v1
    v_and_b32 v121, v121, v19
    v_and_b32 v122, v122, v18
    v_and_b32 v77, v77, v17
    v_msad_u8 v120, v26, v121, 0
    v_lshlrev_b32 v120, 4, v120
    v_msad_u8 v120, v25, v122, v120
    v_lshlrev_b32 v120, 4, v120
    v_msad_u8 v120, v24, v77, v120

    v_and_b32 v120, v120, v119
    v_cmp_eq_u32 vcc, 0, v120
    v_ffbl_b32 v118, v120
    s_or_b64 vcc, vcc, s[70:71]
    v_cndmask_b32 v118, v118, v84, vcc
    v_lshlrev_b32 v72, v118, v10
    v_lshl_add_u32 v73, v118, 1, v31
    v_xor_b32 v71, v71, v72

    ds_read_u16 v80, v73 offset:8

    v_ffbl_b32 v84, v71
    v_mul_u32_u24 v72, 5, v84
    v_lshrrev_b64 v[72:73], v72, v[74:75]
    v_and_or_b32 v72, v72, s66, v85
    ds_add_rtn_u32 v87, v72, v10
    ds_wrxchg_rtn_b32 v116, v86, v13
    v_and_b32 v117, 15, v71
    v_bcnt_u32_b32 v118, v117, 0
    v_cmp_eq_u32 vcc, 3, v118

    buffer_load_dwordx4 v[160:163], v9, s[28:31], s77 offen offset:0
    s_add_u32 s47, s44, 28672
    buffer_load_dwordx4 v[112:115], v7, s[20:23], s47 offen offset:0
    buffer_load_dwordx4 v[124:127], v7, s[20:23], s47 offen offset:64

    v_cndmask_b32 v119, v71, v117, vcc
    s_waitcnt lgkmcnt(0)
    v_cmp_gt_u32 s[68:69], 2, v116
    v_cmp_gt_u32 s[70:71], 2, v87

    s_nop 0
    v_lshrrev_b64 v[76:77], v123, s[68:69]
    v_perm_b32 v121, v76, v76, v3
    v_perm_b32 v122, v76, v76, v2
    v_perm_b32 v77, v76, v76, v1
    v_and_b32 v121, v121, v19
    v_and_b32 v122, v122, v18
    v_and_b32 v77, v77, v17
    v_msad_u8 v120, v26, v121, 0
    v_lshlrev_b32 v120, 4, v120
    v_msad_u8 v120, v25, v122, v120
    v_lshlrev_b32 v120, 4, v120
    v_msad_u8 v120, v24, v77, v120

    v_and_b32 v120, v120, v119
    v_cmp_eq_u32 vcc, 0, v120
    v_ffbl_b32 v118, v120
    s_or_b64 vcc, vcc, s[70:71]
    v_cndmask_b32 v118, v118, v84, vcc
    v_lshlrev_b32 v72, v118, v10
    v_lshl_add_u32 v73, v118, 1, v31
    v_xor_b32 v71, v71, v72

    ds_read_u16 v81, v73 offset:8

    v_ffbl_b32 v84, v71
    v_mul_u32_u24 v72, 5, v84
    v_lshrrev_b64 v[72:73], v72, v[74:75]
    v_and_or_b32 v72, v72, s66, v85
    ds_add_rtn_u32 v87, v72, v10
    ds_wrxchg_rtn_b32 v116, v86, v13
    v_and_b32 v117, 15, v71
    v_bcnt_u32_b32 v118, v117, 0
    v_cmp_eq_u32 vcc, 2, v118

    buffer_load_dwordx4 v[164:167], v9, s[28:31], s77 offen offset:1024

    v_cndmask_b32 v119, v71, v117, vcc
    s_waitcnt lgkmcnt(0)
    v_cmp_gt_u32 s[68:69], 2, v116
    v_cmp_gt_u32 s[70:71], 2, v87

    s_nop 0
    v_lshrrev_b64 v[76:77], v123, s[68:69]
    v_perm_b32 v121, v76, v76, v3
    v_perm_b32 v122, v76, v76, v2
    v_perm_b32 v77, v76, v76, v1
    v_and_b32 v121, v121, v19
    v_and_b32 v122, v122, v18
    v_and_b32 v77, v77, v17
    v_msad_u8 v120, v26, v121, 0
    v_lshlrev_b32 v120, 4, v120
    v_msad_u8 v120, v25, v122, v120
    v_lshlrev_b32 v120, 4, v120
    v_msad_u8 v120, v24, v77, v120

    v_and_b32 v120, v120, v119
    v_cmp_eq_u32 vcc, 0, v120
    v_ffbl_b32 v118, v120
    s_or_b64 vcc, vcc, s[70:71]
    v_cndmask_b32 v118, v118, v84, vcc
    v_lshlrev_b32 v72, v118, v10
    v_lshl_add_u32 v73, v118, 1, v31
    v_xor_b32 v71, v71, v72

    ds_read_u16 v82, v73 offset:8

    v_ffbl_b32 v84, v71
    v_mul_u32_u24 v72, 5, v84
    v_lshrrev_b64 v[72:73], v72, v[74:75]
    v_and_or_b32 v72, v72, s66, v85
    ds_add_rtn_u32 v87, v72, v10
    ds_wrxchg_rtn_b32 v116, v86, v13
    v_and_b32 v117, 15, v71
    v_bcnt_u32_b32 v118, v117, 0
    v_cmp_eq_u32 vcc, 1, v118

    buffer_load_dwordx4 v[168:171], v9, s[28:31], s77 offen offset:2048

    v_cndmask_b32 v119, v71, v117, vcc
    s_waitcnt lgkmcnt(0)
    v_cmp_gt_u32 s[68:69], 2, v116
    v_cmp_gt_u32 s[70:71], 2, v87

    s_nop 0
    v_lshrrev_b64 v[76:77], v123, s[68:69]
    v_perm_b32 v121, v76, v76, v3
    v_perm_b32 v122, v76, v76, v2
    v_perm_b32 v77, v76, v76, v1
    v_and_b32 v121, v121, v19
    v_and_b32 v122, v122, v18
    v_and_b32 v77, v77, v17
    v_msad_u8 v120, v26, v121, 0
    v_lshlrev_b32 v120, 4, v120
    v_msad_u8 v120, v25, v122, v120
    v_lshlrev_b32 v120, 4, v120
    v_msad_u8 v120, v24, v77, v120

    v_and_b32 v120, v120, v119
    v_cmp_eq_u32 vcc, 0, v120
    v_ffbl_b32 v118, v120
    s_or_b64 vcc, vcc, s[70:71]
    v_cndmask_b32 v118, v118, v84, vcc
    v_lshlrev_b32 v72, v118, v10
    v_lshl_add_u32 v73, v118, 1, v31
    v_xor_b32 v71, v71, v72

    ds_read_u16 v83, v73 offset:8
    v_lshrrev_b32 v71, 4, v71
    v_or_b32 v71, 0xf00, v71
    v_lshlrev_b32 v74, 22, v67
    v_lshl_or_b32 v74, v66, 2, v74
    v_lshrrev_b32 v75, 10, v67
    v_lshl_or_b32 v75, v68, 10, v75

    v_ffbl_b32 v84, v71
    v_mul_u32_u24 v72, 5, v84
    v_lshrrev_b64 v[72:73], v72, v[74:75]
    v_and_or_b32 v72, v72, s66, v85
    ds_add_rtn_u32 v87, v72, v10
    ds_wrxchg_rtn_b32 v116, v86, v13
    v_and_b32 v117, 15, v71
    v_bcnt_u32_b32 v118, v117, 0
    v_cmp_eq_u32 vcc, 4, v118

    buffer_load_dwordx4 v[172:175], v9, s[28:31], s77 offen offset:3072
    s_add_u32 s77, s77, 4096

    v_cndmask_b32 v119, v71, v117, vcc
    s_waitcnt lgkmcnt(0)
    v_cmp_gt_u32 s[68:69], 2, v116
    v_cmp_gt_u32 s[70:71], 2, v87

    v_lshl_or_b32 v78, v81, 16, v80
    v_lshl_or_b32 v79, v83, 16, v82
    buffer_store_dwordx2 v[78:79], v30, s[32:35], s62 offen sc1
    s_add_u32 s62, s62, 65536
    v_lshrrev_b64 v[76:77], v123, s[68:69]
    v_perm_b32 v121, v76, v76, v4
    v_perm_b32 v122, v76, v76, v3
    v_perm_b32 v77, v76, v76, v2
    v_and_b32 v121, v121, v20
    v_and_b32 v122, v122, v19
    v_and_b32 v77, v77, v18
    v_msad_u8 v120, v27, v121, 0
    v_lshlrev_b32 v120, 4, v120
    v_msad_u8 v120, v26, v122, v120
    v_lshlrev_b32 v120, 4, v120
    v_msad_u8 v120, v25, v77, v120

    v_and_b32 v120, v120, v119
    v_cmp_eq_u32 vcc, 0, v120
    v_ffbl_b32 v118, v120
    s_or_b64 vcc, vcc, s[70:71]
    v_cndmask_b32 v118, v118, v84, vcc
    v_lshlrev_b32 v72, v118, v10
    v_lshl_add_u32 v73, v118, 1, v31
    v_xor_b32 v71, v71, v72

    ds_read_u16 v80, v73 offset:16

    v_ffbl_b32 v84, v71
    v_mul_u32_u24 v72, 5, v84
    v_lshrrev_b64 v[72:73], v72, v[74:75]
    v_and_or_b32 v72, v72, s66, v85
    ds_add_rtn_u32 v87, v72, v10
    ds_wrxchg_rtn_b32 v116, v86, v13
    v_and_b32 v117, 15, v71
    v_bcnt_u32_b32 v118, v117, 0
    v_cmp_eq_u32 vcc, 3, v118

    buffer_load_dwordx4 v[176:179], v9, s[28:31], s77 offen offset:0

    v_cndmask_b32 v119, v71, v117, vcc
    s_waitcnt lgkmcnt(0)
    v_cmp_gt_u32 s[68:69], 2, v116
    v_cmp_gt_u32 s[70:71], 2, v87

    s_nop 0
    v_lshrrev_b64 v[76:77], v123, s[68:69]
    v_perm_b32 v121, v76, v76, v4
    v_perm_b32 v122, v76, v76, v3
    v_perm_b32 v77, v76, v76, v2
    v_and_b32 v121, v121, v20
    v_and_b32 v122, v122, v19
    v_and_b32 v77, v77, v18
    v_msad_u8 v120, v27, v121, 0
    v_lshlrev_b32 v120, 4, v120
    v_msad_u8 v120, v26, v122, v120
    v_lshlrev_b32 v120, 4, v120
    v_msad_u8 v120, v25, v77, v120

    v_and_b32 v120, v120, v119
    v_cmp_eq_u32 vcc, 0, v120
    v_ffbl_b32 v118, v120
    s_or_b64 vcc, vcc, s[70:71]
    v_cndmask_b32 v118, v118, v84, vcc
    v_lshlrev_b32 v72, v118, v10
    v_lshl_add_u32 v73, v118, 1, v31
    v_xor_b32 v71, v71, v72

    ds_read_u16 v81, v73 offset:16

    v_ffbl_b32 v84, v71
    v_mul_u32_u24 v72, 5, v84
    v_lshrrev_b64 v[72:73], v72, v[74:75]
    v_and_or_b32 v72, v72, s66, v85
    ds_add_rtn_u32 v87, v72, v10
    ds_wrxchg_rtn_b32 v116, v86, v13
    v_and_b32 v117, 15, v71
    v_bcnt_u32_b32 v118, v117, 0
    v_cmp_eq_u32 vcc, 2, v118

    buffer_load_dwordx4 v[180:183], v9, s[28:31], s77 offen offset:1024

    v_cndmask_b32 v119, v71, v117, vcc
    s_waitcnt lgkmcnt(0)
    v_cmp_gt_u32 s[68:69], 2, v116
    v_cmp_gt_u32 s[70:71], 2, v87

    s_nop 0
    v_lshrrev_b64 v[76:77], v123, s[68:69]
    v_perm_b32 v121, v76, v76, v4
    v_perm_b32 v122, v76, v76, v3
    v_perm_b32 v77, v76, v76, v2
    v_and_b32 v121, v121, v20
    v_and_b32 v122, v122, v19
    v_and_b32 v77, v77, v18
    v_msad_u8 v120, v27, v121, 0
    v_lshlrev_b32 v120, 4, v120
    v_msad_u8 v120, v26, v122, v120
    v_lshlrev_b32 v120, 4, v120
    v_msad_u8 v120, v25, v77, v120

    v_and_b32 v120, v120, v119
    v_cmp_eq_u32 vcc, 0, v120
    v_ffbl_b32 v118, v120
    s_or_b64 vcc, vcc, s[70:71]
    v_cndmask_b32 v118, v118, v84, vcc
    v_lshlrev_b32 v72, v118, v10
    v_lshl_add_u32 v73, v118, 1, v31
    v_xor_b32 v71, v71, v72

    ds_read_u16 v82, v73 offset:16

    v_ffbl_b32 v84, v71
    v_mul_u32_u24 v72, 5, v84
    v_lshrrev_b64 v[72:73], v72, v[74:75]
    v_and_or_b32 v72, v72, s66, v85
    ds_add_rtn_u32 v87, v72, v10
    ds_wrxchg_rtn_b32 v116, v86, v13
    v_and_b32 v117, 15, v71
    v_bcnt_u32_b32 v118, v117, 0
    v_cmp_eq_u32 vcc, 1, v118

    buffer_load_dwordx4 v[184:187], v9, s[28:31], s77 offen offset:2048

    v_cndmask_b32 v119, v71, v117, vcc
    s_waitcnt lgkmcnt(0)
    v_cmp_gt_u32 s[68:69], 2, v116
    v_cmp_gt_u32 s[70:71], 2, v87

    s_nop 0
    v_lshrrev_b64 v[76:77], v123, s[68:69]
    v_perm_b32 v121, v76, v76, v4
    v_perm_b32 v122, v76, v76, v3
    v_perm_b32 v77, v76, v76, v2
    v_and_b32 v121, v121, v20
    v_and_b32 v122, v122, v19
    v_and_b32 v77, v77, v18
    v_msad_u8 v120, v27, v121, 0
    v_lshlrev_b32 v120, 4, v120
    v_msad_u8 v120, v26, v122, v120
    v_lshlrev_b32 v120, 4, v120
    v_msad_u8 v120, v25, v77, v120

    v_and_b32 v120, v120, v119
    v_cmp_eq_u32 vcc, 0, v120
    v_ffbl_b32 v118, v120
    s_or_b64 vcc, vcc, s[70:71]
    v_cndmask_b32 v118, v118, v84, vcc
    v_lshlrev_b32 v72, v118, v10
    v_lshl_add_u32 v73, v118, 1, v31
    v_xor_b32 v71, v71, v72

    ds_read_u16 v83, v73 offset:16
    v_lshrrev_b32 v71, 4, v71
    v_or_b32 v71, 0xf00, v71
    v_lshlrev_b32 v74, 22, v68
    v_lshl_or_b32 v74, v67, 2, v74
    v_lshrrev_b32 v75, 10, v68
    v_lshl_or_b32 v75, v69, 10, v75

    v_ffbl_b32 v84, v71
    v_mul_u32_u24 v72, 5, v84
    v_lshrrev_b64 v[72:73], v72, v[74:75]
    v_and_or_b32 v72, v72, s66, v85
    ds_add_rtn_u32 v87, v72, v10
    ds_wrxchg_rtn_b32 v116, v86, v13
    v_and_b32 v117, 15, v71
    v_bcnt_u32_b32 v118, v117, 0
    v_cmp_eq_u32 vcc, 4, v118

    buffer_load_dwordx4 v[188:191], v9, s[28:31], s77 offen offset:3072

    v_cndmask_b32 v119, v71, v117, vcc
    s_waitcnt lgkmcnt(0)
    v_cmp_gt_u32 s[68:69], 2, v116
    v_cmp_gt_u32 s[70:71], 2, v87

    v_lshl_or_b32 v78, v81, 16, v80
    v_lshl_or_b32 v79, v83, 16, v82
    buffer_store_dwordx2 v[78:79], v30, s[32:35], s62 offen sc1
    s_add_u32 s62, s62, 65536
    v_lshrrev_b64 v[76:77], v123, s[68:69]
    v_perm_b32 v121, v76, v76, v5
    v_perm_b32 v122, v76, v76, v4
    v_perm_b32 v77, v76, v76, v3
    v_and_b32 v121, v121, v21
    v_and_b32 v122, v122, v20
    v_and_b32 v77, v77, v19
    v_msad_u8 v120, v28, v121, 0
    v_lshlrev_b32 v120, 4, v120
    v_msad_u8 v120, v27, v122, v120
    v_lshlrev_b32 v120, 4, v120
    v_msad_u8 v120, v26, v77, v120

    v_and_b32 v120, v120, v119
    v_cmp_eq_u32 vcc, 0, v120
    v_ffbl_b32 v118, v120
    s_or_b64 vcc, vcc, s[70:71]
    v_cndmask_b32 v118, v118, v84, vcc
    v_lshlrev_b32 v72, v118, v10
    v_lshl_add_u32 v73, v118, 1, v31
    v_xor_b32 v71, v71, v72

    ds_read_u16 v80, v73 offset:24

    v_ffbl_b32 v84, v71
    v_mul_u32_u24 v72, 5, v84
    v_lshrrev_b64 v[72:73], v72, v[74:75]
    v_and_or_b32 v72, v72, s66, v85
    ds_add_rtn_u32 v87, v72, v10
    ds_wrxchg_rtn_b32 v116, v86, v13
    v_and_b32 v117, 15, v71
    v_bcnt_u32_b32 v118, v117, 0
    v_cmp_eq_u32 vcc, 3, v118

    s_nop 1

    v_cndmask_b32 v119, v71, v117, vcc
    s_waitcnt lgkmcnt(0)
    v_cmp_gt_u32 s[68:69], 2, v116
    v_cmp_gt_u32 s[70:71], 2, v87

    s_nop 0
    v_lshrrev_b64 v[76:77], v123, s[68:69]
    v_perm_b32 v121, v76, v76, v5
    v_perm_b32 v122, v76, v76, v4
    v_perm_b32 v77, v76, v76, v3
    v_and_b32 v121, v121, v21
    v_and_b32 v122, v122, v20
    v_and_b32 v77, v77, v19
    v_msad_u8 v120, v28, v121, 0
    v_lshlrev_b32 v120, 4, v120
    v_msad_u8 v120, v27, v122, v120
    v_lshlrev_b32 v120, 4, v120
    v_msad_u8 v120, v26, v77, v120

    v_and_b32 v120, v120, v119
    v_cmp_eq_u32 vcc, 0, v120
    v_ffbl_b32 v118, v120
    s_or_b64 vcc, vcc, s[70:71]
    v_cndmask_b32 v118, v118, v84, vcc
    v_lshlrev_b32 v72, v118, v10
    v_lshl_add_u32 v73, v118, 1, v31
    v_xor_b32 v71, v71, v72

    ds_read_u16 v81, v73 offset:24

    v_ffbl_b32 v84, v71
    v_mul_u32_u24 v72, 5, v84
    v_lshrrev_b64 v[72:73], v72, v[74:75]
    v_and_or_b32 v72, v72, s66, v85
    ds_add_rtn_u32 v87, v72, v10
    ds_wrxchg_rtn_b32 v116, v86, v13
    v_and_b32 v117, 15, v71
    v_bcnt_u32_b32 v118, v117, 0
    v_cmp_eq_u32 vcc, 2, v118

    s_nop 1

    v_cndmask_b32 v119, v71, v117, vcc
    s_waitcnt lgkmcnt(0)
    v_cmp_gt_u32 s[68:69], 2, v116
    v_cmp_gt_u32 s[70:71], 2, v87

    s_nop 0
    v_lshrrev_b64 v[76:77], v123, s[68:69]
    v_perm_b32 v121, v76, v76, v5
    v_perm_b32 v122, v76, v76, v4
    v_perm_b32 v77, v76, v76, v3
    v_and_b32 v121, v121, v21
    v_and_b32 v122, v122, v20
    v_and_b32 v77, v77, v19
    v_msad_u8 v120, v28, v121, 0
    v_lshlrev_b32 v120, 4, v120
    v_msad_u8 v120, v27, v122, v120
    v_lshlrev_b32 v120, 4, v120
    v_msad_u8 v120, v26, v77, v120

    v_and_b32 v120, v120, v119
    v_cmp_eq_u32 vcc, 0, v120
    v_ffbl_b32 v118, v120
    s_or_b64 vcc, vcc, s[70:71]
    v_cndmask_b32 v118, v118, v84, vcc
    v_lshlrev_b32 v72, v118, v10
    v_lshl_add_u32 v73, v118, 1, v31
    v_xor_b32 v71, v71, v72

    ds_read_u16 v82, v73 offset:24

    v_ffbl_b32 v84, v71
    v_mul_u32_u24 v72, 5, v84
    v_lshrrev_b64 v[72:73], v72, v[74:75]
    v_and_or_b32 v72, v72, s66, v85
    ds_add_rtn_u32 v87, v72, v10
    ds_wrxchg_rtn_b32 v116, v86, v13
    v_and_b32 v117, 15, v71
    v_bcnt_u32_b32 v118, v117, 0
    v_cmp_eq_u32 vcc, 1, v118

    s_nop 1

    v_cndmask_b32 v119, v71, v117, vcc
    s_waitcnt lgkmcnt(0)
    v_cmp_gt_u32 s[68:69], 2, v116
    v_cmp_gt_u32 s[70:71], 2, v87

    s_nop 0
    v_lshrrev_b64 v[76:77], v123, s[68:69]
    v_perm_b32 v121, v76, v76, v5
    v_perm_b32 v122, v76, v76, v4
    v_perm_b32 v77, v76, v76, v3
    v_and_b32 v121, v121, v21
    v_and_b32 v122, v122, v20
    v_and_b32 v77, v77, v19
    v_msad_u8 v120, v28, v121, 0
    v_lshlrev_b32 v120, 4, v120
    v_msad_u8 v120, v27, v122, v120
    v_lshlrev_b32 v120, 4, v120
    v_msad_u8 v120, v26, v77, v120

    v_and_b32 v120, v120, v119
    v_cmp_eq_u32 vcc, 0, v120
    v_ffbl_b32 v118, v120
    s_or_b64 vcc, vcc, s[70:71]
    v_cndmask_b32 v118, v118, v84, vcc
    v_lshlrev_b32 v72, v118, v10
    v_lshl_add_u32 v73, v118, 1, v31
    v_xor_b32 v71, v71, v72

    ds_read_u16 v83, v73 offset:24
    v_lshrrev_b32 v71, 4, v71
    v_or_b32 v71, s63, v71
    v_lshlrev_b32 v74, 22, v69
    v_lshl_or_b32 v74, v68, 2, v74
    v_lshrrev_b32 v75, 10, v69
    v_lshl_or_b32 v75, v70, 10, v75
    s_setprio 3

    s_cmp_ge_u32 s57, 800
    s_cbranch_scc1 k1_kernel_norl
    s_waitcnt vmcnt(0)

    v_perm_b32 v192, v132, v128, s84
    v_perm_b32 v193, v140, v136, s84
    v_perm_b32 v194, v148, v144, s84
    v_perm_b32 v195, v156, v152, s84
    v_perm_b32 v196, v132, v128, s85
    v_perm_b32 v197, v140, v136, s85
    v_perm_b32 v198, v148, v144, s85
    v_perm_b32 v199, v156, v152, s85
    v_perm_b32 v200, v133, v129, s84
    v_perm_b32 v201, v141, v137, s84
    v_perm_b32 v202, v149, v145, s84
    v_perm_b32 v203, v157, v153, s84
    v_perm_b32 v204, v133, v129, s85
    v_perm_b32 v205, v141, v137, s85
    v_perm_b32 v206, v149, v145, s85
    v_perm_b32 v207, v157, v153, s85
    ds_write_b128 v36, v[192:195]
    ds_write_b128 v37, v[196:199]
    ds_write_b128 v38, v[200:203]
    ds_write_b128 v39, v[204:207]
    ds_read_b128 v[224:227], v15 offset:0
    ds_read_b128 v[228:231], v15 offset:1024
    ds_read_b128 v[232:235], v15 offset:2048
    ds_read_b128 v[236:239], v15 offset:3072
    v_perm_b32 v208, v164, v160, s84
    v_perm_b32 v209, v172, v168, s84
    v_perm_b32 v210, v180, v176, s84
    v_perm_b32 v211, v188, v184, s84
    v_perm_b32 v212, v164, v160, s85
    v_perm_b32 v213, v172, v168, s85
    v_perm_b32 v214, v180, v176, s85
    v_perm_b32 v215, v188, v184, s85
    v_perm_b32 v216, v165, v161, s84
    v_perm_b32 v217, v173, v169, s84
    v_perm_b32 v218, v181, v177, s84
    v_perm_b32 v219, v189, v185, s84
    v_perm_b32 v220, v165, v161, s85
    v_perm_b32 v221, v173, v169, s85
    v_perm_b32 v222, v181, v177, s85
    v_perm_b32 v223, v189, v185, s85
    s_waitcnt lgkmcnt(0)
    s_add_u32 s83, s82, 0
    buffer_store_dwordx4 v[224:227], v14, s[32:35], s83 offen sc1
    s_add_u32 s83, s82, 3284992
    buffer_store_dwordx4 v[228:231], v14, s[32:35], s83 offen sc1
    s_add_u32 s83, s82, 6569984
    buffer_store_dwordx4 v[232:235], v14, s[32:35], s83 offen sc1
    s_add_u32 s83, s82, 9854976
    buffer_store_dwordx4 v[236:239], v14, s[32:35], s83 offen sc1
    ds_write_b128 v36, v[208:211]
    ds_write_b128 v37, v[212:215]
    ds_write_b128 v38, v[216:219]
    ds_write_b128 v39, v[220:223]
    ds_read_b128 v[240:243], v15 offset:0
    ds_read_b128 v[244:247], v15 offset:1024
    ds_read_b128 v[248:251], v15 offset:2048
    ds_read_b128 v[252:255], v15 offset:3072
    v_perm_b32 v192, v134, v130, s84
    v_perm_b32 v193, v142, v138, s84
    v_perm_b32 v194, v150, v146, s84
    v_perm_b32 v195, v158, v154, s84
    v_perm_b32 v196, v134, v130, s85
    v_perm_b32 v197, v142, v138, s85
    v_perm_b32 v198, v150, v146, s85
    v_perm_b32 v199, v158, v154, s85
    v_perm_b32 v200, v135, v131, s84
    v_perm_b32 v201, v143, v139, s84
    v_perm_b32 v202, v151, v147, s84
    v_perm_b32 v203, v159, v155, s84
    v_perm_b32 v204, v135, v131, s85
    v_perm_b32 v205, v143, v139, s85
    v_perm_b32 v206, v151, v147, s85
    v_perm_b32 v207, v159, v155, s85
    s_waitcnt lgkmcnt(0)
    s_add_u32 s83, s82, 64
    buffer_store_dwordx4 v[240:243], v14, s[32:35], s83 offen sc1
    s_add_u32 s83, s82, 3285056
    buffer_store_dwordx4 v[244:247], v14, s[32:35], s83 offen sc1
    s_add_u32 s83, s82, 6570048
    buffer_store_dwordx4 v[248:251], v14, s[32:35], s83 offen sc1
    s_add_u32 s83, s82, 9855040
    buffer_store_dwordx4 v[252:255], v14, s[32:35], s83 offen sc1
    ds_write_b128 v36, v[192:195]
    ds_write_b128 v37, v[196:199]
    ds_write_b128 v38, v[200:203]
    ds_write_b128 v39, v[204:207]
    ds_read_b128 v[224:227], v15 offset:0
    ds_read_b128 v[228:231], v15 offset:1024
    ds_read_b128 v[232:235], v15 offset:2048
    ds_read_b128 v[236:239], v15 offset:3072
    v_perm_b32 v208, v166, v162, s84
    v_perm_b32 v209, v174, v170, s84
    v_perm_b32 v210, v182, v178, s84
    v_perm_b32 v211, v190, v186, s84
    v_perm_b32 v212, v166, v162, s85
    v_perm_b32 v213, v174, v170, s85
    v_perm_b32 v214, v182, v178, s85
    v_perm_b32 v215, v190, v186, s85
    v_perm_b32 v216, v167, v163, s84
    v_perm_b32 v217, v175, v171, s84
    v_perm_b32 v218, v183, v179, s84
    v_perm_b32 v219, v191, v187, s84
    v_perm_b32 v220, v167, v163, s85
    v_perm_b32 v221, v175, v171, s85
    v_perm_b32 v222, v183, v179, s85
    v_perm_b32 v223, v191, v187, s85
    s_waitcnt lgkmcnt(0)
    s_add_u32 s83, s82, 102656
    buffer_store_dwordx4 v[224:227], v14, s[32:35], s83 offen sc1
    s_add_u32 s83, s82, 3387648
    buffer_store_dwordx4 v[228:231], v14, s[32:35], s83 offen sc1
    s_add_u32 s83, s82, 6672640
    buffer_store_dwordx4 v[232:235], v14, s[32:35], s83 offen sc1
    s_add_u32 s83, s82, 9957632
    buffer_store_dwordx4 v[236:239], v14, s[32:35], s83 offen sc1
    ds_write_b128 v36, v[208:211]
    ds_write_b128 v37, v[212:215]
    ds_write_b128 v38, v[216:219]
    ds_write_b128 v39, v[220:223]
    ds_read_b128 v[240:243], v15 offset:0
    ds_read_b128 v[244:247], v15 offset:1024
    ds_read_b128 v[248:251], v15 offset:2048
    ds_read_b128 v[252:255], v15 offset:3072
    ds_write_b64 v31, v[40:41] offset:0
    ds_write_b64 v31, v[42:43] offset:8
    ds_write_b64 v31, v[44:45] offset:16
    ds_write_b64 v31, v[46:47] offset:24
    ds_write_b64 v31, v[48:49] offset:32
    ds_write_b64 v31, v[50:51] offset:40
    ds_write_b64 v31, v[52:53] offset:48
    s_waitcnt lgkmcnt(7)
    s_add_u32 s83, s82, 102720
    buffer_store_dwordx4 v[240:243], v14, s[32:35], s83 offen sc1
    s_add_u32 s83, s82, 3387712
    buffer_store_dwordx4 v[244:247], v14, s[32:35], s83 offen sc1
    s_add_u32 s83, s82, 6672704
    buffer_store_dwordx4 v[248:251], v14, s[32:35], s83 offen sc1
    s_add_u32 s83, s82, 9957696
    buffer_store_dwordx4 v[252:255], v14, s[32:35], s83 offen sc1
k1_kernel_norl:
k1_kernel_rld:
    ds_write_b32 v86, v13
    s_setprio 0

    v_ffbl_b32 v84, v71
    v_mul_u32_u24 v72, 5, v84
    v_lshrrev_b64 v[72:73], v72, v[74:75]
    v_and_or_b32 v72, v72, s66, v85
    ds_add_rtn_u32 v87, v72, v10
    ds_wrxchg_rtn_b32 v116, v86, v13
    v_and_b32 v117, 15, v71
    v_bcnt_u32_b32 v118, v117, 0
    v_cmp_eq_u32 vcc, 4, v118

    s_add_u32 s47, s44, 0
    buffer_load_dwordx4 v[32:35], v7, s[20:23], s47 offen offset:0
    buffer_load_dwordx4 v[36:39], v7, s[20:23], s47 offen offset:64
    s_add_u32 s47, s44, 4096
    buffer_load_dwordx4 v[40:43], v7, s[20:23], s47 offen offset:0
    buffer_load_dwordx4 v[44:47], v7, s[20:23], s47 offen offset:64
    s_add_u32 s47, s44, 8192
    buffer_load_dwordx4 v[48:51], v7, s[20:23], s47 offen offset:0
    buffer_load_dwordx4 v[52:55], v7, s[20:23], s47 offen offset:64

    v_cndmask_b32 v119, v71, v117, vcc
    s_waitcnt lgkmcnt(0)
    v_cmp_gt_u32 s[68:69], 2, v116
    v_cmp_gt_u32 s[70:71], 2, v87

    v_lshl_or_b32 v78, v81, 16, v80
    v_lshl_or_b32 v79, v83, 16, v82
    buffer_store_dwordx2 v[78:79], v30, s[32:35], s62 offen sc1
    s_add_u32 s62, s62, 65536
    v_lshrrev_b64 v[76:77], v123, s[68:69]
    v_perm_b32 v121, v76, v76, v6
    v_perm_b32 v122, v76, v76, v5
    v_perm_b32 v77, v76, v76, v4
    v_and_b32 v121, v121, v22
    v_and_b32 v122, v122, v21
    v_and_b32 v77, v77, v20
    v_msad_u8 v120, v29, v121, 0
    v_lshlrev_b32 v120, 4, v120
    v_msad_u8 v120, v28, v122, v120
    v_lshlrev_b32 v120, 4, v120
    v_msad_u8 v120, v27, v77, v120

    v_and_b32 v120, v120, v119
    v_cmp_eq_u32 vcc, 0, v120
    v_ffbl_b32 v118, v120
    s_or_b64 vcc, vcc, s[70:71]
    v_cndmask_b32 v118, v118, v84, vcc
    v_lshlrev_b32 v72, v118, v10
    v_lshl_add_u32 v73, v118, 1, v31
    v_xor_b32 v71, v71, v72

    ds_read_u16 v80, v73 offset:32

    v_ffbl_b32 v84, v71
    v_mul_u32_u24 v72, 5, v84
    v_lshrrev_b64 v[72:73], v72, v[74:75]
    v_and_or_b32 v72, v72, s66, v85
    ds_add_rtn_u32 v87, v72, v10
    ds_wrxchg_rtn_b32 v116, v86, v13
    v_and_b32 v117, 15, v71
    v_bcnt_u32_b32 v118, v117, 0
    v_cmp_eq_u32 vcc, 3, v118

    s_add_u32 s47, s44, 131072
    buffer_load_dwordx4 v[136:139], v7, s[20:23], s47 offen offset:0
    buffer_load_dwordx4 v[140:143], v7, s[20:23], s47 offen offset:64
    s_add_u32 s47, s44, 135168
    buffer_load_dwordx4 v[152:155], v7, s[20:23], s47 offen offset:0
    buffer_load_dwordx4 v[156:159], v7, s[20:23], s47 offen offset:64
    s_add_u32 s47, s44, 139264
    buffer_load_dwordx4 v[168:171], v7, s[20:23], s47 offen offset:0
    buffer_load_dwordx4 v[172:175], v7, s[20:23], s47 offen offset:64

    v_cndmask_b32 v119, v71, v117, vcc
    s_waitcnt lgkmcnt(0)
    v_cmp_gt_u32 s[68:69], 2, v116
    v_cmp_gt_u32 s[70:71], 2, v87

    s_nop 0
    v_lshrrev_b64 v[76:77], v123, s[68:69]
    v_perm_b32 v121, v76, v76, v6
    v_perm_b32 v122, v76, v76, v5
    v_perm_b32 v77, v76, v76, v4
    v_and_b32 v121, v121, v22
    v_and_b32 v122, v122, v21
    v_and_b32 v77, v77, v20
    v_msad_u8 v120, v29, v121, 0
    v_lshlrev_b32 v120, 4, v120
    v_msad_u8 v120, v28, v122, v120
    v_lshlrev_b32 v120, 4, v120
    v_msad_u8 v120, v27, v77, v120

    v_and_b32 v120, v120, v119
    v_cmp_eq_u32 vcc, 0, v120
    v_ffbl_b32 v118, v120
    s_or_b64 vcc, vcc, s[70:71]
    v_cndmask_b32 v118, v118, v84, vcc
    v_lshlrev_b32 v72, v118, v10
    v_lshl_add_u32 v73, v118, 1, v31
    v_xor_b32 v71, v71, v72

    ds_read_u16 v81, v73 offset:32

    v_ffbl_b32 v84, v71
    v_mul_u32_u24 v72, 5, v84
    v_lshrrev_b64 v[72:73], v72, v[74:75]
    v_and_or_b32 v72, v72, s66, v85
    ds_add_rtn_u32 v87, v72, v10
    ds_wrxchg_rtn_b32 v116, v86, v13
    v_and_b32 v117, 15, v71
    v_bcnt_u32_b32 v118, v117, 0
    v_cmp_eq_u32 vcc, 2, v118

    s_add_u32 s47, s44, 143360
    buffer_load_dwordx4 v[184:187], v7, s[20:23], s47 offen offset:0
    buffer_load_dwordx4 v[188:191], v7, s[20:23], s47 offen offset:64
    s_add_u32 s47, s44, 147456
    buffer_load_dwordx4 v[200:203], v7, s[20:23], s47 offen offset:0
    buffer_load_dwordx4 v[204:207], v7, s[20:23], s47 offen offset:64
    s_add_u32 s47, s44, 151552
    buffer_load_dwordx4 v[216:219], v7, s[20:23], s47 offen offset:0
    buffer_load_dwordx4 v[220:223], v7, s[20:23], s47 offen offset:64

    v_cndmask_b32 v119, v71, v117, vcc
    s_waitcnt lgkmcnt(0)
    v_cmp_gt_u32 s[68:69], 2, v116
    v_cmp_gt_u32 s[70:71], 2, v87

    s_nop 0
    v_lshrrev_b64 v[76:77], v123, s[68:69]
    v_perm_b32 v121, v76, v76, v6
    v_perm_b32 v122, v76, v76, v5
    v_perm_b32 v77, v76, v76, v4
    v_and_b32 v121, v121, v22
    v_and_b32 v122, v122, v21
    v_and_b32 v77, v77, v20
    v_msad_u8 v120, v29, v121, 0
    v_lshlrev_b32 v120, 4, v120
    v_msad_u8 v120, v28, v122, v120
    v_lshlrev_b32 v120, 4, v120
    v_msad_u8 v120, v27, v77, v120

    v_and_b32 v120, v120, v119
    v_cmp_eq_u32 vcc, 0, v120
    v_ffbl_b32 v118, v120
    s_or_b64 vcc, vcc, s[70:71]
    v_cndmask_b32 v118, v118, v84, vcc
    v_lshlrev_b32 v72, v118, v10
    v_lshl_add_u32 v73, v118, 1, v31
    v_xor_b32 v71, v71, v72

    ds_read_u16 v82, v73 offset:32

    v_ffbl_b32 v84, v71
    v_mul_u32_u24 v72, 5, v84
    v_lshrrev_b64 v[72:73], v72, v[74:75]
    v_and_or_b32 v72, v72, s66, v85
    ds_add_rtn_u32 v87, v72, v10
    ds_wrxchg_rtn_b32 v116, v86, v13
    v_and_b32 v117, 15, v71
    v_bcnt_u32_b32 v118, v117, 0
    v_cmp_eq_u32 vcc, 1, v118

    s_add_u32 s47, s44, 155648
    buffer_load_dwordx4 v[232:235], v7, s[20:23], s47 offen offset:0
    buffer_load_dwordx4 v[236:239], v7, s[20:23], s47 offen offset:64
    s_add_u32 s47, s44, 159744
    buffer_load_dwordx4 v[248:251], v7, s[20:23], s47 offen offset:0
    buffer_load_dwordx4 v[252:255], v7, s[20:23], s47 offen offset:64

    v_cndmask_b32 v119, v71, v117, vcc
    s_waitcnt lgkmcnt(0)
    v_cmp_gt_u32 s[68:69], 2, v116
    v_cmp_gt_u32 s[70:71], 2, v87

    s_nop 0
    v_lshrrev_b64 v[76:77], v123, s[68:69]
    v_perm_b32 v121, v76, v76, v6
    v_perm_b32 v122, v76, v76, v5
    v_perm_b32 v77, v76, v76, v4
    v_and_b32 v121, v121, v22
    v_and_b32 v122, v122, v21
    v_and_b32 v77, v77, v20
    v_msad_u8 v120, v29, v121, 0
    v_lshlrev_b32 v120, 4, v120
    v_msad_u8 v120, v28, v122, v120
    v_lshlrev_b32 v120, 4, v120
    v_msad_u8 v120, v27, v77, v120

    v_and_b32 v120, v120, v119
    v_cmp_eq_u32 vcc, 0, v120
    v_ffbl_b32 v118, v120
    s_or_b64 vcc, vcc, s[70:71]
    v_cndmask_b32 v118, v118, v84, vcc
    v_lshlrev_b32 v72, v118, v10
    v_lshl_add_u32 v73, v118, 1, v31
    v_xor_b32 v71, v71, v72

    ds_read_u16 v83, v73 offset:32
    s_cmp_lg_u32 s59, 3
    s_cbranch_scc1 k1_kernel_sdone
    v_lshrrev_b32 v71, 4, v71
    v_lshlrev_b32 v74, 22, v70
    v_lshl_or_b32 v74, v69, 2, v74
    v_lshrrev_b32 v75, 10, v70
    s_setprio 3

    v_ffbl_b32 v84, v71
    v_mul_u32_u24 v72, 5, v84
    v_lshrrev_b64 v[72:73], v72, v[74:75]
    v_and_or_b32 v72, v72, s66, v85
    ds_add_rtn_u32 v87, v72, v10
    ds_wrxchg_rtn_b32 v116, v86, v13
    v_and_b32 v117, 15, v71
    v_bcnt_u32_b32 v118, v117, 0
    v_cmp_eq_u32 vcc, 4, v118

    s_nop 1

    v_cndmask_b32 v119, v71, v117, vcc
    s_waitcnt lgkmcnt(0)
    v_cmp_gt_u32 s[68:69], 2, v116
    v_cmp_gt_u32 s[70:71], 2, v87

    v_lshl_or_b32 v78, v81, 16, v80
    v_lshl_or_b32 v79, v83, 16, v82
    buffer_store_dwordx2 v[78:79], v30, s[32:35], s62 offen sc1
    s_add_u32 s62, s62, 65536
    v_lshrrev_b64 v[76:77], v123, s[68:69]
    v_perm_b32 v121, v76, v76, v6
    v_perm_b32 v122, v76, v76, v5
    v_and_b32 v121, v121, v22
    v_and_b32 v122, v122, v21
    v_msad_u8 v120, v29, v121, 0
    v_lshlrev_b32 v120, 4, v120
    v_msad_u8 v120, v28, v122, v120

    v_and_b32 v120, v120, v119
    v_cmp_eq_u32 vcc, 0, v120
    v_ffbl_b32 v118, v120
    s_or_b64 vcc, vcc, s[70:71]
    v_cndmask_b32 v118, v118, v84, vcc
    v_lshlrev_b32 v72, v118, v10
    v_lshl_add_u32 v73, v118, 1, v31
    v_xor_b32 v71, v71, v72

    ds_read_u16 v80, v73 offset:40

    v_ffbl_b32 v84, v71
    v_mul_u32_u24 v72, 5, v84
    v_lshrrev_b64 v[72:73], v72, v[74:75]
    v_and_or_b32 v72, v72, s66, v85
    ds_add_rtn_u32 v87, v72, v10
    ds_wrxchg_rtn_b32 v116, v86, v13
    v_and_b32 v117, 15, v71
    v_bcnt_u32_b32 v118, v117, 0
    v_cmp_eq_u32 vcc, 3, v118

    s_nop 1

    v_cndmask_b32 v119, v71, v117, vcc
    s_waitcnt lgkmcnt(0)
    v_cmp_gt_u32 s[68:69], 2, v116
    v_cmp_gt_u32 s[70:71], 2, v87

    s_nop 0
    v_lshrrev_b64 v[76:77], v123, s[68:69]
    v_perm_b32 v121, v76, v76, v6
    v_perm_b32 v122, v76, v76, v5
    v_and_b32 v121, v121, v22
    v_and_b32 v122, v122, v21
    v_msad_u8 v120, v29, v121, 0
    v_lshlrev_b32 v120, 4, v120
    v_msad_u8 v120, v28, v122, v120

    v_and_b32 v120, v120, v119
    v_cmp_eq_u32 vcc, 0, v120
    v_ffbl_b32 v118, v120
    s_or_b64 vcc, vcc, s[70:71]
    v_cndmask_b32 v118, v118, v84, vcc
    v_lshlrev_b32 v72, v118, v10
    v_lshl_add_u32 v73, v118, 1, v31
    v_xor_b32 v71, v71, v72

    ds_read_u16 v81, v73 offset:40

    v_ffbl_b32 v84, v71
    v_mul_u32_u24 v72, 5, v84
    v_lshrrev_b64 v[72:73], v72, v[74:75]
    v_and_or_b32 v72, v72, s66, v85
    ds_add_rtn_u32 v87, v72, v10
    ds_wrxchg_rtn_b32 v116, v86, v13
    v_and_b32 v117, 15, v71
    v_bcnt_u32_b32 v118, v117, 0
    v_cmp_eq_u32 vcc, 2, v118

    s_nop 1

    v_cndmask_b32 v119, v71, v117, vcc
    s_waitcnt lgkmcnt(0)
    v_cmp_gt_u32 s[68:69], 2, v116
    v_cmp_gt_u32 s[70:71], 2, v87

    s_nop 0
    v_lshrrev_b64 v[76:77], v123, s[68:69]
    v_perm_b32 v121, v76, v76, v6
    v_perm_b32 v122, v76, v76, v5
    v_and_b32 v121, v121, v22
    v_and_b32 v122, v122, v21
    v_msad_u8 v120, v29, v121, 0
    v_lshlrev_b32 v120, 4, v120
    v_msad_u8 v120, v28, v122, v120

    v_and_b32 v120, v120, v119
    v_cmp_eq_u32 vcc, 0, v120
    v_ffbl_b32 v118, v120
    s_or_b64 vcc, vcc, s[70:71]
    v_cndmask_b32 v118, v118, v84, vcc
    v_lshlrev_b32 v72, v118, v10
    v_lshl_add_u32 v73, v118, 1, v31
    v_xor_b32 v71, v71, v72

    ds_read_u16 v82, v73 offset:40

    v_ffbl_b32 v84, v71
    v_mul_u32_u24 v72, 5, v84
    v_lshrrev_b64 v[72:73], v72, v[74:75]
    v_and_or_b32 v72, v72, s66, v85
    ds_add_rtn_u32 v87, v72, v10
    ds_wrxchg_rtn_b32 v116, v86, v13
    v_and_b32 v117, 15, v71
    v_bcnt_u32_b32 v118, v117, 0
    v_cmp_eq_u32 vcc, 1, v118

    s_nop 1

    v_cndmask_b32 v119, v71, v117, vcc
    s_waitcnt lgkmcnt(0)
    v_cmp_gt_u32 s[68:69], 2, v116
    v_cmp_gt_u32 s[70:71], 2, v87

    s_nop 0
    v_lshrrev_b64 v[76:77], v123, s[68:69]
    v_perm_b32 v121, v76, v76, v6
    v_perm_b32 v122, v76, v76, v5
    v_and_b32 v121, v121, v22
    v_and_b32 v122, v122, v21
    v_msad_u8 v120, v29, v121, 0
    v_lshlrev_b32 v120, 4, v120
    v_msad_u8 v120, v28, v122, v120

    v_and_b32 v120, v120, v119
    v_cmp_eq_u32 vcc, 0, v120
    v_ffbl_b32 v118, v120
    s_or_b64 vcc, vcc, s[70:71]
    v_cndmask_b32 v118, v118, v84, vcc
    v_lshlrev_b32 v72, v118, v10
    v_lshl_add_u32 v73, v118, 1, v31
    v_xor_b32 v71, v71, v72

    ds_read_u16 v83, v73 offset:40
k1_kernel_sdone:
    s_waitcnt lgkmcnt(0)
    v_lshl_or_b32 v78, v81, 16, v80
    v_lshl_or_b32 v79, v83, 16, v82
    buffer_store_dwordx2 v[78:79], v30, s[32:35], s62 offen sc1
    s_add_u32 s62, s62, 65536
k1_kernel_udone:
    s_setprio 0

    s_mov_b64 exec, 1
    ds_add_rtn_u32 v12, v11, v10 offset:28
    s_waitcnt lgkmcnt(0)
    v_readfirstlane_b32 s45, v12
    s_cmp_ge_u32 s45, 2
    s_cbranch_scc1 k1_kernel_ncl
    s_mov_b64 exec, -1
    s_mul_i32 s45, s45, 16384
    s_min_u32 s45, s45, 16384
    s_lshl_b32 s72, s2, 15
    s_add_u32 s72, s72, s45
    s_add_u32 s72, s72, 20971520
    v_mov_b32 v192, -1
    v_mov_b32 v193, -1
    v_mov_b32 v194, -1
    v_mov_b32 v195, -1
    buffer_store_dwordx4 v[192:195], v9, s[12:15], s72 offen offset:0 sc1
    buffer_store_dwordx4 v[192:195], v9, s[12:15], s72 offen offset:1024 sc1
    buffer_store_dwordx4 v[192:195], v9, s[12:15], s72 offen offset:2048 sc1
    buffer_store_dwordx4 v[192:195], v9, s[12:15], s72 offen offset:3072 sc1
    s_add_u32 s72, s72, 4096
    buffer_store_dwordx4 v[192:195], v9, s[12:15], s72 offen offset:0 sc1
    buffer_store_dwordx4 v[192:195], v9, s[12:15], s72 offen offset:1024 sc1
    buffer_store_dwordx4 v[192:195], v9, s[12:15], s72 offen offset:2048 sc1
    buffer_store_dwordx4 v[192:195], v9, s[12:15], s72 offen offset:3072 sc1
    s_add_u32 s72, s72, 4096
    buffer_store_dwordx4 v[192:195], v9, s[12:15], s72 offen offset:0 sc1
    buffer_store_dwordx4 v[192:195], v9, s[12:15], s72 offen offset:1024 sc1
    buffer_store_dwordx4 v[192:195], v9, s[12:15], s72 offen offset:2048 sc1
    buffer_store_dwordx4 v[192:195], v9, s[12:15], s72 offen offset:3072 sc1
    s_add_u32 s72, s72, 4096
    buffer_store_dwordx4 v[192:195], v9, s[12:15], s72 offen offset:0 sc1
    buffer_store_dwordx4 v[192:195], v9, s[12:15], s72 offen offset:1024 sc1
    buffer_store_dwordx4 v[192:195], v9, s[12:15], s72 offen offset:2048 sc1
    buffer_store_dwordx4 v[192:195], v9, s[12:15], s72 offen offset:3072 sc1
    s_add_u32 s72, s72, 4096
k1_kernel_ncl:

    s_waitcnt vmcnt(0)

    s_mov_b64 exec, 1
    ds_add_rtn_u32 v12, v11, v10 offset:20
    v_mov_b32 v0, s51
    s_waitcnt lgkmcnt(0)
    v_readfirstlane_b32 s45, v12
    s_and_b32 s45, s45, 3
    s_cmp_eq_u32 s45, 3
    s_cbranch_scc0 k1_kernel_wdec
    s_movk_i32 s38, 0xff
    s_cmp_eq_u32 s64, 0
    s_cselect_b32 exec_lo, 0xffff, s38
    s_lshr_b32 s38, s51, 5
    s_lshl_b32 s39, 1, s51

    v_and_b32 v2, 7, v8
    v_cmp_eq_u32 vcc, s38, v2
    v_mov_b32 v2, s39
    v_lshlrev_b32 v0, 2, v8
    v_cndmask_b32 v2, 0, v2, vcc
    v_mov_b32 v1, v2
    buffer_atomic_or v1, v0, s[52:55], 0 offen sc0
    s_lshl_b32 s45, s2, 8
    s_add_u32 s45, s45, 14680064
    s_mov_b64 exec, 0xff
    s_waitcnt vmcnt(0)
    v_or_b32 v1, v1, v2
    v_cmp_ne_u32 vcc, -1, v1
    s_cbranch_vccnz k1_kernel_poll0
    s_mov_b64 exec, -1
    v_lshlrev_b32 v0, 8, v8
    s_mov_b32 s38, 14680064

    buffer_store_dword v10, v0, s[12:15], s38 offen sc1
    s_add_u32 s38, s38, 16384
    buffer_store_dword v10, v0, s[12:15], s38 offen sc1
    s_add_u32 s38, s38, 16384
    buffer_store_dword v10, v0, s[12:15], s38 offen sc1
    s_add_u32 s38, s38, 16384
    buffer_store_dword v10, v0, s[12:15], s38 offen sc1
    buffer_inv sc1
    s_waitcnt vmcnt(0)
    s_branch k1_kernel_go
k1_kernel_poll0:
    buffer_inv sc1
k1_kernel_poll:

    buffer_load_dword v1, v13, s[12:15], s45 offen sc1
    s_add_u32 s65, s65, 1
    s_waitcnt vmcnt(0)
    v_cmp_eq_u32 vcc, 1, v1
    s_cbranch_vccnz k1_kernel_go

    s_cmp_lt_u32 s65, 200
    s_cbranch_scc1 k1_kernel_poll
    buffer_load_dword v1, v0, s[52:55], 0 offen sc1
    s_waitcnt vmcnt(0)
    v_cmp_ne_u32 vcc, -1, v1
    s_cbranch_vccz k1_kernel_go
    s_ff1_i32_b64 s38, vcc
    s_nop 3
    v_readlane_b32 s39, v1, s38
    s_ff0_i32_b32 s39, s39
    s_lshl_b32 s38, s38, 5
    s_add_u32 s38, s38, s39
    s_andn2_b32 s39, s64, 255
    s_add_u32 s39, s39, 256
    s_or_b32 s38, s38, s39
    s_branch k1_kernel_dec

k1_kernel_go:

    s_mov_b32 s38, 0x80000000

k1_kernel_dec:

    v_mov_b32 v1, s38
    s_mov_b64 exec, 1
    ds_write_b32 v11, v1 offset:24

k1_kernel_wdec:

    s_mov_b64 exec, -1
    ds_read_b32 v12, v11 offset:24
    s_waitcnt lgkmcnt(0)
    v_readfirstlane_b32 s45, v12
    s_cmp_lg_u32 s45, s64
    s_cbranch_scc1 k1_kernel_gotd
    s_sleep 2
    s_branch k1_kernel_wdec

k1_kernel_gotd:

    s_mov_b32 s64, s45
    s_and_b32 s51, s45, 255
    s_mov_b32 s65, 0x10000
    s_bitcmp0_b32 s45, 31
    s_cbranch_scc1 k1_kernel_unit

k1_kernel_k2:

    s_setprio 0
    s_load_dwordx4 s[8:11], s[0:1], 32
    s_load_dwordx2 s[56:57], s[0:1], 48
    s_load_dwordx2 s[60:61], s[0:1], 56
    v_mbcnt_lo_u32_b32 v0, -1, 0
    v_mbcnt_hi_u32_b32 v0, -1, v0
    s_mul_i32 s35, s3, 18432
    v_and_b32 v1, 15, v0
    v_lshrrev_b32 v2, 4, v0
    v_mul_u32_u24 v71, 144, v1
    v_lshl_add_u32 v71, v2, 4, v71
    v_add_u32 v71, s35, v71

    ds_read_b128 v[128:131], v71 offset:0
    ds_read_b128 v[132:135], v71 offset:64
    ds_read_b128 v[144:147], v71 offset:2304
    ds_read_b128 v[148:151], v71 offset:2368
    ds_read_b128 v[160:163], v71 offset:4608
    ds_read_b128 v[164:167], v71 offset:4672
    ds_read_b128 v[176:179], v71 offset:6912
    ds_read_b128 v[180:183], v71 offset:6976
    ds_read_b128 v[192:195], v71 offset:9216
    ds_read_b128 v[196:199], v71 offset:9280
    ds_read_b128 v[208:211], v71 offset:11520
    ds_read_b128 v[212:215], v71 offset:11584
    ds_read_b128 v[224:227], v71 offset:13824
    ds_read_b128 v[228:231], v71 offset:13888
    ds_read_b128 v[240:243], v71 offset:16128
    ds_read_b128 v[244:247], v71 offset:16192

    s_lshr_b32 s33, s2, 1
    s_and_b32 s34, s2, 1
    s_mov_b32 s32, 0x8000
    v_lshlrev_b32 v69, 4, v0
    s_mul_i32 s21, s33, 102656
    s_lshl_b32 s35, s50, 11
    s_xor_b32 s19, s35, 2048
    s_add_u32 s19, s19, s21
    s_add_u32 s21, s21, s35
    s_mul_i32 s20, s34, 1638400
    s_add_u32 s20, s20, 16777216
    s_lshl_b32 s35, s3, 13
    s_add_u32 s20, s20, s35
    v_lshlrev_b32 v70, 13, v2
    v_lshl_add_u32 v70, v1, 3, v70
    s_lshl_b32 s35, s3, 10
    v_add_u32 v70, s35, v70
    v_lshrrev_b32 v4, 3, v0
    v_xor_b32 v4, v4, v2
    v_and_b32 v4, 1, v4
    v_bfe_u32 v5, v0, 2, 1
    v_lshl_or_b32 v4, v4, 1, v5
    v_mov_b32 v6, 0x3f80
    v_cmp_eq_u32 vcc, 0, v4
    s_nop 1
    v_cndmask_b32 v64, 0, v6, vcc
    v_cndmask_b32 v65, 0, v6, vcc
    v_cmp_eq_u32 vcc, 1, v4
    s_nop 1
    v_cndmask_b32 v66, 0, v6, vcc
    v_cndmask_b32 v67, 0, v6, vcc
    v_and_b32 v5, 3, v0
    v_mul_u32_u24 v68, 0x5555, v5

    s_cmp_lt_u32 s3, 4
    s_cbranch_scc1 k1_kernel_k2n
    buffer_load_dwordx4 v[0:3], v69, s[12:15], s21 offen offset:0
    buffer_load_dwordx4 v[4:7], v69, s[12:15], s21 offen offset:1024
    buffer_load_dwordx4 v[8:11], v69, s[12:15], s19 offen offset:0
    buffer_load_dwordx4 v[12:15], v69, s[12:15], s19 offen offset:1024
    s_add_u32 s21, s21, 4096
    s_add_u32 s19, s19, 4096
    buffer_load_dwordx4 v[16:19], v69, s[12:15], s21 offen offset:0
    buffer_load_dwordx4 v[20:23], v69, s[12:15], s21 offen offset:1024
    buffer_load_dwordx4 v[24:27], v69, s[12:15], s19 offen offset:0
    buffer_load_dwordx4 v[28:31], v69, s[12:15], s19 offen offset:1024
    s_add_u32 s21, s21, 4096
    s_add_u32 s19, s19, 4096
    s_mov_b32 s44, s21
    s_mov_b32 s45, s19
    s_add_u32 s21, s21, 4096
    s_add_u32 s19, s19, 4096
    buffer_load_dwordx4 v[72:75], v69, s[12:15], s21 offen offset:0
    buffer_load_dwordx4 v[76:79], v69, s[12:15], s21 offen offset:1024
    buffer_load_dwordx4 v[80:83], v69, s[12:15], s19 offen offset:0
    buffer_load_dwordx4 v[84:87], v69, s[12:15], s19 offen offset:1024
    s_add_u32 s21, s21, 4096
    s_add_u32 s19, s19, 4096
    buffer_load_dwordx4 v[116:119], v69, s[12:15], s20 offen offset:0 sc1
    buffer_load_dwordx4 v[120:123], v69, s[12:15], s20 offen offset:1024 sc1
k1_kernel_k2n:

    s_and_b32 s35, s3, 3
    s_lshl_b32 s35, s35, 14
    s_add_u32 s35, s35, 98304
    v_add_u32 v71, s35, v69
    s_lshl_b32 s35, s33, 3
    s_waitcnt lgkmcnt(0)
    s_add_u32 s8, s8, s35
    s_addc_u32 s9, s9, 0
    s_add_u32 s10, s10, s35
    s_addc_u32 s11, s11, 0
    s_barrier

    s_load_dwordx2 s[36:37], s[8:9], 0
    s_load_dwordx2 s[38:39], s[10:11], 0
    s_cmp_lt_u32 s3, 4
    s_cbranch_scc1 k1_kernel_k2m

    s_waitcnt vmcnt(10)
    ds_write_b128 v71, v[32:35] offset:0
    ds_write_b128 v71, v[36:39] offset:1024
    ds_write_b128 v71, v[40:43] offset:2048
    ds_write_b128 v71, v[44:47] offset:3072
    v_mfma_f32_16x16x32_bf16 v[32:35], v[0:3], v[128:131], 0
    v_mfma_f32_16x16x32_bf16 v[36:39], v[0:3], v[144:147], 0
    ds_write_b128 v71, v[48:51] offset:4096
    v_mfma_f32_16x16x32_bf16 v[40:43], v[0:3], v[160:163], 0
    v_mfma_f32_16x16x32_bf16 v[44:47], v[0:3], v[176:179], 0
    ds_write_b128 v71, v[52:55] offset:5120
    v_mfma_f32_16x16x32_bf16 v[32:35], v[4:7], v[132:135], v[32:35]
    v_mfma_f32_16x16x32_bf16 v[36:39], v[4:7], v[148:151], v[36:39]
    ds_write_b128 v71, v[56:59] offset:6144
    v_mfma_f32_16x16x32_bf16 v[40:43], v[4:7], v[164:167], v[40:43]
    v_mfma_f32_16x16x32_bf16 v[44:47], v[4:7], v[180:183], v[44:47]
    ds_write_b128 v71, v[60:63] offset:7168
    v_mfma_f32_16x16x32_bf16 v[32:35], v[8:11], v[136:139], v[32:35]
    v_mfma_f32_16x16x32_bf16 v[36:39], v[8:11], v[152:155], v[36:39]
    ds_write_b128 v71, v[88:91] offset:8192
    v_mfma_f32_16x16x32_bf16 v[40:43], v[8:11], v[168:171], v[40:43]
    v_mfma_f32_16x16x32_bf16 v[44:47], v[8:11], v[184:187], v[44:47]
    ds_write_b128 v71, v[92:95] offset:9216
    v_mfma_f32_16x16x32_bf16 v[32:35], v[12:15], v[140:143], v[32:35]
    v_mfma_f32_16x16x32_bf16 v[36:39], v[12:15], v[156:159], v[36:39]
    ds_write_b128 v71, v[96:99] offset:10240
    v_mfma_f32_16x16x32_bf16 v[40:43], v[12:15], v[172:175], v[40:43]
    v_mfma_f32_16x16x32_bf16 v[44:47], v[12:15], v[188:191], v[44:47]
    ds_write_b128 v71, v[100:103] offset:11264
    v_mfma_f32_16x16x32_bf16 v[48:51], v[0:3], v[192:195], 0
    v_mfma_f32_16x16x32_bf16 v[52:55], v[0:3], v[208:211], 0
    ds_write_b128 v71, v[104:107] offset:12288
    v_mfma_f32_16x16x32_bf16 v[56:59], v[0:3], v[224:227], 0
    v_mfma_f32_16x16x32_bf16 v[60:63], v[0:3], v[240:243], 0
    ds_write_b128 v71, v[108:111] offset:13312
    v_mfma_f32_16x16x32_bf16 v[48:51], v[4:7], v[196:199], v[48:51]
    v_mfma_f32_16x16x32_bf16 v[52:55], v[4:7], v[212:215], v[52:55]
    ds_write_b128 v71, v[112:115] offset:14336
    v_mfma_f32_16x16x32_bf16 v[56:59], v[4:7], v[228:231], v[56:59]
    v_mfma_f32_16x16x32_bf16 v[60:63], v[4:7], v[244:247], v[60:63]
    ds_write_b128 v71, v[124:127] offset:15360
    v_mfma_f32_16x16x32_bf16 v[48:51], v[8:11], v[200:203], v[48:51]
    v_mfma_f32_16x16x32_bf16 v[52:55], v[8:11], v[216:219], v[52:55]
    v_mfma_f32_16x16x32_bf16 v[56:59], v[8:11], v[232:235], v[56:59]
    v_mfma_f32_16x16x32_bf16 v[60:63], v[8:11], v[248:251], v[60:63]
    s_waitcnt lgkmcnt(0)
    s_barrier
    v_mfma_f32_16x16x32_bf16 v[48:51], v[12:15], v[204:207], v[48:51]
    v_mfma_f32_16x16x32_bf16 v[52:55], v[12:15], v[220:223], v[52:55]
    v_mfma_f32_16x16x32_bf16 v[56:59], v[12:15], v[236:239], v[56:59]
    v_mfma_f32_16x16x32_bf16 v[60:63], v[12:15], v[252:255], v[60:63]
    buffer_load_dwordx4 v[124:127], v69, s[12:15], s20 offen offset:2048 sc1
    buffer_load_dwordx4 v[0:3], v69, s[12:15], s44 offen offset:0
    buffer_load_dwordx4 v[4:7], v69, s[12:15], s44 offen offset:1024
    buffer_load_dwordx4 v[8:11], v69, s[12:15], s45 offen offset:0
    buffer_load_dwordx4 v[12:15], v69, s[12:15], s45 offen offset:1024
    s_waitcnt vmcnt(11)
    s_lshl_b32 s24, s36, 16
    s_and_b32 s25, s36, 0xffff0000
    s_lshl_b32 s26, s37, 16
    s_and_b32 s27, s37, 0xffff0000

    v_mfma_f32_16x16x32_bf16 v[88:91], v[16:19], v[128:131], 0
    v_mfma_f32_16x16x32_bf16 v[92:95], v[16:19], v[144:147], 0
    v_mfma_f32_16x16x32_bf16 v[88:91], v[20:23], v[132:135], v[88:91]
    v_mfma_f32_16x16x32_bf16 v[92:95], v[20:23], v[148:151], v[92:95]
    v_mfma_f32_16x16x32_bf16 v[88:91], v[24:27], v[136:139], v[88:91]
    v_cvt_pk_bf16_f32 v32, v32, v33
    v_mfma_f32_16x16x32_bf16 v[92:95], v[24:27], v[152:155], v[92:95]
    v_cvt_pk_bf16_f32 v33, v34, v35
    v_mfma_f32_16x16x32_bf16 v[88:91], v[28:31], v[140:143], v[88:91]
    ds_write_b64 v70, v[32:33] offset:0
    v_mfma_f32_16x16x32_bf16 v[92:95], v[28:31], v[156:159], v[92:95]
    v_cvt_pk_bf16_f32 v36, v36, v37
    v_mfma_f32_16x16x32_bf16 v[96:99], v[16:19], v[160:163], 0
    v_cvt_pk_bf16_f32 v37, v38, v39
    v_mfma_f32_16x16x32_bf16 v[100:103], v[16:19], v[176:179], 0
    ds_write_b64 v70, v[36:37] offset:128
    v_mfma_f32_16x16x32_bf16 v[96:99], v[20:23], v[164:167], v[96:99]
    v_cvt_pk_bf16_f32 v88, v88, v89
    v_cvt_pk_bf16_f32 v40, v40, v41
    v_mfma_f32_16x16x32_bf16 v[100:103], v[20:23], v[180:183], v[100:103]
    v_cvt_pk_bf16_f32 v89, v90, v91
    v_cvt_pk_bf16_f32 v41, v42, v43
    v_mfma_f32_16x16x32_bf16 v[96:99], v[24:27], v[168:171], v[96:99]
    ds_write_b64 v70, v[88:89] offset:32768
    ds_write_b64 v70, v[40:41] offset:256
    v_mfma_f32_16x16x32_bf16 v[100:103], v[24:27], v[184:187], v[100:103]
    v_cvt_pk_bf16_f32 v92, v92, v93
    v_cvt_pk_bf16_f32 v44, v44, v45
    v_mfma_f32_16x16x32_bf16 v[96:99], v[28:31], v[172:175], v[96:99]
    v_cvt_pk_bf16_f32 v93, v94, v95
    v_cvt_pk_bf16_f32 v45, v46, v47
    v_mfma_f32_16x16x32_bf16 v[100:103], v[28:31], v[188:191], v[100:103]
    ds_write_b64 v70, v[92:93] offset:32896
    ds_write_b64 v70, v[44:45] offset:384
    v_mfma_f32_16x16x32_bf16 v[104:107], v[16:19], v[192:195], 0
    v_cvt_pk_bf16_f32 v48, v48, v49
    v_mfma_f32_16x16x32_bf16 v[108:111], v[16:19], v[208:211], 0
    v_cvt_pk_bf16_f32 v49, v50, v51
    v_mfma_f32_16x16x32_bf16 v[104:107], v[20:23], v[196:199], v[104:107]
    v_cvt_pk_bf16_f32 v96, v96, v97
    ds_write_b64 v70, v[48:49] offset:512
    v_mfma_f32_16x16x32_bf16 v[108:111], v[20:23], v[212:215], v[108:111]
    v_cvt_pk_bf16_f32 v97, v98, v99
    v_cvt_pk_bf16_f32 v52, v52, v53
    v_mfma_f32_16x16x32_bf16 v[104:107], v[24:27], v[200:203], v[104:107]
    ds_write_b64 v70, v[96:97] offset:33024
    v_cvt_pk_bf16_f32 v53, v54, v55
    v_mfma_f32_16x16x32_bf16 v[108:111], v[24:27], v[216:219], v[108:111]
    v_cvt_pk_bf16_f32 v100, v100, v101
    ds_write_b64 v70, v[52:53] offset:640
    v_mfma_f32_16x16x32_bf16 v[104:107], v[28:31], v[204:207], v[104:107]
    v_cvt_pk_bf16_f32 v101, v102, v103
    v_cvt_pk_bf16_f32 v56, v56, v57
    v_mfma_f32_16x16x32_bf16 v[108:111], v[28:31], v[220:223], v[108:111]
    ds_write_b64 v70, v[100:101] offset:33152
    v_cvt_pk_bf16_f32 v57, v58, v59
    v_mfma_f32_16x16x32_bf16 v[88:91], v[16:19], v[224:227], 0
    ds_write_b64 v70, v[56:57] offset:768
    v_mfma_f32_16x16x32_bf16 v[92:95], v[16:19], v[240:243], 0
    v_cvt_pk_bf16_f32 v60, v60, v61
    v_mfma_f32_16x16x32_bf16 v[88:91], v[20:23], v[228:231], v[88:91]
    v_cvt_pk_bf16_f32 v104, v104, v105
    v_cvt_pk_bf16_f32 v61, v62, v63
    v_mfma_f32_16x16x32_bf16 v[92:95], v[20:23], v[244:247], v[92:95]
    v_cvt_pk_bf16_f32 v105, v106, v107
    ds_write_b64 v70, v[60:61] offset:896
    v_mfma_f32_16x16x32_bf16 v[88:91], v[24:27], v[232:235], v[88:91]
    ds_write_b64 v70, v[104:105] offset:33280
    v_mfma_f32_16x16x32_bf16 v[92:95], v[24:27], v[248:251], v[92:95]
    v_cvt_pk_bf16_f32 v108, v108, v109
    v_mfma_f32_16x16x32_bf16 v[88:91], v[28:31], v[236:239], v[88:91]
    v_cvt_pk_bf16_f32 v109, v110, v111
    v_mfma_f32_16x16x32_bf16 v[92:95], v[28:31], v[252:255], v[92:95]
    ds_write_b64 v70, v[108:109] offset:33408
    v_add_u32 v70, 0x8000, v70
    s_waitcnt vmcnt(0)
    v_mfma_f32_16x16x32_bf16 v[96:99], v[0:3], v[128:131], 0
    v_mfma_f32_16x16x32_bf16 v[100:103], v[0:3], v[144:147], 0
    v_mfma_f32_16x16x32_bf16 v[96:99], v[4:7], v[132:135], v[96:99]
    v_cvt_pk_bf16_f32 v88, v88, v89
    v_mfma_f32_16x16x32_bf16 v[100:103], v[4:7], v[148:151], v[100:103]
    v_cvt_pk_bf16_f32 v89, v90, v91
    v_mfma_f32_16x16x32_bf16 v[96:99], v[8:11], v[136:139], v[96:99]
    ds_write_b64 v70, v[88:89] offset:768
    v_mov_b32 v16, s24
    v_mov_b32 v40, s24
    v_mfma_f32_16x16x32_bf16 v[100:103], v[8:11], v[152:155], v[100:103]
    v_cvt_pk_bf16_f32 v92, v92, v93
    v_mov_b32 v17, s25
    v_mov_b32 v41, s25
    v_mfma_f32_16x16x32_bf16 v[96:99], v[12:15], v[140:143], v[96:99]
    v_cvt_pk_bf16_f32 v93, v94, v95
    v_mov_b32 v18, s26
    v_mov_b32 v42, s26
    v_mfma_f32_16x16x32_bf16 v[100:103], v[12:15], v[156:159], v[100:103]
    ds_write_b64 v70, v[92:93] offset:896
    v_mov_b32 v19, s27
    v_mov_b32 v43, s27
    v_mfma_f32_16x16x32_bf16 v[104:107], v[0:3], v[160:163], 0
    v_mov_b32 v20, s24
    v_mov_b32 v44, s24
    v_mfma_f32_16x16x32_bf16 v[108:111], v[0:3], v[176:179], 0
    v_mov_b32 v21, s25
    v_mov_b32 v45, s25
    v_mfma_f32_16x16x32_bf16 v[104:107], v[4:7], v[164:167], v[104:107]
    v_cvt_pk_bf16_f32 v96, v96, v97
    v_mov_b32 v22, s26
    v_mov_b32 v46, s26
    v_mfma_f32_16x16x32_bf16 v[108:111], v[4:7], v[180:183], v[108:111]
    v_cvt_pk_bf16_f32 v97, v98, v99
    v_mov_b32 v23, s27
    v_mov_b32 v47, s27
    v_mfma_f32_16x16x32_bf16 v[104:107], v[8:11], v[168:171], v[104:107]
    ds_write_b64 v70, v[96:97] offset:32768
    v_mov_b32 v24, s24
    v_mov_b32 v48, s24
    v_mfma_f32_16x16x32_bf16 v[108:111], v[8:11], v[184:187], v[108:111]
    v_cvt_pk_bf16_f32 v100, v100, v101
    v_mov_b32 v25, s25
    v_mov_b32 v49, s25
    v_mfma_f32_16x16x32_bf16 v[104:107], v[12:15], v[172:175], v[104:107]
    v_cvt_pk_bf16_f32 v101, v102, v103
    v_mov_b32 v26, s26
    v_mov_b32 v50, s26
    v_mfma_f32_16x16x32_bf16 v[108:111], v[12:15], v[188:191], v[108:111]
    ds_write_b64 v70, v[100:101] offset:32896
    v_mov_b32 v27, s27
    v_mov_b32 v51, s27
    v_mfma_f32_16x16x32_bf16 v[88:91], v[0:3], v[192:195], 0
    v_mov_b32 v28, s24
    v_mov_b32 v52, s24
    v_mfma_f32_16x16x32_bf16 v[92:95], v[0:3], v[208:211], 0
    v_mov_b32 v29, s25
    v_mov_b32 v53, s25
    v_mfma_f32_16x16x32_bf16 v[88:91], v[4:7], v[196:199], v[88:91]
    v_cvt_pk_bf16_f32 v104, v104, v105
    v_mov_b32 v30, s26
    v_mov_b32 v54, s26
    v_mfma_f32_16x16x32_bf16 v[92:95], v[4:7], v[212:215], v[92:95]
    v_cvt_pk_bf16_f32 v105, v106, v107
    v_mov_b32 v31, s27
    v_mov_b32 v55, s27
    v_mfma_f32_16x16x32_bf16 v[88:91], v[8:11], v[200:203], v[88:91]
    ds_write_b64 v70, v[104:105] offset:33024
    v_mov_b32 v32, s24
    v_mov_b32 v56, s24
    v_mfma_f32_16x16x32_bf16 v[92:95], v[8:11], v[216:219], v[92:95]
    v_cvt_pk_bf16_f32 v108, v108, v109
    v_mov_b32 v33, s25
    v_mov_b32 v57, s25
    v_mfma_f32_16x16x32_bf16 v[88:91], v[12:15], v[204:207], v[88:91]
    v_cvt_pk_bf16_f32 v109, v110, v111
    v_mov_b32 v34, s26
    v_mov_b32 v58, s26
    v_mfma_f32_16x16x32_bf16 v[92:95], v[12:15], v[220:223], v[92:95]
    ds_write_b64 v70, v[108:109] offset:33152
    v_mov_b32 v35, s27
    v_mov_b32 v59, s27
    v_mfma_f32_16x16x32_bf16 v[96:99], v[0:3], v[224:227], 0
    v_mov_b32 v36, s24
    v_mov_b32 v60, s24
    v_mfma_f32_16x16x32_bf16 v[100:103], v[0:3], v[240:243], 0
    v_mov_b32 v37, s25
    v_mov_b32 v61, s25
    v_mfma_f32_16x16x32_bf16 v[96:99], v[4:7], v[228:231], v[96:99]
    v_cvt_pk_bf16_f32 v88, v88, v89
    v_mov_b32 v38, s26
    v_mov_b32 v62, s26
    v_mfma_f32_16x16x32_bf16 v[100:103], v[4:7], v[244:247], v[100:103]
    v_cvt_pk_bf16_f32 v89, v90, v91
    v_mov_b32 v39, s27
    v_mov_b32 v63, s27
    v_mfma_f32_16x16x32_bf16 v[96:99], v[8:11], v[232:235], v[96:99]
    ds_write_b64 v70, v[88:89] offset:33280
    s_nop 0
    v_mfma_f32_16x16x32_bf16 v[100:103], v[8:11], v[248:251], v[100:103]
    v_cvt_pk_bf16_f32 v92, v92, v93
    s_nop 0
    v_mfma_f32_16x16x32_bf16 v[96:99], v[12:15], v[236:239], v[96:99]
    v_cvt_pk_bf16_f32 v93, v94, v95
    s_nop 0
    v_mfma_f32_16x16x32_bf16 v[100:103], v[12:15], v[252:255], v[100:103]
    ds_write_b64 v70, v[92:93] offset:33408
    s_nop 0
    v_mov_b32 v0, s24
    v_mov_b32 v1, s25
    v_mov_b32 v2, s26
    v_mov_b32 v3, s27
    v_mov_b32 v4, s24
    v_mov_b32 v5, s25
    v_mov_b32 v6, s26
    v_mov_b32 v7, s27
    v_mov_b32 v8, s24
    v_mov_b32 v9, s25
    v_mov_b32 v10, s26
    v_mov_b32 v11, s27
    v_mov_b32 v12, s24
    v_mov_b32 v13, s25
    v_mov_b32 v14, s26
    v_mov_b32 v15, s27
    s_nop 7
    v_cvt_pk_bf16_f32 v96, v96, v97
    v_cvt_pk_bf16_f32 v97, v98, v99
    ds_write_b64 v70, v[96:97] offset:33536
    v_cvt_pk_bf16_f32 v100, v100, v101
    v_cvt_pk_bf16_f32 v101, v102, v103
    ds_write_b64 v70, v[100:101] offset:33664
    v_add_u32 v70, 0x10000, v70
    s_branch k1_kernel_k2j
k1_kernel_k2m:
    buffer_load_dwordx4 v[0:3], v69, s[12:15], s21 offen offset:0
    buffer_load_dwordx4 v[4:7], v69, s[12:15], s21 offen offset:1024
    buffer_load_dwordx4 v[8:11], v69, s[12:15], s19 offen offset:0
    buffer_load_dwordx4 v[12:15], v69, s[12:15], s19 offen offset:1024
    s_add_u32 s21, s21, 4096
    s_add_u32 s19, s19, 4096
    buffer_load_dwordx4 v[16:19], v69, s[12:15], s21 offen offset:0
    buffer_load_dwordx4 v[20:23], v69, s[12:15], s21 offen offset:1024
    buffer_load_dwordx4 v[24:27], v69, s[12:15], s19 offen offset:0
    buffer_load_dwordx4 v[28:31], v69, s[12:15], s19 offen offset:1024
    s_add_u32 s21, s21, 4096
    s_add_u32 s19, s19, 4096
    s_mov_b32 s44, s21
    s_mov_b32 s45, s19
    s_add_u32 s21, s21, 4096
    s_add_u32 s19, s19, 4096
    buffer_load_dwordx4 v[72:75], v69, s[12:15], s21 offen offset:0
    buffer_load_dwordx4 v[76:79], v69, s[12:15], s21 offen offset:1024
    buffer_load_dwordx4 v[80:83], v69, s[12:15], s19 offen offset:0
    buffer_load_dwordx4 v[84:87], v69, s[12:15], s19 offen offset:1024
    s_add_u32 s21, s21, 4096
    s_add_u32 s19, s19, 4096
    buffer_load_dwordx4 v[116:119], v69, s[12:15], s20 offen offset:0 sc1
    buffer_load_dwordx4 v[120:123], v69, s[12:15], s20 offen offset:1024 sc1
    buffer_load_dwordx4 v[124:127], v69, s[12:15], s20 offen offset:2048 sc1
    buffer_load_dwordx4 v[32:35], v69, s[12:15], s44 offen offset:0
    buffer_load_dwordx4 v[36:39], v69, s[12:15], s44 offen offset:1024
    buffer_load_dwordx4 v[40:43], v69, s[12:15], s45 offen offset:0
    buffer_load_dwordx4 v[44:47], v69, s[12:15], s45 offen offset:1024
    s_mov_b32 exec_lo, 0x00ff00ff
    s_mov_b32 exec_hi, 0x00ff00ff
    buffer_store_dword v112, v113, s[12:15], s74 offen sc1
    s_mov_b64 exec, -1
    s_waitcnt lgkmcnt(0)
    s_barrier
    ds_read_b128 v[136:139], v71 offset:0
    ds_read_b128 v[140:143], v71 offset:1024
    ds_read_b128 v[152:155], v71 offset:2048
    ds_read_b128 v[156:159], v71 offset:3072
    ds_read_b128 v[168:171], v71 offset:4096
    ds_read_b128 v[172:175], v71 offset:5120
    ds_read_b128 v[184:187], v71 offset:6144
    ds_read_b128 v[188:191], v71 offset:7168
    ds_read_b128 v[200:203], v71 offset:8192
    ds_read_b128 v[204:207], v71 offset:9216
    ds_read_b128 v[216:219], v71 offset:10240
    ds_read_b128 v[220:223], v71 offset:11264
    ds_read_b128 v[232:235], v71 offset:12288
    ds_read_b128 v[236:239], v71 offset:13312
    ds_read_b128 v[248:251], v71 offset:14336
    ds_read_b128 v[252:255], v71 offset:15360
    s_waitcnt vmcnt(16)
    v_mfma_f32_16x16x32_bf16 v[48:51], v[0:3], v[128:131], 0
    v_mfma_f32_16x16x32_bf16 v[52:55], v[0:3], v[144:147], 0
    v_mfma_f32_16x16x32_bf16 v[56:59], v[0:3], v[160:163], 0
    v_mfma_f32_16x16x32_bf16 v[60:63], v[0:3], v[176:179], 0
    v_mfma_f32_16x16x32_bf16 v[88:91], v[0:3], v[192:195], 0
    v_mfma_f32_16x16x32_bf16 v[92:95], v[0:3], v[208:211], 0
    v_mfma_f32_16x16x32_bf16 v[96:99], v[0:3], v[224:227], 0
    v_mfma_f32_16x16x32_bf16 v[100:103], v[0:3], v[240:243], 0
    v_mfma_f32_16x16x32_bf16 v[48:51], v[4:7], v[132:135], v[48:51]
    v_mfma_f32_16x16x32_bf16 v[52:55], v[4:7], v[148:151], v[52:55]
    v_mfma_f32_16x16x32_bf16 v[56:59], v[4:7], v[164:167], v[56:59]
    v_mfma_f32_16x16x32_bf16 v[60:63], v[4:7], v[180:183], v[60:63]
    v_mfma_f32_16x16x32_bf16 v[88:91], v[4:7], v[196:199], v[88:91]
    v_mfma_f32_16x16x32_bf16 v[92:95], v[4:7], v[212:215], v[92:95]
    v_mfma_f32_16x16x32_bf16 v[96:99], v[4:7], v[228:231], v[96:99]
    v_mfma_f32_16x16x32_bf16 v[100:103], v[4:7], v[244:247], v[100:103]

    s_lshl_b32 s24, s36, 16
    s_and_b32 s25, s36, 0xffff0000
    s_lshl_b32 s26, s37, 16
    s_and_b32 s27, s37, 0xffff0000

    s_waitcnt lgkmcnt(12)
    v_mfma_f32_16x16x32_bf16 v[48:51], v[8:11], v[136:139], v[48:51]
    v_mfma_f32_16x16x32_bf16 v[52:55], v[8:11], v[152:155], v[52:55]
    v_mfma_f32_16x16x32_bf16 v[48:51], v[12:15], v[140:143], v[48:51]
    v_mfma_f32_16x16x32_bf16 v[52:55], v[12:15], v[156:159], v[52:55]
    s_waitcnt lgkmcnt(8)
    v_mfma_f32_16x16x32_bf16 v[56:59], v[8:11], v[168:171], v[56:59]
    v_mfma_f32_16x16x32_bf16 v[60:63], v[8:11], v[184:187], v[60:63]
    v_mfma_f32_16x16x32_bf16 v[56:59], v[12:15], v[172:175], v[56:59]
    v_mfma_f32_16x16x32_bf16 v[60:63], v[12:15], v[188:191], v[60:63]
    s_waitcnt lgkmcnt(4)
    v_mfma_f32_16x16x32_bf16 v[88:91], v[8:11], v[200:203], v[88:91]
    v_mfma_f32_16x16x32_bf16 v[92:95], v[8:11], v[216:219], v[92:95]
    v_mfma_f32_16x16x32_bf16 v[88:91], v[12:15], v[204:207], v[88:91]
    v_mfma_f32_16x16x32_bf16 v[92:95], v[12:15], v[220:223], v[92:95]
    v_cvt_pk_bf16_f32 v48, v48, v49
    v_cvt_pk_bf16_f32 v49, v50, v51
    ds_write_b64 v70, v[48:49] offset:0
    v_cvt_pk_bf16_f32 v52, v52, v53
    v_cvt_pk_bf16_f32 v53, v54, v55
    ds_write_b64 v70, v[52:53] offset:128
    s_waitcnt lgkmcnt(2)
    v_mfma_f32_16x16x32_bf16 v[96:99], v[8:11], v[232:235], v[96:99]
    v_mfma_f32_16x16x32_bf16 v[100:103], v[8:11], v[248:251], v[100:103]
    v_mfma_f32_16x16x32_bf16 v[96:99], v[12:15], v[236:239], v[96:99]
    v_mfma_f32_16x16x32_bf16 v[100:103], v[12:15], v[252:255], v[100:103]
    v_cvt_pk_bf16_f32 v56, v56, v57
    v_cvt_pk_bf16_f32 v57, v58, v59
    ds_write_b64 v70, v[56:57] offset:256
    v_cvt_pk_bf16_f32 v60, v60, v61
    v_cvt_pk_bf16_f32 v61, v62, v63
    ds_write_b64 v70, v[60:61] offset:384
    s_nop 3
    v_cvt_pk_bf16_f32 v88, v88, v89
    v_cvt_pk_bf16_f32 v89, v90, v91
    ds_write_b64 v70, v[88:89] offset:512
    v_cvt_pk_bf16_f32 v92, v92, v93
    v_cvt_pk_bf16_f32 v93, v94, v95
    ds_write_b64 v70, v[92:93] offset:640
    s_nop 3
    v_cvt_pk_bf16_f32 v96, v96, v97
    v_cvt_pk_bf16_f32 v97, v98, v99
    ds_write_b64 v70, v[96:97] offset:768
    v_cvt_pk_bf16_f32 v100, v100, v101
    v_cvt_pk_bf16_f32 v101, v102, v103
    ds_write_b64 v70, v[100:101] offset:896
    v_add_u32 v70, 0x8000, v70
    s_waitcnt vmcnt(12)
    v_mfma_f32_16x16x32_bf16 v[104:107], v[16:19], v[128:131], 0
    v_mfma_f32_16x16x32_bf16 v[108:111], v[16:19], v[144:147], 0
    v_mfma_f32_16x16x32_bf16 v[104:107], v[20:23], v[132:135], v[104:107]
    v_mfma_f32_16x16x32_bf16 v[108:111], v[20:23], v[148:151], v[108:111]
    v_mfma_f32_16x16x32_bf16 v[104:107], v[24:27], v[136:139], v[104:107]
    v_mov_b32 v48, s24
    v_mfma_f32_16x16x32_bf16 v[108:111], v[24:27], v[152:155], v[108:111]
    v_mov_b32 v49, s25
    v_mfma_f32_16x16x32_bf16 v[104:107], v[28:31], v[140:143], v[104:107]
    v_mov_b32 v50, s26
    v_mfma_f32_16x16x32_bf16 v[108:111], v[28:31], v[156:159], v[108:111]
    v_mov_b32 v51, s27
    v_mfma_f32_16x16x32_bf16 v[88:91], v[16:19], v[160:163], 0
    v_mov_b32 v52, s24
    v_mfma_f32_16x16x32_bf16 v[92:95], v[16:19], v[176:179], 0
    v_mov_b32 v53, s25
    v_mfma_f32_16x16x32_bf16 v[88:91], v[20:23], v[164:167], v[88:91]
    v_cvt_pk_bf16_f32 v104, v104, v105
    v_mov_b32 v54, s26
    v_mfma_f32_16x16x32_bf16 v[92:95], v[20:23], v[180:183], v[92:95]
    v_cvt_pk_bf16_f32 v105, v106, v107
    v_mov_b32 v55, s27
    v_mfma_f32_16x16x32_bf16 v[88:91], v[24:27], v[168:171], v[88:91]
    ds_write_b64 v70, v[104:105] offset:0
    v_mov_b32 v56, s24
    v_mfma_f32_16x16x32_bf16 v[92:95], v[24:27], v[184:187], v[92:95]
    v_cvt_pk_bf16_f32 v108, v108, v109
    v_mov_b32 v57, s25
    v_mfma_f32_16x16x32_bf16 v[88:91], v[28:31], v[172:175], v[88:91]
    v_cvt_pk_bf16_f32 v109, v110, v111
    v_mov_b32 v58, s26
    v_mfma_f32_16x16x32_bf16 v[92:95], v[28:31], v[188:191], v[92:95]
    ds_write_b64 v70, v[108:109] offset:128
    v_mov_b32 v59, s27
    v_mfma_f32_16x16x32_bf16 v[96:99], v[16:19], v[192:195], 0
    v_mov_b32 v60, s24
    v_mfma_f32_16x16x32_bf16 v[100:103], v[16:19], v[208:211], 0
    v_mov_b32 v61, s25
    v_mfma_f32_16x16x32_bf16 v[96:99], v[20:23], v[196:199], v[96:99]
    v_cvt_pk_bf16_f32 v88, v88, v89
    v_mov_b32 v62, s26
    v_mfma_f32_16x16x32_bf16 v[100:103], v[20:23], v[212:215], v[100:103]
    v_cvt_pk_bf16_f32 v89, v90, v91
    v_mov_b32 v63, s27
    v_mfma_f32_16x16x32_bf16 v[96:99], v[24:27], v[200:203], v[96:99]
    ds_write_b64 v70, v[88:89] offset:256
    v_mov_b32 v0, s24
    v_mfma_f32_16x16x32_bf16 v[100:103], v[24:27], v[216:219], v[100:103]
    v_cvt_pk_bf16_f32 v92, v92, v93
    v_mov_b32 v1, s25
    v_mfma_f32_16x16x32_bf16 v[96:99], v[28:31], v[204:207], v[96:99]
    v_cvt_pk_bf16_f32 v93, v94, v95
    v_mov_b32 v2, s26
    v_mfma_f32_16x16x32_bf16 v[100:103], v[28:31], v[220:223], v[100:103]
    ds_write_b64 v70, v[92:93] offset:384
    v_mov_b32 v3, s27
    v_mfma_f32_16x16x32_bf16 v[104:107], v[16:19], v[224:227], 0
    v_mov_b32 v4, s24
    v_mfma_f32_16x16x32_bf16 v[108:111], v[16:19], v[240:243], 0
    v_mov_b32 v5, s25
    v_mfma_f32_16x16x32_bf16 v[104:107], v[20:23], v[228:231], v[104:107]
    v_cvt_pk_bf16_f32 v96, v96, v97
    v_mov_b32 v6, s26
    v_mfma_f32_16x16x32_bf16 v[108:111], v[20:23], v[244:247], v[108:111]
    v_cvt_pk_bf16_f32 v97, v98, v99
    v_mov_b32 v7, s27
    v_mfma_f32_16x16x32_bf16 v[104:107], v[24:27], v[232:235], v[104:107]
    ds_write_b64 v70, v[96:97] offset:512
    v_mov_b32 v8, s24
    v_mfma_f32_16x16x32_bf16 v[108:111], v[24:27], v[248:251], v[108:111]
    v_cvt_pk_bf16_f32 v100, v100, v101
    v_mov_b32 v9, s25
    v_mfma_f32_16x16x32_bf16 v[104:107], v[28:31], v[236:239], v[104:107]
    v_cvt_pk_bf16_f32 v101, v102, v103
    v_mov_b32 v10, s26
    v_mfma_f32_16x16x32_bf16 v[108:111], v[28:31], v[252:255], v[108:111]
    ds_write_b64 v70, v[100:101] offset:640
    v_mov_b32 v11, s27
    s_waitcnt vmcnt(1)
    v_mfma_f32_16x16x32_bf16 v[88:91], v[32:35], v[128:131], 0
    v_mfma_f32_16x16x32_bf16 v[92:95], v[32:35], v[144:147], 0
    v_mfma_f32_16x16x32_bf16 v[88:91], v[36:39], v[132:135], v[88:91]
    v_cvt_pk_bf16_f32 v104, v104, v105
    v_mfma_f32_16x16x32_bf16 v[92:95], v[36:39], v[148:151], v[92:95]
    v_cvt_pk_bf16_f32 v105, v106, v107
    v_mfma_f32_16x16x32_bf16 v[88:91], v[40:43], v[136:139], v[88:91]
    ds_write_b64 v70, v[104:105] offset:768
    v_mov_b32 v12, s24
    v_mfma_f32_16x16x32_bf16 v[92:95], v[40:43], v[152:155], v[92:95]
    v_cvt_pk_bf16_f32 v108, v108, v109
    v_mov_b32 v13, s25
    v_mfma_f32_16x16x32_bf16 v[88:91], v[44:47], v[140:143], v[88:91]
    v_cvt_pk_bf16_f32 v109, v110, v111
    v_mov_b32 v14, s26
    v_mfma_f32_16x16x32_bf16 v[92:95], v[44:47], v[156:159], v[92:95]
    ds_write_b64 v70, v[108:109] offset:896
    v_mov_b32 v15, s27
    v_mfma_f32_16x16x32_bf16 v[96:99], v[32:35], v[160:163], 0
    v_mov_b32 v16, s24
    v_mfma_f32_16x16x32_bf16 v[100:103], v[32:35], v[176:179], 0
    v_mov_b32 v17, s25
    v_mfma_f32_16x16x32_bf16 v[96:99], v[36:39], v[164:167], v[96:99]
    v_cvt_pk_bf16_f32 v88, v88, v89
    v_mov_b32 v18, s26
    v_mfma_f32_16x16x32_bf16 v[100:103], v[36:39], v[180:183], v[100:103]
    v_cvt_pk_bf16_f32 v89, v90, v91
    v_mov_b32 v19, s27
    v_mfma_f32_16x16x32_bf16 v[96:99], v[40:43], v[168:171], v[96:99]
    ds_write_b64 v70, v[88:89] offset:32768
    v_mov_b32 v20, s24
    v_mfma_f32_16x16x32_bf16 v[100:103], v[40:43], v[184:187], v[100:103]
    v_cvt_pk_bf16_f32 v92, v92, v93
    v_mov_b32 v21, s25
    v_mfma_f32_16x16x32_bf16 v[96:99], v[44:47], v[172:175], v[96:99]
    v_cvt_pk_bf16_f32 v93, v94, v95
    v_mov_b32 v22, s26
    v_mfma_f32_16x16x32_bf16 v[100:103], v[44:47], v[188:191], v[100:103]
    ds_write_b64 v70, v[92:93] offset:32896
    v_mov_b32 v23, s27
    v_mfma_f32_16x16x32_bf16 v[104:107], v[32:35], v[192:195], 0
    v_mov_b32 v24, s24
    v_mfma_f32_16x16x32_bf16 v[108:111], v[32:35], v[208:211], 0
    v_mov_b32 v25, s25
    v_mfma_f32_16x16x32_bf16 v[104:107], v[36:39], v[196:199], v[104:107]
    v_cvt_pk_bf16_f32 v96, v96, v97
    v_mov_b32 v26, s26
    v_mfma_f32_16x16x32_bf16 v[108:111], v[36:39], v[212:215], v[108:111]
    v_cvt_pk_bf16_f32 v97, v98, v99
    v_mov_b32 v27, s27
    v_mfma_f32_16x16x32_bf16 v[104:107], v[40:43], v[200:203], v[104:107]
    ds_write_b64 v70, v[96:97] offset:33024
    v_mov_b32 v28, s24
    v_mfma_f32_16x16x32_bf16 v[108:111], v[40:43], v[216:219], v[108:111]
    v_cvt_pk_bf16_f32 v100, v100, v101
    v_mov_b32 v29, s25
    v_mfma_f32_16x16x32_bf16 v[104:107], v[44:47], v[204:207], v[104:107]
    v_cvt_pk_bf16_f32 v101, v102, v103
    v_mov_b32 v30, s26
    v_mfma_f32_16x16x32_bf16 v[108:111], v[44:47], v[220:223], v[108:111]
    ds_write_b64 v70, v[100:101] offset:33152
    v_mov_b32 v31, s27
    v_mfma_f32_16x16x32_bf16 v[88:91], v[32:35], v[224:227], 0
    s_nop 0
    v_mfma_f32_16x16x32_bf16 v[92:95], v[32:35], v[240:243], 0
    s_nop 0
    v_mfma_f32_16x16x32_bf16 v[88:91], v[36:39], v[228:231], v[88:91]
    v_cvt_pk_bf16_f32 v104, v104, v105
    s_nop 0
    v_mfma_f32_16x16x32_bf16 v[92:95], v[36:39], v[244:247], v[92:95]
    v_cvt_pk_bf16_f32 v105, v106, v107
    s_nop 0
    v_mfma_f32_16x16x32_bf16 v[88:91], v[40:43], v[232:235], v[88:91]
    ds_write_b64 v70, v[104:105] offset:33280
    s_nop 0
    v_mfma_f32_16x16x32_bf16 v[92:95], v[40:43], v[248:251], v[92:95]
    v_cvt_pk_bf16_f32 v108, v108, v109
    s_nop 0
    v_mfma_f32_16x16x32_bf16 v[88:91], v[44:47], v[236:239], v[88:91]
    v_cvt_pk_bf16_f32 v109, v110, v111
    s_nop 0
    v_mfma_f32_16x16x32_bf16 v[92:95], v[44:47], v[252:255], v[92:95]
    ds_write_b64 v70, v[108:109] offset:33408
    s_nop 0
    v_mov_b32 v32, s24
    v_mov_b32 v33, s25
    v_mov_b32 v34, s26
    v_mov_b32 v35, s27
    v_mov_b32 v36, s24
    v_mov_b32 v37, s25
    v_mov_b32 v38, s26
    v_mov_b32 v39, s27
    v_mov_b32 v40, s24
    v_mov_b32 v41, s25
    v_mov_b32 v42, s26
    v_mov_b32 v43, s27
    v_mov_b32 v44, s24
    v_mov_b32 v45, s25
    v_mov_b32 v46, s26
    v_mov_b32 v47, s27
    s_nop 7
    v_cvt_pk_bf16_f32 v88, v88, v89
    v_cvt_pk_bf16_f32 v89, v90, v91
    ds_write_b64 v70, v[88:89] offset:33536
    v_cvt_pk_bf16_f32 v92, v92, v93
    v_cvt_pk_bf16_f32 v93, v94, v95
    ds_write_b64 v70, v[92:93] offset:33664
    v_add_u32 v70, 0x10000, v70
k1_kernel_k2j:

    s_mov_b32 s22, 0
    s_mov_b32 s23, 3
    s_waitcnt lgkmcnt(0)
    s_barrier

    v_lshlrev_b32_sdwa v88, 3, v116 dst_sel:DWORD dst_unused:UNUSED_PAD src0_sel:DWORD src1_sel:WORD_0
    v_lshlrev_b32_sdwa v90, 3, v116 dst_sel:DWORD dst_unused:UNUSED_PAD src0_sel:DWORD src1_sel:WORD_1
    v_lshlrev_b32_sdwa v92, 3, v117 dst_sel:DWORD dst_unused:UNUSED_PAD src0_sel:DWORD src1_sel:WORD_0
    v_lshlrev_b32_sdwa v94, 3, v117 dst_sel:DWORD dst_unused:UNUSED_PAD src0_sel:DWORD src1_sel:WORD_1
    ds_read_b64 v[88:89], v88
    ds_read_b64 v[90:91], v90
    ds_read_b64 v[92:93], v92
    ds_read_b64 v[94:95], v94
    v_lshlrev_b32_sdwa v96, 3, v118 dst_sel:DWORD dst_unused:UNUSED_PAD src0_sel:DWORD src1_sel:WORD_0
    v_lshlrev_b32_sdwa v98, 3, v118 dst_sel:DWORD dst_unused:UNUSED_PAD src0_sel:DWORD src1_sel:WORD_1
    v_lshlrev_b32_sdwa v100, 3, v119 dst_sel:DWORD dst_unused:UNUSED_PAD src0_sel:DWORD src1_sel:WORD_0
    v_lshlrev_b32_sdwa v102, 3, v119 dst_sel:DWORD dst_unused:UNUSED_PAD src0_sel:DWORD src1_sel:WORD_1
    ds_read_b64 v[96:97], v96
    ds_read_b64 v[98:99], v98
    ds_read_b64 v[100:101], v100
    ds_read_b64 v[102:103], v102
    buffer_load_dwordx4 v[116:119], v69, s[12:15], s20 offen offset:3072 sc1
    s_add_u32 s20, s20, 4096
k1_kernel_gloop:
    s_setprio 3
    s_waitcnt vmcnt(6)
    v_lshlrev_b32_sdwa v104, 3, v120 dst_sel:DWORD dst_unused:UNUSED_PAD src0_sel:DWORD src1_sel:WORD_0
    v_lshlrev_b32_sdwa v106, 3, v120 dst_sel:DWORD dst_unused:UNUSED_PAD src0_sel:DWORD src1_sel:WORD_1
    ds_read_b64 v[104:105], v104
    ds_read_b64 v[106:107], v106
    v_lshlrev_b32_sdwa v108, 3, v121 dst_sel:DWORD dst_unused:UNUSED_PAD src0_sel:DWORD src1_sel:WORD_0
    v_lshlrev_b32_sdwa v110, 3, v121 dst_sel:DWORD dst_unused:UNUSED_PAD src0_sel:DWORD src1_sel:WORD_1
    ds_read_b64 v[108:109], v108
    ds_read_b64 v[110:111], v110
    s_waitcnt lgkmcnt(8)
    v_smfmac_f32_16x16x64_bf16 v[0:3], v[64:67], v[88:95], v68
    s_waitcnt vmcnt(5)
    v_mfma_f32_16x16x32_bf16 v[112:115], v[72:75], v[128:131], 0
    v_lshlrev_b32_sdwa v88, 3, v122 dst_sel:DWORD dst_unused:UNUSED_PAD src0_sel:DWORD src1_sel:WORD_0
    v_lshlrev_b32_sdwa v90, 3, v122 dst_sel:DWORD dst_unused:UNUSED_PAD src0_sel:DWORD src1_sel:WORD_1
    ds_read_b64 v[88:89], v88
    ds_read_b64 v[90:91], v90
    s_waitcnt vmcnt(4)
    v_mfma_f32_16x16x32_bf16 v[112:115], v[76:79], v[132:135], v[112:115]
    v_lshlrev_b32_sdwa v92, 3, v123 dst_sel:DWORD dst_unused:UNUSED_PAD src0_sel:DWORD src1_sel:WORD_0
    v_lshlrev_b32_sdwa v94, 3, v123 dst_sel:DWORD dst_unused:UNUSED_PAD src0_sel:DWORD src1_sel:WORD_1
    ds_read_b64 v[92:93], v92
    ds_read_b64 v[94:95], v94
    buffer_load_dwordx4 v[120:123], v69, s[12:15], s20 offen offset:0 sc1
    s_waitcnt lgkmcnt(8)
    v_smfmac_f32_16x16x64_bf16 v[4:7], v[64:67], v[96:103], v68
    s_waitcnt vmcnt(4)
    v_mfma_f32_16x16x32_bf16 v[112:115], v[80:83], v[136:139], v[112:115]
    s_waitcnt vmcnt(2)
    v_lshlrev_b32_sdwa v96, 3, v124 dst_sel:DWORD dst_unused:UNUSED_PAD src0_sel:DWORD src1_sel:WORD_0
    v_lshlrev_b32_sdwa v98, 3, v124 dst_sel:DWORD dst_unused:UNUSED_PAD src0_sel:DWORD src1_sel:WORD_1
    ds_read_b64 v[96:97], v96
    ds_read_b64 v[98:99], v98
    s_waitcnt vmcnt(3)
    v_mfma_f32_16x16x32_bf16 v[112:115], v[84:87], v[140:143], v[112:115]
    v_lshlrev_b32_sdwa v100, 3, v125 dst_sel:DWORD dst_unused:UNUSED_PAD src0_sel:DWORD src1_sel:WORD_0
    v_lshlrev_b32_sdwa v102, 3, v125 dst_sel:DWORD dst_unused:UNUSED_PAD src0_sel:DWORD src1_sel:WORD_1
    ds_read_b64 v[100:101], v100
    ds_read_b64 v[102:103], v102
    s_waitcnt lgkmcnt(8)
    v_smfmac_f32_16x16x64_bf16 v[8:11], v[64:67], v[104:111], v68
    s_nop 1
    v_cvt_pk_bf16_f32 v112, v112, v113
    v_cvt_pk_bf16_f32 v113, v114, v115
    ds_write_b64 v70, v[112:113] offset:0
    v_mfma_f32_16x16x32_bf16 v[112:115], v[72:75], v[144:147], 0
    v_mfma_f32_16x16x32_bf16 v[112:115], v[76:79], v[148:151], v[112:115]
    v_lshlrev_b32_sdwa v104, 3, v126 dst_sel:DWORD dst_unused:UNUSED_PAD src0_sel:DWORD src1_sel:WORD_0
    v_lshlrev_b32_sdwa v106, 3, v126 dst_sel:DWORD dst_unused:UNUSED_PAD src0_sel:DWORD src1_sel:WORD_1
    ds_read_b64 v[104:105], v104
    ds_read_b64 v[106:107], v106
    v_mfma_f32_16x16x32_bf16 v[112:115], v[80:83], v[152:155], v[112:115]
    v_mfma_f32_16x16x32_bf16 v[112:115], v[84:87], v[156:159], v[112:115]
    v_lshlrev_b32_sdwa v108, 3, v127 dst_sel:DWORD dst_unused:UNUSED_PAD src0_sel:DWORD src1_sel:WORD_0
    v_lshlrev_b32_sdwa v110, 3, v127 dst_sel:DWORD dst_unused:UNUSED_PAD src0_sel:DWORD src1_sel:WORD_1
    ds_read_b64 v[108:109], v108
    ds_read_b64 v[110:111], v110
    buffer_load_dwordx4 v[124:127], v69, s[12:15], s20 offen offset:1024 sc1
    s_waitcnt lgkmcnt(9)
    v_smfmac_f32_16x16x64_bf16 v[12:15], v[64:67], v[88:95], v68
    s_nop 0
    v_cvt_pk_bf16_f32 v112, v112, v113
    v_cvt_pk_bf16_f32 v113, v114, v115
    ds_write_b64 v70, v[112:113] offset:128
    v_mfma_f32_16x16x32_bf16 v[112:115], v[72:75], v[160:163], 0
    s_waitcnt vmcnt(2)
    v_lshlrev_b32_sdwa v88, 3, v116 dst_sel:DWORD dst_unused:UNUSED_PAD src0_sel:DWORD src1_sel:WORD_0
    v_lshlrev_b32_sdwa v90, 3, v116 dst_sel:DWORD dst_unused:UNUSED_PAD src0_sel:DWORD src1_sel:WORD_1
    ds_read_b64 v[88:89], v88
    ds_read_b64 v[90:91], v90
    v_mfma_f32_16x16x32_bf16 v[112:115], v[76:79], v[164:167], v[112:115]
    v_lshlrev_b32_sdwa v92, 3, v117 dst_sel:DWORD dst_unused:UNUSED_PAD src0_sel:DWORD src1_sel:WORD_0
    v_lshlrev_b32_sdwa v94, 3, v117 dst_sel:DWORD dst_unused:UNUSED_PAD src0_sel:DWORD src1_sel:WORD_1
    ds_read_b64 v[92:93], v92
    ds_read_b64 v[94:95], v94
    s_waitcnt lgkmcnt(10)
    v_smfmac_f32_16x16x64_bf16 v[16:19], v[64:67], v[96:103], v68
    v_mfma_f32_16x16x32_bf16 v[112:115], v[80:83], v[168:171], v[112:115]
    v_lshlrev_b32_sdwa v96, 3, v118 dst_sel:DWORD dst_unused:UNUSED_PAD src0_sel:DWORD src1_sel:WORD_0
    v_lshlrev_b32_sdwa v98, 3, v118 dst_sel:DWORD dst_unused:UNUSED_PAD src0_sel:DWORD src1_sel:WORD_1
    ds_read_b64 v[96:97], v96
    ds_read_b64 v[98:99], v98
    v_mfma_f32_16x16x32_bf16 v[112:115], v[84:87], v[172:175], v[112:115]
    v_lshlrev_b32_sdwa v100, 3, v119 dst_sel:DWORD dst_unused:UNUSED_PAD src0_sel:DWORD src1_sel:WORD_0
    v_lshlrev_b32_sdwa v102, 3, v119 dst_sel:DWORD dst_unused:UNUSED_PAD src0_sel:DWORD src1_sel:WORD_1
    ds_read_b64 v[100:101], v100
    ds_read_b64 v[102:103], v102
    buffer_load_dwordx4 v[116:119], v69, s[12:15], s20 offen offset:2048 sc1
    s_waitcnt lgkmcnt(9)
    v_smfmac_f32_16x16x64_bf16 v[20:23], v[64:67], v[104:111], v68
    s_nop 0
    v_cvt_pk_bf16_f32 v112, v112, v113
    v_cvt_pk_bf16_f32 v113, v114, v115
    ds_write_b64 v70, v[112:113] offset:256
    v_mfma_f32_16x16x32_bf16 v[112:115], v[72:75], v[176:179], 0
    v_mfma_f32_16x16x32_bf16 v[112:115], v[76:79], v[180:183], v[112:115]
    s_waitcnt vmcnt(2)
    v_lshlrev_b32_sdwa v104, 3, v120 dst_sel:DWORD dst_unused:UNUSED_PAD src0_sel:DWORD src1_sel:WORD_0
    v_lshlrev_b32_sdwa v106, 3, v120 dst_sel:DWORD dst_unused:UNUSED_PAD src0_sel:DWORD src1_sel:WORD_1
    ds_read_b64 v[104:105], v104
    ds_read_b64 v[106:107], v106
    v_mfma_f32_16x16x32_bf16 v[112:115], v[80:83], v[184:187], v[112:115]
    v_mfma_f32_16x16x32_bf16 v[112:115], v[84:87], v[188:191], v[112:115]
    v_lshlrev_b32_sdwa v108, 3, v121 dst_sel:DWORD dst_unused:UNUSED_PAD src0_sel:DWORD src1_sel:WORD_0
    v_lshlrev_b32_sdwa v110, 3, v121 dst_sel:DWORD dst_unused:UNUSED_PAD src0_sel:DWORD src1_sel:WORD_1
    ds_read_b64 v[108:109], v108
    ds_read_b64 v[110:111], v110
    s_waitcnt lgkmcnt(9)
    v_smfmac_f32_16x16x64_bf16 v[24:27], v[64:67], v[88:95], v68
    s_nop 1
    v_cvt_pk_bf16_f32 v112, v112, v113
    v_cvt_pk_bf16_f32 v113, v114, v115
    ds_write_b64 v70, v[112:113] offset:384
    v_mfma_f32_16x16x32_bf16 v[112:115], v[72:75], v[192:195], 0
    v_lshlrev_b32_sdwa v88, 3, v122 dst_sel:DWORD dst_unused:UNUSED_PAD src0_sel:DWORD src1_sel:WORD_0
    v_lshlrev_b32_sdwa v90, 3, v122 dst_sel:DWORD dst_unused:UNUSED_PAD src0_sel:DWORD src1_sel:WORD_1
    ds_read_b64 v[88:89], v88
    ds_read_b64 v[90:91], v90
    v_mfma_f32_16x16x32_bf16 v[112:115], v[76:79], v[196:199], v[112:115]
    v_lshlrev_b32_sdwa v92, 3, v123 dst_sel:DWORD dst_unused:UNUSED_PAD src0_sel:DWORD src1_sel:WORD_0
    v_lshlrev_b32_sdwa v94, 3, v123 dst_sel:DWORD dst_unused:UNUSED_PAD src0_sel:DWORD src1_sel:WORD_1
    ds_read_b64 v[92:93], v92
    ds_read_b64 v[94:95], v94
    buffer_load_dwordx4 v[120:123], v69, s[12:15], s20 offen offset:3072 sc1
    s_add_u32 s20, s20, 61440
    s_waitcnt lgkmcnt(10)
    v_smfmac_f32_16x16x64_bf16 v[28:31], v[64:67], v[96:103], v68
    s_setprio 2
    v_mfma_f32_16x16x32_bf16 v[112:115], v[80:83], v[200:203], v[112:115]
    s_waitcnt vmcnt(2)
    v_lshlrev_b32_sdwa v96, 3, v124 dst_sel:DWORD dst_unused:UNUSED_PAD src0_sel:DWORD src1_sel:WORD_0
    v_lshlrev_b32_sdwa v98, 3, v124 dst_sel:DWORD dst_unused:UNUSED_PAD src0_sel:DWORD src1_sel:WORD_1
    ds_read_b64 v[96:97], v96
    ds_read_b64 v[98:99], v98
    v_mfma_f32_16x16x32_bf16 v[112:115], v[84:87], v[204:207], v[112:115]
    v_lshlrev_b32_sdwa v100, 3, v125 dst_sel:DWORD dst_unused:UNUSED_PAD src0_sel:DWORD src1_sel:WORD_0
    v_lshlrev_b32_sdwa v102, 3, v125 dst_sel:DWORD dst_unused:UNUSED_PAD src0_sel:DWORD src1_sel:WORD_1
    ds_read_b64 v[100:101], v100
    ds_read_b64 v[102:103], v102
    s_waitcnt lgkmcnt(9)
    v_smfmac_f32_16x16x64_bf16 v[32:35], v[64:67], v[104:111], v68
    s_nop 1
    v_cvt_pk_bf16_f32 v112, v112, v113
    v_cvt_pk_bf16_f32 v113, v114, v115
    ds_write_b64 v70, v[112:113] offset:512
    v_mfma_f32_16x16x32_bf16 v[112:115], v[72:75], v[208:211], 0
    v_lshlrev_b32_sdwa v104, 3, v126 dst_sel:DWORD dst_unused:UNUSED_PAD src0_sel:DWORD src1_sel:WORD_0
    v_lshlrev_b32_sdwa v106, 3, v126 dst_sel:DWORD dst_unused:UNUSED_PAD src0_sel:DWORD src1_sel:WORD_1
    ds_read_b64 v[104:105], v104
    ds_read_b64 v[106:107], v106
    v_mfma_f32_16x16x32_bf16 v[112:115], v[76:79], v[212:215], v[112:115]
    v_lshlrev_b32_sdwa v108, 3, v127 dst_sel:DWORD dst_unused:UNUSED_PAD src0_sel:DWORD src1_sel:WORD_0
    v_lshlrev_b32_sdwa v110, 3, v127 dst_sel:DWORD dst_unused:UNUSED_PAD src0_sel:DWORD src1_sel:WORD_1
    ds_read_b64 v[108:109], v108
    ds_read_b64 v[110:111], v110
    buffer_load_dwordx4 v[124:127], v69, s[12:15], s20 offen offset:0 sc1
    s_waitcnt lgkmcnt(9)
    v_smfmac_f32_16x16x64_bf16 v[36:39], v[64:67], v[88:95], v68
    v_mfma_f32_16x16x32_bf16 v[112:115], v[80:83], v[216:219], v[112:115]
    s_waitcnt vmcnt(2)
    v_lshlrev_b32_sdwa v88, 3, v116 dst_sel:DWORD dst_unused:UNUSED_PAD src0_sel:DWORD src1_sel:WORD_0
    v_lshlrev_b32_sdwa v90, 3, v116 dst_sel:DWORD dst_unused:UNUSED_PAD src0_sel:DWORD src1_sel:WORD_1
    ds_read_b64 v[88:89], v88
    ds_read_b64 v[90:91], v90
    v_mfma_f32_16x16x32_bf16 v[112:115], v[84:87], v[220:223], v[112:115]
    v_lshlrev_b32_sdwa v92, 3, v117 dst_sel:DWORD dst_unused:UNUSED_PAD src0_sel:DWORD src1_sel:WORD_0
    v_lshlrev_b32_sdwa v94, 3, v117 dst_sel:DWORD dst_unused:UNUSED_PAD src0_sel:DWORD src1_sel:WORD_1
    ds_read_b64 v[92:93], v92
    ds_read_b64 v[94:95], v94
    s_waitcnt lgkmcnt(9)
    v_smfmac_f32_16x16x64_bf16 v[40:43], v[64:67], v[96:103], v68
    s_nop 1
    v_cvt_pk_bf16_f32 v112, v112, v113
    v_cvt_pk_bf16_f32 v113, v114, v115
    ds_write_b64 v70, v[112:113] offset:640
    v_mfma_f32_16x16x32_bf16 v[112:115], v[72:75], v[224:227], 0
    v_mfma_f32_16x16x32_bf16 v[112:115], v[76:79], v[228:231], v[112:115]
    v_lshlrev_b32_sdwa v96, 3, v118 dst_sel:DWORD dst_unused:UNUSED_PAD src0_sel:DWORD src1_sel:WORD_0
    v_lshlrev_b32_sdwa v98, 3, v118 dst_sel:DWORD dst_unused:UNUSED_PAD src0_sel:DWORD src1_sel:WORD_1
    ds_read_b64 v[96:97], v96
    ds_read_b64 v[98:99], v98
    v_mfma_f32_16x16x32_bf16 v[112:115], v[80:83], v[232:235], v[112:115]
    v_mfma_f32_16x16x32_bf16 v[112:115], v[84:87], v[236:239], v[112:115]
    v_lshlrev_b32_sdwa v100, 3, v119 dst_sel:DWORD dst_unused:UNUSED_PAD src0_sel:DWORD src1_sel:WORD_0
    v_lshlrev_b32_sdwa v102, 3, v119 dst_sel:DWORD dst_unused:UNUSED_PAD src0_sel:DWORD src1_sel:WORD_1
    ds_read_b64 v[100:101], v100
    ds_read_b64 v[102:103], v102
    buffer_load_dwordx4 v[116:119], v69, s[12:15], s20 offen offset:1024 sc1
    s_waitcnt lgkmcnt(9)
    v_smfmac_f32_16x16x64_bf16 v[44:47], v[64:67], v[104:111], v68
    s_nop 0
    v_cvt_pk_bf16_f32 v112, v112, v113
    v_cvt_pk_bf16_f32 v113, v114, v115
    ds_write_b64 v70, v[112:113] offset:768
    s_setprio 1
    v_mfma_f32_16x16x32_bf16 v[112:115], v[72:75], v[240:243], 0
    buffer_load_dwordx4 v[72:75], v69, s[12:15], s21 offen offset:0
    s_waitcnt vmcnt(3)
    v_lshlrev_b32_sdwa v104, 3, v120 dst_sel:DWORD dst_unused:UNUSED_PAD src0_sel:DWORD src1_sel:WORD_0
    v_lshlrev_b32_sdwa v106, 3, v120 dst_sel:DWORD dst_unused:UNUSED_PAD src0_sel:DWORD src1_sel:WORD_1
    ds_read_b64 v[104:105], v104
    ds_read_b64 v[106:107], v106
    v_mfma_f32_16x16x32_bf16 v[112:115], v[76:79], v[244:247], v[112:115]
    buffer_load_dwordx4 v[76:79], v69, s[12:15], s21 offen offset:1024
    v_lshlrev_b32_sdwa v108, 3, v121 dst_sel:DWORD dst_unused:UNUSED_PAD src0_sel:DWORD src1_sel:WORD_0
    v_lshlrev_b32_sdwa v110, 3, v121 dst_sel:DWORD dst_unused:UNUSED_PAD src0_sel:DWORD src1_sel:WORD_1
    ds_read_b64 v[108:109], v108
    ds_read_b64 v[110:111], v110
    s_waitcnt lgkmcnt(10)
    v_smfmac_f32_16x16x64_bf16 v[48:51], v[64:67], v[88:95], v68
    v_mfma_f32_16x16x32_bf16 v[112:115], v[80:83], v[248:251], v[112:115]
    buffer_load_dwordx4 v[80:83], v69, s[12:15], s19 offen offset:0
    v_lshlrev_b32_sdwa v88, 3, v122 dst_sel:DWORD dst_unused:UNUSED_PAD src0_sel:DWORD src1_sel:WORD_0
    v_lshlrev_b32_sdwa v90, 3, v122 dst_sel:DWORD dst_unused:UNUSED_PAD src0_sel:DWORD src1_sel:WORD_1
    ds_read_b64 v[88:89], v88
    ds_read_b64 v[90:91], v90
    v_mfma_f32_16x16x32_bf16 v[112:115], v[84:87], v[252:255], v[112:115]
    buffer_load_dwordx4 v[84:87], v69, s[12:15], s19 offen offset:1024
    s_add_u32 s21, s21, 4096
    s_add_u32 s19, s19, 4096
    v_lshlrev_b32_sdwa v92, 3, v123 dst_sel:DWORD dst_unused:UNUSED_PAD src0_sel:DWORD src1_sel:WORD_0
    v_lshlrev_b32_sdwa v94, 3, v123 dst_sel:DWORD dst_unused:UNUSED_PAD src0_sel:DWORD src1_sel:WORD_1
    ds_read_b64 v[92:93], v92
    ds_read_b64 v[94:95], v94
    buffer_load_dwordx4 v[120:123], v69, s[12:15], s20 offen offset:2048 sc1
    s_waitcnt lgkmcnt(9)
    v_smfmac_f32_16x16x64_bf16 v[52:55], v[64:67], v[96:103], v68
    v_cvt_pk_bf16_f32 v112, v112, v113
    v_cvt_pk_bf16_f32 v113, v114, v115
    ds_write_b64 v70, v[112:113] offset:896
    s_add_u32 s23, s23, 1
    s_cmp_eq_u32 s23, 5
    s_cselect_b32 s35, 4294836224, s32
    s_cselect_b32 s23, 0, s23
    v_add_u32 v70, s35, v70
    s_waitcnt vmcnt(6)
    v_lshlrev_b32_sdwa v96, 3, v124 dst_sel:DWORD dst_unused:UNUSED_PAD src0_sel:DWORD src1_sel:WORD_0
    v_lshlrev_b32_sdwa v98, 3, v124 dst_sel:DWORD dst_unused:UNUSED_PAD src0_sel:DWORD src1_sel:WORD_1
    ds_read_b64 v[96:97], v96
    ds_read_b64 v[98:99], v98
    v_lshlrev_b32_sdwa v100, 3, v125 dst_sel:DWORD dst_unused:UNUSED_PAD src0_sel:DWORD src1_sel:WORD_0
    v_lshlrev_b32_sdwa v102, 3, v125 dst_sel:DWORD dst_unused:UNUSED_PAD src0_sel:DWORD src1_sel:WORD_1
    ds_read_b64 v[100:101], v100
    ds_read_b64 v[102:103], v102
    s_waitcnt lgkmcnt(9)
    v_smfmac_f32_16x16x64_bf16 v[56:59], v[64:67], v[104:111], v68
    s_setprio 0
    v_lshlrev_b32_sdwa v104, 3, v126 dst_sel:DWORD dst_unused:UNUSED_PAD src0_sel:DWORD src1_sel:WORD_0
    v_lshlrev_b32_sdwa v106, 3, v126 dst_sel:DWORD dst_unused:UNUSED_PAD src0_sel:DWORD src1_sel:WORD_1
    ds_read_b64 v[104:105], v104
    ds_read_b64 v[106:107], v106
    v_lshlrev_b32_sdwa v108, 3, v127 dst_sel:DWORD dst_unused:UNUSED_PAD src0_sel:DWORD src1_sel:WORD_0
    v_lshlrev_b32_sdwa v110, 3, v127 dst_sel:DWORD dst_unused:UNUSED_PAD src0_sel:DWORD src1_sel:WORD_1
    ds_read_b64 v[108:109], v108
    ds_read_b64 v[110:111], v110
    buffer_load_dwordx4 v[124:127], v69, s[12:15], s20 offen offset:3072 sc1
    s_add_u32 s20, s20, 4096
    s_waitcnt lgkmcnt(9)
    v_smfmac_f32_16x16x64_bf16 v[60:63], v[64:67], v[88:95], v68
    s_waitcnt lgkmcnt(8)
    s_barrier

    s_cmp_eq_u32 s22, 7
    s_cbranch_scc1 k1_kernel_fin

    s_setprio 3
    s_waitcnt vmcnt(6)
    v_lshlrev_b32_sdwa v88, 3, v116 dst_sel:DWORD dst_unused:UNUSED_PAD src0_sel:DWORD src1_sel:WORD_0
    v_lshlrev_b32_sdwa v90, 3, v116 dst_sel:DWORD dst_unused:UNUSED_PAD src0_sel:DWORD src1_sel:WORD_1
    ds_read_b64 v[88:89], v88
    ds_read_b64 v[90:91], v90
    v_lshlrev_b32_sdwa v92, 3, v117 dst_sel:DWORD dst_unused:UNUSED_PAD src0_sel:DWORD src1_sel:WORD_0
    v_lshlrev_b32_sdwa v94, 3, v117 dst_sel:DWORD dst_unused:UNUSED_PAD src0_sel:DWORD src1_sel:WORD_1
    ds_read_b64 v[92:93], v92
    ds_read_b64 v[94:95], v94
    s_waitcnt lgkmcnt(8)
    v_smfmac_f32_16x16x64_bf16 v[0:3], v[64:67], v[96:103], v68
    s_waitcnt vmcnt(5)
    v_mfma_f32_16x16x32_bf16 v[112:115], v[72:75], v[128:131], 0
    v_lshlrev_b32_sdwa v96, 3, v118 dst_sel:DWORD dst_unused:UNUSED_PAD src0_sel:DWORD src1_sel:WORD_0
    v_lshlrev_b32_sdwa v98, 3, v118 dst_sel:DWORD dst_unused:UNUSED_PAD src0_sel:DWORD src1_sel:WORD_1
    ds_read_b64 v[96:97], v96
    ds_read_b64 v[98:99], v98
    s_waitcnt vmcnt(4)
    v_mfma_f32_16x16x32_bf16 v[112:115], v[76:79], v[132:135], v[112:115]
    v_lshlrev_b32_sdwa v100, 3, v119 dst_sel:DWORD dst_unused:UNUSED_PAD src0_sel:DWORD src1_sel:WORD_0
    v_lshlrev_b32_sdwa v102, 3, v119 dst_sel:DWORD dst_unused:UNUSED_PAD src0_sel:DWORD src1_sel:WORD_1
    ds_read_b64 v[100:101], v100
    ds_read_b64 v[102:103], v102
    buffer_load_dwordx4 v[116:119], v69, s[12:15], s20 offen offset:0 sc1
    s_waitcnt lgkmcnt(8)
    v_smfmac_f32_16x16x64_bf16 v[4:7], v[64:67], v[104:111], v68
    s_waitcnt vmcnt(4)
    v_mfma_f32_16x16x32_bf16 v[112:115], v[80:83], v[136:139], v[112:115]
    s_waitcnt vmcnt(2)
    v_lshlrev_b32_sdwa v104, 3, v120 dst_sel:DWORD dst_unused:UNUSED_PAD src0_sel:DWORD src1_sel:WORD_0
    v_lshlrev_b32_sdwa v106, 3, v120 dst_sel:DWORD dst_unused:UNUSED_PAD src0_sel:DWORD src1_sel:WORD_1
    ds_read_b64 v[104:105], v104
    ds_read_b64 v[106:107], v106
    s_waitcnt vmcnt(3)
    v_mfma_f32_16x16x32_bf16 v[112:115], v[84:87], v[140:143], v[112:115]
    v_lshlrev_b32_sdwa v108, 3, v121 dst_sel:DWORD dst_unused:UNUSED_PAD src0_sel:DWORD src1_sel:WORD_0
    v_lshlrev_b32_sdwa v110, 3, v121 dst_sel:DWORD dst_unused:UNUSED_PAD src0_sel:DWORD src1_sel:WORD_1
    ds_read_b64 v[108:109], v108
    ds_read_b64 v[110:111], v110
    s_waitcnt lgkmcnt(8)
    v_smfmac_f32_16x16x64_bf16 v[8:11], v[64:67], v[88:95], v68
    s_nop 1
    v_cvt_pk_bf16_f32 v112, v112, v113
    v_cvt_pk_bf16_f32 v113, v114, v115
    ds_write_b64 v70, v[112:113] offset:0
    v_mfma_f32_16x16x32_bf16 v[112:115], v[72:75], v[144:147], 0
    v_mfma_f32_16x16x32_bf16 v[112:115], v[76:79], v[148:151], v[112:115]
    v_lshlrev_b32_sdwa v88, 3, v122 dst_sel:DWORD dst_unused:UNUSED_PAD src0_sel:DWORD src1_sel:WORD_0
    v_lshlrev_b32_sdwa v90, 3, v122 dst_sel:DWORD dst_unused:UNUSED_PAD src0_sel:DWORD src1_sel:WORD_1
    ds_read_b64 v[88:89], v88
    ds_read_b64 v[90:91], v90
    v_mfma_f32_16x16x32_bf16 v[112:115], v[80:83], v[152:155], v[112:115]
    v_mfma_f32_16x16x32_bf16 v[112:115], v[84:87], v[156:159], v[112:115]
    v_lshlrev_b32_sdwa v92, 3, v123 dst_sel:DWORD dst_unused:UNUSED_PAD src0_sel:DWORD src1_sel:WORD_0
    v_lshlrev_b32_sdwa v94, 3, v123 dst_sel:DWORD dst_unused:UNUSED_PAD src0_sel:DWORD src1_sel:WORD_1
    ds_read_b64 v[92:93], v92
    ds_read_b64 v[94:95], v94
    buffer_load_dwordx4 v[120:123], v69, s[12:15], s20 offen offset:1024 sc1
    s_waitcnt lgkmcnt(9)
    v_smfmac_f32_16x16x64_bf16 v[12:15], v[64:67], v[96:103], v68
    s_nop 0
    v_cvt_pk_bf16_f32 v112, v112, v113
    v_cvt_pk_bf16_f32 v113, v114, v115
    ds_write_b64 v70, v[112:113] offset:128
    v_mfma_f32_16x16x32_bf16 v[112:115], v[72:75], v[160:163], 0
    s_waitcnt vmcnt(2)
    v_lshlrev_b32_sdwa v96, 3, v124 dst_sel:DWORD dst_unused:UNUSED_PAD src0_sel:DWORD src1_sel:WORD_0
    v_lshlrev_b32_sdwa v98, 3, v124 dst_sel:DWORD dst_unused:UNUSED_PAD src0_sel:DWORD src1_sel:WORD_1
    ds_read_b64 v[96:97], v96
    ds_read_b64 v[98:99], v98
    v_mfma_f32_16x16x32_bf16 v[112:115], v[76:79], v[164:167], v[112:115]
    v_lshlrev_b32_sdwa v100, 3, v125 dst_sel:DWORD dst_unused:UNUSED_PAD src0_sel:DWORD src1_sel:WORD_0
    v_lshlrev_b32_sdwa v102, 3, v125 dst_sel:DWORD dst_unused:UNUSED_PAD src0_sel:DWORD src1_sel:WORD_1
    ds_read_b64 v[100:101], v100
    ds_read_b64 v[102:103], v102
    s_waitcnt lgkmcnt(10)
    v_smfmac_f32_16x16x64_bf16 v[16:19], v[64:67], v[104:111], v68
    v_mfma_f32_16x16x32_bf16 v[112:115], v[80:83], v[168:171], v[112:115]
    v_lshlrev_b32_sdwa v104, 3, v126 dst_sel:DWORD dst_unused:UNUSED_PAD src0_sel:DWORD src1_sel:WORD_0
    v_lshlrev_b32_sdwa v106, 3, v126 dst_sel:DWORD dst_unused:UNUSED_PAD src0_sel:DWORD src1_sel:WORD_1
    ds_read_b64 v[104:105], v104
    ds_read_b64 v[106:107], v106
    v_mfma_f32_16x16x32_bf16 v[112:115], v[84:87], v[172:175], v[112:115]
    v_lshlrev_b32_sdwa v108, 3, v127 dst_sel:DWORD dst_unused:UNUSED_PAD src0_sel:DWORD src1_sel:WORD_0
    v_lshlrev_b32_sdwa v110, 3, v127 dst_sel:DWORD dst_unused:UNUSED_PAD src0_sel:DWORD src1_sel:WORD_1
    ds_read_b64 v[108:109], v108
    ds_read_b64 v[110:111], v110
    buffer_load_dwordx4 v[124:127], v69, s[12:15], s20 offen offset:2048 sc1
    s_waitcnt lgkmcnt(9)
    v_smfmac_f32_16x16x64_bf16 v[20:23], v[64:67], v[88:95], v68
    s_nop 0
    v_cvt_pk_bf16_f32 v112, v112, v113
    v_cvt_pk_bf16_f32 v113, v114, v115
    ds_write_b64 v70, v[112:113] offset:256
    v_mfma_f32_16x16x32_bf16 v[112:115], v[72:75], v[176:179], 0
    v_mfma_f32_16x16x32_bf16 v[112:115], v[76:79], v[180:183], v[112:115]
    s_waitcnt vmcnt(2)
    v_lshlrev_b32_sdwa v88, 3, v116 dst_sel:DWORD dst_unused:UNUSED_PAD src0_sel:DWORD src1_sel:WORD_0
    v_lshlrev_b32_sdwa v90, 3, v116 dst_sel:DWORD dst_unused:UNUSED_PAD src0_sel:DWORD src1_sel:WORD_1
    ds_read_b64 v[88:89], v88
    ds_read_b64 v[90:91], v90
    v_mfma_f32_16x16x32_bf16 v[112:115], v[80:83], v[184:187], v[112:115]
    v_mfma_f32_16x16x32_bf16 v[112:115], v[84:87], v[188:191], v[112:115]
    v_lshlrev_b32_sdwa v92, 3, v117 dst_sel:DWORD dst_unused:UNUSED_PAD src0_sel:DWORD src1_sel:WORD_0
    v_lshlrev_b32_sdwa v94, 3, v117 dst_sel:DWORD dst_unused:UNUSED_PAD src0_sel:DWORD src1_sel:WORD_1
    ds_read_b64 v[92:93], v92
    ds_read_b64 v[94:95], v94
    s_waitcnt lgkmcnt(9)
    v_smfmac_f32_16x16x64_bf16 v[24:27], v[64:67], v[96:103], v68
    s_nop 1
    v_cvt_pk_bf16_f32 v112, v112, v113
    v_cvt_pk_bf16_f32 v113, v114, v115
    ds_write_b64 v70, v[112:113] offset:384
    v_mfma_f32_16x16x32_bf16 v[112:115], v[72:75], v[192:195], 0
    v_lshlrev_b32_sdwa v96, 3, v118 dst_sel:DWORD dst_unused:UNUSED_PAD src0_sel:DWORD src1_sel:WORD_0
    v_lshlrev_b32_sdwa v98, 3, v118 dst_sel:DWORD dst_unused:UNUSED_PAD src0_sel:DWORD src1_sel:WORD_1
    ds_read_b64 v[96:97], v96
    ds_read_b64 v[98:99], v98
    v_mfma_f32_16x16x32_bf16 v[112:115], v[76:79], v[196:199], v[112:115]
    v_lshlrev_b32_sdwa v100, 3, v119 dst_sel:DWORD dst_unused:UNUSED_PAD src0_sel:DWORD src1_sel:WORD_0
    v_lshlrev_b32_sdwa v102, 3, v119 dst_sel:DWORD dst_unused:UNUSED_PAD src0_sel:DWORD src1_sel:WORD_1
    ds_read_b64 v[100:101], v100
    ds_read_b64 v[102:103], v102
    buffer_load_dwordx4 v[116:119], v69, s[12:15], s20 offen offset:3072 sc1
    s_add_u32 s20, s20, 61440
    s_waitcnt lgkmcnt(10)
    v_smfmac_f32_16x16x64_bf16 v[28:31], v[64:67], v[104:111], v68
    s_setprio 2
    v_mfma_f32_16x16x32_bf16 v[112:115], v[80:83], v[200:203], v[112:115]
    s_waitcnt vmcnt(2)
    v_lshlrev_b32_sdwa v104, 3, v120 dst_sel:DWORD dst_unused:UNUSED_PAD src0_sel:DWORD src1_sel:WORD_0
    v_lshlrev_b32_sdwa v106, 3, v120 dst_sel:DWORD dst_unused:UNUSED_PAD src0_sel:DWORD src1_sel:WORD_1
    ds_read_b64 v[104:105], v104
    ds_read_b64 v[106:107], v106
    v_mfma_f32_16x16x32_bf16 v[112:115], v[84:87], v[204:207], v[112:115]
    v_lshlrev_b32_sdwa v108, 3, v121 dst_sel:DWORD dst_unused:UNUSED_PAD src0_sel:DWORD src1_sel:WORD_0
    v_lshlrev_b32_sdwa v110, 3, v121 dst_sel:DWORD dst_unused:UNUSED_PAD src0_sel:DWORD src1_sel:WORD_1
    ds_read_b64 v[108:109], v108
    ds_read_b64 v[110:111], v110
    s_waitcnt lgkmcnt(9)
    v_smfmac_f32_16x16x64_bf16 v[32:35], v[64:67], v[88:95], v68
    s_nop 1
    v_cvt_pk_bf16_f32 v112, v112, v113
    v_cvt_pk_bf16_f32 v113, v114, v115
    ds_write_b64 v70, v[112:113] offset:512
    v_mfma_f32_16x16x32_bf16 v[112:115], v[72:75], v[208:211], 0
    v_lshlrev_b32_sdwa v88, 3, v122 dst_sel:DWORD dst_unused:UNUSED_PAD src0_sel:DWORD src1_sel:WORD_0
    v_lshlrev_b32_sdwa v90, 3, v122 dst_sel:DWORD dst_unused:UNUSED_PAD src0_sel:DWORD src1_sel:WORD_1
    ds_read_b64 v[88:89], v88
    ds_read_b64 v[90:91], v90
    v_mfma_f32_16x16x32_bf16 v[112:115], v[76:79], v[212:215], v[112:115]
    v_lshlrev_b32_sdwa v92, 3, v123 dst_sel:DWORD dst_unused:UNUSED_PAD src0_sel:DWORD src1_sel:WORD_0
    v_lshlrev_b32_sdwa v94, 3, v123 dst_sel:DWORD dst_unused:UNUSED_PAD src0_sel:DWORD src1_sel:WORD_1
    ds_read_b64 v[92:93], v92
    ds_read_b64 v[94:95], v94
    buffer_load_dwordx4 v[120:123], v69, s[12:15], s20 offen offset:0 sc1
    s_waitcnt lgkmcnt(9)
    v_smfmac_f32_16x16x64_bf16 v[36:39], v[64:67], v[96:103], v68
    v_mfma_f32_16x16x32_bf16 v[112:115], v[80:83], v[216:219], v[112:115]
    s_waitcnt vmcnt(2)
    v_lshlrev_b32_sdwa v96, 3, v124 dst_sel:DWORD dst_unused:UNUSED_PAD src0_sel:DWORD src1_sel:WORD_0
    v_lshlrev_b32_sdwa v98, 3, v124 dst_sel:DWORD dst_unused:UNUSED_PAD src0_sel:DWORD src1_sel:WORD_1
    ds_read_b64 v[96:97], v96
    ds_read_b64 v[98:99], v98
    v_mfma_f32_16x16x32_bf16 v[112:115], v[84:87], v[220:223], v[112:115]
    v_lshlrev_b32_sdwa v100, 3, v125 dst_sel:DWORD dst_unused:UNUSED_PAD src0_sel:DWORD src1_sel:WORD_0
    v_lshlrev_b32_sdwa v102, 3, v125 dst_sel:DWORD dst_unused:UNUSED_PAD src0_sel:DWORD src1_sel:WORD_1
    ds_read_b64 v[100:101], v100
    ds_read_b64 v[102:103], v102
    s_waitcnt lgkmcnt(9)
    v_smfmac_f32_16x16x64_bf16 v[40:43], v[64:67], v[104:111], v68
    s_nop 1
    v_cvt_pk_bf16_f32 v112, v112, v113
    v_cvt_pk_bf16_f32 v113, v114, v115
    ds_write_b64 v70, v[112:113] offset:640
    v_mfma_f32_16x16x32_bf16 v[112:115], v[72:75], v[224:227], 0
    v_mfma_f32_16x16x32_bf16 v[112:115], v[76:79], v[228:231], v[112:115]
    v_lshlrev_b32_sdwa v104, 3, v126 dst_sel:DWORD dst_unused:UNUSED_PAD src0_sel:DWORD src1_sel:WORD_0
    v_lshlrev_b32_sdwa v106, 3, v126 dst_sel:DWORD dst_unused:UNUSED_PAD src0_sel:DWORD src1_sel:WORD_1
    ds_read_b64 v[104:105], v104
    ds_read_b64 v[106:107], v106
    v_mfma_f32_16x16x32_bf16 v[112:115], v[80:83], v[232:235], v[112:115]
    v_mfma_f32_16x16x32_bf16 v[112:115], v[84:87], v[236:239], v[112:115]
    v_lshlrev_b32_sdwa v108, 3, v127 dst_sel:DWORD dst_unused:UNUSED_PAD src0_sel:DWORD src1_sel:WORD_0
    v_lshlrev_b32_sdwa v110, 3, v127 dst_sel:DWORD dst_unused:UNUSED_PAD src0_sel:DWORD src1_sel:WORD_1
    ds_read_b64 v[108:109], v108
    ds_read_b64 v[110:111], v110
    buffer_load_dwordx4 v[124:127], v69, s[12:15], s20 offen offset:1024 sc1
    s_waitcnt lgkmcnt(9)
    v_smfmac_f32_16x16x64_bf16 v[44:47], v[64:67], v[88:95], v68
    s_nop 0
    v_cvt_pk_bf16_f32 v112, v112, v113
    v_cvt_pk_bf16_f32 v113, v114, v115
    ds_write_b64 v70, v[112:113] offset:768
    s_setprio 1
    v_mfma_f32_16x16x32_bf16 v[112:115], v[72:75], v[240:243], 0
    buffer_load_dwordx4 v[72:75], v69, s[12:15], s21 offen offset:0
    s_waitcnt vmcnt(3)
    v_lshlrev_b32_sdwa v88, 3, v116 dst_sel:DWORD dst_unused:UNUSED_PAD src0_sel:DWORD src1_sel:WORD_0
    v_lshlrev_b32_sdwa v90, 3, v116 dst_sel:DWORD dst_unused:UNUSED_PAD src0_sel:DWORD src1_sel:WORD_1
    ds_read_b64 v[88:89], v88
    ds_read_b64 v[90:91], v90
    v_mfma_f32_16x16x32_bf16 v[112:115], v[76:79], v[244:247], v[112:115]
    buffer_load_dwordx4 v[76:79], v69, s[12:15], s21 offen offset:1024
    v_lshlrev_b32_sdwa v92, 3, v117 dst_sel:DWORD dst_unused:UNUSED_PAD src0_sel:DWORD src1_sel:WORD_0
    v_lshlrev_b32_sdwa v94, 3, v117 dst_sel:DWORD dst_unused:UNUSED_PAD src0_sel:DWORD src1_sel:WORD_1
    ds_read_b64 v[92:93], v92
    ds_read_b64 v[94:95], v94
    s_waitcnt lgkmcnt(10)
    v_smfmac_f32_16x16x64_bf16 v[48:51], v[64:67], v[96:103], v68
    v_mfma_f32_16x16x32_bf16 v[112:115], v[80:83], v[248:251], v[112:115]
    buffer_load_dwordx4 v[80:83], v69, s[12:15], s19 offen offset:0
    v_lshlrev_b32_sdwa v96, 3, v118 dst_sel:DWORD dst_unused:UNUSED_PAD src0_sel:DWORD src1_sel:WORD_0
    v_lshlrev_b32_sdwa v98, 3, v118 dst_sel:DWORD dst_unused:UNUSED_PAD src0_sel:DWORD src1_sel:WORD_1
    ds_read_b64 v[96:97], v96
    ds_read_b64 v[98:99], v98
    v_mfma_f32_16x16x32_bf16 v[112:115], v[84:87], v[252:255], v[112:115]
    buffer_load_dwordx4 v[84:87], v69, s[12:15], s19 offen offset:1024
    s_add_u32 s21, s21, 4096
    s_add_u32 s19, s19, 4096
    v_lshlrev_b32_sdwa v100, 3, v119 dst_sel:DWORD dst_unused:UNUSED_PAD src0_sel:DWORD src1_sel:WORD_0
    v_lshlrev_b32_sdwa v102, 3, v119 dst_sel:DWORD dst_unused:UNUSED_PAD src0_sel:DWORD src1_sel:WORD_1
    ds_read_b64 v[100:101], v100
    ds_read_b64 v[102:103], v102
    buffer_load_dwordx4 v[116:119], v69, s[12:15], s20 offen offset:2048 sc1
    s_waitcnt lgkmcnt(9)
    v_smfmac_f32_16x16x64_bf16 v[52:55], v[64:67], v[104:111], v68
    v_cvt_pk_bf16_f32 v112, v112, v113
    v_cvt_pk_bf16_f32 v113, v114, v115
    ds_write_b64 v70, v[112:113] offset:896
    s_add_u32 s23, s23, 1
    s_cmp_eq_u32 s23, 5
    s_cselect_b32 s35, 4294836224, s32
    s_cselect_b32 s23, 0, s23
    v_add_u32 v70, s35, v70
    s_waitcnt vmcnt(6)
    v_lshlrev_b32_sdwa v104, 3, v120 dst_sel:DWORD dst_unused:UNUSED_PAD src0_sel:DWORD src1_sel:WORD_0
    v_lshlrev_b32_sdwa v106, 3, v120 dst_sel:DWORD dst_unused:UNUSED_PAD src0_sel:DWORD src1_sel:WORD_1
    ds_read_b64 v[104:105], v104
    ds_read_b64 v[106:107], v106
    v_lshlrev_b32_sdwa v108, 3, v121 dst_sel:DWORD dst_unused:UNUSED_PAD src0_sel:DWORD src1_sel:WORD_0
    v_lshlrev_b32_sdwa v110, 3, v121 dst_sel:DWORD dst_unused:UNUSED_PAD src0_sel:DWORD src1_sel:WORD_1
    ds_read_b64 v[108:109], v108
    ds_read_b64 v[110:111], v110
    s_waitcnt lgkmcnt(9)
    v_smfmac_f32_16x16x64_bf16 v[56:59], v[64:67], v[88:95], v68
    s_setprio 0
    v_lshlrev_b32_sdwa v88, 3, v122 dst_sel:DWORD dst_unused:UNUSED_PAD src0_sel:DWORD src1_sel:WORD_0
    v_lshlrev_b32_sdwa v90, 3, v122 dst_sel:DWORD dst_unused:UNUSED_PAD src0_sel:DWORD src1_sel:WORD_1
    ds_read_b64 v[88:89], v88
    ds_read_b64 v[90:91], v90
    v_lshlrev_b32_sdwa v92, 3, v123 dst_sel:DWORD dst_unused:UNUSED_PAD src0_sel:DWORD src1_sel:WORD_0
    v_lshlrev_b32_sdwa v94, 3, v123 dst_sel:DWORD dst_unused:UNUSED_PAD src0_sel:DWORD src1_sel:WORD_1
    ds_read_b64 v[92:93], v92
    ds_read_b64 v[94:95], v94
    buffer_load_dwordx4 v[120:123], v69, s[12:15], s20 offen offset:3072 sc1
    s_add_u32 s20, s20, 4096
    s_waitcnt lgkmcnt(9)
    v_smfmac_f32_16x16x64_bf16 v[60:63], v[64:67], v[96:103], v68
    s_waitcnt lgkmcnt(8)
    s_barrier
    s_setprio 3
    s_waitcnt vmcnt(6)
    v_lshlrev_b32_sdwa v96, 3, v124 dst_sel:DWORD dst_unused:UNUSED_PAD src0_sel:DWORD src1_sel:WORD_0
    v_lshlrev_b32_sdwa v98, 3, v124 dst_sel:DWORD dst_unused:UNUSED_PAD src0_sel:DWORD src1_sel:WORD_1
    ds_read_b64 v[96:97], v96
    ds_read_b64 v[98:99], v98
    v_lshlrev_b32_sdwa v100, 3, v125 dst_sel:DWORD dst_unused:UNUSED_PAD src0_sel:DWORD src1_sel:WORD_0
    v_lshlrev_b32_sdwa v102, 3, v125 dst_sel:DWORD dst_unused:UNUSED_PAD src0_sel:DWORD src1_sel:WORD_1
    ds_read_b64 v[100:101], v100
    ds_read_b64 v[102:103], v102
    s_waitcnt lgkmcnt(8)
    v_smfmac_f32_16x16x64_bf16 v[0:3], v[64:67], v[104:111], v68
    s_waitcnt vmcnt(5)
    v_mfma_f32_16x16x32_bf16 v[112:115], v[72:75], v[128:131], 0
    v_lshlrev_b32_sdwa v104, 3, v126 dst_sel:DWORD dst_unused:UNUSED_PAD src0_sel:DWORD src1_sel:WORD_0
    v_lshlrev_b32_sdwa v106, 3, v126 dst_sel:DWORD dst_unused:UNUSED_PAD src0_sel:DWORD src1_sel:WORD_1
    ds_read_b64 v[104:105], v104
    ds_read_b64 v[106:107], v106
    s_waitcnt vmcnt(4)
    v_mfma_f32_16x16x32_bf16 v[112:115], v[76:79], v[132:135], v[112:115]
    v_lshlrev_b32_sdwa v108, 3, v127 dst_sel:DWORD dst_unused:UNUSED_PAD src0_sel:DWORD src1_sel:WORD_0
    v_lshlrev_b32_sdwa v110, 3, v127 dst_sel:DWORD dst_unused:UNUSED_PAD src0_sel:DWORD src1_sel:WORD_1
    ds_read_b64 v[108:109], v108
    ds_read_b64 v[110:111], v110
    buffer_load_dwordx4 v[124:127], v69, s[12:15], s20 offen offset:0 sc1
    s_waitcnt lgkmcnt(8)
    v_smfmac_f32_16x16x64_bf16 v[4:7], v[64:67], v[88:95], v68
    s_waitcnt vmcnt(4)
    v_mfma_f32_16x16x32_bf16 v[112:115], v[80:83], v[136:139], v[112:115]
    s_waitcnt vmcnt(2)
    v_lshlrev_b32_sdwa v88, 3, v116 dst_sel:DWORD dst_unused:UNUSED_PAD src0_sel:DWORD src1_sel:WORD_0
    v_lshlrev_b32_sdwa v90, 3, v116 dst_sel:DWORD dst_unused:UNUSED_PAD src0_sel:DWORD src1_sel:WORD_1
    ds_read_b64 v[88:89], v88
    ds_read_b64 v[90:91], v90
    s_waitcnt vmcnt(3)
    v_mfma_f32_16x16x32_bf16 v[112:115], v[84:87], v[140:143], v[112:115]
    v_lshlrev_b32_sdwa v92, 3, v117 dst_sel:DWORD dst_unused:UNUSED_PAD src0_sel:DWORD src1_sel:WORD_0
    v_lshlrev_b32_sdwa v94, 3, v117 dst_sel:DWORD dst_unused:UNUSED_PAD src0_sel:DWORD src1_sel:WORD_1
    ds_read_b64 v[92:93], v92
    ds_read_b64 v[94:95], v94
    s_waitcnt lgkmcnt(8)
    v_smfmac_f32_16x16x64_bf16 v[8:11], v[64:67], v[96:103], v68
    s_nop 1
    v_cvt_pk_bf16_f32 v112, v112, v113
    v_cvt_pk_bf16_f32 v113, v114, v115
    ds_write_b64 v70, v[112:113] offset:0
    v_mfma_f32_16x16x32_bf16 v[112:115], v[72:75], v[144:147], 0
    v_mfma_f32_16x16x32_bf16 v[112:115], v[76:79], v[148:151], v[112:115]
    v_lshlrev_b32_sdwa v96, 3, v118 dst_sel:DWORD dst_unused:UNUSED_PAD src0_sel:DWORD src1_sel:WORD_0
    v_lshlrev_b32_sdwa v98, 3, v118 dst_sel:DWORD dst_unused:UNUSED_PAD src0_sel:DWORD src1_sel:WORD_1
    ds_read_b64 v[96:97], v96
    ds_read_b64 v[98:99], v98
    v_mfma_f32_16x16x32_bf16 v[112:115], v[80:83], v[152:155], v[112:115]
    v_mfma_f32_16x16x32_bf16 v[112:115], v[84:87], v[156:159], v[112:115]
    v_lshlrev_b32_sdwa v100, 3, v119 dst_sel:DWORD dst_unused:UNUSED_PAD src0_sel:DWORD src1_sel:WORD_0
    v_lshlrev_b32_sdwa v102, 3, v119 dst_sel:DWORD dst_unused:UNUSED_PAD src0_sel:DWORD src1_sel:WORD_1
    ds_read_b64 v[100:101], v100
    ds_read_b64 v[102:103], v102
    buffer_load_dwordx4 v[116:119], v69, s[12:15], s20 offen offset:1024 sc1
    s_waitcnt lgkmcnt(9)
    v_smfmac_f32_16x16x64_bf16 v[12:15], v[64:67], v[104:111], v68
    s_nop 0
    v_cvt_pk_bf16_f32 v112, v112, v113
    v_cvt_pk_bf16_f32 v113, v114, v115
    ds_write_b64 v70, v[112:113] offset:128
    v_mfma_f32_16x16x32_bf16 v[112:115], v[72:75], v[160:163], 0
    s_waitcnt vmcnt(2)
    v_lshlrev_b32_sdwa v104, 3, v120 dst_sel:DWORD dst_unused:UNUSED_PAD src0_sel:DWORD src1_sel:WORD_0
    v_lshlrev_b32_sdwa v106, 3, v120 dst_sel:DWORD dst_unused:UNUSED_PAD src0_sel:DWORD src1_sel:WORD_1
    ds_read_b64 v[104:105], v104
    ds_read_b64 v[106:107], v106
    v_mfma_f32_16x16x32_bf16 v[112:115], v[76:79], v[164:167], v[112:115]
    v_lshlrev_b32_sdwa v108, 3, v121 dst_sel:DWORD dst_unused:UNUSED_PAD src0_sel:DWORD src1_sel:WORD_0
    v_lshlrev_b32_sdwa v110, 3, v121 dst_sel:DWORD dst_unused:UNUSED_PAD src0_sel:DWORD src1_sel:WORD_1
    ds_read_b64 v[108:109], v108
    ds_read_b64 v[110:111], v110
    s_waitcnt lgkmcnt(10)
    v_smfmac_f32_16x16x64_bf16 v[16:19], v[64:67], v[88:95], v68
    v_mfma_f32_16x16x32_bf16 v[112:115], v[80:83], v[168:171], v[112:115]
    v_lshlrev_b32_sdwa v88, 3, v122 dst_sel:DWORD dst_unused:UNUSED_PAD src0_sel:DWORD src1_sel:WORD_0
    v_lshlrev_b32_sdwa v90, 3, v122 dst_sel:DWORD dst_unused:UNUSED_PAD src0_sel:DWORD src1_sel:WORD_1
    ds_read_b64 v[88:89], v88
    ds_read_b64 v[90:91], v90
    v_mfma_f32_16x16x32_bf16 v[112:115], v[84:87], v[172:175], v[112:115]
    v_lshlrev_b32_sdwa v92, 3, v123 dst_sel:DWORD dst_unused:UNUSED_PAD src0_sel:DWORD src1_sel:WORD_0
    v_lshlrev_b32_sdwa v94, 3, v123 dst_sel:DWORD dst_unused:UNUSED_PAD src0_sel:DWORD src1_sel:WORD_1
    ds_read_b64 v[92:93], v92
    ds_read_b64 v[94:95], v94
    buffer_load_dwordx4 v[120:123], v69, s[12:15], s20 offen offset:2048 sc1
    s_waitcnt lgkmcnt(9)
    v_smfmac_f32_16x16x64_bf16 v[20:23], v[64:67], v[96:103], v68
    s_nop 0
    v_cvt_pk_bf16_f32 v112, v112, v113
    v_cvt_pk_bf16_f32 v113, v114, v115
    ds_write_b64 v70, v[112:113] offset:256
    v_mfma_f32_16x16x32_bf16 v[112:115], v[72:75], v[176:179], 0
    v_mfma_f32_16x16x32_bf16 v[112:115], v[76:79], v[180:183], v[112:115]
    s_waitcnt vmcnt(2)
    v_lshlrev_b32_sdwa v96, 3, v124 dst_sel:DWORD dst_unused:UNUSED_PAD src0_sel:DWORD src1_sel:WORD_0
    v_lshlrev_b32_sdwa v98, 3, v124 dst_sel:DWORD dst_unused:UNUSED_PAD src0_sel:DWORD src1_sel:WORD_1
    ds_read_b64 v[96:97], v96
    ds_read_b64 v[98:99], v98
    v_mfma_f32_16x16x32_bf16 v[112:115], v[80:83], v[184:187], v[112:115]
    v_mfma_f32_16x16x32_bf16 v[112:115], v[84:87], v[188:191], v[112:115]
    v_lshlrev_b32_sdwa v100, 3, v125 dst_sel:DWORD dst_unused:UNUSED_PAD src0_sel:DWORD src1_sel:WORD_0
    v_lshlrev_b32_sdwa v102, 3, v125 dst_sel:DWORD dst_unused:UNUSED_PAD src0_sel:DWORD src1_sel:WORD_1
    ds_read_b64 v[100:101], v100
    ds_read_b64 v[102:103], v102
    s_waitcnt lgkmcnt(9)
    v_smfmac_f32_16x16x64_bf16 v[24:27], v[64:67], v[104:111], v68
    s_nop 1
    v_cvt_pk_bf16_f32 v112, v112, v113
    v_cvt_pk_bf16_f32 v113, v114, v115
    ds_write_b64 v70, v[112:113] offset:384
    v_mfma_f32_16x16x32_bf16 v[112:115], v[72:75], v[192:195], 0
    v_lshlrev_b32_sdwa v104, 3, v126 dst_sel:DWORD dst_unused:UNUSED_PAD src0_sel:DWORD src1_sel:WORD_0
    v_lshlrev_b32_sdwa v106, 3, v126 dst_sel:DWORD dst_unused:UNUSED_PAD src0_sel:DWORD src1_sel:WORD_1
    ds_read_b64 v[104:105], v104
    ds_read_b64 v[106:107], v106
    v_mfma_f32_16x16x32_bf16 v[112:115], v[76:79], v[196:199], v[112:115]
    v_lshlrev_b32_sdwa v108, 3, v127 dst_sel:DWORD dst_unused:UNUSED_PAD src0_sel:DWORD src1_sel:WORD_0
    v_lshlrev_b32_sdwa v110, 3, v127 dst_sel:DWORD dst_unused:UNUSED_PAD src0_sel:DWORD src1_sel:WORD_1
    ds_read_b64 v[108:109], v108
    ds_read_b64 v[110:111], v110
    buffer_load_dwordx4 v[124:127], v69, s[12:15], s20 offen offset:3072 sc1
    s_add_u32 s20, s20, 61440
    s_waitcnt lgkmcnt(10)
    v_smfmac_f32_16x16x64_bf16 v[28:31], v[64:67], v[88:95], v68
    s_setprio 2
    v_mfma_f32_16x16x32_bf16 v[112:115], v[80:83], v[200:203], v[112:115]
    s_waitcnt vmcnt(2)
    v_lshlrev_b32_sdwa v88, 3, v116 dst_sel:DWORD dst_unused:UNUSED_PAD src0_sel:DWORD src1_sel:WORD_0
    v_lshlrev_b32_sdwa v90, 3, v116 dst_sel:DWORD dst_unused:UNUSED_PAD src0_sel:DWORD src1_sel:WORD_1
    ds_read_b64 v[88:89], v88
    ds_read_b64 v[90:91], v90
    v_mfma_f32_16x16x32_bf16 v[112:115], v[84:87], v[204:207], v[112:115]
    v_lshlrev_b32_sdwa v92, 3, v117 dst_sel:DWORD dst_unused:UNUSED_PAD src0_sel:DWORD src1_sel:WORD_0
    v_lshlrev_b32_sdwa v94, 3, v117 dst_sel:DWORD dst_unused:UNUSED_PAD src0_sel:DWORD src1_sel:WORD_1
    ds_read_b64 v[92:93], v92
    ds_read_b64 v[94:95], v94
    s_waitcnt lgkmcnt(9)
    v_smfmac_f32_16x16x64_bf16 v[32:35], v[64:67], v[96:103], v68
    s_nop 1
    v_cvt_pk_bf16_f32 v112, v112, v113
    v_cvt_pk_bf16_f32 v113, v114, v115
    ds_write_b64 v70, v[112:113] offset:512
    v_mfma_f32_16x16x32_bf16 v[112:115], v[72:75], v[208:211], 0
    v_lshlrev_b32_sdwa v96, 3, v118 dst_sel:DWORD dst_unused:UNUSED_PAD src0_sel:DWORD src1_sel:WORD_0
    v_lshlrev_b32_sdwa v98, 3, v118 dst_sel:DWORD dst_unused:UNUSED_PAD src0_sel:DWORD src1_sel:WORD_1
    ds_read_b64 v[96:97], v96
    ds_read_b64 v[98:99], v98
    v_mfma_f32_16x16x32_bf16 v[112:115], v[76:79], v[212:215], v[112:115]
    v_lshlrev_b32_sdwa v100, 3, v119 dst_sel:DWORD dst_unused:UNUSED_PAD src0_sel:DWORD src1_sel:WORD_0
    v_lshlrev_b32_sdwa v102, 3, v119 dst_sel:DWORD dst_unused:UNUSED_PAD src0_sel:DWORD src1_sel:WORD_1
    ds_read_b64 v[100:101], v100
    ds_read_b64 v[102:103], v102
    buffer_load_dwordx4 v[116:119], v69, s[12:15], s20 offen offset:0 sc1
    s_waitcnt lgkmcnt(9)
    v_smfmac_f32_16x16x64_bf16 v[36:39], v[64:67], v[104:111], v68
    v_mfma_f32_16x16x32_bf16 v[112:115], v[80:83], v[216:219], v[112:115]
    s_waitcnt vmcnt(2)
    v_lshlrev_b32_sdwa v104, 3, v120 dst_sel:DWORD dst_unused:UNUSED_PAD src0_sel:DWORD src1_sel:WORD_0
    v_lshlrev_b32_sdwa v106, 3, v120 dst_sel:DWORD dst_unused:UNUSED_PAD src0_sel:DWORD src1_sel:WORD_1
    ds_read_b64 v[104:105], v104
    ds_read_b64 v[106:107], v106
    v_mfma_f32_16x16x32_bf16 v[112:115], v[84:87], v[220:223], v[112:115]
    v_lshlrev_b32_sdwa v108, 3, v121 dst_sel:DWORD dst_unused:UNUSED_PAD src0_sel:DWORD src1_sel:WORD_0
    v_lshlrev_b32_sdwa v110, 3, v121 dst_sel:DWORD dst_unused:UNUSED_PAD src0_sel:DWORD src1_sel:WORD_1
    ds_read_b64 v[108:109], v108
    ds_read_b64 v[110:111], v110
    s_waitcnt lgkmcnt(9)
    v_smfmac_f32_16x16x64_bf16 v[40:43], v[64:67], v[88:95], v68
    s_nop 1
    v_cvt_pk_bf16_f32 v112, v112, v113
    v_cvt_pk_bf16_f32 v113, v114, v115
    ds_write_b64 v70, v[112:113] offset:640
    v_mfma_f32_16x16x32_bf16 v[112:115], v[72:75], v[224:227], 0
    v_mfma_f32_16x16x32_bf16 v[112:115], v[76:79], v[228:231], v[112:115]
    v_lshlrev_b32_sdwa v88, 3, v122 dst_sel:DWORD dst_unused:UNUSED_PAD src0_sel:DWORD src1_sel:WORD_0
    v_lshlrev_b32_sdwa v90, 3, v122 dst_sel:DWORD dst_unused:UNUSED_PAD src0_sel:DWORD src1_sel:WORD_1
    ds_read_b64 v[88:89], v88
    ds_read_b64 v[90:91], v90
    v_mfma_f32_16x16x32_bf16 v[112:115], v[80:83], v[232:235], v[112:115]
    v_mfma_f32_16x16x32_bf16 v[112:115], v[84:87], v[236:239], v[112:115]
    v_lshlrev_b32_sdwa v92, 3, v123 dst_sel:DWORD dst_unused:UNUSED_PAD src0_sel:DWORD src1_sel:WORD_0
    v_lshlrev_b32_sdwa v94, 3, v123 dst_sel:DWORD dst_unused:UNUSED_PAD src0_sel:DWORD src1_sel:WORD_1
    ds_read_b64 v[92:93], v92
    ds_read_b64 v[94:95], v94
    buffer_load_dwordx4 v[120:123], v69, s[12:15], s20 offen offset:1024 sc1
    s_waitcnt lgkmcnt(9)
    v_smfmac_f32_16x16x64_bf16 v[44:47], v[64:67], v[96:103], v68
    s_nop 0
    v_cvt_pk_bf16_f32 v112, v112, v113
    v_cvt_pk_bf16_f32 v113, v114, v115
    ds_write_b64 v70, v[112:113] offset:768
    s_setprio 1
    v_mfma_f32_16x16x32_bf16 v[112:115], v[72:75], v[240:243], 0
    buffer_load_dwordx4 v[72:75], v69, s[12:15], s21 offen offset:0
    s_waitcnt vmcnt(3)
    v_lshlrev_b32_sdwa v96, 3, v124 dst_sel:DWORD dst_unused:UNUSED_PAD src0_sel:DWORD src1_sel:WORD_0
    v_lshlrev_b32_sdwa v98, 3, v124 dst_sel:DWORD dst_unused:UNUSED_PAD src0_sel:DWORD src1_sel:WORD_1
    ds_read_b64 v[96:97], v96
    ds_read_b64 v[98:99], v98
    v_mfma_f32_16x16x32_bf16 v[112:115], v[76:79], v[244:247], v[112:115]
    buffer_load_dwordx4 v[76:79], v69, s[12:15], s21 offen offset:1024
    v_lshlrev_b32_sdwa v100, 3, v125 dst_sel:DWORD dst_unused:UNUSED_PAD src0_sel:DWORD src1_sel:WORD_0
    v_lshlrev_b32_sdwa v102, 3, v125 dst_sel:DWORD dst_unused:UNUSED_PAD src0_sel:DWORD src1_sel:WORD_1
    ds_read_b64 v[100:101], v100
    ds_read_b64 v[102:103], v102
    s_waitcnt lgkmcnt(10)
    v_smfmac_f32_16x16x64_bf16 v[48:51], v[64:67], v[104:111], v68
    v_mfma_f32_16x16x32_bf16 v[112:115], v[80:83], v[248:251], v[112:115]
    buffer_load_dwordx4 v[80:83], v69, s[12:15], s19 offen offset:0
    v_lshlrev_b32_sdwa v104, 3, v126 dst_sel:DWORD dst_unused:UNUSED_PAD src0_sel:DWORD src1_sel:WORD_0
    v_lshlrev_b32_sdwa v106, 3, v126 dst_sel:DWORD dst_unused:UNUSED_PAD src0_sel:DWORD src1_sel:WORD_1
    ds_read_b64 v[104:105], v104
    ds_read_b64 v[106:107], v106
    v_mfma_f32_16x16x32_bf16 v[112:115], v[84:87], v[252:255], v[112:115]
    buffer_load_dwordx4 v[84:87], v69, s[12:15], s19 offen offset:1024
    s_add_u32 s21, s21, 4096
    s_add_u32 s19, s19, 4096
    v_lshlrev_b32_sdwa v108, 3, v127 dst_sel:DWORD dst_unused:UNUSED_PAD src0_sel:DWORD src1_sel:WORD_0
    v_lshlrev_b32_sdwa v110, 3, v127 dst_sel:DWORD dst_unused:UNUSED_PAD src0_sel:DWORD src1_sel:WORD_1
    ds_read_b64 v[108:109], v108
    ds_read_b64 v[110:111], v110
    buffer_load_dwordx4 v[124:127], v69, s[12:15], s20 offen offset:2048 sc1
    s_waitcnt lgkmcnt(9)
    v_smfmac_f32_16x16x64_bf16 v[52:55], v[64:67], v[88:95], v68
    v_cvt_pk_bf16_f32 v112, v112, v113
    v_cvt_pk_bf16_f32 v113, v114, v115
    ds_write_b64 v70, v[112:113] offset:896
    s_add_u32 s23, s23, 1
    s_cmp_eq_u32 s23, 5
    s_cselect_b32 s35, 4294836224, s32
    s_cselect_b32 s23, 0, s23
    v_add_u32 v70, s35, v70
    s_waitcnt vmcnt(6)
    v_lshlrev_b32_sdwa v88, 3, v116 dst_sel:DWORD dst_unused:UNUSED_PAD src0_sel:DWORD src1_sel:WORD_0
    v_lshlrev_b32_sdwa v90, 3, v116 dst_sel:DWORD dst_unused:UNUSED_PAD src0_sel:DWORD src1_sel:WORD_1
    ds_read_b64 v[88:89], v88
    ds_read_b64 v[90:91], v90
    v_lshlrev_b32_sdwa v92, 3, v117 dst_sel:DWORD dst_unused:UNUSED_PAD src0_sel:DWORD src1_sel:WORD_0
    v_lshlrev_b32_sdwa v94, 3, v117 dst_sel:DWORD dst_unused:UNUSED_PAD src0_sel:DWORD src1_sel:WORD_1
    ds_read_b64 v[92:93], v92
    ds_read_b64 v[94:95], v94
    s_waitcnt lgkmcnt(9)
    v_smfmac_f32_16x16x64_bf16 v[56:59], v[64:67], v[96:103], v68
    s_setprio 0
    v_lshlrev_b32_sdwa v96, 3, v118 dst_sel:DWORD dst_unused:UNUSED_PAD src0_sel:DWORD src1_sel:WORD_0
    v_lshlrev_b32_sdwa v98, 3, v118 dst_sel:DWORD dst_unused:UNUSED_PAD src0_sel:DWORD src1_sel:WORD_1
    ds_read_b64 v[96:97], v96
    ds_read_b64 v[98:99], v98
    v_lshlrev_b32_sdwa v100, 3, v119 dst_sel:DWORD dst_unused:UNUSED_PAD src0_sel:DWORD src1_sel:WORD_0
    v_lshlrev_b32_sdwa v102, 3, v119 dst_sel:DWORD dst_unused:UNUSED_PAD src0_sel:DWORD src1_sel:WORD_1
    ds_read_b64 v[100:101], v100
    ds_read_b64 v[102:103], v102
    buffer_load_dwordx4 v[116:119], v69, s[12:15], s20 offen offset:3072 sc1
    s_add_u32 s20, s20, 4096
    s_waitcnt lgkmcnt(9)
    v_smfmac_f32_16x16x64_bf16 v[60:63], v[64:67], v[104:111], v68
    s_waitcnt lgkmcnt(8)
    s_barrier

    s_add_u32 s22, s22, 1
    s_branch k1_kernel_gloop

k1_kernel_fin:

    s_add_u32 s40, s20, 61440
    s_add_u32 s41, s20, 65536
    s_add_u32 s44, s20, 126976
    s_add_u32 s45, s20, 131072

    s_lshl_b32 s28, s38, 16
    s_and_b32 s29, s38, 0xffff0000
    s_lshl_b32 s30, s39, 16
    s_and_b32 s31, s39, 0xffff0000
    s_lshl_b32 s35, s33, 16
    s_lshl_b32 s42, s34, 15
    s_add_u32 s35, s35, s42
    s_lshl_b32 s42, s3, 12
    s_add_u32 s35, s35, s42
    s_add_u32 s35, s35, 20971520

    s_and_b32 s57, s57, 0xffff
    s_mov_b32 s58, 2
    s_mov_b32 s59, 0x00020000
    s_and_b32 s61, s61, 0xffff
    s_mov_b32 s62, 32768
    s_mov_b32 s63, 0x00020000
    s_xor_b32 s64, s34, 1
    s_lshl_b32 s64, s64, 7
    s_add_u32 s64, s64, s33
    s_lshl_b32 s65, s3, 20
    s_add_u32 s66, s65, 1048576
    s_lshl_b32 s67, s3, 8
    s_lshl_b32 s68, s64, 7
    s_lshl_b32 s69, s64, 8
    s_add_u32 s69, s69, s65
    s_add_u32 s69, s69, 20971520
    s_mov_b32 s42, 0
    s_mov_b32 s43, 0

    s_setprio 3
    v_mov_b32 v128, 0xbdd2d3e8
    v_mov_b32 v129, 0xbdd2d3e8
    v_mov_b32 v130, 0xc0135761
    v_mov_b32 v131, 0xc0135761
    v_mov_b32 v132, 1.0
    v_mov_b32 v133, 1.0
    v_mov_b32 v134, s28
    v_mov_b32 v135, s29
    v_mov_b32 v136, s30
    s_waitcnt vmcnt(6)
    v_lshlrev_b32_sdwa v88, 3, v116 dst_sel:DWORD dst_unused:UNUSED_PAD src0_sel:DWORD src1_sel:WORD_0
    v_lshlrev_b32_sdwa v90, 3, v116 dst_sel:DWORD dst_unused:UNUSED_PAD src0_sel:DWORD src1_sel:WORD_1
    ds_read_b64 v[88:89], v88
    ds_read_b64 v[90:91], v90
    v_lshlrev_b32_sdwa v92, 3, v117 dst_sel:DWORD dst_unused:UNUSED_PAD src0_sel:DWORD src1_sel:WORD_0
    v_lshlrev_b32_sdwa v94, 3, v117 dst_sel:DWORD dst_unused:UNUSED_PAD src0_sel:DWORD src1_sel:WORD_1
    ds_read_b64 v[92:93], v92
    ds_read_b64 v[94:95], v94
    s_waitcnt lgkmcnt(8)
    v_smfmac_f32_16x16x64_bf16 v[0:3], v[64:67], v[96:103], v68
    v_mov_b32 v137, s31
    v_lshrrev_b32 v70, 2, v69
    v_and_b32 v71, 128, v70
    v_add_u32 v70, v70, v71
    v_rcp_f32 v134, v134
    v_rcp_f32 v135, v135
    v_rcp_f32 v136, v136
    v_rcp_f32 v137, v137
    v_mov_b32 v132, 0x7f7fffff
    v_lshlrev_b32_sdwa v96, 3, v118 dst_sel:DWORD dst_unused:UNUSED_PAD src0_sel:DWORD src1_sel:WORD_0
    v_lshlrev_b32_sdwa v98, 3, v118 dst_sel:DWORD dst_unused:UNUSED_PAD src0_sel:DWORD src1_sel:WORD_1
    ds_read_b64 v[96:97], v96
    ds_read_b64 v[98:99], v98
    v_lshlrev_b32_sdwa v100, 3, v119 dst_sel:DWORD dst_unused:UNUSED_PAD src0_sel:DWORD src1_sel:WORD_0
    v_lshlrev_b32_sdwa v102, 3, v119 dst_sel:DWORD dst_unused:UNUSED_PAD src0_sel:DWORD src1_sel:WORD_1
    ds_read_b64 v[100:101], v100
    ds_read_b64 v[102:103], v102
    buffer_load_dwordx4 v[116:119], v69, s[12:15], s40 offen offset:0 sc1
    s_waitcnt lgkmcnt(8)
    v_smfmac_f32_16x16x64_bf16 v[4:7], v[64:67], v[104:111], v68
    v_mov_b32 v133, 0xff7fffff
    v_med3_f32 v134, v134, v132, v133
    v_med3_f32 v135, v135, v132, v133
    v_med3_f32 v136, v136, v132, v133
    v_med3_f32 v137, v137, v132, v133
    s_waitcnt vmcnt(3)
    v_mov_b32 v73, 0
    v_lshrrev_b32 v76, 2, v69
    v_mov_b32 v79, 0
    v_and_b32 v75, 0xf0, v69
    s_waitcnt vmcnt(2)
    v_lshlrev_b32_sdwa v104, 3, v120 dst_sel:DWORD dst_unused:UNUSED_PAD src0_sel:DWORD src1_sel:WORD_0
    v_lshlrev_b32_sdwa v106, 3, v120 dst_sel:DWORD dst_unused:UNUSED_PAD src0_sel:DWORD src1_sel:WORD_1
    ds_read_b64 v[104:105], v104
    ds_read_b64 v[106:107], v106
    v_lshlrev_b32_sdwa v108, 3, v121 dst_sel:DWORD dst_unused:UNUSED_PAD src0_sel:DWORD src1_sel:WORD_0
    v_lshlrev_b32_sdwa v110, 3, v121 dst_sel:DWORD dst_unused:UNUSED_PAD src0_sel:DWORD src1_sel:WORD_1
    ds_read_b64 v[108:109], v108
    ds_read_b64 v[110:111], v110
    s_waitcnt lgkmcnt(8)
    v_smfmac_f32_16x16x64_bf16 v[8:11], v[64:67], v[88:95], v68
    v_lshrrev_b32 v80, 8, v69
    v_lshl_add_u32 v74, v80, 16, v75
    v_lshl_add_u32 v75, v80, 2, v75
    v_add_u32 v77, s67, v76
    v_lshrrev_b32 v78, 1, v75
    v_lshlrev_b32_sdwa v88, 3, v122 dst_sel:DWORD dst_unused:UNUSED_PAD src0_sel:DWORD src1_sel:WORD_0
    v_lshlrev_b32_sdwa v90, 3, v122 dst_sel:DWORD dst_unused:UNUSED_PAD src0_sel:DWORD src1_sel:WORD_1
    ds_read_b64 v[88:89], v88
    ds_read_b64 v[90:91], v90
    v_lshlrev_b32_sdwa v92, 3, v123 dst_sel:DWORD dst_unused:UNUSED_PAD src0_sel:DWORD src1_sel:WORD_0
    v_lshlrev_b32_sdwa v94, 3, v123 dst_sel:DWORD dst_unused:UNUSED_PAD src0_sel:DWORD src1_sel:WORD_1
    ds_read_b64 v[92:93], v92
    ds_read_b64 v[94:95], v94
    buffer_load_dwordx4 v[120:123], v69, s[12:15], s44 offen offset:0 sc1
    s_waitcnt lgkmcnt(8)
    v_smfmac_f32_16x16x64_bf16 v[12:15], v[64:67], v[96:103], v68
    s_waitcnt vmcnt(2)
    v_lshlrev_b32_sdwa v96, 3, v124 dst_sel:DWORD dst_unused:UNUSED_PAD src0_sel:DWORD src1_sel:WORD_0
    v_lshlrev_b32_sdwa v98, 3, v124 dst_sel:DWORD dst_unused:UNUSED_PAD src0_sel:DWORD src1_sel:WORD_1
    ds_read_b64 v[96:97], v96
    ds_read_b64 v[98:99], v98
    v_lshlrev_b32_sdwa v100, 3, v125 dst_sel:DWORD dst_unused:UNUSED_PAD src0_sel:DWORD src1_sel:WORD_0
    v_lshlrev_b32_sdwa v102, 3, v125 dst_sel:DWORD dst_unused:UNUSED_PAD src0_sel:DWORD src1_sel:WORD_1
    ds_read_b64 v[100:101], v100
    ds_read_b64 v[102:103], v102
    s_waitcnt lgkmcnt(8)
    v_smfmac_f32_16x16x64_bf16 v[16:19], v[64:67], v[104:111], v68
    v_lshlrev_b32_sdwa v104, 3, v126 dst_sel:DWORD dst_unused:UNUSED_PAD src0_sel:DWORD src1_sel:WORD_0
    v_lshlrev_b32_sdwa v106, 3, v126 dst_sel:DWORD dst_unused:UNUSED_PAD src0_sel:DWORD src1_sel:WORD_1
    ds_read_b64 v[104:105], v104
    ds_read_b64 v[106:107], v106
    v_lshlrev_b32_sdwa v108, 3, v127 dst_sel:DWORD dst_unused:UNUSED_PAD src0_sel:DWORD src1_sel:WORD_0
    v_lshlrev_b32_sdwa v110, 3, v127 dst_sel:DWORD dst_unused:UNUSED_PAD src0_sel:DWORD src1_sel:WORD_1
    ds_read_b64 v[108:109], v108
    ds_read_b64 v[110:111], v110
    buffer_load_dwordx4 v[124:127], v69, s[12:15], s40 offen offset:1024 sc1
    s_waitcnt lgkmcnt(8)
    v_smfmac_f32_16x16x64_bf16 v[20:23], v[64:67], v[88:95], v68
    s_waitcnt vmcnt(2)
    v_lshlrev_b32_sdwa v88, 3, v116 dst_sel:DWORD dst_unused:UNUSED_PAD src0_sel:DWORD src1_sel:WORD_0
    v_lshlrev_b32_sdwa v90, 3, v116 dst_sel:DWORD dst_unused:UNUSED_PAD src0_sel:DWORD src1_sel:WORD_1
    ds_read_b64 v[88:89], v88
    ds_read_b64 v[90:91], v90
    v_lshlrev_b32_sdwa v92, 3, v117 dst_sel:DWORD dst_unused:UNUSED_PAD src0_sel:DWORD src1_sel:WORD_0
    v_lshlrev_b32_sdwa v94, 3, v117 dst_sel:DWORD dst_unused:UNUSED_PAD src0_sel:DWORD src1_sel:WORD_1
    ds_read_b64 v[92:93], v92
    ds_read_b64 v[94:95], v94
    s_waitcnt lgkmcnt(8)
    v_smfmac_f32_16x16x64_bf16 v[24:27], v[64:67], v[96:103], v68
    v_lshlrev_b32_sdwa v96, 3, v118 dst_sel:DWORD dst_unused:UNUSED_PAD src0_sel:DWORD src1_sel:WORD_0
    v_lshlrev_b32_sdwa v98, 3, v118 dst_sel:DWORD dst_unused:UNUSED_PAD src0_sel:DWORD src1_sel:WORD_1
    ds_read_b64 v[96:97], v96
    ds_read_b64 v[98:99], v98
    v_lshlrev_b32_sdwa v100, 3, v119 dst_sel:DWORD dst_unused:UNUSED_PAD src0_sel:DWORD src1_sel:WORD_0
    v_lshlrev_b32_sdwa v102, 3, v119 dst_sel:DWORD dst_unused:UNUSED_PAD src0_sel:DWORD src1_sel:WORD_1
    ds_read_b64 v[100:101], v100
    ds_read_b64 v[102:103], v102
    buffer_load_dwordx4 v[116:119], v69, s[12:15], s44 offen offset:1024 sc1
    s_waitcnt lgkmcnt(8)
    v_smfmac_f32_16x16x64_bf16 v[28:31], v[64:67], v[104:111], v68
    s_waitcnt vmcnt(2)
    v_lshlrev_b32_sdwa v104, 3, v120 dst_sel:DWORD dst_unused:UNUSED_PAD src0_sel:DWORD src1_sel:WORD_0
    v_lshlrev_b32_sdwa v106, 3, v120 dst_sel:DWORD dst_unused:UNUSED_PAD src0_sel:DWORD src1_sel:WORD_1
    ds_read_b64 v[104:105], v104
    ds_read_b64 v[106:107], v106
    v_lshlrev_b32_sdwa v108, 3, v121 dst_sel:DWORD dst_unused:UNUSED_PAD src0_sel:DWORD src1_sel:WORD_0
    v_lshlrev_b32_sdwa v110, 3, v121 dst_sel:DWORD dst_unused:UNUSED_PAD src0_sel:DWORD src1_sel:WORD_1
    ds_read_b64 v[108:109], v108
    ds_read_b64 v[110:111], v110
    s_waitcnt lgkmcnt(8)
    v_smfmac_f32_16x16x64_bf16 v[0:3], v[64:67], v[88:95], v68
    v_lshlrev_b32_sdwa v88, 3, v122 dst_sel:DWORD dst_unused:UNUSED_PAD src0_sel:DWORD src1_sel:WORD_0
    v_lshlrev_b32_sdwa v90, 3, v122 dst_sel:DWORD dst_unused:UNUSED_PAD src0_sel:DWORD src1_sel:WORD_1
    ds_read_b64 v[88:89], v88
    ds_read_b64 v[90:91], v90
    v_lshlrev_b32_sdwa v92, 3, v123 dst_sel:DWORD dst_unused:UNUSED_PAD src0_sel:DWORD src1_sel:WORD_0
    v_lshlrev_b32_sdwa v94, 3, v123 dst_sel:DWORD dst_unused:UNUSED_PAD src0_sel:DWORD src1_sel:WORD_1
    ds_read_b64 v[92:93], v92
    ds_read_b64 v[94:95], v94
    buffer_load_dwordx4 v[120:123], v69, s[12:15], s40 offen offset:2048 sc1
    s_waitcnt lgkmcnt(8)
    v_smfmac_f32_16x16x64_bf16 v[4:7], v[64:67], v[96:103], v68
    s_waitcnt vmcnt(2)
    v_lshlrev_b32_sdwa v96, 3, v124 dst_sel:DWORD dst_unused:UNUSED_PAD src0_sel:DWORD src1_sel:WORD_0
    v_lshlrev_b32_sdwa v98, 3, v124 dst_sel:DWORD dst_unused:UNUSED_PAD src0_sel:DWORD src1_sel:WORD_1
    ds_read_b64 v[96:97], v96
    ds_read_b64 v[98:99], v98
    v_lshlrev_b32_sdwa v100, 3, v125 dst_sel:DWORD dst_unused:UNUSED_PAD src0_sel:DWORD src1_sel:WORD_0
    v_lshlrev_b32_sdwa v102, 3, v125 dst_sel:DWORD dst_unused:UNUSED_PAD src0_sel:DWORD src1_sel:WORD_1
    ds_read_b64 v[100:101], v100
    ds_read_b64 v[102:103], v102
    s_waitcnt lgkmcnt(8)
    v_smfmac_f32_16x16x64_bf16 v[0:3], v[64:67], v[104:111], v68
    v_lshlrev_b32_sdwa v104, 3, v126 dst_sel:DWORD dst_unused:UNUSED_PAD src0_sel:DWORD src1_sel:WORD_0
    v_lshlrev_b32_sdwa v106, 3, v126 dst_sel:DWORD dst_unused:UNUSED_PAD src0_sel:DWORD src1_sel:WORD_1
    ds_read_b64 v[104:105], v104
    ds_read_b64 v[106:107], v106
    v_lshlrev_b32_sdwa v108, 3, v127 dst_sel:DWORD dst_unused:UNUSED_PAD src0_sel:DWORD src1_sel:WORD_0
    v_lshlrev_b32_sdwa v110, 3, v127 dst_sel:DWORD dst_unused:UNUSED_PAD src0_sel:DWORD src1_sel:WORD_1
    ds_read_b64 v[108:109], v108
    ds_read_b64 v[110:111], v110
    buffer_load_dwordx4 v[124:127], v69, s[12:15], s44 offen offset:2048 sc1
    s_waitcnt lgkmcnt(8)
    v_smfmac_f32_16x16x64_bf16 v[4:7], v[64:67], v[88:95], v68
    s_waitcnt vmcnt(2)
    v_lshlrev_b32_sdwa v88, 3, v116 dst_sel:DWORD dst_unused:UNUSED_PAD src0_sel:DWORD src1_sel:WORD_0
    v_lshlrev_b32_sdwa v90, 3, v116 dst_sel:DWORD dst_unused:UNUSED_PAD src0_sel:DWORD src1_sel:WORD_1
    ds_read_b64 v[88:89], v88
    ds_read_b64 v[90:91], v90
    v_lshlrev_b32_sdwa v92, 3, v117 dst_sel:DWORD dst_unused:UNUSED_PAD src0_sel:DWORD src1_sel:WORD_0
    v_lshlrev_b32_sdwa v94, 3, v117 dst_sel:DWORD dst_unused:UNUSED_PAD src0_sel:DWORD src1_sel:WORD_1
    ds_read_b64 v[92:93], v92
    ds_read_b64 v[94:95], v94
    s_waitcnt lgkmcnt(8)
    v_smfmac_f32_16x16x64_bf16 v[8:11], v[64:67], v[96:103], v68
    v_pk_mul_f32 v[140:141], v[0:1], v[0:1]
    v_pk_mul_f32 v[142:143], v[2:3], v[2:3]
    v_pk_fma_f32 v[140:141], v[140:141], v[128:129], v[130:131]
    v_pk_fma_f32 v[142:143], v[142:143], v[128:129], v[130:131]
    v_pk_mul_f32 v[140:141], v[140:141], v[0:1]
    v_pk_mul_f32 v[142:143], v[142:143], v[2:3]
    v_exp_f32 v140, v140
    v_pk_mul_f32 v[146:147], v[4:5], v[4:5]
    v_pk_mul_f32 v[148:149], v[6:7], v[6:7]
    v_lshlrev_b32_sdwa v96, 3, v118 dst_sel:DWORD dst_unused:UNUSED_PAD src0_sel:DWORD src1_sel:WORD_0
    v_lshlrev_b32_sdwa v98, 3, v118 dst_sel:DWORD dst_unused:UNUSED_PAD src0_sel:DWORD src1_sel:WORD_1
    ds_read_b64 v[96:97], v96
    ds_read_b64 v[98:99], v98
    v_lshlrev_b32_sdwa v100, 3, v119 dst_sel:DWORD dst_unused:UNUSED_PAD src0_sel:DWORD src1_sel:WORD_0
    v_lshlrev_b32_sdwa v102, 3, v119 dst_sel:DWORD dst_unused:UNUSED_PAD src0_sel:DWORD src1_sel:WORD_1
    ds_read_b64 v[100:101], v100
    ds_read_b64 v[102:103], v102
    buffer_load_dwordx4 v[116:119], v69, s[12:15], s40 offen offset:3072 sc1
    s_waitcnt lgkmcnt(8)
    v_smfmac_f32_16x16x64_bf16 v[12:15], v[64:67], v[104:111], v68
    v_exp_f32 v141, v141
    v_pk_fma_f32 v[146:147], v[146:147], v[128:129], v[130:131]
    v_pk_fma_f32 v[148:149], v[148:149], v[128:129], v[130:131]
    v_exp_f32 v142, v142
    v_pk_fma_f32 v[140:141], v[140:141], v[134:135], v[134:135]
    v_pk_mul_f32 v[146:147], v[146:147], v[4:5]
    v_rcp_f32 v140, v140
    v_pk_mul_f32 v[148:149], v[148:149], v[6:7]
    v_rcp_f32 v141, v141
    s_waitcnt vmcnt(2)
    v_lshlrev_b32_sdwa v104, 3, v120 dst_sel:DWORD dst_unused:UNUSED_PAD src0_sel:DWORD src1_sel:WORD_0
    v_lshlrev_b32_sdwa v106, 3, v120 dst_sel:DWORD dst_unused:UNUSED_PAD src0_sel:DWORD src1_sel:WORD_1
    ds_read_b64 v[104:105], v104
    ds_read_b64 v[106:107], v106
    v_lshlrev_b32_sdwa v108, 3, v121 dst_sel:DWORD dst_unused:UNUSED_PAD src0_sel:DWORD src1_sel:WORD_0
    v_lshlrev_b32_sdwa v110, 3, v121 dst_sel:DWORD dst_unused:UNUSED_PAD src0_sel:DWORD src1_sel:WORD_1
    ds_read_b64 v[108:109], v108
    ds_read_b64 v[110:111], v110
    s_waitcnt lgkmcnt(8)
    v_smfmac_f32_16x16x64_bf16 v[8:11], v[64:67], v[88:95], v68
    v_exp_f32 v143, v143
    v_pk_mul_f32 v[144:145], v[0:1], v[140:141]
    v_exp_f32 v146, v146
    v_pk_fma_f32 v[142:143], v[142:143], v[136:137], v[136:137]
    v_exp_f32 v147, v147
    v_rcp_f32 v142, v142
    v_rcp_f32 v143, v143
    v_pk_fma_f32 v[146:147], v[146:147], v[134:135], v[134:135]
    v_exp_f32 v148, v148
    v_lshlrev_b32_sdwa v88, 3, v122 dst_sel:DWORD dst_unused:UNUSED_PAD src0_sel:DWORD src1_sel:WORD_0
    v_lshlrev_b32_sdwa v90, 3, v122 dst_sel:DWORD dst_unused:UNUSED_PAD src0_sel:DWORD src1_sel:WORD_1
    ds_read_b64 v[88:89], v88
    ds_read_b64 v[90:91], v90
    v_lshlrev_b32_sdwa v92, 3, v123 dst_sel:DWORD dst_unused:UNUSED_PAD src0_sel:DWORD src1_sel:WORD_0
    v_lshlrev_b32_sdwa v94, 3, v123 dst_sel:DWORD dst_unused:UNUSED_PAD src0_sel:DWORD src1_sel:WORD_1
    ds_read_b64 v[92:93], v92
    ds_read_b64 v[94:95], v94
    buffer_load_dwordx4 v[120:123], v69, s[12:15], s44 offen offset:3072 sc1
    s_waitcnt lgkmcnt(8)
    v_smfmac_f32_16x16x64_bf16 v[12:15], v[64:67], v[96:103], v68
    v_rcp_f32 v146, v146
    v_pk_fma_f32 v[144:145], v[2:3], v[142:143], v[144:145]
    v_pk_mul_f32 v[152:153], v[8:9], v[8:9]
    v_rcp_f32 v147, v147
    v_add_f32 v144, v144, v145
    v_pk_fma_f32 v[152:153], v[152:153], v[128:129], v[130:131]
    v_exp_f32 v149, v149
    v_min_u32 v144, -2, v144
    v_pk_mul_f32 v[150:151], v[4:5], v[146:147]
    s_waitcnt vmcnt(2)
    v_lshlrev_b32_sdwa v96, 3, v124 dst_sel:DWORD dst_unused:UNUSED_PAD src0_sel:DWORD src1_sel:WORD_0
    v_lshlrev_b32_sdwa v98, 3, v124 dst_sel:DWORD dst_unused:UNUSED_PAD src0_sel:DWORD src1_sel:WORD_1
    ds_read_b64 v[96:97], v96
    ds_read_b64 v[98:99], v98
    v_lshlrev_b32_sdwa v100, 3, v125 dst_sel:DWORD dst_unused:UNUSED_PAD src0_sel:DWORD src1_sel:WORD_0
    v_lshlrev_b32_sdwa v102, 3, v125 dst_sel:DWORD dst_unused:UNUSED_PAD src0_sel:DWORD src1_sel:WORD_1
    ds_read_b64 v[100:101], v100
    ds_read_b64 v[102:103], v102
    s_waitcnt lgkmcnt(8)
    v_smfmac_f32_16x16x64_bf16 v[16:19], v[64:67], v[104:111], v68
    buffer_store_dword v144, v70, s[12:15], s35 offen offset:0 sc1
    v_pk_fma_f32 v[148:149], v[148:149], v[136:137], v[136:137]
    v_pk_mul_f32 v[152:153], v[152:153], v[8:9]
    v_rcp_f32 v148, v148
    v_pk_mul_f32 v[154:155], v[10:11], v[10:11]
    v_pk_mul_f32 v[158:159], v[12:13], v[12:13]
    v_rcp_f32 v149, v149
    v_pk_fma_f32 v[154:155], v[154:155], v[128:129], v[130:131]
    v_pk_fma_f32 v[158:159], v[158:159], v[128:129], v[130:131]
    v_lshlrev_b32_sdwa v104, 3, v126 dst_sel:DWORD dst_unused:UNUSED_PAD src0_sel:DWORD src1_sel:WORD_0
    v_lshlrev_b32_sdwa v106, 3, v126 dst_sel:DWORD dst_unused:UNUSED_PAD src0_sel:DWORD src1_sel:WORD_1
    ds_read_b64 v[104:105], v104
    ds_read_b64 v[106:107], v106
    v_lshlrev_b32_sdwa v108, 3, v127 dst_sel:DWORD dst_unused:UNUSED_PAD src0_sel:DWORD src1_sel:WORD_0
    v_lshlrev_b32_sdwa v110, 3, v127 dst_sel:DWORD dst_unused:UNUSED_PAD src0_sel:DWORD src1_sel:WORD_1
    ds_read_b64 v[108:109], v108
    ds_read_b64 v[110:111], v110
    buffer_load_dwordx4 v[124:127], v69, s[12:15], s20 offen offset:0 sc1
    s_waitcnt lgkmcnt(8)
    v_smfmac_f32_16x16x64_bf16 v[20:23], v[64:67], v[88:95], v68
    v_exp_f32 v152, v152
    v_pk_fma_f32 v[150:151], v[6:7], v[148:149], v[150:151]
    v_pk_mul_f32 v[154:155], v[154:155], v[10:11]
    v_exp_f32 v153, v153
    v_add_f32 v150, v150, v151
    v_pk_mul_f32 v[158:159], v[158:159], v[12:13]
    v_exp_f32 v154, v154
    v_min_u32 v150, -2, v150
    v_pk_fma_f32 v[152:153], v[152:153], v[134:135], v[134:135]
    s_waitcnt vmcnt(3)
    v_lshlrev_b32_sdwa v88, 3, v116 dst_sel:DWORD dst_unused:UNUSED_PAD src0_sel:DWORD src1_sel:WORD_0
    v_lshlrev_b32_sdwa v90, 3, v116 dst_sel:DWORD dst_unused:UNUSED_PAD src0_sel:DWORD src1_sel:WORD_1
    ds_read_b64 v[88:89], v88
    ds_read_b64 v[90:91], v90
    v_lshlrev_b32_sdwa v92, 3, v117 dst_sel:DWORD dst_unused:UNUSED_PAD src0_sel:DWORD src1_sel:WORD_0
    v_lshlrev_b32_sdwa v94, 3, v117 dst_sel:DWORD dst_unused:UNUSED_PAD src0_sel:DWORD src1_sel:WORD_1
    ds_read_b64 v[92:93], v92
    ds_read_b64 v[94:95], v94
    s_waitcnt lgkmcnt(8)
    v_smfmac_f32_16x16x64_bf16 v[16:19], v[64:67], v[96:103], v68
    v_rcp_f32 v152, v152
    buffer_store_dword v150, v70, s[12:15], s35 offen offset:128 sc1
    v_pk_mul_f32 v[160:161], v[14:15], v[14:15]
    v_rcp_f32 v153, v153
    v_pk_fma_f32 v[160:161], v[160:161], v[128:129], v[130:131]
    v_exp_f32 v155, v155
    v_pk_mul_f32 v[156:157], v[8:9], v[152:153]
    v_pk_mul_f32 v[160:161], v[160:161], v[14:15]
    v_exp_f32 v158, v158
    v_lshlrev_b32_sdwa v96, 3, v118 dst_sel:DWORD dst_unused:UNUSED_PAD src0_sel:DWORD src1_sel:WORD_0
    v_lshlrev_b32_sdwa v98, 3, v118 dst_sel:DWORD dst_unused:UNUSED_PAD src0_sel:DWORD src1_sel:WORD_1
    ds_read_b64 v[96:97], v96
    ds_read_b64 v[98:99], v98
    v_lshlrev_b32_sdwa v100, 3, v119 dst_sel:DWORD dst_unused:UNUSED_PAD src0_sel:DWORD src1_sel:WORD_0
    v_lshlrev_b32_sdwa v102, 3, v119 dst_sel:DWORD dst_unused:UNUSED_PAD src0_sel:DWORD src1_sel:WORD_1
    ds_read_b64 v[100:101], v100
    ds_read_b64 v[102:103], v102
    buffer_load_dwordx4 v[116:119], v69, s[12:15], s41 offen offset:0 sc1
    s_waitcnt lgkmcnt(8)
    v_smfmac_f32_16x16x64_bf16 v[20:23], v[64:67], v[104:111], v68
    v_exp_f32 v159, v159
    v_pk_fma_f32 v[154:155], v[154:155], v[136:137], v[136:137]
    v_pk_mul_f32 v[164:165], v[16:17], v[16:17]
    v_rcp_f32 v154, v154
    v_pk_fma_f32 v[158:159], v[158:159], v[134:135], v[134:135]
    v_pk_fma_f32 v[164:165], v[164:165], v[128:129], v[130:131]
    v_rcp_f32 v155, v155
    v_pk_mul_f32 v[164:165], v[164:165], v[16:17]
    v_pk_mul_f32 v[166:167], v[18:19], v[18:19]
    s_waitcnt vmcnt(4)
    v_lshlrev_b32_sdwa v104, 3, v120 dst_sel:DWORD dst_unused:UNUSED_PAD src0_sel:DWORD src1_sel:WORD_0
    v_lshlrev_b32_sdwa v106, 3, v120 dst_sel:DWORD dst_unused:UNUSED_PAD src0_sel:DWORD src1_sel:WORD_1
    ds_read_b64 v[104:105], v104
    ds_read_b64 v[106:107], v106
    v_lshlrev_b32_sdwa v108, 3, v121 dst_sel:DWORD dst_unused:UNUSED_PAD src0_sel:DWORD src1_sel:WORD_0
    v_lshlrev_b32_sdwa v110, 3, v121 dst_sel:DWORD dst_unused:UNUSED_PAD src0_sel:DWORD src1_sel:WORD_1
    ds_read_b64 v[108:109], v108
    ds_read_b64 v[110:111], v110
    s_waitcnt lgkmcnt(8)
    v_smfmac_f32_16x16x64_bf16 v[24:27], v[64:67], v[88:95], v68
    v_rcp_f32 v158, v158
    v_pk_fma_f32 v[156:157], v[10:11], v[154:155], v[156:157]
    v_pk_fma_f32 v[166:167], v[166:167], v[128:129], v[130:131]
    v_rcp_f32 v159, v159
    v_add_f32 v156, v156, v157
    v_pk_mul_f32 v[166:167], v[166:167], v[18:19]
    v_exp_f32 v160, v160
    v_min_u32 v156, -2, v156
    v_pk_mul_f32 v[162:163], v[12:13], v[158:159]
    v_lshlrev_b32_sdwa v88, 3, v122 dst_sel:DWORD dst_unused:UNUSED_PAD src0_sel:DWORD src1_sel:WORD_0
    v_lshlrev_b32_sdwa v90, 3, v122 dst_sel:DWORD dst_unused:UNUSED_PAD src0_sel:DWORD src1_sel:WORD_1
    ds_read_b64 v[88:89], v88
    ds_read_b64 v[90:91], v90
    v_lshlrev_b32_sdwa v92, 3, v123 dst_sel:DWORD dst_unused:UNUSED_PAD src0_sel:DWORD src1_sel:WORD_0
    v_lshlrev_b32_sdwa v94, 3, v123 dst_sel:DWORD dst_unused:UNUSED_PAD src0_sel:DWORD src1_sel:WORD_1
    ds_read_b64 v[92:93], v92
    ds_read_b64 v[94:95], v94
    buffer_load_dwordx4 v[120:123], v69, s[12:15], s45 offen offset:0 sc1
    s_waitcnt lgkmcnt(8)
    v_smfmac_f32_16x16x64_bf16 v[28:31], v[64:67], v[96:103], v68
    v_exp_f32 v161, v161
    buffer_store_dword v156, v70, s[12:15], s35 offen offset:512 sc1
    v_pk_mul_f32 v[170:171], v[20:21], v[20:21]
    v_exp_f32 v164, v164
    v_pk_fma_f32 v[160:161], v[160:161], v[136:137], v[136:137]
    v_pk_fma_f32 v[170:171], v[170:171], v[128:129], v[130:131]
    v_rcp_f32 v160, v160
    v_pk_mul_f32 v[170:171], v[170:171], v[20:21]
    v_pk_mul_f32 v[172:173], v[22:23], v[22:23]
    s_waitcnt vmcnt(4)
    v_lshlrev_b32_sdwa v96, 3, v124 dst_sel:DWORD dst_unused:UNUSED_PAD src0_sel:DWORD src1_sel:WORD_0
    v_lshlrev_b32_sdwa v98, 3, v124 dst_sel:DWORD dst_unused:UNUSED_PAD src0_sel:DWORD src1_sel:WORD_1
    ds_read_b64 v[96:97], v96
    ds_read_b64 v[98:99], v98
    v_lshlrev_b32_sdwa v100, 3, v125 dst_sel:DWORD dst_unused:UNUSED_PAD src0_sel:DWORD src1_sel:WORD_0
    v_lshlrev_b32_sdwa v102, 3, v125 dst_sel:DWORD dst_unused:UNUSED_PAD src0_sel:DWORD src1_sel:WORD_1
    ds_read_b64 v[100:101], v100
    ds_read_b64 v[102:103], v102
    s_waitcnt lgkmcnt(8)
    v_smfmac_f32_16x16x64_bf16 v[24:27], v[64:67], v[104:111], v68
    v_rcp_f32 v161, v161
    v_pk_fma_f32 v[172:173], v[172:173], v[128:129], v[130:131]
    v_exp_f32 v165, v165
    v_pk_fma_f32 v[162:163], v[14:15], v[160:161], v[162:163]
    v_pk_mul_f32 v[172:173], v[172:173], v[22:23]
    v_exp_f32 v166, v166
    v_add_f32 v162, v162, v163
    v_pk_fma_f32 v[164:165], v[164:165], v[134:135], v[134:135]
    v_exp_f32 v167, v167
    v_lshlrev_b32_sdwa v104, 3, v126 dst_sel:DWORD dst_unused:UNUSED_PAD src0_sel:DWORD src1_sel:WORD_0
    v_lshlrev_b32_sdwa v106, 3, v126 dst_sel:DWORD dst_unused:UNUSED_PAD src0_sel:DWORD src1_sel:WORD_1
    ds_read_b64 v[104:105], v104
    ds_read_b64 v[106:107], v106
    v_lshlrev_b32_sdwa v108, 3, v127 dst_sel:DWORD dst_unused:UNUSED_PAD src0_sel:DWORD src1_sel:WORD_0
    v_lshlrev_b32_sdwa v110, 3, v127 dst_sel:DWORD dst_unused:UNUSED_PAD src0_sel:DWORD src1_sel:WORD_1
    ds_read_b64 v[108:109], v108
    ds_read_b64 v[110:111], v110
    buffer_load_dwordx4 v[124:127], v69, s[12:15], s20 offen offset:1024 sc1
    s_waitcnt lgkmcnt(8)
    v_smfmac_f32_16x16x64_bf16 v[28:31], v[64:67], v[88:95], v68
    s_setprio 2
    v_rcp_f32 v164, v164
    v_min_u32 v162, -2, v162
    v_pk_fma_f32 v[166:167], v[166:167], v[136:137], v[136:137]
    v_rcp_f32 v165, v165
    buffer_store_dword v162, v70, s[12:15], s35 offen offset:640 sc1
    v_pk_mul_f32 v[140:141], v[24:25], v[24:25]
    v_rcp_f32 v166, v166
    v_pk_mul_f32 v[168:169], v[16:17], v[164:165]
    v_pk_fma_f32 v[140:141], v[140:141], v[128:129], v[130:131]
    s_waitcnt vmcnt(4)
    v_lshlrev_b32_sdwa v88, 3, v116 dst_sel:DWORD dst_unused:UNUSED_PAD src0_sel:DWORD src1_sel:WORD_0
    v_lshlrev_b32_sdwa v90, 3, v116 dst_sel:DWORD dst_unused:UNUSED_PAD src0_sel:DWORD src1_sel:WORD_1
    ds_read_b64 v[88:89], v88
    ds_read_b64 v[90:91], v90
    v_lshlrev_b32_sdwa v92, 3, v117 dst_sel:DWORD dst_unused:UNUSED_PAD src0_sel:DWORD src1_sel:WORD_0
    v_lshlrev_b32_sdwa v94, 3, v117 dst_sel:DWORD dst_unused:UNUSED_PAD src0_sel:DWORD src1_sel:WORD_1
    ds_read_b64 v[92:93], v92
    ds_read_b64 v[94:95], v94
    s_waitcnt lgkmcnt(8)
    v_smfmac_f32_16x16x64_bf16 v[32:35], v[64:67], v[96:103], v68
    v_rcp_f32 v167, v167
    v_pk_mul_f32 v[140:141], v[140:141], v[24:25]
    v_pk_mul_f32 v[142:143], v[26:27], v[26:27]
    v_exp_f32 v170, v170
    v_pk_fma_f32 v[168:169], v[18:19], v[166:167], v[168:169]
    v_pk_fma_f32 v[142:143], v[142:143], v[128:129], v[130:131]
    v_exp_f32 v171, v171
    v_add_f32 v168, v168, v169
    v_pk_mul_f32 v[142:143], v[142:143], v[26:27]
    v_lshlrev_b32_sdwa v96, 3, v118 dst_sel:DWORD dst_unused:UNUSED_PAD src0_sel:DWORD src1_sel:WORD_0
    v_lshlrev_b32_sdwa v98, 3, v118 dst_sel:DWORD dst_unused:UNUSED_PAD src0_sel:DWORD src1_sel:WORD_1
    ds_read_b64 v[96:97], v96
    ds_read_b64 v[98:99], v98
    v_lshlrev_b32_sdwa v100, 3, v119 dst_sel:DWORD dst_unused:UNUSED_PAD src0_sel:DWORD src1_sel:WORD_0
    v_lshlrev_b32_sdwa v102, 3, v119 dst_sel:DWORD dst_unused:UNUSED_PAD src0_sel:DWORD src1_sel:WORD_1
    ds_read_b64 v[100:101], v100
    ds_read_b64 v[102:103], v102
    buffer_load_dwordx4 v[116:119], v69, s[12:15], s41 offen offset:1024 sc1
    s_waitcnt lgkmcnt(8)
    v_smfmac_f32_16x16x64_bf16 v[36:39], v[64:67], v[104:111], v68
    v_exp_f32 v172, v172
    v_min_u32 v168, -2, v168
    v_pk_fma_f32 v[170:171], v[170:171], v[134:135], v[134:135]
    v_exp_f32 v173, v173
    buffer_store_dword v168, v70, s[12:15], s35 offen offset:1024 sc1
    v_pk_mul_f32 v[146:147], v[28:29], v[28:29]
    v_rcp_f32 v170, v170
    v_pk_fma_f32 v[172:173], v[172:173], v[136:137], v[136:137]
    v_pk_fma_f32 v[146:147], v[146:147], v[128:129], v[130:131]
    s_waitcnt vmcnt(5)
    v_lshlrev_b32_sdwa v104, 3, v120 dst_sel:DWORD dst_unused:UNUSED_PAD src0_sel:DWORD src1_sel:WORD_0
    v_lshlrev_b32_sdwa v106, 3, v120 dst_sel:DWORD dst_unused:UNUSED_PAD src0_sel:DWORD src1_sel:WORD_1
    ds_read_b64 v[104:105], v104
    ds_read_b64 v[106:107], v106
    v_lshlrev_b32_sdwa v108, 3, v121 dst_sel:DWORD dst_unused:UNUSED_PAD src0_sel:DWORD src1_sel:WORD_0
    v_lshlrev_b32_sdwa v110, 3, v121 dst_sel:DWORD dst_unused:UNUSED_PAD src0_sel:DWORD src1_sel:WORD_1
    ds_read_b64 v[108:109], v108
    ds_read_b64 v[110:111], v110
    s_waitcnt lgkmcnt(8)
    v_smfmac_f32_16x16x64_bf16 v[32:35], v[64:67], v[88:95], v68
    v_rcp_f32 v171, v171
    v_pk_mul_f32 v[146:147], v[146:147], v[28:29]
    v_pk_mul_f32 v[148:149], v[30:31], v[30:31]
    v_rcp_f32 v172, v172
    v_pk_mul_f32 v[174:175], v[20:21], v[170:171]
    v_pk_fma_f32 v[148:149], v[148:149], v[128:129], v[130:131]
    v_rcp_f32 v173, v173
    v_pk_mul_f32 v[148:149], v[148:149], v[30:31]
    v_exp_f32 v140, v140
    v_lshlrev_b32_sdwa v88, 3, v122 dst_sel:DWORD dst_unused:UNUSED_PAD src0_sel:DWORD src1_sel:WORD_0
    v_lshlrev_b32_sdwa v90, 3, v122 dst_sel:DWORD dst_unused:UNUSED_PAD src0_sel:DWORD src1_sel:WORD_1
    ds_read_b64 v[88:89], v88
    ds_read_b64 v[90:91], v90
    v_lshlrev_b32_sdwa v92, 3, v123 dst_sel:DWORD dst_unused:UNUSED_PAD src0_sel:DWORD src1_sel:WORD_0
    v_lshlrev_b32_sdwa v94, 3, v123 dst_sel:DWORD dst_unused:UNUSED_PAD src0_sel:DWORD src1_sel:WORD_1
    ds_read_b64 v[92:93], v92
    ds_read_b64 v[94:95], v94
    buffer_load_dwordx4 v[120:123], v69, s[12:15], s45 offen offset:1024 sc1
    s_waitcnt lgkmcnt(8)
    v_smfmac_f32_16x16x64_bf16 v[36:39], v[64:67], v[96:103], v68
    v_exp_f32 v141, v141
    v_pk_fma_f32 v[174:175], v[22:23], v[172:173], v[174:175]
    v_exp_f32 v142, v142
    v_add_f32 v174, v174, v175
    v_pk_fma_f32 v[140:141], v[140:141], v[134:135], v[134:135]
    v_exp_f32 v143, v143
    v_min_u32 v174, -2, v174
    v_rcp_f32 v140, v140
    buffer_store_dword v174, v70, s[12:15], s35 offen offset:1152 sc1
    s_waitcnt vmcnt(5)
    v_lshlrev_b32_sdwa v96, 3, v124 dst_sel:DWORD dst_unused:UNUSED_PAD src0_sel:DWORD src1_sel:WORD_0
    v_lshlrev_b32_sdwa v98, 3, v124 dst_sel:DWORD dst_unused:UNUSED_PAD src0_sel:DWORD src1_sel:WORD_1
    ds_read_b64 v[96:97], v96
    ds_read_b64 v[98:99], v98
    v_lshlrev_b32_sdwa v100, 3, v125 dst_sel:DWORD dst_unused:UNUSED_PAD src0_sel:DWORD src1_sel:WORD_0
    v_lshlrev_b32_sdwa v102, 3, v125 dst_sel:DWORD dst_unused:UNUSED_PAD src0_sel:DWORD src1_sel:WORD_1
    ds_read_b64 v[100:101], v100
    ds_read_b64 v[102:103], v102
    s_waitcnt lgkmcnt(8)
    v_smfmac_f32_16x16x64_bf16 v[32:35], v[64:67], v[104:111], v68
    v_rcp_f32 v141, v141
    v_pk_fma_f32 v[142:143], v[142:143], v[136:137], v[136:137]
    v_exp_f32 v146, v146
    v_pk_mul_f32 v[144:145], v[24:25], v[140:141]
    v_rcp_f32 v142, v142
    v_rcp_f32 v143, v143
    v_exp_f32 v147, v147
    v_exp_f32 v148, v148
    v_pk_fma_f32 v[144:145], v[26:27], v[142:143], v[144:145]
    v_lshlrev_b32_sdwa v104, 3, v126 dst_sel:DWORD dst_unused:UNUSED_PAD src0_sel:DWORD src1_sel:WORD_0
    v_lshlrev_b32_sdwa v106, 3, v126 dst_sel:DWORD dst_unused:UNUSED_PAD src0_sel:DWORD src1_sel:WORD_1
    ds_read_b64 v[104:105], v104
    ds_read_b64 v[106:107], v106
    v_lshlrev_b32_sdwa v108, 3, v127 dst_sel:DWORD dst_unused:UNUSED_PAD src0_sel:DWORD src1_sel:WORD_0
    v_lshlrev_b32_sdwa v110, 3, v127 dst_sel:DWORD dst_unused:UNUSED_PAD src0_sel:DWORD src1_sel:WORD_1
    ds_read_b64 v[108:109], v108
    ds_read_b64 v[110:111], v110
    buffer_load_dwordx4 v[124:127], v69, s[12:15], s20 offen offset:2048 sc1
    s_waitcnt lgkmcnt(8)
    v_smfmac_f32_16x16x64_bf16 v[36:39], v[64:67], v[88:95], v68
    v_exp_f32 v149, v149
    v_add_f32 v144, v144, v145
    v_pk_fma_f32 v[146:147], v[146:147], v[134:135], v[134:135]
    v_min_u32 v144, -2, v144
    v_rcp_f32 v146, v146
    buffer_store_dword v144, v70, s[12:15], s35 offen offset:1536 sc1
    v_pk_fma_f32 v[148:149], v[148:149], v[136:137], v[136:137]
    v_rcp_f32 v147, v147
    v_pk_mul_f32 v[152:153], v[32:33], v[32:33]
    s_waitcnt vmcnt(5)
    v_lshlrev_b32_sdwa v88, 3, v116 dst_sel:DWORD dst_unused:UNUSED_PAD src0_sel:DWORD src1_sel:WORD_0
    v_lshlrev_b32_sdwa v90, 3, v116 dst_sel:DWORD dst_unused:UNUSED_PAD src0_sel:DWORD src1_sel:WORD_1
    ds_read_b64 v[88:89], v88
    ds_read_b64 v[90:91], v90
    v_lshlrev_b32_sdwa v92, 3, v117 dst_sel:DWORD dst_unused:UNUSED_PAD src0_sel:DWORD src1_sel:WORD_0
    v_lshlrev_b32_sdwa v94, 3, v117 dst_sel:DWORD dst_unused:UNUSED_PAD src0_sel:DWORD src1_sel:WORD_1
    ds_read_b64 v[92:93], v92
    ds_read_b64 v[94:95], v94
    s_waitcnt lgkmcnt(8)
    v_smfmac_f32_16x16x64_bf16 v[40:43], v[64:67], v[96:103], v68
    v_rcp_f32 v148, v148
    v_pk_mul_f32 v[150:151], v[28:29], v[146:147]
    v_pk_fma_f32 v[152:153], v[152:153], v[128:129], v[130:131]
    v_rcp_f32 v149, v149
    v_pk_mul_f32 v[152:153], v[152:153], v[32:33]
    v_pk_mul_f32 v[154:155], v[34:35], v[34:35]
    v_exp_f32 v152, v152
    v_pk_fma_f32 v[150:151], v[30:31], v[148:149], v[150:151]
    v_pk_fma_f32 v[154:155], v[154:155], v[128:129], v[130:131]
    v_lshlrev_b32_sdwa v96, 3, v118 dst_sel:DWORD dst_unused:UNUSED_PAD src0_sel:DWORD src1_sel:WORD_0
    v_lshlrev_b32_sdwa v98, 3, v118 dst_sel:DWORD dst_unused:UNUSED_PAD src0_sel:DWORD src1_sel:WORD_1
    ds_read_b64 v[96:97], v96
    ds_read_b64 v[98:99], v98
    v_lshlrev_b32_sdwa v100, 3, v119 dst_sel:DWORD dst_unused:UNUSED_PAD src0_sel:DWORD src1_sel:WORD_0
    v_lshlrev_b32_sdwa v102, 3, v119 dst_sel:DWORD dst_unused:UNUSED_PAD src0_sel:DWORD src1_sel:WORD_1
    ds_read_b64 v[100:101], v100
    ds_read_b64 v[102:103], v102
    buffer_load_dwordx4 v[116:119], v69, s[12:15], s41 offen offset:2048 sc1
    s_waitcnt lgkmcnt(8)
    v_smfmac_f32_16x16x64_bf16 v[44:47], v[64:67], v[104:111], v68
    v_exp_f32 v153, v153
    v_add_f32 v150, v150, v151
    v_pk_mul_f32 v[154:155], v[154:155], v[34:35]
    v_min_u32 v150, -2, v150
    v_exp_f32 v154, v154
    buffer_store_dword v150, v70, s[12:15], s35 offen offset:1664 sc1
    v_pk_fma_f32 v[152:153], v[152:153], v[134:135], v[134:135]
    v_exp_f32 v155, v155
    v_pk_mul_f32 v[158:159], v[36:37], v[36:37]
    s_waitcnt vmcnt(5)
    v_lshlrev_b32_sdwa v104, 3, v120 dst_sel:DWORD dst_unused:UNUSED_PAD src0_sel:DWORD src1_sel:WORD_0
    v_lshlrev_b32_sdwa v106, 3, v120 dst_sel:DWORD dst_unused:UNUSED_PAD src0_sel:DWORD src1_sel:WORD_1
    ds_read_b64 v[104:105], v104
    ds_read_b64 v[106:107], v106
    v_lshlrev_b32_sdwa v108, 3, v121 dst_sel:DWORD dst_unused:UNUSED_PAD src0_sel:DWORD src1_sel:WORD_0
    v_lshlrev_b32_sdwa v110, 3, v121 dst_sel:DWORD dst_unused:UNUSED_PAD src0_sel:DWORD src1_sel:WORD_1
    ds_read_b64 v[108:109], v108
    ds_read_b64 v[110:111], v110
    s_waitcnt lgkmcnt(8)
    v_smfmac_f32_16x16x64_bf16 v[40:43], v[64:67], v[88:95], v68
    v_rcp_f32 v152, v152
    v_pk_fma_f32 v[154:155], v[154:155], v[136:137], v[136:137]
    v_pk_fma_f32 v[158:159], v[158:159], v[128:129], v[130:131]
    v_rcp_f32 v153, v153
    v_pk_mul_f32 v[158:159], v[158:159], v[36:37]
    v_pk_mul_f32 v[160:161], v[38:39], v[38:39]
    v_rcp_f32 v154, v154
    v_pk_mul_f32 v[156:157], v[32:33], v[152:153]
    v_pk_fma_f32 v[160:161], v[160:161], v[128:129], v[130:131]
    v_lshlrev_b32_sdwa v88, 3, v122 dst_sel:DWORD dst_unused:UNUSED_PAD src0_sel:DWORD src1_sel:WORD_0
    v_lshlrev_b32_sdwa v90, 3, v122 dst_sel:DWORD dst_unused:UNUSED_PAD src0_sel:DWORD src1_sel:WORD_1
    ds_read_b64 v[88:89], v88
    ds_read_b64 v[90:91], v90
    v_lshlrev_b32_sdwa v92, 3, v123 dst_sel:DWORD dst_unused:UNUSED_PAD src0_sel:DWORD src1_sel:WORD_0
    v_lshlrev_b32_sdwa v94, 3, v123 dst_sel:DWORD dst_unused:UNUSED_PAD src0_sel:DWORD src1_sel:WORD_1
    ds_read_b64 v[92:93], v92
    ds_read_b64 v[94:95], v94
    buffer_load_dwordx4 v[120:123], v69, s[12:15], s45 offen offset:2048 sc1
    s_waitcnt lgkmcnt(8)
    v_smfmac_f32_16x16x64_bf16 v[44:47], v[64:67], v[96:103], v68
    v_rcp_f32 v155, v155
    v_pk_mul_f32 v[160:161], v[160:161], v[38:39]
    v_exp_f32 v158, v158
    v_pk_fma_f32 v[156:157], v[34:35], v[154:155], v[156:157]
    v_exp_f32 v159, v159
    v_add_f32 v156, v156, v157
    v_exp_f32 v160, v160
    v_min_u32 v156, -2, v156
    v_pk_fma_f32 v[158:159], v[158:159], v[134:135], v[134:135]
    s_waitcnt vmcnt(4)
    v_lshlrev_b32_sdwa v96, 3, v124 dst_sel:DWORD dst_unused:UNUSED_PAD src0_sel:DWORD src1_sel:WORD_0
    v_lshlrev_b32_sdwa v98, 3, v124 dst_sel:DWORD dst_unused:UNUSED_PAD src0_sel:DWORD src1_sel:WORD_1
    ds_read_b64 v[96:97], v96
    ds_read_b64 v[98:99], v98
    v_lshlrev_b32_sdwa v100, 3, v125 dst_sel:DWORD dst_unused:UNUSED_PAD src0_sel:DWORD src1_sel:WORD_0
    v_lshlrev_b32_sdwa v102, 3, v125 dst_sel:DWORD dst_unused:UNUSED_PAD src0_sel:DWORD src1_sel:WORD_1
    ds_read_b64 v[100:101], v100
    ds_read_b64 v[102:103], v102
    s_waitcnt lgkmcnt(8)
    v_smfmac_f32_16x16x64_bf16 v[40:43], v[64:67], v[104:111], v68
    v_rcp_f32 v158, v158
    buffer_store_dword v156, v70, s[12:15], s35 offen offset:2048 sc1
    v_rcp_f32 v159, v159
    v_exp_f32 v161, v161
    v_lshlrev_b32_sdwa v104, 3, v126 dst_sel:DWORD dst_unused:UNUSED_PAD src0_sel:DWORD src1_sel:WORD_0
    v_lshlrev_b32_sdwa v106, 3, v126 dst_sel:DWORD dst_unused:UNUSED_PAD src0_sel:DWORD src1_sel:WORD_1
    ds_read_b64 v[104:105], v104
    ds_read_b64 v[106:107], v106
    v_lshlrev_b32_sdwa v108, 3, v127 dst_sel:DWORD dst_unused:UNUSED_PAD src0_sel:DWORD src1_sel:WORD_0
    v_lshlrev_b32_sdwa v110, 3, v127 dst_sel:DWORD dst_unused:UNUSED_PAD src0_sel:DWORD src1_sel:WORD_1
    ds_read_b64 v[108:109], v108
    ds_read_b64 v[110:111], v110
    buffer_load_dwordx4 v[124:127], v69, s[12:15], s20 offen offset:3072 sc1
    s_waitcnt lgkmcnt(8)
    v_smfmac_f32_16x16x64_bf16 v[44:47], v[64:67], v[88:95], v68
    v_pk_fma_f32 v[160:161], v[160:161], v[136:137], v[136:137]
    v_pk_mul_f32 v[162:163], v[36:37], v[158:159]
    v_rcp_f32 v160, v160
    v_pk_mul_f32 v[164:165], v[40:41], v[40:41]
    v_pk_mul_f32 v[166:167], v[42:43], v[42:43]
    v_rcp_f32 v161, v161
    v_pk_fma_f32 v[164:165], v[164:165], v[128:129], v[130:131]
    v_pk_fma_f32 v[166:167], v[166:167], v[128:129], v[130:131]
    v_pk_fma_f32 v[162:163], v[38:39], v[160:161], v[162:163]
    s_waitcnt vmcnt(4)
    v_lshlrev_b32_sdwa v88, 3, v116 dst_sel:DWORD dst_unused:UNUSED_PAD src0_sel:DWORD src1_sel:WORD_0
    v_lshlrev_b32_sdwa v90, 3, v116 dst_sel:DWORD dst_unused:UNUSED_PAD src0_sel:DWORD src1_sel:WORD_1
    ds_read_b64 v[88:89], v88
    ds_read_b64 v[90:91], v90
    v_lshlrev_b32_sdwa v92, 3, v117 dst_sel:DWORD dst_unused:UNUSED_PAD src0_sel:DWORD src1_sel:WORD_0
    v_lshlrev_b32_sdwa v94, 3, v117 dst_sel:DWORD dst_unused:UNUSED_PAD src0_sel:DWORD src1_sel:WORD_1
    ds_read_b64 v[92:93], v92
    ds_read_b64 v[94:95], v94
    s_waitcnt lgkmcnt(8)
    v_smfmac_f32_16x16x64_bf16 v[48:51], v[64:67], v[96:103], v68
    v_add_f32 v162, v162, v163
    v_pk_mul_f32 v[164:165], v[164:165], v[40:41]
    v_min_u32 v162, -2, v162
    v_exp_f32 v164, v164
    buffer_store_dword v162, v70, s[12:15], s35 offen offset:2176 sc1
    v_pk_mul_f32 v[166:167], v[166:167], v[42:43]
    v_exp_f32 v165, v165
    v_pk_mul_f32 v[170:171], v[44:45], v[44:45]
    v_pk_mul_f32 v[172:173], v[46:47], v[46:47]
    v_lshlrev_b32_sdwa v96, 3, v118 dst_sel:DWORD dst_unused:UNUSED_PAD src0_sel:DWORD src1_sel:WORD_0
    v_lshlrev_b32_sdwa v98, 3, v118 dst_sel:DWORD dst_unused:UNUSED_PAD src0_sel:DWORD src1_sel:WORD_1
    ds_read_b64 v[96:97], v96
    ds_read_b64 v[98:99], v98
    v_lshlrev_b32_sdwa v100, 3, v119 dst_sel:DWORD dst_unused:UNUSED_PAD src0_sel:DWORD src1_sel:WORD_0
    v_lshlrev_b32_sdwa v102, 3, v119 dst_sel:DWORD dst_unused:UNUSED_PAD src0_sel:DWORD src1_sel:WORD_1
    ds_read_b64 v[100:101], v100
    ds_read_b64 v[102:103], v102
    buffer_load_dwordx4 v[116:119], v69, s[12:15], s41 offen offset:3072 sc1
    s_waitcnt lgkmcnt(8)
    v_smfmac_f32_16x16x64_bf16 v[52:55], v[64:67], v[104:111], v68
    s_setprio 1
    v_exp_f32 v166, v166
    v_pk_fma_f32 v[164:165], v[164:165], v[134:135], v[134:135]
    v_pk_fma_f32 v[170:171], v[170:171], v[128:129], v[130:131]
    v_rcp_f32 v164, v164
    v_pk_mul_f32 v[170:171], v[170:171], v[44:45]
    v_pk_fma_f32 v[172:173], v[172:173], v[128:129], v[130:131]
    v_rcp_f32 v165, v165
    v_pk_mul_f32 v[172:173], v[172:173], v[46:47]
    v_exp_f32 v167, v167
    s_waitcnt vmcnt(4)
    v_lshlrev_b32_sdwa v104, 3, v120 dst_sel:DWORD dst_unused:UNUSED_PAD src0_sel:DWORD src1_sel:WORD_0
    v_lshlrev_b32_sdwa v106, 3, v120 dst_sel:DWORD dst_unused:UNUSED_PAD src0_sel:DWORD src1_sel:WORD_1
    ds_read_b64 v[104:105], v104
    ds_read_b64 v[106:107], v106
    v_lshlrev_b32_sdwa v108, 3, v121 dst_sel:DWORD dst_unused:UNUSED_PAD src0_sel:DWORD src1_sel:WORD_0
    v_lshlrev_b32_sdwa v110, 3, v121 dst_sel:DWORD dst_unused:UNUSED_PAD src0_sel:DWORD src1_sel:WORD_1
    ds_read_b64 v[108:109], v108
    ds_read_b64 v[110:111], v110
    s_waitcnt lgkmcnt(8)
    v_smfmac_f32_16x16x64_bf16 v[48:51], v[64:67], v[88:95], v68
    v_exp_f32 v170, v170
    v_pk_fma_f32 v[166:167], v[166:167], v[136:137], v[136:137]
    v_pk_mul_f32 v[168:169], v[40:41], v[164:165]
    v_rcp_f32 v166, v166
    v_rcp_f32 v167, v167
    v_exp_f32 v171, v171
    v_exp_f32 v172, v172
    v_pk_fma_f32 v[168:169], v[42:43], v[166:167], v[168:169]
    v_pk_fma_f32 v[170:171], v[170:171], v[134:135], v[134:135]
    v_lshlrev_b32_sdwa v88, 3, v122 dst_sel:DWORD dst_unused:UNUSED_PAD src0_sel:DWORD src1_sel:WORD_0
    v_lshlrev_b32_sdwa v90, 3, v122 dst_sel:DWORD dst_unused:UNUSED_PAD src0_sel:DWORD src1_sel:WORD_1
    ds_read_b64 v[88:89], v88
    ds_read_b64 v[90:91], v90
    v_lshlrev_b32_sdwa v92, 3, v123 dst_sel:DWORD dst_unused:UNUSED_PAD src0_sel:DWORD src1_sel:WORD_0
    v_lshlrev_b32_sdwa v94, 3, v123 dst_sel:DWORD dst_unused:UNUSED_PAD src0_sel:DWORD src1_sel:WORD_1
    ds_read_b64 v[92:93], v92
    ds_read_b64 v[94:95], v94
    buffer_load_dwordx4 v[120:123], v69, s[12:15], s45 offen offset:3072 sc1
    s_waitcnt lgkmcnt(8)
    v_smfmac_f32_16x16x64_bf16 v[52:55], v[64:67], v[96:103], v68
    v_rcp_f32 v170, v170
    v_add_f32 v168, v168, v169
    v_rcp_f32 v171, v171
    v_min_u32 v168, -2, v168
    v_exp_f32 v173, v173
    buffer_store_dword v168, v70, s[12:15], s35 offen offset:2560 sc1
    v_pk_mul_f32 v[174:175], v[44:45], v[170:171]
    v_pk_fma_f32 v[172:173], v[172:173], v[136:137], v[136:137]
    s_waitcnt vmcnt(4)
    v_lshlrev_b32_sdwa v96, 3, v124 dst_sel:DWORD dst_unused:UNUSED_PAD src0_sel:DWORD src1_sel:WORD_0
    v_lshlrev_b32_sdwa v98, 3, v124 dst_sel:DWORD dst_unused:UNUSED_PAD src0_sel:DWORD src1_sel:WORD_1
    ds_read_b64 v[96:97], v96
    ds_read_b64 v[98:99], v98
    v_lshlrev_b32_sdwa v100, 3, v125 dst_sel:DWORD dst_unused:UNUSED_PAD src0_sel:DWORD src1_sel:WORD_0
    v_lshlrev_b32_sdwa v102, 3, v125 dst_sel:DWORD dst_unused:UNUSED_PAD src0_sel:DWORD src1_sel:WORD_1
    ds_read_b64 v[100:101], v100
    ds_read_b64 v[102:103], v102
    s_waitcnt lgkmcnt(8)
    v_smfmac_f32_16x16x64_bf16 v[48:51], v[64:67], v[104:111], v68
    buffer_load_dword v72, v76, s[52:55], 0 offen offset:32 sc1
    buffer_load_short_d16_hi v73, v79, s[56:59], 0 offen
    buffer_load_ushort v81, v78, s[60:63], s68 offen
    buffer_load_dword v82, v79, s[12:15], s69 offen sc1
    v_rcp_f32 v172, v172
    v_rcp_f32 v173, v173
    v_lshlrev_b32_sdwa v104, 3, v126 dst_sel:DWORD dst_unused:UNUSED_PAD src0_sel:DWORD src1_sel:WORD_0
    v_lshlrev_b32_sdwa v106, 3, v126 dst_sel:DWORD dst_unused:UNUSED_PAD src0_sel:DWORD src1_sel:WORD_1
    ds_read_b64 v[104:105], v104
    ds_read_b64 v[106:107], v106
    v_lshlrev_b32_sdwa v108, 3, v127 dst_sel:DWORD dst_unused:UNUSED_PAD src0_sel:DWORD src1_sel:WORD_0
    v_lshlrev_b32_sdwa v110, 3, v127 dst_sel:DWORD dst_unused:UNUSED_PAD src0_sel:DWORD src1_sel:WORD_1
    ds_read_b64 v[108:109], v108
    ds_read_b64 v[110:111], v110
    s_waitcnt lgkmcnt(8)
    v_smfmac_f32_16x16x64_bf16 v[52:55], v[64:67], v[88:95], v68
    v_pk_fma_f32 v[174:175], v[46:47], v[172:173], v[174:175]
    v_pk_mul_f32 v[140:141], v[48:49], v[48:49]
    v_add_f32 v174, v174, v175
    v_pk_fma_f32 v[140:141], v[140:141], v[128:129], v[130:131]
    v_min_u32 v174, -2, v174
    v_pk_mul_f32 v[140:141], v[140:141], v[48:49]
    buffer_store_dword v174, v70, s[12:15], s35 offen offset:2688 sc1
    v_exp_f32 v140, v140
    v_pk_mul_f32 v[142:143], v[50:51], v[50:51]
    s_waitcnt vmcnt(7)
    v_lshlrev_b32_sdwa v88, 3, v116 dst_sel:DWORD dst_unused:UNUSED_PAD src0_sel:DWORD src1_sel:WORD_0
    v_lshlrev_b32_sdwa v90, 3, v116 dst_sel:DWORD dst_unused:UNUSED_PAD src0_sel:DWORD src1_sel:WORD_1
    ds_read_b64 v[88:89], v88
    ds_read_b64 v[90:91], v90
    v_lshlrev_b32_sdwa v92, 3, v117 dst_sel:DWORD dst_unused:UNUSED_PAD src0_sel:DWORD src1_sel:WORD_0
    v_lshlrev_b32_sdwa v94, 3, v117 dst_sel:DWORD dst_unused:UNUSED_PAD src0_sel:DWORD src1_sel:WORD_1
    ds_read_b64 v[92:93], v92
    ds_read_b64 v[94:95], v94
    s_waitcnt lgkmcnt(8)
    v_smfmac_f32_16x16x64_bf16 v[56:59], v[64:67], v[96:103], v68
    v_exp_f32 v141, v141
    v_pk_fma_f32 v[142:143], v[142:143], v[128:129], v[130:131]
    v_pk_mul_f32 v[146:147], v[52:53], v[52:53]
    v_pk_fma_f32 v[140:141], v[140:141], v[134:135], v[134:135]
    v_pk_mul_f32 v[142:143], v[142:143], v[50:51]
    v_rcp_f32 v140, v140
    v_pk_fma_f32 v[146:147], v[146:147], v[128:129], v[130:131]
    v_pk_mul_f32 v[148:149], v[54:55], v[54:55]
    v_rcp_f32 v141, v141
    v_lshlrev_b32_sdwa v96, 3, v118 dst_sel:DWORD dst_unused:UNUSED_PAD src0_sel:DWORD src1_sel:WORD_0
    v_lshlrev_b32_sdwa v98, 3, v118 dst_sel:DWORD dst_unused:UNUSED_PAD src0_sel:DWORD src1_sel:WORD_1
    ds_read_b64 v[96:97], v96
    ds_read_b64 v[98:99], v98
    v_lshlrev_b32_sdwa v100, 3, v119 dst_sel:DWORD dst_unused:UNUSED_PAD src0_sel:DWORD src1_sel:WORD_0
    v_lshlrev_b32_sdwa v102, 3, v119 dst_sel:DWORD dst_unused:UNUSED_PAD src0_sel:DWORD src1_sel:WORD_1
    ds_read_b64 v[100:101], v100
    ds_read_b64 v[102:103], v102
    s_waitcnt lgkmcnt(8)
    v_smfmac_f32_16x16x64_bf16 v[60:63], v[64:67], v[104:111], v68
    v_exp_f32 v142, v142
    v_pk_mul_f32 v[144:145], v[48:49], v[140:141]
    v_pk_mul_f32 v[146:147], v[146:147], v[52:53]
    v_exp_f32 v143, v143
    v_pk_fma_f32 v[148:149], v[148:149], v[128:129], v[130:131]
    v_exp_f32 v146, v146
    v_pk_fma_f32 v[142:143], v[142:143], v[136:137], v[136:137]
    v_pk_mul_f32 v[148:149], v[148:149], v[54:55]
    v_rcp_f32 v142, v142
    s_waitcnt vmcnt(6)
    v_lshlrev_b32_sdwa v104, 3, v120 dst_sel:DWORD dst_unused:UNUSED_PAD src0_sel:DWORD src1_sel:WORD_0
    v_lshlrev_b32_sdwa v106, 3, v120 dst_sel:DWORD dst_unused:UNUSED_PAD src0_sel:DWORD src1_sel:WORD_1
    ds_read_b64 v[104:105], v104
    ds_read_b64 v[106:107], v106
    v_lshlrev_b32_sdwa v108, 3, v121 dst_sel:DWORD dst_unused:UNUSED_PAD src0_sel:DWORD src1_sel:WORD_0
    v_lshlrev_b32_sdwa v110, 3, v121 dst_sel:DWORD dst_unused:UNUSED_PAD src0_sel:DWORD src1_sel:WORD_1
    ds_read_b64 v[108:109], v108
    ds_read_b64 v[110:111], v110
    s_waitcnt lgkmcnt(8)
    v_smfmac_f32_16x16x64_bf16 v[56:59], v[64:67], v[88:95], v68
    v_rcp_f32 v143, v143
    v_exp_f32 v147, v147
    v_exp_f32 v148, v148
    v_pk_fma_f32 v[144:145], v[50:51], v[142:143], v[144:145]
    v_pk_fma_f32 v[146:147], v[146:147], v[134:135], v[134:135]
    v_exp_f32 v149, v149
    v_add_f32 v144, v144, v145
    v_rcp_f32 v146, v146
    v_min_u32 v144, -2, v144
    v_lshlrev_b32_sdwa v88, 3, v122 dst_sel:DWORD dst_unused:UNUSED_PAD src0_sel:DWORD src1_sel:WORD_0
    v_lshlrev_b32_sdwa v90, 3, v122 dst_sel:DWORD dst_unused:UNUSED_PAD src0_sel:DWORD src1_sel:WORD_1
    ds_read_b64 v[88:89], v88
    ds_read_b64 v[90:91], v90
    v_lshlrev_b32_sdwa v92, 3, v123 dst_sel:DWORD dst_unused:UNUSED_PAD src0_sel:DWORD src1_sel:WORD_0
    v_lshlrev_b32_sdwa v94, 3, v123 dst_sel:DWORD dst_unused:UNUSED_PAD src0_sel:DWORD src1_sel:WORD_1
    ds_read_b64 v[92:93], v92
    ds_read_b64 v[94:95], v94
    s_waitcnt lgkmcnt(8)
    v_smfmac_f32_16x16x64_bf16 v[60:63], v[64:67], v[96:103], v68
    s_setprio 0
    v_rcp_f32 v147, v147
    buffer_store_dword v144, v70, s[12:15], s35 offen offset:3072 sc1
    v_pk_fma_f32 v[148:149], v[148:149], v[136:137], v[136:137]
    v_pk_mul_f32 v[150:151], v[52:53], v[146:147]
    v_rcp_f32 v148, v148
    v_rcp_f32 v149, v149
    s_waitcnt lgkmcnt(4)
    v_smfmac_f32_16x16x64_bf16 v[56:59], v[64:67], v[104:111], v68
    v_pk_fma_f32 v[150:151], v[54:55], v[148:149], v[150:151]
    s_waitcnt lgkmcnt(0)
    v_smfmac_f32_16x16x64_bf16 v[60:63], v[64:67], v[88:95], v68
    v_add_f32 v150, v150, v151
    s_nop 0
    v_min_u32 v150, -2, v150
    s_nop 0
    buffer_store_dword v150, v70, s[12:15], s35 offen offset:3200 sc1
    s_nop 0
    s_nop 0
    s_nop 0
    s_nop 0
    v_pk_mul_f32 v[152:153], v[56:57], v[56:57]
    v_pk_mul_f32 v[154:155], v[58:59], v[58:59]
    v_pk_fma_f32 v[152:153], v[152:153], v[128:129], v[130:131]
    v_pk_fma_f32 v[154:155], v[154:155], v[128:129], v[130:131]
    v_pk_mul_f32 v[152:153], v[152:153], v[56:57]
    v_pk_mul_f32 v[154:155], v[154:155], v[58:59]
    v_exp_f32 v152, v152
    v_pk_mul_f32 v[158:159], v[60:61], v[60:61]
    v_pk_mul_f32 v[160:161], v[62:63], v[62:63]
    v_exp_f32 v153, v153
    v_pk_fma_f32 v[158:159], v[158:159], v[128:129], v[130:131]
    v_pk_fma_f32 v[160:161], v[160:161], v[128:129], v[130:131]
    v_exp_f32 v154, v154
    v_pk_fma_f32 v[152:153], v[152:153], v[134:135], v[134:135]
    v_pk_mul_f32 v[158:159], v[158:159], v[60:61]
    v_rcp_f32 v152, v152
    v_pk_mul_f32 v[160:161], v[160:161], v[62:63]
    v_rcp_f32 v153, v153
    v_exp_f32 v155, v155
    v_exp_f32 v158, v158
    v_pk_mul_f32 v[156:157], v[56:57], v[152:153]
    v_pk_fma_f32 v[154:155], v[154:155], v[136:137], v[136:137]
    v_exp_f32 v159, v159
    v_rcp_f32 v154, v154
    v_rcp_f32 v155, v155
    v_pk_fma_f32 v[158:159], v[158:159], v[134:135], v[134:135]
    v_exp_f32 v160, v160
    v_pk_fma_f32 v[156:157], v[58:59], v[154:155], v[156:157]
    v_rcp_f32 v158, v158
    v_add_f32 v156, v156, v157
    v_rcp_f32 v159, v159
    v_min_u32 v156, -2, v156
    v_exp_f32 v161, v161
    buffer_store_dword v156, v70, s[12:15], s35 offen offset:3584 sc1
    v_pk_mul_f32 v[162:163], v[60:61], v[158:159]
    v_pk_fma_f32 v[160:161], v[160:161], v[136:137], v[136:137]
    s_nop 0
    v_rcp_f32 v160, v160
    v_rcp_f32 v161, v161
    s_nop 0
    s_nop 0
    v_pk_fma_f32 v[162:163], v[62:63], v[160:161], v[162:163]
    s_nop 0
    v_add_f32 v162, v162, v163
    s_nop 0
    v_min_u32 v162, -2, v162
    s_nop 0
    buffer_store_dword v162, v70, s[12:15], s35 offen offset:3712 sc1
    s_waitcnt vmcnt(5)

    v_cmp_ne_u32 vcc, -1, v72
    s_and_b32 s45, vcc_lo, 0xff
    s_cbranch_scc1 k1_kernel_rslow

k1_kernel_rjob:

    s_lshl_b32 s67, s64, 8
    s_add_u32 s68, s67, 29360128
    s_add_u32 s69, s68, 65536
    s_add_u32 s67, s67, 20971520

k1_kernel_rgrp:

    s_add_u32 s70, s67, s65
    s_add_u32 s71, s70, 262144
    s_add_u32 s72, s70, 524288
    s_add_u32 s73, s70, 786432
    s_add_u32 s65, s65, 1048576

    buffer_load_dwordx4 v[0:3], v74, s[12:15], s70 offen sc1
    buffer_load_dwordx4 v[4:7], v74, s[12:15], s71 offen sc1
    buffer_load_dwordx4 v[8:11], v74, s[12:15], s72 offen sc1
    buffer_load_dwordx4 v[12:15], v74, s[12:15], s73 offen sc1
    buffer_load_dword v16, v75, s[12:15], s68 offen sc1
    buffer_load_dword v17, v75, s[12:15], s69 offen sc1
    s_branch k1_kernel_rchk
k1_kernel_rpoll:
    s_mov_b64 exec, s[74:75]
    s_cbranch_execz k1_kernel_rsk0
    buffer_load_dwordx4 v[0:3], v74, s[12:15], s70 offen sc1
k1_kernel_rsk0:
    s_mov_b64 exec, s[76:77]
    s_cbranch_execz k1_kernel_rsk1
    buffer_load_dwordx4 v[4:7], v74, s[12:15], s71 offen sc1
k1_kernel_rsk1:
    s_mov_b64 exec, s[78:79]
    s_cbranch_execz k1_kernel_rsk2
    buffer_load_dwordx4 v[8:11], v74, s[12:15], s72 offen sc1
k1_kernel_rsk2:
    s_mov_b64 exec, s[80:81]
    s_cbranch_execz k1_kernel_rsk3
    buffer_load_dwordx4 v[12:15], v74, s[12:15], s73 offen sc1
k1_kernel_rsk3:
    s_mov_b64 exec, -1
k1_kernel_rchk:
    s_waitcnt vmcnt(0)
k1_kernel_rchk0:
    v_max3_u32 v20, v0, v1, v2
    v_max3_u32 v21, v4, v5, v6
    v_max3_u32 v22, v8, v9, v10
    v_max3_u32 v23, v12, v13, v14
    v_max_u32 v20, v20, v3
    v_max_u32 v21, v21, v7
    v_max_u32 v22, v22, v11
    v_max_u32 v23, v23, v15
    v_cmp_eq_u32 s[74:75], -1, v20
    v_cmp_eq_u32 s[76:77], -1, v21
    v_cmp_eq_u32 s[78:79], -1, v22
    v_cmp_eq_u32 s[80:81], -1, v23

    v_pk_add_f32 v[26:27], v[0:1], v[4:5]
    v_pk_add_f32 v[28:29], v[2:3], v[6:7]
    v_pk_add_f32 v[30:31], v[8:9], v[12:13]
    v_pk_add_f32 v[32:33], v[10:11], v[14:15]
    s_or_b64 s[82:83], s[74:75], s[76:77]
    s_or_b64 s[84:85], s[78:79], s[80:81]
    v_pk_add_f32 v[26:27], v[26:27], v[30:31]
    v_pk_add_f32 v[28:29], v[28:29], v[32:33]
    s_or_b64 s[82:83], s[82:83], s[84:85]
    s_cbranch_scc1 k1_kernel_rpoll
    v_permlane32_swap_b32 v26, v28
    v_permlane32_swap_b32 v27, v29
    s_cmp_lt_u32 s65, s66
    s_nop 0
    v_pk_add_f32 v[26:27], v[26:27], v[28:29]
    s_nop 1
    v_permlane16_swap_b32 v26, v27
    s_nop 1
    v_add_f32 v26, v26, v27
    v_add_f32 v79, v79, v26
    s_cbranch_scc1 k1_kernel_rgrp
    s_cmp_lg_u32 s43, 0
    s_cbranch_scc1 k1_kernel_rpn
    ds_write_b32 v77, v79
    s_cmp_lg_u32 s3, 0
    s_waitcnt lgkmcnt(0)
    s_barrier
    s_cbranch_scc1 k1_kernel_rend

    ds_read2st64_b32 v[40:41], v77 offset0:0 offset1:1
    ds_read2st64_b32 v[42:43], v77 offset0:2 offset1:3
    ds_read2st64_b32 v[44:45], v77 offset0:4 offset1:5
    ds_read2st64_b32 v[46:47], v77 offset0:6 offset1:7

    s_waitcnt lgkmcnt(2)
    v_pk_add_f32 v[26:27], v[40:41], v[42:43]
    v_max3_u32 v20, v41, v42, v43
    s_waitcnt lgkmcnt(0)
    v_pk_add_f32 v[28:29], v[44:45], v[46:47]
    v_max3_u32 v20, v20, v44, v45
    v_pk_add_f32 v[26:27], v[26:27], v[28:29]
    v_max3_u32 v20, v20, v46, v47
    v_add_f32 v79, v26, v27
    v_cmp_eq_u32 vcc, -1, v20
    s_cbranch_vccnz k1_kernel_rnext

k1_kernel_rpn:

    v_max_u32 v20, v16, v17
    v_add_f32 v21, v16, v17
    v_cmp_eq_u32 vcc, -1, v20
    v_cvt_pk_bf16_f32 v21, v79, v21
    s_cbranch_vccnz k1_kernel_rpn2
    v_lshlrev_b32 v22, 16, v21
    v_and_b32 v21, 0xffff0000, v21
    v_add_f32 v22, v22, v73
    v_cvt_pk_bf16_f32 v22, v22, v22
    v_lshlrev_b32 v22, 16, v22
    v_add_f32 v22, v22, v21
    s_lshl_b32 s45, s64, 7
    v_cvt_pk_bf16_f32 v22, v22, v22
    buffer_store_short v22, v78, s[60:63], s45 offen

k1_kernel_rnext:

    v_cmp_ne_u32 vcc, 0, v72
    s_and_b32 s45, vcc_lo, 0xff00
    s_cbranch_scc1 k1_kernel_rmore

k1_kernel_rend:
    s_endpgm
k1_kernel_rpn2:
    buffer_load_dword v16, v75, s[12:15], s68 offen sc1
    buffer_load_dword v17, v75, s[12:15], s69 offen sc1
    s_waitcnt vmcnt(0)
    s_branch k1_kernel_rpn
k1_kernel_rmore:

    s_ff1_i32_b32 s45, s45
    s_mov_b32 s43, 1
    s_mov_b32 s65, 0
    s_mov_b32 s66, 8388608
    v_readlane_b32 s44, v72, s45
    v_mov_b32 v79, 0
    s_mov_b32 m0, s45
    s_ff1_i32_b32 s64, s44
    s_bitset0_b32 s44, s64
    s_sub_u32 s45, s45, 8
    s_lshl_b32 s45, s45, 5
    s_add_u32 s64, s64, s45
    v_writelane_b32 v72, s44, m0
    s_branch k1_kernel_rjob

k1_kernel_rslow:
    s_lshl_b32 s65, s3, 20
    buffer_load_dword v72, v76, s[52:55], 0 offen offset:32 sc1
    s_waitcnt vmcnt(0)

    v_cmp_ne_u32 vcc, -1, v72
    s_and_b32 s45, vcc_lo, 0xff
    s_cbranch_scc0 k1_kernel_rjob

    s_add_u32 s42, s42, 1
    s_cmp_lt_u32 s42, 200
    s_cbranch_scc1 k1_kernel_rslow
    s_lshl_b32 s44, 1, s64
    s_lshr_b32 s45, s64, 5
    s_lshl_b32 s45, s45, 2
    v_mov_b32 v20, s44
    s_mov_b64 exec, 1
    buffer_atomic_or v20, v76, s[52:55], s45 offen offset:64 sc0
    s_mov_b64 exec, -1
    s_waitcnt vmcnt(0)
    buffer_load_dword v72, v76, s[52:55], 0 offen offset:32 sc1
    s_waitcnt vmcnt(0)

    v_cmp_ne_u32 vcc, -1, v72
    s_and_b32 s45, vcc_lo, 0xff
    s_cbranch_scc0 k1_kernel_rjob

    v_mov_b32 v20, -1
    ds_write_b32 v77, v20
    s_waitcnt lgkmcnt(0)
    s_endpgm

k1_kernel_end:
    s_endpgm
k1_kernel_main:
    s_setprio 3
    s_mov_b32 s16, s4
    s_and_b32 s17, s5, 0xffff
    s_mov_b32 s20, s6
    s_and_b32 s21, s7, 0xffff
    s_mov_b32 s28, s10
    s_and_b32 s29, s11, 0xffff
    s_mov_b32 s32, s12
    s_and_b32 s33, s13, 0xffff
    s_and_b32 s13, s13, 0xffff
    s_and_b32 s53, s53, 0xffff

    v_and_b32 v5, 15, v255
    v_lshrrev_b32 v6, 4, v255
    v_and_b32 v7, 3, v255
    v_bfe_u32 v8, v255, 2, 2
    v_lshl_add_u32 v9, v7, 2, v8
    v_cmp_eq_u32 s[46:47], 0, v7
    s_movk_i32 s45, 200
    v_mov_b32 v10, 144384
    v_mad_u32_u24 v11, v9, s45, v10
    v_and_b32 v205, 48, v255
    v_add_u32 v120, v11, v205
    v_mul_u32_u24 v12, 6400, v6
    v_add_u32 v124, v11, v12
    v_and_b32 v12, 16, v255
    v_add_u32 v10, v10, v12
    v_add_u32 v11, v11, v12
    v_and_b32 v12, 32, v255
    v_mul_u32_u24 v12, 100, v12
    v_add_u32 v123, v11, v12
    v_and_b32 v12, 8, v255
    v_lshl_add_u32 v13, v7, 1, v12
    v_and_b32 v14, 1, v8
    v_add_u32 v13, v13, v14
    v_lshrrev_b32 v14, 5, v255
    v_lshl_add_u32 v14, v13, 1, v14
    v_mad_u32_u24 v121, v14, s45, v10
    v_lshl_add_u32 v122, v12, 2, v121
    v_lshlrev_b32 v15, 2, v6
    v_sub_u32 v13, v13, v15
    v_lshrrev_b32 v14, 1, v9
    v_sub_u32 v14, v14, v15
    v_sub_u32 v15, v5, v15
    v_and_b32 v12, 1, v9
    v_lshlrev_b32 v12, 4, v12
    v_mov_b32 v16, 0x3f80
    v_lshlrev_b32 v12, v12, v16
    v_mov_b32 v17, 0x3f800000

    v_cmp_eq_u32 vcc, 0, v13
    v_cndmask_b32 v112, 0, v16, vcc
    v_cmp_eq_u32 vcc, 0, v14
    v_cndmask_b32 v104, 0, v12, vcc
    v_cmp_eq_u32 vcc, -8, v14
    v_cndmask_b32 v108, 0, v12, vcc
    v_cmp_eq_u32 vcc, 0, v15
    v_cndmask_b32 v192, 0, v17, vcc
    v_lshlrev_b32 v116, 16, v112

    v_cmp_eq_u32 vcc, 1, v13
    v_cndmask_b32 v113, 0, v16, vcc
    v_cmp_eq_u32 vcc, 1, v14
    v_cndmask_b32 v105, 0, v12, vcc
    v_cmp_eq_u32 vcc, -7, v14
    v_cndmask_b32 v109, 0, v12, vcc
    v_cmp_eq_u32 vcc, 1, v15
    v_cndmask_b32 v193, 0, v17, vcc
    v_lshlrev_b32 v117, 16, v113

    v_cmp_eq_u32 vcc, 2, v13
    v_cndmask_b32 v114, 0, v16, vcc
    v_cmp_eq_u32 vcc, 2, v14
    v_cndmask_b32 v106, 0, v12, vcc
    v_cmp_eq_u32 vcc, -6, v14
    v_cndmask_b32 v110, 0, v12, vcc
    v_cmp_eq_u32 vcc, 2, v15
    v_cndmask_b32 v194, 0, v17, vcc
    v_lshlrev_b32 v118, 16, v114

    v_cmp_eq_u32 vcc, 3, v13
    v_cndmask_b32 v115, 0, v16, vcc
    v_cmp_eq_u32 vcc, 3, v14
    v_cndmask_b32 v107, 0, v12, vcc
    v_cmp_eq_u32 vcc, -5, v14
    v_cndmask_b32 v111, 0, v12, vcc
    v_cmp_eq_u32 vcc, 3, v15
    v_cndmask_b32 v195, 0, v17, vcc
    v_lshlrev_b32 v119, 16, v115

    s_mul_i32 s45, s3, 36864
    s_add_u32 s45, s45, 128
    s_movk_i32 s57, 144
    v_mov_b32 v10, s45
    v_mad_u32_u24 v206, v5, s57, v10
    v_mad_u32_u24 v210, v255, s57, v10
    v_add_u32 v210, 12, v210
    v_cmp_lt_u32 vcc, 25, v255
    v_subrev_u32 v11, 26, v255
    v_cndmask_b32 v11, v255, v11, vcc
    v_add_u32 v12, 2304, v10
    v_cndmask_b32 v10, v10, v12, vcc
    v_and_b32 v12, 3, v11
    v_mad_u32_u24 v10, v12, s57, v10
    v_lshrrev_b32 v11, 2, v11
    v_lshl_add_u32 v207, v11, 1, v10
    v_cmp_gt_u32 vcc, 52, v255
    v_add_u32 v11, 2304, v210
    v_cndmask_b32 v207, v11, v207, vcc
    v_mov_b32 v208, 0xdddddddd
    v_mov_b32 v211, 1000
    s_mov_b32 s60, 0xff00ff00
    s_mov_b32 s61, 0xff00ff00
    s_mov_b32 s62, -1
    s_mov_b32 s63, 0xffff

    s_waitcnt vmcnt(3)

    s_mov_b64 exec, 1
    ds_add_u32 v252, v253 offset:0
    s_mov_b64 exec, -1

k1_kernel_wf1:

    ds_read_b32 v251, v252 offset:0
    s_waitcnt lgkmcnt(0)
    v_readfirstlane_b32 s45, v251
    s_cmp_lt_u32 s45, 4
    s_cbranch_scc1 k1_kernel_wf1

    v_mov_b32 v64, 0
    v_mov_b32 v65, 0
    v_mov_b32 v66, 0
    v_mov_b32 v67, 0
    s_mov_b64 exec, s[62:63]
    ds_read_b64 v[64:65], v124 offset:192
    ds_read_b64 v[66:67], v124 offset:3392
    s_mov_b64 exec, -1
    ds_read_b64 v[68:69], v120 offset:16160
    ds_read_b64 v[70:71], v120 offset:16168
    ds_read_b64 v[72:73], v120 offset:0
    ds_read_b64 v[74:75], v120 offset:8
    ds_read_b64 v[76:77], v123 offset:0
    ds_read_b64 v[78:79], v123 offset:8
    s_waitcnt vmcnt(2)
    s_waitcnt lgkmcnt(4)
    v_mfma_f32_16x16x32_bf16 v[56:59], v[104:107], v[64:67], 0
    ds_read_b64 v[80:81], v120 offset:3232
    ds_read_b64 v[82:83], v120 offset:3240
    v_mfma_f32_16x16x32_bf16 v[60:63], v[108:111], v[64:67], 0
    v_mfma_f32_16x16x32_bf16 v[52:55], v[104:107], v[68:71], 0
    v_mfma_f32_16x16x32_bf16 v[56:59], v[232:235], v[104:107], v[56:59]
    v_mov_b32 v84, 0
    v_mov_b32 v85, 0
    v_mov_b32 v86, 0
    v_mov_b32 v87, 0
    s_mov_b64 exec, s[60:61]
    ds_read_b64 v[84:85], v121 offset:3232
    ds_read_b64 v[86:87], v121 offset:3240
    s_mov_b64 exec, -1
    v_mfma_f32_16x16x32_bf16 v[60:63], v[232:235], v[108:111], v[60:63]
    s_waitcnt lgkmcnt(4)
    v_mfma_f32_16x16x32_bf16 v[0:3], v[104:107], v[72:75], 0
    ds_read_b64 v[64:65], v120 offset:64
    ds_read_b64 v[66:67], v120 offset:72
    v_mfma_f32_16x16x32_bf16 v[4:7], v[108:111], v[72:75], 0
    v_mfma_f32_16x16x32_bf16 v[4:7], v[76:79], v[108:111], v[4:7]
    v_cndmask_b32 v62, 0, v62, s[46:47]
    ds_read_b64 v[68:69], v121 offset:6400
    ds_read_b64 v[70:71], v121 offset:6408
    s_waitcnt lgkmcnt(4)
    v_mfma_f32_16x16x32_bf16 v[88:91], v[112:115], v[80:83], 0
    ds_read_b64 v[72:73], v120 offset:9632
    ds_read_b64 v[74:75], v120 offset:9640
    v_mfma_f32_16x16x32_bf16 v[92:95], v[116:119], v[80:83], 0
    v_mfma_f32_16x16x32_bf16 v[88:91], v[84:87], v[104:107], v[88:91]
    v_mfma_f32_16x16x32_bf16 v[92:95], v[84:87], v[108:111], v[92:95]
    ds_read_b64 v[76:77], v123 offset:3296
    ds_read_b64 v[78:79], v123 offset:3304
    s_waitcnt lgkmcnt(4)
    v_mfma_f32_16x16x32_bf16 v[96:99], v[112:115], v[64:67], 0
    ds_read_b64 v[84:85], v122 offset:6464
    ds_read_b64 v[86:87], v122 offset:6472
    v_mfma_f32_16x16x32_bf16 v[100:103], v[116:119], v[64:67], 0
    v_cvt_pk_bf16_f32 v8, v88, v89
    v_cvt_pk_bf16_f32 v9, v90, v91
    v_mfma_f32_16x16x32_bf16 v[96:99], v[68:71], v[104:107], v[96:99]
    v_cvt_pk_bf16_f32 v10, v92, v93
    v_cvt_pk_bf16_f32 v11, v94, v95
    v_mfma_f32_16x16x32_bf16 v[100:103], v[68:71], v[108:111], v[100:103]
    s_waitcnt lgkmcnt(2)
    v_mfma_f32_16x16x32_bf16 v[16:19], v[104:107], v[72:75], 0
    ds_read_b64 v[64:65], v120 offset:128
    ds_read_b64 v[66:67], v120 offset:136
    v_mfma_f32_16x16x32_bf16 v[20:23], v[108:111], v[72:75], 0
    v_cvt_pk_bf16_f32 v12, v96, v97
    v_cvt_pk_bf16_f32 v13, v98, v99
    v_mfma_f32_16x16x32_bf16 v[16:19], v[76:79], v[104:107], v[16:19]
    v_cvt_pk_bf16_f32 v14, v100, v101
    v_cvt_pk_bf16_f32 v15, v102, v103
    v_mfma_f32_16x16x32_bf16 v[20:23], v[76:79], v[108:111], v[20:23]
    ds_read_b64 v[68:69], v121 offset:12800
    ds_read_b64 v[70:71], v121 offset:12808
    s_waitcnt lgkmcnt(4)
    v_mfma_f32_16x16x32_bf16 v[96:99], v[84:87], v[104:107], 0
    ds_read_b64 v[72:73], v120 offset:3328
    ds_read_b64 v[74:75], v120 offset:3336
    v_mfma_f32_16x16x32_bf16 v[100:103], v[84:87], v[108:111], 0
    s_nop 3
    ds_read_b64 v[76:77], v123 offset:12832
    ds_read_b64 v[78:79], v123 offset:12840
    s_waitcnt lgkmcnt(4)
    v_mfma_f32_16x16x32_bf16 v[88:91], v[112:115], v[64:67], 0
    ds_read_b64 v[80:81], v120 offset:6528
    ds_read_b64 v[82:83], v120 offset:6536
    v_mfma_f32_16x16x32_bf16 v[92:95], v[116:119], v[64:67], 0
    v_cvt_pk_bf16_f32 v24, v96, v97
    v_cvt_pk_bf16_f32 v25, v98, v99
    v_mfma_f32_16x16x32_bf16 v[88:91], v[68:71], v[104:107], v[88:91]
    v_cvt_pk_bf16_f32 v26, v100, v101
    v_cvt_pk_bf16_f32 v27, v102, v103
    v_mfma_f32_16x16x32_bf16 v[92:95], v[68:71], v[108:111], v[92:95]
    ds_read_b64 v[84:85], v121 offset:12864
    ds_read_b64 v[86:87], v121 offset:12872
    s_waitcnt lgkmcnt(4)
    v_mfma_f32_16x16x32_bf16 v[32:35], v[104:107], v[72:75], 0
    ds_read_b64 v[64:65], v120 offset:9728
    ds_read_b64 v[66:67], v120 offset:9736
    v_mfma_f32_16x16x32_bf16 v[36:39], v[108:111], v[72:75], 0
    v_cvt_pk_bf16_f32 v28, v88, v89
    v_cvt_pk_bf16_f32 v29, v90, v91
    v_mfma_f32_16x16x32_bf16 v[32:35], v[76:79], v[104:107], v[32:35]
    v_cvt_pk_bf16_f32 v30, v92, v93
    v_cvt_pk_bf16_f32 v31, v94, v95
    v_mfma_f32_16x16x32_bf16 v[36:39], v[76:79], v[108:111], v[36:39]
    ds_read_b64 v[68:69], v121 offset:12896
    ds_read_b64 v[70:71], v121 offset:12904
    s_waitcnt lgkmcnt(4)
    v_mfma_f32_16x16x32_bf16 v[88:91], v[112:115], v[80:83], 0
    ds_read_b64 v[72:73], v120 offset:12928
    ds_read_b64 v[74:75], v120 offset:12936
    v_mfma_f32_16x16x32_bf16 v[92:95], v[116:119], v[80:83], 0
    v_mfma_f32_16x16x32_bf16 v[88:91], v[84:87], v[104:107], v[88:91]
    v_mfma_f32_16x16x32_bf16 v[92:95], v[84:87], v[108:111], v[92:95]
    v_mov_b32 v76, 0
    v_mov_b32 v77, 0
    v_mov_b32 v78, 0
    v_mov_b32 v79, 0
    s_mov_b64 exec, s[60:61]
    ds_read_b64 v[76:77], v121 offset:12928
    ds_read_b64 v[78:79], v121 offset:12936
    s_mov_b64 exec, -1
    s_waitcnt lgkmcnt(4)
    v_mfma_f32_16x16x32_bf16 v[96:99], v[112:115], v[64:67], 0
    v_mfma_f32_16x16x32_bf16 v[100:103], v[116:119], v[64:67], 0
    v_cvt_pk_bf16_f32 v40, v88, v89
    v_cvt_pk_bf16_f32 v41, v90, v91
    v_mfma_f32_16x16x32_bf16 v[96:99], v[68:71], v[104:107], v[96:99]
    v_cvt_pk_bf16_f32 v42, v92, v93
    v_cvt_pk_bf16_f32 v43, v94, v95
    v_mfma_f32_16x16x32_bf16 v[100:103], v[68:71], v[108:111], v[100:103]
    s_waitcnt lgkmcnt(0)

    s_mov_b64 exec, 1
    ds_add_u32 v252, v253 offset:12
    s_mov_b64 exec, -1

    v_mfma_f32_16x16x32_bf16 v[88:91], v[112:115], v[72:75], 0
    v_mfma_f32_16x16x32_bf16 v[92:95], v[116:119], v[72:75], 0
    v_cvt_pk_bf16_f32 v44, v96, v97
    v_cvt_pk_bf16_f32 v45, v98, v99
    v_mfma_f32_16x16x32_bf16 v[88:91], v[76:79], v[104:107], v[88:91]
    v_cvt_pk_bf16_f32 v46, v100, v101
    v_cvt_pk_bf16_f32 v47, v102, v103
    v_mfma_f32_16x16x32_bf16 v[92:95], v[76:79], v[108:111], v[92:95]
    s_nop 7
    v_cvt_pk_bf16_f32 v48, v88, v89
    v_cvt_pk_bf16_f32 v49, v90, v91
    v_cvt_pk_bf16_f32 v50, v92, v93
    v_cvt_pk_bf16_f32 v51, v94, v95

    v_mov_b32_dpp v63, v62 row_shr:1 row_mask:0xf bank_mask:0xf bound_ctrl:0
    ds_write_b32 v210, v211
    v_and_b32 v209, 1, v255
    v_lshlrev_b32 v248, 1, v205
    v_lshl_add_u32 v248, v209, 2, v248
    v_mul_u32_u24 v200, 0xaaaa, v209
    v_mov_b32 v209, 0
    s_mov_b32 vcc_lo, 0x01010101
    s_mov_b32 vcc_hi, 0x01010101
    s_movk_i32 s58, 7

    v_mov_b64 v[164:165], 0
    v_mov_b64 v[168:169], 0
    v_mov_b64 v[172:173], 0
    v_mov_b64 v[176:177], 0
    v_mov_b64 v[180:181], 0
    v_mov_b64 v[184:185], 0
    v_mov_b64 v[188:189], 0
    v_mov_b64 v[190:191], 0
    s_waitcnt vmcnt(1)
    ds_write_b16 v207, v240 offset:0
    ds_write_b16 v207, v241 offset:576
    ds_write_b16 v207, v242 offset:1152
    ds_write_b16 v207, v243 offset:1728
    v_add_u32 v250, 0x4444, v200
    ds_read_b128 v[196:199], v206 offset:0
k1_kernel_wf2:

    ds_read_b32 v251, v252 offset:16
    s_waitcnt lgkmcnt(0)
    v_readfirstlane_b32 s45, v251
    s_cmp_lt_u32 s45, 4
    s_cbranch_scc1 k1_kernel_wf2

    s_setprio 2
    v_mad_u32_u16 v68, v196, s57, v205 op_sel:[0,0,0,0]
    ds_read_b128 v[64:67], v68 offset:0
    ds_read_b128 v[68:71], v68 offset:64
    v_mad_u32_u16 v76, v196, s57, v205 op_sel:[1,0,0,0]
    ds_read_b128 v[72:75], v76 offset:0
    ds_read_b128 v[76:79], v76 offset:64
    v_mad_u32_u16 v84, v197, s57, v205 op_sel:[0,0,0,0]
    ds_read_b128 v[80:83], v84 offset:0
    ds_read_b128 v[84:87], v84 offset:64
    v_mad_u32_u16 v92, v197, s57, v205 op_sel:[1,0,0,0]
    ds_read_b128 v[88:91], v92 offset:0
    ds_read_b128 v[92:95], v92 offset:64
    v_mad_u32_u16 v100, v198, s57, v205 op_sel:[0,0,0,0]
    ds_read_b128 v[96:99], v100 offset:0
    ds_read_b128 v[100:103], v100 offset:64
    buffer_load_dwordx4 v[240:243], v249, s[16:19], s74 offen offset:0
    s_waitcnt lgkmcnt(4)
    v_mad_u32_u16 v108, v198, s57, v205 op_sel:[1,0,0,0]
    ds_read_b128 v[104:107], v108 offset:0
k1_kernel_loop:
    v_mfma_f32_16x16x32_bf16 v[116:119], v[64:67], v[64:67], 0
    ds_read_b128 v[108:111], v108 offset:64
    v_mad_u32_u16 v114, v199, s57, v248 op_sel:[0,0,0,0]
    v_mfma_f32_16x16x32_bf16 v[116:119], v[68:71], v[68:71], v[116:119]
    ds_read2_b32 v[112:113], v114 offset0:0 offset1:2
    ds_read2_b32 v[114:115], v114 offset0:4 offset1:6
    v_mfma_f32_16x16x32_bf16 v[120:123], v[72:75], v[64:67], 0
    ds_read_b128 v[196:199], v206 offset:2304
    v_fmac_f32 v209, v181, v60
    v_mfma_f32_16x16x32_bf16 v[120:123], v[76:79], v[68:71], v[120:123]
    v_fmac_f32 v209, v184, v61
    v_fmac_f32 v209, v188, v192
    v_mfma_f32_16x16x32_bf16 v[124:127], v[72:75], v[72:75], 0
    v_fmac_f32 v209, v185, v61
    v_fmac_f32 v209, v189, v193
    v_mfma_f32_16x16x32_bf16 v[124:127], v[76:79], v[76:79], v[124:127]
    v_fmac_f32 v209, v190, v194
    v_fmac_f32 v209, v191, v195
    v_mfma_f32_16x16x32_bf16 v[128:131], v[80:83], v[72:75], 0
    v_fmac_f32 v200, v156, v52
    v_fmac_f32 v201, v157, v53
    v_mfma_f32_16x16x32_bf16 v[128:131], v[84:87], v[76:79], v[128:131]
    v_fmac_f32 v200, v158, v54
    v_fmac_f32 v201, v159, v55
    v_mfma_f32_16x16x32_bf16 v[132:135], v[80:83], v[64:67], 0
    v_add_f32 v201, v201, v209
    v_fmac_f32 v200, v160, v62
    v_mfma_f32_16x16x32_bf16 v[132:135], v[84:87], v[68:71], v[132:135]
    s_waitcnt lgkmcnt(7)
    v_fmac_f32 v200, v161, v63
    v_smfmac_f32_16x16x64_bf16 v[188:191], v[8:11], v[124:131], v208
    v_add_f32 v203, v200, v201
    v_mfma_f32_16x16x32_bf16 v[136:139], v[88:91], v[64:67], 0
    v_fma_f32 v200, v116, v0, -v209
    v_mul_f32 v201, v117, v1
    v_mfma_f32_16x16x32_bf16 v[136:139], v[92:95], v[68:71], v[136:139]
    v_fmac_f32 v200, v118, v2
    v_fmac_f32 v201, v119, v3
    v_mfma_f32_16x16x32_bf16 v[140:143], v[72:75], v[88:91], 0
    v_fmac_f32 v200, v120, v4
    v_fmac_f32 v201, v121, v5
    v_mfma_f32_16x16x32_bf16 v[140:143], v[76:79], v[92:95], v[140:143]
    v_fmac_f32 v200, v122, v6
    v_fmac_f32 v201, v123, v7
    v_smfmac_f32_16x16x64_bf16 v[188:191], v[12:15], v[132:139], v208
    v_permlane32_swap_b32 v202, v203
    v_mfma_f32_16x16x32_bf16 v[144:147], v[80:83], v[88:91], 0
    s_waitcnt vmcnt(1)
    ds_write_b16 v207, v244 offset:4608
    v_mfma_f32_16x16x32_bf16 v[144:147], v[84:87], v[92:95], v[144:147]
    v_fmac_f32 v200, v140, v16
    v_fmac_f32 v201, v141, v17
    v_mfma_f32_16x16x32_bf16 v[148:151], v[80:83], v[80:83], 0
    v_fmac_f32 v200, v142, v18
    v_fmac_f32 v201, v143, v19
    v_mfma_f32_16x16x32_bf16 v[148:151], v[84:87], v[84:87], v[148:151]
    v_add_f32 v211, v202, v203
    ds_write_b16 v207, v245 offset:5184
    v_mfma_f32_16x16x32_bf16 v[152:155], v[88:91], v[88:91], 0
    s_waitcnt lgkmcnt(2)
    v_fmac_f32 v200, v144, v20
    v_mfma_f32_16x16x32_bf16 v[152:155], v[92:95], v[92:95], v[152:155]
    v_fmac_f32 v201, v145, v21
    v_fmac_f32 v200, v146, v22
    v_mfma_f32_16x16x32_bf16 v[116:119], v[96:99], v[64:67], 0
    v_fmac_f32 v201, v147, v23
    ds_write_b16 v207, v246 offset:5760
    v_mfma_f32_16x16x32_bf16 v[116:119], v[100:103], v[68:71], v[116:119]
    ds_write_b16 v207, v247 offset:6336
    buffer_load_dwordx4 v[244:247], v249, s[16:19], s74 offen offset:800
    v_smfmac_f32_16x16x64_bf16 v[188:191], v[24:27], v[148:155], v208
    v_mfma_f32_16x16x32_bf16 v[120:123], v[104:107], v[64:67], 0
    v_mfma_f32_16x16x32_bf16 v[120:123], v[108:111], v[68:71], v[120:123]
    v_smfmac_f32_16x16x64_bf16 v[164:167], v[112:115], v[64:71], v250
    v_mad_u32_u16 v68, v196, s57, v205 op_sel:[0,0,0,0]
    v_mfma_f32_16x16x32_bf16 v[124:127], v[96:99], v[72:75], 0
    ds_read_b128 v[64:67], v68 offset:0
    ds_read_b128 v[68:71], v68 offset:64
    v_smfmac_f32_16x16x64_bf16 v[188:191], v[28:31], v[116:123], v208
    v_mfma_f32_16x16x32_bf16 v[124:127], v[100:103], v[76:79], v[124:127]
    v_mul_f32 v209, v164, v56
    v_mfma_f32_16x16x32_bf16 v[128:131], v[104:107], v[72:75], 0
    v_fmac_f32 v209, v165, v56
    v_mfma_f32_16x16x32_bf16 v[128:131], v[108:111], v[76:79], v[128:131]
    v_smfmac_f32_16x16x64_bf16 v[168:171], v[112:115], v[72:79], v250
    v_mad_u32_u16 v76, v196, s57, v205 op_sel:[1,0,0,0]
    v_mfma_f32_16x16x32_bf16 v[132:135], v[96:99], v[80:83], 0
    ds_read_b128 v[72:75], v76 offset:0
    ds_read_b128 v[76:79], v76 offset:64
    v_mfma_f32_16x16x32_bf16 v[132:135], v[100:103], v[84:87], v[132:135]
    v_fmac_f32 v200, v124, v32
    v_fmac_f32 v201, v125, v33
    v_mfma_f32_16x16x32_bf16 v[136:139], v[104:107], v[80:83], 0
    v_fmac_f32 v209, v168, v57
    v_fmac_f32 v200, v126, v34
    v_mfma_f32_16x16x32_bf16 v[136:139], v[108:111], v[84:87], v[136:139]
    v_fmac_f32 v209, v169, v57
    v_fmac_f32 v201, v127, v35
    v_smfmac_f32_16x16x64_bf16 v[172:175], v[112:115], v[80:87], v250
    v_mad_u32_u16 v84, v197, s57, v205 op_sel:[0,0,0,0]
    v_mfma_f32_16x16x32_bf16 v[140:143], v[96:99], v[88:91], 0
    ds_read_b128 v[80:83], v84 offset:0
    ds_read_b128 v[84:87], v84 offset:64
    v_smfmac_f32_16x16x64_bf16 v[188:191], v[40:43], v[132:139], v208
    v_fmac_f32 v200, v128, v36
    v_mfma_f32_16x16x32_bf16 v[140:143], v[100:103], v[92:95], v[140:143]
    v_fmac_f32 v209, v172, v58
    v_fmac_f32 v201, v129, v37
    v_mfma_f32_16x16x32_bf16 v[144:147], v[104:107], v[88:91], 0
    v_fmac_f32 v209, v173, v58
    v_fmac_f32 v200, v130, v38
    v_mfma_f32_16x16x32_bf16 v[144:147], v[108:111], v[92:95], v[144:147]
    v_fmac_f32 v201, v131, v39
    v_smfmac_f32_16x16x64_bf16 v[176:179], v[112:115], v[88:95], v250
    v_mad_u32_u16 v92, v197, s57, v205 op_sel:[1,0,0,0]
    v_mfma_f32_16x16x32_bf16 v[148:151], v[96:99], v[96:99], 0
    ds_read_b128 v[88:91], v92 offset:0
    ds_read_b128 v[92:95], v92 offset:64
    v_smfmac_f32_16x16x64_bf16 v[188:191], v[44:47], v[140:147], v208
    v_mfma_f32_16x16x32_bf16 v[148:151], v[100:103], v[100:103], v[148:151]
    v_fmac_f32 v209, v176, v59
    v_mfma_f32_16x16x32_bf16 v[152:155], v[104:107], v[96:99], 0
    v_fmac_f32 v209, v177, v59
    v_mfma_f32_16x16x32_bf16 v[152:155], v[108:111], v[100:103], v[152:155]
    v_smfmac_f32_16x16x64_bf16 v[180:183], v[112:115], v[96:103], v250
    v_mad_u32_u16 v100, v198, s57, v205 op_sel:[0,0,0,0]
    v_mfma_f32_16x16x32_bf16 v[156:159], v[104:107], v[104:107], 0
    ds_read_b128 v[96:99], v100 offset:0
    ds_read_b128 v[100:103], v100 offset:64
    v_smfmac_f32_16x16x64_bf16 v[188:191], v[48:51], v[148:155], v208
    s_waitcnt lgkmcnt(4)
    v_mfma_f32_16x16x32_bf16 v[156:159], v[108:111], v[108:111], v[156:159]
    v_fmac_f32 v209, v180, v60
    v_smfmac_f32_16x16x64_bf16 v[184:187], v[112:115], v[104:111], v250
    v_mad_u32_u16 v108, v198, s57, v205 op_sel:[1,0,0,0]
    v_mfma_f32_16x16x32_bf16 v[160:163], v[112:115], v[112:115], 0
    ds_read_b128 v[104:107], v108 offset:0
    v_mfma_f32_16x16x32_bf16 v[116:119], v[64:67], v[64:67], 0
    ds_read_b128 v[108:111], v108 offset:64
    v_mad_u32_u16 v114, v199, s57, v248 op_sel:[0,0,0,0]
    v_mfma_f32_16x16x32_bf16 v[116:119], v[68:71], v[68:71], v[116:119]
    ds_read2_b32 v[112:113], v114 offset0:0 offset1:2
    ds_read2_b32 v[114:115], v114 offset0:4 offset1:6
    v_mfma_f32_16x16x32_bf16 v[120:123], v[72:75], v[64:67], 0
    ds_read_b128 v[196:199], v206 offset:4608
    v_fmac_f32 v209, v181, v60
    v_mfma_f32_16x16x32_bf16 v[120:123], v[76:79], v[68:71], v[120:123]
    v_fmac_f32 v209, v184, v61
    v_fmac_f32 v209, v188, v192
    v_mfma_f32_16x16x32_bf16 v[124:127], v[72:75], v[72:75], 0
    v_fmac_f32 v209, v185, v61
    v_fmac_f32 v209, v189, v193
    v_mfma_f32_16x16x32_bf16 v[124:127], v[76:79], v[76:79], v[124:127]
    v_fmac_f32 v209, v190, v194
    v_fmac_f32 v209, v191, v195
    v_mfma_f32_16x16x32_bf16 v[128:131], v[80:83], v[72:75], 0
    v_fmac_f32 v200, v156, v52
    v_fmac_f32 v201, v157, v53
    v_mfma_f32_16x16x32_bf16 v[128:131], v[84:87], v[76:79], v[128:131]
    v_fmac_f32 v200, v158, v54
    v_fmac_f32 v201, v159, v55
    v_mfma_f32_16x16x32_bf16 v[132:135], v[80:83], v[64:67], 0
    v_add_f32 v201, v201, v209
    v_fmac_f32 v200, v160, v62
    v_mfma_f32_16x16x32_bf16 v[132:135], v[84:87], v[68:71], v[132:135]
    s_waitcnt lgkmcnt(7)
    v_fmac_f32 v200, v161, v63
    v_smfmac_f32_16x16x64_bf16 v[188:191], v[8:11], v[124:131], v208
    v_add_f32 v202, v200, v201
    v_mfma_f32_16x16x32_bf16 v[136:139], v[88:91], v[64:67], 0
    v_fma_f32 v200, v116, v0, -v209
    v_mul_f32 v201, v117, v1
    v_mfma_f32_16x16x32_bf16 v[136:139], v[92:95], v[68:71], v[136:139]
    v_fmac_f32 v200, v118, v2
    v_fmac_f32 v201, v119, v3
    v_mfma_f32_16x16x32_bf16 v[140:143], v[72:75], v[88:91], 0
    v_fmac_f32 v200, v120, v4
    v_fmac_f32 v201, v121, v5
    v_mfma_f32_16x16x32_bf16 v[140:143], v[76:79], v[92:95], v[140:143]
    v_fmac_f32 v200, v122, v6
    v_fmac_f32 v201, v123, v7
    v_smfmac_f32_16x16x64_bf16 v[188:191], v[12:15], v[132:139], v208
    v_permlane16_swap_b32 v210, v211
    v_mfma_f32_16x16x32_bf16 v[144:147], v[80:83], v[88:91], 0
    s_add_u32 s74, s74, s77
    s_min_i32 s74, s74, s79
    v_mfma_f32_16x16x32_bf16 v[144:147], v[84:87], v[92:95], v[144:147]
    v_fmac_f32 v200, v140, v16
    v_fmac_f32 v201, v141, v17
    v_mfma_f32_16x16x32_bf16 v[148:151], v[80:83], v[80:83], 0
    v_fmac_f32 v200, v142, v18
    v_fmac_f32 v201, v143, v19
    v_mfma_f32_16x16x32_bf16 v[148:151], v[84:87], v[84:87], v[148:151]
    v_add_f32 v212, v210, v211
    s_max_i32 s74, s74, s78
    v_mfma_f32_16x16x32_bf16 v[152:155], v[88:91], v[88:91], 0
    s_waitcnt lgkmcnt(0)
    v_fmac_f32 v200, v144, v20
    v_mfma_f32_16x16x32_bf16 v[152:155], v[92:95], v[92:95], v[152:155]
    v_fmac_f32 v201, v145, v21
    v_fmac_f32 v200, v146, v22
    v_mfma_f32_16x16x32_bf16 v[116:119], v[96:99], v[64:67], 0
    v_fmac_f32 v201, v147, v23
    v_mfma_f32_16x16x32_bf16 v[116:119], v[100:103], v[68:71], v[116:119]
    v_smfmac_f32_16x16x64_bf16 v[188:191], v[24:27], v[148:155], v208
    v_mfma_f32_16x16x32_bf16 v[120:123], v[104:107], v[64:67], 0
    v_mfma_f32_16x16x32_bf16 v[120:123], v[108:111], v[68:71], v[120:123]
    v_smfmac_f32_16x16x64_bf16 v[164:167], v[112:115], v[64:71], v250
    v_mad_u32_u16 v68, v196, s57, v205 op_sel:[0,0,0,0]
    v_mfma_f32_16x16x32_bf16 v[124:127], v[96:99], v[72:75], 0
    ds_read_b128 v[64:67], v68 offset:0
    ds_read_b128 v[68:71], v68 offset:64
    v_smfmac_f32_16x16x64_bf16 v[188:191], v[28:31], v[116:123], v208
    v_mfma_f32_16x16x32_bf16 v[124:127], v[100:103], v[76:79], v[124:127]
    v_mul_f32 v209, v164, v56
    v_mfma_f32_16x16x32_bf16 v[128:131], v[104:107], v[72:75], 0
    v_fmac_f32 v209, v165, v56
    v_mfma_f32_16x16x32_bf16 v[128:131], v[108:111], v[76:79], v[128:131]
    v_smfmac_f32_16x16x64_bf16 v[168:171], v[112:115], v[72:79], v250
    v_mad_u32_u16 v76, v196, s57, v205 op_sel:[1,0,0,0]
    v_mfma_f32_16x16x32_bf16 v[132:135], v[96:99], v[80:83], 0
    ds_read_b128 v[72:75], v76 offset:0
    ds_read_b128 v[76:79], v76 offset:64
    v_mfma_f32_16x16x32_bf16 v[132:135], v[100:103], v[84:87], v[132:135]
    v_fmac_f32 v200, v124, v32
    v_fmac_f32 v201, v125, v33
    v_mfma_f32_16x16x32_bf16 v[136:139], v[104:107], v[80:83], 0
    v_fmac_f32 v209, v168, v57
    v_fmac_f32 v200, v126, v34
    v_mfma_f32_16x16x32_bf16 v[136:139], v[108:111], v[84:87], v[136:139]
    v_fmac_f32 v209, v169, v57
    v_fmac_f32 v201, v127, v35
    v_smfmac_f32_16x16x64_bf16 v[172:175], v[112:115], v[80:87], v250
    v_mad_u32_u16 v84, v197, s57, v205 op_sel:[0,0,0,0]
    v_mfma_f32_16x16x32_bf16 v[140:143], v[96:99], v[88:91], 0
    ds_read_b128 v[80:83], v84 offset:0
    ds_read_b128 v[84:87], v84 offset:64
    v_smfmac_f32_16x16x64_bf16 v[188:191], v[40:43], v[132:139], v208
    v_fmac_f32 v200, v128, v36
    v_mfma_f32_16x16x32_bf16 v[140:143], v[100:103], v[92:95], v[140:143]
    v_fmac_f32 v209, v172, v58
    v_fmac_f32 v201, v129, v37
    v_mfma_f32_16x16x32_bf16 v[144:147], v[104:107], v[88:91], 0
    v_fmac_f32 v209, v173, v58
    v_fmac_f32 v200, v130, v38
    v_mfma_f32_16x16x32_bf16 v[144:147], v[108:111], v[92:95], v[144:147]
    v_fmac_f32 v201, v131, v39
    v_smfmac_f32_16x16x64_bf16 v[176:179], v[112:115], v[88:95], v250
    v_mad_u32_u16 v92, v197, s57, v205 op_sel:[1,0,0,0]
    v_mfma_f32_16x16x32_bf16 v[148:151], v[96:99], v[96:99], 0
    ds_read_b128 v[88:91], v92 offset:0
    ds_read_b128 v[92:95], v92 offset:64
    v_smfmac_f32_16x16x64_bf16 v[188:191], v[44:47], v[140:147], v208
    v_mfma_f32_16x16x32_bf16 v[148:151], v[100:103], v[100:103], v[148:151]
    v_fmac_f32 v209, v176, v59
    v_mfma_f32_16x16x32_bf16 v[152:155], v[104:107], v[96:99], 0
    v_fmac_f32 v209, v177, v59
    v_mfma_f32_16x16x32_bf16 v[152:155], v[108:111], v[100:103], v[152:155]
    v_smfmac_f32_16x16x64_bf16 v[180:183], v[112:115], v[96:103], v250
    v_mad_u32_u16 v100, v198, s57, v205 op_sel:[0,0,0,0]
    v_mfma_f32_16x16x32_bf16 v[156:159], v[104:107], v[104:107], 0
    ds_read_b128 v[96:99], v100 offset:0
    ds_read_b128 v[100:103], v100 offset:64
    v_smfmac_f32_16x16x64_bf16 v[188:191], v[48:51], v[148:155], v208
    s_waitcnt lgkmcnt(4)
    v_mfma_f32_16x16x32_bf16 v[156:159], v[108:111], v[108:111], v[156:159]
    v_fmac_f32 v209, v180, v60
    v_smfmac_f32_16x16x64_bf16 v[184:187], v[112:115], v[104:111], v250
    v_mad_u32_u16 v108, v198, s57, v205 op_sel:[1,0,0,0]
    v_mfma_f32_16x16x32_bf16 v[160:163], v[112:115], v[112:115], 0
    ds_read_b128 v[104:107], v108 offset:0
    v_mfma_f32_16x16x32_bf16 v[116:119], v[64:67], v[64:67], 0
    ds_read_b128 v[108:111], v108 offset:64
    v_mad_u32_u16 v114, v199, s57, v248 op_sel:[0,0,0,0]
    v_mfma_f32_16x16x32_bf16 v[116:119], v[68:71], v[68:71], v[116:119]
    ds_read2_b32 v[112:113], v114 offset0:0 offset1:2
    ds_read2_b32 v[114:115], v114 offset0:4 offset1:6
    v_mfma_f32_16x16x32_bf16 v[120:123], v[72:75], v[64:67], 0
    ds_read_b128 v[196:199], v206 offset:6912
    v_fmac_f32 v209, v181, v60
    v_mfma_f32_16x16x32_bf16 v[120:123], v[76:79], v[68:71], v[120:123]
    v_fmac_f32 v209, v184, v61
    v_fmac_f32 v209, v188, v192
    v_mfma_f32_16x16x32_bf16 v[124:127], v[72:75], v[72:75], 0
    v_fmac_f32 v209, v185, v61
    v_fmac_f32 v209, v189, v193
    v_mfma_f32_16x16x32_bf16 v[124:127], v[76:79], v[76:79], v[124:127]
    v_fmac_f32 v209, v190, v194
    v_fmac_f32 v209, v191, v195
    v_mfma_f32_16x16x32_bf16 v[128:131], v[80:83], v[72:75], 0
    v_fmac_f32 v200, v156, v52
    v_fmac_f32 v201, v157, v53
    v_mfma_f32_16x16x32_bf16 v[128:131], v[84:87], v[76:79], v[128:131]
    v_fmac_f32 v200, v158, v54
    v_fmac_f32 v201, v159, v55
    v_mfma_f32_16x16x32_bf16 v[132:135], v[80:83], v[64:67], 0
    v_add_f32 v201, v201, v209
    v_fmac_f32 v200, v160, v62
    v_mfma_f32_16x16x32_bf16 v[132:135], v[84:87], v[68:71], v[132:135]
    s_waitcnt lgkmcnt(7)
    v_fmac_f32 v200, v161, v63
    v_smfmac_f32_16x16x64_bf16 v[188:191], v[8:11], v[124:131], v208
    v_add_f32 v203, v200, v201
    v_mfma_f32_16x16x32_bf16 v[136:139], v[88:91], v[64:67], 0
    v_fma_f32 v200, v116, v0, -v209
    v_mul_f32 v201, v117, v1
    v_mfma_f32_16x16x32_bf16 v[136:139], v[92:95], v[68:71], v[136:139]
    v_fmac_f32 v200, v118, v2
    v_fmac_f32 v201, v119, v3
    v_mfma_f32_16x16x32_bf16 v[140:143], v[72:75], v[88:91], 0
    v_fmac_f32 v200, v120, v4
    v_fmac_f32 v201, v121, v5
    v_mfma_f32_16x16x32_bf16 v[140:143], v[76:79], v[92:95], v[140:143]
    v_fmac_f32 v200, v122, v6
    v_fmac_f32 v201, v123, v7
    v_smfmac_f32_16x16x64_bf16 v[188:191], v[12:15], v[132:139], v208
    v_permlane32_swap_b32 v202, v203
    v_mfma_f32_16x16x32_bf16 v[144:147], v[80:83], v[88:91], 0
    s_waitcnt vmcnt(1)
    ds_write_b16 v207, v240 offset:0
    v_mfma_f32_16x16x32_bf16 v[144:147], v[84:87], v[92:95], v[144:147]
    v_fmac_f32 v200, v140, v16
    v_fmac_f32 v201, v141, v17
    v_mfma_f32_16x16x32_bf16 v[148:151], v[80:83], v[80:83], 0
    v_fmac_f32 v200, v142, v18
    v_fmac_f32 v201, v143, v19
    v_mfma_f32_16x16x32_bf16 v[148:151], v[84:87], v[84:87], v[148:151]
    v_add_f32 v210, v202, v203
    ds_write_b16 v207, v241 offset:576
    v_mfma_f32_16x16x32_bf16 v[152:155], v[88:91], v[88:91], 0
    s_waitcnt lgkmcnt(2)
    v_fmac_f32 v200, v144, v20
    v_mfma_f32_16x16x32_bf16 v[152:155], v[92:95], v[92:95], v[152:155]
    v_fmac_f32 v201, v145, v21
    v_fmac_f32 v200, v146, v22
    v_mfma_f32_16x16x32_bf16 v[116:119], v[96:99], v[64:67], 0
    v_fmac_f32 v201, v147, v23
    ds_write_b16 v207, v242 offset:1152
    v_mfma_f32_16x16x32_bf16 v[116:119], v[100:103], v[68:71], v[116:119]
    ds_write_b16 v207, v243 offset:1728
    buffer_load_dwordx4 v[240:243], v249, s[16:19], s74 offen offset:0
    v_smfmac_f32_16x16x64_bf16 v[188:191], v[24:27], v[148:155], v208
    v_mfma_f32_16x16x32_bf16 v[120:123], v[104:107], v[64:67], 0
    v_mfma_f32_16x16x32_bf16 v[120:123], v[108:111], v[68:71], v[120:123]
    v_smfmac_f32_16x16x64_bf16 v[164:167], v[112:115], v[64:71], v250
    v_mad_u32_u16 v68, v196, s57, v205 op_sel:[0,0,0,0]
    v_mfma_f32_16x16x32_bf16 v[124:127], v[96:99], v[72:75], 0
    ds_read_b128 v[64:67], v68 offset:0
    ds_read_b128 v[68:71], v68 offset:64
    v_smfmac_f32_16x16x64_bf16 v[188:191], v[28:31], v[116:123], v208
    v_mfma_f32_16x16x32_bf16 v[124:127], v[100:103], v[76:79], v[124:127]
    v_mul_f32 v209, v164, v56
    v_mfma_f32_16x16x32_bf16 v[128:131], v[104:107], v[72:75], 0
    v_fmac_f32 v209, v165, v56
    v_mfma_f32_16x16x32_bf16 v[128:131], v[108:111], v[76:79], v[128:131]
    v_smfmac_f32_16x16x64_bf16 v[168:171], v[112:115], v[72:79], v250
    v_mad_u32_u16 v76, v196, s57, v205 op_sel:[1,0,0,0]
    v_mfma_f32_16x16x32_bf16 v[132:135], v[96:99], v[80:83], 0
    ds_read_b128 v[72:75], v76 offset:0
    ds_read_b128 v[76:79], v76 offset:64
    v_mfma_f32_16x16x32_bf16 v[132:135], v[100:103], v[84:87], v[132:135]
    v_fmac_f32 v200, v124, v32
    v_fmac_f32 v201, v125, v33
    v_mfma_f32_16x16x32_bf16 v[136:139], v[104:107], v[80:83], 0
    v_fmac_f32 v209, v168, v57
    v_fmac_f32 v200, v126, v34
    v_mfma_f32_16x16x32_bf16 v[136:139], v[108:111], v[84:87], v[136:139]
    v_fmac_f32 v209, v169, v57
    v_fmac_f32 v201, v127, v35
    v_smfmac_f32_16x16x64_bf16 v[172:175], v[112:115], v[80:87], v250
    v_mad_u32_u16 v84, v197, s57, v205 op_sel:[0,0,0,0]
    v_mfma_f32_16x16x32_bf16 v[140:143], v[96:99], v[88:91], 0
    ds_read_b128 v[80:83], v84 offset:0
    ds_read_b128 v[84:87], v84 offset:64
    v_smfmac_f32_16x16x64_bf16 v[188:191], v[40:43], v[132:139], v208
    v_fmac_f32 v200, v128, v36
    v_mfma_f32_16x16x32_bf16 v[140:143], v[100:103], v[92:95], v[140:143]
    v_fmac_f32 v209, v172, v58
    v_fmac_f32 v201, v129, v37
    v_mfma_f32_16x16x32_bf16 v[144:147], v[104:107], v[88:91], 0
    v_fmac_f32 v209, v173, v58
    v_fmac_f32 v200, v130, v38
    v_mfma_f32_16x16x32_bf16 v[144:147], v[108:111], v[92:95], v[144:147]
    v_fmac_f32 v201, v131, v39
    v_smfmac_f32_16x16x64_bf16 v[176:179], v[112:115], v[88:95], v250
    v_mad_u32_u16 v92, v197, s57, v205 op_sel:[1,0,0,0]
    v_mfma_f32_16x16x32_bf16 v[148:151], v[96:99], v[96:99], 0
    ds_read_b128 v[88:91], v92 offset:0
    ds_read_b128 v[92:95], v92 offset:64
    v_smfmac_f32_16x16x64_bf16 v[188:191], v[44:47], v[140:147], v208
    v_mfma_f32_16x16x32_bf16 v[148:151], v[100:103], v[100:103], v[148:151]
    v_fmac_f32 v209, v176, v59
    v_mfma_f32_16x16x32_bf16 v[152:155], v[104:107], v[96:99], 0
    v_fmac_f32 v209, v177, v59
    v_mfma_f32_16x16x32_bf16 v[152:155], v[108:111], v[100:103], v[152:155]
    v_smfmac_f32_16x16x64_bf16 v[180:183], v[112:115], v[96:103], v250
    v_mad_u32_u16 v100, v198, s57, v205 op_sel:[0,0,0,0]
    v_mfma_f32_16x16x32_bf16 v[156:159], v[104:107], v[104:107], 0
    ds_read_b128 v[96:99], v100 offset:0
    ds_read_b128 v[100:103], v100 offset:64
    v_smfmac_f32_16x16x64_bf16 v[188:191], v[48:51], v[148:155], v208
    s_waitcnt lgkmcnt(4)
    v_mfma_f32_16x16x32_bf16 v[156:159], v[108:111], v[108:111], v[156:159]
    v_fmac_f32 v209, v180, v60
    v_smfmac_f32_16x16x64_bf16 v[184:187], v[112:115], v[104:111], v250
    v_mad_u32_u16 v108, v198, s57, v205 op_sel:[1,0,0,0]
    v_mfma_f32_16x16x32_bf16 v[160:163], v[112:115], v[112:115], 0
    ds_read_b128 v[104:107], v108 offset:0
    v_mfma_f32_16x16x32_bf16 v[116:119], v[64:67], v[64:67], 0
    ds_read_b128 v[108:111], v108 offset:64
    v_mad_u32_u16 v114, v199, s57, v248 op_sel:[0,0,0,0]
    v_mfma_f32_16x16x32_bf16 v[116:119], v[68:71], v[68:71], v[116:119]
    ds_read2_b32 v[112:113], v114 offset0:0 offset1:2
    ds_read2_b32 v[114:115], v114 offset0:4 offset1:6
    v_mfma_f32_16x16x32_bf16 v[120:123], v[72:75], v[64:67], 0
    ds_read_b128 v[196:199], v206 offset:0
    v_fmac_f32 v209, v181, v60
    v_mfma_f32_16x16x32_bf16 v[120:123], v[76:79], v[68:71], v[120:123]
    v_fmac_f32 v209, v184, v61
    v_fmac_f32 v209, v188, v192
    v_mfma_f32_16x16x32_bf16 v[124:127], v[72:75], v[72:75], 0
    v_fmac_f32 v209, v185, v61
    v_fmac_f32 v209, v189, v193
    v_mfma_f32_16x16x32_bf16 v[124:127], v[76:79], v[76:79], v[124:127]
    v_fmac_f32 v209, v190, v194
    v_fmac_f32 v209, v191, v195
    v_mfma_f32_16x16x32_bf16 v[128:131], v[80:83], v[72:75], 0
    v_fmac_f32 v200, v156, v52
    v_fmac_f32 v201, v157, v53
    v_mfma_f32_16x16x32_bf16 v[128:131], v[84:87], v[76:79], v[128:131]
    v_fmac_f32 v200, v158, v54
    v_fmac_f32 v201, v159, v55
    v_mfma_f32_16x16x32_bf16 v[132:135], v[80:83], v[64:67], 0
    v_add_f32 v201, v201, v209
    v_fmac_f32 v200, v160, v62
    v_mfma_f32_16x16x32_bf16 v[132:135], v[84:87], v[68:71], v[132:135]
    s_waitcnt lgkmcnt(7)
    v_fmac_f32 v200, v161, v63
    v_smfmac_f32_16x16x64_bf16 v[188:191], v[8:11], v[124:131], v208
    v_add_f32 v202, v200, v201
    v_mfma_f32_16x16x32_bf16 v[136:139], v[88:91], v[64:67], 0
    v_fma_f32 v200, v116, v0, -v209
    v_mul_f32 v201, v117, v1
    v_mfma_f32_16x16x32_bf16 v[136:139], v[92:95], v[68:71], v[136:139]
    v_fmac_f32 v200, v118, v2
    v_fmac_f32 v201, v119, v3
    v_mfma_f32_16x16x32_bf16 v[140:143], v[72:75], v[88:91], 0
    v_fmac_f32 v200, v120, v4
    v_fmac_f32 v201, v121, v5
    v_mfma_f32_16x16x32_bf16 v[140:143], v[76:79], v[92:95], v[140:143]
    v_fmac_f32 v200, v122, v6
    v_fmac_f32 v201, v123, v7
    v_smfmac_f32_16x16x64_bf16 v[188:191], v[12:15], v[132:139], v208
    v_add_f32_dpp v212, v212, v212 quad_perm:[1,0,3,2] row_mask:0xf bank_mask:0xf
    v_mfma_f32_16x16x32_bf16 v[144:147], v[80:83], v[88:91], 0
    s_sub_u32 s58, s58, 1
    v_mfma_f32_16x16x32_bf16 v[144:147], v[84:87], v[92:95], v[144:147]
    v_fmac_f32 v200, v140, v16
    v_fmac_f32 v201, v141, v17
    v_mfma_f32_16x16x32_bf16 v[148:151], v[80:83], v[80:83], 0
    v_fmac_f32 v200, v142, v18
    v_fmac_f32 v201, v143, v19
    v_mfma_f32_16x16x32_bf16 v[148:151], v[84:87], v[84:87], v[148:151]
    v_add_f32_dpp v212, v212, v212 quad_perm:[2,3,0,1] row_mask:0xf bank_mask:0xf
    v_mfma_f32_16x16x32_bf16 v[152:155], v[88:91], v[88:91], 0
    s_waitcnt lgkmcnt(0)
    v_fmac_f32 v200, v144, v20
    v_mfma_f32_16x16x32_bf16 v[152:155], v[92:95], v[92:95], v[152:155]
    v_fmac_f32 v201, v145, v21
    v_fmac_f32 v200, v146, v22
    v_mfma_f32_16x16x32_bf16 v[116:119], v[96:99], v[64:67], 0
    v_fmac_f32 v201, v147, v23
    v_add_f32_dpp v212, v212, v212 row_half_mirror row_mask:0xf bank_mask:0xf
    v_mfma_f32_16x16x32_bf16 v[116:119], v[100:103], v[68:71], v[116:119]
    v_smfmac_f32_16x16x64_bf16 v[188:191], v[24:27], v[148:155], v208
    v_cndmask_b32_dpp v204, v204, v212, vcc row_shr:1 row_mask:0xf bank_mask:0xf bound_ctrl:0
    v_mfma_f32_16x16x32_bf16 v[120:123], v[104:107], v[64:67], 0
    v_mfma_f32_16x16x32_bf16 v[120:123], v[108:111], v[68:71], v[120:123]
    v_smfmac_f32_16x16x64_bf16 v[164:167], v[112:115], v[64:71], v250
    v_mad_u32_u16 v68, v196, s57, v205 op_sel:[0,0,0,0]
    v_mfma_f32_16x16x32_bf16 v[124:127], v[96:99], v[72:75], 0
    ds_read_b128 v[64:67], v68 offset:0
    ds_read_b128 v[68:71], v68 offset:64
    v_smfmac_f32_16x16x64_bf16 v[188:191], v[28:31], v[116:123], v208
    v_mfma_f32_16x16x32_bf16 v[124:127], v[100:103], v[76:79], v[124:127]
    v_mul_f32 v209, v164, v56
    v_mfma_f32_16x16x32_bf16 v[128:131], v[104:107], v[72:75], 0
    v_fmac_f32 v209, v165, v56
    v_mfma_f32_16x16x32_bf16 v[128:131], v[108:111], v[76:79], v[128:131]
    v_smfmac_f32_16x16x64_bf16 v[168:171], v[112:115], v[72:79], v250
    v_mad_u32_u16 v76, v196, s57, v205 op_sel:[1,0,0,0]
    v_mfma_f32_16x16x32_bf16 v[132:135], v[96:99], v[80:83], 0
    ds_read_b128 v[72:75], v76 offset:0
    ds_read_b128 v[76:79], v76 offset:64
    v_mfma_f32_16x16x32_bf16 v[132:135], v[100:103], v[84:87], v[132:135]
    v_fmac_f32 v200, v124, v32
    v_fmac_f32 v201, v125, v33
    v_mfma_f32_16x16x32_bf16 v[136:139], v[104:107], v[80:83], 0
    v_fmac_f32 v209, v168, v57
    v_fmac_f32 v200, v126, v34
    v_mfma_f32_16x16x32_bf16 v[136:139], v[108:111], v[84:87], v[136:139]
    v_fmac_f32 v209, v169, v57
    v_fmac_f32 v201, v127, v35
    v_smfmac_f32_16x16x64_bf16 v[172:175], v[112:115], v[80:87], v250
    v_mad_u32_u16 v84, v197, s57, v205 op_sel:[0,0,0,0]
    v_mfma_f32_16x16x32_bf16 v[140:143], v[96:99], v[88:91], 0
    ds_read_b128 v[80:83], v84 offset:0
    ds_read_b128 v[84:87], v84 offset:64
    v_smfmac_f32_16x16x64_bf16 v[188:191], v[40:43], v[132:139], v208
    v_fmac_f32 v200, v128, v36
    v_mfma_f32_16x16x32_bf16 v[140:143], v[100:103], v[92:95], v[140:143]
    v_fmac_f32 v209, v172, v58
    v_fmac_f32 v201, v129, v37
    v_mfma_f32_16x16x32_bf16 v[144:147], v[104:107], v[88:91], 0
    v_fmac_f32 v209, v173, v58
    v_fmac_f32 v200, v130, v38
    v_mfma_f32_16x16x32_bf16 v[144:147], v[108:111], v[92:95], v[144:147]
    v_fmac_f32 v201, v131, v39
    v_smfmac_f32_16x16x64_bf16 v[176:179], v[112:115], v[88:95], v250
    v_mad_u32_u16 v92, v197, s57, v205 op_sel:[1,0,0,0]
    v_mfma_f32_16x16x32_bf16 v[148:151], v[96:99], v[96:99], 0
    ds_read_b128 v[88:91], v92 offset:0
    ds_read_b128 v[92:95], v92 offset:64
    v_smfmac_f32_16x16x64_bf16 v[188:191], v[44:47], v[140:147], v208
    v_mfma_f32_16x16x32_bf16 v[148:151], v[100:103], v[100:103], v[148:151]
    v_fmac_f32 v209, v176, v59
    v_mfma_f32_16x16x32_bf16 v[152:155], v[104:107], v[96:99], 0
    v_fmac_f32 v209, v177, v59
    v_mfma_f32_16x16x32_bf16 v[152:155], v[108:111], v[100:103], v[152:155]
    v_smfmac_f32_16x16x64_bf16 v[180:183], v[112:115], v[96:103], v250
    v_mad_u32_u16 v100, v198, s57, v205 op_sel:[0,0,0,0]
    v_mfma_f32_16x16x32_bf16 v[156:159], v[104:107], v[104:107], 0
    ds_read_b128 v[96:99], v100 offset:0
    ds_read_b128 v[100:103], v100 offset:64
    v_smfmac_f32_16x16x64_bf16 v[188:191], v[48:51], v[148:155], v208
    s_waitcnt lgkmcnt(4)
    v_mfma_f32_16x16x32_bf16 v[156:159], v[108:111], v[108:111], v[156:159]
    v_fmac_f32 v209, v180, v60
    v_smfmac_f32_16x16x64_bf16 v[184:187], v[112:115], v[104:111], v250
    v_mad_u32_u16 v108, v198, s57, v205 op_sel:[1,0,0,0]
    v_mfma_f32_16x16x32_bf16 v[160:163], v[112:115], v[112:115], 0
    ds_read_b128 v[104:107], v108 offset:0
    s_cbranch_scc0 k1_kernel_loop
    s_nop 7
    v_fmac_f32 v209, v181, v60
    v_fmac_f32 v209, v184, v61
    v_fmac_f32 v209, v188, v192
    v_fmac_f32 v209, v185, v61
    v_fmac_f32 v209, v189, v193
    v_fmac_f32 v209, v190, v194
    v_fmac_f32 v209, v191, v195
    v_fmac_f32 v200, v156, v52
    v_fmac_f32 v201, v157, v53
    v_fmac_f32 v200, v158, v54
    v_fmac_f32 v201, v159, v55
    v_add_f32 v201, v201, v209
    v_fmac_f32 v200, v160, v62
    v_fmac_f32 v200, v161, v63
    v_add_f32 v203, v200, v201
    v_and_b32 v40, 7, v255
    s_mul_i32 s76, s36, 7
    v_permlane32_swap_b32 v202, v203
    v_add_f32 v211, v202, v203
    s_waitcnt lgkmcnt(0)
    v_lshrrev_b32 v41, 5, v255
    v_permlane16_swap_b32 v210, v211
    v_add_f32 v212, v210, v211
    s_xor_b32 s76, s76, 7
    v_bfe_u32 v42, v255, 4, 1
    v_add_f32_dpp v212, v212, v212 quad_perm:[1,0,3,2] row_mask:0xf bank_mask:0xf
    v_xor_b32 v40, s76, v40
    v_lshl_add_u32 v41, v42, 1, v41
    v_add_f32_dpp v212, v212, v212 quad_perm:[2,3,0,1] row_mask:0xf bank_mask:0xf
    s_lshl_b32 s74, s72, 2
    v_lshl_add_u32 v40, v40, 2, v41
    v_add_f32_dpp v212, v212, v212 row_half_mirror row_mask:0xf bank_mask:0xf
    v_cndmask_b32_dpp v204, v204, v212, vcc row_shr:1 row_mask:0xf bank_mask:0xf bound_ctrl:0
    s_lshl_b32 s76, s36, 16
    v_lshlrev_b32 v113, 2, v40
    v_add_f32_dpp v112, v204, v204 row_ror:8 row_mask:0xf bank_mask:0xf
    s_add_u32 s74, s74, s76
    s_add_u32 s74, s74, 29360128
    s_waitcnt vmcnt(0)
    v_min_u32 v112, -2, v112
    s_branch k1_kernel_k2
k1_kernel_last:
    s_endpgm
.section .rodata,"a"
.p2align 6
.amdhsa_kernel standalone__deep_cross_pnn__recsys_kernel
  .amdhsa_next_free_vgpr 256
  .amdhsa_next_free_sgpr 96
  .amdhsa_accum_offset 256
  .amdhsa_group_segment_fixed_size 0
  .amdhsa_kernarg_size 80
  .amdhsa_user_sgpr_count 2
  .amdhsa_user_sgpr_kernarg_segment_ptr 1
  .amdhsa_system_sgpr_workgroup_id_x 1
.end_amdhsa_kernel
```

```asm
; @launch grid=(256,1,1) block=(512,1,1) lds=163840
.amdgcn_target "amdgcn-amd-amdhsa--gfx950"
.text
.globl standalone__deep_cross_pnn__recsys_kernel
.p2align 8
.type standalone__deep_cross_pnn__recsys_kernel,@function
standalone__deep_cross_pnn__recsys_kernel:

    s_cmp_ge_u32 s2, 256
    s_cbranch_scc1 k1_kernel_end

    s_load_dwordx8 s[4:11], s[0:1], 0
    s_load_dwordx2 s[12:13], s[0:1], 72
    s_load_dwordx2 s[52:53], s[0:1], 64

    v_cmp_gt_u32 vcc, 18, v0
    s_and_saveexec_b64 s[48:49], vcc
    s_cbranch_execz k1_kernel_ncp
    s_getpc_b64 s[46:47]
k1_kernel_pc:
    s_bfe_u32 s38, s2, 0x40003
    s_lshl_b32 s38, s38, 7
    v_lshl_add_u32 v2, v0, 11, s38
    v_min_u32 v2, k1_kernel_last-k1_kernel_pc, v2
    global_load_dword v250, v2, s[46:47]
k1_kernel_ncp:
    s_mov_b64 exec, s[48:49]

    v_lshrrev_b32 v1, 6, v0
    v_and_b32 v255, 63, v0
    s_bfe_u32 s36, s2, 0x10003
    v_readfirstlane_b32 s3, v1
    s_lshr_b32 s37, s2, 4
    s_lshl_b32 s37, s37, 3
    s_and_b32 s38, s2, 7
    s_or_b32 s37, s37, s38
    v_lshlrev_b32 v254, 4, v255
    v_mov_b32 v252, 144144
    v_mov_b32 v253, 1
    v_mov_b32 v40, 0
    v_lshl_add_u32 v41, v0, 2, v252
    v_cmp_gt_u32 vcc, 8, v0
    s_and_saveexec_b64 s[46:47], vcc
    ds_write_b32 v41, v40
    s_mov_b64 exec, s[46:47]
    v_mul_u32_u24 v6, 57, v255
    v_lshrrev_b32 v6, 9, v6
    v_mul_u32_u24 v5, 9, v6
    v_sub_u32 v5, v255, v5
    v_cmp_gt_u32 s[40:41], 8, v5
    s_lshl_b32 s38, s36, 7
    v_lshl_add_u32 v5, v5, 4, s38
    v_lshl_add_u32 v83, v6, 8, v5
    s_and_b32 s56, s3, 3
    s_bitset0_b32 s41, 31
    s_lshr_b32 s42, s2, 3
    s_mul_i32 s42, s42, 36
    s_lshr_b32 s42, s42, 5
    s_lshl_b32 s42, s42, 2
    s_add_u32 s42, s42, s56
    s_mov_b32 s43, s42
    s_mov_b32 s50, s36
    s_lshl_b32 s72, s37, 7
    s_lshl_b32 s73, s3, 5
    s_add_u32 s72, s72, s73
    s_mul_i32 s74, s72, 400
    s_mul_i32 s45, s36, 11200
    s_add_u32 s74, s74, s45
    s_lshl_b32 s38, s3, 10
    s_add_u32 m0, s38, 144384

    s_mov_b32 s18, 6553600
    s_mov_b32 s19, 0x00020000
    s_mov_b32 s22, 256000
    s_mov_b32 s23, 0x00020000
    s_mov_b32 s26, 20000
    s_mov_b32 s27, 0x00020000
    s_mov_b32 s30, 13107200
    s_mov_b32 s31, 0x00020000
    s_mov_b32 s34, 268435456
    s_mov_b32 s35, 0x00020000
    s_mov_b32 s14, 268435456
    s_mov_b32 s15, 0x00020000
    s_mov_b32 s54, 256
    s_mov_b32 s55, 0x00020000

    v_bfe_u32 v5, v255, 2, 2
    v_mul_u32_u24 v5, 200, v5
    v_and_b32 v6, 3, v255
    v_lshl_add_u32 v5, v6, 5, v5
    v_and_b32 v6, 32, v255
    v_lshl_add_u32 v5, v6, 2, v5
    v_and_b32 v6, 16, v255
    v_add_u32 v5, v5, v6
    s_movk_i32 s39, 19200
    s_cmp_ge_u32 s3, 4
    s_waitcnt lgkmcnt(0)
    s_barrier
    s_cbranch_scc1 k1_kernel_dma

    s_mov_b32 s24, s8
    s_and_b32 s25, s9, 0xffff
    buffer_load_dwordx4 v254, s[24:27], s38 offen lds
    s_add_u32 s38, s38, 4096
    s_add_u32 m0, s38, 144384
    s_mov_b32 s16, s4
    s_and_b32 s17, s5, 0xffff
    buffer_load_dwordx4 v254, s[24:27], s38 offen lds
    s_add_u32 s38, s38, 4096
    s_add_u32 m0, s38, 144384
    v_cmp_lt_u32 vcc, 24, v255
    buffer_load_dwordx4 v254, s[24:27], s38 offen lds
    s_add_u32 s38, s38, 4096
    s_add_u32 m0, s38, 144384
    v_subbrev_co_u32 v249, vcc, 0, v255, vcc
    buffer_load_dwordx4 v254, s[24:27], s38 offen lds
    s_add_u32 s38, s38, 4096
    s_min_u32 s38, s38, 18432
    s_add_u32 m0, s38, 144384
    v_min_u32 v249, 49, v249
    v_lshlrev_b32 v249, 4, v249
    buffer_load_dwordx4 v254, s[24:27], s38 offen lds
    buffer_load_dwordx4 v[232:235], v5, s[24:27], s39 offen
    buffer_load_dwordx4 v[240:243], v249, s[16:19], s74 offen offset:0
    buffer_load_dwordx4 v[244:247], v249, s[16:19], s74 offen offset:800

    s_mul_i32 s77, s36, -3200
    s_mul_i32 s78, s72, 400
    s_addk_i32 s77, 1600
    s_add_u32 s79, s78, 11200
    s_add_u32 s74, s74, s77

    s_branch k1_kernel_main
k1_kernel_dma:
    s_mov_b32 s20, s6
    s_and_b32 s21, s7, 0xffff
    s_mov_b64 exec, s[40:41]
k1_kernel_dml:

    s_min_u32 s38, s42, 142
    s_mul_i32 m0, s38, 1008
    s_mul_i32 s39, s38, 1792
    s_add_u32 s42, s42, 4
    buffer_load_dwordx4 v83, s[20:23], s39 offen lds
    s_cmp_ge_u32 s42, 144
    s_cselect_b32 s38, 144, 0
    s_sub_u32 s42, s42, s38
    s_cmp_lg_u32 s42, s43
    s_cbranch_scc1 k1_kernel_dml
    s_mov_b64 exec, -1

    s_mov_b32 s16, s4
    s_and_b32 s17, s5, 0xffff
    s_mov_b32 s20, s6
    s_and_b32 s21, s7, 0xffff
    s_mov_b32 s28, s10
    s_and_b32 s29, s11, 0xffff
    s_mov_b32 s32, s12
    s_and_b32 s33, s13, 0xffff
    s_and_b32 s13, s13, 0xffff
    s_and_b32 s53, s53, 0xffff
k1_kernel_aux:

    s_setprio 0
    v_mov_b32 v8, v255
    v_mov_b32 v9, v254
    v_mov_b32 v10, v253
    v_mov_b32 v11, v252
    s_mov_b32 s51, s2
    s_mov_b32 s64, 0
    s_mov_b32 s65, 0

k1_kernel_unit:

    s_bfe_u32 s36, s51, 0x10003

    s_lshr_b32 s38, s51, 4
    s_and_b32 s39, s51, 7
    s_sub_u32 s57, 2, s36
    s_lshl_b32 s57, s39, s57
    s_lshl_b32 s37, s36, 5
    s_add_u32 s57, s57, s37
    s_add_u32 s57, s57, s56
    s_mul_i32 s37, s38, 48
    s_add_u32 s37, s37, s57
    s_lshl_b32 s38, s38, 1
    s_lshr_b32 s39, s39, 2
    s_add_u32 s38, s38, s39
    s_add_u32 s38, s38, 768
    s_and_b32 s57, s57, 7
    s_cmp_eq_u32 s57, 2
    s_cselect_b32 s38, s38, 1000
    s_lshl_b32 s39, s36, 1
    s_and_b32 s39, s39, s56
    s_cselect_b32 s57, s38, s37

    s_lshr_b32 s37, s51, 4
    s_lshl_b32 s37, s37, 3
    s_and_b32 s38, s51, 7
    s_or_b32 s37, s37, s38
    s_and_b32 s58, s56, 1
    s_lshl_b32 s59, s37, 1
    s_add_u32 s58, s58, s59
    s_lshr_b32 s59, s56, 1
    s_lshl_b32 s60, s36, 1
    s_add_u32 s59, s59, s60
    s_mul_i32 s60, s58, 25600
    s_mul_i32 s61, s59, 96
    s_add_u32 s60, s60, s61
    s_movk_i32 s61, 400
    v_lshrrev_b32 v1, 3, v8
    v_and_b32 v2, 7, v8
    v_mul_u32_u24 v0, s61, v1
    v_cmp_gt_u32 s[48:49], 7, v2
    v_lshl_add_u32 v0, v2, 4, v0
    v_and_b32 v5, 15, v8
    v_and_b32 v6, 48, v8
    v_lshl_add_u32 v7, v5, 8, v6
    s_lshl_b32 s44, s56, 15
    s_xor_b32 s38, s50, 1
    s_lshl_b32 s38, s38, 7
    s_add_u32 s44, s44, s38

    s_mov_b64 exec, s[48:49]
    buffer_load_dwordx4 v[224:227], v0, s[16:19], s60 offen
    s_add_u32 s60, s60, 3200
    buffer_load_dwordx4 v[228:231], v0, s[16:19], s60 offen
    s_add_u32 s60, s60, 3200
    buffer_load_dwordx4 v[232:235], v0, s[16:19], s60 offen
    s_add_u32 s60, s60, 3200
    buffer_load_dwordx4 v[236:239], v0, s[16:19], s60 offen
    s_add_u32 s60, s60, 3200
    buffer_load_dwordx4 v[240:243], v0, s[16:19], s60 offen
    s_add_u32 s60, s60, 3200
    buffer_load_dwordx4 v[244:247], v0, s[16:19], s60 offen
    s_add_u32 s60, s60, 3200
    buffer_load_dwordx4 v[248:251], v0, s[16:19], s60 offen
    s_add_u32 s60, s60, 3200
    buffer_load_dwordx4 v[252:255], v0, s[16:19], s60 offen
    s_add_u32 s60, s60, 3200
    s_mov_b64 exec, -1

    s_lshr_b32 s78, s57, 5
    s_bfe_u32 s79, s57, 0x20003
    s_bfe_u32 s80, s57, 0x20001
    s_and_b32 s81, s57, 1
    s_lshl_b32 s77, s78, 2
    s_lshl_b32 s83, s81, 1
    s_add_u32 s77, s77, s83
    s_lshl_b32 s77, s77, 7
    s_lshl_b32 s83, s79, 5
    s_add_u32 s77, s77, s83
    s_lshl_b32 s83, s80, 3
    s_add_u32 s77, s77, s83
    s_lshl_b32 s77, s77, 10
    s_lshl_b32 s82, s78, 12
    s_lshl_b32 s83, s79, 10
    s_add_u32 s82, s82, s83
    s_lshl_b32 s83, s80, 8
    s_add_u32 s82, s82, s83
    s_lshl_b32 s83, s81, 7
    s_add_u32 s82, s82, s83
    s_mov_b32 s84, 205312
    v_lshrrev_b32 v3, 2, v8
    v_and_b32 v4, 3, v8
    v_mul_lo_u32 v14, v3, s84
    v_lshl_add_u32 v14, v4, 4, v14
    s_lshl_b32 s61, s56, 12
    s_add_u32 s61, s61, 147456
    v_and_b32 v3, 3, v3
    v_lshlrev_b32 v36, 6, v8
    v_lshl_add_u32 v36, v3, 4, v36
    v_add_u32 v36, s61, v36
    v_xor_b32 v37, 16, v36
    v_xor_b32 v38, 32, v36
    v_xor_b32 v39, 48, v36
    v_and_b32 v3, 48, v8
    v_xor_b32 v15, v3, v9
    v_add_u32 v15, s61, v15
    s_mov_b32 s84, 0x05040100
    s_mov_b32 s85, 0x07060302
    s_cmp_eq_u32 s64, 0
    s_cbranch_scc1 k1_kernel_nsig0
    s_waitcnt vmcnt(0)

k1_kernel_nsig0:

    s_waitcnt vmcnt(8)
    s_cmp_lg_u32 s64, 0
    s_cbranch_scc1 k1_kernel_nsig

    s_mov_b64 exec, 1
    ds_add_u32 v11, v10 offset:16
    s_mov_b64 exec, -1

k1_kernel_nsig:
    s_setprio 3

    s_lshl_b32 s61, s56, 12
    s_add_u32 s61, s61, 147456
    v_lshlrev_b32 v86, 2, v8
    v_add_u32 v86, s61, v86
    v_and_b32 v85, 0xffffff80, v86
    v_and_b32 v123, 32, v8
    s_add_u32 s61, s61, 256
    v_mul_u32_u24 v31, 56, v8
    v_add_u32 v31, s61, v31
    v_mul_u32_u24 v34, 56, v1
    v_lshl_add_u32 v34, v2, 3, v34
    v_add_u32 v34, s61, v34
    v_add_u32 v2, s59, v2
    v_subrev_u32 v3, 5, v2
    v_min_u32 v2, v2, v3
    v_mov_b32 v13, 0
    v_mul_u32_u24 v2, 0x10001, v2
    v_lshlrev_b32 v2, 12, v2
    v_add_u32 v32, 67108864, v2
    v_add_u32 v33, 201328640, v2
    v_mov_b32 v71, 0xf00
    s_lshr_b32 s62, s58, 7
    s_mul_i32 s62, s62, 25
    s_mul_i32 s63, s59, 6
    s_add_u32 s62, s62, s63
    s_lshl_b32 s62, s62, 3
    s_bfe_u32 s63, s58, 0x30004
    s_add_u32 s62, s62, s63
    s_lshl_b32 s62, s62, 13
    s_bfe_u32 s63, s58, 0x30001
    s_lshl_b32 s63, s63, 10
    s_add_u32 s62, s62, s63
    s_and_b32 s63, s58, 1
    s_lshl_b32 s63, s63, 9
    s_add_u32 s62, s62, s63
    s_add_u32 s62, s62, 16777216
    v_and_b32 v30, 31, v8
    v_lshrrev_b32 v3, 5, v8
    v_lshlrev_b32 v30, 4, v30
    v_lshl_add_u32 v30, v3, 3, v30
    s_cmp_eq_u32 s59, 3
    s_cselect_b32 s63, 0xf00, 0
    s_movk_i32 s66, 0x7c
    s_mov_b32 s67, 0x001f001f
    s_mov_b32 s75, 0x06040200
    v_mov_b32 v54, 0x08040201
    v_mov_b32 v55, 0x80402010

    s_lshl_b32 s72, s2, 15
    s_lshl_b32 s73, s56, 13
    s_add_u32 s72, s72, s73
    s_add_u32 s72, s72, 20971520
    s_lshl_b32 s73, s36, 9
    s_lshl2_add_u32 s73, s37, s73
    s_add_u32 s73, s73, s56
    s_lshl_b32 s73, s73, 7
    s_add_u32 s73, s73, 29360128

k1_kernel_wf3:

    ds_read_b32 v12, v11 offset:12
    s_waitcnt lgkmcnt(0)
    v_readfirstlane_b32 s45, v12
    s_cmp_lt_u32 s45, 4
    s_cbranch_scc1 k1_kernel_wf3

    s_mov_b64 exec, s[48:49]

    s_waitcnt vmcnt(7)
    v_lshl_or_b32 v224, v225, 16, v224
    v_lshl_or_b32 v225, v227, 16, v226
    v_add_u32 v224, v32, v224
    v_add_u32 v225, v33, v225
    ds_write_b64 v34, v[224:225] offset:0

    s_waitcnt vmcnt(6)
    v_lshl_or_b32 v228, v229, 16, v228
    v_lshl_or_b32 v229, v231, 16, v230
    v_add_u32 v228, v32, v228
    v_add_u32 v229, v33, v229
    ds_write_b64 v34, v[228:229] offset:448

    s_waitcnt vmcnt(5)
    v_lshl_or_b32 v232, v233, 16, v232
    v_lshl_or_b32 v233, v235, 16, v234
    v_add_u32 v232, v32, v232
    v_add_u32 v233, v33, v233
    ds_write_b64 v34, v[232:233] offset:896

    s_waitcnt vmcnt(4)
    v_lshl_or_b32 v236, v237, 16, v236
    v_lshl_or_b32 v237, v239, 16, v238
    v_add_u32 v236, v32, v236
    v_add_u32 v237, v33, v237
    ds_write_b64 v34, v[236:237] offset:1344

    s_waitcnt vmcnt(3)
    v_lshl_or_b32 v240, v241, 16, v240
    v_lshl_or_b32 v241, v243, 16, v242
    v_add_u32 v240, v32, v240
    v_add_u32 v241, v33, v241
    ds_write_b64 v34, v[240:241] offset:1792

    s_waitcnt vmcnt(2)
    v_lshl_or_b32 v244, v245, 16, v244
    v_lshl_or_b32 v245, v247, 16, v246
    v_add_u32 v244, v32, v244
    v_add_u32 v245, v33, v245
    ds_write_b64 v34, v[244:245] offset:2240

    s_waitcnt vmcnt(1)
    v_lshl_or_b32 v248, v249, 16, v248
    v_lshl_or_b32 v249, v251, 16, v250
    v_add_u32 v248, v32, v248
    v_add_u32 v249, v33, v249
    ds_write_b64 v34, v[248:249] offset:2688

    s_waitcnt vmcnt(0)
    v_lshl_or_b32 v252, v253, 16, v252
    v_lshl_or_b32 v253, v255, 16, v254
    v_add_u32 v252, v32, v252
    v_add_u32 v253, v33, v253
    ds_write_b64 v34, v[252:253] offset:3136

    s_mov_b64 exec, -1
    ds_read_b64 v[40:41], v31 offset:0
    ds_read_b64 v[42:43], v31 offset:8
    ds_read_b64 v[44:45], v31 offset:16
    ds_read_b64 v[46:47], v31 offset:24
    ds_read_b64 v[48:49], v31 offset:32
    ds_read_b64 v[50:51], v31 offset:40
    ds_read_b64 v[52:53], v31 offset:48

    s_waitcnt lgkmcnt(6)
    v_and_b32 v72, s67, v40
    v_and_b32 v73, s67, v41
    v_lshl_or_b32 v72, v73, 10, v72
    v_lshlrev_b32_sdwa v73, 5, v72 dst_sel:DWORD dst_unused:UNUSED_PAD src0_sel:DWORD src1_sel:WORD_1
    v_or_b32_sdwa v64, v73, v72 dst_sel:DWORD dst_unused:UNUSED_PAD src0_sel:DWORD src1_sel:WORD_0
    v_perm_b32 v72, v41, v40, s75
    v_lshrrev_b32 v73, 3, v72
    v_and_b32 v72, 0x07070707, v72
    v_and_b32 v0, 0x03030303, v73
    v_perm_b32 v16, v55, v54, v72
    v_add_u32 v23, v54, v16

    s_waitcnt lgkmcnt(5)
    v_and_b32 v72, s67, v42
    v_and_b32 v73, s67, v43
    v_lshl_or_b32 v72, v73, 10, v72
    v_lshlrev_b32_sdwa v73, 5, v72 dst_sel:DWORD dst_unused:UNUSED_PAD src0_sel:DWORD src1_sel:WORD_1
    v_or_b32_sdwa v65, v73, v72 dst_sel:DWORD dst_unused:UNUSED_PAD src0_sel:DWORD src1_sel:WORD_0
    v_perm_b32 v72, v43, v42, s75
    v_lshrrev_b32 v73, 3, v72
    v_and_b32 v72, 0x07070707, v72
    v_and_b32 v1, 0x03030303, v73
    v_perm_b32 v17, v55, v54, v72
    v_add_u32 v24, v54, v17

    s_waitcnt lgkmcnt(4)
    v_and_b32 v72, s67, v44
    v_and_b32 v73, s67, v45
    v_lshl_or_b32 v72, v73, 10, v72
    v_lshlrev_b32_sdwa v73, 5, v72 dst_sel:DWORD dst_unused:UNUSED_PAD src0_sel:DWORD src1_sel:WORD_1
    v_or_b32_sdwa v66, v73, v72 dst_sel:DWORD dst_unused:UNUSED_PAD src0_sel:DWORD src1_sel:WORD_0
    v_perm_b32 v72, v45, v44, s75
    v_lshrrev_b32 v73, 3, v72
    v_and_b32 v72, 0x07070707, v72
    v_and_b32 v2, 0x03030303, v73
    v_perm_b32 v18, v55, v54, v72
    v_add_u32 v25, v54, v18

    s_waitcnt lgkmcnt(3)
    v_and_b32 v72, s67, v46
    v_and_b32 v73, s67, v47
    v_lshl_or_b32 v72, v73, 10, v72
    v_lshlrev_b32_sdwa v73, 5, v72 dst_sel:DWORD dst_unused:UNUSED_PAD src0_sel:DWORD src1_sel:WORD_1
    v_or_b32_sdwa v67, v73, v72 dst_sel:DWORD dst_unused:UNUSED_PAD src0_sel:DWORD src1_sel:WORD_0
    v_perm_b32 v72, v47, v46, s75
    v_lshrrev_b32 v73, 3, v72
    v_and_b32 v72, 0x07070707, v72
    v_and_b32 v3, 0x03030303, v73
    v_perm_b32 v19, v55, v54, v72
    v_add_u32 v26, v54, v19

    s_waitcnt lgkmcnt(2)
    v_and_b32 v72, s67, v48
    v_and_b32 v73, s67, v49
    v_lshl_or_b32 v72, v73, 10, v72
    v_lshlrev_b32_sdwa v73, 5, v72 dst_sel:DWORD dst_unused:UNUSED_PAD src0_sel:DWORD src1_sel:WORD_1
    v_or_b32_sdwa v68, v73, v72 dst_sel:DWORD dst_unused:UNUSED_PAD src0_sel:DWORD src1_sel:WORD_0
    v_perm_b32 v72, v49, v48, s75
    v_lshrrev_b32 v73, 3, v72
    v_and_b32 v72, 0x07070707, v72
    v_and_b32 v4, 0x03030303, v73
    v_perm_b32 v20, v55, v54, v72
    v_add_u32 v27, v54, v20

    s_waitcnt lgkmcnt(1)
    v_and_b32 v72, s67, v50
    v_and_b32 v73, s67, v51
    v_lshl_or_b32 v72, v73, 10, v72
    v_lshlrev_b32_sdwa v73, 5, v72 dst_sel:DWORD dst_unused:UNUSED_PAD src0_sel:DWORD src1_sel:WORD_1
    v_or_b32_sdwa v69, v73, v72 dst_sel:DWORD dst_unused:UNUSED_PAD src0_sel:DWORD src1_sel:WORD_0
    v_perm_b32 v72, v51, v50, s75
    v_lshrrev_b32 v73, 3, v72
    v_and_b32 v72, 0x07070707, v72
    v_and_b32 v5, 0x03030303, v73
    v_perm_b32 v21, v55, v54, v72
    v_add_u32 v28, v54, v21

    s_waitcnt lgkmcnt(0)
    v_and_b32 v72, s67, v52
    v_and_b32 v73, s67, v53
    v_lshl_or_b32 v72, v73, 10, v72
    v_lshlrev_b32_sdwa v73, 5, v72 dst_sel:DWORD dst_unused:UNUSED_PAD src0_sel:DWORD src1_sel:WORD_1
    v_or_b32_sdwa v70, v73, v72 dst_sel:DWORD dst_unused:UNUSED_PAD src0_sel:DWORD src1_sel:WORD_0
    v_perm_b32 v72, v53, v52, s75
    v_lshrrev_b32 v73, 3, v72
    v_and_b32 v72, 0x07070707, v72
    v_and_b32 v6, 0x03030303, v73
    v_perm_b32 v22, v55, v54, v72
    v_add_u32 v29, v54, v22

    ds_write_b32 v86, v13
    v_lshrrev_b32 v71, 4, v71
    v_or_b32 v71, 0xf00, v71
    v_lshlrev_b32 v74, 22, v64
    v_lshrrev_b32 v75, 10, v64
    v_lshl_or_b32 v75, v65, 10, v75
    s_setprio 0

    v_ffbl_b32 v84, v71
    v_mul_u32_u24 v72, 5, v84
    v_lshrrev_b64 v[72:73], v72, v[74:75]
    v_and_or_b32 v72, v72, s66, v85
    ds_add_rtn_u32 v87, v72, v10
    ds_wrxchg_rtn_b32 v116, v86, v13
    v_and_b32 v117, 15, v71
    v_bcnt_u32_b32 v118, v117, 0
    v_cmp_eq_u32 vcc, 4, v118

    s_nop 1

    v_cndmask_b32 v119, v71, v117, vcc
    s_waitcnt lgkmcnt(0)
    v_cmp_gt_u32 s[68:69], 2, v116
    v_cmp_gt_u32 s[70:71], 2, v87

    s_nop 0
    v_lshrrev_b64 v[76:77], v123, s[68:69]
    v_perm_b32 v121, v76, v76, v1
    v_perm_b32 v122, v76, v76, v0
    v_and_b32 v121, v121, v17
    v_and_b32 v122, v122, v16
    v_msad_u8 v120, v24, v121, 0
    v_lshlrev_b32 v120, 4, v120
    v_msad_u8 v120, v23, v122, v120
    v_lshlrev_b32 v120, 4, v120

    v_and_b32 v120, v120, v119
    v_cmp_eq_u32 vcc, 0, v120
    v_ffbl_b32 v118, v120
    s_or_b64 vcc, vcc, s[70:71]
    v_cndmask_b32 v118, v118, v84, vcc
    v_lshlrev_b32 v72, v118, v10
    v_lshl_add_u32 v73, v118, 1, v31
    v_xor_b32 v71, v71, v72

    v_subrev_u32 v73, 8, v73
    ds_read_u16 v80, v73 offset:0

    v_ffbl_b32 v84, v71
    v_mul_u32_u24 v72, 5, v84
    v_lshrrev_b64 v[72:73], v72, v[74:75]
    v_and_or_b32 v72, v72, s66, v85
    ds_add_rtn_u32 v87, v72, v10
    ds_wrxchg_rtn_b32 v116, v86, v13
    v_and_b32 v117, 15, v71
    v_bcnt_u32_b32 v118, v117, 0
    v_cmp_eq_u32 vcc, 3, v118

    s_lshl_b32 s45, s2, 8
    s_add_u32 s45, s45, 14680064
    s_mov_b64 exec, 3
    buffer_store_dword v13, v9, s[12:15], s45 offen sc1
    s_mov_b64 exec, -1
    buffer_load_dwordx4 v[128:131], v9, s[28:31], s77 offen offset:0

    v_cndmask_b32 v119, v71, v117, vcc
    s_waitcnt lgkmcnt(0)
    v_cmp_gt_u32 s[68:69], 2, v116
    v_cmp_gt_u32 s[70:71], 2, v87

    s_nop 0
    v_lshrrev_b64 v[76:77], v123, s[68:69]
    v_perm_b32 v121, v76, v76, v1
    v_perm_b32 v122, v76, v76, v0
    v_and_b32 v121, v121, v17
    v_and_b32 v122, v122, v16
    v_msad_u8 v120, v24, v121, 0
    v_lshlrev_b32 v120, 4, v120
    v_msad_u8 v120, v23, v122, v120
    v_lshlrev_b32 v120, 4, v120

    v_and_b32 v120, v120, v119
    v_cmp_eq_u32 vcc, 0, v120
    v_ffbl_b32 v118, v120
    s_or_b64 vcc, vcc, s[70:71]
    v_cndmask_b32 v118, v118, v84, vcc
    v_lshlrev_b32 v72, v118, v10
    v_lshl_add_u32 v73, v118, 1, v31
    v_xor_b32 v71, v71, v72

    v_subrev_u32 v73, 8, v73
    ds_read_u16 v81, v73 offset:0

    v_ffbl_b32 v84, v71
    v_mul_u32_u24 v72, 5, v84
    v_lshrrev_b64 v[72:73], v72, v[74:75]
    v_and_or_b32 v72, v72, s66, v85
    ds_add_rtn_u32 v87, v72, v10
    ds_wrxchg_rtn_b32 v116, v86, v13
    v_and_b32 v117, 15, v71
    v_bcnt_u32_b32 v118, v117, 0
    v_cmp_eq_u32 vcc, 2, v118

    buffer_load_dwordx4 v[132:135], v9, s[28:31], s77 offen offset:1024

    v_cndmask_b32 v119, v71, v117, vcc
    s_waitcnt lgkmcnt(0)
    v_cmp_gt_u32 s[68:69], 2, v116
    v_cmp_gt_u32 s[70:71], 2, v87

    s_nop 0
    v_lshrrev_b64 v[76:77], v123, s[68:69]
    v_perm_b32 v121, v76, v76, v1
    v_perm_b32 v122, v76, v76, v0
    v_and_b32 v121, v121, v17
    v_and_b32 v122, v122, v16
    v_msad_u8 v120, v24, v121, 0
    v_lshlrev_b32 v120, 4, v120
    v_msad_u8 v120, v23, v122, v120
    v_lshlrev_b32 v120, 4, v120

    v_and_b32 v120, v120, v119
    v_cmp_eq_u32 vcc, 0, v120
    v_ffbl_b32 v118, v120
    s_or_b64 vcc, vcc, s[70:71]
    v_cndmask_b32 v118, v118, v84, vcc
    v_lshlrev_b32 v72, v118, v10
    v_lshl_add_u32 v73, v118, 1, v31
    v_xor_b32 v71, v71, v72

    v_subrev_u32 v73, 8, v73
    ds_read_u16 v82, v73 offset:0

    v_ffbl_b32 v84, v71
    v_mul_u32_u24 v72, 5, v84
    v_lshrrev_b64 v[72:73], v72, v[74:75]
    v_and_or_b32 v72, v72, s66, v85
    ds_add_rtn_u32 v87, v72, v10
    ds_wrxchg_rtn_b32 v116, v86, v13
    v_and_b32 v117, 15, v71
    v_bcnt_u32_b32 v118, v117, 0
    v_cmp_eq_u32 vcc, 1, v118

    buffer_load_dwordx4 v[144:147], v9, s[28:31], s77 offen offset:2048
    s_add_u32 s47, s44, 12288
    buffer_load_dwordx4 v[56:59], v7, s[20:23], s47 offen offset:0
    buffer_load_dwordx4 v[60:63], v7, s[20:23], s47 offen offset:64

    v_cndmask_b32 v119, v71, v117, vcc
    s_waitcnt lgkmcnt(0)
    v_cmp_gt_u32 s[68:69], 2, v116
    v_cmp_gt_u32 s[70:71], 2, v87

    s_nop 0
    v_lshrrev_b64 v[76:77], v123, s[68:69]
    v_perm_b32 v121, v76, v76, v1
    v_perm_b32 v122, v76, v76, v0
    v_and_b32 v121, v121, v17
    v_and_b32 v122, v122, v16
    v_msad_u8 v120, v24, v121, 0
    v_lshlrev_b32 v120, 4, v120
    v_msad_u8 v120, v23, v122, v120
    v_lshlrev_b32 v120, 4, v120

    v_and_b32 v120, v120, v119
    v_cmp_eq_u32 vcc, 0, v120
    v_ffbl_b32 v118, v120
    s_or_b64 vcc, vcc, s[70:71]
    v_cndmask_b32 v118, v118, v84, vcc
    v_lshlrev_b32 v72, v118, v10
    v_lshl_add_u32 v73, v118, 1, v31
    v_xor_b32 v71, v71, v72

    v_subrev_u32 v73, 8, v73
    ds_read_u16 v83, v73 offset:0
    v_lshrrev_b32 v71, 4, v71
    v_or_b32 v71, 0xf00, v71
    v_lshlrev_b32 v74, 22, v65
    v_lshl_or_b32 v74, v64, 2, v74
    v_lshrrev_b32 v75, 10, v65
    v_lshl_or_b32 v75, v66, 10, v75

    v_ffbl_b32 v84, v71
    v_mul_u32_u24 v72, 5, v84
    v_lshrrev_b64 v[72:73], v72, v[74:75]
    v_and_or_b32 v72, v72, s66, v85
    ds_add_rtn_u32 v87, v72, v10
    ds_wrxchg_rtn_b32 v116, v86, v13
    v_and_b32 v117, 15, v71
    v_bcnt_u32_b32 v118, v117, 0
    v_cmp_eq_u32 vcc, 4, v118

    buffer_load_dwordx4 v[148:151], v9, s[28:31], s77 offen offset:3072
    s_add_u32 s77, s77, 4096
    s_add_u32 s47, s44, 16384
    buffer_load_dwordx4 v[88:91], v7, s[20:23], s47 offen offset:0
    buffer_load_dwordx4 v[92:95], v7, s[20:23], s47 offen offset:64

    v_cndmask_b32 v119, v71, v117, vcc
    s_waitcnt lgkmcnt(0)
    v_cmp_gt_u32 s[68:69], 2, v116
    v_cmp_gt_u32 s[70:71], 2, v87

    v_lshl_or_b32 v78, v81, 16, v80
    v_lshl_or_b32 v79, v83, 16, v82
    buffer_store_dwordx2 v[78:79], v30, s[32:35], s62 offen sc1
    s_add_u32 s62, s62, 65536
    v_lshrrev_b64 v[76:77], v123, s[68:69]
    v_perm_b32 v121, v76, v76, v2
    v_perm_b32 v122, v76, v76, v1
    v_perm_b32 v77, v76, v76, v0
    v_and_b32 v121, v121, v18
    v_and_b32 v122, v122, v17
    v_and_b32 v77, v77, v16
    v_msad_u8 v120, v25, v121, 0
    v_lshlrev_b32 v120, 4, v120
    v_msad_u8 v120, v24, v122, v120
    v_lshlrev_b32 v120, 4, v120
    v_msad_u8 v120, v23, v77, v120

    v_and_b32 v120, v120, v119
    v_cmp_eq_u32 vcc, 0, v120
    v_ffbl_b32 v118, v120
    s_or_b64 vcc, vcc, s[70:71]
    v_cndmask_b32 v118, v118, v84, vcc
    v_lshlrev_b32 v72, v118, v10
    v_lshl_add_u32 v73, v118, 1, v31
    v_xor_b32 v71, v71, v72

    ds_read_u16 v80, v73 offset:0

    v_ffbl_b32 v84, v71
    v_mul_u32_u24 v72, 5, v84
    v_lshrrev_b64 v[72:73], v72, v[74:75]
    v_and_or_b32 v72, v72, s66, v85
    ds_add_rtn_u32 v87, v72, v10
    ds_wrxchg_rtn_b32 v116, v86, v13
    v_and_b32 v117, 15, v71
    v_bcnt_u32_b32 v118, v117, 0
    v_cmp_eq_u32 vcc, 3, v118

    buffer_load_dwordx4 v[160:163], v9, s[28:31], s77 offen offset:0
    s_add_u32 s47, s44, 20480
    buffer_load_dwordx4 v[96:99], v7, s[20:23], s47 offen offset:0
    buffer_load_dwordx4 v[100:103], v7, s[20:23], s47 offen offset:64

    v_cndmask_b32 v119, v71, v117, vcc
    s_waitcnt lgkmcnt(0)
    v_cmp_gt_u32 s[68:69], 2, v116
    v_cmp_gt_u32 s[70:71], 2, v87

    s_nop 0
    v_lshrrev_b64 v[76:77], v123, s[68:69]
    v_perm_b32 v121, v76, v76, v2
    v_perm_b32 v122, v76, v76, v1
    v_perm_b32 v77, v76, v76, v0
    v_and_b32 v121, v121, v18
    v_and_b32 v122, v122, v17
    v_and_b32 v77, v77, v16
    v_msad_u8 v120, v25, v121, 0
    v_lshlrev_b32 v120, 4, v120
    v_msad_u8 v120, v24, v122, v120
    v_lshlrev_b32 v120, 4, v120
    v_msad_u8 v120, v23, v77, v120

    v_and_b32 v120, v120, v119
    v_cmp_eq_u32 vcc, 0, v120
    v_ffbl_b32 v118, v120
    s_or_b64 vcc, vcc, s[70:71]
    v_cndmask_b32 v118, v118, v84, vcc
    v_lshlrev_b32 v72, v118, v10
    v_lshl_add_u32 v73, v118, 1, v31
    v_xor_b32 v71, v71, v72

    ds_read_u16 v81, v73 offset:0

    v_ffbl_b32 v84, v71
    v_mul_u32_u24 v72, 5, v84
    v_lshrrev_b64 v[72:73], v72, v[74:75]
    v_and_or_b32 v72, v72, s66, v85
    ds_add_rtn_u32 v87, v72, v10
    ds_wrxchg_rtn_b32 v116, v86, v13
    v_and_b32 v117, 15, v71
    v_bcnt_u32_b32 v118, v117, 0
    v_cmp_eq_u32 vcc, 2, v118

    buffer_load_dwordx4 v[164:167], v9, s[28:31], s77 offen offset:1024
    s_add_u32 s47, s44, 24576
    buffer_load_dwordx4 v[104:107], v7, s[20:23], s47 offen offset:0
    buffer_load_dwordx4 v[108:111], v7, s[20:23], s47 offen offset:64

    v_cndmask_b32 v119, v71, v117, vcc
    s_waitcnt lgkmcnt(0)
    v_cmp_gt_u32 s[68:69], 2, v116
    v_cmp_gt_u32 s[70:71], 2, v87

    s_nop 0
    v_lshrrev_b64 v[76:77], v123, s[68:69]
    v_perm_b32 v121, v76, v76, v2
    v_perm_b32 v122, v76, v76, v1
    v_perm_b32 v77, v76, v76, v0
    v_and_b32 v121, v121, v18
    v_and_b32 v122, v122, v17
    v_and_b32 v77, v77, v16
    v_msad_u8 v120, v25, v121, 0
    v_lshlrev_b32 v120, 4, v120
    v_msad_u8 v120, v24, v122, v120
    v_lshlrev_b32 v120, 4, v120
    v_msad_u8 v120, v23, v77, v120

    v_and_b32 v120, v120, v119
    v_cmp_eq_u32 vcc, 0, v120
    v_ffbl_b32 v118, v120
    s_or_b64 vcc, vcc, s[70:71]
    v_cndmask_b32 v118, v118, v84, vcc
    v_lshlrev_b32 v72, v118, v10
    v_lshl_add_u32 v73, v118, 1, v31
    v_xor_b32 v71, v71, v72

    ds_read_u16 v82, v73 offset:0

    v_ffbl_b32 v84, v71
    v_mul_u32_u24 v72, 5, v84
    v_lshrrev_b64 v[72:73], v72, v[74:75]
    v_and_or_b32 v72, v72, s66, v85
    ds_add_rtn_u32 v87, v72, v10
    ds_wrxchg_rtn_b32 v116, v86, v13
    v_and_b32 v117, 15, v71
    v_bcnt_u32_b32 v118, v117, 0
    v_cmp_eq_u32 vcc, 1, v118

    buffer_load_dwordx4 v[176:179], v9, s[28:31], s77 offen offset:2048
    s_add_u32 s47, s44, 28672
    buffer_load_dwordx4 v[112:115], v7, s[20:23], s47 offen offset:0
    buffer_load_dwordx4 v[124:127], v7, s[20:23], s47 offen offset:64

    v_cndmask_b32 v119, v71, v117, vcc
    s_waitcnt lgkmcnt(0)
    v_cmp_gt_u32 s[68:69], 2, v116
    v_cmp_gt_u32 s[70:71], 2, v87

    s_nop 0
    v_lshrrev_b64 v[76:77], v123, s[68:69]
    v_perm_b32 v121, v76, v76, v2
    v_perm_b32 v122, v76, v76, v1
    v_perm_b32 v77, v76, v76, v0
    v_and_b32 v121, v121, v18
    v_and_b32 v122, v122, v17
    v_and_b32 v77, v77, v16
    v_msad_u8 v120, v25, v121, 0
    v_lshlrev_b32 v120, 4, v120
    v_msad_u8 v120, v24, v122, v120
    v_lshlrev_b32 v120, 4, v120
    v_msad_u8 v120, v23, v77, v120

    v_and_b32 v120, v120, v119
    v_cmp_eq_u32 vcc, 0, v120
    v_ffbl_b32 v118, v120
    s_or_b64 vcc, vcc, s[70:71]
    v_cndmask_b32 v118, v118, v84, vcc
    v_lshlrev_b32 v72, v118, v10
    v_lshl_add_u32 v73, v118, 1, v31
    v_xor_b32 v71, v71, v72

    ds_read_u16 v83, v73 offset:0
    v_lshrrev_b32 v71, 4, v71
    v_or_b32 v71, 0xf00, v71
    v_lshlrev_b32 v74, 22, v66
    v_lshl_or_b32 v74, v65, 2, v74
    v_lshrrev_b32 v75, 10, v66
    v_lshl_or_b32 v75, v67, 10, v75

    v_ffbl_b32 v84, v71
    v_mul_u32_u24 v72, 5, v84
    v_lshrrev_b64 v[72:73], v72, v[74:75]
    v_and_or_b32 v72, v72, s66, v85
    ds_add_rtn_u32 v87, v72, v10
    ds_wrxchg_rtn_b32 v116, v86, v13
    v_and_b32 v117, 15, v71
    v_bcnt_u32_b32 v118, v117, 0
    v_cmp_eq_u32 vcc, 4, v118

    buffer_load_dwordx4 v[180:183], v9, s[28:31], s77 offen offset:3072
    s_add_u32 s77, s77, 126976
    s_cmp_lg_u32 s64, 0
    s_cbranch_scc1 k1_kernel_nc8
    v_mov_b32 v121, -1
    v_lshlrev_b32 v122, 1, v8
    buffer_store_short v121, v122, s[12:15], s73 offen sc1
k1_kernel_nc8:
    s_add_u32 s47, s44, 131072
    buffer_load_dwordx4 v[136:139], v7, s[20:23], s47 offen offset:0
    buffer_load_dwordx4 v[140:143], v7, s[20:23], s47 offen offset:64

    v_cndmask_b32 v119, v71, v117, vcc
    s_waitcnt lgkmcnt(0)
    v_cmp_gt_u32 s[68:69], 2, v116
    v_cmp_gt_u32 s[70:71], 2, v87

    v_lshl_or_b32 v78, v81, 16, v80
    v_lshl_or_b32 v79, v83, 16, v82
    buffer_store_dwordx2 v[78:79], v30, s[32:35], s62 offen sc1
    s_add_u32 s62, s62, 65536
    v_lshrrev_b64 v[76:77], v123, s[68:69]
    v_perm_b32 v121, v76, v76, v3
    v_perm_b32 v122, v76, v76, v2
    v_perm_b32 v77, v76, v76, v1
    v_and_b32 v121, v121, v19
    v_and_b32 v122, v122, v18
    v_and_b32 v77, v77, v17
    v_msad_u8 v120, v26, v121, 0
    v_lshlrev_b32 v120, 4, v120
    v_msad_u8 v120, v25, v122, v120
    v_lshlrev_b32 v120, 4, v120
    v_msad_u8 v120, v24, v77, v120

    v_and_b32 v120, v120, v119
    v_cmp_eq_u32 vcc, 0, v120
    v_ffbl_b32 v118, v120
    s_or_b64 vcc, vcc, s[70:71]
    v_cndmask_b32 v118, v118, v84, vcc
    v_lshlrev_b32 v72, v118, v10
    v_lshl_add_u32 v73, v118, 1, v31
    v_xor_b32 v71, v71, v72

    ds_read_u16 v80, v73 offset:8

    v_ffbl_b32 v84, v71
    v_mul_u32_u24 v72, 5, v84
    v_lshrrev_b64 v[72:73], v72, v[74:75]
    v_and_or_b32 v72, v72, s66, v85
    ds_add_rtn_u32 v87, v72, v10
    ds_wrxchg_rtn_b32 v116, v86, v13
    v_and_b32 v117, 15, v71
    v_bcnt_u32_b32 v118, v117, 0
    v_cmp_eq_u32 vcc, 3, v118

    buffer_load_dwordx4 v[192:195], v9, s[28:31], s77 offen offset:0
    s_add_u32 s47, s44, 135168
    buffer_load_dwordx4 v[152:155], v7, s[20:23], s47 offen offset:0
    buffer_load_dwordx4 v[156:159], v7, s[20:23], s47 offen offset:64

    v_cndmask_b32 v119, v71, v117, vcc
    s_waitcnt lgkmcnt(0)
    v_cmp_gt_u32 s[68:69], 2, v116
    v_cmp_gt_u32 s[70:71], 2, v87

    s_nop 0
    v_lshrrev_b64 v[76:77], v123, s[68:69]
    v_perm_b32 v121, v76, v76, v3
    v_perm_b32 v122, v76, v76, v2
    v_perm_b32 v77, v76, v76, v1
    v_and_b32 v121, v121, v19
    v_and_b32 v122, v122, v18
    v_and_b32 v77, v77, v17
    v_msad_u8 v120, v26, v121, 0
    v_lshlrev_b32 v120, 4, v120
    v_msad_u8 v120, v25, v122, v120
    v_lshlrev_b32 v120, 4, v120
    v_msad_u8 v120, v24, v77, v120

    v_and_b32 v120, v120, v119
    v_cmp_eq_u32 vcc, 0, v120
    v_ffbl_b32 v118, v120
    s_or_b64 vcc, vcc, s[70:71]
    v_cndmask_b32 v118, v118, v84, vcc
    v_lshlrev_b32 v72, v118, v10
    v_lshl_add_u32 v73, v118, 1, v31
    v_xor_b32 v71, v71, v72

    ds_read_u16 v81, v73 offset:8

    v_ffbl_b32 v84, v71
    v_mul_u32_u24 v72, 5, v84
    v_lshrrev_b64 v[72:73], v72, v[74:75]
    v_and_or_b32 v72, v72, s66, v85
    ds_add_rtn_u32 v87, v72, v10
    ds_wrxchg_rtn_b32 v116, v86, v13
    v_and_b32 v117, 15, v71
    v_bcnt_u32_b32 v118, v117, 0
    v_cmp_eq_u32 vcc, 2, v118

    buffer_load_dwordx4 v[196:199], v9, s[28:31], s77 offen offset:1024
    s_add_u32 s47, s44, 139264
    buffer_load_dwordx4 v[168:171], v7, s[20:23], s47 offen offset:0
    buffer_load_dwordx4 v[172:175], v7, s[20:23], s47 offen offset:64

    v_cndmask_b32 v119, v71, v117, vcc
    s_waitcnt lgkmcnt(0)
    v_cmp_gt_u32 s[68:69], 2, v116
    v_cmp_gt_u32 s[70:71], 2, v87

    s_nop 0
    v_lshrrev_b64 v[76:77], v123, s[68:69]
    v_perm_b32 v121, v76, v76, v3
    v_perm_b32 v122, v76, v76, v2
    v_perm_b32 v77, v76, v76, v1
    v_and_b32 v121, v121, v19
    v_and_b32 v122, v122, v18
    v_and_b32 v77, v77, v17
    v_msad_u8 v120, v26, v121, 0
    v_lshlrev_b32 v120, 4, v120
    v_msad_u8 v120, v25, v122, v120
    v_lshlrev_b32 v120, 4, v120
    v_msad_u8 v120, v24, v77, v120

    v_and_b32 v120, v120, v119
    v_cmp_eq_u32 vcc, 0, v120
    v_ffbl_b32 v118, v120
    s_or_b64 vcc, vcc, s[70:71]
    v_cndmask_b32 v118, v118, v84, vcc
    v_lshlrev_b32 v72, v118, v10
    v_lshl_add_u32 v73, v118, 1, v31
    v_xor_b32 v71, v71, v72

    ds_read_u16 v82, v73 offset:8

    v_ffbl_b32 v84, v71
    v_mul_u32_u24 v72, 5, v84
    v_lshrrev_b64 v[72:73], v72, v[74:75]
    v_and_or_b32 v72, v72, s66, v85
    ds_add_rtn_u32 v87, v72, v10
    ds_wrxchg_rtn_b32 v116, v86, v13
    v_and_b32 v117, 15, v71
    v_bcnt_u32_b32 v118, v117, 0
    v_cmp_eq_u32 vcc, 1, v118

    buffer_load_dwordx4 v[208:211], v9, s[28:31], s77 offen offset:2048
    s_add_u32 s47, s44, 143360
    buffer_load_dwordx4 v[184:187], v7, s[20:23], s47 offen offset:0
    buffer_load_dwordx4 v[188:191], v7, s[20:23], s47 offen offset:64

    v_cndmask_b32 v119, v71, v117, vcc
    s_waitcnt lgkmcnt(0)
    v_cmp_gt_u32 s[68:69], 2, v116
    v_cmp_gt_u32 s[70:71], 2, v87

    s_nop 0
    v_lshrrev_b64 v[76:77], v123, s[68:69]
    v_perm_b32 v121, v76, v76, v3
    v_perm_b32 v122, v76, v76, v2
    v_perm_b32 v77, v76, v76, v1
    v_and_b32 v121, v121, v19
    v_and_b32 v122, v122, v18
    v_and_b32 v77, v77, v17
    v_msad_u8 v120, v26, v121, 0
    v_lshlrev_b32 v120, 4, v120
    v_msad_u8 v120, v25, v122, v120
    v_lshlrev_b32 v120, 4, v120
    v_msad_u8 v120, v24, v77, v120

    v_and_b32 v120, v120, v119
    v_cmp_eq_u32 vcc, 0, v120
    v_ffbl_b32 v118, v120
    s_or_b64 vcc, vcc, s[70:71]
    v_cndmask_b32 v118, v118, v84, vcc
    v_lshlrev_b32 v72, v118, v10
    v_lshl_add_u32 v73, v118, 1, v31
    v_xor_b32 v71, v71, v72

    ds_read_u16 v83, v73 offset:8
    v_lshrrev_b32 v71, 4, v71
    v_or_b32 v71, 0xf00, v71
    v_lshlrev_b32 v74, 22, v67
    v_lshl_or_b32 v74, v66, 2, v74
    v_lshrrev_b32 v75, 10, v67
    v_lshl_or_b32 v75, v68, 10, v75

    v_ffbl_b32 v84, v71
    v_mul_u32_u24 v72, 5, v84
    v_lshrrev_b64 v[72:73], v72, v[74:75]
    v_and_or_b32 v72, v72, s66, v85
    ds_add_rtn_u32 v87, v72, v10
    ds_wrxchg_rtn_b32 v116, v86, v13
    v_and_b32 v117, 15, v71
    v_bcnt_u32_b32 v118, v117, 0
    v_cmp_eq_u32 vcc, 4, v118

    buffer_load_dwordx4 v[212:215], v9, s[28:31], s77 offen offset:3072
    s_add_u32 s77, s77, 4096
    s_add_u32 s47, s44, 147456
    buffer_load_dwordx4 v[200:203], v7, s[20:23], s47 offen offset:0
    buffer_load_dwordx4 v[204:207], v7, s[20:23], s47 offen offset:64

    v_cndmask_b32 v119, v71, v117, vcc
    s_waitcnt lgkmcnt(0)
    v_cmp_gt_u32 s[68:69], 2, v116
    v_cmp_gt_u32 s[70:71], 2, v87

    v_lshl_or_b32 v78, v81, 16, v80
    v_lshl_or_b32 v79, v83, 16, v82
    buffer_store_dwordx2 v[78:79], v30, s[32:35], s62 offen sc1
    s_add_u32 s62, s62, 65536
    v_lshrrev_b64 v[76:77], v123, s[68:69]
    v_perm_b32 v121, v76, v76, v4
    v_perm_b32 v122, v76, v76, v3
    v_perm_b32 v77, v76, v76, v2
    v_and_b32 v121, v121, v20
    v_and_b32 v122, v122, v19
    v_and_b32 v77, v77, v18
    v_msad_u8 v120, v27, v121, 0
    v_lshlrev_b32 v120, 4, v120
    v_msad_u8 v120, v26, v122, v120
    v_lshlrev_b32 v120, 4, v120
    v_msad_u8 v120, v25, v77, v120

    v_and_b32 v120, v120, v119
    v_cmp_eq_u32 vcc, 0, v120
    v_ffbl_b32 v118, v120
    s_or_b64 vcc, vcc, s[70:71]
    v_cndmask_b32 v118, v118, v84, vcc
    v_lshlrev_b32 v72, v118, v10
    v_lshl_add_u32 v73, v118, 1, v31
    v_xor_b32 v71, v71, v72

    ds_read_u16 v80, v73 offset:16

    v_ffbl_b32 v84, v71
    v_mul_u32_u24 v72, 5, v84
    v_lshrrev_b64 v[72:73], v72, v[74:75]
    v_and_or_b32 v72, v72, s66, v85
    ds_add_rtn_u32 v87, v72, v10
    ds_wrxchg_rtn_b32 v116, v86, v13
    v_and_b32 v117, 15, v71
    v_bcnt_u32_b32 v118, v117, 0
    v_cmp_eq_u32 vcc, 3, v118

    buffer_load_dwordx4 v[224:227], v9, s[28:31], s77 offen offset:0
    s_add_u32 s47, s44, 151552
    buffer_load_dwordx4 v[216:219], v7, s[20:23], s47 offen offset:0
    buffer_load_dwordx4 v[220:223], v7, s[20:23], s47 offen offset:64

    v_cndmask_b32 v119, v71, v117, vcc
    s_waitcnt lgkmcnt(0)
    v_cmp_gt_u32 s[68:69], 2, v116
    v_cmp_gt_u32 s[70:71], 2, v87

    s_nop 0
    v_lshrrev_b64 v[76:77], v123, s[68:69]
    v_perm_b32 v121, v76, v76, v4
    v_perm_b32 v122, v76, v76, v3
    v_perm_b32 v77, v76, v76, v2
    v_and_b32 v121, v121, v20
    v_and_b32 v122, v122, v19
    v_and_b32 v77, v77, v18
    v_msad_u8 v120, v27, v121, 0
    v_lshlrev_b32 v120, 4, v120
    v_msad_u8 v120, v26, v122, v120
    v_lshlrev_b32 v120, 4, v120
    v_msad_u8 v120, v25, v77, v120

    v_and_b32 v120, v120, v119
    v_cmp_eq_u32 vcc, 0, v120
    v_ffbl_b32 v118, v120
    s_or_b64 vcc, vcc, s[70:71]
    v_cndmask_b32 v118, v118, v84, vcc
    v_lshlrev_b32 v72, v118, v10
    v_lshl_add_u32 v73, v118, 1, v31
    v_xor_b32 v71, v71, v72

    ds_read_u16 v81, v73 offset:16

    v_ffbl_b32 v84, v71
    v_mul_u32_u24 v72, 5, v84
    v_lshrrev_b64 v[72:73], v72, v[74:75]
    v_and_or_b32 v72, v72, s66, v85
    ds_add_rtn_u32 v87, v72, v10
    ds_wrxchg_rtn_b32 v116, v86, v13
    v_and_b32 v117, 15, v71
    v_bcnt_u32_b32 v118, v117, 0
    v_cmp_eq_u32 vcc, 2, v118

    buffer_load_dwordx4 v[228:231], v9, s[28:31], s77 offen offset:1024
    s_add_u32 s47, s44, 155648
    buffer_load_dwordx4 v[232:235], v7, s[20:23], s47 offen offset:0
    buffer_load_dwordx4 v[236:239], v7, s[20:23], s47 offen offset:64

    v_cndmask_b32 v119, v71, v117, vcc
    s_waitcnt lgkmcnt(0)
    v_cmp_gt_u32 s[68:69], 2, v116
    v_cmp_gt_u32 s[70:71], 2, v87

    s_nop 0
    v_lshrrev_b64 v[76:77], v123, s[68:69]
    v_perm_b32 v121, v76, v76, v4
    v_perm_b32 v122, v76, v76, v3
    v_perm_b32 v77, v76, v76, v2
    v_and_b32 v121, v121, v20
    v_and_b32 v122, v122, v19
    v_and_b32 v77, v77, v18
    v_msad_u8 v120, v27, v121, 0
    v_lshlrev_b32 v120, 4, v120
    v_msad_u8 v120, v26, v122, v120
    v_lshlrev_b32 v120, 4, v120
    v_msad_u8 v120, v25, v77, v120

    v_and_b32 v120, v120, v119
    v_cmp_eq_u32 vcc, 0, v120
    v_ffbl_b32 v118, v120
    s_or_b64 vcc, vcc, s[70:71]
    v_cndmask_b32 v118, v118, v84, vcc
    v_lshlrev_b32 v72, v118, v10
    v_lshl_add_u32 v73, v118, 1, v31
    v_xor_b32 v71, v71, v72

    ds_read_u16 v82, v73 offset:16

    v_ffbl_b32 v84, v71
    v_mul_u32_u24 v72, 5, v84
    v_lshrrev_b64 v[72:73], v72, v[74:75]
    v_and_or_b32 v72, v72, s66, v85
    ds_add_rtn_u32 v87, v72, v10
    ds_wrxchg_rtn_b32 v116, v86, v13
    v_and_b32 v117, 15, v71
    v_bcnt_u32_b32 v118, v117, 0
    v_cmp_eq_u32 vcc, 1, v118

    buffer_load_dwordx4 v[240:243], v9, s[28:31], s77 offen offset:2048
    s_add_u32 s47, s44, 159744
    buffer_load_dwordx4 v[248:251], v7, s[20:23], s47 offen offset:0
    buffer_load_dwordx4 v[252:255], v7, s[20:23], s47 offen offset:64

    v_cndmask_b32 v119, v71, v117, vcc
    s_waitcnt lgkmcnt(0)
    v_cmp_gt_u32 s[68:69], 2, v116
    v_cmp_gt_u32 s[70:71], 2, v87

    s_nop 0
    v_lshrrev_b64 v[76:77], v123, s[68:69]
    v_perm_b32 v121, v76, v76, v4
    v_perm_b32 v122, v76, v76, v3
    v_perm_b32 v77, v76, v76, v2
    v_and_b32 v121, v121, v20
    v_and_b32 v122, v122, v19
    v_and_b32 v77, v77, v18
    v_msad_u8 v120, v27, v121, 0
    v_lshlrev_b32 v120, 4, v120
    v_msad_u8 v120, v26, v122, v120
    v_lshlrev_b32 v120, 4, v120
    v_msad_u8 v120, v25, v77, v120

    v_and_b32 v120, v120, v119
    v_cmp_eq_u32 vcc, 0, v120
    v_ffbl_b32 v118, v120
    s_or_b64 vcc, vcc, s[70:71]
    v_cndmask_b32 v118, v118, v84, vcc
    v_lshlrev_b32 v72, v118, v10
    v_lshl_add_u32 v73, v118, 1, v31
    v_xor_b32 v71, v71, v72

    ds_read_u16 v83, v73 offset:16
    v_lshrrev_b32 v71, 4, v71
    v_or_b32 v71, 0xf00, v71
    v_lshlrev_b32 v74, 22, v68
    v_lshl_or_b32 v74, v67, 2, v74
    v_lshrrev_b32 v75, 10, v68
    v_lshl_or_b32 v75, v69, 10, v75

    v_ffbl_b32 v84, v71
    v_mul_u32_u24 v72, 5, v84
    v_lshrrev_b64 v[72:73], v72, v[74:75]
    v_and_or_b32 v72, v72, s66, v85
    ds_add_rtn_u32 v87, v72, v10
    ds_wrxchg_rtn_b32 v116, v86, v13
    v_and_b32 v117, 15, v71
    v_bcnt_u32_b32 v118, v117, 0
    v_cmp_eq_u32 vcc, 4, v118

    buffer_load_dwordx4 v[244:247], v9, s[28:31], s77 offen offset:3072

    v_cndmask_b32 v119, v71, v117, vcc
    s_waitcnt lgkmcnt(0)
    v_cmp_gt_u32 s[68:69], 2, v116
    v_cmp_gt_u32 s[70:71], 2, v87

    v_lshl_or_b32 v78, v81, 16, v80
    v_lshl_or_b32 v79, v83, 16, v82
    buffer_store_dwordx2 v[78:79], v30, s[32:35], s62 offen sc1
    s_add_u32 s62, s62, 65536
    v_lshrrev_b64 v[76:77], v123, s[68:69]
    v_perm_b32 v121, v76, v76, v5
    v_perm_b32 v122, v76, v76, v4
    v_perm_b32 v77, v76, v76, v3
    v_and_b32 v121, v121, v21
    v_and_b32 v122, v122, v20
    v_and_b32 v77, v77, v19
    v_msad_u8 v120, v28, v121, 0
    v_lshlrev_b32 v120, 4, v120
    v_msad_u8 v120, v27, v122, v120
    v_lshlrev_b32 v120, 4, v120
    v_msad_u8 v120, v26, v77, v120

    v_and_b32 v120, v120, v119
    v_cmp_eq_u32 vcc, 0, v120
    v_ffbl_b32 v118, v120
    s_or_b64 vcc, vcc, s[70:71]
    v_cndmask_b32 v118, v118, v84, vcc
    v_lshlrev_b32 v72, v118, v10
    v_lshl_add_u32 v73, v118, 1, v31
    v_xor_b32 v71, v71, v72

    ds_read_u16 v80, v73 offset:24

    v_ffbl_b32 v84, v71
    v_mul_u32_u24 v72, 5, v84
    v_lshrrev_b64 v[72:73], v72, v[74:75]
    v_and_or_b32 v72, v72, s66, v85
    ds_add_rtn_u32 v87, v72, v10
    ds_wrxchg_rtn_b32 v116, v86, v13
    v_and_b32 v117, 15, v71
    v_bcnt_u32_b32 v118, v117, 0
    v_cmp_eq_u32 vcc, 3, v118

    s_nop 1

    v_cndmask_b32 v119, v71, v117, vcc
    s_waitcnt lgkmcnt(0)
    v_cmp_gt_u32 s[68:69], 2, v116
    v_cmp_gt_u32 s[70:71], 2, v87

    s_nop 0
    v_lshrrev_b64 v[76:77], v123, s[68:69]
    v_perm_b32 v121, v76, v76, v5
    v_perm_b32 v122, v76, v76, v4
    v_perm_b32 v77, v76, v76, v3
    v_and_b32 v121, v121, v21
    v_and_b32 v122, v122, v20
    v_and_b32 v77, v77, v19
    v_msad_u8 v120, v28, v121, 0
    v_lshlrev_b32 v120, 4, v120
    v_msad_u8 v120, v27, v122, v120
    v_lshlrev_b32 v120, 4, v120
    v_msad_u8 v120, v26, v77, v120

    v_and_b32 v120, v120, v119
    v_cmp_eq_u32 vcc, 0, v120
    v_ffbl_b32 v118, v120
    s_or_b64 vcc, vcc, s[70:71]
    v_cndmask_b32 v118, v118, v84, vcc
    v_lshlrev_b32 v72, v118, v10
    v_lshl_add_u32 v73, v118, 1, v31
    v_xor_b32 v71, v71, v72

    ds_read_u16 v81, v73 offset:24

    v_ffbl_b32 v84, v71
    v_mul_u32_u24 v72, 5, v84
    v_lshrrev_b64 v[72:73], v72, v[74:75]
    v_and_or_b32 v72, v72, s66, v85
    ds_add_rtn_u32 v87, v72, v10
    ds_wrxchg_rtn_b32 v116, v86, v13
    v_and_b32 v117, 15, v71
    v_bcnt_u32_b32 v118, v117, 0
    v_cmp_eq_u32 vcc, 2, v118

    s_nop 1

    v_cndmask_b32 v119, v71, v117, vcc
    s_waitcnt lgkmcnt(0)
    v_cmp_gt_u32 s[68:69], 2, v116
    v_cmp_gt_u32 s[70:71], 2, v87

    s_nop 0
    v_lshrrev_b64 v[76:77], v123, s[68:69]
    v_perm_b32 v121, v76, v76, v5
    v_perm_b32 v122, v76, v76, v4
    v_perm_b32 v77, v76, v76, v3
    v_and_b32 v121, v121, v21
    v_and_b32 v122, v122, v20
    v_and_b32 v77, v77, v19
    v_msad_u8 v120, v28, v121, 0
    v_lshlrev_b32 v120, 4, v120
    v_msad_u8 v120, v27, v122, v120
    v_lshlrev_b32 v120, 4, v120
    v_msad_u8 v120, v26, v77, v120

    v_and_b32 v120, v120, v119
    v_cmp_eq_u32 vcc, 0, v120
    v_ffbl_b32 v118, v120
    s_or_b64 vcc, vcc, s[70:71]
    v_cndmask_b32 v118, v118, v84, vcc
    v_lshlrev_b32 v72, v118, v10
    v_lshl_add_u32 v73, v118, 1, v31
    v_xor_b32 v71, v71, v72

    ds_read_u16 v82, v73 offset:24

    v_ffbl_b32 v84, v71
    v_mul_u32_u24 v72, 5, v84
    v_lshrrev_b64 v[72:73], v72, v[74:75]
    v_and_or_b32 v72, v72, s66, v85
    ds_add_rtn_u32 v87, v72, v10
    ds_wrxchg_rtn_b32 v116, v86, v13
    v_and_b32 v117, 15, v71
    v_bcnt_u32_b32 v118, v117, 0
    v_cmp_eq_u32 vcc, 1, v118

    s_nop 1

    v_cndmask_b32 v119, v71, v117, vcc
    s_waitcnt lgkmcnt(0)
    v_cmp_gt_u32 s[68:69], 2, v116
    v_cmp_gt_u32 s[70:71], 2, v87

    s_nop 0
    v_lshrrev_b64 v[76:77], v123, s[68:69]
    v_perm_b32 v121, v76, v76, v5
    v_perm_b32 v122, v76, v76, v4
    v_perm_b32 v77, v76, v76, v3
    v_and_b32 v121, v121, v21
    v_and_b32 v122, v122, v20
    v_and_b32 v77, v77, v19
    v_msad_u8 v120, v28, v121, 0
    v_lshlrev_b32 v120, 4, v120
    v_msad_u8 v120, v27, v122, v120
    v_lshlrev_b32 v120, 4, v120
    v_msad_u8 v120, v26, v77, v120

    v_and_b32 v120, v120, v119
    v_cmp_eq_u32 vcc, 0, v120
    v_ffbl_b32 v118, v120
    s_or_b64 vcc, vcc, s[70:71]
    v_cndmask_b32 v118, v118, v84, vcc
    v_lshlrev_b32 v72, v118, v10
    v_lshl_add_u32 v73, v118, 1, v31
    v_xor_b32 v71, v71, v72

    ds_read_u16 v83, v73 offset:24
    v_lshrrev_b32 v71, 4, v71
    v_or_b32 v71, s63, v71
    v_lshlrev_b32 v74, 22, v69
    v_lshl_or_b32 v74, v68, 2, v74
    v_lshrrev_b32 v75, 10, v69
    v_lshl_or_b32 v75, v70, 10, v75

    s_cmp_ge_u32 s57, 800
    s_cbranch_scc1 k1_kernel_norl
    s_waitcnt vmcnt(0)

    v_perm_b32 v0, v132, v128, s84
    v_perm_b32 v1, v148, v144, s84
    v_perm_b32 v2, v164, v160, s84
    v_perm_b32 v3, v180, v176, s84
    v_perm_b32 v16, v132, v128, s85
    v_perm_b32 v17, v148, v144, s85
    v_perm_b32 v18, v164, v160, s85
    v_perm_b32 v19, v180, v176, s85
    v_perm_b32 v32, v133, v129, s84
    v_perm_b32 v33, v149, v145, s84
    v_perm_b32 v34, v165, v161, s84
    v_perm_b32 v35, v181, v177, s84
    v_perm_b32 v64, v133, v129, s85
    v_perm_b32 v65, v149, v145, s85
    v_perm_b32 v66, v165, v161, s85
    v_perm_b32 v67, v181, v177, s85
    ds_write_b128 v36, v[0:3]
    ds_write_b128 v37, v[16:19]
    ds_write_b128 v38, v[32:35]
    ds_write_b128 v39, v[64:67]
    ds_read_b128 v[40:43], v15 offset:0
    ds_read_b128 v[44:47], v15 offset:1024
    ds_read_b128 v[76:79], v15 offset:2048
    ds_read_b128 v[116:119], v15 offset:3072
    v_perm_b32 v0, v196, v192, s84
    v_perm_b32 v1, v212, v208, s84
    v_perm_b32 v2, v228, v224, s84
    v_perm_b32 v3, v244, v240, s84
    v_perm_b32 v16, v196, v192, s85
    v_perm_b32 v17, v212, v208, s85
    v_perm_b32 v18, v228, v224, s85
    v_perm_b32 v19, v244, v240, s85
    v_perm_b32 v32, v197, v193, s84
    v_perm_b32 v33, v213, v209, s84
    v_perm_b32 v34, v229, v225, s84
    v_perm_b32 v35, v245, v241, s84
    v_perm_b32 v64, v197, v193, s85
    v_perm_b32 v65, v213, v209, s85
    v_perm_b32 v66, v229, v225, s85
    v_perm_b32 v67, v245, v241, s85
    s_waitcnt lgkmcnt(0)
    s_add_u32 s83, s82, 0
    buffer_store_dwordx4 v[40:43], v14, s[32:35], s83 offen sc1
    s_add_u32 s83, s82, 3284992
    buffer_store_dwordx4 v[44:47], v14, s[32:35], s83 offen sc1
    s_add_u32 s83, s82, 6569984
    buffer_store_dwordx4 v[76:79], v14, s[32:35], s83 offen sc1
    s_add_u32 s83, s82, 9854976
    buffer_store_dwordx4 v[116:119], v14, s[32:35], s83 offen sc1
    ds_write_b128 v36, v[0:3]
    ds_write_b128 v37, v[16:19]
    ds_write_b128 v38, v[32:35]
    ds_write_b128 v39, v[64:67]
    ds_read_b128 v[40:43], v15 offset:0
    ds_read_b128 v[44:47], v15 offset:1024
    ds_read_b128 v[76:79], v15 offset:2048
    ds_read_b128 v[116:119], v15 offset:3072
    v_perm_b32 v0, v134, v130, s84
    v_perm_b32 v1, v150, v146, s84
    v_perm_b32 v2, v166, v162, s84
    v_perm_b32 v3, v182, v178, s84
    v_perm_b32 v16, v134, v130, s85
    v_perm_b32 v17, v150, v146, s85
    v_perm_b32 v18, v166, v162, s85
    v_perm_b32 v19, v182, v178, s85
    v_perm_b32 v32, v135, v131, s84
    v_perm_b32 v33, v151, v147, s84
    v_perm_b32 v34, v167, v163, s84
    v_perm_b32 v35, v183, v179, s84
    v_perm_b32 v64, v135, v131, s85
    v_perm_b32 v65, v151, v147, s85
    v_perm_b32 v66, v167, v163, s85
    v_perm_b32 v67, v183, v179, s85
    s_waitcnt lgkmcnt(0)
    s_add_u32 s83, s82, 64
    buffer_store_dwordx4 v[40:43], v14, s[32:35], s83 offen sc1
    s_add_u32 s83, s82, 3285056
    buffer_store_dwordx4 v[44:47], v14, s[32:35], s83 offen sc1
    s_add_u32 s83, s82, 6570048
    buffer_store_dwordx4 v[76:79], v14, s[32:35], s83 offen sc1
    s_add_u32 s83, s82, 9855040
    buffer_store_dwordx4 v[116:119], v14, s[32:35], s83 offen sc1
    ds_write_b128 v36, v[0:3]
    ds_write_b128 v37, v[16:19]
    ds_write_b128 v38, v[32:35]
    ds_write_b128 v39, v[64:67]
    ds_read_b128 v[40:43], v15 offset:0
    ds_read_b128 v[44:47], v15 offset:1024
    ds_read_b128 v[76:79], v15 offset:2048
    ds_read_b128 v[116:119], v15 offset:3072
    v_perm_b32 v0, v198, v194, s84
    v_perm_b32 v1, v214, v210, s84
    v_perm_b32 v2, v230, v226, s84
    v_perm_b32 v3, v246, v242, s84
    v_perm_b32 v16, v198, v194, s85
    v_perm_b32 v17, v214, v210, s85
    v_perm_b32 v18, v230, v226, s85
    v_perm_b32 v19, v246, v242, s85
    v_perm_b32 v32, v199, v195, s84
    v_perm_b32 v33, v215, v211, s84
    v_perm_b32 v34, v231, v227, s84
    v_perm_b32 v35, v247, v243, s84
    v_perm_b32 v64, v199, v195, s85
    v_perm_b32 v65, v215, v211, s85
    v_perm_b32 v66, v231, v227, s85
    v_perm_b32 v67, v247, v243, s85
    s_waitcnt lgkmcnt(0)
    s_add_u32 s83, s82, 102656
    buffer_store_dwordx4 v[40:43], v14, s[32:35], s83 offen sc1
    s_add_u32 s83, s82, 3387648
    buffer_store_dwordx4 v[44:47], v14, s[32:35], s83 offen sc1
    s_add_u32 s83, s82, 6672640
    buffer_store_dwordx4 v[76:79], v14, s[32:35], s83 offen sc1
    s_add_u32 s83, s82, 9957632
    buffer_store_dwordx4 v[116:119], v14, s[32:35], s83 offen sc1
    ds_write_b128 v36, v[0:3]
    ds_write_b128 v37, v[16:19]
    ds_write_b128 v38, v[32:35]
    ds_write_b128 v39, v[64:67]
    ds_read_b128 v[40:43], v15 offset:0
    ds_read_b128 v[44:47], v15 offset:1024
    ds_read_b128 v[76:79], v15 offset:2048
    ds_read_b128 v[116:119], v15 offset:3072
    ds_write_b64 v31, v[48:49] offset:32
    ds_write_b64 v31, v[50:51] offset:40
    ds_write_b64 v31, v[52:53] offset:48
    s_waitcnt lgkmcnt(3)
    s_add_u32 s83, s82, 102720
    buffer_store_dwordx4 v[40:43], v14, s[32:35], s83 offen sc1
    s_add_u32 s83, s82, 3387712
    buffer_store_dwordx4 v[44:47], v14, s[32:35], s83 offen sc1
    s_add_u32 s83, s82, 6672704
    buffer_store_dwordx4 v[76:79], v14, s[32:35], s83 offen sc1
    s_add_u32 s83, s82, 9957696
    buffer_store_dwordx4 v[116:119], v14, s[32:35], s83 offen sc1
k1_kernel_norl:
k1_kernel_rld:
    ds_write_b32 v86, v13

    v_ffbl_b32 v84, v71
    v_mul_u32_u24 v72, 5, v84
    v_lshrrev_b64 v[72:73], v72, v[74:75]
    v_and_or_b32 v72, v72, s66, v85
    ds_add_rtn_u32 v87, v72, v10
    ds_wrxchg_rtn_b32 v116, v86, v13
    v_and_b32 v117, 15, v71
    v_bcnt_u32_b32 v118, v117, 0
    v_cmp_eq_u32 vcc, 4, v118

    s_nop 1

    v_cndmask_b32 v119, v71, v117, vcc
    s_waitcnt lgkmcnt(0)
    v_cmp_gt_u32 s[68:69], 2, v116
    v_cmp_gt_u32 s[70:71], 2, v87

    v_lshl_or_b32 v78, v81, 16, v80
    v_lshl_or_b32 v79, v83, 16, v82
    buffer_store_dwordx2 v[78:79], v30, s[32:35], s62 offen sc1
    s_add_u32 s62, s62, 65536
    v_lshrrev_b64 v[76:77], v123, s[68:69]
    v_perm_b32 v121, v76, v76, v6
    v_perm_b32 v122, v76, v76, v5
    v_perm_b32 v77, v76, v76, v4
    v_and_b32 v121, v121, v22
    v_and_b32 v122, v122, v21
    v_and_b32 v77, v77, v20
    v_msad_u8 v120, v29, v121, 0
    v_lshlrev_b32 v120, 4, v120
    v_msad_u8 v120, v28, v122, v120
    v_lshlrev_b32 v120, 4, v120
    v_msad_u8 v120, v27, v77, v120

    v_and_b32 v120, v120, v119
    v_cmp_eq_u32 vcc, 0, v120
    v_ffbl_b32 v118, v120
    s_or_b64 vcc, vcc, s[70:71]
    v_cndmask_b32 v118, v118, v84, vcc
    v_lshlrev_b32 v72, v118, v10
    v_lshl_add_u32 v73, v118, 1, v31
    v_xor_b32 v71, v71, v72

    ds_read_u16 v80, v73 offset:32

    v_ffbl_b32 v84, v71
    v_mul_u32_u24 v72, 5, v84
    v_lshrrev_b64 v[72:73], v72, v[74:75]
    v_and_or_b32 v72, v72, s66, v85
    ds_add_rtn_u32 v87, v72, v10
    ds_wrxchg_rtn_b32 v116, v86, v13
    v_and_b32 v117, 15, v71
    v_bcnt_u32_b32 v118, v117, 0
    v_cmp_eq_u32 vcc, 3, v118

    s_nop 1

    v_cndmask_b32 v119, v71, v117, vcc
    s_waitcnt lgkmcnt(0)
    v_cmp_gt_u32 s[68:69], 2, v116
    v_cmp_gt_u32 s[70:71], 2, v87

    s_nop 0
    v_lshrrev_b64 v[76:77], v123, s[68:69]
    v_perm_b32 v121, v76, v76, v6
    v_perm_b32 v122, v76, v76, v5
    v_perm_b32 v77, v76, v76, v4
    v_and_b32 v121, v121, v22
    v_and_b32 v122, v122, v21
    v_and_b32 v77, v77, v20
    v_msad_u8 v120, v29, v121, 0
    v_lshlrev_b32 v120, 4, v120
    v_msad_u8 v120, v28, v122, v120
    v_lshlrev_b32 v120, 4, v120
    v_msad_u8 v120, v27, v77, v120

    v_and_b32 v120, v120, v119
    v_cmp_eq_u32 vcc, 0, v120
    v_ffbl_b32 v118, v120
    s_or_b64 vcc, vcc, s[70:71]
    v_cndmask_b32 v118, v118, v84, vcc
    v_lshlrev_b32 v72, v118, v10
    v_lshl_add_u32 v73, v118, 1, v31
    v_xor_b32 v71, v71, v72

    ds_read_u16 v81, v73 offset:32

    v_ffbl_b32 v84, v71
    v_mul_u32_u24 v72, 5, v84
    v_lshrrev_b64 v[72:73], v72, v[74:75]
    v_and_or_b32 v72, v72, s66, v85
    ds_add_rtn_u32 v87, v72, v10
    ds_wrxchg_rtn_b32 v116, v86, v13
    v_and_b32 v117, 15, v71
    v_bcnt_u32_b32 v118, v117, 0
    v_cmp_eq_u32 vcc, 2, v118

    s_nop 1

    v_cndmask_b32 v119, v71, v117, vcc
    s_waitcnt lgkmcnt(0)
    v_cmp_gt_u32 s[68:69], 2, v116
    v_cmp_gt_u32 s[70:71], 2, v87

    s_nop 0
    v_lshrrev_b64 v[76:77], v123, s[68:69]
    v_perm_b32 v121, v76, v76, v6
    v_perm_b32 v122, v76, v76, v5
    v_perm_b32 v77, v76, v76, v4
    v_and_b32 v121, v121, v22
    v_and_b32 v122, v122, v21
    v_and_b32 v77, v77, v20
    v_msad_u8 v120, v29, v121, 0
    v_lshlrev_b32 v120, 4, v120
    v_msad_u8 v120, v28, v122, v120
    v_lshlrev_b32 v120, 4, v120
    v_msad_u8 v120, v27, v77, v120

    v_and_b32 v120, v120, v119
    v_cmp_eq_u32 vcc, 0, v120
    v_ffbl_b32 v118, v120
    s_or_b64 vcc, vcc, s[70:71]
    v_cndmask_b32 v118, v118, v84, vcc
    v_lshlrev_b32 v72, v118, v10
    v_lshl_add_u32 v73, v118, 1, v31
    v_xor_b32 v71, v71, v72

    ds_read_u16 v82, v73 offset:32

    v_ffbl_b32 v84, v71
    v_mul_u32_u24 v72, 5, v84
    v_lshrrev_b64 v[72:73], v72, v[74:75]
    v_and_or_b32 v72, v72, s66, v85
    ds_add_rtn_u32 v87, v72, v10
    ds_wrxchg_rtn_b32 v116, v86, v13
    v_and_b32 v117, 15, v71
    v_bcnt_u32_b32 v118, v117, 0
    v_cmp_eq_u32 vcc, 1, v118

    s_nop 1

    v_cndmask_b32 v119, v71, v117, vcc
    s_waitcnt lgkmcnt(0)
    v_cmp_gt_u32 s[68:69], 2, v116
    v_cmp_gt_u32 s[70:71], 2, v87

    s_nop 0
    v_lshrrev_b64 v[76:77], v123, s[68:69]
    v_perm_b32 v121, v76, v76, v6
    v_perm_b32 v122, v76, v76, v5
    v_perm_b32 v77, v76, v76, v4
    v_and_b32 v121, v121, v22
    v_and_b32 v122, v122, v21
    v_and_b32 v77, v77, v20
    v_msad_u8 v120, v29, v121, 0
    v_lshlrev_b32 v120, 4, v120
    v_msad_u8 v120, v28, v122, v120
    v_lshlrev_b32 v120, 4, v120
    v_msad_u8 v120, v27, v77, v120

    v_and_b32 v120, v120, v119
    v_cmp_eq_u32 vcc, 0, v120
    v_ffbl_b32 v118, v120
    s_or_b64 vcc, vcc, s[70:71]
    v_cndmask_b32 v118, v118, v84, vcc
    v_lshlrev_b32 v72, v118, v10
    v_lshl_add_u32 v73, v118, 1, v31
    v_xor_b32 v71, v71, v72

    ds_read_u16 v83, v73 offset:32
    s_cmp_lg_u32 s59, 3
    s_cbranch_scc1 k1_kernel_sdone
    v_lshrrev_b32 v71, 4, v71
    v_lshlrev_b32 v74, 22, v70
    v_lshl_or_b32 v74, v69, 2, v74
    v_lshrrev_b32 v75, 10, v70

    v_ffbl_b32 v84, v71
    v_mul_u32_u24 v72, 5, v84
    v_lshrrev_b64 v[72:73], v72, v[74:75]
    v_and_or_b32 v72, v72, s66, v85
    ds_add_rtn_u32 v87, v72, v10
    ds_wrxchg_rtn_b32 v116, v86, v13
    v_and_b32 v117, 15, v71
    v_bcnt_u32_b32 v118, v117, 0
    v_cmp_eq_u32 vcc, 4, v118

    s_nop 1

    v_cndmask_b32 v119, v71, v117, vcc
    s_waitcnt lgkmcnt(0)
    v_cmp_gt_u32 s[68:69], 2, v116
    v_cmp_gt_u32 s[70:71], 2, v87

    v_lshl_or_b32 v78, v81, 16, v80
    v_lshl_or_b32 v79, v83, 16, v82
    buffer_store_dwordx2 v[78:79], v30, s[32:35], s62 offen sc1
    s_add_u32 s62, s62, 65536
    v_lshrrev_b64 v[76:77], v123, s[68:69]
    v_perm_b32 v121, v76, v76, v6
    v_perm_b32 v122, v76, v76, v5
    v_and_b32 v121, v121, v22
    v_and_b32 v122, v122, v21
    v_msad_u8 v120, v29, v121, 0
    v_lshlrev_b32 v120, 4, v120
    v_msad_u8 v120, v28, v122, v120

    v_and_b32 v120, v120, v119
    v_cmp_eq_u32 vcc, 0, v120
    v_ffbl_b32 v118, v120
    s_or_b64 vcc, vcc, s[70:71]
    v_cndmask_b32 v118, v118, v84, vcc
    v_lshlrev_b32 v72, v118, v10
    v_lshl_add_u32 v73, v118, 1, v31
    v_xor_b32 v71, v71, v72

    ds_read_u16 v80, v73 offset:40

    v_ffbl_b32 v84, v71
    v_mul_u32_u24 v72, 5, v84
    v_lshrrev_b64 v[72:73], v72, v[74:75]
    v_and_or_b32 v72, v72, s66, v85
    ds_add_rtn_u32 v87, v72, v10
    ds_wrxchg_rtn_b32 v116, v86, v13
    v_and_b32 v117, 15, v71
    v_bcnt_u32_b32 v118, v117, 0
    v_cmp_eq_u32 vcc, 3, v118

    s_nop 1

    v_cndmask_b32 v119, v71, v117, vcc
    s_waitcnt lgkmcnt(0)
    v_cmp_gt_u32 s[68:69], 2, v116
    v_cmp_gt_u32 s[70:71], 2, v87

    s_nop 0
    v_lshrrev_b64 v[76:77], v123, s[68:69]
    v_perm_b32 v121, v76, v76, v6
    v_perm_b32 v122, v76, v76, v5
    v_and_b32 v121, v121, v22
    v_and_b32 v122, v122, v21
    v_msad_u8 v120, v29, v121, 0
    v_lshlrev_b32 v120, 4, v120
    v_msad_u8 v120, v28, v122, v120

    v_and_b32 v120, v120, v119
    v_cmp_eq_u32 vcc, 0, v120
    v_ffbl_b32 v118, v120
    s_or_b64 vcc, vcc, s[70:71]
    v_cndmask_b32 v118, v118, v84, vcc
    v_lshlrev_b32 v72, v118, v10
    v_lshl_add_u32 v73, v118, 1, v31
    v_xor_b32 v71, v71, v72

    ds_read_u16 v81, v73 offset:40

    v_ffbl_b32 v84, v71
    v_mul_u32_u24 v72, 5, v84
    v_lshrrev_b64 v[72:73], v72, v[74:75]
    v_and_or_b32 v72, v72, s66, v85
    ds_add_rtn_u32 v87, v72, v10
    ds_wrxchg_rtn_b32 v116, v86, v13
    v_and_b32 v117, 15, v71
    v_bcnt_u32_b32 v118, v117, 0
    v_cmp_eq_u32 vcc, 2, v118

    s_nop 1

    v_cndmask_b32 v119, v71, v117, vcc
    s_waitcnt lgkmcnt(0)
    v_cmp_gt_u32 s[68:69], 2, v116
    v_cmp_gt_u32 s[70:71], 2, v87

    s_nop 0
    v_lshrrev_b64 v[76:77], v123, s[68:69]
    v_perm_b32 v121, v76, v76, v6
    v_perm_b32 v122, v76, v76, v5
    v_and_b32 v121, v121, v22
    v_and_b32 v122, v122, v21
    v_msad_u8 v120, v29, v121, 0
    v_lshlrev_b32 v120, 4, v120
    v_msad_u8 v120, v28, v122, v120

    v_and_b32 v120, v120, v119
    v_cmp_eq_u32 vcc, 0, v120
    v_ffbl_b32 v118, v120
    s_or_b64 vcc, vcc, s[70:71]
    v_cndmask_b32 v118, v118, v84, vcc
    v_lshlrev_b32 v72, v118, v10
    v_lshl_add_u32 v73, v118, 1, v31
    v_xor_b32 v71, v71, v72

    ds_read_u16 v82, v73 offset:40

    v_ffbl_b32 v84, v71
    v_mul_u32_u24 v72, 5, v84
    v_lshrrev_b64 v[72:73], v72, v[74:75]
    v_and_or_b32 v72, v72, s66, v85
    ds_add_rtn_u32 v87, v72, v10
    ds_wrxchg_rtn_b32 v116, v86, v13
    v_and_b32 v117, 15, v71
    v_bcnt_u32_b32 v118, v117, 0
    v_cmp_eq_u32 vcc, 1, v118

    s_nop 1

    v_cndmask_b32 v119, v71, v117, vcc
    s_waitcnt lgkmcnt(0)
    v_cmp_gt_u32 s[68:69], 2, v116
    v_cmp_gt_u32 s[70:71], 2, v87

    s_nop 0
    v_lshrrev_b64 v[76:77], v123, s[68:69]
    v_perm_b32 v121, v76, v76, v6
    v_perm_b32 v122, v76, v76, v5
    v_and_b32 v121, v121, v22
    v_and_b32 v122, v122, v21
    v_msad_u8 v120, v29, v121, 0
    v_lshlrev_b32 v120, 4, v120
    v_msad_u8 v120, v28, v122, v120

    v_and_b32 v120, v120, v119
    v_cmp_eq_u32 vcc, 0, v120
    v_ffbl_b32 v118, v120
    s_or_b64 vcc, vcc, s[70:71]
    v_cndmask_b32 v118, v118, v84, vcc
    v_lshlrev_b32 v72, v118, v10
    v_lshl_add_u32 v73, v118, 1, v31
    v_xor_b32 v71, v71, v72

    ds_read_u16 v83, v73 offset:40
k1_kernel_sdone:
    s_waitcnt lgkmcnt(0)
    v_lshl_or_b32 v78, v81, 16, v80
    v_lshl_or_b32 v79, v83, 16, v82
    buffer_store_dwordx2 v[78:79], v30, s[32:35], s62 offen sc1
    s_add_u32 s62, s62, 65536
k1_kernel_udone:
    s_setprio 3

    s_mov_b64 exec, 1
    ds_add_rtn_u32 v12, v11, v10 offset:28
    s_waitcnt lgkmcnt(0)
    v_readfirstlane_b32 s45, v12
    s_cmp_ge_u32 s45, 2
    s_cbranch_scc1 k1_kernel_ncl
    s_mov_b64 exec, -1
    s_mul_i32 s45, s45, 16384
    s_min_u32 s45, s45, 16384
    s_lshl_b32 s72, s2, 15
    s_add_u32 s72, s72, s45
    s_add_u32 s72, s72, 20971520
    v_mov_b32 v192, -1
    v_mov_b32 v193, -1
    v_mov_b32 v194, -1
    v_mov_b32 v195, -1
    buffer_store_dwordx4 v[192:195], v9, s[12:15], s72 offen offset:0 sc1
    buffer_store_dwordx4 v[192:195], v9, s[12:15], s72 offen offset:1024 sc1
    buffer_store_dwordx4 v[192:195], v9, s[12:15], s72 offen offset:2048 sc1
    buffer_store_dwordx4 v[192:195], v9, s[12:15], s72 offen offset:3072 sc1
    s_add_u32 s72, s72, 4096
    buffer_store_dwordx4 v[192:195], v9, s[12:15], s72 offen offset:0 sc1
    buffer_store_dwordx4 v[192:195], v9, s[12:15], s72 offen offset:1024 sc1
    buffer_store_dwordx4 v[192:195], v9, s[12:15], s72 offen offset:2048 sc1
    buffer_store_dwordx4 v[192:195], v9, s[12:15], s72 offen offset:3072 sc1
    s_add_u32 s72, s72, 4096
    buffer_store_dwordx4 v[192:195], v9, s[12:15], s72 offen offset:0 sc1
    buffer_store_dwordx4 v[192:195], v9, s[12:15], s72 offen offset:1024 sc1
    buffer_store_dwordx4 v[192:195], v9, s[12:15], s72 offen offset:2048 sc1
    buffer_store_dwordx4 v[192:195], v9, s[12:15], s72 offen offset:3072 sc1
    s_add_u32 s72, s72, 4096
    buffer_store_dwordx4 v[192:195], v9, s[12:15], s72 offen offset:0 sc1
    buffer_store_dwordx4 v[192:195], v9, s[12:15], s72 offen offset:1024 sc1
    buffer_store_dwordx4 v[192:195], v9, s[12:15], s72 offen offset:2048 sc1
    buffer_store_dwordx4 v[192:195], v9, s[12:15], s72 offen offset:3072 sc1
    s_add_u32 s72, s72, 4096
k1_kernel_ncl:

    s_waitcnt vmcnt(0)

    s_mov_b64 exec, 1
    ds_add_rtn_u32 v12, v11, v10 offset:20
    v_mov_b32 v3, 1
    s_bfe_u32 s39, s2, 0x10004
    s_mul_i32 s38, s39, 128
    s_waitcnt lgkmcnt(0)
    v_readfirstlane_b32 s45, v12
    s_cmp_eq_u32 s45, 3
    s_cbranch_scc0 k1_kernel_tld0
    buffer_atomic_add v3, v13, s[52:55], s38 offen offset:32 sc0
k1_kernel_tld0:
    s_and_b32 s45, s45, 3
k1_kernel_tld:
    s_mov_b64 exec, -1
    s_add_u32 s47, s44, 0
    buffer_load_dwordx4 v[32:35], v7, s[20:23], s47 offen offset:0
    buffer_load_dwordx4 v[36:39], v7, s[20:23], s47 offen offset:64
    s_add_u32 s47, s44, 4096
    buffer_load_dwordx4 v[40:43], v7, s[20:23], s47 offen offset:0
    buffer_load_dwordx4 v[44:47], v7, s[20:23], s47 offen offset:64
    s_add_u32 s47, s44, 8192
    buffer_load_dwordx4 v[48:51], v7, s[20:23], s47 offen offset:0
    buffer_load_dwordx4 v[52:55], v7, s[20:23], s47 offen offset:64
    s_cmp_eq_u32 s45, 3
    s_cbranch_scc0 k1_kernel_wdec
    s_lshl_b32 s45, s2, 8
    s_add_u32 s45, s45, 14680064
    v_lshlrev_b32 v0, 8, v8
    v_mov_b32 v116, 0
    s_lshl4_add_u32 s38, s39, 14680064
    s_cmp_lg_u32 s64, 0
    s_cbranch_scc1 k1_kernel_bits
    s_waitcnt vmcnt(6)
    v_readfirstlane_b32 s39, v3

    s_cmp_eq_u32 s39, 127
    s_cbranch_scc0 k1_kernel_poll0

    buffer_store_dword v10, v0, s[12:15], s38 offen sc1
    s_add_u32 s38, s38, 16384
    buffer_store_dword v10, v0, s[12:15], s38 offen sc1
    s_add_u32 s38, s38, 16384
    buffer_store_dword v10, v0, s[12:15], s38 offen sc1
    s_add_u32 s38, s38, 16384
    buffer_store_dword v10, v0, s[12:15], s38 offen sc1

k1_kernel_poll0:
    s_mov_b64 exec, 3
k1_kernel_poll:
    buffer_load_dword v116, v9, s[12:15], s45 offen sc1
    s_add_u32 s65, s65, 1
    s_waitcnt vmcnt(0)
    v_cmp_ne_u32 vcc, 1, v116
    s_cbranch_vccz k1_kernel_go

    s_cmp_lt_u32 s65, 200
    s_cbranch_scc1 k1_kernel_poll
k1_kernel_bits:
    s_mov_b64 exec, -1
    s_lshr_b32 s38, s51, 5
    s_lshl_b32 s39, 1, s51
    v_cmp_eq_u32 vcc, s38, v8
    v_mov_b32 v2, s39
    v_lshlrev_b32 v0, 2, v8
    v_cndmask_b32 v2, 0, v2, vcc
    v_mov_b32 v1, v2
    buffer_atomic_or v1, v0, s[52:55], 0 offen sc0
    s_waitcnt vmcnt(0)
    v_cmp_ne_u32 vcc, 128, v1
    v_or_b32 v1, v1, v2
    s_and_b32 s38, vcc_lo, 0x100
    s_and_b32 s39, vcc_hi, 0x100
    v_cmp_ne_u32 vcc, -1, v1
    s_or_b32 s38, s38, s39
    s_cbranch_scc0 k1_kernel_go
    s_and_b32 s38, vcc_lo, 0xff
    s_cbranch_scc0 k1_kernel_go
    s_ff1_i32_b32 s38, s38
    s_nop 3
    v_readlane_b32 s39, v1, s38
    s_ff0_i32_b32 s39, s39
    s_lshl_b32 s38, s38, 5
    s_add_u32 s38, s38, s39
    s_andn2_b32 s39, s64, 255
    s_add_u32 s39, s39, 256
    s_or_b32 s38, s38, s39
    s_branch k1_kernel_dec

k1_kernel_go:

    s_mov_b32 s38, 0x80000000

k1_kernel_dec:

    v_mov_b32 v1, s38
    s_mov_b64 exec, 1
    ds_write_b32 v11, v1 offset:24

k1_kernel_wdec:

    s_mov_b64 exec, -1
    ds_read_b32 v12, v11 offset:24
    s_waitcnt lgkmcnt(0)
    v_readfirstlane_b32 s45, v12
    s_cmp_lg_u32 s45, s64
    s_cbranch_scc1 k1_kernel_gotd
    s_sleep 2
    s_branch k1_kernel_wdec
k1_kernel_redo:
    s_waitcnt vmcnt(0) lgkmcnt(0)
    s_branch k1_kernel_unit

k1_kernel_gotd:

    s_mov_b32 s64, s45
    s_and_b32 s51, s45, 255
    s_mov_b32 s65, 0x10000
    s_bitcmp0_b32 s45, 31
    s_cbranch_scc1 k1_kernel_redo

k1_kernel_k2:

    s_setprio 0
    s_load_dwordx4 s[8:11], s[0:1], 32
    s_load_dwordx2 s[56:57], s[0:1], 48
    s_load_dwordx2 s[60:61], s[0:1], 56
    v_mbcnt_lo_u32_b32 v0, -1, 0
    v_mbcnt_hi_u32_b32 v0, -1, v0
    s_mul_i32 s35, s3, 18432
    v_and_b32 v1, 15, v0
    v_lshrrev_b32 v2, 4, v0
    v_mul_u32_u24 v71, 144, v1
    v_lshl_add_u32 v71, v2, 4, v71
    v_add_u32 v71, s35, v71

    ds_read_b128 v[128:131], v71 offset:0
    ds_read_b128 v[132:135], v71 offset:64
    ds_read_b128 v[144:147], v71 offset:2304
    ds_read_b128 v[148:151], v71 offset:2368
    ds_read_b128 v[160:163], v71 offset:4608
    ds_read_b128 v[164:167], v71 offset:4672
    ds_read_b128 v[176:179], v71 offset:6912
    ds_read_b128 v[180:183], v71 offset:6976
    ds_read_b128 v[192:195], v71 offset:9216
    ds_read_b128 v[196:199], v71 offset:9280
    ds_read_b128 v[208:211], v71 offset:11520
    ds_read_b128 v[212:215], v71 offset:11584
    ds_read_b128 v[224:227], v71 offset:13824
    ds_read_b128 v[228:231], v71 offset:13888
    ds_read_b128 v[240:243], v71 offset:16128
    ds_read_b128 v[244:247], v71 offset:16192

    s_lshr_b32 s33, s2, 1
    s_and_b32 s34, s2, 1
    s_mov_b32 s32, 0x8000
    v_lshlrev_b32 v69, 4, v0
    s_mul_i32 s21, s33, 102656
    s_lshl_b32 s35, s50, 11
    s_xor_b32 s19, s35, 2048
    s_add_u32 s19, s19, s21
    s_add_u32 s21, s21, s35
    s_mul_i32 s20, s34, 1638400
    s_add_u32 s20, s20, 16777216
    s_lshl_b32 s35, s3, 13
    s_add_u32 s20, s20, s35
    v_lshlrev_b32 v70, 13, v2
    v_lshl_add_u32 v70, v1, 3, v70
    s_lshl_b32 s35, s3, 10
    v_add_u32 v70, s35, v70
    v_lshrrev_b32 v4, 3, v0
    v_xor_b32 v4, v4, v2
    v_and_b32 v4, 1, v4
    v_bfe_u32 v5, v0, 2, 1
    v_lshl_or_b32 v4, v4, 1, v5
    v_mov_b32 v6, 0x3f80
    v_cmp_eq_u32 vcc, 0, v4
    s_nop 1
    v_cndmask_b32 v64, 0, v6, vcc
    v_cndmask_b32 v65, 0, v6, vcc
    v_cmp_eq_u32 vcc, 1, v4
    s_nop 1
    v_cndmask_b32 v66, 0, v6, vcc
    v_cndmask_b32 v67, 0, v6, vcc
    v_and_b32 v5, 3, v0
    v_mul_u32_u24 v68, 0x5555, v5

    s_cmp_lt_u32 s3, 4
    s_cbranch_scc1 k1_kernel_k2n
    buffer_load_dwordx4 v[0:3], v69, s[12:15], s21 offen offset:0
    buffer_load_dwordx4 v[4:7], v69, s[12:15], s21 offen offset:1024
    buffer_load_dwordx4 v[8:11], v69, s[12:15], s19 offen offset:0
    buffer_load_dwordx4 v[12:15], v69, s[12:15], s19 offen offset:1024
    s_add_u32 s21, s21, 4096
    s_add_u32 s19, s19, 4096
    buffer_load_dwordx4 v[16:19], v69, s[12:15], s21 offen offset:0
    buffer_load_dwordx4 v[20:23], v69, s[12:15], s21 offen offset:1024
    buffer_load_dwordx4 v[24:27], v69, s[12:15], s19 offen offset:0
    buffer_load_dwordx4 v[28:31], v69, s[12:15], s19 offen offset:1024
    s_add_u32 s21, s21, 4096
    s_add_u32 s19, s19, 4096
    s_mov_b32 s44, s21
    s_mov_b32 s45, s19
    s_add_u32 s21, s21, 4096
    s_add_u32 s19, s19, 4096
    buffer_load_dwordx4 v[72:75], v69, s[12:15], s21 offen offset:0
    buffer_load_dwordx4 v[76:79], v69, s[12:15], s21 offen offset:1024
    buffer_load_dwordx4 v[80:83], v69, s[12:15], s19 offen offset:0
    buffer_load_dwordx4 v[84:87], v69, s[12:15], s19 offen offset:1024
    s_add_u32 s21, s21, 4096
    s_add_u32 s19, s19, 4096
    buffer_load_dwordx4 v[116:119], v69, s[12:15], s20 offen offset:0 sc1
    buffer_load_dwordx4 v[120:123], v69, s[12:15], s20 offen offset:1024 sc1
k1_kernel_k2n:

    s_and_b32 s35, s3, 3
    s_lshl_b32 s35, s35, 14
    s_add_u32 s35, s35, 98304
    v_add_u32 v71, s35, v69
    s_lshl_b32 s35, s33, 3
    s_waitcnt lgkmcnt(0)
    s_add_u32 s8, s8, s35
    s_addc_u32 s9, s9, 0
    s_add_u32 s10, s10, s35
    s_addc_u32 s11, s11, 0
    s_barrier

    s_load_dwordx2 s[36:37], s[8:9], 0
    s_load_dwordx2 s[38:39], s[10:11], 0
    s_cmp_lt_u32 s3, 4
    s_cbranch_scc1 k1_kernel_k2m

    s_waitcnt vmcnt(10)
    ds_write_b128 v71, v[32:35] offset:0
    ds_write_b128 v71, v[36:39] offset:1024
    ds_write_b128 v71, v[40:43] offset:2048
    ds_write_b128 v71, v[44:47] offset:3072
    v_mfma_f32_16x16x32_bf16 v[32:35], v[0:3], v[128:131], 0
    v_mfma_f32_16x16x32_bf16 v[36:39], v[0:3], v[144:147], 0
    ds_write_b128 v71, v[48:51] offset:4096
    v_mfma_f32_16x16x32_bf16 v[40:43], v[0:3], v[160:163], 0
    v_mfma_f32_16x16x32_bf16 v[44:47], v[0:3], v[176:179], 0
    ds_write_b128 v71, v[52:55] offset:5120
    v_mfma_f32_16x16x32_bf16 v[32:35], v[4:7], v[132:135], v[32:35]
    v_mfma_f32_16x16x32_bf16 v[36:39], v[4:7], v[148:151], v[36:39]
    ds_write_b128 v71, v[56:59] offset:6144
    v_mfma_f32_16x16x32_bf16 v[40:43], v[4:7], v[164:167], v[40:43]
    v_mfma_f32_16x16x32_bf16 v[44:47], v[4:7], v[180:183], v[44:47]
    ds_write_b128 v71, v[60:63] offset:7168
    v_mfma_f32_16x16x32_bf16 v[32:35], v[8:11], v[136:139], v[32:35]
    v_mfma_f32_16x16x32_bf16 v[36:39], v[8:11], v[152:155], v[36:39]
    ds_write_b128 v71, v[88:91] offset:8192
    v_mfma_f32_16x16x32_bf16 v[40:43], v[8:11], v[168:171], v[40:43]
    v_mfma_f32_16x16x32_bf16 v[44:47], v[8:11], v[184:187], v[44:47]
    ds_write_b128 v71, v[92:95] offset:9216
    v_mfma_f32_16x16x32_bf16 v[32:35], v[12:15], v[140:143], v[32:35]
    v_mfma_f32_16x16x32_bf16 v[36:39], v[12:15], v[156:159], v[36:39]
    ds_write_b128 v71, v[96:99] offset:10240
    v_mfma_f32_16x16x32_bf16 v[40:43], v[12:15], v[172:175], v[40:43]
    v_mfma_f32_16x16x32_bf16 v[44:47], v[12:15], v[188:191], v[44:47]
    ds_write_b128 v71, v[100:103] offset:11264
    v_mfma_f32_16x16x32_bf16 v[48:51], v[0:3], v[192:195], 0
    v_mfma_f32_16x16x32_bf16 v[52:55], v[0:3], v[208:211], 0
    ds_write_b128 v71, v[104:107] offset:12288
    v_mfma_f32_16x16x32_bf16 v[56:59], v[0:3], v[224:227], 0
    v_mfma_f32_16x16x32_bf16 v[60:63], v[0:3], v[240:243], 0
    ds_write_b128 v71, v[108:111] offset:13312
    v_mfma_f32_16x16x32_bf16 v[48:51], v[4:7], v[196:199], v[48:51]
    v_mfma_f32_16x16x32_bf16 v[52:55], v[4:7], v[212:215], v[52:55]
    ds_write_b128 v71, v[112:115] offset:14336
    v_mfma_f32_16x16x32_bf16 v[56:59], v[4:7], v[228:231], v[56:59]
    v_mfma_f32_16x16x32_bf16 v[60:63], v[4:7], v[244:247], v[60:63]
    ds_write_b128 v71, v[124:127] offset:15360
    v_mfma_f32_16x16x32_bf16 v[48:51], v[8:11], v[200:203], v[48:51]
    v_mfma_f32_16x16x32_bf16 v[52:55], v[8:11], v[216:219], v[52:55]
    v_mfma_f32_16x16x32_bf16 v[56:59], v[8:11], v[232:235], v[56:59]
    v_mfma_f32_16x16x32_bf16 v[60:63], v[8:11], v[248:251], v[60:63]
    s_waitcnt lgkmcnt(0)
    s_barrier
    v_mfma_f32_16x16x32_bf16 v[48:51], v[12:15], v[204:207], v[48:51]
    v_mfma_f32_16x16x32_bf16 v[52:55], v[12:15], v[220:223], v[52:55]
    v_mfma_f32_16x16x32_bf16 v[56:59], v[12:15], v[236:239], v[56:59]
    v_mfma_f32_16x16x32_bf16 v[60:63], v[12:15], v[252:255], v[60:63]
    buffer_load_dwordx4 v[124:127], v69, s[12:15], s20 offen offset:2048 sc1
    buffer_load_dwordx4 v[0:3], v69, s[12:15], s44 offen offset:0
    buffer_load_dwordx4 v[4:7], v69, s[12:15], s44 offen offset:1024
    buffer_load_dwordx4 v[8:11], v69, s[12:15], s45 offen offset:0
    buffer_load_dwordx4 v[12:15], v69, s[12:15], s45 offen offset:1024
    s_waitcnt vmcnt(11)
    s_lshl_b32 s24, s36, 16
    s_and_b32 s25, s36, 0xffff0000
    s_lshl_b32 s26, s37, 16
    s_and_b32 s27, s37, 0xffff0000

    v_mfma_f32_16x16x32_bf16 v[88:91], v[16:19], v[128:131], 0
    v_mfma_f32_16x16x32_bf16 v[92:95], v[16:19], v[144:147], 0
    v_mfma_f32_16x16x32_bf16 v[88:91], v[20:23], v[132:135], v[88:91]
    v_mfma_f32_16x16x32_bf16 v[92:95], v[20:23], v[148:151], v[92:95]
    v_mfma_f32_16x16x32_bf16 v[88:91], v[24:27], v[136:139], v[88:91]
    v_cvt_pk_bf16_f32 v32, v32, v33
    v_mfma_f32_16x16x32_bf16 v[92:95], v[24:27], v[152:155], v[92:95]
    v_cvt_pk_bf16_f32 v33, v34, v35
    v_mfma_f32_16x16x32_bf16 v[88:91], v[28:31], v[140:143], v[88:91]
    ds_write_b64 v70, v[32:33] offset:0
    v_mfma_f32_16x16x32_bf16 v[92:95], v[28:31], v[156:159], v[92:95]
    v_cvt_pk_bf16_f32 v36, v36, v37
    v_mfma_f32_16x16x32_bf16 v[96:99], v[16:19], v[160:163], 0
    v_cvt_pk_bf16_f32 v37, v38, v39
    v_mfma_f32_16x16x32_bf16 v[100:103], v[16:19], v[176:179], 0
    ds_write_b64 v70, v[36:37] offset:128
    v_mfma_f32_16x16x32_bf16 v[96:99], v[20:23], v[164:167], v[96:99]
    v_cvt_pk_bf16_f32 v88, v88, v89
    v_cvt_pk_bf16_f32 v40, v40, v41
    v_mfma_f32_16x16x32_bf16 v[100:103], v[20:23], v[180:183], v[100:103]
    v_cvt_pk_bf16_f32 v89, v90, v91
    v_cvt_pk_bf16_f32 v41, v42, v43
    v_mfma_f32_16x16x32_bf16 v[96:99], v[24:27], v[168:171], v[96:99]
    ds_write_b64 v70, v[88:89] offset:32768
    ds_write_b64 v70, v[40:41] offset:256
    v_mfma_f32_16x16x32_bf16 v[100:103], v[24:27], v[184:187], v[100:103]
    v_cvt_pk_bf16_f32 v92, v92, v93
    v_cvt_pk_bf16_f32 v44, v44, v45
    v_mfma_f32_16x16x32_bf16 v[96:99], v[28:31], v[172:175], v[96:99]
    v_cvt_pk_bf16_f32 v93, v94, v95
    v_cvt_pk_bf16_f32 v45, v46, v47
    v_mfma_f32_16x16x32_bf16 v[100:103], v[28:31], v[188:191], v[100:103]
    ds_write_b64 v70, v[92:93] offset:32896
    ds_write_b64 v70, v[44:45] offset:384
    v_mfma_f32_16x16x32_bf16 v[104:107], v[16:19], v[192:195], 0
    v_cvt_pk_bf16_f32 v48, v48, v49
    v_mfma_f32_16x16x32_bf16 v[108:111], v[16:19], v[208:211], 0
    v_cvt_pk_bf16_f32 v49, v50, v51
    v_mfma_f32_16x16x32_bf16 v[104:107], v[20:23], v[196:199], v[104:107]
    v_cvt_pk_bf16_f32 v96, v96, v97
    ds_write_b64 v70, v[48:49] offset:512
    v_mfma_f32_16x16x32_bf16 v[108:111], v[20:23], v[212:215], v[108:111]
    v_cvt_pk_bf16_f32 v97, v98, v99
    v_cvt_pk_bf16_f32 v52, v52, v53
    v_mfma_f32_16x16x32_bf16 v[104:107], v[24:27], v[200:203], v[104:107]
    ds_write_b64 v70, v[96:97] offset:33024
    v_cvt_pk_bf16_f32 v53, v54, v55
    v_mfma_f32_16x16x32_bf16 v[108:111], v[24:27], v[216:219], v[108:111]
    v_cvt_pk_bf16_f32 v100, v100, v101
    ds_write_b64 v70, v[52:53] offset:640
    v_mfma_f32_16x16x32_bf16 v[104:107], v[28:31], v[204:207], v[104:107]
    v_cvt_pk_bf16_f32 v101, v102, v103
    v_cvt_pk_bf16_f32 v56, v56, v57
    v_mfma_f32_16x16x32_bf16 v[108:111], v[28:31], v[220:223], v[108:111]
    ds_write_b64 v70, v[100:101] offset:33152
    v_cvt_pk_bf16_f32 v57, v58, v59
    v_mfma_f32_16x16x32_bf16 v[88:91], v[16:19], v[224:227], 0
    ds_write_b64 v70, v[56:57] offset:768
    v_mfma_f32_16x16x32_bf16 v[92:95], v[16:19], v[240:243], 0
    v_cvt_pk_bf16_f32 v60, v60, v61
    v_mfma_f32_16x16x32_bf16 v[88:91], v[20:23], v[228:231], v[88:91]
    v_cvt_pk_bf16_f32 v104, v104, v105
    v_cvt_pk_bf16_f32 v61, v62, v63
    v_mfma_f32_16x16x32_bf16 v[92:95], v[20:23], v[244:247], v[92:95]
    v_cvt_pk_bf16_f32 v105, v106, v107
    ds_write_b64 v70, v[60:61] offset:896
    v_mfma_f32_16x16x32_bf16 v[88:91], v[24:27], v[232:235], v[88:91]
    ds_write_b64 v70, v[104:105] offset:33280
    v_mfma_f32_16x16x32_bf16 v[92:95], v[24:27], v[248:251], v[92:95]
    v_cvt_pk_bf16_f32 v108, v108, v109
    v_mfma_f32_16x16x32_bf16 v[88:91], v[28:31], v[236:239], v[88:91]
    v_cvt_pk_bf16_f32 v109, v110, v111
    v_mfma_f32_16x16x32_bf16 v[92:95], v[28:31], v[252:255], v[92:95]
    ds_write_b64 v70, v[108:109] offset:33408
    v_add_u32 v70, 0x8000, v70
    s_waitcnt vmcnt(0)
    v_mfma_f32_16x16x32_bf16 v[96:99], v[0:3], v[128:131], 0
    v_mfma_f32_16x16x32_bf16 v[100:103], v[0:3], v[144:147], 0
    v_mfma_f32_16x16x32_bf16 v[96:99], v[4:7], v[132:135], v[96:99]
    v_cvt_pk_bf16_f32 v88, v88, v89
    v_mfma_f32_16x16x32_bf16 v[100:103], v[4:7], v[148:151], v[100:103]
    v_cvt_pk_bf16_f32 v89, v90, v91
    v_mfma_f32_16x16x32_bf16 v[96:99], v[8:11], v[136:139], v[96:99]
    ds_write_b64 v70, v[88:89] offset:768
    v_mov_b32 v16, s24
    v_mov_b32 v40, s24
    v_mfma_f32_16x16x32_bf16 v[100:103], v[8:11], v[152:155], v[100:103]
    v_cvt_pk_bf16_f32 v92, v92, v93
    v_mov_b32 v17, s25
    v_mov_b32 v41, s25
    v_mfma_f32_16x16x32_bf16 v[96:99], v[12:15], v[140:143], v[96:99]
    v_cvt_pk_bf16_f32 v93, v94, v95
    v_mov_b32 v18, s26
    v_mov_b32 v42, s26
    v_mfma_f32_16x16x32_bf16 v[100:103], v[12:15], v[156:159], v[100:103]
    ds_write_b64 v70, v[92:93] offset:896
    v_mov_b32 v19, s27
    v_mov_b32 v43, s27
    v_mfma_f32_16x16x32_bf16 v[104:107], v[0:3], v[160:163], 0
    v_mov_b32 v20, s24
    v_mov_b32 v44, s24
    v_mfma_f32_16x16x32_bf16 v[108:111], v[0:3], v[176:179], 0
    v_mov_b32 v21, s25
    v_mov_b32 v45, s25
    v_mfma_f32_16x16x32_bf16 v[104:107], v[4:7], v[164:167], v[104:107]
    v_cvt_pk_bf16_f32 v96, v96, v97
    v_mov_b32 v22, s26
    v_mov_b32 v46, s26
    v_mfma_f32_16x16x32_bf16 v[108:111], v[4:7], v[180:183], v[108:111]
    v_cvt_pk_bf16_f32 v97, v98, v99
    v_mov_b32 v23, s27
    v_mov_b32 v47, s27
    v_mfma_f32_16x16x32_bf16 v[104:107], v[8:11], v[168:171], v[104:107]
    ds_write_b64 v70, v[96:97] offset:32768
    v_mov_b32 v24, s24
    v_mov_b32 v48, s24
    v_mfma_f32_16x16x32_bf16 v[108:111], v[8:11], v[184:187], v[108:111]
    v_cvt_pk_bf16_f32 v100, v100, v101
    v_mov_b32 v25, s25
    v_mov_b32 v49, s25
    v_mfma_f32_16x16x32_bf16 v[104:107], v[12:15], v[172:175], v[104:107]
    v_cvt_pk_bf16_f32 v101, v102, v103
    v_mov_b32 v26, s26
    v_mov_b32 v50, s26
    v_mfma_f32_16x16x32_bf16 v[108:111], v[12:15], v[188:191], v[108:111]
    ds_write_b64 v70, v[100:101] offset:32896
    v_mov_b32 v27, s27
    v_mov_b32 v51, s27
    v_mfma_f32_16x16x32_bf16 v[88:91], v[0:3], v[192:195], 0
    v_mov_b32 v28, s24
    v_mov_b32 v52, s24
    v_mfma_f32_16x16x32_bf16 v[92:95], v[0:3], v[208:211], 0
    v_mov_b32 v29, s25
    v_mov_b32 v53, s25
    v_mfma_f32_16x16x32_bf16 v[88:91], v[4:7], v[196:199], v[88:91]
    v_cvt_pk_bf16_f32 v104, v104, v105
    v_mov_b32 v30, s26
    v_mov_b32 v54, s26
    v_mfma_f32_16x16x32_bf16 v[92:95], v[4:7], v[212:215], v[92:95]
    v_cvt_pk_bf16_f32 v105, v106, v107
    v_mov_b32 v31, s27
    v_mov_b32 v55, s27
    v_mfma_f32_16x16x32_bf16 v[88:91], v[8:11], v[200:203], v[88:91]
    ds_write_b64 v70, v[104:105] offset:33024
    v_mov_b32 v32, s24
    v_mov_b32 v56, s24
    v_mfma_f32_16x16x32_bf16 v[92:95], v[8:11], v[216:219], v[92:95]
    v_cvt_pk_bf16_f32 v108, v108, v109
    v_mov_b32 v33, s25
    v_mov_b32 v57, s25
    v_mfma_f32_16x16x32_bf16 v[88:91], v[12:15], v[204:207], v[88:91]
    v_cvt_pk_bf16_f32 v109, v110, v111
    v_mov_b32 v34, s26
    v_mov_b32 v58, s26
    v_mfma_f32_16x16x32_bf16 v[92:95], v[12:15], v[220:223], v[92:95]
    ds_write_b64 v70, v[108:109] offset:33152
    v_mov_b32 v35, s27
    v_mov_b32 v59, s27
    v_mfma_f32_16x16x32_bf16 v[96:99], v[0:3], v[224:227], 0
    v_mov_b32 v36, s24
    v_mov_b32 v60, s24
    v_mfma_f32_16x16x32_bf16 v[100:103], v[0:3], v[240:243], 0
    v_mov_b32 v37, s25
    v_mov_b32 v61, s25
    v_mfma_f32_16x16x32_bf16 v[96:99], v[4:7], v[228:231], v[96:99]
    v_cvt_pk_bf16_f32 v88, v88, v89
    v_mov_b32 v38, s26
    v_mov_b32 v62, s26
    v_mfma_f32_16x16x32_bf16 v[100:103], v[4:7], v[244:247], v[100:103]
    v_cvt_pk_bf16_f32 v89, v90, v91
    v_mov_b32 v39, s27
    v_mov_b32 v63, s27
    v_mfma_f32_16x16x32_bf16 v[96:99], v[8:11], v[232:235], v[96:99]
    ds_write_b64 v70, v[88:89] offset:33280
    s_nop 0
    v_mfma_f32_16x16x32_bf16 v[100:103], v[8:11], v[248:251], v[100:103]
    v_cvt_pk_bf16_f32 v92, v92, v93
    s_nop 0
    v_mfma_f32_16x16x32_bf16 v[96:99], v[12:15], v[236:239], v[96:99]
    v_cvt_pk_bf16_f32 v93, v94, v95
    s_nop 0
    v_mfma_f32_16x16x32_bf16 v[100:103], v[12:15], v[252:255], v[100:103]
    ds_write_b64 v70, v[92:93] offset:33408
    s_nop 0
    v_mov_b32 v0, s24
    v_mov_b32 v1, s25
    v_mov_b32 v2, s26
    v_mov_b32 v3, s27
    v_mov_b32 v4, s24
    v_mov_b32 v5, s25
    v_mov_b32 v6, s26
    v_mov_b32 v7, s27
    v_mov_b32 v8, s24
    v_mov_b32 v9, s25
    v_mov_b32 v10, s26
    v_mov_b32 v11, s27
    v_mov_b32 v12, s24
    v_mov_b32 v13, s25
    v_mov_b32 v14, s26
    v_mov_b32 v15, s27
    s_nop 7
    v_cvt_pk_bf16_f32 v96, v96, v97
    v_cvt_pk_bf16_f32 v97, v98, v99
    ds_write_b64 v70, v[96:97] offset:33536
    v_cvt_pk_bf16_f32 v100, v100, v101
    v_cvt_pk_bf16_f32 v101, v102, v103
    ds_write_b64 v70, v[100:101] offset:33664
    v_add_u32 v70, 0x10000, v70
    s_branch k1_kernel_k2j
k1_kernel_k2m:
    buffer_load_dwordx4 v[0:3], v69, s[12:15], s21 offen offset:0
    buffer_load_dwordx4 v[4:7], v69, s[12:15], s21 offen offset:1024
    buffer_load_dwordx4 v[8:11], v69, s[12:15], s19 offen offset:0
    buffer_load_dwordx4 v[12:15], v69, s[12:15], s19 offen offset:1024
    s_add_u32 s21, s21, 4096
    s_add_u32 s19, s19, 4096
    buffer_load_dwordx4 v[16:19], v69, s[12:15], s21 offen offset:0
    buffer_load_dwordx4 v[20:23], v69, s[12:15], s21 offen offset:1024
    buffer_load_dwordx4 v[24:27], v69, s[12:15], s19 offen offset:0
    buffer_load_dwordx4 v[28:31], v69, s[12:15], s19 offen offset:1024
    s_add_u32 s21, s21, 4096
    s_add_u32 s19, s19, 4096
    s_mov_b32 s44, s21
    s_mov_b32 s45, s19
    s_add_u32 s21, s21, 4096
    s_add_u32 s19, s19, 4096
    buffer_load_dwordx4 v[72:75], v69, s[12:15], s21 offen offset:0
    buffer_load_dwordx4 v[76:79], v69, s[12:15], s21 offen offset:1024
    buffer_load_dwordx4 v[80:83], v69, s[12:15], s19 offen offset:0
    buffer_load_dwordx4 v[84:87], v69, s[12:15], s19 offen offset:1024
    s_add_u32 s21, s21, 4096
    s_add_u32 s19, s19, 4096
    buffer_load_dwordx4 v[116:119], v69, s[12:15], s20 offen offset:0 sc1
    buffer_load_dwordx4 v[120:123], v69, s[12:15], s20 offen offset:1024 sc1
    buffer_load_dwordx4 v[124:127], v69, s[12:15], s20 offen offset:2048 sc1
    buffer_load_dwordx4 v[32:35], v69, s[12:15], s44 offen offset:0
    buffer_load_dwordx4 v[36:39], v69, s[12:15], s44 offen offset:1024
    buffer_load_dwordx4 v[40:43], v69, s[12:15], s45 offen offset:0
    buffer_load_dwordx4 v[44:47], v69, s[12:15], s45 offen offset:1024
    s_mov_b32 exec_lo, 0x00ff00ff
    s_mov_b32 exec_hi, 0x00ff00ff
    buffer_store_dword v112, v113, s[12:15], s74 offen sc1
    s_mov_b64 exec, -1
    s_waitcnt lgkmcnt(0)
    s_barrier
    ds_read_b128 v[136:139], v71 offset:0
    ds_read_b128 v[140:143], v71 offset:1024
    ds_read_b128 v[152:155], v71 offset:2048
    ds_read_b128 v[156:159], v71 offset:3072
    ds_read_b128 v[168:171], v71 offset:4096
    ds_read_b128 v[172:175], v71 offset:5120
    ds_read_b128 v[184:187], v71 offset:6144
    ds_read_b128 v[188:191], v71 offset:7168
    ds_read_b128 v[200:203], v71 offset:8192
    ds_read_b128 v[204:207], v71 offset:9216
    ds_read_b128 v[216:219], v71 offset:10240
    ds_read_b128 v[220:223], v71 offset:11264
    ds_read_b128 v[232:235], v71 offset:12288
    ds_read_b128 v[236:239], v71 offset:13312
    ds_read_b128 v[248:251], v71 offset:14336
    ds_read_b128 v[252:255], v71 offset:15360
    s_waitcnt vmcnt(16)
    v_mfma_f32_16x16x32_bf16 v[48:51], v[0:3], v[128:131], 0
    v_mfma_f32_16x16x32_bf16 v[52:55], v[0:3], v[144:147], 0
    v_mfma_f32_16x16x32_bf16 v[56:59], v[0:3], v[160:163], 0
    v_mfma_f32_16x16x32_bf16 v[60:63], v[0:3], v[176:179], 0
    v_mfma_f32_16x16x32_bf16 v[88:91], v[0:3], v[192:195], 0
    v_mfma_f32_16x16x32_bf16 v[92:95], v[0:3], v[208:211], 0
    v_mfma_f32_16x16x32_bf16 v[96:99], v[0:3], v[224:227], 0
    v_mfma_f32_16x16x32_bf16 v[100:103], v[0:3], v[240:243], 0
    v_mfma_f32_16x16x32_bf16 v[48:51], v[4:7], v[132:135], v[48:51]
    v_mfma_f32_16x16x32_bf16 v[52:55], v[4:7], v[148:151], v[52:55]
    v_mfma_f32_16x16x32_bf16 v[56:59], v[4:7], v[164:167], v[56:59]
    v_mfma_f32_16x16x32_bf16 v[60:63], v[4:7], v[180:183], v[60:63]
    v_mfma_f32_16x16x32_bf16 v[88:91], v[4:7], v[196:199], v[88:91]
    v_mfma_f32_16x16x32_bf16 v[92:95], v[4:7], v[212:215], v[92:95]
    v_mfma_f32_16x16x32_bf16 v[96:99], v[4:7], v[228:231], v[96:99]
    v_mfma_f32_16x16x32_bf16 v[100:103], v[4:7], v[244:247], v[100:103]

    s_lshl_b32 s24, s36, 16
    s_and_b32 s25, s36, 0xffff0000
    s_lshl_b32 s26, s37, 16
    s_and_b32 s27, s37, 0xffff0000

    s_waitcnt lgkmcnt(12)
    v_mfma_f32_16x16x32_bf16 v[48:51], v[8:11], v[136:139], v[48:51]
    v_mfma_f32_16x16x32_bf16 v[52:55], v[8:11], v[152:155], v[52:55]
    v_mfma_f32_16x16x32_bf16 v[48:51], v[12:15], v[140:143], v[48:51]
    v_mfma_f32_16x16x32_bf16 v[52:55], v[12:15], v[156:159], v[52:55]
    s_waitcnt lgkmcnt(8)
    v_mfma_f32_16x16x32_bf16 v[56:59], v[8:11], v[168:171], v[56:59]
    v_mfma_f32_16x16x32_bf16 v[60:63], v[8:11], v[184:187], v[60:63]
    v_mfma_f32_16x16x32_bf16 v[56:59], v[12:15], v[172:175], v[56:59]
    v_mfma_f32_16x16x32_bf16 v[60:63], v[12:15], v[188:191], v[60:63]
    s_waitcnt lgkmcnt(4)
    v_mfma_f32_16x16x32_bf16 v[88:91], v[8:11], v[200:203], v[88:91]
    v_mfma_f32_16x16x32_bf16 v[92:95], v[8:11], v[216:219], v[92:95]
    v_mfma_f32_16x16x32_bf16 v[88:91], v[12:15], v[204:207], v[88:91]
    v_mfma_f32_16x16x32_bf16 v[92:95], v[12:15], v[220:223], v[92:95]
    v_cvt_pk_bf16_f32 v48, v48, v49
    v_cvt_pk_bf16_f32 v49, v50, v51
    ds_write_b64 v70, v[48:49] offset:0
    v_cvt_pk_bf16_f32 v52, v52, v53
    v_cvt_pk_bf16_f32 v53, v54, v55
    ds_write_b64 v70, v[52:53] offset:128
    s_waitcnt lgkmcnt(2)
    v_mfma_f32_16x16x32_bf16 v[96:99], v[8:11], v[232:235], v[96:99]
    v_mfma_f32_16x16x32_bf16 v[100:103], v[8:11], v[248:251], v[100:103]
    v_mfma_f32_16x16x32_bf16 v[96:99], v[12:15], v[236:239], v[96:99]
    v_mfma_f32_16x16x32_bf16 v[100:103], v[12:15], v[252:255], v[100:103]
    v_cvt_pk_bf16_f32 v56, v56, v57
    v_cvt_pk_bf16_f32 v57, v58, v59
    ds_write_b64 v70, v[56:57] offset:256
    v_cvt_pk_bf16_f32 v60, v60, v61
    v_cvt_pk_bf16_f32 v61, v62, v63
    ds_write_b64 v70, v[60:61] offset:384
    s_nop 3
    v_cvt_pk_bf16_f32 v88, v88, v89
    v_cvt_pk_bf16_f32 v89, v90, v91
    ds_write_b64 v70, v[88:89] offset:512
    v_cvt_pk_bf16_f32 v92, v92, v93
    v_cvt_pk_bf16_f32 v93, v94, v95
    ds_write_b64 v70, v[92:93] offset:640
    s_nop 3
    v_cvt_pk_bf16_f32 v96, v96, v97
    v_cvt_pk_bf16_f32 v97, v98, v99
    ds_write_b64 v70, v[96:97] offset:768
    v_cvt_pk_bf16_f32 v100, v100, v101
    v_cvt_pk_bf16_f32 v101, v102, v103
    ds_write_b64 v70, v[100:101] offset:896
    v_add_u32 v70, 0x8000, v70
    s_waitcnt vmcnt(12)
    v_mfma_f32_16x16x32_bf16 v[104:107], v[16:19], v[128:131], 0
    v_mfma_f32_16x16x32_bf16 v[108:111], v[16:19], v[144:147], 0
    v_mfma_f32_16x16x32_bf16 v[104:107], v[20:23], v[132:135], v[104:107]
    v_mfma_f32_16x16x32_bf16 v[108:111], v[20:23], v[148:151], v[108:111]
    v_mfma_f32_16x16x32_bf16 v[104:107], v[24:27], v[136:139], v[104:107]
    v_mov_b32 v48, s24
    v_mfma_f32_16x16x32_bf16 v[108:111], v[24:27], v[152:155], v[108:111]
    v_mov_b32 v49, s25
    v_mfma_f32_16x16x32_bf16 v[104:107], v[28:31], v[140:143], v[104:107]
    v_mov_b32 v50, s26
    v_mfma_f32_16x16x32_bf16 v[108:111], v[28:31], v[156:159], v[108:111]
    v_mov_b32 v51, s27
    v_mfma_f32_16x16x32_bf16 v[88:91], v[16:19], v[160:163], 0
    v_mov_b32 v52, s24
    v_mfma_f32_16x16x32_bf16 v[92:95], v[16:19], v[176:179], 0
    v_mov_b32 v53, s25
    v_mfma_f32_16x16x32_bf16 v[88:91], v[20:23], v[164:167], v[88:91]
    v_cvt_pk_bf16_f32 v104, v104, v105
    v_mov_b32 v54, s26
    v_mfma_f32_16x16x32_bf16 v[92:95], v[20:23], v[180:183], v[92:95]
    v_cvt_pk_bf16_f32 v105, v106, v107
    v_mov_b32 v55, s27
    v_mfma_f32_16x16x32_bf16 v[88:91], v[24:27], v[168:171], v[88:91]
    ds_write_b64 v70, v[104:105] offset:0
    v_mov_b32 v56, s24
    v_mfma_f32_16x16x32_bf16 v[92:95], v[24:27], v[184:187], v[92:95]
    v_cvt_pk_bf16_f32 v108, v108, v109
    v_mov_b32 v57, s25
    v_mfma_f32_16x16x32_bf16 v[88:91], v[28:31], v[172:175], v[88:91]
    v_cvt_pk_bf16_f32 v109, v110, v111
    v_mov_b32 v58, s26
    v_mfma_f32_16x16x32_bf16 v[92:95], v[28:31], v[188:191], v[92:95]
    ds_write_b64 v70, v[108:109] offset:128
    v_mov_b32 v59, s27
    v_mfma_f32_16x16x32_bf16 v[96:99], v[16:19], v[192:195], 0
    v_mov_b32 v60, s24
    v_mfma_f32_16x16x32_bf16 v[100:103], v[16:19], v[208:211], 0
    v_mov_b32 v61, s25
    v_mfma_f32_16x16x32_bf16 v[96:99], v[20:23], v[196:199], v[96:99]
    v_cvt_pk_bf16_f32 v88, v88, v89
    v_mov_b32 v62, s26
    v_mfma_f32_16x16x32_bf16 v[100:103], v[20:23], v[212:215], v[100:103]
    v_cvt_pk_bf16_f32 v89, v90, v91
    v_mov_b32 v63, s27
    v_mfma_f32_16x16x32_bf16 v[96:99], v[24:27], v[200:203], v[96:99]
    ds_write_b64 v70, v[88:89] offset:256
    v_mov_b32 v0, s24
    v_mfma_f32_16x16x32_bf16 v[100:103], v[24:27], v[216:219], v[100:103]
    v_cvt_pk_bf16_f32 v92, v92, v93
    v_mov_b32 v1, s25
    v_mfma_f32_16x16x32_bf16 v[96:99], v[28:31], v[204:207], v[96:99]
    v_cvt_pk_bf16_f32 v93, v94, v95
    v_mov_b32 v2, s26
    v_mfma_f32_16x16x32_bf16 v[100:103], v[28:31], v[220:223], v[100:103]
    ds_write_b64 v70, v[92:93] offset:384
    v_mov_b32 v3, s27
    v_mfma_f32_16x16x32_bf16 v[104:107], v[16:19], v[224:227], 0
    v_mov_b32 v4, s24
    v_mfma_f32_16x16x32_bf16 v[108:111], v[16:19], v[240:243], 0
    v_mov_b32 v5, s25
    v_mfma_f32_16x16x32_bf16 v[104:107], v[20:23], v[228:231], v[104:107]
    v_cvt_pk_bf16_f32 v96, v96, v97
    v_mov_b32 v6, s26
    v_mfma_f32_16x16x32_bf16 v[108:111], v[20:23], v[244:247], v[108:111]
    v_cvt_pk_bf16_f32 v97, v98, v99
    v_mov_b32 v7, s27
    v_mfma_f32_16x16x32_bf16 v[104:107], v[24:27], v[232:235], v[104:107]
    ds_write_b64 v70, v[96:97] offset:512
    v_mov_b32 v8, s24
    v_mfma_f32_16x16x32_bf16 v[108:111], v[24:27], v[248:251], v[108:111]
    v_cvt_pk_bf16_f32 v100, v100, v101
    v_mov_b32 v9, s25
    v_mfma_f32_16x16x32_bf16 v[104:107], v[28:31], v[236:239], v[104:107]
    v_cvt_pk_bf16_f32 v101, v102, v103
    v_mov_b32 v10, s26
    v_mfma_f32_16x16x32_bf16 v[108:111], v[28:31], v[252:255], v[108:111]
    ds_write_b64 v70, v[100:101] offset:640
    v_mov_b32 v11, s27
    s_waitcnt vmcnt(1)
    v_mfma_f32_16x16x32_bf16 v[88:91], v[32:35], v[128:131], 0
    v_mfma_f32_16x16x32_bf16 v[92:95], v[32:35], v[144:147], 0
    v_mfma_f32_16x16x32_bf16 v[88:91], v[36:39], v[132:135], v[88:91]
    v_cvt_pk_bf16_f32 v104, v104, v105
    v_mfma_f32_16x16x32_bf16 v[92:95], v[36:39], v[148:151], v[92:95]
    v_cvt_pk_bf16_f32 v105, v106, v107
    v_mfma_f32_16x16x32_bf16 v[88:91], v[40:43], v[136:139], v[88:91]
    ds_write_b64 v70, v[104:105] offset:768
    v_mov_b32 v12, s24
    v_mfma_f32_16x16x32_bf16 v[92:95], v[40:43], v[152:155], v[92:95]
    v_cvt_pk_bf16_f32 v108, v108, v109
    v_mov_b32 v13, s25
    v_mfma_f32_16x16x32_bf16 v[88:91], v[44:47], v[140:143], v[88:91]
    v_cvt_pk_bf16_f32 v109, v110, v111
    v_mov_b32 v14, s26
    v_mfma_f32_16x16x32_bf16 v[92:95], v[44:47], v[156:159], v[92:95]
    ds_write_b64 v70, v[108:109] offset:896
    v_mov_b32 v15, s27
    v_mfma_f32_16x16x32_bf16 v[96:99], v[32:35], v[160:163], 0
    v_mov_b32 v16, s24
    v_mfma_f32_16x16x32_bf16 v[100:103], v[32:35], v[176:179], 0
    v_mov_b32 v17, s25
    v_mfma_f32_16x16x32_bf16 v[96:99], v[36:39], v[164:167], v[96:99]
    v_cvt_pk_bf16_f32 v88, v88, v89
    v_mov_b32 v18, s26
    v_mfma_f32_16x16x32_bf16 v[100:103], v[36:39], v[180:183], v[100:103]
    v_cvt_pk_bf16_f32 v89, v90, v91
    v_mov_b32 v19, s27
    v_mfma_f32_16x16x32_bf16 v[96:99], v[40:43], v[168:171], v[96:99]
    ds_write_b64 v70, v[88:89] offset:32768
    v_mov_b32 v20, s24
    v_mfma_f32_16x16x32_bf16 v[100:103], v[40:43], v[184:187], v[100:103]
    v_cvt_pk_bf16_f32 v92, v92, v93
    v_mov_b32 v21, s25
    v_mfma_f32_16x16x32_bf16 v[96:99], v[44:47], v[172:175], v[96:99]
    v_cvt_pk_bf16_f32 v93, v94, v95
    v_mov_b32 v22, s26
    v_mfma_f32_16x16x32_bf16 v[100:103], v[44:47], v[188:191], v[100:103]
    ds_write_b64 v70, v[92:93] offset:32896
    v_mov_b32 v23, s27
    v_mfma_f32_16x16x32_bf16 v[104:107], v[32:35], v[192:195], 0
    v_mov_b32 v24, s24
    v_mfma_f32_16x16x32_bf16 v[108:111], v[32:35], v[208:211], 0
    v_mov_b32 v25, s25
    v_mfma_f32_16x16x32_bf16 v[104:107], v[36:39], v[196:199], v[104:107]
    v_cvt_pk_bf16_f32 v96, v96, v97
    v_mov_b32 v26, s26
    v_mfma_f32_16x16x32_bf16 v[108:111], v[36:39], v[212:215], v[108:111]
    v_cvt_pk_bf16_f32 v97, v98, v99
    v_mov_b32 v27, s27
    v_mfma_f32_16x16x32_bf16 v[104:107], v[40:43], v[200:203], v[104:107]
    ds_write_b64 v70, v[96:97] offset:33024
    v_mov_b32 v28, s24
    v_mfma_f32_16x16x32_bf16 v[108:111], v[40:43], v[216:219], v[108:111]
    v_cvt_pk_bf16_f32 v100, v100, v101
    v_mov_b32 v29, s25
    v_mfma_f32_16x16x32_bf16 v[104:107], v[44:47], v[204:207], v[104:107]
    v_cvt_pk_bf16_f32 v101, v102, v103
    v_mov_b32 v30, s26
    v_mfma_f32_16x16x32_bf16 v[108:111], v[44:47], v[220:223], v[108:111]
    ds_write_b64 v70, v[100:101] offset:33152
    v_mov_b32 v31, s27
    v_mfma_f32_16x16x32_bf16 v[88:91], v[32:35], v[224:227], 0
    s_nop 0
    v_mfma_f32_16x16x32_bf16 v[92:95], v[32:35], v[240:243], 0
    s_nop 0
    v_mfma_f32_16x16x32_bf16 v[88:91], v[36:39], v[228:231], v[88:91]
    v_cvt_pk_bf16_f32 v104, v104, v105
    s_nop 0
    v_mfma_f32_16x16x32_bf16 v[92:95], v[36:39], v[244:247], v[92:95]
    v_cvt_pk_bf16_f32 v105, v106, v107
    s_nop 0
    v_mfma_f32_16x16x32_bf16 v[88:91], v[40:43], v[232:235], v[88:91]
    ds_write_b64 v70, v[104:105] offset:33280
    s_nop 0
    v_mfma_f32_16x16x32_bf16 v[92:95], v[40:43], v[248:251], v[92:95]
    v_cvt_pk_bf16_f32 v108, v108, v109
    s_nop 0
    v_mfma_f32_16x16x32_bf16 v[88:91], v[44:47], v[236:239], v[88:91]
    v_cvt_pk_bf16_f32 v109, v110, v111
    s_nop 0
    v_mfma_f32_16x16x32_bf16 v[92:95], v[44:47], v[252:255], v[92:95]
    ds_write_b64 v70, v[108:109] offset:33408
    s_nop 0
    v_mov_b32 v32, s24
    v_mov_b32 v33, s25
    v_mov_b32 v34, s26
    v_mov_b32 v35, s27
    v_mov_b32 v36, s24
    v_mov_b32 v37, s25
    v_mov_b32 v38, s26
    v_mov_b32 v39, s27
    v_mov_b32 v40, s24
    v_mov_b32 v41, s25
    v_mov_b32 v42, s26
    v_mov_b32 v43, s27
    v_mov_b32 v44, s24
    v_mov_b32 v45, s25
    v_mov_b32 v46, s26
    v_mov_b32 v47, s27
    s_nop 7
    v_cvt_pk_bf16_f32 v88, v88, v89
    v_cvt_pk_bf16_f32 v89, v90, v91
    ds_write_b64 v70, v[88:89] offset:33536
    v_cvt_pk_bf16_f32 v92, v92, v93
    v_cvt_pk_bf16_f32 v93, v94, v95
    ds_write_b64 v70, v[92:93] offset:33664
    v_add_u32 v70, 0x10000, v70
k1_kernel_k2j:

    s_mov_b32 s22, 0
    s_mov_b32 s23, 3
    s_waitcnt lgkmcnt(0)
    s_barrier

    v_lshlrev_b32_sdwa v88, 3, v116 dst_sel:DWORD dst_unused:UNUSED_PAD src0_sel:DWORD src1_sel:WORD_0
    v_lshlrev_b32_sdwa v90, 3, v116 dst_sel:DWORD dst_unused:UNUSED_PAD src0_sel:DWORD src1_sel:WORD_1
    v_lshlrev_b32_sdwa v92, 3, v117 dst_sel:DWORD dst_unused:UNUSED_PAD src0_sel:DWORD src1_sel:WORD_0
    v_lshlrev_b32_sdwa v94, 3, v117 dst_sel:DWORD dst_unused:UNUSED_PAD src0_sel:DWORD src1_sel:WORD_1
    ds_read_b64 v[88:89], v88
    ds_read_b64 v[90:91], v90
    ds_read_b64 v[92:93], v92
    ds_read_b64 v[94:95], v94
    v_lshlrev_b32_sdwa v96, 3, v118 dst_sel:DWORD dst_unused:UNUSED_PAD src0_sel:DWORD src1_sel:WORD_0
    v_lshlrev_b32_sdwa v98, 3, v118 dst_sel:DWORD dst_unused:UNUSED_PAD src0_sel:DWORD src1_sel:WORD_1
    v_lshlrev_b32_sdwa v100, 3, v119 dst_sel:DWORD dst_unused:UNUSED_PAD src0_sel:DWORD src1_sel:WORD_0
    v_lshlrev_b32_sdwa v102, 3, v119 dst_sel:DWORD dst_unused:UNUSED_PAD src0_sel:DWORD src1_sel:WORD_1
    ds_read_b64 v[96:97], v96
    ds_read_b64 v[98:99], v98
    ds_read_b64 v[100:101], v100
    ds_read_b64 v[102:103], v102
    buffer_load_dwordx4 v[116:119], v69, s[12:15], s20 offen offset:3072 sc1
    s_add_u32 s20, s20, 4096
k1_kernel_gloop:
    s_setprio 3
    s_waitcnt vmcnt(6)
    v_lshlrev_b32_sdwa v104, 3, v120 dst_sel:DWORD dst_unused:UNUSED_PAD src0_sel:DWORD src1_sel:WORD_0
    v_lshlrev_b32_sdwa v106, 3, v120 dst_sel:DWORD dst_unused:UNUSED_PAD src0_sel:DWORD src1_sel:WORD_1
    ds_read_b64 v[104:105], v104
    ds_read_b64 v[106:107], v106
    v_lshlrev_b32_sdwa v108, 3, v121 dst_sel:DWORD dst_unused:UNUSED_PAD src0_sel:DWORD src1_sel:WORD_0
    v_lshlrev_b32_sdwa v110, 3, v121 dst_sel:DWORD dst_unused:UNUSED_PAD src0_sel:DWORD src1_sel:WORD_1
    ds_read_b64 v[108:109], v108
    ds_read_b64 v[110:111], v110
    s_waitcnt lgkmcnt(8)
    v_smfmac_f32_16x16x64_bf16 v[0:3], v[64:67], v[88:95], v68
    s_waitcnt vmcnt(5)
    v_mfma_f32_16x16x32_bf16 v[112:115], v[72:75], v[128:131], 0
    v_lshlrev_b32_sdwa v88, 3, v122 dst_sel:DWORD dst_unused:UNUSED_PAD src0_sel:DWORD src1_sel:WORD_0
    v_lshlrev_b32_sdwa v90, 3, v122 dst_sel:DWORD dst_unused:UNUSED_PAD src0_sel:DWORD src1_sel:WORD_1
    ds_read_b64 v[88:89], v88
    ds_read_b64 v[90:91], v90
    s_waitcnt vmcnt(4)
    v_mfma_f32_16x16x32_bf16 v[112:115], v[76:79], v[132:135], v[112:115]
    v_lshlrev_b32_sdwa v92, 3, v123 dst_sel:DWORD dst_unused:UNUSED_PAD src0_sel:DWORD src1_sel:WORD_0
    v_lshlrev_b32_sdwa v94, 3, v123 dst_sel:DWORD dst_unused:UNUSED_PAD src0_sel:DWORD src1_sel:WORD_1
    ds_read_b64 v[92:93], v92
    ds_read_b64 v[94:95], v94
    buffer_load_dwordx4 v[120:123], v69, s[12:15], s20 offen offset:0 sc1
    s_waitcnt lgkmcnt(8)
    v_smfmac_f32_16x16x64_bf16 v[4:7], v[64:67], v[96:103], v68
    s_waitcnt vmcnt(4)
    v_mfma_f32_16x16x32_bf16 v[112:115], v[80:83], v[136:139], v[112:115]
    s_waitcnt vmcnt(2)
    v_lshlrev_b32_sdwa v96, 3, v124 dst_sel:DWORD dst_unused:UNUSED_PAD src0_sel:DWORD src1_sel:WORD_0
    v_lshlrev_b32_sdwa v98, 3, v124 dst_sel:DWORD dst_unused:UNUSED_PAD src0_sel:DWORD src1_sel:WORD_1
    ds_read_b64 v[96:97], v96
    ds_read_b64 v[98:99], v98
    s_waitcnt vmcnt(3)
    v_mfma_f32_16x16x32_bf16 v[112:115], v[84:87], v[140:143], v[112:115]
    v_lshlrev_b32_sdwa v100, 3, v125 dst_sel:DWORD dst_unused:UNUSED_PAD src0_sel:DWORD src1_sel:WORD_0
    v_lshlrev_b32_sdwa v102, 3, v125 dst_sel:DWORD dst_unused:UNUSED_PAD src0_sel:DWORD src1_sel:WORD_1
    ds_read_b64 v[100:101], v100
    ds_read_b64 v[102:103], v102
    s_waitcnt lgkmcnt(8)
    v_smfmac_f32_16x16x64_bf16 v[8:11], v[64:67], v[104:111], v68
    s_nop 1
    v_cvt_pk_bf16_f32 v112, v112, v113
    v_cvt_pk_bf16_f32 v113, v114, v115
    ds_write_b64 v70, v[112:113] offset:0
    v_mfma_f32_16x16x32_bf16 v[112:115], v[72:75], v[144:147], 0
    v_mfma_f32_16x16x32_bf16 v[112:115], v[76:79], v[148:151], v[112:115]
    v_lshlrev_b32_sdwa v104, 3, v126 dst_sel:DWORD dst_unused:UNUSED_PAD src0_sel:DWORD src1_sel:WORD_0
    v_lshlrev_b32_sdwa v106, 3, v126 dst_sel:DWORD dst_unused:UNUSED_PAD src0_sel:DWORD src1_sel:WORD_1
    ds_read_b64 v[104:105], v104
    ds_read_b64 v[106:107], v106
    v_mfma_f32_16x16x32_bf16 v[112:115], v[80:83], v[152:155], v[112:115]
    v_mfma_f32_16x16x32_bf16 v[112:115], v[84:87], v[156:159], v[112:115]
    v_lshlrev_b32_sdwa v108, 3, v127 dst_sel:DWORD dst_unused:UNUSED_PAD src0_sel:DWORD src1_sel:WORD_0
    v_lshlrev_b32_sdwa v110, 3, v127 dst_sel:DWORD dst_unused:UNUSED_PAD src0_sel:DWORD src1_sel:WORD_1
    ds_read_b64 v[108:109], v108
    ds_read_b64 v[110:111], v110
    buffer_load_dwordx4 v[124:127], v69, s[12:15], s20 offen offset:1024 sc1
    s_waitcnt lgkmcnt(9)
    v_smfmac_f32_16x16x64_bf16 v[12:15], v[64:67], v[88:95], v68
    s_nop 0
    v_cvt_pk_bf16_f32 v112, v112, v113
    v_cvt_pk_bf16_f32 v113, v114, v115
    ds_write_b64 v70, v[112:113] offset:128
    v_mfma_f32_16x16x32_bf16 v[112:115], v[72:75], v[160:163], 0
    s_waitcnt vmcnt(2)
    v_lshlrev_b32_sdwa v88, 3, v116 dst_sel:DWORD dst_unused:UNUSED_PAD src0_sel:DWORD src1_sel:WORD_0
    v_lshlrev_b32_sdwa v90, 3, v116 dst_sel:DWORD dst_unused:UNUSED_PAD src0_sel:DWORD src1_sel:WORD_1
    ds_read_b64 v[88:89], v88
    ds_read_b64 v[90:91], v90
    v_mfma_f32_16x16x32_bf16 v[112:115], v[76:79], v[164:167], v[112:115]
    v_lshlrev_b32_sdwa v92, 3, v117 dst_sel:DWORD dst_unused:UNUSED_PAD src0_sel:DWORD src1_sel:WORD_0
    v_lshlrev_b32_sdwa v94, 3, v117 dst_sel:DWORD dst_unused:UNUSED_PAD src0_sel:DWORD src1_sel:WORD_1
    ds_read_b64 v[92:93], v92
    ds_read_b64 v[94:95], v94
    s_waitcnt lgkmcnt(10)
    v_smfmac_f32_16x16x64_bf16 v[16:19], v[64:67], v[96:103], v68
    v_mfma_f32_16x16x32_bf16 v[112:115], v[80:83], v[168:171], v[112:115]
    v_lshlrev_b32_sdwa v96, 3, v118 dst_sel:DWORD dst_unused:UNUSED_PAD src0_sel:DWORD src1_sel:WORD_0
    v_lshlrev_b32_sdwa v98, 3, v118 dst_sel:DWORD dst_unused:UNUSED_PAD src0_sel:DWORD src1_sel:WORD_1
    ds_read_b64 v[96:97], v96
    ds_read_b64 v[98:99], v98
    v_mfma_f32_16x16x32_bf16 v[112:115], v[84:87], v[172:175], v[112:115]
    v_lshlrev_b32_sdwa v100, 3, v119 dst_sel:DWORD dst_unused:UNUSED_PAD src0_sel:DWORD src1_sel:WORD_0
    v_lshlrev_b32_sdwa v102, 3, v119 dst_sel:DWORD dst_unused:UNUSED_PAD src0_sel:DWORD src1_sel:WORD_1
    ds_read_b64 v[100:101], v100
    ds_read_b64 v[102:103], v102
    buffer_load_dwordx4 v[116:119], v69, s[12:15], s20 offen offset:2048 sc1
    s_waitcnt lgkmcnt(9)
    v_smfmac_f32_16x16x64_bf16 v[20:23], v[64:67], v[104:111], v68
    s_nop 0
    v_cvt_pk_bf16_f32 v112, v112, v113
    v_cvt_pk_bf16_f32 v113, v114, v115
    ds_write_b64 v70, v[112:113] offset:256
    v_mfma_f32_16x16x32_bf16 v[112:115], v[72:75], v[176:179], 0
    v_mfma_f32_16x16x32_bf16 v[112:115], v[76:79], v[180:183], v[112:115]
    s_waitcnt vmcnt(2)
    v_lshlrev_b32_sdwa v104, 3, v120 dst_sel:DWORD dst_unused:UNUSED_PAD src0_sel:DWORD src1_sel:WORD_0
    v_lshlrev_b32_sdwa v106, 3, v120 dst_sel:DWORD dst_unused:UNUSED_PAD src0_sel:DWORD src1_sel:WORD_1
    ds_read_b64 v[104:105], v104
    ds_read_b64 v[106:107], v106
    v_mfma_f32_16x16x32_bf16 v[112:115], v[80:83], v[184:187], v[112:115]
    v_mfma_f32_16x16x32_bf16 v[112:115], v[84:87], v[188:191], v[112:115]
    v_lshlrev_b32_sdwa v108, 3, v121 dst_sel:DWORD dst_unused:UNUSED_PAD src0_sel:DWORD src1_sel:WORD_0
    v_lshlrev_b32_sdwa v110, 3, v121 dst_sel:DWORD dst_unused:UNUSED_PAD src0_sel:DWORD src1_sel:WORD_1
    ds_read_b64 v[108:109], v108
    ds_read_b64 v[110:111], v110
    s_waitcnt lgkmcnt(9)
    v_smfmac_f32_16x16x64_bf16 v[24:27], v[64:67], v[88:95], v68
    s_nop 1
    v_cvt_pk_bf16_f32 v112, v112, v113
    v_cvt_pk_bf16_f32 v113, v114, v115
    ds_write_b64 v70, v[112:113] offset:384
    v_mfma_f32_16x16x32_bf16 v[112:115], v[72:75], v[192:195], 0
    v_lshlrev_b32_sdwa v88, 3, v122 dst_sel:DWORD dst_unused:UNUSED_PAD src0_sel:DWORD src1_sel:WORD_0
    v_lshlrev_b32_sdwa v90, 3, v122 dst_sel:DWORD dst_unused:UNUSED_PAD src0_sel:DWORD src1_sel:WORD_1
    ds_read_b64 v[88:89], v88
    ds_read_b64 v[90:91], v90
    v_mfma_f32_16x16x32_bf16 v[112:115], v[76:79], v[196:199], v[112:115]
    v_lshlrev_b32_sdwa v92, 3, v123 dst_sel:DWORD dst_unused:UNUSED_PAD src0_sel:DWORD src1_sel:WORD_0
    v_lshlrev_b32_sdwa v94, 3, v123 dst_sel:DWORD dst_unused:UNUSED_PAD src0_sel:DWORD src1_sel:WORD_1
    ds_read_b64 v[92:93], v92
    ds_read_b64 v[94:95], v94
    buffer_load_dwordx4 v[120:123], v69, s[12:15], s20 offen offset:3072 sc1
    s_add_u32 s20, s20, 61440
    s_waitcnt lgkmcnt(10)
    v_smfmac_f32_16x16x64_bf16 v[28:31], v[64:67], v[96:103], v68
    s_setprio 2
    v_mfma_f32_16x16x32_bf16 v[112:115], v[80:83], v[200:203], v[112:115]
    s_waitcnt vmcnt(2)
    v_lshlrev_b32_sdwa v96, 3, v124 dst_sel:DWORD dst_unused:UNUSED_PAD src0_sel:DWORD src1_sel:WORD_0
    v_lshlrev_b32_sdwa v98, 3, v124 dst_sel:DWORD dst_unused:UNUSED_PAD src0_sel:DWORD src1_sel:WORD_1
    ds_read_b64 v[96:97], v96
    ds_read_b64 v[98:99], v98
    v_mfma_f32_16x16x32_bf16 v[112:115], v[84:87], v[204:207], v[112:115]
    v_lshlrev_b32_sdwa v100, 3, v125 dst_sel:DWORD dst_unused:UNUSED_PAD src0_sel:DWORD src1_sel:WORD_0
    v_lshlrev_b32_sdwa v102, 3, v125 dst_sel:DWORD dst_unused:UNUSED_PAD src0_sel:DWORD src1_sel:WORD_1
    ds_read_b64 v[100:101], v100
    ds_read_b64 v[102:103], v102
    s_waitcnt lgkmcnt(9)
    v_smfmac_f32_16x16x64_bf16 v[32:35], v[64:67], v[104:111], v68
    s_nop 1
    v_cvt_pk_bf16_f32 v112, v112, v113
    v_cvt_pk_bf16_f32 v113, v114, v115
    ds_write_b64 v70, v[112:113] offset:512
    v_mfma_f32_16x16x32_bf16 v[112:115], v[72:75], v[208:211], 0
    v_lshlrev_b32_sdwa v104, 3, v126 dst_sel:DWORD dst_unused:UNUSED_PAD src0_sel:DWORD src1_sel:WORD_0
    v_lshlrev_b32_sdwa v106, 3, v126 dst_sel:DWORD dst_unused:UNUSED_PAD src0_sel:DWORD src1_sel:WORD_1
    ds_read_b64 v[104:105], v104
    ds_read_b64 v[106:107], v106
    v_mfma_f32_16x16x32_bf16 v[112:115], v[76:79], v[212:215], v[112:115]
    v_lshlrev_b32_sdwa v108, 3, v127 dst_sel:DWORD dst_unused:UNUSED_PAD src0_sel:DWORD src1_sel:WORD_0
    v_lshlrev_b32_sdwa v110, 3, v127 dst_sel:DWORD dst_unused:UNUSED_PAD src0_sel:DWORD src1_sel:WORD_1
    ds_read_b64 v[108:109], v108
    ds_read_b64 v[110:111], v110
    buffer_load_dwordx4 v[124:127], v69, s[12:15], s20 offen offset:0 sc1
    s_waitcnt lgkmcnt(9)
    v_smfmac_f32_16x16x64_bf16 v[36:39], v[64:67], v[88:95], v68
    v_mfma_f32_16x16x32_bf16 v[112:115], v[80:83], v[216:219], v[112:115]
    s_waitcnt vmcnt(2)
    v_lshlrev_b32_sdwa v88, 3, v116 dst_sel:DWORD dst_unused:UNUSED_PAD src0_sel:DWORD src1_sel:WORD_0
    v_lshlrev_b32_sdwa v90, 3, v116 dst_sel:DWORD dst_unused:UNUSED_PAD src0_sel:DWORD src1_sel:WORD_1
    ds_read_b64 v[88:89], v88
    ds_read_b64 v[90:91], v90
    v_mfma_f32_16x16x32_bf16 v[112:115], v[84:87], v[220:223], v[112:115]
    v_lshlrev_b32_sdwa v92, 3, v117 dst_sel:DWORD dst_unused:UNUSED_PAD src0_sel:DWORD src1_sel:WORD_0
    v_lshlrev_b32_sdwa v94, 3, v117 dst_sel:DWORD dst_unused:UNUSED_PAD src0_sel:DWORD src1_sel:WORD_1
    ds_read_b64 v[92:93], v92
    ds_read_b64 v[94:95], v94
    s_waitcnt lgkmcnt(9)
    v_smfmac_f32_16x16x64_bf16 v[40:43], v[64:67], v[96:103], v68
    s_nop 1
    v_cvt_pk_bf16_f32 v112, v112, v113
    v_cvt_pk_bf16_f32 v113, v114, v115
    ds_write_b64 v70, v[112:113] offset:640
    v_mfma_f32_16x16x32_bf16 v[112:115], v[72:75], v[224:227], 0
    v_mfma_f32_16x16x32_bf16 v[112:115], v[76:79], v[228:231], v[112:115]
    v_lshlrev_b32_sdwa v96, 3, v118 dst_sel:DWORD dst_unused:UNUSED_PAD src0_sel:DWORD src1_sel:WORD_0
    v_lshlrev_b32_sdwa v98, 3, v118 dst_sel:DWORD dst_unused:UNUSED_PAD src0_sel:DWORD src1_sel:WORD_1
    ds_read_b64 v[96:97], v96
    ds_read_b64 v[98:99], v98
    v_mfma_f32_16x16x32_bf16 v[112:115], v[80:83], v[232:235], v[112:115]
    v_mfma_f32_16x16x32_bf16 v[112:115], v[84:87], v[236:239], v[112:115]
    v_lshlrev_b32_sdwa v100, 3, v119 dst_sel:DWORD dst_unused:UNUSED_PAD src0_sel:DWORD src1_sel:WORD_0
    v_lshlrev_b32_sdwa v102, 3, v119 dst_sel:DWORD dst_unused:UNUSED_PAD src0_sel:DWORD src1_sel:WORD_1
    ds_read_b64 v[100:101], v100
    ds_read_b64 v[102:103], v102
    buffer_load_dwordx4 v[116:119], v69, s[12:15], s20 offen offset:1024 sc1
    s_waitcnt lgkmcnt(9)
    v_smfmac_f32_16x16x64_bf16 v[44:47], v[64:67], v[104:111], v68
    s_nop 0
    v_cvt_pk_bf16_f32 v112, v112, v113
    v_cvt_pk_bf16_f32 v113, v114, v115
    ds_write_b64 v70, v[112:113] offset:768
    s_setprio 1
    v_mfma_f32_16x16x32_bf16 v[112:115], v[72:75], v[240:243], 0
    buffer_load_dwordx4 v[72:75], v69, s[12:15], s21 offen offset:0
    s_waitcnt vmcnt(3)
    v_lshlrev_b32_sdwa v104, 3, v120 dst_sel:DWORD dst_unused:UNUSED_PAD src0_sel:DWORD src1_sel:WORD_0
    v_lshlrev_b32_sdwa v106, 3, v120 dst_sel:DWORD dst_unused:UNUSED_PAD src0_sel:DWORD src1_sel:WORD_1
    ds_read_b64 v[104:105], v104
    ds_read_b64 v[106:107], v106
    v_mfma_f32_16x16x32_bf16 v[112:115], v[76:79], v[244:247], v[112:115]
    buffer_load_dwordx4 v[76:79], v69, s[12:15], s21 offen offset:1024
    v_lshlrev_b32_sdwa v108, 3, v121 dst_sel:DWORD dst_unused:UNUSED_PAD src0_sel:DWORD src1_sel:WORD_0
    v_lshlrev_b32_sdwa v110, 3, v121 dst_sel:DWORD dst_unused:UNUSED_PAD src0_sel:DWORD src1_sel:WORD_1
    ds_read_b64 v[108:109], v108
    ds_read_b64 v[110:111], v110
    s_waitcnt lgkmcnt(10)
    v_smfmac_f32_16x16x64_bf16 v[48:51], v[64:67], v[88:95], v68
    v_mfma_f32_16x16x32_bf16 v[112:115], v[80:83], v[248:251], v[112:115]
    buffer_load_dwordx4 v[80:83], v69, s[12:15], s19 offen offset:0
    v_lshlrev_b32_sdwa v88, 3, v122 dst_sel:DWORD dst_unused:UNUSED_PAD src0_sel:DWORD src1_sel:WORD_0
    v_lshlrev_b32_sdwa v90, 3, v122 dst_sel:DWORD dst_unused:UNUSED_PAD src0_sel:DWORD src1_sel:WORD_1
    ds_read_b64 v[88:89], v88
    ds_read_b64 v[90:91], v90
    v_mfma_f32_16x16x32_bf16 v[112:115], v[84:87], v[252:255], v[112:115]
    buffer_load_dwordx4 v[84:87], v69, s[12:15], s19 offen offset:1024
    s_add_u32 s21, s21, 4096
    s_add_u32 s19, s19, 4096
    v_lshlrev_b32_sdwa v92, 3, v123 dst_sel:DWORD dst_unused:UNUSED_PAD src0_sel:DWORD src1_sel:WORD_0
    v_lshlrev_b32_sdwa v94, 3, v123 dst_sel:DWORD dst_unused:UNUSED_PAD src0_sel:DWORD src1_sel:WORD_1
    ds_read_b64 v[92:93], v92
    ds_read_b64 v[94:95], v94
    buffer_load_dwordx4 v[120:123], v69, s[12:15], s20 offen offset:2048 sc1
    s_waitcnt lgkmcnt(9)
    v_smfmac_f32_16x16x64_bf16 v[52:55], v[64:67], v[96:103], v68
    v_cvt_pk_bf16_f32 v112, v112, v113
    v_cvt_pk_bf16_f32 v113, v114, v115
    ds_write_b64 v70, v[112:113] offset:896
    s_add_u32 s23, s23, 1
    s_cmp_eq_u32 s23, 5
    s_cselect_b32 s35, 4294836224, s32
    s_cselect_b32 s23, 0, s23
    v_add_u32 v70, s35, v70
    s_waitcnt vmcnt(6)
    v_lshlrev_b32_sdwa v96, 3, v124 dst_sel:DWORD dst_unused:UNUSED_PAD src0_sel:DWORD src1_sel:WORD_0
    v_lshlrev_b32_sdwa v98, 3, v124 dst_sel:DWORD dst_unused:UNUSED_PAD src0_sel:DWORD src1_sel:WORD_1
    ds_read_b64 v[96:97], v96
    ds_read_b64 v[98:99], v98
    v_lshlrev_b32_sdwa v100, 3, v125 dst_sel:DWORD dst_unused:UNUSED_PAD src0_sel:DWORD src1_sel:WORD_0
    v_lshlrev_b32_sdwa v102, 3, v125 dst_sel:DWORD dst_unused:UNUSED_PAD src0_sel:DWORD src1_sel:WORD_1
    ds_read_b64 v[100:101], v100
    ds_read_b64 v[102:103], v102
    s_waitcnt lgkmcnt(9)
    v_smfmac_f32_16x16x64_bf16 v[56:59], v[64:67], v[104:111], v68
    s_setprio 0
    v_lshlrev_b32_sdwa v104, 3, v126 dst_sel:DWORD dst_unused:UNUSED_PAD src0_sel:DWORD src1_sel:WORD_0
    v_lshlrev_b32_sdwa v106, 3, v126 dst_sel:DWORD dst_unused:UNUSED_PAD src0_sel:DWORD src1_sel:WORD_1
    ds_read_b64 v[104:105], v104
    ds_read_b64 v[106:107], v106
    v_lshlrev_b32_sdwa v108, 3, v127 dst_sel:DWORD dst_unused:UNUSED_PAD src0_sel:DWORD src1_sel:WORD_0
    v_lshlrev_b32_sdwa v110, 3, v127 dst_sel:DWORD dst_unused:UNUSED_PAD src0_sel:DWORD src1_sel:WORD_1
    ds_read_b64 v[108:109], v108
    ds_read_b64 v[110:111], v110
    buffer_load_dwordx4 v[124:127], v69, s[12:15], s20 offen offset:3072 sc1
    s_add_u32 s20, s20, 4096
    s_waitcnt lgkmcnt(9)
    v_smfmac_f32_16x16x64_bf16 v[60:63], v[64:67], v[88:95], v68
    s_waitcnt lgkmcnt(8)
    s_barrier

    s_cmp_eq_u32 s22, 7
    s_cbranch_scc1 k1_kernel_fin

    s_setprio 3
    s_waitcnt vmcnt(6)
    v_lshlrev_b32_sdwa v88, 3, v116 dst_sel:DWORD dst_unused:UNUSED_PAD src0_sel:DWORD src1_sel:WORD_0
    v_lshlrev_b32_sdwa v90, 3, v116 dst_sel:DWORD dst_unused:UNUSED_PAD src0_sel:DWORD src1_sel:WORD_1
    ds_read_b64 v[88:89], v88
    ds_read_b64 v[90:91], v90
    v_lshlrev_b32_sdwa v92, 3, v117 dst_sel:DWORD dst_unused:UNUSED_PAD src0_sel:DWORD src1_sel:WORD_0
    v_lshlrev_b32_sdwa v94, 3, v117 dst_sel:DWORD dst_unused:UNUSED_PAD src0_sel:DWORD src1_sel:WORD_1
    ds_read_b64 v[92:93], v92
    ds_read_b64 v[94:95], v94
    s_waitcnt lgkmcnt(8)
    v_smfmac_f32_16x16x64_bf16 v[0:3], v[64:67], v[96:103], v68
    s_waitcnt vmcnt(5)
    v_mfma_f32_16x16x32_bf16 v[112:115], v[72:75], v[128:131], 0
    v_lshlrev_b32_sdwa v96, 3, v118 dst_sel:DWORD dst_unused:UNUSED_PAD src0_sel:DWORD src1_sel:WORD_0
    v_lshlrev_b32_sdwa v98, 3, v118 dst_sel:DWORD dst_unused:UNUSED_PAD src0_sel:DWORD src1_sel:WORD_1
    ds_read_b64 v[96:97], v96
    ds_read_b64 v[98:99], v98
    s_waitcnt vmcnt(4)
    v_mfma_f32_16x16x32_bf16 v[112:115], v[76:79], v[132:135], v[112:115]
    v_lshlrev_b32_sdwa v100, 3, v119 dst_sel:DWORD dst_unused:UNUSED_PAD src0_sel:DWORD src1_sel:WORD_0
    v_lshlrev_b32_sdwa v102, 3, v119 dst_sel:DWORD dst_unused:UNUSED_PAD src0_sel:DWORD src1_sel:WORD_1
    ds_read_b64 v[100:101], v100
    ds_read_b64 v[102:103], v102
    buffer_load_dwordx4 v[116:119], v69, s[12:15], s20 offen offset:0 sc1
    s_waitcnt lgkmcnt(8)
    v_smfmac_f32_16x16x64_bf16 v[4:7], v[64:67], v[104:111], v68
    s_waitcnt vmcnt(4)
    v_mfma_f32_16x16x32_bf16 v[112:115], v[80:83], v[136:139], v[112:115]
    s_waitcnt vmcnt(2)
    v_lshlrev_b32_sdwa v104, 3, v120 dst_sel:DWORD dst_unused:UNUSED_PAD src0_sel:DWORD src1_sel:WORD_0
    v_lshlrev_b32_sdwa v106, 3, v120 dst_sel:DWORD dst_unused:UNUSED_PAD src0_sel:DWORD src1_sel:WORD_1
    ds_read_b64 v[104:105], v104
    ds_read_b64 v[106:107], v106
    s_waitcnt vmcnt(3)
    v_mfma_f32_16x16x32_bf16 v[112:115], v[84:87], v[140:143], v[112:115]
    v_lshlrev_b32_sdwa v108, 3, v121 dst_sel:DWORD dst_unused:UNUSED_PAD src0_sel:DWORD src1_sel:WORD_0
    v_lshlrev_b32_sdwa v110, 3, v121 dst_sel:DWORD dst_unused:UNUSED_PAD src0_sel:DWORD src1_sel:WORD_1
    ds_read_b64 v[108:109], v108
    ds_read_b64 v[110:111], v110
    s_waitcnt lgkmcnt(8)
    v_smfmac_f32_16x16x64_bf16 v[8:11], v[64:67], v[88:95], v68
    s_nop 1
    v_cvt_pk_bf16_f32 v112, v112, v113
    v_cvt_pk_bf16_f32 v113, v114, v115
    ds_write_b64 v70, v[112:113] offset:0
    v_mfma_f32_16x16x32_bf16 v[112:115], v[72:75], v[144:147], 0
    v_mfma_f32_16x16x32_bf16 v[112:115], v[76:79], v[148:151], v[112:115]
    v_lshlrev_b32_sdwa v88, 3, v122 dst_sel:DWORD dst_unused:UNUSED_PAD src0_sel:DWORD src1_sel:WORD_0
    v_lshlrev_b32_sdwa v90, 3, v122 dst_sel:DWORD dst_unused:UNUSED_PAD src0_sel:DWORD src1_sel:WORD_1
    ds_read_b64 v[88:89], v88
    ds_read_b64 v[90:91], v90
    v_mfma_f32_16x16x32_bf16 v[112:115], v[80:83], v[152:155], v[112:115]
    v_mfma_f32_16x16x32_bf16 v[112:115], v[84:87], v[156:159], v[112:115]
    v_lshlrev_b32_sdwa v92, 3, v123 dst_sel:DWORD dst_unused:UNUSED_PAD src0_sel:DWORD src1_sel:WORD_0
    v_lshlrev_b32_sdwa v94, 3, v123 dst_sel:DWORD dst_unused:UNUSED_PAD src0_sel:DWORD src1_sel:WORD_1
    ds_read_b64 v[92:93], v92
    ds_read_b64 v[94:95], v94
    buffer_load_dwordx4 v[120:123], v69, s[12:15], s20 offen offset:1024 sc1
    s_waitcnt lgkmcnt(9)
    v_smfmac_f32_16x16x64_bf16 v[12:15], v[64:67], v[96:103], v68
    s_nop 0
    v_cvt_pk_bf16_f32 v112, v112, v113
    v_cvt_pk_bf16_f32 v113, v114, v115
    ds_write_b64 v70, v[112:113] offset:128
    v_mfma_f32_16x16x32_bf16 v[112:115], v[72:75], v[160:163], 0
    s_waitcnt vmcnt(2)
    v_lshlrev_b32_sdwa v96, 3, v124 dst_sel:DWORD dst_unused:UNUSED_PAD src0_sel:DWORD src1_sel:WORD_0
    v_lshlrev_b32_sdwa v98, 3, v124 dst_sel:DWORD dst_unused:UNUSED_PAD src0_sel:DWORD src1_sel:WORD_1
    ds_read_b64 v[96:97], v96
    ds_read_b64 v[98:99], v98
    v_mfma_f32_16x16x32_bf16 v[112:115], v[76:79], v[164:167], v[112:115]
    v_lshlrev_b32_sdwa v100, 3, v125 dst_sel:DWORD dst_unused:UNUSED_PAD src0_sel:DWORD src1_sel:WORD_0
    v_lshlrev_b32_sdwa v102, 3, v125 dst_sel:DWORD dst_unused:UNUSED_PAD src0_sel:DWORD src1_sel:WORD_1
    ds_read_b64 v[100:101], v100
    ds_read_b64 v[102:103], v102
    s_waitcnt lgkmcnt(10)
    v_smfmac_f32_16x16x64_bf16 v[16:19], v[64:67], v[104:111], v68
    v_mfma_f32_16x16x32_bf16 v[112:115], v[80:83], v[168:171], v[112:115]
    v_lshlrev_b32_sdwa v104, 3, v126 dst_sel:DWORD dst_unused:UNUSED_PAD src0_sel:DWORD src1_sel:WORD_0
    v_lshlrev_b32_sdwa v106, 3, v126 dst_sel:DWORD dst_unused:UNUSED_PAD src0_sel:DWORD src1_sel:WORD_1
    ds_read_b64 v[104:105], v104
    ds_read_b64 v[106:107], v106
    v_mfma_f32_16x16x32_bf16 v[112:115], v[84:87], v[172:175], v[112:115]
    v_lshlrev_b32_sdwa v108, 3, v127 dst_sel:DWORD dst_unused:UNUSED_PAD src0_sel:DWORD src1_sel:WORD_0
    v_lshlrev_b32_sdwa v110, 3, v127 dst_sel:DWORD dst_unused:UNUSED_PAD src0_sel:DWORD src1_sel:WORD_1
    ds_read_b64 v[108:109], v108
    ds_read_b64 v[110:111], v110
    buffer_load_dwordx4 v[124:127], v69, s[12:15], s20 offen offset:2048 sc1
    s_waitcnt lgkmcnt(9)
    v_smfmac_f32_16x16x64_bf16 v[20:23], v[64:67], v[88:95], v68
    s_nop 0
    v_cvt_pk_bf16_f32 v112, v112, v113
    v_cvt_pk_bf16_f32 v113, v114, v115
    ds_write_b64 v70, v[112:113] offset:256
    v_mfma_f32_16x16x32_bf16 v[112:115], v[72:75], v[176:179], 0
    v_mfma_f32_16x16x32_bf16 v[112:115], v[76:79], v[180:183], v[112:115]
    s_waitcnt vmcnt(2)
    v_lshlrev_b32_sdwa v88, 3, v116 dst_sel:DWORD dst_unused:UNUSED_PAD src0_sel:DWORD src1_sel:WORD_0
    v_lshlrev_b32_sdwa v90, 3, v116 dst_sel:DWORD dst_unused:UNUSED_PAD src0_sel:DWORD src1_sel:WORD_1
    ds_read_b64 v[88:89], v88
    ds_read_b64 v[90:91], v90
    v_mfma_f32_16x16x32_bf16 v[112:115], v[80:83], v[184:187], v[112:115]
    v_mfma_f32_16x16x32_bf16 v[112:115], v[84:87], v[188:191], v[112:115]
    v_lshlrev_b32_sdwa v92, 3, v117 dst_sel:DWORD dst_unused:UNUSED_PAD src0_sel:DWORD src1_sel:WORD_0
    v_lshlrev_b32_sdwa v94, 3, v117 dst_sel:DWORD dst_unused:UNUSED_PAD src0_sel:DWORD src1_sel:WORD_1
    ds_read_b64 v[92:93], v92
    ds_read_b64 v[94:95], v94
    s_waitcnt lgkmcnt(9)
    v_smfmac_f32_16x16x64_bf16 v[24:27], v[64:67], v[96:103], v68
    s_nop 1
    v_cvt_pk_bf16_f32 v112, v112, v113
    v_cvt_pk_bf16_f32 v113, v114, v115
    ds_write_b64 v70, v[112:113] offset:384
    v_mfma_f32_16x16x32_bf16 v[112:115], v[72:75], v[192:195], 0
    v_lshlrev_b32_sdwa v96, 3, v118 dst_sel:DWORD dst_unused:UNUSED_PAD src0_sel:DWORD src1_sel:WORD_0
    v_lshlrev_b32_sdwa v98, 3, v118 dst_sel:DWORD dst_unused:UNUSED_PAD src0_sel:DWORD src1_sel:WORD_1
    ds_read_b64 v[96:97], v96
    ds_read_b64 v[98:99], v98
    v_mfma_f32_16x16x32_bf16 v[112:115], v[76:79], v[196:199], v[112:115]
    v_lshlrev_b32_sdwa v100, 3, v119 dst_sel:DWORD dst_unused:UNUSED_PAD src0_sel:DWORD src1_sel:WORD_0
    v_lshlrev_b32_sdwa v102, 3, v119 dst_sel:DWORD dst_unused:UNUSED_PAD src0_sel:DWORD src1_sel:WORD_1
    ds_read_b64 v[100:101], v100
    ds_read_b64 v[102:103], v102
    buffer_load_dwordx4 v[116:119], v69, s[12:15], s20 offen offset:3072 sc1
    s_add_u32 s20, s20, 61440
    s_waitcnt lgkmcnt(10)
    v_smfmac_f32_16x16x64_bf16 v[28:31], v[64:67], v[104:111], v68
    s_setprio 2
    v_mfma_f32_16x16x32_bf16 v[112:115], v[80:83], v[200:203], v[112:115]
    s_waitcnt vmcnt(2)
    v_lshlrev_b32_sdwa v104, 3, v120 dst_sel:DWORD dst_unused:UNUSED_PAD src0_sel:DWORD src1_sel:WORD_0
    v_lshlrev_b32_sdwa v106, 3, v120 dst_sel:DWORD dst_unused:UNUSED_PAD src0_sel:DWORD src1_sel:WORD_1
    ds_read_b64 v[104:105], v104
    ds_read_b64 v[106:107], v106
    v_mfma_f32_16x16x32_bf16 v[112:115], v[84:87], v[204:207], v[112:115]
    v_lshlrev_b32_sdwa v108, 3, v121 dst_sel:DWORD dst_unused:UNUSED_PAD src0_sel:DWORD src1_sel:WORD_0
    v_lshlrev_b32_sdwa v110, 3, v121 dst_sel:DWORD dst_unused:UNUSED_PAD src0_sel:DWORD src1_sel:WORD_1
    ds_read_b64 v[108:109], v108
    ds_read_b64 v[110:111], v110
    s_waitcnt lgkmcnt(9)
    v_smfmac_f32_16x16x64_bf16 v[32:35], v[64:67], v[88:95], v68
    s_nop 1
    v_cvt_pk_bf16_f32 v112, v112, v113
    v_cvt_pk_bf16_f32 v113, v114, v115
    ds_write_b64 v70, v[112:113] offset:512
    v_mfma_f32_16x16x32_bf16 v[112:115], v[72:75], v[208:211], 0
    v_lshlrev_b32_sdwa v88, 3, v122 dst_sel:DWORD dst_unused:UNUSED_PAD src0_sel:DWORD src1_sel:WORD_0
    v_lshlrev_b32_sdwa v90, 3, v122 dst_sel:DWORD dst_unused:UNUSED_PAD src0_sel:DWORD src1_sel:WORD_1
    ds_read_b64 v[88:89], v88
    ds_read_b64 v[90:91], v90
    v_mfma_f32_16x16x32_bf16 v[112:115], v[76:79], v[212:215], v[112:115]
    v_lshlrev_b32_sdwa v92, 3, v123 dst_sel:DWORD dst_unused:UNUSED_PAD src0_sel:DWORD src1_sel:WORD_0
    v_lshlrev_b32_sdwa v94, 3, v123 dst_sel:DWORD dst_unused:UNUSED_PAD src0_sel:DWORD src1_sel:WORD_1
    ds_read_b64 v[92:93], v92
    ds_read_b64 v[94:95], v94
    buffer_load_dwordx4 v[120:123], v69, s[12:15], s20 offen offset:0 sc1
    s_waitcnt lgkmcnt(9)
    v_smfmac_f32_16x16x64_bf16 v[36:39], v[64:67], v[96:103], v68
    v_mfma_f32_16x16x32_bf16 v[112:115], v[80:83], v[216:219], v[112:115]
    s_waitcnt vmcnt(2)
    v_lshlrev_b32_sdwa v96, 3, v124 dst_sel:DWORD dst_unused:UNUSED_PAD src0_sel:DWORD src1_sel:WORD_0
    v_lshlrev_b32_sdwa v98, 3, v124 dst_sel:DWORD dst_unused:UNUSED_PAD src0_sel:DWORD src1_sel:WORD_1
    ds_read_b64 v[96:97], v96
    ds_read_b64 v[98:99], v98
    v_mfma_f32_16x16x32_bf16 v[112:115], v[84:87], v[220:223], v[112:115]
    v_lshlrev_b32_sdwa v100, 3, v125 dst_sel:DWORD dst_unused:UNUSED_PAD src0_sel:DWORD src1_sel:WORD_0
    v_lshlrev_b32_sdwa v102, 3, v125 dst_sel:DWORD dst_unused:UNUSED_PAD src0_sel:DWORD src1_sel:WORD_1
    ds_read_b64 v[100:101], v100
    ds_read_b64 v[102:103], v102
    s_waitcnt lgkmcnt(9)
    v_smfmac_f32_16x16x64_bf16 v[40:43], v[64:67], v[104:111], v68
    s_nop 1
    v_cvt_pk_bf16_f32 v112, v112, v113
    v_cvt_pk_bf16_f32 v113, v114, v115
    ds_write_b64 v70, v[112:113] offset:640
    v_mfma_f32_16x16x32_bf16 v[112:115], v[72:75], v[224:227], 0
    v_mfma_f32_16x16x32_bf16 v[112:115], v[76:79], v[228:231], v[112:115]
    v_lshlrev_b32_sdwa v104, 3, v126 dst_sel:DWORD dst_unused:UNUSED_PAD src0_sel:DWORD src1_sel:WORD_0
    v_lshlrev_b32_sdwa v106, 3, v126 dst_sel:DWORD dst_unused:UNUSED_PAD src0_sel:DWORD src1_sel:WORD_1
    ds_read_b64 v[104:105], v104
    ds_read_b64 v[106:107], v106
    v_mfma_f32_16x16x32_bf16 v[112:115], v[80:83], v[232:235], v[112:115]
    v_mfma_f32_16x16x32_bf16 v[112:115], v[84:87], v[236:239], v[112:115]
    v_lshlrev_b32_sdwa v108, 3, v127 dst_sel:DWORD dst_unused:UNUSED_PAD src0_sel:DWORD src1_sel:WORD_0
    v_lshlrev_b32_sdwa v110, 3, v127 dst_sel:DWORD dst_unused:UNUSED_PAD src0_sel:DWORD src1_sel:WORD_1
    ds_read_b64 v[108:109], v108
    ds_read_b64 v[110:111], v110
    buffer_load_dwordx4 v[124:127], v69, s[12:15], s20 offen offset:1024 sc1
    s_waitcnt lgkmcnt(9)
    v_smfmac_f32_16x16x64_bf16 v[44:47], v[64:67], v[88:95], v68
    s_nop 0
    v_cvt_pk_bf16_f32 v112, v112, v113
    v_cvt_pk_bf16_f32 v113, v114, v115
    ds_write_b64 v70, v[112:113] offset:768
    s_setprio 1
    v_mfma_f32_16x16x32_bf16 v[112:115], v[72:75], v[240:243], 0
    buffer_load_dwordx4 v[72:75], v69, s[12:15], s21 offen offset:0
    s_waitcnt vmcnt(3)
    v_lshlrev_b32_sdwa v88, 3, v116 dst_sel:DWORD dst_unused:UNUSED_PAD src0_sel:DWORD src1_sel:WORD_0
    v_lshlrev_b32_sdwa v90, 3, v116 dst_sel:DWORD dst_unused:UNUSED_PAD src0_sel:DWORD src1_sel:WORD_1
    ds_read_b64 v[88:89], v88
    ds_read_b64 v[90:91], v90
    v_mfma_f32_16x16x32_bf16 v[112:115], v[76:79], v[244:247], v[112:115]
    buffer_load_dwordx4 v[76:79], v69, s[12:15], s21 offen offset:1024
    v_lshlrev_b32_sdwa v92, 3, v117 dst_sel:DWORD dst_unused:UNUSED_PAD src0_sel:DWORD src1_sel:WORD_0
    v_lshlrev_b32_sdwa v94, 3, v117 dst_sel:DWORD dst_unused:UNUSED_PAD src0_sel:DWORD src1_sel:WORD_1
    ds_read_b64 v[92:93], v92
    ds_read_b64 v[94:95], v94
    s_waitcnt lgkmcnt(10)
    v_smfmac_f32_16x16x64_bf16 v[48:51], v[64:67], v[96:103], v68
    v_mfma_f32_16x16x32_bf16 v[112:115], v[80:83], v[248:251], v[112:115]
    buffer_load_dwordx4 v[80:83], v69, s[12:15], s19 offen offset:0
    v_lshlrev_b32_sdwa v96, 3, v118 dst_sel:DWORD dst_unused:UNUSED_PAD src0_sel:DWORD src1_sel:WORD_0
    v_lshlrev_b32_sdwa v98, 3, v118 dst_sel:DWORD dst_unused:UNUSED_PAD src0_sel:DWORD src1_sel:WORD_1
    ds_read_b64 v[96:97], v96
    ds_read_b64 v[98:99], v98
    v_mfma_f32_16x16x32_bf16 v[112:115], v[84:87], v[252:255], v[112:115]
    buffer_load_dwordx4 v[84:87], v69, s[12:15], s19 offen offset:1024
    s_add_u32 s21, s21, 4096
    s_add_u32 s19, s19, 4096
    v_lshlrev_b32_sdwa v100, 3, v119 dst_sel:DWORD dst_unused:UNUSED_PAD src0_sel:DWORD src1_sel:WORD_0
    v_lshlrev_b32_sdwa v102, 3, v119 dst_sel:DWORD dst_unused:UNUSED_PAD src0_sel:DWORD src1_sel:WORD_1
    ds_read_b64 v[100:101], v100
    ds_read_b64 v[102:103], v102
    buffer_load_dwordx4 v[116:119], v69, s[12:15], s20 offen offset:2048 sc1
    s_waitcnt lgkmcnt(9)
    v_smfmac_f32_16x16x64_bf16 v[52:55], v[64:67], v[104:111], v68
    v_cvt_pk_bf16_f32 v112, v112, v113
    v_cvt_pk_bf16_f32 v113, v114, v115
    ds_write_b64 v70, v[112:113] offset:896
    s_add_u32 s23, s23, 1
    s_cmp_eq_u32 s23, 5
    s_cselect_b32 s35, 4294836224, s32
    s_cselect_b32 s23, 0, s23
    v_add_u32 v70, s35, v70
    s_waitcnt vmcnt(6)
    v_lshlrev_b32_sdwa v104, 3, v120 dst_sel:DWORD dst_unused:UNUSED_PAD src0_sel:DWORD src1_sel:WORD_0
    v_lshlrev_b32_sdwa v106, 3, v120 dst_sel:DWORD dst_unused:UNUSED_PAD src0_sel:DWORD src1_sel:WORD_1
    ds_read_b64 v[104:105], v104
    ds_read_b64 v[106:107], v106
    v_lshlrev_b32_sdwa v108, 3, v121 dst_sel:DWORD dst_unused:UNUSED_PAD src0_sel:DWORD src1_sel:WORD_0
    v_lshlrev_b32_sdwa v110, 3, v121 dst_sel:DWORD dst_unused:UNUSED_PAD src0_sel:DWORD src1_sel:WORD_1
    ds_read_b64 v[108:109], v108
    ds_read_b64 v[110:111], v110
    s_waitcnt lgkmcnt(9)
    v_smfmac_f32_16x16x64_bf16 v[56:59], v[64:67], v[88:95], v68
    s_setprio 0
    v_lshlrev_b32_sdwa v88, 3, v122 dst_sel:DWORD dst_unused:UNUSED_PAD src0_sel:DWORD src1_sel:WORD_0
    v_lshlrev_b32_sdwa v90, 3, v122 dst_sel:DWORD dst_unused:UNUSED_PAD src0_sel:DWORD src1_sel:WORD_1
    ds_read_b64 v[88:89], v88
    ds_read_b64 v[90:91], v90
    v_lshlrev_b32_sdwa v92, 3, v123 dst_sel:DWORD dst_unused:UNUSED_PAD src0_sel:DWORD src1_sel:WORD_0
    v_lshlrev_b32_sdwa v94, 3, v123 dst_sel:DWORD dst_unused:UNUSED_PAD src0_sel:DWORD src1_sel:WORD_1
    ds_read_b64 v[92:93], v92
    ds_read_b64 v[94:95], v94
    buffer_load_dwordx4 v[120:123], v69, s[12:15], s20 offen offset:3072 sc1
    s_add_u32 s20, s20, 4096
    s_waitcnt lgkmcnt(9)
    v_smfmac_f32_16x16x64_bf16 v[60:63], v[64:67], v[96:103], v68
    s_waitcnt lgkmcnt(8)
    s_barrier
    s_setprio 3
    s_waitcnt vmcnt(6)
    v_lshlrev_b32_sdwa v96, 3, v124 dst_sel:DWORD dst_unused:UNUSED_PAD src0_sel:DWORD src1_sel:WORD_0
    v_lshlrev_b32_sdwa v98, 3, v124 dst_sel:DWORD dst_unused:UNUSED_PAD src0_sel:DWORD src1_sel:WORD_1
    ds_read_b64 v[96:97], v96
    ds_read_b64 v[98:99], v98
    v_lshlrev_b32_sdwa v100, 3, v125 dst_sel:DWORD dst_unused:UNUSED_PAD src0_sel:DWORD src1_sel:WORD_0
    v_lshlrev_b32_sdwa v102, 3, v125 dst_sel:DWORD dst_unused:UNUSED_PAD src0_sel:DWORD src1_sel:WORD_1
    ds_read_b64 v[100:101], v100
    ds_read_b64 v[102:103], v102
    s_waitcnt lgkmcnt(8)
    v_smfmac_f32_16x16x64_bf16 v[0:3], v[64:67], v[104:111], v68
    s_waitcnt vmcnt(5)
    v_mfma_f32_16x16x32_bf16 v[112:115], v[72:75], v[128:131], 0
    v_lshlrev_b32_sdwa v104, 3, v126 dst_sel:DWORD dst_unused:UNUSED_PAD src0_sel:DWORD src1_sel:WORD_0
    v_lshlrev_b32_sdwa v106, 3, v126 dst_sel:DWORD dst_unused:UNUSED_PAD src0_sel:DWORD src1_sel:WORD_1
    ds_read_b64 v[104:105], v104
    ds_read_b64 v[106:107], v106
    s_waitcnt vmcnt(4)
    v_mfma_f32_16x16x32_bf16 v[112:115], v[76:79], v[132:135], v[112:115]
    v_lshlrev_b32_sdwa v108, 3, v127 dst_sel:DWORD dst_unused:UNUSED_PAD src0_sel:DWORD src1_sel:WORD_0
    v_lshlrev_b32_sdwa v110, 3, v127 dst_sel:DWORD dst_unused:UNUSED_PAD src0_sel:DWORD src1_sel:WORD_1
    ds_read_b64 v[108:109], v108
    ds_read_b64 v[110:111], v110
    buffer_load_dwordx4 v[124:127], v69, s[12:15], s20 offen offset:0 sc1
    s_waitcnt lgkmcnt(8)
    v_smfmac_f32_16x16x64_bf16 v[4:7], v[64:67], v[88:95], v68
    s_waitcnt vmcnt(4)
    v_mfma_f32_16x16x32_bf16 v[112:115], v[80:83], v[136:139], v[112:115]
    s_waitcnt vmcnt(2)
    v_lshlrev_b32_sdwa v88, 3, v116 dst_sel:DWORD dst_unused:UNUSED_PAD src0_sel:DWORD src1_sel:WORD_0
    v_lshlrev_b32_sdwa v90, 3, v116 dst_sel:DWORD dst_unused:UNUSED_PAD src0_sel:DWORD src1_sel:WORD_1
    ds_read_b64 v[88:89], v88
    ds_read_b64 v[90:91], v90
    s_waitcnt vmcnt(3)
    v_mfma_f32_16x16x32_bf16 v[112:115], v[84:87], v[140:143], v[112:115]
    v_lshlrev_b32_sdwa v92, 3, v117 dst_sel:DWORD dst_unused:UNUSED_PAD src0_sel:DWORD src1_sel:WORD_0
    v_lshlrev_b32_sdwa v94, 3, v117 dst_sel:DWORD dst_unused:UNUSED_PAD src0_sel:DWORD src1_sel:WORD_1
    ds_read_b64 v[92:93], v92
    ds_read_b64 v[94:95], v94
    s_waitcnt lgkmcnt(8)
    v_smfmac_f32_16x16x64_bf16 v[8:11], v[64:67], v[96:103], v68
    s_nop 1
    v_cvt_pk_bf16_f32 v112, v112, v113
    v_cvt_pk_bf16_f32 v113, v114, v115
    ds_write_b64 v70, v[112:113] offset:0
    v_mfma_f32_16x16x32_bf16 v[112:115], v[72:75], v[144:147], 0
    v_mfma_f32_16x16x32_bf16 v[112:115], v[76:79], v[148:151], v[112:115]
    v_lshlrev_b32_sdwa v96, 3, v118 dst_sel:DWORD dst_unused:UNUSED_PAD src0_sel:DWORD src1_sel:WORD_0
    v_lshlrev_b32_sdwa v98, 3, v118 dst_sel:DWORD dst_unused:UNUSED_PAD src0_sel:DWORD src1_sel:WORD_1
    ds_read_b64 v[96:97], v96
    ds_read_b64 v[98:99], v98
    v_mfma_f32_16x16x32_bf16 v[112:115], v[80:83], v[152:155], v[112:115]
    v_mfma_f32_16x16x32_bf16 v[112:115], v[84:87], v[156:159], v[112:115]
    v_lshlrev_b32_sdwa v100, 3, v119 dst_sel:DWORD dst_unused:UNUSED_PAD src0_sel:DWORD src1_sel:WORD_0
    v_lshlrev_b32_sdwa v102, 3, v119 dst_sel:DWORD dst_unused:UNUSED_PAD src0_sel:DWORD src1_sel:WORD_1
    ds_read_b64 v[100:101], v100
    ds_read_b64 v[102:103], v102
    buffer_load_dwordx4 v[116:119], v69, s[12:15], s20 offen offset:1024 sc1
    s_waitcnt lgkmcnt(9)
    v_smfmac_f32_16x16x64_bf16 v[12:15], v[64:67], v[104:111], v68
    s_nop 0
    v_cvt_pk_bf16_f32 v112, v112, v113
    v_cvt_pk_bf16_f32 v113, v114, v115
    ds_write_b64 v70, v[112:113] offset:128
    v_mfma_f32_16x16x32_bf16 v[112:115], v[72:75], v[160:163], 0
    s_waitcnt vmcnt(2)
    v_lshlrev_b32_sdwa v104, 3, v120 dst_sel:DWORD dst_unused:UNUSED_PAD src0_sel:DWORD src1_sel:WORD_0
    v_lshlrev_b32_sdwa v106, 3, v120 dst_sel:DWORD dst_unused:UNUSED_PAD src0_sel:DWORD src1_sel:WORD_1
    ds_read_b64 v[104:105], v104
    ds_read_b64 v[106:107], v106
    v_mfma_f32_16x16x32_bf16 v[112:115], v[76:79], v[164:167], v[112:115]
    v_lshlrev_b32_sdwa v108, 3, v121 dst_sel:DWORD dst_unused:UNUSED_PAD src0_sel:DWORD src1_sel:WORD_0
    v_lshlrev_b32_sdwa v110, 3, v121 dst_sel:DWORD dst_unused:UNUSED_PAD src0_sel:DWORD src1_sel:WORD_1
    ds_read_b64 v[108:109], v108
    ds_read_b64 v[110:111], v110
    s_waitcnt lgkmcnt(10)
    v_smfmac_f32_16x16x64_bf16 v[16:19], v[64:67], v[88:95], v68
    v_mfma_f32_16x16x32_bf16 v[112:115], v[80:83], v[168:171], v[112:115]
    v_lshlrev_b32_sdwa v88, 3, v122 dst_sel:DWORD dst_unused:UNUSED_PAD src0_sel:DWORD src1_sel:WORD_0
    v_lshlrev_b32_sdwa v90, 3, v122 dst_sel:DWORD dst_unused:UNUSED_PAD src0_sel:DWORD src1_sel:WORD_1
    ds_read_b64 v[88:89], v88
    ds_read_b64 v[90:91], v90
    v_mfma_f32_16x16x32_bf16 v[112:115], v[84:87], v[172:175], v[112:115]
    v_lshlrev_b32_sdwa v92, 3, v123 dst_sel:DWORD dst_unused:UNUSED_PAD src0_sel:DWORD src1_sel:WORD_0
    v_lshlrev_b32_sdwa v94, 3, v123 dst_sel:DWORD dst_unused:UNUSED_PAD src0_sel:DWORD src1_sel:WORD_1
    ds_read_b64 v[92:93], v92
    ds_read_b64 v[94:95], v94
    buffer_load_dwordx4 v[120:123], v69, s[12:15], s20 offen offset:2048 sc1
    s_waitcnt lgkmcnt(9)
    v_smfmac_f32_16x16x64_bf16 v[20:23], v[64:67], v[96:103], v68
    s_nop 0
    v_cvt_pk_bf16_f32 v112, v112, v113
    v_cvt_pk_bf16_f32 v113, v114, v115
    ds_write_b64 v70, v[112:113] offset:256
    v_mfma_f32_16x16x32_bf16 v[112:115], v[72:75], v[176:179], 0
    v_mfma_f32_16x16x32_bf16 v[112:115], v[76:79], v[180:183], v[112:115]
    s_waitcnt vmcnt(2)
    v_lshlrev_b32_sdwa v96, 3, v124 dst_sel:DWORD dst_unused:UNUSED_PAD src0_sel:DWORD src1_sel:WORD_0
    v_lshlrev_b32_sdwa v98, 3, v124 dst_sel:DWORD dst_unused:UNUSED_PAD src0_sel:DWORD src1_sel:WORD_1
    ds_read_b64 v[96:97], v96
    ds_read_b64 v[98:99], v98
    v_mfma_f32_16x16x32_bf16 v[112:115], v[80:83], v[184:187], v[112:115]
    v_mfma_f32_16x16x32_bf16 v[112:115], v[84:87], v[188:191], v[112:115]
    v_lshlrev_b32_sdwa v100, 3, v125 dst_sel:DWORD dst_unused:UNUSED_PAD src0_sel:DWORD src1_sel:WORD_0
    v_lshlrev_b32_sdwa v102, 3, v125 dst_sel:DWORD dst_unused:UNUSED_PAD src0_sel:DWORD src1_sel:WORD_1
    ds_read_b64 v[100:101], v100
    ds_read_b64 v[102:103], v102
    s_waitcnt lgkmcnt(9)
    v_smfmac_f32_16x16x64_bf16 v[24:27], v[64:67], v[104:111], v68
    s_nop 1
    v_cvt_pk_bf16_f32 v112, v112, v113
    v_cvt_pk_bf16_f32 v113, v114, v115
    ds_write_b64 v70, v[112:113] offset:384
    v_mfma_f32_16x16x32_bf16 v[112:115], v[72:75], v[192:195], 0
    v_lshlrev_b32_sdwa v104, 3, v126 dst_sel:DWORD dst_unused:UNUSED_PAD src0_sel:DWORD src1_sel:WORD_0
    v_lshlrev_b32_sdwa v106, 3, v126 dst_sel:DWORD dst_unused:UNUSED_PAD src0_sel:DWORD src1_sel:WORD_1
    ds_read_b64 v[104:105], v104
    ds_read_b64 v[106:107], v106
    v_mfma_f32_16x16x32_bf16 v[112:115], v[76:79], v[196:199], v[112:115]
    v_lshlrev_b32_sdwa v108, 3, v127 dst_sel:DWORD dst_unused:UNUSED_PAD src0_sel:DWORD src1_sel:WORD_0
    v_lshlrev_b32_sdwa v110, 3, v127 dst_sel:DWORD dst_unused:UNUSED_PAD src0_sel:DWORD src1_sel:WORD_1
    ds_read_b64 v[108:109], v108
    ds_read_b64 v[110:111], v110
    buffer_load_dwordx4 v[124:127], v69, s[12:15], s20 offen offset:3072 sc1
    s_add_u32 s20, s20, 61440
    s_waitcnt lgkmcnt(10)
    v_smfmac_f32_16x16x64_bf16 v[28:31], v[64:67], v[88:95], v68
    s_setprio 2
    v_mfma_f32_16x16x32_bf16 v[112:115], v[80:83], v[200:203], v[112:115]
    s_waitcnt vmcnt(2)
    v_lshlrev_b32_sdwa v88, 3, v116 dst_sel:DWORD dst_unused:UNUSED_PAD src0_sel:DWORD src1_sel:WORD_0
    v_lshlrev_b32_sdwa v90, 3, v116 dst_sel:DWORD dst_unused:UNUSED_PAD src0_sel:DWORD src1_sel:WORD_1
    ds_read_b64 v[88:89], v88
    ds_read_b64 v[90:91], v90
    v_mfma_f32_16x16x32_bf16 v[112:115], v[84:87], v[204:207], v[112:115]
    v_lshlrev_b32_sdwa v92, 3, v117 dst_sel:DWORD dst_unused:UNUSED_PAD src0_sel:DWORD src1_sel:WORD_0
    v_lshlrev_b32_sdwa v94, 3, v117 dst_sel:DWORD dst_unused:UNUSED_PAD src0_sel:DWORD src1_sel:WORD_1
    ds_read_b64 v[92:93], v92
    ds_read_b64 v[94:95], v94
    s_waitcnt lgkmcnt(9)
    v_smfmac_f32_16x16x64_bf16 v[32:35], v[64:67], v[96:103], v68
    s_nop 1
    v_cvt_pk_bf16_f32 v112, v112, v113
    v_cvt_pk_bf16_f32 v113, v114, v115
    ds_write_b64 v70, v[112:113] offset:512
    v_mfma_f32_16x16x32_bf16 v[112:115], v[72:75], v[208:211], 0
    v_lshlrev_b32_sdwa v96, 3, v118 dst_sel:DWORD dst_unused:UNUSED_PAD src0_sel:DWORD src1_sel:WORD_0
    v_lshlrev_b32_sdwa v98, 3, v118 dst_sel:DWORD dst_unused:UNUSED_PAD src0_sel:DWORD src1_sel:WORD_1
    ds_read_b64 v[96:97], v96
    ds_read_b64 v[98:99], v98
    v_mfma_f32_16x16x32_bf16 v[112:115], v[76:79], v[212:215], v[112:115]
    v_lshlrev_b32_sdwa v100, 3, v119 dst_sel:DWORD dst_unused:UNUSED_PAD src0_sel:DWORD src1_sel:WORD_0
    v_lshlrev_b32_sdwa v102, 3, v119 dst_sel:DWORD dst_unused:UNUSED_PAD src0_sel:DWORD src1_sel:WORD_1
    ds_read_b64 v[100:101], v100
    ds_read_b64 v[102:103], v102
    buffer_load_dwordx4 v[116:119], v69, s[12:15], s20 offen offset:0 sc1
    s_waitcnt lgkmcnt(9)
    v_smfmac_f32_16x16x64_bf16 v[36:39], v[64:67], v[104:111], v68
    v_mfma_f32_16x16x32_bf16 v[112:115], v[80:83], v[216:219], v[112:115]
    s_waitcnt vmcnt(2)
    v_lshlrev_b32_sdwa v104, 3, v120 dst_sel:DWORD dst_unused:UNUSED_PAD src0_sel:DWORD src1_sel:WORD_0
    v_lshlrev_b32_sdwa v106, 3, v120 dst_sel:DWORD dst_unused:UNUSED_PAD src0_sel:DWORD src1_sel:WORD_1
    ds_read_b64 v[104:105], v104
    ds_read_b64 v[106:107], v106
    v_mfma_f32_16x16x32_bf16 v[112:115], v[84:87], v[220:223], v[112:115]
    v_lshlrev_b32_sdwa v108, 3, v121 dst_sel:DWORD dst_unused:UNUSED_PAD src0_sel:DWORD src1_sel:WORD_0
    v_lshlrev_b32_sdwa v110, 3, v121 dst_sel:DWORD dst_unused:UNUSED_PAD src0_sel:DWORD src1_sel:WORD_1
    ds_read_b64 v[108:109], v108
    ds_read_b64 v[110:111], v110
    s_waitcnt lgkmcnt(9)
    v_smfmac_f32_16x16x64_bf16 v[40:43], v[64:67], v[88:95], v68
    s_nop 1
    v_cvt_pk_bf16_f32 v112, v112, v113
    v_cvt_pk_bf16_f32 v113, v114, v115
    ds_write_b64 v70, v[112:113] offset:640
    v_mfma_f32_16x16x32_bf16 v[112:115], v[72:75], v[224:227], 0
    v_mfma_f32_16x16x32_bf16 v[112:115], v[76:79], v[228:231], v[112:115]
    v_lshlrev_b32_sdwa v88, 3, v122 dst_sel:DWORD dst_unused:UNUSED_PAD src0_sel:DWORD src1_sel:WORD_0
    v_lshlrev_b32_sdwa v90, 3, v122 dst_sel:DWORD dst_unused:UNUSED_PAD src0_sel:DWORD src1_sel:WORD_1
    ds_read_b64 v[88:89], v88
    ds_read_b64 v[90:91], v90
    v_mfma_f32_16x16x32_bf16 v[112:115], v[80:83], v[232:235], v[112:115]
    v_mfma_f32_16x16x32_bf16 v[112:115], v[84:87], v[236:239], v[112:115]
    v_lshlrev_b32_sdwa v92, 3, v123 dst_sel:DWORD dst_unused:UNUSED_PAD src0_sel:DWORD src1_sel:WORD_0
    v_lshlrev_b32_sdwa v94, 3, v123 dst_sel:DWORD dst_unused:UNUSED_PAD src0_sel:DWORD src1_sel:WORD_1
    ds_read_b64 v[92:93], v92
    ds_read_b64 v[94:95], v94
    buffer_load_dwordx4 v[120:123], v69, s[12:15], s20 offen offset:1024 sc1
    s_waitcnt lgkmcnt(9)
    v_smfmac_f32_16x16x64_bf16 v[44:47], v[64:67], v[96:103], v68
    s_nop 0
    v_cvt_pk_bf16_f32 v112, v112, v113
    v_cvt_pk_bf16_f32 v113, v114, v115
    ds_write_b64 v70, v[112:113] offset:768
    s_setprio 1
    v_mfma_f32_16x16x32_bf16 v[112:115], v[72:75], v[240:243], 0
    buffer_load_dwordx4 v[72:75], v69, s[12:15], s21 offen offset:0
    s_waitcnt vmcnt(3)
    v_lshlrev_b32_sdwa v96, 3, v124 dst_sel:DWORD dst_unused:UNUSED_PAD src0_sel:DWORD src1_sel:WORD_0
    v_lshlrev_b32_sdwa v98, 3, v124 dst_sel:DWORD dst_unused:UNUSED_PAD src0_sel:DWORD src1_sel:WORD_1
    ds_read_b64 v[96:97], v96
    ds_read_b64 v[98:99], v98
    v_mfma_f32_16x16x32_bf16 v[112:115], v[76:79], v[244:247], v[112:115]
    buffer_load_dwordx4 v[76:79], v69, s[12:15], s21 offen offset:1024
    v_lshlrev_b32_sdwa v100, 3, v125 dst_sel:DWORD dst_unused:UNUSED_PAD src0_sel:DWORD src1_sel:WORD_0
    v_lshlrev_b32_sdwa v102, 3, v125 dst_sel:DWORD dst_unused:UNUSED_PAD src0_sel:DWORD src1_sel:WORD_1
    ds_read_b64 v[100:101], v100
    ds_read_b64 v[102:103], v102
    s_waitcnt lgkmcnt(10)
    v_smfmac_f32_16x16x64_bf16 v[48:51], v[64:67], v[104:111], v68
    v_mfma_f32_16x16x32_bf16 v[112:115], v[80:83], v[248:251], v[112:115]
    buffer_load_dwordx4 v[80:83], v69, s[12:15], s19 offen offset:0
    v_lshlrev_b32_sdwa v104, 3, v126 dst_sel:DWORD dst_unused:UNUSED_PAD src0_sel:DWORD src1_sel:WORD_0
    v_lshlrev_b32_sdwa v106, 3, v126 dst_sel:DWORD dst_unused:UNUSED_PAD src0_sel:DWORD src1_sel:WORD_1
    ds_read_b64 v[104:105], v104
    ds_read_b64 v[106:107], v106
    v_mfma_f32_16x16x32_bf16 v[112:115], v[84:87], v[252:255], v[112:115]
    buffer_load_dwordx4 v[84:87], v69, s[12:15], s19 offen offset:1024
    s_add_u32 s21, s21, 4096
    s_add_u32 s19, s19, 4096
    v_lshlrev_b32_sdwa v108, 3, v127 dst_sel:DWORD dst_unused:UNUSED_PAD src0_sel:DWORD src1_sel:WORD_0
    v_lshlrev_b32_sdwa v110, 3, v127 dst_sel:DWORD dst_unused:UNUSED_PAD src0_sel:DWORD src1_sel:WORD_1
    ds_read_b64 v[108:109], v108
    ds_read_b64 v[110:111], v110
    buffer_load_dwordx4 v[124:127], v69, s[12:15], s20 offen offset:2048 sc1
    s_waitcnt lgkmcnt(9)
    v_smfmac_f32_16x16x64_bf16 v[52:55], v[64:67], v[88:95], v68
    v_cvt_pk_bf16_f32 v112, v112, v113
    v_cvt_pk_bf16_f32 v113, v114, v115
    ds_write_b64 v70, v[112:113] offset:896
    s_add_u32 s23, s23, 1
    s_cmp_eq_u32 s23, 5
    s_cselect_b32 s35, 4294836224, s32
    s_cselect_b32 s23, 0, s23
    v_add_u32 v70, s35, v70
    s_waitcnt vmcnt(6)
    v_lshlrev_b32_sdwa v88, 3, v116 dst_sel:DWORD dst_unused:UNUSED_PAD src0_sel:DWORD src1_sel:WORD_0
    v_lshlrev_b32_sdwa v90, 3, v116 dst_sel:DWORD dst_unused:UNUSED_PAD src0_sel:DWORD src1_sel:WORD_1
    ds_read_b64 v[88:89], v88
    ds_read_b64 v[90:91], v90
    v_lshlrev_b32_sdwa v92, 3, v117 dst_sel:DWORD dst_unused:UNUSED_PAD src0_sel:DWORD src1_sel:WORD_0
    v_lshlrev_b32_sdwa v94, 3, v117 dst_sel:DWORD dst_unused:UNUSED_PAD src0_sel:DWORD src1_sel:WORD_1
    ds_read_b64 v[92:93], v92
    ds_read_b64 v[94:95], v94
    s_waitcnt lgkmcnt(9)
    v_smfmac_f32_16x16x64_bf16 v[56:59], v[64:67], v[96:103], v68
    s_setprio 0
    v_lshlrev_b32_sdwa v96, 3, v118 dst_sel:DWORD dst_unused:UNUSED_PAD src0_sel:DWORD src1_sel:WORD_0
    v_lshlrev_b32_sdwa v98, 3, v118 dst_sel:DWORD dst_unused:UNUSED_PAD src0_sel:DWORD src1_sel:WORD_1
    ds_read_b64 v[96:97], v96
    ds_read_b64 v[98:99], v98
    v_lshlrev_b32_sdwa v100, 3, v119 dst_sel:DWORD dst_unused:UNUSED_PAD src0_sel:DWORD src1_sel:WORD_0
    v_lshlrev_b32_sdwa v102, 3, v119 dst_sel:DWORD dst_unused:UNUSED_PAD src0_sel:DWORD src1_sel:WORD_1
    ds_read_b64 v[100:101], v100
    ds_read_b64 v[102:103], v102
    buffer_load_dwordx4 v[116:119], v69, s[12:15], s20 offen offset:3072 sc1
    s_add_u32 s20, s20, 4096
    s_waitcnt lgkmcnt(9)
    v_smfmac_f32_16x16x64_bf16 v[60:63], v[64:67], v[104:111], v68
    s_waitcnt lgkmcnt(8)
    s_barrier

    s_add_u32 s22, s22, 1
    s_branch k1_kernel_gloop

k1_kernel_fin:

    s_add_u32 s40, s20, 61440
    s_add_u32 s41, s20, 65536
    s_add_u32 s44, s20, 126976
    s_add_u32 s45, s20, 131072

    s_lshl_b32 s28, s38, 16
    s_and_b32 s29, s38, 0xffff0000
    s_lshl_b32 s30, s39, 16
    s_and_b32 s31, s39, 0xffff0000
    s_lshl_b32 s35, s33, 16
    s_lshl_b32 s42, s34, 15
    s_add_u32 s35, s35, s42
    s_lshl_b32 s42, s3, 12
    s_add_u32 s35, s35, s42
    s_add_u32 s35, s35, 20971520

    s_and_b32 s57, s57, 0xffff
    s_mov_b32 s58, 2
    s_mov_b32 s59, 0x00020000
    s_and_b32 s61, s61, 0xffff
    s_mov_b32 s62, 32768
    s_mov_b32 s63, 0x00020000
    s_xor_b32 s64, s34, 1
    s_lshl_b32 s64, s64, 7
    s_add_u32 s64, s64, s33
    s_lshl_b32 s65, s3, 20
    s_add_u32 s66, s65, 1048576
    s_lshl_b32 s67, s3, 8
    s_lshl_b32 s68, s64, 7
    s_lshl_b32 s69, s64, 8
    s_add_u32 s69, s69, s65
    s_add_u32 s69, s69, 20971520
    s_mov_b32 s42, 0
    s_mov_b32 s43, 0

    s_setprio 3
    v_mov_b32 v128, 0xbdd2d3e8
    v_mov_b32 v129, 0xbdd2d3e8
    v_mov_b32 v130, 0xc0135761
    v_mov_b32 v131, 0xc0135761
    v_mov_b32 v132, 1.0
    v_mov_b32 v133, 1.0
    v_mov_b32 v134, s28
    v_mov_b32 v135, s29
    v_mov_b32 v136, s30
    s_waitcnt vmcnt(6)
    v_lshlrev_b32_sdwa v88, 3, v116 dst_sel:DWORD dst_unused:UNUSED_PAD src0_sel:DWORD src1_sel:WORD_0
    v_lshlrev_b32_sdwa v90, 3, v116 dst_sel:DWORD dst_unused:UNUSED_PAD src0_sel:DWORD src1_sel:WORD_1
    ds_read_b64 v[88:89], v88
    ds_read_b64 v[90:91], v90
    v_lshlrev_b32_sdwa v92, 3, v117 dst_sel:DWORD dst_unused:UNUSED_PAD src0_sel:DWORD src1_sel:WORD_0
    v_lshlrev_b32_sdwa v94, 3, v117 dst_sel:DWORD dst_unused:UNUSED_PAD src0_sel:DWORD src1_sel:WORD_1
    ds_read_b64 v[92:93], v92
    ds_read_b64 v[94:95], v94
    s_waitcnt lgkmcnt(8)
    v_smfmac_f32_16x16x64_bf16 v[0:3], v[64:67], v[96:103], v68
    v_mov_b32 v137, s31
    v_lshrrev_b32 v70, 2, v69
    v_and_b32 v71, 128, v70
    v_add_u32 v70, v70, v71
    v_rcp_f32 v134, v134
    v_rcp_f32 v135, v135
    v_rcp_f32 v136, v136
    v_rcp_f32 v137, v137
    v_mov_b32 v132, 0x7f7fffff
    v_lshlrev_b32_sdwa v96, 3, v118 dst_sel:DWORD dst_unused:UNUSED_PAD src0_sel:DWORD src1_sel:WORD_0
    v_lshlrev_b32_sdwa v98, 3, v118 dst_sel:DWORD dst_unused:UNUSED_PAD src0_sel:DWORD src1_sel:WORD_1
    ds_read_b64 v[96:97], v96
    ds_read_b64 v[98:99], v98
    v_lshlrev_b32_sdwa v100, 3, v119 dst_sel:DWORD dst_unused:UNUSED_PAD src0_sel:DWORD src1_sel:WORD_0
    v_lshlrev_b32_sdwa v102, 3, v119 dst_sel:DWORD dst_unused:UNUSED_PAD src0_sel:DWORD src1_sel:WORD_1
    ds_read_b64 v[100:101], v100
    ds_read_b64 v[102:103], v102
    buffer_load_dwordx4 v[116:119], v69, s[12:15], s40 offen offset:0 sc1
    s_waitcnt lgkmcnt(8)
    v_smfmac_f32_16x16x64_bf16 v[4:7], v[64:67], v[104:111], v68
    v_mov_b32 v133, 0xff7fffff
    v_med3_f32 v134, v134, v132, v133
    v_med3_f32 v135, v135, v132, v133
    v_med3_f32 v136, v136, v132, v133
    v_med3_f32 v137, v137, v132, v133
    s_waitcnt vmcnt(3)
    v_mov_b32 v73, 0
    v_lshrrev_b32 v76, 2, v69
    v_mov_b32 v79, 0
    v_and_b32 v75, 0xf0, v69
    s_waitcnt vmcnt(2)
    v_lshlrev_b32_sdwa v104, 3, v120 dst_sel:DWORD dst_unused:UNUSED_PAD src0_sel:DWORD src1_sel:WORD_0
    v_lshlrev_b32_sdwa v106, 3, v120 dst_sel:DWORD dst_unused:UNUSED_PAD src0_sel:DWORD src1_sel:WORD_1
    ds_read_b64 v[104:105], v104
    ds_read_b64 v[106:107], v106
    v_lshlrev_b32_sdwa v108, 3, v121 dst_sel:DWORD dst_unused:UNUSED_PAD src0_sel:DWORD src1_sel:WORD_0
    v_lshlrev_b32_sdwa v110, 3, v121 dst_sel:DWORD dst_unused:UNUSED_PAD src0_sel:DWORD src1_sel:WORD_1
    ds_read_b64 v[108:109], v108
    ds_read_b64 v[110:111], v110
    s_waitcnt lgkmcnt(8)
    v_smfmac_f32_16x16x64_bf16 v[8:11], v[64:67], v[88:95], v68
    v_lshrrev_b32 v80, 8, v69
    v_lshl_add_u32 v74, v80, 16, v75
    v_lshl_add_u32 v75, v80, 2, v75
    v_add_u32 v77, s67, v76
    v_lshrrev_b32 v78, 1, v75
    v_lshlrev_b32_sdwa v88, 3, v122 dst_sel:DWORD dst_unused:UNUSED_PAD src0_sel:DWORD src1_sel:WORD_0
    v_lshlrev_b32_sdwa v90, 3, v122 dst_sel:DWORD dst_unused:UNUSED_PAD src0_sel:DWORD src1_sel:WORD_1
    ds_read_b64 v[88:89], v88
    ds_read_b64 v[90:91], v90
    v_lshlrev_b32_sdwa v92, 3, v123 dst_sel:DWORD dst_unused:UNUSED_PAD src0_sel:DWORD src1_sel:WORD_0
    v_lshlrev_b32_sdwa v94, 3, v123 dst_sel:DWORD dst_unused:UNUSED_PAD src0_sel:DWORD src1_sel:WORD_1
    ds_read_b64 v[92:93], v92
    ds_read_b64 v[94:95], v94
    buffer_load_dwordx4 v[120:123], v69, s[12:15], s44 offen offset:0 sc1
    s_waitcnt lgkmcnt(8)
    v_smfmac_f32_16x16x64_bf16 v[12:15], v[64:67], v[96:103], v68
    s_waitcnt vmcnt(2)
    v_lshlrev_b32_sdwa v96, 3, v124 dst_sel:DWORD dst_unused:UNUSED_PAD src0_sel:DWORD src1_sel:WORD_0
    v_lshlrev_b32_sdwa v98, 3, v124 dst_sel:DWORD dst_unused:UNUSED_PAD src0_sel:DWORD src1_sel:WORD_1
    ds_read_b64 v[96:97], v96
    ds_read_b64 v[98:99], v98
    v_lshlrev_b32_sdwa v100, 3, v125 dst_sel:DWORD dst_unused:UNUSED_PAD src0_sel:DWORD src1_sel:WORD_0
    v_lshlrev_b32_sdwa v102, 3, v125 dst_sel:DWORD dst_unused:UNUSED_PAD src0_sel:DWORD src1_sel:WORD_1
    ds_read_b64 v[100:101], v100
    ds_read_b64 v[102:103], v102
    s_waitcnt lgkmcnt(8)
    v_smfmac_f32_16x16x64_bf16 v[16:19], v[64:67], v[104:111], v68
    v_lshlrev_b32_sdwa v104, 3, v126 dst_sel:DWORD dst_unused:UNUSED_PAD src0_sel:DWORD src1_sel:WORD_0
    v_lshlrev_b32_sdwa v106, 3, v126 dst_sel:DWORD dst_unused:UNUSED_PAD src0_sel:DWORD src1_sel:WORD_1
    ds_read_b64 v[104:105], v104
    ds_read_b64 v[106:107], v106
    v_lshlrev_b32_sdwa v108, 3, v127 dst_sel:DWORD dst_unused:UNUSED_PAD src0_sel:DWORD src1_sel:WORD_0
    v_lshlrev_b32_sdwa v110, 3, v127 dst_sel:DWORD dst_unused:UNUSED_PAD src0_sel:DWORD src1_sel:WORD_1
    ds_read_b64 v[108:109], v108
    ds_read_b64 v[110:111], v110
    buffer_load_dwordx4 v[124:127], v69, s[12:15], s40 offen offset:1024 sc1
    s_waitcnt lgkmcnt(8)
    v_smfmac_f32_16x16x64_bf16 v[20:23], v[64:67], v[88:95], v68
    s_waitcnt vmcnt(2)
    v_lshlrev_b32_sdwa v88, 3, v116 dst_sel:DWORD dst_unused:UNUSED_PAD src0_sel:DWORD src1_sel:WORD_0
    v_lshlrev_b32_sdwa v90, 3, v116 dst_sel:DWORD dst_unused:UNUSED_PAD src0_sel:DWORD src1_sel:WORD_1
    ds_read_b64 v[88:89], v88
    ds_read_b64 v[90:91], v90
    v_lshlrev_b32_sdwa v92, 3, v117 dst_sel:DWORD dst_unused:UNUSED_PAD src0_sel:DWORD src1_sel:WORD_0
    v_lshlrev_b32_sdwa v94, 3, v117 dst_sel:DWORD dst_unused:UNUSED_PAD src0_sel:DWORD src1_sel:WORD_1
    ds_read_b64 v[92:93], v92
    ds_read_b64 v[94:95], v94
    s_waitcnt lgkmcnt(8)
    v_smfmac_f32_16x16x64_bf16 v[24:27], v[64:67], v[96:103], v68
    v_lshlrev_b32_sdwa v96, 3, v118 dst_sel:DWORD dst_unused:UNUSED_PAD src0_sel:DWORD src1_sel:WORD_0
    v_lshlrev_b32_sdwa v98, 3, v118 dst_sel:DWORD dst_unused:UNUSED_PAD src0_sel:DWORD src1_sel:WORD_1
    ds_read_b64 v[96:97], v96
    ds_read_b64 v[98:99], v98
    v_lshlrev_b32_sdwa v100, 3, v119 dst_sel:DWORD dst_unused:UNUSED_PAD src0_sel:DWORD src1_sel:WORD_0
    v_lshlrev_b32_sdwa v102, 3, v119 dst_sel:DWORD dst_unused:UNUSED_PAD src0_sel:DWORD src1_sel:WORD_1
    ds_read_b64 v[100:101], v100
    ds_read_b64 v[102:103], v102
    buffer_load_dwordx4 v[116:119], v69, s[12:15], s44 offen offset:1024 sc1
    s_waitcnt lgkmcnt(8)
    v_smfmac_f32_16x16x64_bf16 v[28:31], v[64:67], v[104:111], v68
    s_waitcnt vmcnt(2)
    v_lshlrev_b32_sdwa v104, 3, v120 dst_sel:DWORD dst_unused:UNUSED_PAD src0_sel:DWORD src1_sel:WORD_0
    v_lshlrev_b32_sdwa v106, 3, v120 dst_sel:DWORD dst_unused:UNUSED_PAD src0_sel:DWORD src1_sel:WORD_1
    ds_read_b64 v[104:105], v104
    ds_read_b64 v[106:107], v106
    v_lshlrev_b32_sdwa v108, 3, v121 dst_sel:DWORD dst_unused:UNUSED_PAD src0_sel:DWORD src1_sel:WORD_0
    v_lshlrev_b32_sdwa v110, 3, v121 dst_sel:DWORD dst_unused:UNUSED_PAD src0_sel:DWORD src1_sel:WORD_1
    ds_read_b64 v[108:109], v108
    ds_read_b64 v[110:111], v110
    s_waitcnt lgkmcnt(8)
    v_smfmac_f32_16x16x64_bf16 v[0:3], v[64:67], v[88:95], v68
    v_lshlrev_b32_sdwa v88, 3, v122 dst_sel:DWORD dst_unused:UNUSED_PAD src0_sel:DWORD src1_sel:WORD_0
    v_lshlrev_b32_sdwa v90, 3, v122 dst_sel:DWORD dst_unused:UNUSED_PAD src0_sel:DWORD src1_sel:WORD_1
    ds_read_b64 v[88:89], v88
    ds_read_b64 v[90:91], v90
    v_lshlrev_b32_sdwa v92, 3, v123 dst_sel:DWORD dst_unused:UNUSED_PAD src0_sel:DWORD src1_sel:WORD_0
    v_lshlrev_b32_sdwa v94, 3, v123 dst_sel:DWORD dst_unused:UNUSED_PAD src0_sel:DWORD src1_sel:WORD_1
    ds_read_b64 v[92:93], v92
    ds_read_b64 v[94:95], v94
    buffer_load_dwordx4 v[120:123], v69, s[12:15], s40 offen offset:2048 sc1
    s_waitcnt lgkmcnt(8)
    v_smfmac_f32_16x16x64_bf16 v[4:7], v[64:67], v[96:103], v68
    s_waitcnt vmcnt(2)
    v_lshlrev_b32_sdwa v96, 3, v124 dst_sel:DWORD dst_unused:UNUSED_PAD src0_sel:DWORD src1_sel:WORD_0
    v_lshlrev_b32_sdwa v98, 3, v124 dst_sel:DWORD dst_unused:UNUSED_PAD src0_sel:DWORD src1_sel:WORD_1
    ds_read_b64 v[96:97], v96
    ds_read_b64 v[98:99], v98
    v_lshlrev_b32_sdwa v100, 3, v125 dst_sel:DWORD dst_unused:UNUSED_PAD src0_sel:DWORD src1_sel:WORD_0
    v_lshlrev_b32_sdwa v102, 3, v125 dst_sel:DWORD dst_unused:UNUSED_PAD src0_sel:DWORD src1_sel:WORD_1
    ds_read_b64 v[100:101], v100
    ds_read_b64 v[102:103], v102
    s_waitcnt lgkmcnt(8)
    v_smfmac_f32_16x16x64_bf16 v[0:3], v[64:67], v[104:111], v68
    v_lshlrev_b32_sdwa v104, 3, v126 dst_sel:DWORD dst_unused:UNUSED_PAD src0_sel:DWORD src1_sel:WORD_0
    v_lshlrev_b32_sdwa v106, 3, v126 dst_sel:DWORD dst_unused:UNUSED_PAD src0_sel:DWORD src1_sel:WORD_1
    ds_read_b64 v[104:105], v104
    ds_read_b64 v[106:107], v106
    v_lshlrev_b32_sdwa v108, 3, v127 dst_sel:DWORD dst_unused:UNUSED_PAD src0_sel:DWORD src1_sel:WORD_0
    v_lshlrev_b32_sdwa v110, 3, v127 dst_sel:DWORD dst_unused:UNUSED_PAD src0_sel:DWORD src1_sel:WORD_1
    ds_read_b64 v[108:109], v108
    ds_read_b64 v[110:111], v110
    buffer_load_dwordx4 v[124:127], v69, s[12:15], s44 offen offset:2048 sc1
    s_waitcnt lgkmcnt(8)
    v_smfmac_f32_16x16x64_bf16 v[4:7], v[64:67], v[88:95], v68
    s_waitcnt vmcnt(2)
    v_lshlrev_b32_sdwa v88, 3, v116 dst_sel:DWORD dst_unused:UNUSED_PAD src0_sel:DWORD src1_sel:WORD_0
    v_lshlrev_b32_sdwa v90, 3, v116 dst_sel:DWORD dst_unused:UNUSED_PAD src0_sel:DWORD src1_sel:WORD_1
    ds_read_b64 v[88:89], v88
    ds_read_b64 v[90:91], v90
    v_lshlrev_b32_sdwa v92, 3, v117 dst_sel:DWORD dst_unused:UNUSED_PAD src0_sel:DWORD src1_sel:WORD_0
    v_lshlrev_b32_sdwa v94, 3, v117 dst_sel:DWORD dst_unused:UNUSED_PAD src0_sel:DWORD src1_sel:WORD_1
    ds_read_b64 v[92:93], v92
    ds_read_b64 v[94:95], v94
    s_waitcnt lgkmcnt(8)
    v_smfmac_f32_16x16x64_bf16 v[8:11], v[64:67], v[96:103], v68
    v_pk_mul_f32 v[140:141], v[0:1], v[0:1]
    v_pk_mul_f32 v[142:143], v[2:3], v[2:3]
    v_pk_fma_f32 v[140:141], v[140:141], v[128:129], v[130:131]
    v_pk_fma_f32 v[142:143], v[142:143], v[128:129], v[130:131]
    v_pk_mul_f32 v[140:141], v[140:141], v[0:1]
    v_pk_mul_f32 v[142:143], v[142:143], v[2:3]
    v_exp_f32 v140, v140
    v_pk_mul_f32 v[146:147], v[4:5], v[4:5]
    v_pk_mul_f32 v[148:149], v[6:7], v[6:7]
    v_lshlrev_b32_sdwa v96, 3, v118 dst_sel:DWORD dst_unused:UNUSED_PAD src0_sel:DWORD src1_sel:WORD_0
    v_lshlrev_b32_sdwa v98, 3, v118 dst_sel:DWORD dst_unused:UNUSED_PAD src0_sel:DWORD src1_sel:WORD_1
    ds_read_b64 v[96:97], v96
    ds_read_b64 v[98:99], v98
    v_lshlrev_b32_sdwa v100, 3, v119 dst_sel:DWORD dst_unused:UNUSED_PAD src0_sel:DWORD src1_sel:WORD_0
    v_lshlrev_b32_sdwa v102, 3, v119 dst_sel:DWORD dst_unused:UNUSED_PAD src0_sel:DWORD src1_sel:WORD_1
    ds_read_b64 v[100:101], v100
    ds_read_b64 v[102:103], v102
    buffer_load_dwordx4 v[116:119], v69, s[12:15], s40 offen offset:3072 sc1
    s_waitcnt lgkmcnt(8)
    v_smfmac_f32_16x16x64_bf16 v[12:15], v[64:67], v[104:111], v68
    v_exp_f32 v141, v141
    v_pk_fma_f32 v[146:147], v[146:147], v[128:129], v[130:131]
    v_pk_fma_f32 v[148:149], v[148:149], v[128:129], v[130:131]
    v_exp_f32 v142, v142
    v_pk_fma_f32 v[140:141], v[140:141], v[134:135], v[134:135]
    v_pk_mul_f32 v[146:147], v[146:147], v[4:5]
    v_rcp_f32 v140, v140
    v_pk_mul_f32 v[148:149], v[148:149], v[6:7]
    v_rcp_f32 v141, v141
    s_waitcnt vmcnt(2)
    v_lshlrev_b32_sdwa v104, 3, v120 dst_sel:DWORD dst_unused:UNUSED_PAD src0_sel:DWORD src1_sel:WORD_0
    v_lshlrev_b32_sdwa v106, 3, v120 dst_sel:DWORD dst_unused:UNUSED_PAD src0_sel:DWORD src1_sel:WORD_1
    ds_read_b64 v[104:105], v104
    ds_read_b64 v[106:107], v106
    v_lshlrev_b32_sdwa v108, 3, v121 dst_sel:DWORD dst_unused:UNUSED_PAD src0_sel:DWORD src1_sel:WORD_0
    v_lshlrev_b32_sdwa v110, 3, v121 dst_sel:DWORD dst_unused:UNUSED_PAD src0_sel:DWORD src1_sel:WORD_1
    ds_read_b64 v[108:109], v108
    ds_read_b64 v[110:111], v110
    s_waitcnt lgkmcnt(8)
    v_smfmac_f32_16x16x64_bf16 v[8:11], v[64:67], v[88:95], v68
    v_exp_f32 v143, v143
    v_pk_mul_f32 v[144:145], v[0:1], v[140:141]
    v_exp_f32 v146, v146
    v_pk_fma_f32 v[142:143], v[142:143], v[136:137], v[136:137]
    v_exp_f32 v147, v147
    v_rcp_f32 v142, v142
    v_rcp_f32 v143, v143
    v_pk_fma_f32 v[146:147], v[146:147], v[134:135], v[134:135]
    v_exp_f32 v148, v148
    v_lshlrev_b32_sdwa v88, 3, v122 dst_sel:DWORD dst_unused:UNUSED_PAD src0_sel:DWORD src1_sel:WORD_0
    v_lshlrev_b32_sdwa v90, 3, v122 dst_sel:DWORD dst_unused:UNUSED_PAD src0_sel:DWORD src1_sel:WORD_1
    ds_read_b64 v[88:89], v88
    ds_read_b64 v[90:91], v90
    v_lshlrev_b32_sdwa v92, 3, v123 dst_sel:DWORD dst_unused:UNUSED_PAD src0_sel:DWORD src1_sel:WORD_0
    v_lshlrev_b32_sdwa v94, 3, v123 dst_sel:DWORD dst_unused:UNUSED_PAD src0_sel:DWORD src1_sel:WORD_1
    ds_read_b64 v[92:93], v92
    ds_read_b64 v[94:95], v94
    buffer_load_dwordx4 v[120:123], v69, s[12:15], s44 offen offset:3072 sc1
    s_waitcnt lgkmcnt(8)
    v_smfmac_f32_16x16x64_bf16 v[12:15], v[64:67], v[96:103], v68
    v_rcp_f32 v146, v146
    v_pk_fma_f32 v[144:145], v[2:3], v[142:143], v[144:145]
    v_pk_mul_f32 v[152:153], v[8:9], v[8:9]
    v_rcp_f32 v147, v147
    v_add_f32 v144, v144, v145
    v_pk_fma_f32 v[152:153], v[152:153], v[128:129], v[130:131]
    v_exp_f32 v149, v149
    v_min_u32 v144, -2, v144
    v_pk_mul_f32 v[150:151], v[4:5], v[146:147]
    s_waitcnt vmcnt(2)
    v_lshlrev_b32_sdwa v96, 3, v124 dst_sel:DWORD dst_unused:UNUSED_PAD src0_sel:DWORD src1_sel:WORD_0
    v_lshlrev_b32_sdwa v98, 3, v124 dst_sel:DWORD dst_unused:UNUSED_PAD src0_sel:DWORD src1_sel:WORD_1
    ds_read_b64 v[96:97], v96
    ds_read_b64 v[98:99], v98
    v_lshlrev_b32_sdwa v100, 3, v125 dst_sel:DWORD dst_unused:UNUSED_PAD src0_sel:DWORD src1_sel:WORD_0
    v_lshlrev_b32_sdwa v102, 3, v125 dst_sel:DWORD dst_unused:UNUSED_PAD src0_sel:DWORD src1_sel:WORD_1
    ds_read_b64 v[100:101], v100
    ds_read_b64 v[102:103], v102
    s_waitcnt lgkmcnt(8)
    v_smfmac_f32_16x16x64_bf16 v[16:19], v[64:67], v[104:111], v68
    buffer_store_dword v144, v70, s[12:15], s35 offen offset:0 sc1
    v_pk_fma_f32 v[148:149], v[148:149], v[136:137], v[136:137]
    v_pk_mul_f32 v[152:153], v[152:153], v[8:9]
    v_rcp_f32 v148, v148
    v_pk_mul_f32 v[154:155], v[10:11], v[10:11]
    v_pk_mul_f32 v[158:159], v[12:13], v[12:13]
    v_rcp_f32 v149, v149
    v_pk_fma_f32 v[154:155], v[154:155], v[128:129], v[130:131]
    v_pk_fma_f32 v[158:159], v[158:159], v[128:129], v[130:131]
    v_lshlrev_b32_sdwa v104, 3, v126 dst_sel:DWORD dst_unused:UNUSED_PAD src0_sel:DWORD src1_sel:WORD_0
    v_lshlrev_b32_sdwa v106, 3, v126 dst_sel:DWORD dst_unused:UNUSED_PAD src0_sel:DWORD src1_sel:WORD_1
    ds_read_b64 v[104:105], v104
    ds_read_b64 v[106:107], v106
    v_lshlrev_b32_sdwa v108, 3, v127 dst_sel:DWORD dst_unused:UNUSED_PAD src0_sel:DWORD src1_sel:WORD_0
    v_lshlrev_b32_sdwa v110, 3, v127 dst_sel:DWORD dst_unused:UNUSED_PAD src0_sel:DWORD src1_sel:WORD_1
    ds_read_b64 v[108:109], v108
    ds_read_b64 v[110:111], v110
    buffer_load_dwordx4 v[124:127], v69, s[12:15], s20 offen offset:0 sc1
    s_waitcnt lgkmcnt(8)
    v_smfmac_f32_16x16x64_bf16 v[20:23], v[64:67], v[88:95], v68
    v_exp_f32 v152, v152
    v_pk_fma_f32 v[150:151], v[6:7], v[148:149], v[150:151]
    v_pk_mul_f32 v[154:155], v[154:155], v[10:11]
    v_exp_f32 v153, v153
    v_add_f32 v150, v150, v151
    v_pk_mul_f32 v[158:159], v[158:159], v[12:13]
    v_exp_f32 v154, v154
    v_min_u32 v150, -2, v150
    v_pk_fma_f32 v[152:153], v[152:153], v[134:135], v[134:135]
    s_waitcnt vmcnt(3)
    v_lshlrev_b32_sdwa v88, 3, v116 dst_sel:DWORD dst_unused:UNUSED_PAD src0_sel:DWORD src1_sel:WORD_0
    v_lshlrev_b32_sdwa v90, 3, v116 dst_sel:DWORD dst_unused:UNUSED_PAD src0_sel:DWORD src1_sel:WORD_1
    ds_read_b64 v[88:89], v88
    ds_read_b64 v[90:91], v90
    v_lshlrev_b32_sdwa v92, 3, v117 dst_sel:DWORD dst_unused:UNUSED_PAD src0_sel:DWORD src1_sel:WORD_0
    v_lshlrev_b32_sdwa v94, 3, v117 dst_sel:DWORD dst_unused:UNUSED_PAD src0_sel:DWORD src1_sel:WORD_1
    ds_read_b64 v[92:93], v92
    ds_read_b64 v[94:95], v94
    s_waitcnt lgkmcnt(8)
    v_smfmac_f32_16x16x64_bf16 v[16:19], v[64:67], v[96:103], v68
    v_rcp_f32 v152, v152
    buffer_store_dword v150, v70, s[12:15], s35 offen offset:128 sc1
    v_pk_mul_f32 v[160:161], v[14:15], v[14:15]
    v_rcp_f32 v153, v153
    v_pk_fma_f32 v[160:161], v[160:161], v[128:129], v[130:131]
    v_exp_f32 v155, v155
    v_pk_mul_f32 v[156:157], v[8:9], v[152:153]
    v_pk_mul_f32 v[160:161], v[160:161], v[14:15]
    v_exp_f32 v158, v158
    v_lshlrev_b32_sdwa v96, 3, v118 dst_sel:DWORD dst_unused:UNUSED_PAD src0_sel:DWORD src1_sel:WORD_0
    v_lshlrev_b32_sdwa v98, 3, v118 dst_sel:DWORD dst_unused:UNUSED_PAD src0_sel:DWORD src1_sel:WORD_1
    ds_read_b64 v[96:97], v96
    ds_read_b64 v[98:99], v98
    v_lshlrev_b32_sdwa v100, 3, v119 dst_sel:DWORD dst_unused:UNUSED_PAD src0_sel:DWORD src1_sel:WORD_0
    v_lshlrev_b32_sdwa v102, 3, v119 dst_sel:DWORD dst_unused:UNUSED_PAD src0_sel:DWORD src1_sel:WORD_1
    ds_read_b64 v[100:101], v100
    ds_read_b64 v[102:103], v102
    buffer_load_dwordx4 v[116:119], v69, s[12:15], s41 offen offset:0 sc1
    s_waitcnt lgkmcnt(8)
    v_smfmac_f32_16x16x64_bf16 v[20:23], v[64:67], v[104:111], v68
    v_exp_f32 v159, v159
    v_pk_fma_f32 v[154:155], v[154:155], v[136:137], v[136:137]
    v_pk_mul_f32 v[164:165], v[16:17], v[16:17]
    v_rcp_f32 v154, v154
    v_pk_fma_f32 v[158:159], v[158:159], v[134:135], v[134:135]
    v_pk_fma_f32 v[164:165], v[164:165], v[128:129], v[130:131]
    v_rcp_f32 v155, v155
    v_pk_mul_f32 v[164:165], v[164:165], v[16:17]
    v_pk_mul_f32 v[166:167], v[18:19], v[18:19]
    s_waitcnt vmcnt(4)
    v_lshlrev_b32_sdwa v104, 3, v120 dst_sel:DWORD dst_unused:UNUSED_PAD src0_sel:DWORD src1_sel:WORD_0
    v_lshlrev_b32_sdwa v106, 3, v120 dst_sel:DWORD dst_unused:UNUSED_PAD src0_sel:DWORD src1_sel:WORD_1
    ds_read_b64 v[104:105], v104
    ds_read_b64 v[106:107], v106
    v_lshlrev_b32_sdwa v108, 3, v121 dst_sel:DWORD dst_unused:UNUSED_PAD src0_sel:DWORD src1_sel:WORD_0
    v_lshlrev_b32_sdwa v110, 3, v121 dst_sel:DWORD dst_unused:UNUSED_PAD src0_sel:DWORD src1_sel:WORD_1
    ds_read_b64 v[108:109], v108
    ds_read_b64 v[110:111], v110
    s_waitcnt lgkmcnt(8)
    v_smfmac_f32_16x16x64_bf16 v[24:27], v[64:67], v[88:95], v68
    v_rcp_f32 v158, v158
    v_pk_fma_f32 v[156:157], v[10:11], v[154:155], v[156:157]
    v_pk_fma_f32 v[166:167], v[166:167], v[128:129], v[130:131]
    v_rcp_f32 v159, v159
    v_add_f32 v156, v156, v157
    v_pk_mul_f32 v[166:167], v[166:167], v[18:19]
    v_exp_f32 v160, v160
    v_min_u32 v156, -2, v156
    v_pk_mul_f32 v[162:163], v[12:13], v[158:159]
    v_lshlrev_b32_sdwa v88, 3, v122 dst_sel:DWORD dst_unused:UNUSED_PAD src0_sel:DWORD src1_sel:WORD_0
    v_lshlrev_b32_sdwa v90, 3, v122 dst_sel:DWORD dst_unused:UNUSED_PAD src0_sel:DWORD src1_sel:WORD_1
    ds_read_b64 v[88:89], v88
    ds_read_b64 v[90:91], v90
    v_lshlrev_b32_sdwa v92, 3, v123 dst_sel:DWORD dst_unused:UNUSED_PAD src0_sel:DWORD src1_sel:WORD_0
    v_lshlrev_b32_sdwa v94, 3, v123 dst_sel:DWORD dst_unused:UNUSED_PAD src0_sel:DWORD src1_sel:WORD_1
    ds_read_b64 v[92:93], v92
    ds_read_b64 v[94:95], v94
    buffer_load_dwordx4 v[120:123], v69, s[12:15], s45 offen offset:0 sc1
    s_waitcnt lgkmcnt(8)
    v_smfmac_f32_16x16x64_bf16 v[28:31], v[64:67], v[96:103], v68
    v_exp_f32 v161, v161
    buffer_store_dword v156, v70, s[12:15], s35 offen offset:512 sc1
    v_pk_mul_f32 v[170:171], v[20:21], v[20:21]
    v_exp_f32 v164, v164
    v_pk_fma_f32 v[160:161], v[160:161], v[136:137], v[136:137]
    v_pk_fma_f32 v[170:171], v[170:171], v[128:129], v[130:131]
    v_rcp_f32 v160, v160
    v_pk_mul_f32 v[170:171], v[170:171], v[20:21]
    v_pk_mul_f32 v[172:173], v[22:23], v[22:23]
    s_waitcnt vmcnt(4)
    v_lshlrev_b32_sdwa v96, 3, v124 dst_sel:DWORD dst_unused:UNUSED_PAD src0_sel:DWORD src1_sel:WORD_0
    v_lshlrev_b32_sdwa v98, 3, v124 dst_sel:DWORD dst_unused:UNUSED_PAD src0_sel:DWORD src1_sel:WORD_1
    ds_read_b64 v[96:97], v96
    ds_read_b64 v[98:99], v98
    v_lshlrev_b32_sdwa v100, 3, v125 dst_sel:DWORD dst_unused:UNUSED_PAD src0_sel:DWORD src1_sel:WORD_0
    v_lshlrev_b32_sdwa v102, 3, v125 dst_sel:DWORD dst_unused:UNUSED_PAD src0_sel:DWORD src1_sel:WORD_1
    ds_read_b64 v[100:101], v100
    ds_read_b64 v[102:103], v102
    s_waitcnt lgkmcnt(8)
    v_smfmac_f32_16x16x64_bf16 v[24:27], v[64:67], v[104:111], v68
    v_rcp_f32 v161, v161
    v_pk_fma_f32 v[172:173], v[172:173], v[128:129], v[130:131]
    v_exp_f32 v165, v165
    v_pk_fma_f32 v[162:163], v[14:15], v[160:161], v[162:163]
    v_pk_mul_f32 v[172:173], v[172:173], v[22:23]
    v_exp_f32 v166, v166
    v_add_f32 v162, v162, v163
    v_pk_fma_f32 v[164:165], v[164:165], v[134:135], v[134:135]
    v_exp_f32 v167, v167
    v_lshlrev_b32_sdwa v104, 3, v126 dst_sel:DWORD dst_unused:UNUSED_PAD src0_sel:DWORD src1_sel:WORD_0
    v_lshlrev_b32_sdwa v106, 3, v126 dst_sel:DWORD dst_unused:UNUSED_PAD src0_sel:DWORD src1_sel:WORD_1
    ds_read_b64 v[104:105], v104
    ds_read_b64 v[106:107], v106
    v_lshlrev_b32_sdwa v108, 3, v127 dst_sel:DWORD dst_unused:UNUSED_PAD src0_sel:DWORD src1_sel:WORD_0
    v_lshlrev_b32_sdwa v110, 3, v127 dst_sel:DWORD dst_unused:UNUSED_PAD src0_sel:DWORD src1_sel:WORD_1
    ds_read_b64 v[108:109], v108
    ds_read_b64 v[110:111], v110
    buffer_load_dwordx4 v[124:127], v69, s[12:15], s20 offen offset:1024 sc1
    s_waitcnt lgkmcnt(8)
    v_smfmac_f32_16x16x64_bf16 v[28:31], v[64:67], v[88:95], v68
    s_setprio 2
    v_rcp_f32 v164, v164
    v_min_u32 v162, -2, v162
    v_pk_fma_f32 v[166:167], v[166:167], v[136:137], v[136:137]
    v_rcp_f32 v165, v165
    buffer_store_dword v162, v70, s[12:15], s35 offen offset:640 sc1
    v_pk_mul_f32 v[140:141], v[24:25], v[24:25]
    v_rcp_f32 v166, v166
    v_pk_mul_f32 v[168:169], v[16:17], v[164:165]
    v_pk_fma_f32 v[140:141], v[140:141], v[128:129], v[130:131]
    s_waitcnt vmcnt(4)
    v_lshlrev_b32_sdwa v88, 3, v116 dst_sel:DWORD dst_unused:UNUSED_PAD src0_sel:DWORD src1_sel:WORD_0
    v_lshlrev_b32_sdwa v90, 3, v116 dst_sel:DWORD dst_unused:UNUSED_PAD src0_sel:DWORD src1_sel:WORD_1
    ds_read_b64 v[88:89], v88
    ds_read_b64 v[90:91], v90
    v_lshlrev_b32_sdwa v92, 3, v117 dst_sel:DWORD dst_unused:UNUSED_PAD src0_sel:DWORD src1_sel:WORD_0
    v_lshlrev_b32_sdwa v94, 3, v117 dst_sel:DWORD dst_unused:UNUSED_PAD src0_sel:DWORD src1_sel:WORD_1
    ds_read_b64 v[92:93], v92
    ds_read_b64 v[94:95], v94
    s_waitcnt lgkmcnt(8)
    v_smfmac_f32_16x16x64_bf16 v[32:35], v[64:67], v[96:103], v68
    v_rcp_f32 v167, v167
    v_pk_mul_f32 v[140:141], v[140:141], v[24:25]
    v_pk_mul_f32 v[142:143], v[26:27], v[26:27]
    v_exp_f32 v170, v170
    v_pk_fma_f32 v[168:169], v[18:19], v[166:167], v[168:169]
    v_pk_fma_f32 v[142:143], v[142:143], v[128:129], v[130:131]
    v_exp_f32 v171, v171
    v_add_f32 v168, v168, v169
    v_pk_mul_f32 v[142:143], v[142:143], v[26:27]
    v_lshlrev_b32_sdwa v96, 3, v118 dst_sel:DWORD dst_unused:UNUSED_PAD src0_sel:DWORD src1_sel:WORD_0
    v_lshlrev_b32_sdwa v98, 3, v118 dst_sel:DWORD dst_unused:UNUSED_PAD src0_sel:DWORD src1_sel:WORD_1
    ds_read_b64 v[96:97], v96
    ds_read_b64 v[98:99], v98
    v_lshlrev_b32_sdwa v100, 3, v119 dst_sel:DWORD dst_unused:UNUSED_PAD src0_sel:DWORD src1_sel:WORD_0
    v_lshlrev_b32_sdwa v102, 3, v119 dst_sel:DWORD dst_unused:UNUSED_PAD src0_sel:DWORD src1_sel:WORD_1
    ds_read_b64 v[100:101], v100
    ds_read_b64 v[102:103], v102
    buffer_load_dwordx4 v[116:119], v69, s[12:15], s41 offen offset:1024 sc1
    s_waitcnt lgkmcnt(8)
    v_smfmac_f32_16x16x64_bf16 v[36:39], v[64:67], v[104:111], v68
    v_exp_f32 v172, v172
    v_min_u32 v168, -2, v168
    v_pk_fma_f32 v[170:171], v[170:171], v[134:135], v[134:135]
    v_exp_f32 v173, v173
    buffer_store_dword v168, v70, s[12:15], s35 offen offset:1024 sc1
    v_pk_mul_f32 v[146:147], v[28:29], v[28:29]
    v_rcp_f32 v170, v170
    v_pk_fma_f32 v[172:173], v[172:173], v[136:137], v[136:137]
    v_pk_fma_f32 v[146:147], v[146:147], v[128:129], v[130:131]
    s_waitcnt vmcnt(5)
    v_lshlrev_b32_sdwa v104, 3, v120 dst_sel:DWORD dst_unused:UNUSED_PAD src0_sel:DWORD src1_sel:WORD_0
    v_lshlrev_b32_sdwa v106, 3, v120 dst_sel:DWORD dst_unused:UNUSED_PAD src0_sel:DWORD src1_sel:WORD_1
    ds_read_b64 v[104:105], v104
    ds_read_b64 v[106:107], v106
    v_lshlrev_b32_sdwa v108, 3, v121 dst_sel:DWORD dst_unused:UNUSED_PAD src0_sel:DWORD src1_sel:WORD_0
    v_lshlrev_b32_sdwa v110, 3, v121 dst_sel:DWORD dst_unused:UNUSED_PAD src0_sel:DWORD src1_sel:WORD_1
    ds_read_b64 v[108:109], v108
    ds_read_b64 v[110:111], v110
    s_waitcnt lgkmcnt(8)
    v_smfmac_f32_16x16x64_bf16 v[32:35], v[64:67], v[88:95], v68
    v_rcp_f32 v171, v171
    v_pk_mul_f32 v[146:147], v[146:147], v[28:29]
    v_pk_mul_f32 v[148:149], v[30:31], v[30:31]
    v_rcp_f32 v172, v172
    v_pk_mul_f32 v[174:175], v[20:21], v[170:171]
    v_pk_fma_f32 v[148:149], v[148:149], v[128:129], v[130:131]
    v_rcp_f32 v173, v173
    v_pk_mul_f32 v[148:149], v[148:149], v[30:31]
    v_exp_f32 v140, v140
    v_lshlrev_b32_sdwa v88, 3, v122 dst_sel:DWORD dst_unused:UNUSED_PAD src0_sel:DWORD src1_sel:WORD_0
    v_lshlrev_b32_sdwa v90, 3, v122 dst_sel:DWORD dst_unused:UNUSED_PAD src0_sel:DWORD src1_sel:WORD_1
    ds_read_b64 v[88:89], v88
    ds_read_b64 v[90:91], v90
    v_lshlrev_b32_sdwa v92, 3, v123 dst_sel:DWORD dst_unused:UNUSED_PAD src0_sel:DWORD src1_sel:WORD_0
    v_lshlrev_b32_sdwa v94, 3, v123 dst_sel:DWORD dst_unused:UNUSED_PAD src0_sel:DWORD src1_sel:WORD_1
    ds_read_b64 v[92:93], v92
    ds_read_b64 v[94:95], v94
    buffer_load_dwordx4 v[120:123], v69, s[12:15], s45 offen offset:1024 sc1
    s_waitcnt lgkmcnt(8)
    v_smfmac_f32_16x16x64_bf16 v[36:39], v[64:67], v[96:103], v68
    v_exp_f32 v141, v141
    v_pk_fma_f32 v[174:175], v[22:23], v[172:173], v[174:175]
    v_exp_f32 v142, v142
    v_add_f32 v174, v174, v175
    v_pk_fma_f32 v[140:141], v[140:141], v[134:135], v[134:135]
    v_exp_f32 v143, v143
    v_min_u32 v174, -2, v174
    v_rcp_f32 v140, v140
    buffer_store_dword v174, v70, s[12:15], s35 offen offset:1152 sc1
    s_waitcnt vmcnt(5)
    v_lshlrev_b32_sdwa v96, 3, v124 dst_sel:DWORD dst_unused:UNUSED_PAD src0_sel:DWORD src1_sel:WORD_0
    v_lshlrev_b32_sdwa v98, 3, v124 dst_sel:DWORD dst_unused:UNUSED_PAD src0_sel:DWORD src1_sel:WORD_1
    ds_read_b64 v[96:97], v96
    ds_read_b64 v[98:99], v98
    v_lshlrev_b32_sdwa v100, 3, v125 dst_sel:DWORD dst_unused:UNUSED_PAD src0_sel:DWORD src1_sel:WORD_0
    v_lshlrev_b32_sdwa v102, 3, v125 dst_sel:DWORD dst_unused:UNUSED_PAD src0_sel:DWORD src1_sel:WORD_1
    ds_read_b64 v[100:101], v100
    ds_read_b64 v[102:103], v102
    s_waitcnt lgkmcnt(8)
    v_smfmac_f32_16x16x64_bf16 v[32:35], v[64:67], v[104:111], v68
    v_rcp_f32 v141, v141
    v_pk_fma_f32 v[142:143], v[142:143], v[136:137], v[136:137]
    v_exp_f32 v146, v146
    v_pk_mul_f32 v[144:145], v[24:25], v[140:141]
    v_rcp_f32 v142, v142
    v_rcp_f32 v143, v143
    v_exp_f32 v147, v147
    v_exp_f32 v148, v148
    v_pk_fma_f32 v[144:145], v[26:27], v[142:143], v[144:145]
    v_lshlrev_b32_sdwa v104, 3, v126 dst_sel:DWORD dst_unused:UNUSED_PAD src0_sel:DWORD src1_sel:WORD_0
    v_lshlrev_b32_sdwa v106, 3, v126 dst_sel:DWORD dst_unused:UNUSED_PAD src0_sel:DWORD src1_sel:WORD_1
    ds_read_b64 v[104:105], v104
    ds_read_b64 v[106:107], v106
    v_lshlrev_b32_sdwa v108, 3, v127 dst_sel:DWORD dst_unused:UNUSED_PAD src0_sel:DWORD src1_sel:WORD_0
    v_lshlrev_b32_sdwa v110, 3, v127 dst_sel:DWORD dst_unused:UNUSED_PAD src0_sel:DWORD src1_sel:WORD_1
    ds_read_b64 v[108:109], v108
    ds_read_b64 v[110:111], v110
    buffer_load_dwordx4 v[124:127], v69, s[12:15], s20 offen offset:2048 sc1
    s_waitcnt lgkmcnt(8)
    v_smfmac_f32_16x16x64_bf16 v[36:39], v[64:67], v[88:95], v68
    v_exp_f32 v149, v149
    v_add_f32 v144, v144, v145
    v_pk_fma_f32 v[146:147], v[146:147], v[134:135], v[134:135]
    v_min_u32 v144, -2, v144
    v_rcp_f32 v146, v146
    buffer_store_dword v144, v70, s[12:15], s35 offen offset:1536 sc1
    v_pk_fma_f32 v[148:149], v[148:149], v[136:137], v[136:137]
    v_rcp_f32 v147, v147
    v_pk_mul_f32 v[152:153], v[32:33], v[32:33]
    s_waitcnt vmcnt(5)
    v_lshlrev_b32_sdwa v88, 3, v116 dst_sel:DWORD dst_unused:UNUSED_PAD src0_sel:DWORD src1_sel:WORD_0
    v_lshlrev_b32_sdwa v90, 3, v116 dst_sel:DWORD dst_unused:UNUSED_PAD src0_sel:DWORD src1_sel:WORD_1
    ds_read_b64 v[88:89], v88
    ds_read_b64 v[90:91], v90
    v_lshlrev_b32_sdwa v92, 3, v117 dst_sel:DWORD dst_unused:UNUSED_PAD src0_sel:DWORD src1_sel:WORD_0
    v_lshlrev_b32_sdwa v94, 3, v117 dst_sel:DWORD dst_unused:UNUSED_PAD src0_sel:DWORD src1_sel:WORD_1
    ds_read_b64 v[92:93], v92
    ds_read_b64 v[94:95], v94
    s_waitcnt lgkmcnt(8)
    v_smfmac_f32_16x16x64_bf16 v[40:43], v[64:67], v[96:103], v68
    v_rcp_f32 v148, v148
    v_pk_mul_f32 v[150:151], v[28:29], v[146:147]
    v_pk_fma_f32 v[152:153], v[152:153], v[128:129], v[130:131]
    v_rcp_f32 v149, v149
    v_pk_mul_f32 v[152:153], v[152:153], v[32:33]
    v_pk_mul_f32 v[154:155], v[34:35], v[34:35]
    v_exp_f32 v152, v152
    v_pk_fma_f32 v[150:151], v[30:31], v[148:149], v[150:151]
    v_pk_fma_f32 v[154:155], v[154:155], v[128:129], v[130:131]
    v_lshlrev_b32_sdwa v96, 3, v118 dst_sel:DWORD dst_unused:UNUSED_PAD src0_sel:DWORD src1_sel:WORD_0
    v_lshlrev_b32_sdwa v98, 3, v118 dst_sel:DWORD dst_unused:UNUSED_PAD src0_sel:DWORD src1_sel:WORD_1
    ds_read_b64 v[96:97], v96
    ds_read_b64 v[98:99], v98
    v_lshlrev_b32_sdwa v100, 3, v119 dst_sel:DWORD dst_unused:UNUSED_PAD src0_sel:DWORD src1_sel:WORD_0
    v_lshlrev_b32_sdwa v102, 3, v119 dst_sel:DWORD dst_unused:UNUSED_PAD src0_sel:DWORD src1_sel:WORD_1
    ds_read_b64 v[100:101], v100
    ds_read_b64 v[102:103], v102
    buffer_load_dwordx4 v[116:119], v69, s[12:15], s41 offen offset:2048 sc1
    s_waitcnt lgkmcnt(8)
    v_smfmac_f32_16x16x64_bf16 v[44:47], v[64:67], v[104:111], v68
    v_exp_f32 v153, v153
    v_add_f32 v150, v150, v151
    v_pk_mul_f32 v[154:155], v[154:155], v[34:35]
    v_min_u32 v150, -2, v150
    v_exp_f32 v154, v154
    buffer_store_dword v150, v70, s[12:15], s35 offen offset:1664 sc1
    v_pk_fma_f32 v[152:153], v[152:153], v[134:135], v[134:135]
    v_exp_f32 v155, v155
    v_pk_mul_f32 v[158:159], v[36:37], v[36:37]
    s_waitcnt vmcnt(5)
    v_lshlrev_b32_sdwa v104, 3, v120 dst_sel:DWORD dst_unused:UNUSED_PAD src0_sel:DWORD src1_sel:WORD_0
    v_lshlrev_b32_sdwa v106, 3, v120 dst_sel:DWORD dst_unused:UNUSED_PAD src0_sel:DWORD src1_sel:WORD_1
    ds_read_b64 v[104:105], v104
    ds_read_b64 v[106:107], v106
    v_lshlrev_b32_sdwa v108, 3, v121 dst_sel:DWORD dst_unused:UNUSED_PAD src0_sel:DWORD src1_sel:WORD_0
    v_lshlrev_b32_sdwa v110, 3, v121 dst_sel:DWORD dst_unused:UNUSED_PAD src0_sel:DWORD src1_sel:WORD_1
    ds_read_b64 v[108:109], v108
    ds_read_b64 v[110:111], v110
    s_waitcnt lgkmcnt(8)
    v_smfmac_f32_16x16x64_bf16 v[40:43], v[64:67], v[88:95], v68
    v_rcp_f32 v152, v152
    v_pk_fma_f32 v[154:155], v[154:155], v[136:137], v[136:137]
    v_pk_fma_f32 v[158:159], v[158:159], v[128:129], v[130:131]
    v_rcp_f32 v153, v153
    v_pk_mul_f32 v[158:159], v[158:159], v[36:37]
    v_pk_mul_f32 v[160:161], v[38:39], v[38:39]
    v_rcp_f32 v154, v154
    v_pk_mul_f32 v[156:157], v[32:33], v[152:153]
    v_pk_fma_f32 v[160:161], v[160:161], v[128:129], v[130:131]
    v_lshlrev_b32_sdwa v88, 3, v122 dst_sel:DWORD dst_unused:UNUSED_PAD src0_sel:DWORD src1_sel:WORD_0
    v_lshlrev_b32_sdwa v90, 3, v122 dst_sel:DWORD dst_unused:UNUSED_PAD src0_sel:DWORD src1_sel:WORD_1
    ds_read_b64 v[88:89], v88
    ds_read_b64 v[90:91], v90
    v_lshlrev_b32_sdwa v92, 3, v123 dst_sel:DWORD dst_unused:UNUSED_PAD src0_sel:DWORD src1_sel:WORD_0
    v_lshlrev_b32_sdwa v94, 3, v123 dst_sel:DWORD dst_unused:UNUSED_PAD src0_sel:DWORD src1_sel:WORD_1
    ds_read_b64 v[92:93], v92
    ds_read_b64 v[94:95], v94
    buffer_load_dwordx4 v[120:123], v69, s[12:15], s45 offen offset:2048 sc1
    s_waitcnt lgkmcnt(8)
    v_smfmac_f32_16x16x64_bf16 v[44:47], v[64:67], v[96:103], v68
    v_rcp_f32 v155, v155
    v_pk_mul_f32 v[160:161], v[160:161], v[38:39]
    v_exp_f32 v158, v158
    v_pk_fma_f32 v[156:157], v[34:35], v[154:155], v[156:157]
    v_exp_f32 v159, v159
    v_add_f32 v156, v156, v157
    v_exp_f32 v160, v160
    v_min_u32 v156, -2, v156
    v_pk_fma_f32 v[158:159], v[158:159], v[134:135], v[134:135]
    s_waitcnt vmcnt(4)
    v_lshlrev_b32_sdwa v96, 3, v124 dst_sel:DWORD dst_unused:UNUSED_PAD src0_sel:DWORD src1_sel:WORD_0
    v_lshlrev_b32_sdwa v98, 3, v124 dst_sel:DWORD dst_unused:UNUSED_PAD src0_sel:DWORD src1_sel:WORD_1
    ds_read_b64 v[96:97], v96
    ds_read_b64 v[98:99], v98
    v_lshlrev_b32_sdwa v100, 3, v125 dst_sel:DWORD dst_unused:UNUSED_PAD src0_sel:DWORD src1_sel:WORD_0
    v_lshlrev_b32_sdwa v102, 3, v125 dst_sel:DWORD dst_unused:UNUSED_PAD src0_sel:DWORD src1_sel:WORD_1
    ds_read_b64 v[100:101], v100
    ds_read_b64 v[102:103], v102
    s_waitcnt lgkmcnt(8)
    v_smfmac_f32_16x16x64_bf16 v[40:43], v[64:67], v[104:111], v68
    v_rcp_f32 v158, v158
    buffer_store_dword v156, v70, s[12:15], s35 offen offset:2048 sc1
    v_rcp_f32 v159, v159
    v_exp_f32 v161, v161
    v_lshlrev_b32_sdwa v104, 3, v126 dst_sel:DWORD dst_unused:UNUSED_PAD src0_sel:DWORD src1_sel:WORD_0
    v_lshlrev_b32_sdwa v106, 3, v126 dst_sel:DWORD dst_unused:UNUSED_PAD src0_sel:DWORD src1_sel:WORD_1
    ds_read_b64 v[104:105], v104
    ds_read_b64 v[106:107], v106
    v_lshlrev_b32_sdwa v108, 3, v127 dst_sel:DWORD dst_unused:UNUSED_PAD src0_sel:DWORD src1_sel:WORD_0
    v_lshlrev_b32_sdwa v110, 3, v127 dst_sel:DWORD dst_unused:UNUSED_PAD src0_sel:DWORD src1_sel:WORD_1
    ds_read_b64 v[108:109], v108
    ds_read_b64 v[110:111], v110
    buffer_load_dwordx4 v[124:127], v69, s[12:15], s20 offen offset:3072 sc1
    s_waitcnt lgkmcnt(8)
    v_smfmac_f32_16x16x64_bf16 v[44:47], v[64:67], v[88:95], v68
    v_pk_fma_f32 v[160:161], v[160:161], v[136:137], v[136:137]
    v_pk_mul_f32 v[162:163], v[36:37], v[158:159]
    v_rcp_f32 v160, v160
    v_pk_mul_f32 v[164:165], v[40:41], v[40:41]
    v_pk_mul_f32 v[166:167], v[42:43], v[42:43]
    v_rcp_f32 v161, v161
    v_pk_fma_f32 v[164:165], v[164:165], v[128:129], v[130:131]
    v_pk_fma_f32 v[166:167], v[166:167], v[128:129], v[130:131]
    v_pk_fma_f32 v[162:163], v[38:39], v[160:161], v[162:163]
    s_waitcnt vmcnt(4)
    v_lshlrev_b32_sdwa v88, 3, v116 dst_sel:DWORD dst_unused:UNUSED_PAD src0_sel:DWORD src1_sel:WORD_0
    v_lshlrev_b32_sdwa v90, 3, v116 dst_sel:DWORD dst_unused:UNUSED_PAD src0_sel:DWORD src1_sel:WORD_1
    ds_read_b64 v[88:89], v88
    ds_read_b64 v[90:91], v90
    v_lshlrev_b32_sdwa v92, 3, v117 dst_sel:DWORD dst_unused:UNUSED_PAD src0_sel:DWORD src1_sel:WORD_0
    v_lshlrev_b32_sdwa v94, 3, v117 dst_sel:DWORD dst_unused:UNUSED_PAD src0_sel:DWORD src1_sel:WORD_1
    ds_read_b64 v[92:93], v92
    ds_read_b64 v[94:95], v94
    s_waitcnt lgkmcnt(8)
    v_smfmac_f32_16x16x64_bf16 v[48:51], v[64:67], v[96:103], v68
    v_add_f32 v162, v162, v163
    v_pk_mul_f32 v[164:165], v[164:165], v[40:41]
    v_min_u32 v162, -2, v162
    v_exp_f32 v164, v164
    buffer_store_dword v162, v70, s[12:15], s35 offen offset:2176 sc1
    v_pk_mul_f32 v[166:167], v[166:167], v[42:43]
    v_exp_f32 v165, v165
    v_pk_mul_f32 v[170:171], v[44:45], v[44:45]
    v_pk_mul_f32 v[172:173], v[46:47], v[46:47]
    v_lshlrev_b32_sdwa v96, 3, v118 dst_sel:DWORD dst_unused:UNUSED_PAD src0_sel:DWORD src1_sel:WORD_0
    v_lshlrev_b32_sdwa v98, 3, v118 dst_sel:DWORD dst_unused:UNUSED_PAD src0_sel:DWORD src1_sel:WORD_1
    ds_read_b64 v[96:97], v96
    ds_read_b64 v[98:99], v98
    v_lshlrev_b32_sdwa v100, 3, v119 dst_sel:DWORD dst_unused:UNUSED_PAD src0_sel:DWORD src1_sel:WORD_0
    v_lshlrev_b32_sdwa v102, 3, v119 dst_sel:DWORD dst_unused:UNUSED_PAD src0_sel:DWORD src1_sel:WORD_1
    ds_read_b64 v[100:101], v100
    ds_read_b64 v[102:103], v102
    buffer_load_dwordx4 v[116:119], v69, s[12:15], s41 offen offset:3072 sc1
    s_waitcnt lgkmcnt(8)
    v_smfmac_f32_16x16x64_bf16 v[52:55], v[64:67], v[104:111], v68
    s_setprio 1
    v_exp_f32 v166, v166
    v_pk_fma_f32 v[164:165], v[164:165], v[134:135], v[134:135]
    v_pk_fma_f32 v[170:171], v[170:171], v[128:129], v[130:131]
    v_rcp_f32 v164, v164
    v_pk_mul_f32 v[170:171], v[170:171], v[44:45]
    v_pk_fma_f32 v[172:173], v[172:173], v[128:129], v[130:131]
    v_rcp_f32 v165, v165
    v_pk_mul_f32 v[172:173], v[172:173], v[46:47]
    v_exp_f32 v167, v167
    s_waitcnt vmcnt(4)
    v_lshlrev_b32_sdwa v104, 3, v120 dst_sel:DWORD dst_unused:UNUSED_PAD src0_sel:DWORD src1_sel:WORD_0
    v_lshlrev_b32_sdwa v106, 3, v120 dst_sel:DWORD dst_unused:UNUSED_PAD src0_sel:DWORD src1_sel:WORD_1
    ds_read_b64 v[104:105], v104
    ds_read_b64 v[106:107], v106
    v_lshlrev_b32_sdwa v108, 3, v121 dst_sel:DWORD dst_unused:UNUSED_PAD src0_sel:DWORD src1_sel:WORD_0
    v_lshlrev_b32_sdwa v110, 3, v121 dst_sel:DWORD dst_unused:UNUSED_PAD src0_sel:DWORD src1_sel:WORD_1
    ds_read_b64 v[108:109], v108
    ds_read_b64 v[110:111], v110
    s_waitcnt lgkmcnt(8)
    v_smfmac_f32_16x16x64_bf16 v[48:51], v[64:67], v[88:95], v68
    v_exp_f32 v170, v170
    v_pk_fma_f32 v[166:167], v[166:167], v[136:137], v[136:137]
    v_pk_mul_f32 v[168:169], v[40:41], v[164:165]
    v_rcp_f32 v166, v166
    v_rcp_f32 v167, v167
    v_exp_f32 v171, v171
    v_exp_f32 v172, v172
    v_pk_fma_f32 v[168:169], v[42:43], v[166:167], v[168:169]
    v_pk_fma_f32 v[170:171], v[170:171], v[134:135], v[134:135]
    v_lshlrev_b32_sdwa v88, 3, v122 dst_sel:DWORD dst_unused:UNUSED_PAD src0_sel:DWORD src1_sel:WORD_0
    v_lshlrev_b32_sdwa v90, 3, v122 dst_sel:DWORD dst_unused:UNUSED_PAD src0_sel:DWORD src1_sel:WORD_1
    ds_read_b64 v[88:89], v88
    ds_read_b64 v[90:91], v90
    v_lshlrev_b32_sdwa v92, 3, v123 dst_sel:DWORD dst_unused:UNUSED_PAD src0_sel:DWORD src1_sel:WORD_0
    v_lshlrev_b32_sdwa v94, 3, v123 dst_sel:DWORD dst_unused:UNUSED_PAD src0_sel:DWORD src1_sel:WORD_1
    ds_read_b64 v[92:93], v92
    ds_read_b64 v[94:95], v94
    buffer_load_dwordx4 v[120:123], v69, s[12:15], s45 offen offset:3072 sc1
    s_waitcnt lgkmcnt(8)
    v_smfmac_f32_16x16x64_bf16 v[52:55], v[64:67], v[96:103], v68
    v_rcp_f32 v170, v170
    v_add_f32 v168, v168, v169
    v_rcp_f32 v171, v171
    v_min_u32 v168, -2, v168
    v_exp_f32 v173, v173
    buffer_store_dword v168, v70, s[12:15], s35 offen offset:2560 sc1
    v_pk_mul_f32 v[174:175], v[44:45], v[170:171]
    v_pk_fma_f32 v[172:173], v[172:173], v[136:137], v[136:137]
    s_waitcnt vmcnt(4)
    v_lshlrev_b32_sdwa v96, 3, v124 dst_sel:DWORD dst_unused:UNUSED_PAD src0_sel:DWORD src1_sel:WORD_0
    v_lshlrev_b32_sdwa v98, 3, v124 dst_sel:DWORD dst_unused:UNUSED_PAD src0_sel:DWORD src1_sel:WORD_1
    ds_read_b64 v[96:97], v96
    ds_read_b64 v[98:99], v98
    v_lshlrev_b32_sdwa v100, 3, v125 dst_sel:DWORD dst_unused:UNUSED_PAD src0_sel:DWORD src1_sel:WORD_0
    v_lshlrev_b32_sdwa v102, 3, v125 dst_sel:DWORD dst_unused:UNUSED_PAD src0_sel:DWORD src1_sel:WORD_1
    ds_read_b64 v[100:101], v100
    ds_read_b64 v[102:103], v102
    s_waitcnt lgkmcnt(8)
    v_smfmac_f32_16x16x64_bf16 v[48:51], v[64:67], v[104:111], v68
    buffer_load_dword v72, v76, s[52:55], 0 offen offset:32 sc1
    buffer_load_short_d16_hi v73, v79, s[56:59], 0 offen
    buffer_load_ushort v81, v78, s[60:63], s68 offen
    buffer_load_dword v82, v79, s[12:15], s69 offen sc1
    v_rcp_f32 v172, v172
    v_rcp_f32 v173, v173
    v_lshlrev_b32_sdwa v104, 3, v126 dst_sel:DWORD dst_unused:UNUSED_PAD src0_sel:DWORD src1_sel:WORD_0
    v_lshlrev_b32_sdwa v106, 3, v126 dst_sel:DWORD dst_unused:UNUSED_PAD src0_sel:DWORD src1_sel:WORD_1
    ds_read_b64 v[104:105], v104
    ds_read_b64 v[106:107], v106
    v_lshlrev_b32_sdwa v108, 3, v127 dst_sel:DWORD dst_unused:UNUSED_PAD src0_sel:DWORD src1_sel:WORD_0
    v_lshlrev_b32_sdwa v110, 3, v127 dst_sel:DWORD dst_unused:UNUSED_PAD src0_sel:DWORD src1_sel:WORD_1
    ds_read_b64 v[108:109], v108
    ds_read_b64 v[110:111], v110
    s_waitcnt lgkmcnt(8)
    v_smfmac_f32_16x16x64_bf16 v[52:55], v[64:67], v[88:95], v68
    v_pk_fma_f32 v[174:175], v[46:47], v[172:173], v[174:175]
    v_pk_mul_f32 v[140:141], v[48:49], v[48:49]
    v_add_f32 v174, v174, v175
    v_pk_fma_f32 v[140:141], v[140:141], v[128:129], v[130:131]
    v_min_u32 v174, -2, v174
    v_pk_mul_f32 v[140:141], v[140:141], v[48:49]
    buffer_store_dword v174, v70, s[12:15], s35 offen offset:2688 sc1
    v_exp_f32 v140, v140
    v_pk_mul_f32 v[142:143], v[50:51], v[50:51]
    s_waitcnt vmcnt(7)
    v_lshlrev_b32_sdwa v88, 3, v116 dst_sel:DWORD dst_unused:UNUSED_PAD src0_sel:DWORD src1_sel:WORD_0
    v_lshlrev_b32_sdwa v90, 3, v116 dst_sel:DWORD dst_unused:UNUSED_PAD src0_sel:DWORD src1_sel:WORD_1
    ds_read_b64 v[88:89], v88
    ds_read_b64 v[90:91], v90
    v_lshlrev_b32_sdwa v92, 3, v117 dst_sel:DWORD dst_unused:UNUSED_PAD src0_sel:DWORD src1_sel:WORD_0
    v_lshlrev_b32_sdwa v94, 3, v117 dst_sel:DWORD dst_unused:UNUSED_PAD src0_sel:DWORD src1_sel:WORD_1
    ds_read_b64 v[92:93], v92
    ds_read_b64 v[94:95], v94
    s_waitcnt lgkmcnt(8)
    v_smfmac_f32_16x16x64_bf16 v[56:59], v[64:67], v[96:103], v68
    v_exp_f32 v141, v141
    v_pk_fma_f32 v[142:143], v[142:143], v[128:129], v[130:131]
    v_pk_mul_f32 v[146:147], v[52:53], v[52:53]
    v_pk_fma_f32 v[140:141], v[140:141], v[134:135], v[134:135]
    v_pk_mul_f32 v[142:143], v[142:143], v[50:51]
    v_rcp_f32 v140, v140
    v_pk_fma_f32 v[146:147], v[146:147], v[128:129], v[130:131]
    v_pk_mul_f32 v[148:149], v[54:55], v[54:55]
    v_rcp_f32 v141, v141
    v_lshlrev_b32_sdwa v96, 3, v118 dst_sel:DWORD dst_unused:UNUSED_PAD src0_sel:DWORD src1_sel:WORD_0
    v_lshlrev_b32_sdwa v98, 3, v118 dst_sel:DWORD dst_unused:UNUSED_PAD src0_sel:DWORD src1_sel:WORD_1
    ds_read_b64 v[96:97], v96
    ds_read_b64 v[98:99], v98
    v_lshlrev_b32_sdwa v100, 3, v119 dst_sel:DWORD dst_unused:UNUSED_PAD src0_sel:DWORD src1_sel:WORD_0
    v_lshlrev_b32_sdwa v102, 3, v119 dst_sel:DWORD dst_unused:UNUSED_PAD src0_sel:DWORD src1_sel:WORD_1
    ds_read_b64 v[100:101], v100
    ds_read_b64 v[102:103], v102
    s_waitcnt lgkmcnt(8)
    v_smfmac_f32_16x16x64_bf16 v[60:63], v[64:67], v[104:111], v68
    v_exp_f32 v142, v142
    v_pk_mul_f32 v[144:145], v[48:49], v[140:141]
    v_pk_mul_f32 v[146:147], v[146:147], v[52:53]
    v_exp_f32 v143, v143
    v_pk_fma_f32 v[148:149], v[148:149], v[128:129], v[130:131]
    v_exp_f32 v146, v146
    v_pk_fma_f32 v[142:143], v[142:143], v[136:137], v[136:137]
    v_pk_mul_f32 v[148:149], v[148:149], v[54:55]
    v_rcp_f32 v142, v142
    s_waitcnt vmcnt(6)
    v_lshlrev_b32_sdwa v104, 3, v120 dst_sel:DWORD dst_unused:UNUSED_PAD src0_sel:DWORD src1_sel:WORD_0
    v_lshlrev_b32_sdwa v106, 3, v120 dst_sel:DWORD dst_unused:UNUSED_PAD src0_sel:DWORD src1_sel:WORD_1
    ds_read_b64 v[104:105], v104
    ds_read_b64 v[106:107], v106
    v_lshlrev_b32_sdwa v108, 3, v121 dst_sel:DWORD dst_unused:UNUSED_PAD src0_sel:DWORD src1_sel:WORD_0
    v_lshlrev_b32_sdwa v110, 3, v121 dst_sel:DWORD dst_unused:UNUSED_PAD src0_sel:DWORD src1_sel:WORD_1
    ds_read_b64 v[108:109], v108
    ds_read_b64 v[110:111], v110
    s_waitcnt lgkmcnt(8)
    v_smfmac_f32_16x16x64_bf16 v[56:59], v[64:67], v[88:95], v68
    v_rcp_f32 v143, v143
    v_exp_f32 v147, v147
    v_exp_f32 v148, v148
    v_pk_fma_f32 v[144:145], v[50:51], v[142:143], v[144:145]
    v_pk_fma_f32 v[146:147], v[146:147], v[134:135], v[134:135]
    v_exp_f32 v149, v149
    v_add_f32 v144, v144, v145
    v_rcp_f32 v146, v146
    v_min_u32 v144, -2, v144
    v_lshlrev_b32_sdwa v88, 3, v122 dst_sel:DWORD dst_unused:UNUSED_PAD src0_sel:DWORD src1_sel:WORD_0
    v_lshlrev_b32_sdwa v90, 3, v122 dst_sel:DWORD dst_unused:UNUSED_PAD src0_sel:DWORD src1_sel:WORD_1
    ds_read_b64 v[88:89], v88
    ds_read_b64 v[90:91], v90
    v_lshlrev_b32_sdwa v92, 3, v123 dst_sel:DWORD dst_unused:UNUSED_PAD src0_sel:DWORD src1_sel:WORD_0
    v_lshlrev_b32_sdwa v94, 3, v123 dst_sel:DWORD dst_unused:UNUSED_PAD src0_sel:DWORD src1_sel:WORD_1
    ds_read_b64 v[92:93], v92
    ds_read_b64 v[94:95], v94
    s_waitcnt lgkmcnt(8)
    v_smfmac_f32_16x16x64_bf16 v[60:63], v[64:67], v[96:103], v68
    s_setprio 0
    v_rcp_f32 v147, v147
    buffer_store_dword v144, v70, s[12:15], s35 offen offset:3072 sc1
    v_pk_fma_f32 v[148:149], v[148:149], v[136:137], v[136:137]
    v_pk_mul_f32 v[150:151], v[52:53], v[146:147]
    v_rcp_f32 v148, v148
    v_rcp_f32 v149, v149
    s_waitcnt lgkmcnt(4)
    v_smfmac_f32_16x16x64_bf16 v[56:59], v[64:67], v[104:111], v68
    v_pk_fma_f32 v[150:151], v[54:55], v[148:149], v[150:151]
    s_waitcnt lgkmcnt(0)
    v_smfmac_f32_16x16x64_bf16 v[60:63], v[64:67], v[88:95], v68
    v_add_f32 v150, v150, v151
    s_nop 0
    v_min_u32 v150, -2, v150
    s_nop 0
    buffer_store_dword v150, v70, s[12:15], s35 offen offset:3200 sc1
    s_nop 0
    s_nop 0
    s_nop 0
    s_nop 0
    v_pk_mul_f32 v[152:153], v[56:57], v[56:57]
    v_pk_mul_f32 v[154:155], v[58:59], v[58:59]
    v_pk_fma_f32 v[152:153], v[152:153], v[128:129], v[130:131]
    v_pk_fma_f32 v[154:155], v[154:155], v[128:129], v[130:131]
    v_pk_mul_f32 v[152:153], v[152:153], v[56:57]
    v_pk_mul_f32 v[154:155], v[154:155], v[58:59]
    v_exp_f32 v152, v152
    v_pk_mul_f32 v[158:159], v[60:61], v[60:61]
    v_pk_mul_f32 v[160:161], v[62:63], v[62:63]
    v_exp_f32 v153, v153
    v_pk_fma_f32 v[158:159], v[158:159], v[128:129], v[130:131]
    v_pk_fma_f32 v[160:161], v[160:161], v[128:129], v[130:131]
    v_exp_f32 v154, v154
    v_pk_fma_f32 v[152:153], v[152:153], v[134:135], v[134:135]
    v_pk_mul_f32 v[158:159], v[158:159], v[60:61]
    v_rcp_f32 v152, v152
    v_pk_mul_f32 v[160:161], v[160:161], v[62:63]
    v_rcp_f32 v153, v153
    v_exp_f32 v155, v155
    v_exp_f32 v158, v158
    v_pk_mul_f32 v[156:157], v[56:57], v[152:153]
    v_pk_fma_f32 v[154:155], v[154:155], v[136:137], v[136:137]
    v_exp_f32 v159, v159
    v_rcp_f32 v154, v154
    v_rcp_f32 v155, v155
    v_pk_fma_f32 v[158:159], v[158:159], v[134:135], v[134:135]
    v_exp_f32 v160, v160
    v_pk_fma_f32 v[156:157], v[58:59], v[154:155], v[156:157]
    v_rcp_f32 v158, v158
    v_add_f32 v156, v156, v157
    v_rcp_f32 v159, v159
    v_min_u32 v156, -2, v156
    v_exp_f32 v161, v161
    buffer_store_dword v156, v70, s[12:15], s35 offen offset:3584 sc1
    v_pk_mul_f32 v[162:163], v[60:61], v[158:159]
    v_pk_fma_f32 v[160:161], v[160:161], v[136:137], v[136:137]
    s_nop 0
    v_rcp_f32 v160, v160
    v_rcp_f32 v161, v161
    s_nop 0
    s_nop 0
    v_pk_fma_f32 v[162:163], v[62:63], v[160:161], v[162:163]
    s_nop 0
    v_add_f32 v162, v162, v163
    s_nop 0
    v_min_u32 v162, -2, v162
    s_nop 0
    buffer_store_dword v162, v70, s[12:15], s35 offen offset:3712 sc1
    s_waitcnt vmcnt(5)

    v_cmp_ne_u32 vcc, 128, v72
    s_and_b32 s44, vcc_hi, 0x1
    s_and_b32 s45, vcc_lo, 0x1
    s_or_b32 s45, s45, s44
    s_cbranch_scc1 k1_kernel_rslow

k1_kernel_rjob:

    s_lshl_b32 s67, s64, 8
    s_add_u32 s68, s67, 29360128
    s_add_u32 s69, s68, 65536
    s_add_u32 s67, s67, 20971520

k1_kernel_rgrp:

    s_add_u32 s70, s67, s65
    s_add_u32 s71, s70, 262144
    s_add_u32 s72, s70, 524288
    s_add_u32 s73, s70, 786432
    s_add_u32 s65, s65, 1048576

    buffer_load_dwordx4 v[0:3], v74, s[12:15], s70 offen sc1
    buffer_load_dwordx4 v[4:7], v74, s[12:15], s71 offen sc1
    buffer_load_dwordx4 v[8:11], v74, s[12:15], s72 offen sc1
    buffer_load_dwordx4 v[12:15], v74, s[12:15], s73 offen sc1
    buffer_load_dword v16, v75, s[12:15], s68 offen sc1
    buffer_load_dword v17, v75, s[12:15], s69 offen sc1
    s_branch k1_kernel_rchk
k1_kernel_rpoll:
    s_mov_b64 exec, s[74:75]
    s_cbranch_execz k1_kernel_rsk0
    buffer_load_dwordx4 v[0:3], v74, s[12:15], s70 offen sc1
k1_kernel_rsk0:
    s_mov_b64 exec, s[76:77]
    s_cbranch_execz k1_kernel_rsk1
    buffer_load_dwordx4 v[4:7], v74, s[12:15], s71 offen sc1
k1_kernel_rsk1:
    s_mov_b64 exec, s[78:79]
    s_cbranch_execz k1_kernel_rsk2
    buffer_load_dwordx4 v[8:11], v74, s[12:15], s72 offen sc1
k1_kernel_rsk2:
    s_mov_b64 exec, s[80:81]
    s_cbranch_execz k1_kernel_rsk3
    buffer_load_dwordx4 v[12:15], v74, s[12:15], s73 offen sc1
k1_kernel_rsk3:
    s_mov_b64 exec, -1
k1_kernel_rchk:
    s_waitcnt vmcnt(0)
k1_kernel_rchk0:
    v_max3_u32 v20, v0, v1, v2
    v_max3_u32 v21, v4, v5, v6
    v_max3_u32 v22, v8, v9, v10
    v_max3_u32 v23, v12, v13, v14
    v_max_u32 v20, v20, v3
    v_max_u32 v21, v21, v7
    v_max_u32 v22, v22, v11
    v_max_u32 v23, v23, v15
    v_cmp_eq_u32 s[74:75], -1, v20
    v_cmp_eq_u32 s[76:77], -1, v21
    v_cmp_eq_u32 s[78:79], -1, v22
    v_cmp_eq_u32 s[80:81], -1, v23

    v_pk_add_f32 v[26:27], v[0:1], v[4:5]
    v_pk_add_f32 v[28:29], v[2:3], v[6:7]
    v_pk_add_f32 v[30:31], v[8:9], v[12:13]
    v_pk_add_f32 v[32:33], v[10:11], v[14:15]
    s_or_b64 s[82:83], s[74:75], s[76:77]
    s_or_b64 s[84:85], s[78:79], s[80:81]
    v_pk_add_f32 v[26:27], v[26:27], v[30:31]
    v_pk_add_f32 v[28:29], v[28:29], v[32:33]
    s_or_b64 s[82:83], s[82:83], s[84:85]
    s_cbranch_scc1 k1_kernel_rpoll
    v_permlane32_swap_b32 v26, v28
    v_permlane32_swap_b32 v27, v29
    s_cmp_lt_u32 s65, s66
    s_nop 0
    v_pk_add_f32 v[26:27], v[26:27], v[28:29]
    s_nop 1
    v_permlane16_swap_b32 v26, v27
    s_nop 1
    v_add_f32 v26, v26, v27
    v_add_f32 v79, v79, v26
    s_cbranch_scc1 k1_kernel_rgrp
    s_cmp_lg_u32 s43, 0
    s_cbranch_scc1 k1_kernel_rpn
    ds_write_b32 v77, v79
    s_cmp_lg_u32 s3, 0
    s_waitcnt lgkmcnt(0)
    s_barrier
    s_cbranch_scc1 k1_kernel_rend

    ds_read2st64_b32 v[40:41], v77 offset0:0 offset1:1
    ds_read2st64_b32 v[42:43], v77 offset0:2 offset1:3
    ds_read2st64_b32 v[44:45], v77 offset0:4 offset1:5
    ds_read2st64_b32 v[46:47], v77 offset0:6 offset1:7

    s_waitcnt lgkmcnt(2)
    v_pk_add_f32 v[26:27], v[40:41], v[42:43]
    v_max3_u32 v20, v41, v42, v43
    s_waitcnt lgkmcnt(0)
    v_pk_add_f32 v[28:29], v[44:45], v[46:47]
    v_max3_u32 v20, v20, v44, v45
    v_pk_add_f32 v[26:27], v[26:27], v[28:29]
    v_max3_u32 v20, v20, v46, v47
    v_add_f32 v79, v26, v27
    v_cmp_eq_u32 vcc, -1, v20
    s_cbranch_vccnz k1_kernel_rnext

k1_kernel_rpn:

    v_max_u32 v20, v16, v17
    v_add_f32 v21, v16, v17
    v_cmp_eq_u32 vcc, -1, v20
    v_cvt_pk_bf16_f32 v21, v79, v21
    s_cbranch_vccnz k1_kernel_rpn2
    v_lshlrev_b32 v22, 16, v21
    v_and_b32 v21, 0xffff0000, v21
    v_add_f32 v22, v22, v73
    v_cvt_pk_bf16_f32 v22, v22, v22
    v_lshlrev_b32 v22, 16, v22
    v_add_f32 v22, v22, v21
    s_lshl_b32 s45, s64, 7
    v_cvt_pk_bf16_f32 v22, v22, v22
    buffer_store_short v22, v78, s[60:63], s45 offen

k1_kernel_rnext:

    v_cmp_ne_u32 vcc, 0, v72
    s_and_b32 s45, vcc_lo, 0xff00
    s_cbranch_scc1 k1_kernel_rmore

k1_kernel_rend:
    s_endpgm
k1_kernel_rpn2:
    buffer_load_dword v16, v75, s[12:15], s68 offen sc1
    buffer_load_dword v17, v75, s[12:15], s69 offen sc1
    s_waitcnt vmcnt(0)
    s_branch k1_kernel_rpn
k1_kernel_rmore:

    s_ff1_i32_b32 s45, s45
    s_mov_b32 s43, 1
    s_mov_b32 s65, 0
    s_mov_b32 s66, 8388608
    v_readlane_b32 s44, v72, s45
    v_mov_b32 v79, 0
    s_mov_b32 m0, s45
    s_ff1_i32_b32 s64, s44
    s_bitset0_b32 s44, s64
    s_sub_u32 s45, s45, 8
    s_lshl_b32 s45, s45, 5
    s_add_u32 s64, s64, s45
    v_writelane_b32 v72, s44, m0
    s_branch k1_kernel_rjob

k1_kernel_rslow:
    s_lshl_b32 s65, s3, 20
    buffer_load_dword v72, v76, s[52:55], 0 offen offset:32 sc1
    s_waitcnt vmcnt(0)

    v_cmp_ne_u32 vcc, 128, v72
    s_and_b32 s44, vcc_hi, 0x1
    s_and_b32 s45, vcc_lo, 0x1
    s_or_b32 s45, s45, s44
    s_cbranch_scc0 k1_kernel_rjob

    s_add_u32 s42, s42, 1
    s_cmp_lt_u32 s42, 200
    s_cbranch_scc1 k1_kernel_rslow
    s_lshl_b32 s44, 1, s64
    s_lshr_b32 s45, s64, 5
    s_lshl_b32 s45, s45, 2
    v_mov_b32 v20, s44
    s_mov_b64 exec, 1
    buffer_atomic_or v20, v76, s[52:55], s45 offen offset:64 sc0
    s_mov_b64 exec, -1
    s_waitcnt vmcnt(0)
    buffer_load_dword v72, v76, s[52:55], 0 offen offset:32 sc1
    s_waitcnt vmcnt(0)

    v_cmp_ne_u32 vcc, 128, v72
    s_and_b32 s44, vcc_hi, 0x1
    s_and_b32 s45, vcc_lo, 0x1
    s_or_b32 s45, s45, s44
    s_cbranch_scc0 k1_kernel_rjob

    v_mov_b32 v20, -1
    ds_write_b32 v77, v20
    s_waitcnt lgkmcnt(0)
    s_endpgm

k1_kernel_end:
    s_endpgm
k1_kernel_main:
    s_setprio 3
    s_mov_b32 s16, s4
    s_and_b32 s17, s5, 0xffff
    s_mov_b32 s20, s6
    s_and_b32 s21, s7, 0xffff
    s_mov_b32 s28, s10
    s_and_b32 s29, s11, 0xffff
    s_mov_b32 s32, s12
    s_and_b32 s33, s13, 0xffff
    s_and_b32 s13, s13, 0xffff
    s_and_b32 s53, s53, 0xffff

    v_and_b32 v5, 15, v255
    v_lshrrev_b32 v6, 4, v255
    v_and_b32 v7, 3, v255
    v_bfe_u32 v8, v255, 2, 2
    v_lshl_add_u32 v9, v7, 2, v8
    v_cmp_eq_u32 s[46:47], 0, v7
    s_movk_i32 s45, 200
    v_mov_b32 v10, 144384
    v_mad_u32_u24 v11, v9, s45, v10
    v_and_b32 v205, 48, v255
    v_add_u32 v120, v11, v205
    v_mul_u32_u24 v12, 6400, v6
    v_add_u32 v124, v11, v12
    v_and_b32 v12, 16, v255
    v_add_u32 v10, v10, v12
    v_add_u32 v11, v11, v12
    v_and_b32 v12, 32, v255
    v_mul_u32_u24 v12, 100, v12
    v_add_u32 v123, v11, v12
    v_and_b32 v12, 8, v255
    v_lshl_add_u32 v13, v7, 1, v12
    v_and_b32 v14, 1, v8
    v_add_u32 v13, v13, v14
    v_lshrrev_b32 v14, 5, v255
    v_lshl_add_u32 v14, v13, 1, v14
    v_mad_u32_u24 v121, v14, s45, v10
    v_lshl_add_u32 v122, v12, 2, v121
    v_lshlrev_b32 v15, 2, v6
    v_sub_u32 v13, v13, v15
    v_lshrrev_b32 v14, 1, v9
    v_sub_u32 v14, v14, v15
    v_sub_u32 v15, v5, v15
    v_and_b32 v12, 1, v9
    v_lshlrev_b32 v12, 4, v12
    v_mov_b32 v16, 0x3f80
    v_lshlrev_b32 v12, v12, v16
    v_mov_b32 v17, 0x3f800000

    v_cmp_eq_u32 vcc, 0, v13
    v_cndmask_b32 v112, 0, v16, vcc
    v_cmp_eq_u32 vcc, 0, v14
    v_cndmask_b32 v104, 0, v12, vcc
    v_cmp_eq_u32 vcc, -8, v14
    v_cndmask_b32 v108, 0, v12, vcc
    v_cmp_eq_u32 vcc, 0, v15
    v_cndmask_b32 v192, 0, v17, vcc
    v_lshlrev_b32 v116, 16, v112

    v_cmp_eq_u32 vcc, 1, v13
    v_cndmask_b32 v113, 0, v16, vcc
    v_cmp_eq_u32 vcc, 1, v14
    v_cndmask_b32 v105, 0, v12, vcc
    v_cmp_eq_u32 vcc, -7, v14
    v_cndmask_b32 v109, 0, v12, vcc
    v_cmp_eq_u32 vcc, 1, v15
    v_cndmask_b32 v193, 0, v17, vcc
    v_lshlrev_b32 v117, 16, v113

    v_cmp_eq_u32 vcc, 2, v13
    v_cndmask_b32 v114, 0, v16, vcc
    v_cmp_eq_u32 vcc, 2, v14
    v_cndmask_b32 v106, 0, v12, vcc
    v_cmp_eq_u32 vcc, -6, v14
    v_cndmask_b32 v110, 0, v12, vcc
    v_cmp_eq_u32 vcc, 2, v15
    v_cndmask_b32 v194, 0, v17, vcc
    v_lshlrev_b32 v118, 16, v114

    v_cmp_eq_u32 vcc, 3, v13
    v_cndmask_b32 v115, 0, v16, vcc
    v_cmp_eq_u32 vcc, 3, v14
    v_cndmask_b32 v107, 0, v12, vcc
    v_cmp_eq_u32 vcc, -5, v14
    v_cndmask_b32 v111, 0, v12, vcc
    v_cmp_eq_u32 vcc, 3, v15
    v_cndmask_b32 v195, 0, v17, vcc
    v_lshlrev_b32 v119, 16, v115

    s_mul_i32 s45, s3, 36864
    s_add_u32 s45, s45, 128
    s_movk_i32 s57, 144
    v_mov_b32 v10, s45
    v_mad_u32_u24 v206, v5, s57, v10
    v_mad_u32_u24 v210, v255, s57, v10
    v_add_u32 v210, 12, v210
    v_cmp_lt_u32 vcc, 25, v255
    v_subrev_u32 v11, 26, v255
    v_cndmask_b32 v11, v255, v11, vcc
    v_add_u32 v12, 2304, v10
    v_cndmask_b32 v10, v10, v12, vcc
    v_and_b32 v12, 3, v11
    v_mad_u32_u24 v10, v12, s57, v10
    v_lshrrev_b32 v11, 2, v11
    v_lshl_add_u32 v207, v11, 1, v10
    v_cmp_gt_u32 vcc, 52, v255
    v_add_u32 v11, 2304, v210
    v_cndmask_b32 v207, v11, v207, vcc
    v_mov_b32 v208, 0xdddddddd
    v_mov_b32 v211, 1000
    s_mov_b32 s60, 0xff00ff00
    s_mov_b32 s61, 0xff00ff00
    s_mov_b32 s62, -1
    s_mov_b32 s63, 0xffff

    s_waitcnt vmcnt(3)

    s_mov_b64 exec, 1
    ds_add_u32 v252, v253 offset:0
    s_mov_b64 exec, -1

k1_kernel_wf1:

    ds_read_b32 v251, v252 offset:0
    s_waitcnt lgkmcnt(0)
    v_readfirstlane_b32 s45, v251
    s_cmp_lt_u32 s45, 4
    s_cbranch_scc1 k1_kernel_wf1

    v_mov_b32 v64, 0
    v_mov_b32 v65, 0
    v_mov_b32 v66, 0
    v_mov_b32 v67, 0
    s_mov_b64 exec, s[62:63]
    ds_read_b64 v[64:65], v124 offset:192
    ds_read_b64 v[66:67], v124 offset:3392
    s_mov_b64 exec, -1
    ds_read_b64 v[68:69], v120 offset:16160
    ds_read_b64 v[70:71], v120 offset:16168
    ds_read_b64 v[72:73], v120 offset:0
    ds_read_b64 v[74:75], v120 offset:8
    ds_read_b64 v[76:77], v123 offset:0
    ds_read_b64 v[78:79], v123 offset:8
    s_waitcnt vmcnt(2)
    s_waitcnt lgkmcnt(4)
    v_mfma_f32_16x16x32_bf16 v[56:59], v[104:107], v[64:67], 0
    ds_read_b64 v[80:81], v120 offset:3232
    ds_read_b64 v[82:83], v120 offset:3240
    v_mfma_f32_16x16x32_bf16 v[60:63], v[108:111], v[64:67], 0
    v_mfma_f32_16x16x32_bf16 v[52:55], v[104:107], v[68:71], 0
    v_mfma_f32_16x16x32_bf16 v[56:59], v[232:235], v[104:107], v[56:59]
    v_mov_b32 v84, 0
    v_mov_b32 v85, 0
    v_mov_b32 v86, 0
    v_mov_b32 v87, 0
    s_mov_b64 exec, s[60:61]
    ds_read_b64 v[84:85], v121 offset:3232
    ds_read_b64 v[86:87], v121 offset:3240
    s_mov_b64 exec, -1
    v_mfma_f32_16x16x32_bf16 v[60:63], v[232:235], v[108:111], v[60:63]
    s_waitcnt lgkmcnt(4)
    v_mfma_f32_16x16x32_bf16 v[0:3], v[104:107], v[72:75], 0
    ds_read_b64 v[64:65], v120 offset:64
    ds_read_b64 v[66:67], v120 offset:72
    v_mfma_f32_16x16x32_bf16 v[4:7], v[108:111], v[72:75], 0
    v_mfma_f32_16x16x32_bf16 v[4:7], v[76:79], v[108:111], v[4:7]
    v_cndmask_b32 v62, 0, v62, s[46:47]
    ds_read_b64 v[68:69], v121 offset:6400
    ds_read_b64 v[70:71], v121 offset:6408
    s_waitcnt lgkmcnt(4)
    v_mfma_f32_16x16x32_bf16 v[88:91], v[112:115], v[80:83], 0
    ds_read_b64 v[72:73], v120 offset:9632
    ds_read_b64 v[74:75], v120 offset:9640
    v_mfma_f32_16x16x32_bf16 v[92:95], v[116:119], v[80:83], 0
    v_mfma_f32_16x16x32_bf16 v[88:91], v[84:87], v[104:107], v[88:91]
    v_mfma_f32_16x16x32_bf16 v[92:95], v[84:87], v[108:111], v[92:95]
    ds_read_b64 v[76:77], v123 offset:3296
    ds_read_b64 v[78:79], v123 offset:3304
    s_waitcnt lgkmcnt(4)
    v_mfma_f32_16x16x32_bf16 v[96:99], v[112:115], v[64:67], 0
    ds_read_b64 v[84:85], v122 offset:6464
    ds_read_b64 v[86:87], v122 offset:6472
    v_mfma_f32_16x16x32_bf16 v[100:103], v[116:119], v[64:67], 0
    v_cvt_pk_bf16_f32 v8, v88, v89
    v_cvt_pk_bf16_f32 v9, v90, v91
    v_mfma_f32_16x16x32_bf16 v[96:99], v[68:71], v[104:107], v[96:99]
    v_cvt_pk_bf16_f32 v10, v92, v93
    v_cvt_pk_bf16_f32 v11, v94, v95
    v_mfma_f32_16x16x32_bf16 v[100:103], v[68:71], v[108:111], v[100:103]
    s_waitcnt lgkmcnt(2)
    v_mfma_f32_16x16x32_bf16 v[16:19], v[104:107], v[72:75], 0
    ds_read_b64 v[64:65], v120 offset:128
    ds_read_b64 v[66:67], v120 offset:136
    v_mfma_f32_16x16x32_bf16 v[20:23], v[108:111], v[72:75], 0
    v_cvt_pk_bf16_f32 v12, v96, v97
    v_cvt_pk_bf16_f32 v13, v98, v99
    v_mfma_f32_16x16x32_bf16 v[16:19], v[76:79], v[104:107], v[16:19]
    v_cvt_pk_bf16_f32 v14, v100, v101
    v_cvt_pk_bf16_f32 v15, v102, v103
    v_mfma_f32_16x16x32_bf16 v[20:23], v[76:79], v[108:111], v[20:23]
    ds_read_b64 v[68:69], v121 offset:12800
    ds_read_b64 v[70:71], v121 offset:12808
    s_waitcnt lgkmcnt(4)
    v_mfma_f32_16x16x32_bf16 v[96:99], v[84:87], v[104:107], 0
    ds_read_b64 v[72:73], v120 offset:3328
    ds_read_b64 v[74:75], v120 offset:3336
    v_mfma_f32_16x16x32_bf16 v[100:103], v[84:87], v[108:111], 0
    s_nop 3
    ds_read_b64 v[76:77], v123 offset:12832
    ds_read_b64 v[78:79], v123 offset:12840
    s_waitcnt lgkmcnt(4)
    v_mfma_f32_16x16x32_bf16 v[88:91], v[112:115], v[64:67], 0
    ds_read_b64 v[80:81], v120 offset:6528
    ds_read_b64 v[82:83], v120 offset:6536
    v_mfma_f32_16x16x32_bf16 v[92:95], v[116:119], v[64:67], 0
    v_cvt_pk_bf16_f32 v24, v96, v97
    v_cvt_pk_bf16_f32 v25, v98, v99
    v_mfma_f32_16x16x32_bf16 v[88:91], v[68:71], v[104:107], v[88:91]
    v_cvt_pk_bf16_f32 v26, v100, v101
    v_cvt_pk_bf16_f32 v27, v102, v103
    v_mfma_f32_16x16x32_bf16 v[92:95], v[68:71], v[108:111], v[92:95]
    ds_read_b64 v[84:85], v121 offset:12864
    ds_read_b64 v[86:87], v121 offset:12872
    s_waitcnt lgkmcnt(4)
    v_mfma_f32_16x16x32_bf16 v[32:35], v[104:107], v[72:75], 0
    ds_read_b64 v[64:65], v120 offset:9728
    ds_read_b64 v[66:67], v120 offset:9736
    v_mfma_f32_16x16x32_bf16 v[36:39], v[108:111], v[72:75], 0
    v_cvt_pk_bf16_f32 v28, v88, v89
    v_cvt_pk_bf16_f32 v29, v90, v91
    v_mfma_f32_16x16x32_bf16 v[32:35], v[76:79], v[104:107], v[32:35]
    v_cvt_pk_bf16_f32 v30, v92, v93
    v_cvt_pk_bf16_f32 v31, v94, v95
    v_mfma_f32_16x16x32_bf16 v[36:39], v[76:79], v[108:111], v[36:39]
    ds_read_b64 v[68:69], v121 offset:12896
    ds_read_b64 v[70:71], v121 offset:12904
    s_waitcnt lgkmcnt(4)
    v_mfma_f32_16x16x32_bf16 v[88:91], v[112:115], v[80:83], 0
    ds_read_b64 v[72:73], v120 offset:12928
    ds_read_b64 v[74:75], v120 offset:12936
    v_mfma_f32_16x16x32_bf16 v[92:95], v[116:119], v[80:83], 0
    v_mfma_f32_16x16x32_bf16 v[88:91], v[84:87], v[104:107], v[88:91]
    v_mfma_f32_16x16x32_bf16 v[92:95], v[84:87], v[108:111], v[92:95]
    v_mov_b32 v76, 0
    v_mov_b32 v77, 0
    v_mov_b32 v78, 0
    v_mov_b32 v79, 0
    s_mov_b64 exec, s[60:61]
    ds_read_b64 v[76:77], v121 offset:12928
    ds_read_b64 v[78:79], v121 offset:12936
    s_mov_b64 exec, -1
    s_waitcnt lgkmcnt(4)
    v_mfma_f32_16x16x32_bf16 v[96:99], v[112:115], v[64:67], 0
    v_mfma_f32_16x16x32_bf16 v[100:103], v[116:119], v[64:67], 0
    v_cvt_pk_bf16_f32 v40, v88, v89
    v_cvt_pk_bf16_f32 v41, v90, v91
    v_mfma_f32_16x16x32_bf16 v[96:99], v[68:71], v[104:107], v[96:99]
    v_cvt_pk_bf16_f32 v42, v92, v93
    v_cvt_pk_bf16_f32 v43, v94, v95
    v_mfma_f32_16x16x32_bf16 v[100:103], v[68:71], v[108:111], v[100:103]
    s_waitcnt lgkmcnt(0)

    s_mov_b64 exec, 1
    ds_add_u32 v252, v253 offset:12
    s_mov_b64 exec, -1

    v_mfma_f32_16x16x32_bf16 v[88:91], v[112:115], v[72:75], 0
    v_mfma_f32_16x16x32_bf16 v[92:95], v[116:119], v[72:75], 0
    v_cvt_pk_bf16_f32 v44, v96, v97
    v_cvt_pk_bf16_f32 v45, v98, v99
    v_mfma_f32_16x16x32_bf16 v[88:91], v[76:79], v[104:107], v[88:91]
    v_cvt_pk_bf16_f32 v46, v100, v101
    v_cvt_pk_bf16_f32 v47, v102, v103
    v_mfma_f32_16x16x32_bf16 v[92:95], v[76:79], v[108:111], v[92:95]
    s_nop 7
    v_cvt_pk_bf16_f32 v48, v88, v89
    v_cvt_pk_bf16_f32 v49, v90, v91
    v_cvt_pk_bf16_f32 v50, v92, v93
    v_cvt_pk_bf16_f32 v51, v94, v95

    v_mov_b32_dpp v63, v62 row_shr:1 row_mask:0xf bank_mask:0xf bound_ctrl:0
    ds_write_b32 v210, v211
    v_and_b32 v209, 1, v255
    v_lshlrev_b32 v248, 1, v205
    v_lshl_add_u32 v248, v209, 2, v248
    v_mul_u32_u24 v200, 0xaaaa, v209
    v_mov_b32 v209, 0
    s_mov_b32 vcc_lo, 0x01010101
    s_mov_b32 vcc_hi, 0x01010101
    s_movk_i32 s58, 7

    v_mov_b64 v[164:165], 0
    v_mov_b64 v[168:169], 0
    v_mov_b64 v[172:173], 0
    v_mov_b64 v[176:177], 0
    v_mov_b64 v[180:181], 0
    v_mov_b64 v[184:185], 0
    v_mov_b64 v[188:189], 0
    v_mov_b64 v[190:191], 0
    s_waitcnt vmcnt(1)
    ds_write_b16 v207, v240 offset:0
    ds_write_b16 v207, v241 offset:576
    ds_write_b16 v207, v242 offset:1152
    ds_write_b16 v207, v243 offset:1728
    v_add_u32 v250, 0x4444, v200
    ds_read_b128 v[196:199], v206 offset:0
k1_kernel_wf2:

    ds_read_b32 v251, v252 offset:16
    s_waitcnt lgkmcnt(0)
    v_readfirstlane_b32 s45, v251
    s_cmp_lt_u32 s45, 4
    s_cbranch_scc1 k1_kernel_wf2

    s_setprio 2
    v_mad_u32_u16 v68, v196, s57, v205 op_sel:[0,0,0,0]
    ds_read_b128 v[64:67], v68 offset:0
    ds_read_b128 v[68:71], v68 offset:64
    v_mad_u32_u16 v76, v196, s57, v205 op_sel:[1,0,0,0]
    ds_read_b128 v[72:75], v76 offset:0
    ds_read_b128 v[76:79], v76 offset:64
    v_mad_u32_u16 v84, v197, s57, v205 op_sel:[0,0,0,0]
    ds_read_b128 v[80:83], v84 offset:0
    ds_read_b128 v[84:87], v84 offset:64
    v_mad_u32_u16 v92, v197, s57, v205 op_sel:[1,0,0,0]
    ds_read_b128 v[88:91], v92 offset:0
    ds_read_b128 v[92:95], v92 offset:64
    v_mad_u32_u16 v100, v198, s57, v205 op_sel:[0,0,0,0]
    ds_read_b128 v[96:99], v100 offset:0
    ds_read_b128 v[100:103], v100 offset:64
    buffer_load_dwordx4 v[240:243], v249, s[16:19], s74 offen offset:0
    s_waitcnt lgkmcnt(4)
    v_mad_u32_u16 v108, v198, s57, v205 op_sel:[1,0,0,0]
    ds_read_b128 v[104:107], v108 offset:0
k1_kernel_loop:
    v_mfma_f32_16x16x32_bf16 v[116:119], v[64:67], v[64:67], 0
    ds_read_b128 v[108:111], v108 offset:64
    v_mad_u32_u16 v114, v199, s57, v248 op_sel:[0,0,0,0]
    v_mfma_f32_16x16x32_bf16 v[116:119], v[68:71], v[68:71], v[116:119]
    ds_read2_b32 v[112:113], v114 offset0:0 offset1:2
    ds_read2_b32 v[114:115], v114 offset0:4 offset1:6
    v_mfma_f32_16x16x32_bf16 v[120:123], v[72:75], v[64:67], 0
    ds_read_b128 v[196:199], v206 offset:2304
    v_fmac_f32 v209, v181, v60
    v_mfma_f32_16x16x32_bf16 v[120:123], v[76:79], v[68:71], v[120:123]
    v_fmac_f32 v209, v184, v61
    v_fmac_f32 v209, v188, v192
    v_mfma_f32_16x16x32_bf16 v[124:127], v[72:75], v[72:75], 0
    v_fmac_f32 v209, v185, v61
    v_fmac_f32 v209, v189, v193
    v_mfma_f32_16x16x32_bf16 v[124:127], v[76:79], v[76:79], v[124:127]
    v_fmac_f32 v209, v190, v194
    v_fmac_f32 v209, v191, v195
    v_mfma_f32_16x16x32_bf16 v[128:131], v[80:83], v[72:75], 0
    v_fmac_f32 v200, v156, v52
    v_fmac_f32 v201, v157, v53
    v_mfma_f32_16x16x32_bf16 v[128:131], v[84:87], v[76:79], v[128:131]
    v_fmac_f32 v200, v158, v54
    v_fmac_f32 v201, v159, v55
    v_mfma_f32_16x16x32_bf16 v[132:135], v[80:83], v[64:67], 0
    v_add_f32 v201, v201, v209
    v_fmac_f32 v200, v160, v62
    v_mfma_f32_16x16x32_bf16 v[132:135], v[84:87], v[68:71], v[132:135]
    s_waitcnt lgkmcnt(7)
    v_fmac_f32 v200, v161, v63
    v_smfmac_f32_16x16x64_bf16 v[188:191], v[8:11], v[124:131], v208
    v_add_f32 v203, v200, v201
    v_mfma_f32_16x16x32_bf16 v[136:139], v[88:91], v[64:67], 0
    v_fma_f32 v200, v116, v0, -v209
    v_mul_f32 v201, v117, v1
    v_mfma_f32_16x16x32_bf16 v[136:139], v[92:95], v[68:71], v[136:139]
    v_fmac_f32 v200, v118, v2
    v_fmac_f32 v201, v119, v3
    v_mfma_f32_16x16x32_bf16 v[140:143], v[72:75], v[88:91], 0
    v_fmac_f32 v200, v120, v4
    v_fmac_f32 v201, v121, v5
    v_mfma_f32_16x16x32_bf16 v[140:143], v[76:79], v[92:95], v[140:143]
    v_fmac_f32 v200, v122, v6
    v_fmac_f32 v201, v123, v7
    v_smfmac_f32_16x16x64_bf16 v[188:191], v[12:15], v[132:139], v208
    v_permlane32_swap_b32 v202, v203
    v_mfma_f32_16x16x32_bf16 v[144:147], v[80:83], v[88:91], 0
    s_waitcnt vmcnt(1)
    ds_write_b16 v207, v244 offset:4608
    v_mfma_f32_16x16x32_bf16 v[144:147], v[84:87], v[92:95], v[144:147]
    v_fmac_f32 v200, v140, v16
    v_fmac_f32 v201, v141, v17
    v_mfma_f32_16x16x32_bf16 v[148:151], v[80:83], v[80:83], 0
    v_fmac_f32 v200, v142, v18
    v_fmac_f32 v201, v143, v19
    v_mfma_f32_16x16x32_bf16 v[148:151], v[84:87], v[84:87], v[148:151]
    v_add_f32 v211, v202, v203
    ds_write_b16 v207, v245 offset:5184
    v_mfma_f32_16x16x32_bf16 v[152:155], v[88:91], v[88:91], 0
    s_waitcnt lgkmcnt(2)
    v_fmac_f32 v200, v144, v20
    v_mfma_f32_16x16x32_bf16 v[152:155], v[92:95], v[92:95], v[152:155]
    v_fmac_f32 v201, v145, v21
    v_fmac_f32 v200, v146, v22
    v_mfma_f32_16x16x32_bf16 v[116:119], v[96:99], v[64:67], 0
    v_fmac_f32 v201, v147, v23
    ds_write_b16 v207, v246 offset:5760
    v_mfma_f32_16x16x32_bf16 v[116:119], v[100:103], v[68:71], v[116:119]
    ds_write_b16 v207, v247 offset:6336
    buffer_load_dwordx4 v[244:247], v249, s[16:19], s74 offen offset:800
    v_smfmac_f32_16x16x64_bf16 v[188:191], v[24:27], v[148:155], v208
    v_mfma_f32_16x16x32_bf16 v[120:123], v[104:107], v[64:67], 0
    v_mfma_f32_16x16x32_bf16 v[120:123], v[108:111], v[68:71], v[120:123]
    v_smfmac_f32_16x16x64_bf16 v[164:167], v[112:115], v[64:71], v250
    v_mad_u32_u16 v68, v196, s57, v205 op_sel:[0,0,0,0]
    v_mfma_f32_16x16x32_bf16 v[124:127], v[96:99], v[72:75], 0
    ds_read_b128 v[64:67], v68 offset:0
    ds_read_b128 v[68:71], v68 offset:64
    v_smfmac_f32_16x16x64_bf16 v[188:191], v[28:31], v[116:123], v208
    v_mfma_f32_16x16x32_bf16 v[124:127], v[100:103], v[76:79], v[124:127]
    v_mul_f32 v209, v164, v56
    v_mfma_f32_16x16x32_bf16 v[128:131], v[104:107], v[72:75], 0
    v_fmac_f32 v209, v165, v56
    v_mfma_f32_16x16x32_bf16 v[128:131], v[108:111], v[76:79], v[128:131]
    v_smfmac_f32_16x16x64_bf16 v[168:171], v[112:115], v[72:79], v250
    v_mad_u32_u16 v76, v196, s57, v205 op_sel:[1,0,0,0]
    v_mfma_f32_16x16x32_bf16 v[132:135], v[96:99], v[80:83], 0
    ds_read_b128 v[72:75], v76 offset:0
    ds_read_b128 v[76:79], v76 offset:64
    v_mfma_f32_16x16x32_bf16 v[132:135], v[100:103], v[84:87], v[132:135]
    v_fmac_f32 v200, v124, v32
    v_fmac_f32 v201, v125, v33
    v_mfma_f32_16x16x32_bf16 v[136:139], v[104:107], v[80:83], 0
    v_fmac_f32 v209, v168, v57
    v_fmac_f32 v200, v126, v34
    v_mfma_f32_16x16x32_bf16 v[136:139], v[108:111], v[84:87], v[136:139]
    v_fmac_f32 v209, v169, v57
    v_fmac_f32 v201, v127, v35
    v_smfmac_f32_16x16x64_bf16 v[172:175], v[112:115], v[80:87], v250
    v_mad_u32_u16 v84, v197, s57, v205 op_sel:[0,0,0,0]
    v_mfma_f32_16x16x32_bf16 v[140:143], v[96:99], v[88:91], 0
    ds_read_b128 v[80:83], v84 offset:0
    ds_read_b128 v[84:87], v84 offset:64
    v_smfmac_f32_16x16x64_bf16 v[188:191], v[40:43], v[132:139], v208
    v_fmac_f32 v200, v128, v36
    v_mfma_f32_16x16x32_bf16 v[140:143], v[100:103], v[92:95], v[140:143]
    v_fmac_f32 v209, v172, v58
    v_fmac_f32 v201, v129, v37
    v_mfma_f32_16x16x32_bf16 v[144:147], v[104:107], v[88:91], 0
    v_fmac_f32 v209, v173, v58
    v_fmac_f32 v200, v130, v38
    v_mfma_f32_16x16x32_bf16 v[144:147], v[108:111], v[92:95], v[144:147]
    v_fmac_f32 v201, v131, v39
    v_smfmac_f32_16x16x64_bf16 v[176:179], v[112:115], v[88:95], v250
    v_mad_u32_u16 v92, v197, s57, v205 op_sel:[1,0,0,0]
    v_mfma_f32_16x16x32_bf16 v[148:151], v[96:99], v[96:99], 0
    ds_read_b128 v[88:91], v92 offset:0
    ds_read_b128 v[92:95], v92 offset:64
    v_smfmac_f32_16x16x64_bf16 v[188:191], v[44:47], v[140:147], v208
    v_mfma_f32_16x16x32_bf16 v[148:151], v[100:103], v[100:103], v[148:151]
    v_fmac_f32 v209, v176, v59
    v_mfma_f32_16x16x32_bf16 v[152:155], v[104:107], v[96:99], 0
    v_fmac_f32 v209, v177, v59
    v_mfma_f32_16x16x32_bf16 v[152:155], v[108:111], v[100:103], v[152:155]
    v_smfmac_f32_16x16x64_bf16 v[180:183], v[112:115], v[96:103], v250
    v_mad_u32_u16 v100, v198, s57, v205 op_sel:[0,0,0,0]
    v_mfma_f32_16x16x32_bf16 v[156:159], v[104:107], v[104:107], 0
    ds_read_b128 v[96:99], v100 offset:0
    ds_read_b128 v[100:103], v100 offset:64
    v_smfmac_f32_16x16x64_bf16 v[188:191], v[48:51], v[148:155], v208
    s_waitcnt lgkmcnt(4)
    v_mfma_f32_16x16x32_bf16 v[156:159], v[108:111], v[108:111], v[156:159]
    v_fmac_f32 v209, v180, v60
    v_smfmac_f32_16x16x64_bf16 v[184:187], v[112:115], v[104:111], v250
    v_mad_u32_u16 v108, v198, s57, v205 op_sel:[1,0,0,0]
    v_mfma_f32_16x16x32_bf16 v[160:163], v[112:115], v[112:115], 0
    ds_read_b128 v[104:107], v108 offset:0
    v_mfma_f32_16x16x32_bf16 v[116:119], v[64:67], v[64:67], 0
    ds_read_b128 v[108:111], v108 offset:64
    v_mad_u32_u16 v114, v199, s57, v248 op_sel:[0,0,0,0]
    v_mfma_f32_16x16x32_bf16 v[116:119], v[68:71], v[68:71], v[116:119]
    ds_read2_b32 v[112:113], v114 offset0:0 offset1:2
    ds_read2_b32 v[114:115], v114 offset0:4 offset1:6
    v_mfma_f32_16x16x32_bf16 v[120:123], v[72:75], v[64:67], 0
    ds_read_b128 v[196:199], v206 offset:4608
    v_fmac_f32 v209, v181, v60
    v_mfma_f32_16x16x32_bf16 v[120:123], v[76:79], v[68:71], v[120:123]
    v_fmac_f32 v209, v184, v61
    v_fmac_f32 v209, v188, v192
    v_mfma_f32_16x16x32_bf16 v[124:127], v[72:75], v[72:75], 0
    v_fmac_f32 v209, v185, v61
    v_fmac_f32 v209, v189, v193
    v_mfma_f32_16x16x32_bf16 v[124:127], v[76:79], v[76:79], v[124:127]
    v_fmac_f32 v209, v190, v194
    v_fmac_f32 v209, v191, v195
    v_mfma_f32_16x16x32_bf16 v[128:131], v[80:83], v[72:75], 0
    v_fmac_f32 v200, v156, v52
    v_fmac_f32 v201, v157, v53
    v_mfma_f32_16x16x32_bf16 v[128:131], v[84:87], v[76:79], v[128:131]
    v_fmac_f32 v200, v158, v54
    v_fmac_f32 v201, v159, v55
    v_mfma_f32_16x16x32_bf16 v[132:135], v[80:83], v[64:67], 0
    v_add_f32 v201, v201, v209
    v_fmac_f32 v200, v160, v62
    v_mfma_f32_16x16x32_bf16 v[132:135], v[84:87], v[68:71], v[132:135]
    s_waitcnt lgkmcnt(7)
    v_fmac_f32 v200, v161, v63
    v_smfmac_f32_16x16x64_bf16 v[188:191], v[8:11], v[124:131], v208
    v_add_f32 v202, v200, v201
    v_mfma_f32_16x16x32_bf16 v[136:139], v[88:91], v[64:67], 0
    v_fma_f32 v200, v116, v0, -v209
    v_mul_f32 v201, v117, v1
    v_mfma_f32_16x16x32_bf16 v[136:139], v[92:95], v[68:71], v[136:139]
    v_fmac_f32 v200, v118, v2
    v_fmac_f32 v201, v119, v3
    v_mfma_f32_16x16x32_bf16 v[140:143], v[72:75], v[88:91], 0
    v_fmac_f32 v200, v120, v4
    v_fmac_f32 v201, v121, v5
    v_mfma_f32_16x16x32_bf16 v[140:143], v[76:79], v[92:95], v[140:143]
    v_fmac_f32 v200, v122, v6
    v_fmac_f32 v201, v123, v7
    v_smfmac_f32_16x16x64_bf16 v[188:191], v[12:15], v[132:139], v208
    v_permlane16_swap_b32 v210, v211
    v_mfma_f32_16x16x32_bf16 v[144:147], v[80:83], v[88:91], 0
    s_add_u32 s74, s74, s77
    s_min_i32 s74, s74, s79
    v_mfma_f32_16x16x32_bf16 v[144:147], v[84:87], v[92:95], v[144:147]
    v_fmac_f32 v200, v140, v16
    v_fmac_f32 v201, v141, v17
    v_mfma_f32_16x16x32_bf16 v[148:151], v[80:83], v[80:83], 0
    v_fmac_f32 v200, v142, v18
    v_fmac_f32 v201, v143, v19
    v_mfma_f32_16x16x32_bf16 v[148:151], v[84:87], v[84:87], v[148:151]
    v_add_f32 v212, v210, v211
    s_max_i32 s74, s74, s78
    v_mfma_f32_16x16x32_bf16 v[152:155], v[88:91], v[88:91], 0
    s_waitcnt lgkmcnt(0)
    v_fmac_f32 v200, v144, v20
    v_mfma_f32_16x16x32_bf16 v[152:155], v[92:95], v[92:95], v[152:155]
    v_fmac_f32 v201, v145, v21
    v_fmac_f32 v200, v146, v22
    v_mfma_f32_16x16x32_bf16 v[116:119], v[96:99], v[64:67], 0
    v_fmac_f32 v201, v147, v23
    v_mfma_f32_16x16x32_bf16 v[116:119], v[100:103], v[68:71], v[116:119]
    v_smfmac_f32_16x16x64_bf16 v[188:191], v[24:27], v[148:155], v208
    v_mfma_f32_16x16x32_bf16 v[120:123], v[104:107], v[64:67], 0
    v_mfma_f32_16x16x32_bf16 v[120:123], v[108:111], v[68:71], v[120:123]
    v_smfmac_f32_16x16x64_bf16 v[164:167], v[112:115], v[64:71], v250
    v_mad_u32_u16 v68, v196, s57, v205 op_sel:[0,0,0,0]
    v_mfma_f32_16x16x32_bf16 v[124:127], v[96:99], v[72:75], 0
    ds_read_b128 v[64:67], v68 offset:0
    ds_read_b128 v[68:71], v68 offset:64
    v_smfmac_f32_16x16x64_bf16 v[188:191], v[28:31], v[116:123], v208
    v_mfma_f32_16x16x32_bf16 v[124:127], v[100:103], v[76:79], v[124:127]
    v_mul_f32 v209, v164, v56
    v_mfma_f32_16x16x32_bf16 v[128:131], v[104:107], v[72:75], 0
    v_fmac_f32 v209, v165, v56
    v_mfma_f32_16x16x32_bf16 v[128:131], v[108:111], v[76:79], v[128:131]
    v_smfmac_f32_16x16x64_bf16 v[168:171], v[112:115], v[72:79], v250
    v_mad_u32_u16 v76, v196, s57, v205 op_sel:[1,0,0,0]
    v_mfma_f32_16x16x32_bf16 v[132:135], v[96:99], v[80:83], 0
    ds_read_b128 v[72:75], v76 offset:0
    ds_read_b128 v[76:79], v76 offset:64
    v_mfma_f32_16x16x32_bf16 v[132:135], v[100:103], v[84:87], v[132:135]
    v_fmac_f32 v200, v124, v32
    v_fmac_f32 v201, v125, v33
    v_mfma_f32_16x16x32_bf16 v[136:139], v[104:107], v[80:83], 0
    v_fmac_f32 v209, v168, v57
    v_fmac_f32 v200, v126, v34
    v_mfma_f32_16x16x32_bf16 v[136:139], v[108:111], v[84:87], v[136:139]
    v_fmac_f32 v209, v169, v57
    v_fmac_f32 v201, v127, v35
    v_smfmac_f32_16x16x64_bf16 v[172:175], v[112:115], v[80:87], v250
    v_mad_u32_u16 v84, v197, s57, v205 op_sel:[0,0,0,0]
    v_mfma_f32_16x16x32_bf16 v[140:143], v[96:99], v[88:91], 0
    ds_read_b128 v[80:83], v84 offset:0
    ds_read_b128 v[84:87], v84 offset:64
    v_smfmac_f32_16x16x64_bf16 v[188:191], v[40:43], v[132:139], v208
    v_fmac_f32 v200, v128, v36
    v_mfma_f32_16x16x32_bf16 v[140:143], v[100:103], v[92:95], v[140:143]
    v_fmac_f32 v209, v172, v58
    v_fmac_f32 v201, v129, v37
    v_mfma_f32_16x16x32_bf16 v[144:147], v[104:107], v[88:91], 0
    v_fmac_f32 v209, v173, v58
    v_fmac_f32 v200, v130, v38
    v_mfma_f32_16x16x32_bf16 v[144:147], v[108:111], v[92:95], v[144:147]
    v_fmac_f32 v201, v131, v39
    v_smfmac_f32_16x16x64_bf16 v[176:179], v[112:115], v[88:95], v250
    v_mad_u32_u16 v92, v197, s57, v205 op_sel:[1,0,0,0]
    v_mfma_f32_16x16x32_bf16 v[148:151], v[96:99], v[96:99], 0
    ds_read_b128 v[88:91], v92 offset:0
    ds_read_b128 v[92:95], v92 offset:64
    v_smfmac_f32_16x16x64_bf16 v[188:191], v[44:47], v[140:147], v208
    v_mfma_f32_16x16x32_bf16 v[148:151], v[100:103], v[100:103], v[148:151]
    v_fmac_f32 v209, v176, v59
    v_mfma_f32_16x16x32_bf16 v[152:155], v[104:107], v[96:99], 0
    v_fmac_f32 v209, v177, v59
    v_mfma_f32_16x16x32_bf16 v[152:155], v[108:111], v[100:103], v[152:155]
    v_smfmac_f32_16x16x64_bf16 v[180:183], v[112:115], v[96:103], v250
    v_mad_u32_u16 v100, v198, s57, v205 op_sel:[0,0,0,0]
    v_mfma_f32_16x16x32_bf16 v[156:159], v[104:107], v[104:107], 0
    ds_read_b128 v[96:99], v100 offset:0
    ds_read_b128 v[100:103], v100 offset:64
    v_smfmac_f32_16x16x64_bf16 v[188:191], v[48:51], v[148:155], v208
    s_waitcnt lgkmcnt(4)
    v_mfma_f32_16x16x32_bf16 v[156:159], v[108:111], v[108:111], v[156:159]
    v_fmac_f32 v209, v180, v60
    v_smfmac_f32_16x16x64_bf16 v[184:187], v[112:115], v[104:111], v250
    v_mad_u32_u16 v108, v198, s57, v205 op_sel:[1,0,0,0]
    v_mfma_f32_16x16x32_bf16 v[160:163], v[112:115], v[112:115], 0
    ds_read_b128 v[104:107], v108 offset:0
    v_mfma_f32_16x16x32_bf16 v[116:119], v[64:67], v[64:67], 0
    ds_read_b128 v[108:111], v108 offset:64
    v_mad_u32_u16 v114, v199, s57, v248 op_sel:[0,0,0,0]
    v_mfma_f32_16x16x32_bf16 v[116:119], v[68:71], v[68:71], v[116:119]
    ds_read2_b32 v[112:113], v114 offset0:0 offset1:2
    ds_read2_b32 v[114:115], v114 offset0:4 offset1:6
    v_mfma_f32_16x16x32_bf16 v[120:123], v[72:75], v[64:67], 0
    ds_read_b128 v[196:199], v206 offset:6912
    v_fmac_f32 v209, v181, v60
    v_mfma_f32_16x16x32_bf16 v[120:123], v[76:79], v[68:71], v[120:123]
    v_fmac_f32 v209, v184, v61
    v_fmac_f32 v209, v188, v192
    v_mfma_f32_16x16x32_bf16 v[124:127], v[72:75], v[72:75], 0
    v_fmac_f32 v209, v185, v61
    v_fmac_f32 v209, v189, v193
    v_mfma_f32_16x16x32_bf16 v[124:127], v[76:79], v[76:79], v[124:127]
    v_fmac_f32 v209, v190, v194
    v_fmac_f32 v209, v191, v195
    v_mfma_f32_16x16x32_bf16 v[128:131], v[80:83], v[72:75], 0
    v_fmac_f32 v200, v156, v52
    v_fmac_f32 v201, v157, v53
    v_mfma_f32_16x16x32_bf16 v[128:131], v[84:87], v[76:79], v[128:131]
    v_fmac_f32 v200, v158, v54
    v_fmac_f32 v201, v159, v55
    v_mfma_f32_16x16x32_bf16 v[132:135], v[80:83], v[64:67], 0
    v_add_f32 v201, v201, v209
    v_fmac_f32 v200, v160, v62
    v_mfma_f32_16x16x32_bf16 v[132:135], v[84:87], v[68:71], v[132:135]
    s_waitcnt lgkmcnt(7)
    v_fmac_f32 v200, v161, v63
    v_smfmac_f32_16x16x64_bf16 v[188:191], v[8:11], v[124:131], v208
    v_add_f32 v203, v200, v201
    v_mfma_f32_16x16x32_bf16 v[136:139], v[88:91], v[64:67], 0
    v_fma_f32 v200, v116, v0, -v209
    v_mul_f32 v201, v117, v1
    v_mfma_f32_16x16x32_bf16 v[136:139], v[92:95], v[68:71], v[136:139]
    v_fmac_f32 v200, v118, v2
    v_fmac_f32 v201, v119, v3
    v_mfma_f32_16x16x32_bf16 v[140:143], v[72:75], v[88:91], 0
    v_fmac_f32 v200, v120, v4
    v_fmac_f32 v201, v121, v5
    v_mfma_f32_16x16x32_bf16 v[140:143], v[76:79], v[92:95], v[140:143]
    v_fmac_f32 v200, v122, v6
    v_fmac_f32 v201, v123, v7
    v_smfmac_f32_16x16x64_bf16 v[188:191], v[12:15], v[132:139], v208
    v_permlane32_swap_b32 v202, v203
    v_mfma_f32_16x16x32_bf16 v[144:147], v[80:83], v[88:91], 0
    s_waitcnt vmcnt(1)
    ds_write_b16 v207, v240 offset:0
    v_mfma_f32_16x16x32_bf16 v[144:147], v[84:87], v[92:95], v[144:147]
    v_fmac_f32 v200, v140, v16
    v_fmac_f32 v201, v141, v17
    v_mfma_f32_16x16x32_bf16 v[148:151], v[80:83], v[80:83], 0
    v_fmac_f32 v200, v142, v18
    v_fmac_f32 v201, v143, v19
    v_mfma_f32_16x16x32_bf16 v[148:151], v[84:87], v[84:87], v[148:151]
    v_add_f32 v210, v202, v203
    ds_write_b16 v207, v241 offset:576
    v_mfma_f32_16x16x32_bf16 v[152:155], v[88:91], v[88:91], 0
    s_waitcnt lgkmcnt(2)
    v_fmac_f32 v200, v144, v20
    v_mfma_f32_16x16x32_bf16 v[152:155], v[92:95], v[92:95], v[152:155]
    v_fmac_f32 v201, v145, v21
    v_fmac_f32 v200, v146, v22
    v_mfma_f32_16x16x32_bf16 v[116:119], v[96:99], v[64:67], 0
    v_fmac_f32 v201, v147, v23
    ds_write_b16 v207, v242 offset:1152
    v_mfma_f32_16x16x32_bf16 v[116:119], v[100:103], v[68:71], v[116:119]
    ds_write_b16 v207, v243 offset:1728
    buffer_load_dwordx4 v[240:243], v249, s[16:19], s74 offen offset:0
    v_smfmac_f32_16x16x64_bf16 v[188:191], v[24:27], v[148:155], v208
    v_mfma_f32_16x16x32_bf16 v[120:123], v[104:107], v[64:67], 0
    v_mfma_f32_16x16x32_bf16 v[120:123], v[108:111], v[68:71], v[120:123]
    v_smfmac_f32_16x16x64_bf16 v[164:167], v[112:115], v[64:71], v250
    v_mad_u32_u16 v68, v196, s57, v205 op_sel:[0,0,0,0]
    v_mfma_f32_16x16x32_bf16 v[124:127], v[96:99], v[72:75], 0
    ds_read_b128 v[64:67], v68 offset:0
    ds_read_b128 v[68:71], v68 offset:64
    v_smfmac_f32_16x16x64_bf16 v[188:191], v[28:31], v[116:123], v208
    v_mfma_f32_16x16x32_bf16 v[124:127], v[100:103], v[76:79], v[124:127]
    v_mul_f32 v209, v164, v56
    v_mfma_f32_16x16x32_bf16 v[128:131], v[104:107], v[72:75], 0
    v_fmac_f32 v209, v165, v56
    v_mfma_f32_16x16x32_bf16 v[128:131], v[108:111], v[76:79], v[128:131]
    v_smfmac_f32_16x16x64_bf16 v[168:171], v[112:115], v[72:79], v250
    v_mad_u32_u16 v76, v196, s57, v205 op_sel:[1,0,0,0]
    v_mfma_f32_16x16x32_bf16 v[132:135], v[96:99], v[80:83], 0
    ds_read_b128 v[72:75], v76 offset:0
    ds_read_b128 v[76:79], v76 offset:64
    v_mfma_f32_16x16x32_bf16 v[132:135], v[100:103], v[84:87], v[132:135]
    v_fmac_f32 v200, v124, v32
    v_fmac_f32 v201, v125, v33
    v_mfma_f32_16x16x32_bf16 v[136:139], v[104:107], v[80:83], 0
    v_fmac_f32 v209, v168, v57
    v_fmac_f32 v200, v126, v34
    v_mfma_f32_16x16x32_bf16 v[136:139], v[108:111], v[84:87], v[136:139]
    v_fmac_f32 v209, v169, v57
    v_fmac_f32 v201, v127, v35
    v_smfmac_f32_16x16x64_bf16 v[172:175], v[112:115], v[80:87], v250
    v_mad_u32_u16 v84, v197, s57, v205 op_sel:[0,0,0,0]
    v_mfma_f32_16x16x32_bf16 v[140:143], v[96:99], v[88:91], 0
    ds_read_b128 v[80:83], v84 offset:0
    ds_read_b128 v[84:87], v84 offset:64
    v_smfmac_f32_16x16x64_bf16 v[188:191], v[40:43], v[132:139], v208
    v_fmac_f32 v200, v128, v36
    v_mfma_f32_16x16x32_bf16 v[140:143], v[100:103], v[92:95], v[140:143]
    v_fmac_f32 v209, v172, v58
    v_fmac_f32 v201, v129, v37
    v_mfma_f32_16x16x32_bf16 v[144:147], v[104:107], v[88:91], 0
    v_fmac_f32 v209, v173, v58
    v_fmac_f32 v200, v130, v38
    v_mfma_f32_16x16x32_bf16 v[144:147], v[108:111], v[92:95], v[144:147]
    v_fmac_f32 v201, v131, v39
    v_smfmac_f32_16x16x64_bf16 v[176:179], v[112:115], v[88:95], v250
    v_mad_u32_u16 v92, v197, s57, v205 op_sel:[1,0,0,0]
    v_mfma_f32_16x16x32_bf16 v[148:151], v[96:99], v[96:99], 0
    ds_read_b128 v[88:91], v92 offset:0
    ds_read_b128 v[92:95], v92 offset:64
    v_smfmac_f32_16x16x64_bf16 v[188:191], v[44:47], v[140:147], v208
    v_mfma_f32_16x16x32_bf16 v[148:151], v[100:103], v[100:103], v[148:151]
    v_fmac_f32 v209, v176, v59
    v_mfma_f32_16x16x32_bf16 v[152:155], v[104:107], v[96:99], 0
    v_fmac_f32 v209, v177, v59
    v_mfma_f32_16x16x32_bf16 v[152:155], v[108:111], v[100:103], v[152:155]
    v_smfmac_f32_16x16x64_bf16 v[180:183], v[112:115], v[96:103], v250
    v_mad_u32_u16 v100, v198, s57, v205 op_sel:[0,0,0,0]
    v_mfma_f32_16x16x32_bf16 v[156:159], v[104:107], v[104:107], 0
    ds_read_b128 v[96:99], v100 offset:0
    ds_read_b128 v[100:103], v100 offset:64
    v_smfmac_f32_16x16x64_bf16 v[188:191], v[48:51], v[148:155], v208
    s_waitcnt lgkmcnt(4)
    v_mfma_f32_16x16x32_bf16 v[156:159], v[108:111], v[108:111], v[156:159]
    v_fmac_f32 v209, v180, v60
    v_smfmac_f32_16x16x64_bf16 v[184:187], v[112:115], v[104:111], v250
    v_mad_u32_u16 v108, v198, s57, v205 op_sel:[1,0,0,0]
    v_mfma_f32_16x16x32_bf16 v[160:163], v[112:115], v[112:115], 0
    ds_read_b128 v[104:107], v108 offset:0
    v_mfma_f32_16x16x32_bf16 v[116:119], v[64:67], v[64:67], 0
    ds_read_b128 v[108:111], v108 offset:64
    v_mad_u32_u16 v114, v199, s57, v248 op_sel:[0,0,0,0]
    v_mfma_f32_16x16x32_bf16 v[116:119], v[68:71], v[68:71], v[116:119]
    ds_read2_b32 v[112:113], v114 offset0:0 offset1:2
    ds_read2_b32 v[114:115], v114 offset0:4 offset1:6
    v_mfma_f32_16x16x32_bf16 v[120:123], v[72:75], v[64:67], 0
    ds_read_b128 v[196:199], v206 offset:0
    v_fmac_f32 v209, v181, v60
    v_mfma_f32_16x16x32_bf16 v[120:123], v[76:79], v[68:71], v[120:123]
    v_fmac_f32 v209, v184, v61
    v_fmac_f32 v209, v188, v192
    v_mfma_f32_16x16x32_bf16 v[124:127], v[72:75], v[72:75], 0
    v_fmac_f32 v209, v185, v61
    v_fmac_f32 v209, v189, v193
    v_mfma_f32_16x16x32_bf16 v[124:127], v[76:79], v[76:79], v[124:127]
    v_fmac_f32 v209, v190, v194
    v_fmac_f32 v209, v191, v195
    v_mfma_f32_16x16x32_bf16 v[128:131], v[80:83], v[72:75], 0
    v_fmac_f32 v200, v156, v52
    v_fmac_f32 v201, v157, v53
    v_mfma_f32_16x16x32_bf16 v[128:131], v[84:87], v[76:79], v[128:131]
    v_fmac_f32 v200, v158, v54
    v_fmac_f32 v201, v159, v55
    v_mfma_f32_16x16x32_bf16 v[132:135], v[80:83], v[64:67], 0
    v_add_f32 v201, v201, v209
    v_fmac_f32 v200, v160, v62
    v_mfma_f32_16x16x32_bf16 v[132:135], v[84:87], v[68:71], v[132:135]
    s_waitcnt lgkmcnt(7)
    v_fmac_f32 v200, v161, v63
    v_smfmac_f32_16x16x64_bf16 v[188:191], v[8:11], v[124:131], v208
    v_add_f32 v202, v200, v201
    v_mfma_f32_16x16x32_bf16 v[136:139], v[88:91], v[64:67], 0
    v_fma_f32 v200, v116, v0, -v209
    v_mul_f32 v201, v117, v1
    v_mfma_f32_16x16x32_bf16 v[136:139], v[92:95], v[68:71], v[136:139]
    v_fmac_f32 v200, v118, v2
    v_fmac_f32 v201, v119, v3
    v_mfma_f32_16x16x32_bf16 v[140:143], v[72:75], v[88:91], 0
    v_fmac_f32 v200, v120, v4
    v_fmac_f32 v201, v121, v5
    v_mfma_f32_16x16x32_bf16 v[140:143], v[76:79], v[92:95], v[140:143]
    v_fmac_f32 v200, v122, v6
    v_fmac_f32 v201, v123, v7
    v_smfmac_f32_16x16x64_bf16 v[188:191], v[12:15], v[132:139], v208
    v_add_f32_dpp v212, v212, v212 quad_perm:[1,0,3,2] row_mask:0xf bank_mask:0xf
    v_mfma_f32_16x16x32_bf16 v[144:147], v[80:83], v[88:91], 0
    s_sub_u32 s58, s58, 1
    v_mfma_f32_16x16x32_bf16 v[144:147], v[84:87], v[92:95], v[144:147]
    v_fmac_f32 v200, v140, v16
    v_fmac_f32 v201, v141, v17
    v_mfma_f32_16x16x32_bf16 v[148:151], v[80:83], v[80:83], 0
    v_fmac_f32 v200, v142, v18
    v_fmac_f32 v201, v143, v19
    v_mfma_f32_16x16x32_bf16 v[148:151], v[84:87], v[84:87], v[148:151]
    v_add_f32_dpp v212, v212, v212 quad_perm:[2,3,0,1] row_mask:0xf bank_mask:0xf
    v_mfma_f32_16x16x32_bf16 v[152:155], v[88:91], v[88:91], 0
    s_waitcnt lgkmcnt(0)
    v_fmac_f32 v200, v144, v20
    v_mfma_f32_16x16x32_bf16 v[152:155], v[92:95], v[92:95], v[152:155]
    v_fmac_f32 v201, v145, v21
    v_fmac_f32 v200, v146, v22
    v_mfma_f32_16x16x32_bf16 v[116:119], v[96:99], v[64:67], 0
    v_fmac_f32 v201, v147, v23
    v_add_f32_dpp v212, v212, v212 row_half_mirror row_mask:0xf bank_mask:0xf
    v_mfma_f32_16x16x32_bf16 v[116:119], v[100:103], v[68:71], v[116:119]
    v_smfmac_f32_16x16x64_bf16 v[188:191], v[24:27], v[148:155], v208
    v_cndmask_b32_dpp v204, v204, v212, vcc row_shr:1 row_mask:0xf bank_mask:0xf bound_ctrl:0
    v_mfma_f32_16x16x32_bf16 v[120:123], v[104:107], v[64:67], 0
    v_mfma_f32_16x16x32_bf16 v[120:123], v[108:111], v[68:71], v[120:123]
    v_smfmac_f32_16x16x64_bf16 v[164:167], v[112:115], v[64:71], v250
    v_mad_u32_u16 v68, v196, s57, v205 op_sel:[0,0,0,0]
    v_mfma_f32_16x16x32_bf16 v[124:127], v[96:99], v[72:75], 0
    ds_read_b128 v[64:67], v68 offset:0
    ds_read_b128 v[68:71], v68 offset:64
    v_smfmac_f32_16x16x64_bf16 v[188:191], v[28:31], v[116:123], v208
    v_mfma_f32_16x16x32_bf16 v[124:127], v[100:103], v[76:79], v[124:127]
    v_mul_f32 v209, v164, v56
    v_mfma_f32_16x16x32_bf16 v[128:131], v[104:107], v[72:75], 0
    v_fmac_f32 v209, v165, v56
    v_mfma_f32_16x16x32_bf16 v[128:131], v[108:111], v[76:79], v[128:131]
    v_smfmac_f32_16x16x64_bf16 v[168:171], v[112:115], v[72:79], v250
    v_mad_u32_u16 v76, v196, s57, v205 op_sel:[1,0,0,0]
    v_mfma_f32_16x16x32_bf16 v[132:135], v[96:99], v[80:83], 0
    ds_read_b128 v[72:75], v76 offset:0
    ds_read_b128 v[76:79], v76 offset:64
    v_mfma_f32_16x16x32_bf16 v[132:135], v[100:103], v[84:87], v[132:135]
    v_fmac_f32 v200, v124, v32
    v_fmac_f32 v201, v125, v33
    v_mfma_f32_16x16x32_bf16 v[136:139], v[104:107], v[80:83], 0
    v_fmac_f32 v209, v168, v57
    v_fmac_f32 v200, v126, v34
    v_mfma_f32_16x16x32_bf16 v[136:139], v[108:111], v[84:87], v[136:139]
    v_fmac_f32 v209, v169, v57
    v_fmac_f32 v201, v127, v35
    v_smfmac_f32_16x16x64_bf16 v[172:175], v[112:115], v[80:87], v250
    v_mad_u32_u16 v84, v197, s57, v205 op_sel:[0,0,0,0]
    v_mfma_f32_16x16x32_bf16 v[140:143], v[96:99], v[88:91], 0
    ds_read_b128 v[80:83], v84 offset:0
    ds_read_b128 v[84:87], v84 offset:64
    v_smfmac_f32_16x16x64_bf16 v[188:191], v[40:43], v[132:139], v208
    v_fmac_f32 v200, v128, v36
    v_mfma_f32_16x16x32_bf16 v[140:143], v[100:103], v[92:95], v[140:143]
    v_fmac_f32 v209, v172, v58
    v_fmac_f32 v201, v129, v37
    v_mfma_f32_16x16x32_bf16 v[144:147], v[104:107], v[88:91], 0
    v_fmac_f32 v209, v173, v58
    v_fmac_f32 v200, v130, v38
    v_mfma_f32_16x16x32_bf16 v[144:147], v[108:111], v[92:95], v[144:147]
    v_fmac_f32 v201, v131, v39
    v_smfmac_f32_16x16x64_bf16 v[176:179], v[112:115], v[88:95], v250
    v_mad_u32_u16 v92, v197, s57, v205 op_sel:[1,0,0,0]
    v_mfma_f32_16x16x32_bf16 v[148:151], v[96:99], v[96:99], 0
    ds_read_b128 v[88:91], v92 offset:0
    ds_read_b128 v[92:95], v92 offset:64
    v_smfmac_f32_16x16x64_bf16 v[188:191], v[44:47], v[140:147], v208
    v_mfma_f32_16x16x32_bf16 v[148:151], v[100:103], v[100:103], v[148:151]
    v_fmac_f32 v209, v176, v59
    v_mfma_f32_16x16x32_bf16 v[152:155], v[104:107], v[96:99], 0
    v_fmac_f32 v209, v177, v59
    v_mfma_f32_16x16x32_bf16 v[152:155], v[108:111], v[100:103], v[152:155]
    v_smfmac_f32_16x16x64_bf16 v[180:183], v[112:115], v[96:103], v250
    v_mad_u32_u16 v100, v198, s57, v205 op_sel:[0,0,0,0]
    v_mfma_f32_16x16x32_bf16 v[156:159], v[104:107], v[104:107], 0
    ds_read_b128 v[96:99], v100 offset:0
    ds_read_b128 v[100:103], v100 offset:64
    v_smfmac_f32_16x16x64_bf16 v[188:191], v[48:51], v[148:155], v208
    s_waitcnt lgkmcnt(4)
    v_mfma_f32_16x16x32_bf16 v[156:159], v[108:111], v[108:111], v[156:159]
    v_fmac_f32 v209, v180, v60
    v_smfmac_f32_16x16x64_bf16 v[184:187], v[112:115], v[104:111], v250
    v_mad_u32_u16 v108, v198, s57, v205 op_sel:[1,0,0,0]
    v_mfma_f32_16x16x32_bf16 v[160:163], v[112:115], v[112:115], 0
    ds_read_b128 v[104:107], v108 offset:0
    s_cbranch_scc0 k1_kernel_loop
    s_nop 7
    v_fmac_f32 v209, v181, v60
    v_fmac_f32 v209, v184, v61
    v_fmac_f32 v209, v188, v192
    v_fmac_f32 v209, v185, v61
    v_fmac_f32 v209, v189, v193
    v_fmac_f32 v209, v190, v194
    v_fmac_f32 v209, v191, v195
    v_fmac_f32 v200, v156, v52
    v_fmac_f32 v201, v157, v53
    v_fmac_f32 v200, v158, v54
    v_fmac_f32 v201, v159, v55
    v_add_f32 v201, v201, v209
    v_fmac_f32 v200, v160, v62
    v_fmac_f32 v200, v161, v63
    v_add_f32 v203, v200, v201
    v_and_b32 v40, 7, v255
    s_mul_i32 s76, s36, 7
    v_permlane32_swap_b32 v202, v203
    v_add_f32 v211, v202, v203
    s_waitcnt lgkmcnt(0)
    v_lshrrev_b32 v41, 5, v255
    v_permlane16_swap_b32 v210, v211
    v_add_f32 v212, v210, v211
    s_xor_b32 s76, s76, 7
    v_bfe_u32 v42, v255, 4, 1
    v_add_f32_dpp v212, v212, v212 quad_perm:[1,0,3,2] row_mask:0xf bank_mask:0xf
    v_xor_b32 v40, s76, v40
    v_lshl_add_u32 v41, v42, 1, v41
    v_add_f32_dpp v212, v212, v212 quad_perm:[2,3,0,1] row_mask:0xf bank_mask:0xf
    s_lshl_b32 s74, s72, 2
    v_lshl_add_u32 v40, v40, 2, v41
    v_add_f32_dpp v212, v212, v212 row_half_mirror row_mask:0xf bank_mask:0xf
    v_cndmask_b32_dpp v204, v204, v212, vcc row_shr:1 row_mask:0xf bank_mask:0xf bound_ctrl:0
    s_lshl_b32 s76, s36, 16
    v_lshlrev_b32 v113, 2, v40
    v_add_f32_dpp v112, v204, v204 row_ror:8 row_mask:0xf bank_mask:0xf
    s_add_u32 s74, s74, s76
    s_add_u32 s74, s74, 29360128
    s_waitcnt vmcnt(0)
    v_min_u32 v112, -2, v112
    s_branch k1_kernel_k2
k1_kernel_last:
    s_endpgm
.section .rodata,"a"
.p2align 6
.amdhsa_kernel standalone__deep_cross_pnn__recsys_kernel
  .amdhsa_next_free_vgpr 256
  .amdhsa_next_free_sgpr 96
  .amdhsa_accum_offset 256
  .amdhsa_group_segment_fixed_size 0
  .amdhsa_kernarg_size 80
  .amdhsa_user_sgpr_count 2
  .amdhsa_user_sgpr_kernarg_segment_ptr 1
  .amdhsa_system_sgpr_workgroup_id_x 1
.end_amdhsa_kernel
```

```asm
; @launch grid=(256,1,1) block=(512,1,1) lds=163840
.amdgcn_target "amdgcn-amd-amdhsa--gfx950"
.text
.globl standalone__deep_cross_pnn__recsys_kernel
.p2align 8
.type standalone__deep_cross_pnn__recsys_kernel,@function
standalone__deep_cross_pnn__recsys_kernel:

    s_cmp_ge_u32 s2, 256
    s_cbranch_scc1 k1_kernel_end

    s_load_dwordx8 s[4:11], s[0:1], 0
    s_load_dwordx2 s[12:13], s[0:1], 72
    s_load_dwordx2 s[52:53], s[0:1], 64

    v_cmp_gt_u32 vcc, 18, v0
    s_and_saveexec_b64 s[48:49], vcc
    s_cbranch_execz k1_kernel_ncp
    s_getpc_b64 s[46:47]
k1_kernel_pc:
    s_bfe_u32 s38, s2, 0x40003
    s_lshl_b32 s38, s38, 7
    v_lshl_add_u32 v2, v0, 11, s38
    v_min_u32 v2, k1_kernel_last-k1_kernel_pc, v2
    global_load_dword v250, v2, s[46:47]
k1_kernel_ncp:
    s_mov_b64 exec, s[48:49]

    v_lshrrev_b32 v1, 6, v0
    v_and_b32 v255, 63, v0
    s_bfe_u32 s36, s2, 0x10003
    v_readfirstlane_b32 s3, v1
    s_lshr_b32 s37, s2, 4
    s_lshl_b32 s37, s37, 3
    s_and_b32 s38, s2, 7
    s_or_b32 s37, s37, s38
    v_lshlrev_b32 v254, 4, v255
    v_mov_b32 v252, 144144
    v_mov_b32 v253, 1
    v_mov_b32 v40, 0
    v_lshl_add_u32 v41, v0, 2, v252
    v_cmp_gt_u32 vcc, 8, v0
    s_and_saveexec_b64 s[46:47], vcc
    ds_write_b32 v41, v40
    s_mov_b64 exec, s[46:47]
    v_mul_u32_u24 v6, 57, v255
    v_lshrrev_b32 v6, 9, v6
    v_mul_u32_u24 v5, 9, v6
    v_sub_u32 v5, v255, v5
    v_cmp_gt_u32 s[40:41], 8, v5
    s_lshl_b32 s38, s36, 7
    v_lshl_add_u32 v5, v5, 4, s38
    v_lshl_add_u32 v83, v6, 8, v5
    s_and_b32 s56, s3, 3
    s_bitset0_b32 s41, 31
    s_lshr_b32 s42, s2, 3
    s_mul_i32 s42, s42, 36
    s_lshr_b32 s42, s42, 5
    s_lshl_b32 s42, s42, 2
    s_add_u32 s42, s42, s56
    s_mov_b32 s43, s42
    s_mov_b32 s50, s36
    s_lshl_b32 s72, s37, 7
    s_lshl_b32 s73, s3, 5
    s_add_u32 s72, s72, s73
    s_mul_i32 s74, s72, 400
    s_mul_i32 s45, s36, 11200
    s_add_u32 s74, s74, s45
    s_lshl_b32 s38, s3, 10
    s_add_u32 m0, s38, 144384

    s_mov_b32 s18, 6553600
    s_mov_b32 s19, 0x00020000
    s_mov_b32 s22, 256000
    s_mov_b32 s23, 0x00020000
    s_mov_b32 s26, 20000
    s_mov_b32 s27, 0x00020000
    s_mov_b32 s30, 13107200
    s_mov_b32 s31, 0x00020000
    s_mov_b32 s34, 268435456
    s_mov_b32 s35, 0x00020000
    s_mov_b32 s14, 268435456
    s_mov_b32 s15, 0x00020000
    s_mov_b32 s54, 256
    s_mov_b32 s55, 0x00020000

    v_bfe_u32 v5, v255, 2, 2
    v_mul_u32_u24 v5, 200, v5
    v_and_b32 v6, 3, v255
    v_lshl_add_u32 v5, v6, 5, v5
    v_and_b32 v6, 32, v255
    v_lshl_add_u32 v5, v6, 2, v5
    v_and_b32 v6, 16, v255
    v_add_u32 v5, v5, v6
    s_movk_i32 s39, 19200
    s_cmp_ge_u32 s3, 4
    s_waitcnt lgkmcnt(0)
    s_barrier
    s_cbranch_scc1 k1_kernel_dma

    s_mov_b32 s24, s8
    s_and_b32 s25, s9, 0xffff
    buffer_load_dwordx4 v254, s[24:27], s38 offen lds
    s_add_u32 s38, s38, 4096
    s_add_u32 m0, s38, 144384
    s_mov_b32 s16, s4
    s_and_b32 s17, s5, 0xffff
    buffer_load_dwordx4 v254, s[24:27], s38 offen lds
    s_add_u32 s38, s38, 4096
    s_add_u32 m0, s38, 144384
    v_cmp_lt_u32 vcc, 24, v255
    buffer_load_dwordx4 v254, s[24:27], s38 offen lds
    s_add_u32 s38, s38, 4096
    s_add_u32 m0, s38, 144384
    v_subbrev_co_u32 v249, vcc, 0, v255, vcc
    buffer_load_dwordx4 v254, s[24:27], s38 offen lds
    s_add_u32 s38, s38, 4096
    s_min_u32 s38, s38, 18432
    s_add_u32 m0, s38, 144384
    v_min_u32 v249, 49, v249
    v_lshlrev_b32 v249, 4, v249
    buffer_load_dwordx4 v254, s[24:27], s38 offen lds
    buffer_load_dwordx4 v[232:235], v5, s[24:27], s39 offen
    buffer_load_dwordx4 v[240:243], v249, s[16:19], s74 offen offset:0
    buffer_load_dwordx4 v[244:247], v249, s[16:19], s74 offen offset:800

    s_mul_i32 s77, s36, -3200
    s_mul_i32 s78, s72, 400
    s_addk_i32 s77, 1600
    s_add_u32 s79, s78, 11200
    s_add_u32 s74, s74, s77

    s_branch k1_kernel_main
k1_kernel_dma:
    s_mov_b32 s20, s6
    s_and_b32 s21, s7, 0xffff
    s_mov_b64 exec, s[40:41]
k1_kernel_dml:

    s_min_u32 s38, s42, 142
    s_mul_i32 m0, s38, 1008
    s_mul_i32 s39, s38, 1792
    s_add_u32 s42, s42, 4
    buffer_load_dwordx4 v83, s[20:23], s39 offen lds
    s_cmp_ge_u32 s42, 144
    s_cselect_b32 s38, 144, 0
    s_sub_u32 s42, s42, s38
    s_cmp_lg_u32 s42, s43
    s_cbranch_scc1 k1_kernel_dml
    s_mov_b64 exec, -1

    s_mov_b32 s16, s4
    s_and_b32 s17, s5, 0xffff
    s_mov_b32 s20, s6
    s_and_b32 s21, s7, 0xffff
    s_mov_b32 s28, s10
    s_and_b32 s29, s11, 0xffff
    s_mov_b32 s32, s12
    s_and_b32 s33, s13, 0xffff
    s_and_b32 s13, s13, 0xffff
    s_and_b32 s53, s53, 0xffff
k1_kernel_aux:

    s_setprio 0
    v_mov_b32 v8, v255
    v_mov_b32 v9, v254
    v_mov_b32 v10, v253
    v_mov_b32 v11, v252
    s_mov_b32 s51, s2
    s_mov_b32 s64, 0
    s_mov_b32 s65, 0

k1_kernel_unit:

    s_bfe_u32 s36, s51, 0x10003

    s_lshr_b32 s38, s51, 4
    s_and_b32 s39, s51, 7
    s_sub_u32 s57, 2, s36
    s_lshl_b32 s57, s39, s57
    s_lshl_b32 s37, s36, 5
    s_add_u32 s57, s57, s37
    s_add_u32 s57, s57, s56
    s_mul_i32 s37, s38, 48
    s_add_u32 s37, s37, s57
    s_lshl_b32 s38, s38, 1
    s_lshr_b32 s39, s39, 2
    s_add_u32 s38, s38, s39
    s_add_u32 s38, s38, 768
    s_and_b32 s57, s57, 7
    s_cmp_eq_u32 s57, 2
    s_cselect_b32 s38, s38, 1000
    s_lshl_b32 s39, s36, 1
    s_and_b32 s39, s39, s56
    s_cselect_b32 s57, s38, s37

    s_lshr_b32 s37, s51, 4
    s_lshl_b32 s37, s37, 3
    s_and_b32 s38, s51, 7
    s_or_b32 s37, s37, s38
    s_and_b32 s58, s56, 1
    s_lshl_b32 s59, s37, 1
    s_add_u32 s58, s58, s59
    s_lshr_b32 s59, s56, 1
    s_lshl_b32 s60, s36, 1
    s_add_u32 s59, s59, s60
    s_mul_i32 s60, s58, 25600
    s_mul_i32 s61, s59, 96
    s_add_u32 s60, s60, s61
    s_movk_i32 s61, 400
    v_lshrrev_b32 v1, 3, v8
    v_and_b32 v2, 7, v8
    v_mul_u32_u24 v0, s61, v1
    v_cmp_gt_u32 s[48:49], 7, v2
    v_lshl_add_u32 v0, v2, 4, v0
    v_and_b32 v5, 15, v8
    v_and_b32 v6, 48, v8
    v_lshl_add_u32 v7, v5, 8, v6
    s_lshl_b32 s44, s56, 15
    s_xor_b32 s38, s50, 1
    s_lshl_b32 s38, s38, 7
    s_add_u32 s44, s44, s38

    s_mov_b64 exec, s[48:49]
    buffer_load_dwordx4 v[224:227], v0, s[16:19], s60 offen
    s_add_u32 s60, s60, 3200
    buffer_load_dwordx4 v[228:231], v0, s[16:19], s60 offen
    s_add_u32 s60, s60, 3200
    buffer_load_dwordx4 v[232:235], v0, s[16:19], s60 offen
    s_add_u32 s60, s60, 3200
    buffer_load_dwordx4 v[236:239], v0, s[16:19], s60 offen
    s_add_u32 s60, s60, 3200
    buffer_load_dwordx4 v[240:243], v0, s[16:19], s60 offen
    s_add_u32 s60, s60, 3200
    buffer_load_dwordx4 v[244:247], v0, s[16:19], s60 offen
    s_add_u32 s60, s60, 3200
    buffer_load_dwordx4 v[248:251], v0, s[16:19], s60 offen
    s_add_u32 s60, s60, 3200
    buffer_load_dwordx4 v[252:255], v0, s[16:19], s60 offen
    s_add_u32 s60, s60, 3200
    s_mov_b64 exec, -1

    s_lshr_b32 s78, s57, 5
    s_bfe_u32 s79, s57, 0x20003
    s_bfe_u32 s80, s57, 0x20001
    s_and_b32 s81, s57, 1
    s_lshl_b32 s77, s78, 2
    s_lshl_b32 s83, s81, 1
    s_add_u32 s77, s77, s83
    s_lshl_b32 s77, s77, 7
    s_lshl_b32 s83, s79, 5
    s_add_u32 s77, s77, s83
    s_lshl_b32 s83, s80, 3
    s_add_u32 s77, s77, s83
    s_lshl_b32 s77, s77, 10
    s_lshl_b32 s82, s78, 12
    s_lshl_b32 s83, s79, 10
    s_add_u32 s82, s82, s83
    s_lshl_b32 s83, s80, 8
    s_add_u32 s82, s82, s83
    s_lshl_b32 s83, s81, 7
    s_add_u32 s82, s82, s83
    s_mov_b32 s84, 205312
    v_lshrrev_b32 v3, 2, v8
    v_and_b32 v4, 3, v8
    v_mul_lo_u32 v14, v3, s84
    v_lshl_add_u32 v14, v4, 4, v14
    s_lshl_b32 s61, s56, 12
    s_add_u32 s61, s61, 147456
    v_and_b32 v3, 3, v3
    v_lshlrev_b32 v36, 6, v8
    v_lshl_add_u32 v36, v3, 4, v36
    v_add_u32 v36, s61, v36
    v_xor_b32 v37, 16, v36
    v_xor_b32 v38, 32, v36
    v_xor_b32 v39, 48, v36
    v_and_b32 v3, 48, v8
    v_xor_b32 v15, v3, v9
    v_add_u32 v15, s61, v15
    s_mov_b32 s84, 0x05040100
    s_mov_b32 s85, 0x07060302
    s_cmp_eq_u32 s64, 0
    s_cbranch_scc1 k1_kernel_nsig0
    s_waitcnt vmcnt(0)

k1_kernel_nsig0:

    s_waitcnt vmcnt(8)
    s_cmp_lg_u32 s64, 0
    s_cbranch_scc1 k1_kernel_nsig

    s_mov_b64 exec, 1
    ds_add_u32 v11, v10 offset:16
    s_mov_b64 exec, -1

k1_kernel_nsig:
    s_setprio 3

    s_lshl_b32 s61, s56, 12
    s_add_u32 s61, s61, 147456
    v_lshlrev_b32 v86, 2, v8
    v_add_u32 v86, s61, v86
    v_and_b32 v85, 0xffffff80, v86
    v_and_b32 v123, 32, v8
    s_add_u32 s61, s61, 256
    v_mul_u32_u24 v31, 56, v8
    v_add_u32 v31, s61, v31
    v_mul_u32_u24 v34, 56, v1
    v_lshl_add_u32 v34, v2, 3, v34
    v_add_u32 v34, s61, v34
    v_add_u32 v2, s59, v2
    v_subrev_u32 v3, 5, v2
    v_min_u32 v2, v2, v3
    v_mov_b32 v13, 0
    v_mul_u32_u24 v2, 0x10001, v2
    v_lshlrev_b32 v2, 12, v2
    v_add_u32 v32, 67108864, v2
    v_add_u32 v33, 201328640, v2
    v_mov_b32 v71, 0xf00
    s_lshr_b32 s62, s58, 7
    s_mul_i32 s62, s62, 25
    s_mul_i32 s63, s59, 6
    s_add_u32 s62, s62, s63
    s_lshl_b32 s62, s62, 3
    s_bfe_u32 s63, s58, 0x30004
    s_add_u32 s62, s62, s63
    s_lshl_b32 s62, s62, 13
    s_bfe_u32 s63, s58, 0x30001
    s_lshl_b32 s63, s63, 10
    s_add_u32 s62, s62, s63
    s_and_b32 s63, s58, 1
    s_lshl_b32 s63, s63, 9
    s_add_u32 s62, s62, s63
    s_add_u32 s62, s62, 16777216
    v_and_b32 v30, 31, v8
    v_lshrrev_b32 v3, 5, v8
    v_lshlrev_b32 v30, 4, v30
    v_lshl_add_u32 v30, v3, 3, v30
    s_cmp_eq_u32 s59, 3
    s_cselect_b32 s63, -16, 0x0ffffff0
    s_movk_i32 s66, 0x7c
    s_mov_b32 s67, 0x001f001f
    s_mov_b32 s75, 0x06040200
    v_mov_b32 v54, 0x08040201
    v_mov_b32 v55, 0x80402010

    s_lshl_b32 s72, s2, 15
    s_lshl_b32 s73, s56, 13
    s_add_u32 s72, s72, s73
    s_add_u32 s72, s72, 20971520
    s_lshl_b32 s73, s36, 9
    s_lshl2_add_u32 s73, s37, s73
    s_add_u32 s73, s73, s56
    s_lshl_b32 s73, s73, 7
    s_add_u32 s73, s73, 29360128

k1_kernel_wf3:

    ds_read_b32 v12, v11 offset:12
    s_waitcnt lgkmcnt(0)
    v_readfirstlane_b32 s45, v12
    s_cmp_lt_u32 s45, 4
    s_cbranch_scc1 k1_kernel_wf3

    s_mov_b64 exec, s[48:49]

    s_waitcnt vmcnt(7)
    v_lshl_or_b32 v224, v225, 16, v224
    v_lshl_or_b32 v225, v227, 16, v226
    v_add_u32 v224, v32, v224
    v_add_u32 v225, v33, v225
    ds_write_b64 v34, v[224:225] offset:0

    s_waitcnt vmcnt(6)
    v_lshl_or_b32 v228, v229, 16, v228
    v_lshl_or_b32 v229, v231, 16, v230
    v_add_u32 v228, v32, v228
    v_add_u32 v229, v33, v229
    ds_write_b64 v34, v[228:229] offset:448

    s_waitcnt vmcnt(5)
    v_lshl_or_b32 v232, v233, 16, v232
    v_lshl_or_b32 v233, v235, 16, v234
    v_add_u32 v232, v32, v232
    v_add_u32 v233, v33, v233
    ds_write_b64 v34, v[232:233] offset:896

    s_waitcnt vmcnt(4)
    v_lshl_or_b32 v236, v237, 16, v236
    v_lshl_or_b32 v237, v239, 16, v238
    v_add_u32 v236, v32, v236
    v_add_u32 v237, v33, v237
    ds_write_b64 v34, v[236:237] offset:1344

    s_waitcnt vmcnt(3)
    v_lshl_or_b32 v240, v241, 16, v240
    v_lshl_or_b32 v241, v243, 16, v242
    v_add_u32 v240, v32, v240
    v_add_u32 v241, v33, v241
    ds_write_b64 v34, v[240:241] offset:1792

    s_waitcnt vmcnt(2)
    v_lshl_or_b32 v244, v245, 16, v244
    v_lshl_or_b32 v245, v247, 16, v246
    v_add_u32 v244, v32, v244
    v_add_u32 v245, v33, v245
    ds_write_b64 v34, v[244:245] offset:2240

    s_waitcnt vmcnt(1)
    v_lshl_or_b32 v248, v249, 16, v248
    v_lshl_or_b32 v249, v251, 16, v250
    v_add_u32 v248, v32, v248
    v_add_u32 v249, v33, v249
    ds_write_b64 v34, v[248:249] offset:2688

    s_waitcnt vmcnt(0)
    v_lshl_or_b32 v252, v253, 16, v252
    v_lshl_or_b32 v253, v255, 16, v254
    v_add_u32 v252, v32, v252
    v_add_u32 v253, v33, v253
    ds_write_b64 v34, v[252:253] offset:3136

    s_mov_b64 exec, -1
    ds_read_b64 v[40:41], v31 offset:0
    ds_read_b64 v[42:43], v31 offset:8
    ds_read_b64 v[44:45], v31 offset:16
    ds_read_b64 v[46:47], v31 offset:24
    ds_read_b64 v[48:49], v31 offset:32
    ds_read_b64 v[50:51], v31 offset:40
    ds_read_b64 v[52:53], v31 offset:48

    s_waitcnt lgkmcnt(6)
    v_perm_b32 v72, v41, v40, s75
    v_lshrrev_b32 v73, 3, v72
    v_lshlrev_b32 v64, 2, v72
    v_and_b32 v72, 0x07070707, v72
    v_and_b32 v0, 0x03030303, v73
    v_perm_b32 v16, v55, v54, v72
    v_xor_b32 v23, v55, v16

    s_waitcnt lgkmcnt(5)
    v_perm_b32 v72, v43, v42, s75
    v_lshrrev_b32 v73, 3, v72
    v_lshlrev_b32 v65, 2, v72
    v_and_b32 v72, 0x07070707, v72
    v_and_b32 v1, 0x03030303, v73
    v_perm_b32 v17, v55, v54, v72
    v_xor_b32 v24, v55, v17

    s_waitcnt lgkmcnt(4)
    v_perm_b32 v72, v45, v44, s75
    v_lshrrev_b32 v73, 3, v72
    v_lshlrev_b32 v66, 2, v72
    v_and_b32 v72, 0x07070707, v72
    v_and_b32 v2, 0x03030303, v73
    v_perm_b32 v18, v55, v54, v72
    v_xor_b32 v25, v55, v18

    s_waitcnt lgkmcnt(3)
    v_perm_b32 v72, v47, v46, s75
    v_lshrrev_b32 v73, 3, v72
    v_lshlrev_b32 v67, 2, v72
    v_and_b32 v72, 0x07070707, v72
    v_and_b32 v3, 0x03030303, v73
    v_perm_b32 v19, v55, v54, v72
    v_xor_b32 v26, v55, v19

    s_waitcnt lgkmcnt(2)
    v_perm_b32 v72, v49, v48, s75
    v_lshrrev_b32 v73, 3, v72
    v_lshlrev_b32 v68, 2, v72
    v_and_b32 v72, 0x07070707, v72
    v_and_b32 v4, 0x03030303, v73
    v_perm_b32 v20, v55, v54, v72
    v_xor_b32 v27, v55, v20

    s_waitcnt lgkmcnt(1)
    v_perm_b32 v72, v51, v50, s75
    v_lshrrev_b32 v73, 3, v72
    v_lshlrev_b32 v69, 2, v72
    v_and_b32 v72, 0x07070707, v72
    v_and_b32 v5, 0x03030303, v73
    v_perm_b32 v21, v55, v54, v72
    v_xor_b32 v28, v55, v21

    s_waitcnt lgkmcnt(0)
    v_perm_b32 v72, v53, v52, s75
    v_lshrrev_b32 v73, 3, v72
    v_lshlrev_b32 v70, 2, v72
    v_and_b32 v72, 0x07070707, v72
    v_and_b32 v6, 0x03030303, v73
    v_perm_b32 v22, v55, v54, v72
    v_xor_b32 v29, v55, v22

    ds_write_b32 v86, v13
    v_mov_b32 v71, s63
    v_subrev_u32 v74, 8, v31
    s_setprio 0
    v_ffbl_b32 v84, v71

    v_perm_b32 v72, v64, v64, v84
    v_and_or_b32 v72, v72, s66, v85
    ds_add_rtn_u32 v87, v72, v10
    ds_wrxchg_rtn_b32 v116, v86, v13

    s_waitcnt lgkmcnt(0)
    v_cmp_gt_u32 s[68:69], 2, v116

    v_cmpx_lt_u32 vcc, 1, v87
    s_nop 0
    v_lshrrev_b64 v[76:77], v123, s[68:69]
    v_perm_b32 v121, v76, v76, v1
    v_perm_b32 v122, v76, v76, v0
    v_and_b32 v121, v121, v17
    v_and_b32 v122, v122, v16
    v_msad_u8 v120, v24, v121, 0
    v_lshlrev_b32 v120, 4, v120
    v_msad_u8 v120, v23, v122, v120
    v_and_b32 v120, v120, v71

    v_ffbl_b32 v120, v120
    v_max_i32 v84, v120, v84
    s_mov_b64 exec, -1

    v_lshl_add_u32 v73, v84, 1, v74
    v_lshl_add_u32 v71, -1, v84, v71
    ds_read_u16 v80, v73 offset:0
    v_ffbl_b32 v84, v71

    v_perm_b32 v72, v64, v64, v84
    v_and_or_b32 v72, v72, s66, v85
    ds_add_rtn_u32 v87, v72, v10
    ds_wrxchg_rtn_b32 v116, v86, v13

    s_lshl_b32 s45, s2, 8
    s_add_u32 s45, s45, 14680064
    s_mov_b64 exec, 3
    buffer_store_dword v13, v9, s[12:15], s45 offen sc1
    s_mov_b64 exec, -1
    buffer_load_dwordx4 v[128:131], v9, s[28:31], s77 offen offset:0

    s_waitcnt lgkmcnt(0)
    v_cmp_gt_u32 s[68:69], 2, v116

    v_cmpx_lt_u32 vcc, 1, v87
    s_nop 0
    v_lshrrev_b64 v[76:77], v123, s[68:69]
    v_perm_b32 v121, v76, v76, v1
    v_perm_b32 v122, v76, v76, v0
    v_and_b32 v121, v121, v17
    v_and_b32 v122, v122, v16
    v_msad_u8 v120, v24, v121, 0
    v_lshlrev_b32 v120, 4, v120
    v_msad_u8 v120, v23, v122, v120
    v_and_b32 v120, v120, v71

    v_ffbl_b32 v120, v120
    v_max_i32 v84, v120, v84
    s_mov_b64 exec, -1

    v_lshl_add_u32 v73, v84, 1, v74
    v_lshl_add_u32 v71, -1, v84, v71
    ds_read_u16 v81, v73 offset:0
    v_ffbl_b32 v84, v71

    v_perm_b32 v72, v64, v64, v84
    v_and_or_b32 v72, v72, s66, v85
    ds_add_rtn_u32 v87, v72, v10
    ds_wrxchg_rtn_b32 v116, v86, v13

    buffer_load_dwordx4 v[132:135], v9, s[28:31], s77 offen offset:1024

    s_waitcnt lgkmcnt(0)
    v_cmp_gt_u32 s[68:69], 2, v116

    v_cmpx_lt_u32 vcc, 1, v87
    s_nop 0
    v_lshrrev_b64 v[76:77], v123, s[68:69]
    v_perm_b32 v121, v76, v76, v1
    v_perm_b32 v122, v76, v76, v0
    v_and_b32 v121, v121, v17
    v_and_b32 v122, v122, v16
    v_msad_u8 v120, v24, v121, 0
    v_lshlrev_b32 v120, 4, v120
    v_msad_u8 v120, v23, v122, v120
    v_and_b32 v120, v120, v71

    v_ffbl_b32 v120, v120
    v_max_i32 v84, v120, v84
    s_mov_b64 exec, -1

    v_lshl_add_u32 v73, v84, 1, v74
    v_lshl_add_u32 v71, -1, v84, v71
    ds_read_u16 v82, v73 offset:0
    v_ffbl_b32 v84, v71

    v_perm_b32 v72, v64, v64, v84
    v_and_or_b32 v72, v72, s66, v85
    ds_add_rtn_u32 v87, v72, v10
    ds_wrxchg_rtn_b32 v116, v86, v13

    buffer_load_dwordx4 v[144:147], v9, s[28:31], s77 offen offset:2048

    s_waitcnt lgkmcnt(0)
    v_cmp_gt_u32 s[68:69], 2, v116

    v_cmpx_lt_u32 vcc, 1, v87
    s_nop 0
    v_lshrrev_b64 v[76:77], v123, s[68:69]
    v_perm_b32 v121, v76, v76, v1
    v_and_b32 v121, v121, v17
    v_msad_u8 v120, v24, v121, 0
    v_lshlrev_b32 v120, 4, v120
    v_and_b32 v120, v120, v71

    v_ffbl_b32 v120, v120
    v_max_i32 v84, v120, v84
    s_mov_b64 exec, -1

    v_lshl_add_u32 v73, v84, 1, v74
    v_lshl_add_u32 v71, -1, v84, v71
    ds_read_u16 v83, v73 offset:0
    v_lshrrev_b32 v71, 4, v71
    v_ffbl_b32 v84, v71

    v_perm_b32 v72, v65, v64, v84
    v_and_or_b32 v72, v72, s66, v85
    ds_add_rtn_u32 v87, v72, v10
    ds_wrxchg_rtn_b32 v116, v86, v13

    buffer_load_dwordx4 v[148:151], v9, s[28:31], s77 offen offset:3072
    s_add_u32 s77, s77, 4096
    s_mov_b32 s70, 0x7fff7fff

    s_waitcnt lgkmcnt(0)
    v_cmp_gt_u32 s[68:69], 2, v116

    v_lshl_or_b32 v78, v81, 16, v80
    v_lshl_or_b32 v79, v83, 16, v82
    buffer_store_dwordx2 v[78:79], v30, s[32:35], s62 offen sc1
    s_add_u32 s62, s62, 65536
    v_cmpx_lt_u32 vcc, 1, v87
    v_bfe_i32 v119, s70, v71, 1
    v_lshrrev_b64 v[76:77], v123, s[68:69]
    v_perm_b32 v121, v76, v76, v2
    v_perm_b32 v122, v76, v76, v1
    v_and_b32 v121, v121, v18
    v_and_b32 v122, v122, v17
    v_msad_u8 v120, v25, v121, 0
    v_lshlrev_b32 v120, 4, v120
    v_msad_u8 v120, v24, v122, v120
    v_bitop3_b32 v120, v120, v71, v119 bitop3:0x80

    v_ffbl_b32 v120, v120
    v_max_i32 v84, v120, v84
    s_mov_b64 exec, -1

    v_lshl_add_u32 v73, v84, 1, v74
    v_lshl_add_u32 v71, -1, v84, v71
    ds_read_u16 v80, v73 offset:8
    v_ffbl_b32 v84, v71

    v_perm_b32 v72, v65, v64, v84
    v_and_or_b32 v72, v72, s66, v85
    ds_add_rtn_u32 v87, v72, v10
    ds_wrxchg_rtn_b32 v116, v86, v13

    buffer_load_dwordx4 v[160:163], v9, s[28:31], s77 offen offset:0
    s_mov_b32 s70, 0x977f977f

    s_waitcnt lgkmcnt(0)
    v_cmp_gt_u32 s[68:69], 2, v116

    v_cmpx_lt_u32 vcc, 1, v87
    v_bfe_i32 v119, s70, v71, 1
    v_lshrrev_b64 v[76:77], v123, s[68:69]
    v_perm_b32 v121, v76, v76, v2
    v_perm_b32 v122, v76, v76, v1
    v_and_b32 v121, v121, v18
    v_and_b32 v122, v122, v17
    v_msad_u8 v120, v25, v121, 0
    v_lshlrev_b32 v120, 4, v120
    v_msad_u8 v120, v24, v122, v120
    v_bitop3_b32 v120, v120, v71, v119 bitop3:0x80

    v_ffbl_b32 v120, v120
    v_max_i32 v84, v120, v84
    s_mov_b64 exec, -1

    v_lshl_add_u32 v73, v84, 1, v74
    v_lshl_add_u32 v71, -1, v84, v71
    ds_read_u16 v81, v73 offset:8
    v_ffbl_b32 v84, v71

    v_perm_b32 v72, v65, v64, v84
    v_and_or_b32 v72, v72, s66, v85
    ds_add_rtn_u32 v87, v72, v10
    ds_wrxchg_rtn_b32 v116, v86, v13

    buffer_load_dwordx4 v[164:167], v9, s[28:31], s77 offen offset:1024
    s_mov_b32 s70, 0xe997e997

    s_waitcnt lgkmcnt(0)
    v_cmp_gt_u32 s[68:69], 2, v116

    v_cmpx_lt_u32 vcc, 1, v87
    v_bfe_i32 v119, s70, v71, 1
    v_lshrrev_b64 v[76:77], v123, s[68:69]
    v_perm_b32 v121, v76, v76, v2
    v_perm_b32 v122, v76, v76, v1
    v_and_b32 v121, v121, v18
    v_and_b32 v122, v122, v17
    v_msad_u8 v120, v25, v121, 0
    v_lshlrev_b32 v120, 4, v120
    v_msad_u8 v120, v24, v122, v120
    v_bitop3_b32 v120, v120, v71, v119 bitop3:0x80

    v_ffbl_b32 v120, v120
    v_max_i32 v84, v120, v84
    s_mov_b64 exec, -1

    v_lshl_add_u32 v73, v84, 1, v74
    v_lshl_add_u32 v71, -1, v84, v71
    ds_read_u16 v82, v73 offset:8
    v_ffbl_b32 v84, v71

    v_perm_b32 v72, v65, v64, v84
    v_and_or_b32 v72, v72, s66, v85
    ds_add_rtn_u32 v87, v72, v10
    ds_wrxchg_rtn_b32 v116, v86, v13

    buffer_load_dwordx4 v[176:179], v9, s[28:31], s77 offen offset:2048
    s_add_u32 s47, s44, 12288
    buffer_load_dwordx4 v[56:59], v7, s[20:23], s47 offen offset:0
    buffer_load_dwordx4 v[60:63], v7, s[20:23], s47 offen offset:64
    s_mov_b32 s70, 0xfee9fee9

    s_waitcnt lgkmcnt(0)
    v_cmp_gt_u32 s[68:69], 2, v116

    v_cmpx_lt_u32 vcc, 1, v87
    v_bfe_i32 v119, s70, v71, 1
    v_lshrrev_b64 v[76:77], v123, s[68:69]
    v_perm_b32 v121, v76, v76, v2
    v_and_b32 v121, v121, v18
    v_msad_u8 v120, v25, v121, 0
    v_lshlrev_b32 v120, 4, v120
    v_bitop3_b32 v120, v120, v71, v119 bitop3:0x80

    v_ffbl_b32 v120, v120
    v_max_i32 v84, v120, v84
    s_mov_b64 exec, -1

    v_lshl_add_u32 v73, v84, 1, v74
    v_lshl_add_u32 v71, -1, v84, v71
    ds_read_u16 v83, v73 offset:8
    v_lshrrev_b32 v71, 4, v71
    v_ffbl_b32 v84, v71

    v_perm_b32 v72, v66, v65, v84
    v_and_or_b32 v72, v72, s66, v85
    ds_add_rtn_u32 v87, v72, v10
    ds_wrxchg_rtn_b32 v116, v86, v13

    buffer_load_dwordx4 v[180:183], v9, s[28:31], s77 offen offset:3072
    s_add_u32 s77, s77, 126976
    s_cmp_lg_u32 s64, 0
    s_cbranch_scc1 k1_kernel_nc8
    v_mov_b32 v121, -1
    v_lshlrev_b32 v122, 1, v8
    buffer_store_short v121, v122, s[12:15], s73 offen sc1
k1_kernel_nc8:
    s_add_u32 s47, s44, 16384
    buffer_load_dwordx4 v[88:91], v7, s[20:23], s47 offen offset:0
    buffer_load_dwordx4 v[92:95], v7, s[20:23], s47 offen offset:64
    s_mov_b32 s70, 0x7fff7fff

    s_waitcnt lgkmcnt(0)
    v_cmp_gt_u32 s[68:69], 2, v116

    v_lshl_or_b32 v78, v81, 16, v80
    v_lshl_or_b32 v79, v83, 16, v82
    buffer_store_dwordx2 v[78:79], v30, s[32:35], s62 offen sc1
    s_add_u32 s62, s62, 65536
    v_cmpx_lt_u32 vcc, 1, v87
    v_bfe_i32 v119, s70, v71, 1
    v_lshrrev_b64 v[76:77], v123, s[68:69]
    v_perm_b32 v121, v76, v76, v3
    v_perm_b32 v122, v76, v76, v2
    v_and_b32 v121, v121, v19
    v_and_b32 v122, v122, v18
    v_msad_u8 v120, v26, v121, 0
    v_lshlrev_b32 v120, 4, v120
    v_msad_u8 v120, v25, v122, v120
    v_bitop3_b32 v120, v120, v71, v119 bitop3:0x80

    v_ffbl_b32 v120, v120
    v_max_i32 v84, v120, v84
    s_mov_b64 exec, -1

    v_lshl_add_u32 v73, v84, 1, v74
    v_lshl_add_u32 v71, -1, v84, v71
    ds_read_u16 v80, v73 offset:16
    v_ffbl_b32 v84, v71

    v_perm_b32 v72, v66, v65, v84
    v_and_or_b32 v72, v72, s66, v85
    ds_add_rtn_u32 v87, v72, v10
    ds_wrxchg_rtn_b32 v116, v86, v13

    buffer_load_dwordx4 v[192:195], v9, s[28:31], s77 offen offset:0
    s_add_u32 s47, s44, 20480
    buffer_load_dwordx4 v[96:99], v7, s[20:23], s47 offen offset:0
    buffer_load_dwordx4 v[100:103], v7, s[20:23], s47 offen offset:64
    s_mov_b32 s70, 0x977f977f

    s_waitcnt lgkmcnt(0)
    v_cmp_gt_u32 s[68:69], 2, v116

    v_cmpx_lt_u32 vcc, 1, v87
    v_bfe_i32 v119, s70, v71, 1
    v_lshrrev_b64 v[76:77], v123, s[68:69]
    v_perm_b32 v121, v76, v76, v3
    v_perm_b32 v122, v76, v76, v2
    v_and_b32 v121, v121, v19
    v_and_b32 v122, v122, v18
    v_msad_u8 v120, v26, v121, 0
    v_lshlrev_b32 v120, 4, v120
    v_msad_u8 v120, v25, v122, v120
    v_bitop3_b32 v120, v120, v71, v119 bitop3:0x80

    v_ffbl_b32 v120, v120
    v_max_i32 v84, v120, v84
    s_mov_b64 exec, -1

    v_lshl_add_u32 v73, v84, 1, v74
    v_lshl_add_u32 v71, -1, v84, v71
    ds_read_u16 v81, v73 offset:16
    v_ffbl_b32 v84, v71

    v_perm_b32 v72, v66, v65, v84
    v_and_or_b32 v72, v72, s66, v85
    ds_add_rtn_u32 v87, v72, v10
    ds_wrxchg_rtn_b32 v116, v86, v13

    buffer_load_dwordx4 v[196:199], v9, s[28:31], s77 offen offset:1024
    s_add_u32 s47, s44, 24576
    buffer_load_dwordx4 v[104:107], v7, s[20:23], s47 offen offset:0
    buffer_load_dwordx4 v[108:111], v7, s[20:23], s47 offen offset:64
    s_mov_b32 s70, 0xe997e997

    s_waitcnt lgkmcnt(0)
    v_cmp_gt_u32 s[68:69], 2, v116

    v_cmpx_lt_u32 vcc, 1, v87
    v_bfe_i32 v119, s70, v71, 1
    v_lshrrev_b64 v[76:77], v123, s[68:69]
    v_perm_b32 v121, v76, v76, v3
    v_perm_b32 v122, v76, v76, v2
    v_and_b32 v121, v121, v19
    v_and_b32 v122, v122, v18
    v_msad_u8 v120, v26, v121, 0
    v_lshlrev_b32 v120, 4, v120
    v_msad_u8 v120, v25, v122, v120
    v_bitop3_b32 v120, v120, v71, v119 bitop3:0x80

    v_ffbl_b32 v120, v120
    v_max_i32 v84, v120, v84
    s_mov_b64 exec, -1

    v_lshl_add_u32 v73, v84, 1, v74
    v_lshl_add_u32 v71, -1, v84, v71
    ds_read_u16 v82, v73 offset:16
    v_ffbl_b32 v84, v71

    v_perm_b32 v72, v66, v65, v84
    v_and_or_b32 v72, v72, s66, v85
    ds_add_rtn_u32 v87, v72, v10
    ds_wrxchg_rtn_b32 v116, v86, v13

    buffer_load_dwordx4 v[208:211], v9, s[28:31], s77 offen offset:2048
    s_add_u32 s47, s44, 28672
    buffer_load_dwordx4 v[112:115], v7, s[20:23], s47 offen offset:0
    buffer_load_dwordx4 v[124:127], v7, s[20:23], s47 offen offset:64
    s_mov_b32 s70, 0xfee9fee9

    s_waitcnt lgkmcnt(0)
    v_cmp_gt_u32 s[68:69], 2, v116

    v_cmpx_lt_u32 vcc, 1, v87
    v_bfe_i32 v119, s70, v71, 1
    v_lshrrev_b64 v[76:77], v123, s[68:69]
    v_perm_b32 v121, v76, v76, v3
    v_and_b32 v121, v121, v19
    v_msad_u8 v120, v26, v121, 0
    v_lshlrev_b32 v120, 4, v120
    v_bitop3_b32 v120, v120, v71, v119 bitop3:0x80

    v_ffbl_b32 v120, v120
    v_max_i32 v84, v120, v84
    s_mov_b64 exec, -1

    v_lshl_add_u32 v73, v84, 1, v74
    v_lshl_add_u32 v71, -1, v84, v71
    ds_read_u16 v83, v73 offset:16
    v_lshrrev_b32 v71, 4, v71
    v_ffbl_b32 v84, v71

    v_perm_b32 v72, v67, v66, v84
    v_and_or_b32 v72, v72, s66, v85
    ds_add_rtn_u32 v87, v72, v10
    ds_wrxchg_rtn_b32 v116, v86, v13

    buffer_load_dwordx4 v[212:215], v9, s[28:31], s77 offen offset:3072
    s_add_u32 s77, s77, 4096
    s_add_u32 s47, s44, 131072
    buffer_load_dwordx4 v[136:139], v7, s[20:23], s47 offen offset:0
    buffer_load_dwordx4 v[140:143], v7, s[20:23], s47 offen offset:64
    s_mov_b32 s70, 0x7fff7fff

    s_waitcnt lgkmcnt(0)
    v_cmp_gt_u32 s[68:69], 2, v116

    v_lshl_or_b32 v78, v81, 16, v80
    v_lshl_or_b32 v79, v83, 16, v82
    buffer_store_dwordx2 v[78:79], v30, s[32:35], s62 offen sc1
    s_add_u32 s62, s62, 65536
    v_cmpx_lt_u32 vcc, 1, v87
    v_bfe_i32 v119, s70, v71, 1
    v_lshrrev_b64 v[76:77], v123, s[68:69]
    v_perm_b32 v121, v76, v76, v4
    v_perm_b32 v122, v76, v76, v3
    v_and_b32 v121, v121, v20
    v_and_b32 v122, v122, v19
    v_msad_u8 v120, v27, v121, 0
    v_lshlrev_b32 v120, 4, v120
    v_msad_u8 v120, v26, v122, v120
    v_bitop3_b32 v120, v120, v71, v119 bitop3:0x80

    v_ffbl_b32 v120, v120
    v_max_i32 v84, v120, v84
    s_mov_b64 exec, -1

    v_lshl_add_u32 v73, v84, 1, v74
    v_lshl_add_u32 v71, -1, v84, v71
    ds_read_u16 v80, v73 offset:24
    v_ffbl_b32 v84, v71

    v_perm_b32 v72, v67, v66, v84
    v_and_or_b32 v72, v72, s66, v85
    ds_add_rtn_u32 v87, v72, v10
    ds_wrxchg_rtn_b32 v116, v86, v13

    buffer_load_dwordx4 v[224:227], v9, s[28:31], s77 offen offset:0
    s_add_u32 s47, s44, 135168
    buffer_load_dwordx4 v[152:155], v7, s[20:23], s47 offen offset:0
    buffer_load_dwordx4 v[156:159], v7, s[20:23], s47 offen offset:64
    s_mov_b32 s70, 0x977f977f

    s_waitcnt lgkmcnt(0)
    v_cmp_gt_u32 s[68:69], 2, v116

    v_cmpx_lt_u32 vcc, 1, v87
    v_bfe_i32 v119, s70, v71, 1
    v_lshrrev_b64 v[76:77], v123, s[68:69]
    v_perm_b32 v121, v76, v76, v4
    v_perm_b32 v122, v76, v76, v3
    v_and_b32 v121, v121, v20
    v_and_b32 v122, v122, v19
    v_msad_u8 v120, v27, v121, 0
    v_lshlrev_b32 v120, 4, v120
    v_msad_u8 v120, v26, v122, v120
    v_bitop3_b32 v120, v120, v71, v119 bitop3:0x80

    v_ffbl_b32 v120, v120
    v_max_i32 v84, v120, v84
    s_mov_b64 exec, -1

    v_lshl_add_u32 v73, v84, 1, v74
    v_lshl_add_u32 v71, -1, v84, v71
    ds_read_u16 v81, v73 offset:24
    v_ffbl_b32 v84, v71

    v_perm_b32 v72, v67, v66, v84
    v_and_or_b32 v72, v72, s66, v85
    ds_add_rtn_u32 v87, v72, v10
    ds_wrxchg_rtn_b32 v116, v86, v13

    buffer_load_dwordx4 v[228:231], v9, s[28:31], s77 offen offset:1024
    s_add_u32 s47, s44, 139264
    buffer_load_dwordx4 v[168:171], v7, s[20:23], s47 offen offset:0
    buffer_load_dwordx4 v[172:175], v7, s[20:23], s47 offen offset:64
    s_mov_b32 s70, 0xe997e997

    s_waitcnt lgkmcnt(0)
    v_cmp_gt_u32 s[68:69], 2, v116

    v_cmpx_lt_u32 vcc, 1, v87
    v_bfe_i32 v119, s70, v71, 1
    v_lshrrev_b64 v[76:77], v123, s[68:69]
    v_perm_b32 v121, v76, v76, v4
    v_perm_b32 v122, v76, v76, v3
    v_and_b32 v121, v121, v20
    v_and_b32 v122, v122, v19
    v_msad_u8 v120, v27, v121, 0
    v_lshlrev_b32 v120, 4, v120
    v_msad_u8 v120, v26, v122, v120
    v_bitop3_b32 v120, v120, v71, v119 bitop3:0x80

    v_ffbl_b32 v120, v120
    v_max_i32 v84, v120, v84
    s_mov_b64 exec, -1

    v_lshl_add_u32 v73, v84, 1, v74
    v_lshl_add_u32 v71, -1, v84, v71
    ds_read_u16 v82, v73 offset:24
    v_ffbl_b32 v84, v71

    v_perm_b32 v72, v67, v66, v84
    v_and_or_b32 v72, v72, s66, v85
    ds_add_rtn_u32 v87, v72, v10
    ds_wrxchg_rtn_b32 v116, v86, v13

    buffer_load_dwordx4 v[240:243], v9, s[28:31], s77 offen offset:2048
    s_add_u32 s47, s44, 143360
    buffer_load_dwordx4 v[184:187], v7, s[20:23], s47 offen offset:0
    buffer_load_dwordx4 v[188:191], v7, s[20:23], s47 offen offset:64
    s_mov_b32 s70, 0xfee9fee9

    s_waitcnt lgkmcnt(0)
    v_cmp_gt_u32 s[68:69], 2, v116

    v_cmpx_lt_u32 vcc, 1, v87
    v_bfe_i32 v119, s70, v71, 1
    v_lshrrev_b64 v[76:77], v123, s[68:69]
    v_perm_b32 v121, v76, v76, v4
    v_and_b32 v121, v121, v20
    v_msad_u8 v120, v27, v121, 0
    v_lshlrev_b32 v120, 4, v120
    v_bitop3_b32 v120, v120, v71, v119 bitop3:0x80

    v_ffbl_b32 v120, v120
    v_max_i32 v84, v120, v84
    s_mov_b64 exec, -1

    v_lshl_add_u32 v73, v84, 1, v74
    v_lshl_add_u32 v71, -1, v84, v71
    ds_read_u16 v83, v73 offset:24
    v_lshrrev_b32 v71, 4, v71
    v_ffbl_b32 v84, v71

    v_perm_b32 v72, v68, v67, v84
    v_and_or_b32 v72, v72, s66, v85
    ds_add_rtn_u32 v87, v72, v10
    ds_wrxchg_rtn_b32 v116, v86, v13

    buffer_load_dwordx4 v[244:247], v9, s[28:31], s77 offen offset:3072
    s_add_u32 s47, s44, 147456
    buffer_load_dwordx4 v[200:203], v7, s[20:23], s47 offen offset:0
    buffer_load_dwordx4 v[204:207], v7, s[20:23], s47 offen offset:64
    s_mov_b32 s70, 0x7fff7fff

    s_waitcnt lgkmcnt(0)
    v_cmp_gt_u32 s[68:69], 2, v116

    v_lshl_or_b32 v78, v81, 16, v80
    v_lshl_or_b32 v79, v83, 16, v82
    buffer_store_dwordx2 v[78:79], v30, s[32:35], s62 offen sc1
    s_add_u32 s62, s62, 65536
    v_cmpx_lt_u32 vcc, 1, v87
    v_bfe_i32 v119, s70, v71, 1
    v_lshrrev_b64 v[76:77], v123, s[68:69]
    v_perm_b32 v121, v76, v76, v5
    v_perm_b32 v122, v76, v76, v4
    v_and_b32 v121, v121, v21
    v_and_b32 v122, v122, v20
    v_msad_u8 v120, v28, v121, 0
    v_lshlrev_b32 v120, 4, v120
    v_msad_u8 v120, v27, v122, v120
    v_bitop3_b32 v120, v120, v71, v119 bitop3:0x80

    v_ffbl_b32 v120, v120
    v_max_i32 v84, v120, v84
    s_mov_b64 exec, -1

    v_lshl_add_u32 v73, v84, 1, v74
    v_lshl_add_u32 v71, -1, v84, v71
    ds_read_u16 v80, v73 offset:32
    v_ffbl_b32 v84, v71

    v_perm_b32 v72, v68, v67, v84
    v_and_or_b32 v72, v72, s66, v85
    ds_add_rtn_u32 v87, v72, v10
    ds_wrxchg_rtn_b32 v116, v86, v13

    s_add_u32 s47, s44, 151552
    buffer_load_dwordx4 v[216:219], v7, s[20:23], s47 offen offset:0
    buffer_load_dwordx4 v[220:223], v7, s[20:23], s47 offen offset:64
    s_mov_b32 s70, 0x977f977f

    s_waitcnt lgkmcnt(0)
    v_cmp_gt_u32 s[68:69], 2, v116

    v_cmpx_lt_u32 vcc, 1, v87
    v_bfe_i32 v119, s70, v71, 1
    v_lshrrev_b64 v[76:77], v123, s[68:69]
    v_perm_b32 v121, v76, v76, v5
    v_perm_b32 v122, v76, v76, v4
    v_and_b32 v121, v121, v21
    v_and_b32 v122, v122, v20
    v_msad_u8 v120, v28, v121, 0
    v_lshlrev_b32 v120, 4, v120
    v_msad_u8 v120, v27, v122, v120
    v_bitop3_b32 v120, v120, v71, v119 bitop3:0x80

    v_ffbl_b32 v120, v120
    v_max_i32 v84, v120, v84
    s_mov_b64 exec, -1

    v_lshl_add_u32 v73, v84, 1, v74
    v_lshl_add_u32 v71, -1, v84, v71
    ds_read_u16 v81, v73 offset:32
    v_ffbl_b32 v84, v71

    v_perm_b32 v72, v68, v67, v84
    v_and_or_b32 v72, v72, s66, v85
    ds_add_rtn_u32 v87, v72, v10
    ds_wrxchg_rtn_b32 v116, v86, v13

    s_add_u32 s47, s44, 155648
    buffer_load_dwordx4 v[232:235], v7, s[20:23], s47 offen offset:0
    buffer_load_dwordx4 v[236:239], v7, s[20:23], s47 offen offset:64
    s_mov_b32 s70, 0xe997e997

    s_waitcnt lgkmcnt(0)
    v_cmp_gt_u32 s[68:69], 2, v116

    v_cmpx_lt_u32 vcc, 1, v87
    v_bfe_i32 v119, s70, v71, 1
    v_lshrrev_b64 v[76:77], v123, s[68:69]
    v_perm_b32 v121, v76, v76, v5
    v_perm_b32 v122, v76, v76, v4
    v_and_b32 v121, v121, v21
    v_and_b32 v122, v122, v20
    v_msad_u8 v120, v28, v121, 0
    v_lshlrev_b32 v120, 4, v120
    v_msad_u8 v120, v27, v122, v120
    v_bitop3_b32 v120, v120, v71, v119 bitop3:0x80

    v_ffbl_b32 v120, v120
    v_max_i32 v84, v120, v84
    s_mov_b64 exec, -1

    v_lshl_add_u32 v73, v84, 1, v74
    v_lshl_add_u32 v71, -1, v84, v71
    ds_read_u16 v82, v73 offset:32
    v_ffbl_b32 v84, v71

    v_perm_b32 v72, v68, v67, v84
    v_and_or_b32 v72, v72, s66, v85
    ds_add_rtn_u32 v87, v72, v10
    ds_wrxchg_rtn_b32 v116, v86, v13

    s_add_u32 s47, s44, 159744
    buffer_load_dwordx4 v[248:251], v7, s[20:23], s47 offen offset:0
    buffer_load_dwordx4 v[252:255], v7, s[20:23], s47 offen offset:64
    s_mov_b32 s70, 0xfee9fee9

    s_waitcnt lgkmcnt(0)
    v_cmp_gt_u32 s[68:69], 2, v116

    v_cmpx_lt_u32 vcc, 1, v87
    v_bfe_i32 v119, s70, v71, 1
    v_lshrrev_b64 v[76:77], v123, s[68:69]
    v_perm_b32 v121, v76, v76, v5
    v_and_b32 v121, v121, v21
    v_msad_u8 v120, v28, v121, 0
    v_lshlrev_b32 v120, 4, v120
    v_bitop3_b32 v120, v120, v71, v119 bitop3:0x80

    v_ffbl_b32 v120, v120
    v_max_i32 v84, v120, v84
    s_mov_b64 exec, -1

    v_lshl_add_u32 v73, v84, 1, v74
    v_lshl_add_u32 v71, -1, v84, v71
    ds_read_u16 v83, v73 offset:32
    v_lshrrev_b32 v71, 4, v71

    s_cmp_ge_u32 s57, 800
    s_cbranch_scc1 k1_kernel_norl
    s_waitcnt vmcnt(0)

    v_perm_b32 v0, v132, v128, s84
    v_perm_b32 v1, v148, v144, s84
    v_perm_b32 v2, v164, v160, s84
    v_perm_b32 v3, v180, v176, s84
    v_perm_b32 v16, v132, v128, s85
    v_perm_b32 v17, v148, v144, s85
    v_perm_b32 v18, v164, v160, s85
    v_perm_b32 v19, v180, v176, s85
    v_perm_b32 v32, v133, v129, s84
    v_perm_b32 v33, v149, v145, s84
    v_perm_b32 v34, v165, v161, s84
    v_perm_b32 v35, v181, v177, s84
    v_perm_b32 v64, v133, v129, s85
    v_perm_b32 v65, v149, v145, s85
    v_perm_b32 v66, v165, v161, s85
    v_perm_b32 v67, v181, v177, s85
    ds_write_b128 v36, v[0:3]
    ds_write_b128 v37, v[16:19]
    ds_write_b128 v38, v[32:35]
    ds_write_b128 v39, v[64:67]
    ds_read_b128 v[40:43], v15 offset:0
    ds_read_b128 v[44:47], v15 offset:1024
    ds_read_b128 v[76:79], v15 offset:2048
    ds_read_b128 v[116:119], v15 offset:3072
    v_perm_b32 v0, v196, v192, s84
    v_perm_b32 v1, v212, v208, s84
    v_perm_b32 v2, v228, v224, s84
    v_perm_b32 v3, v244, v240, s84
    v_perm_b32 v16, v196, v192, s85
    v_perm_b32 v17, v212, v208, s85
    v_perm_b32 v18, v228, v224, s85
    v_perm_b32 v19, v244, v240, s85
    v_perm_b32 v32, v197, v193, s84
    v_perm_b32 v33, v213, v209, s84
    v_perm_b32 v34, v229, v225, s84
    v_perm_b32 v35, v245, v241, s84
    v_perm_b32 v64, v197, v193, s85
    v_perm_b32 v65, v213, v209, s85
    v_perm_b32 v66, v229, v225, s85
    v_perm_b32 v67, v245, v241, s85
    s_waitcnt lgkmcnt(0)
    s_add_u32 s83, s82, 0
    buffer_store_dwordx4 v[40:43], v14, s[32:35], s83 offen sc1
    s_add_u32 s83, s82, 3284992
    buffer_store_dwordx4 v[44:47], v14, s[32:35], s83 offen sc1
    s_add_u32 s83, s82, 6569984
    buffer_store_dwordx4 v[76:79], v14, s[32:35], s83 offen sc1
    s_add_u32 s83, s82, 9854976
    buffer_store_dwordx4 v[116:119], v14, s[32:35], s83 offen sc1
    ds_write_b128 v36, v[0:3]
    ds_write_b128 v37, v[16:19]
    ds_write_b128 v38, v[32:35]
    ds_write_b128 v39, v[64:67]
    ds_read_b128 v[40:43], v15 offset:0
    ds_read_b128 v[44:47], v15 offset:1024
    ds_read_b128 v[76:79], v15 offset:2048
    ds_read_b128 v[116:119], v15 offset:3072
    v_perm_b32 v0, v134, v130, s84
    v_perm_b32 v1, v150, v146, s84
    v_perm_b32 v2, v166, v162, s84
    v_perm_b32 v3, v182, v178, s84
    v_perm_b32 v16, v134, v130, s85
    v_perm_b32 v17, v150, v146, s85
    v_perm_b32 v18, v166, v162, s85
    v_perm_b32 v19, v182, v178, s85
    v_perm_b32 v32, v135, v131, s84
    v_perm_b32 v33, v151, v147, s84
    v_perm_b32 v34, v167, v163, s84
    v_perm_b32 v35, v183, v179, s84
    v_perm_b32 v64, v135, v131, s85
    v_perm_b32 v65, v151, v147, s85
    v_perm_b32 v66, v167, v163, s85
    v_perm_b32 v67, v183, v179, s85
    s_waitcnt lgkmcnt(0)
    s_add_u32 s83, s82, 64
    buffer_store_dwordx4 v[40:43], v14, s[32:35], s83 offen sc1
    s_add_u32 s83, s82, 3285056
    buffer_store_dwordx4 v[44:47], v14, s[32:35], s83 offen sc1
    s_add_u32 s83, s82, 6570048
    buffer_store_dwordx4 v[76:79], v14, s[32:35], s83 offen sc1
    s_add_u32 s83, s82, 9855040
    buffer_store_dwordx4 v[116:119], v14, s[32:35], s83 offen sc1
    ds_write_b128 v36, v[0:3]
    ds_write_b128 v37, v[16:19]
    ds_write_b128 v38, v[32:35]
    ds_write_b128 v39, v[64:67]
    ds_read_b128 v[40:43], v15 offset:0
    ds_read_b128 v[44:47], v15 offset:1024
    ds_read_b128 v[76:79], v15 offset:2048
    ds_read_b128 v[116:119], v15 offset:3072
    v_perm_b32 v0, v198, v194, s84
    v_perm_b32 v1, v214, v210, s84
    v_perm_b32 v2, v230, v226, s84
    v_perm_b32 v3, v246, v242, s84
    v_perm_b32 v16, v198, v194, s85
    v_perm_b32 v17, v214, v210, s85
    v_perm_b32 v18, v230, v226, s85
    v_perm_b32 v19, v246, v242, s85
    v_perm_b32 v32, v199, v195, s84
    v_perm_b32 v33, v215, v211, s84
    v_perm_b32 v34, v231, v227, s84
    v_perm_b32 v35, v247, v243, s84
    v_perm_b32 v64, v199, v195, s85
    v_perm_b32 v65, v215, v211, s85
    v_perm_b32 v66, v231, v227, s85
    v_perm_b32 v67, v247, v243, s85
    s_waitcnt lgkmcnt(0)
    s_add_u32 s83, s82, 102656
    buffer_store_dwordx4 v[40:43], v14, s[32:35], s83 offen sc1
    s_add_u32 s83, s82, 3387648
    buffer_store_dwordx4 v[44:47], v14, s[32:35], s83 offen sc1
    s_add_u32 s83, s82, 6672640
    buffer_store_dwordx4 v[76:79], v14, s[32:35], s83 offen sc1
    s_add_u32 s83, s82, 9957632
    buffer_store_dwordx4 v[116:119], v14, s[32:35], s83 offen sc1
    ds_write_b128 v36, v[0:3]
    ds_write_b128 v37, v[16:19]
    ds_write_b128 v38, v[32:35]
    ds_write_b128 v39, v[64:67]
    ds_read_b128 v[40:43], v15 offset:0
    ds_read_b128 v[44:47], v15 offset:1024
    ds_read_b128 v[76:79], v15 offset:2048
    ds_read_b128 v[116:119], v15 offset:3072
    ds_write_b64 v31, v[48:49] offset:32
    ds_write_b64 v31, v[50:51] offset:40
    ds_write_b64 v31, v[52:53] offset:48
    s_waitcnt lgkmcnt(3)
    s_add_u32 s83, s82, 102720
    buffer_store_dwordx4 v[40:43], v14, s[32:35], s83 offen sc1
    s_add_u32 s83, s82, 3387712
    buffer_store_dwordx4 v[44:47], v14, s[32:35], s83 offen sc1
    s_add_u32 s83, s82, 6672704
    buffer_store_dwordx4 v[76:79], v14, s[32:35], s83 offen sc1
    s_add_u32 s83, s82, 9957696
    buffer_store_dwordx4 v[116:119], v14, s[32:35], s83 offen sc1
k1_kernel_norl:
k1_kernel_rld:
    ds_write_b32 v86, v13
    v_ffbl_b32 v84, v71

    v_perm_b32 v72, v69, v68, v84
    v_and_or_b32 v72, v72, s66, v85
    ds_add_rtn_u32 v87, v72, v10
    ds_wrxchg_rtn_b32 v116, v86, v13

    s_mov_b32 s70, 0x7fff7fff

    s_waitcnt lgkmcnt(0)
    v_cmp_gt_u32 s[68:69], 2, v116

    v_lshl_or_b32 v78, v81, 16, v80
    v_lshl_or_b32 v79, v83, 16, v82
    buffer_store_dwordx2 v[78:79], v30, s[32:35], s62 offen sc1
    s_add_u32 s62, s62, 65536
    v_cmpx_lt_u32 vcc, 1, v87
    v_bfe_i32 v119, s70, v71, 1
    v_lshrrev_b64 v[76:77], v123, s[68:69]
    v_perm_b32 v121, v76, v76, v6
    v_perm_b32 v122, v76, v76, v5
    v_and_b32 v121, v121, v22
    v_and_b32 v122, v122, v21
    v_msad_u8 v120, v29, v121, 0
    v_lshlrev_b32 v120, 4, v120
    v_msad_u8 v120, v28, v122, v120
    v_bitop3_b32 v120, v120, v71, v119 bitop3:0x80

    v_ffbl_b32 v120, v120
    v_max_i32 v84, v120, v84
    s_mov_b64 exec, -1

    v_lshl_add_u32 v73, v84, 1, v74
    v_lshl_add_u32 v71, -1, v84, v71
    ds_read_u16 v80, v73 offset:40
    v_ffbl_b32 v84, v71

    v_perm_b32 v72, v69, v68, v84
    v_and_or_b32 v72, v72, s66, v85
    ds_add_rtn_u32 v87, v72, v10
    ds_wrxchg_rtn_b32 v116, v86, v13

    s_mov_b32 s70, 0x977f977f

    s_waitcnt lgkmcnt(0)
    v_cmp_gt_u32 s[68:69], 2, v116

    v_cmpx_lt_u32 vcc, 1, v87
    v_bfe_i32 v119, s70, v71, 1
    v_lshrrev_b64 v[76:77], v123, s[68:69]
    v_perm_b32 v121, v76, v76, v6
    v_perm_b32 v122, v76, v76, v5
    v_and_b32 v121, v121, v22
    v_and_b32 v122, v122, v21
    v_msad_u8 v120, v29, v121, 0
    v_lshlrev_b32 v120, 4, v120
    v_msad_u8 v120, v28, v122, v120
    v_bitop3_b32 v120, v120, v71, v119 bitop3:0x80

    v_ffbl_b32 v120, v120
    v_max_i32 v84, v120, v84
    s_mov_b64 exec, -1

    v_lshl_add_u32 v73, v84, 1, v74
    v_lshl_add_u32 v71, -1, v84, v71
    ds_read_u16 v81, v73 offset:40
    v_ffbl_b32 v84, v71

    v_perm_b32 v72, v69, v68, v84
    v_and_or_b32 v72, v72, s66, v85
    ds_add_rtn_u32 v87, v72, v10
    ds_wrxchg_rtn_b32 v116, v86, v13

    s_mov_b32 s70, 0xe997e997

    s_waitcnt lgkmcnt(0)
    v_cmp_gt_u32 s[68:69], 2, v116

    v_cmpx_lt_u32 vcc, 1, v87
    v_bfe_i32 v119, s70, v71, 1
    v_lshrrev_b64 v[76:77], v123, s[68:69]
    v_perm_b32 v121, v76, v76, v6
    v_perm_b32 v122, v76, v76, v5
    v_and_b32 v121, v121, v22
    v_and_b32 v122, v122, v21
    v_msad_u8 v120, v29, v121, 0
    v_lshlrev_b32 v120, 4, v120
    v_msad_u8 v120, v28, v122, v120
    v_bitop3_b32 v120, v120, v71, v119 bitop3:0x80

    v_ffbl_b32 v120, v120
    v_max_i32 v84, v120, v84
    s_mov_b64 exec, -1

    v_lshl_add_u32 v73, v84, 1, v74
    v_lshl_add_u32 v71, -1, v84, v71
    ds_read_u16 v82, v73 offset:40
    v_ffbl_b32 v84, v71

    v_perm_b32 v72, v69, v68, v84
    v_and_or_b32 v72, v72, s66, v85
    ds_add_rtn_u32 v87, v72, v10
    ds_wrxchg_rtn_b32 v116, v86, v13

    s_mov_b32 s70, 0xfee9fee9

    s_waitcnt lgkmcnt(0)
    v_cmp_gt_u32 s[68:69], 2, v116

    v_cmpx_lt_u32 vcc, 1, v87
    v_bfe_i32 v119, s70, v71, 1
    v_lshrrev_b64 v[76:77], v123, s[68:69]
    v_perm_b32 v121, v76, v76, v6
    v_and_b32 v121, v121, v22
    v_msad_u8 v120, v29, v121, 0
    v_lshlrev_b32 v120, 4, v120
    v_bitop3_b32 v120, v120, v71, v119 bitop3:0x80

    v_ffbl_b32 v120, v120
    v_max_i32 v84, v120, v84
    s_mov_b64 exec, -1

    v_lshl_add_u32 v73, v84, 1, v74
    v_lshl_add_u32 v71, -1, v84, v71
    ds_read_u16 v83, v73 offset:40
    s_cmp_lg_u32 s59, 3
    s_cbranch_scc1 k1_kernel_sdone
    v_lshrrev_b32 v71, 4, v71
    v_ffbl_b32 v84, v71

    v_perm_b32 v72, v70, v69, v84
    v_and_or_b32 v72, v72, s66, v85
    ds_add_rtn_u32 v87, v72, v10
    ds_wrxchg_rtn_b32 v116, v86, v13

    s_waitcnt lgkmcnt(0)
    v_cmp_gt_u32 s[68:69], 2, v116

    v_lshl_or_b32 v78, v81, 16, v80
    v_lshl_or_b32 v79, v83, 16, v82
    buffer_store_dwordx2 v[78:79], v30, s[32:35], s62 offen sc1
    s_add_u32 s62, s62, 65536
    v_cmpx_lt_u32 vcc, 1, v87
    v_lshrrev_b64 v[76:77], v123, s[68:69]
    v_perm_b32 v121, v76, v76, v6
    v_and_b32 v121, v121, v22
    v_msad_u8 v120, v29, v121, 0
    v_and_b32 v120, v120, v71

    v_ffbl_b32 v120, v120
    v_max_i32 v84, v120, v84
    s_mov_b64 exec, -1

    v_lshl_add_u32 v73, v84, 1, v74
    v_lshl_add_u32 v71, -1, v84, v71
    ds_read_u16 v80, v73 offset:48
    v_ffbl_b32 v84, v71

    v_perm_b32 v72, v70, v69, v84
    v_and_or_b32 v72, v72, s66, v85
    ds_add_rtn_u32 v87, v72, v10
    ds_wrxchg_rtn_b32 v116, v86, v13

    s_waitcnt lgkmcnt(0)
    v_cmp_gt_u32 s[68:69], 2, v116

    v_cmpx_lt_u32 vcc, 1, v87
    s_nop 0
    v_lshrrev_b64 v[76:77], v123, s[68:69]
    v_perm_b32 v121, v76, v76, v6
    v_and_b32 v121, v121, v22
    v_msad_u8 v120, v29, v121, 0
    v_and_b32 v120, v120, v71

    v_ffbl_b32 v120, v120
    v_max_i32 v84, v120, v84
    s_mov_b64 exec, -1

    v_lshl_add_u32 v73, v84, 1, v74
    v_lshl_add_u32 v71, -1, v84, v71
    ds_read_u16 v81, v73 offset:48
    v_ffbl_b32 v84, v71

    v_perm_b32 v72, v70, v69, v84
    v_and_or_b32 v72, v72, s66, v85
    ds_add_rtn_u32 v87, v72, v10
    ds_wrxchg_rtn_b32 v116, v86, v13

    s_waitcnt lgkmcnt(0)
    v_cmp_gt_u32 s[68:69], 2, v116

    v_cmpx_lt_u32 vcc, 1, v87
    s_nop 0
    v_lshrrev_b64 v[76:77], v123, s[68:69]
    v_perm_b32 v121, v76, v76, v6
    v_and_b32 v121, v121, v22
    v_msad_u8 v120, v29, v121, 0
    v_and_b32 v120, v120, v71

    v_ffbl_b32 v120, v120
    v_max_i32 v84, v120, v84
    s_mov_b64 exec, -1

    v_lshl_add_u32 v73, v84, 1, v74
    v_lshl_add_u32 v71, -1, v84, v71
    ds_read_u16 v82, v73 offset:48
    v_ffbl_b32 v84, v71
    v_lshl_add_u32 v73, v84, 1, v74
    ds_read_u16 v83, v73 offset:48
k1_kernel_sdone:
    s_waitcnt lgkmcnt(0)
    v_lshl_or_b32 v78, v81, 16, v80
    v_lshl_or_b32 v79, v83, 16, v82
    buffer_store_dwordx2 v[78:79], v30, s[32:35], s62 offen sc1
    s_add_u32 s62, s62, 65536
k1_kernel_udone:
    s_setprio 3

    s_mov_b64 exec, 1
    ds_add_rtn_u32 v12, v11, v10 offset:28
    s_waitcnt lgkmcnt(0)
    v_readfirstlane_b32 s45, v12
    s_cmp_ge_u32 s45, 2
    s_cbranch_scc1 k1_kernel_ncl
    s_mov_b64 exec, -1
    s_mul_i32 s45, s45, 16384
    s_min_u32 s45, s45, 16384
    s_lshl_b32 s72, s2, 15
    s_add_u32 s72, s72, s45
    s_add_u32 s72, s72, 20971520
    v_mov_b32 v192, -1
    v_mov_b32 v193, -1
    v_mov_b32 v194, -1
    v_mov_b32 v195, -1
    buffer_store_dwordx4 v[192:195], v9, s[12:15], s72 offen offset:0 sc1
    buffer_store_dwordx4 v[192:195], v9, s[12:15], s72 offen offset:1024 sc1
    buffer_store_dwordx4 v[192:195], v9, s[12:15], s72 offen offset:2048 sc1
    buffer_store_dwordx4 v[192:195], v9, s[12:15], s72 offen offset:3072 sc1
    s_add_u32 s72, s72, 4096
    buffer_store_dwordx4 v[192:195], v9, s[12:15], s72 offen offset:0 sc1
    buffer_store_dwordx4 v[192:195], v9, s[12:15], s72 offen offset:1024 sc1
    buffer_store_dwordx4 v[192:195], v9, s[12:15], s72 offen offset:2048 sc1
    buffer_store_dwordx4 v[192:195], v9, s[12:15], s72 offen offset:3072 sc1
    s_add_u32 s72, s72, 4096
    buffer_store_dwordx4 v[192:195], v9, s[12:15], s72 offen offset:0 sc1
    buffer_store_dwordx4 v[192:195], v9, s[12:15], s72 offen offset:1024 sc1
    buffer_store_dwordx4 v[192:195], v9, s[12:15], s72 offen offset:2048 sc1
    buffer_store_dwordx4 v[192:195], v9, s[12:15], s72 offen offset:3072 sc1
    s_add_u32 s72, s72, 4096
    buffer_store_dwordx4 v[192:195], v9, s[12:15], s72 offen offset:0 sc1
    buffer_store_dwordx4 v[192:195], v9, s[12:15], s72 offen offset:1024 sc1
    buffer_store_dwordx4 v[192:195], v9, s[12:15], s72 offen offset:2048 sc1
    buffer_store_dwordx4 v[192:195], v9, s[12:15], s72 offen offset:3072 sc1
    s_add_u32 s72, s72, 4096
k1_kernel_ncl:

    s_waitcnt vmcnt(0)

    s_mov_b64 exec, 1
    ds_add_rtn_u32 v12, v11, v10 offset:20
    v_mov_b32 v3, 1
    s_bfe_u32 s39, s2, 0x10004
    s_mul_i32 s38, s39, 128
    s_waitcnt lgkmcnt(0)
    v_readfirstlane_b32 s45, v12
    s_cmp_eq_u32 s45, 3
    s_cbranch_scc0 k1_kernel_tld0
    buffer_atomic_add v3, v13, s[52:55], s38 offen offset:32 sc0
k1_kernel_tld0:
    s_and_b32 s45, s45, 3
k1_kernel_tld:
    s_mov_b64 exec, -1
    s_add_u32 s47, s44, 0
    buffer_load_dwordx4 v[32:35], v7, s[20:23], s47 offen offset:0
    buffer_load_dwordx4 v[36:39], v7, s[20:23], s47 offen offset:64
    s_add_u32 s47, s44, 4096
    buffer_load_dwordx4 v[40:43], v7, s[20:23], s47 offen offset:0
    buffer_load_dwordx4 v[44:47], v7, s[20:23], s47 offen offset:64
    s_add_u32 s47, s44, 8192
    buffer_load_dwordx4 v[48:51], v7, s[20:23], s47 offen offset:0
    buffer_load_dwordx4 v[52:55], v7, s[20:23], s47 offen offset:64
    s_cmp_eq_u32 s45, 3
    s_cbranch_scc0 k1_kernel_wdec
    s_lshl_b32 s45, s2, 8
    s_add_u32 s45, s45, 14680064
    v_lshlrev_b32 v0, 8, v8
    v_mov_b32 v116, 0
    s_lshl4_add_u32 s38, s39, 14680064
    s_cmp_lg_u32 s64, 0
    s_cbranch_scc1 k1_kernel_bits
    s_waitcnt vmcnt(6)
    v_readfirstlane_b32 s39, v3

    s_cmp_eq_u32 s39, 127
    s_cbranch_scc0 k1_kernel_poll0

    buffer_store_dword v10, v0, s[12:15], s38 offen sc1
    s_add_u32 s38, s38, 16384
    buffer_store_dword v10, v0, s[12:15], s38 offen sc1
    s_add_u32 s38, s38, 16384
    buffer_store_dword v10, v0, s[12:15], s38 offen sc1
    s_add_u32 s38, s38, 16384
    buffer_store_dword v10, v0, s[12:15], s38 offen sc1

k1_kernel_poll0:
    s_mov_b64 exec, 3
k1_kernel_poll:
    buffer_load_dword v116, v9, s[12:15], s45 offen sc1
    s_add_u32 s65, s65, 1
    s_waitcnt vmcnt(0)
    v_cmp_ne_u32 vcc, 1, v116
    s_cbranch_vccz k1_kernel_go

    s_cmp_lt_u32 s65, 200
    s_cbranch_scc1 k1_kernel_poll
k1_kernel_bits:
    s_mov_b64 exec, -1
    s_lshr_b32 s38, s51, 5
    s_lshl_b32 s39, 1, s51
    v_cmp_eq_u32 vcc, s38, v8
    v_mov_b32 v2, s39
    v_lshlrev_b32 v0, 2, v8
    v_cndmask_b32 v2, 0, v2, vcc
    v_mov_b32 v1, v2
    buffer_atomic_or v1, v0, s[52:55], 0 offen sc0
    s_waitcnt vmcnt(0)
    v_cmp_ne_u32 vcc, 128, v1
    v_or_b32 v1, v1, v2
    s_and_b32 s38, vcc_lo, 0x100
    s_and_b32 s39, vcc_hi, 0x100
    v_cmp_ne_u32 vcc, -1, v1
    s_or_b32 s38, s38, s39
    s_cbranch_scc0 k1_kernel_go
    s_and_b32 s38, vcc_lo, 0xff
    s_cbranch_scc0 k1_kernel_go
    s_ff1_i32_b32 s38, s38
    s_nop 3
    v_readlane_b32 s39, v1, s38
    s_ff0_i32_b32 s39, s39
    s_lshl_b32 s38, s38, 5
    s_add_u32 s38, s38, s39
    s_andn2_b32 s39, s64, 255
    s_add_u32 s39, s39, 256
    s_or_b32 s38, s38, s39
    s_branch k1_kernel_dec

k1_kernel_go:

    s_mov_b32 s38, 0x80000000

k1_kernel_dec:

    v_mov_b32 v1, s38
    s_mov_b64 exec, 1
    ds_write_b32 v11, v1 offset:24

k1_kernel_wdec:

    s_mov_b64 exec, -1
    ds_read_b32 v12, v11 offset:24
    s_waitcnt lgkmcnt(0)
    v_readfirstlane_b32 s45, v12
    s_cmp_lg_u32 s45, s64
    s_cbranch_scc1 k1_kernel_gotd
    s_sleep 2
    s_branch k1_kernel_wdec
k1_kernel_redo:
    s_waitcnt vmcnt(0) lgkmcnt(0)
    s_branch k1_kernel_unit

k1_kernel_gotd:

    s_mov_b32 s64, s45
    s_and_b32 s51, s45, 255
    s_mov_b32 s65, 0x10000
    s_bitcmp0_b32 s45, 31
    s_cbranch_scc1 k1_kernel_redo

k1_kernel_k2:

    s_setprio 0
    s_load_dwordx4 s[8:11], s[0:1], 32
    s_load_dwordx2 s[56:57], s[0:1], 48
    s_load_dwordx2 s[60:61], s[0:1], 56
    v_mbcnt_lo_u32_b32 v0, -1, 0
    v_mbcnt_hi_u32_b32 v0, -1, v0
    s_mul_i32 s35, s3, 18432
    v_and_b32 v1, 15, v0
    v_lshrrev_b32 v2, 4, v0
    v_mul_u32_u24 v71, 144, v1
    v_lshl_add_u32 v71, v2, 4, v71
    v_add_u32 v71, s35, v71

    ds_read_b128 v[128:131], v71 offset:0
    ds_read_b128 v[132:135], v71 offset:64
    ds_read_b128 v[144:147], v71 offset:2304
    ds_read_b128 v[148:151], v71 offset:2368
    ds_read_b128 v[160:163], v71 offset:4608
    ds_read_b128 v[164:167], v71 offset:4672
    ds_read_b128 v[176:179], v71 offset:6912
    ds_read_b128 v[180:183], v71 offset:6976
    ds_read_b128 v[192:195], v71 offset:9216
    ds_read_b128 v[196:199], v71 offset:9280
    ds_read_b128 v[208:211], v71 offset:11520
    ds_read_b128 v[212:215], v71 offset:11584
    ds_read_b128 v[224:227], v71 offset:13824
    ds_read_b128 v[228:231], v71 offset:13888
    ds_read_b128 v[240:243], v71 offset:16128
    ds_read_b128 v[244:247], v71 offset:16192

    s_lshr_b32 s33, s2, 1
    s_and_b32 s34, s2, 1
    s_mov_b32 s32, 0x8000
    v_lshlrev_b32 v69, 4, v0
    s_mul_i32 s21, s33, 102656
    s_lshl_b32 s35, s50, 11
    s_xor_b32 s19, s35, 2048
    s_add_u32 s19, s19, s21
    s_add_u32 s21, s21, s35
    s_mul_i32 s20, s34, 1638400
    s_add_u32 s20, s20, 16777216
    s_lshl_b32 s35, s3, 13
    s_add_u32 s20, s20, s35
    v_lshlrev_b32 v70, 13, v2
    v_lshl_add_u32 v70, v1, 3, v70
    s_lshl_b32 s35, s3, 10
    v_add_u32 v70, s35, v70
    v_lshrrev_b32 v4, 3, v0
    v_xor_b32 v4, v4, v2
    v_and_b32 v4, 1, v4
    v_bfe_u32 v5, v0, 2, 1
    v_lshl_or_b32 v4, v4, 1, v5
    v_mov_b32 v6, 0x3f80
    v_cmp_eq_u32 vcc, 0, v4
    s_nop 1
    v_cndmask_b32 v64, 0, v6, vcc
    v_cndmask_b32 v65, 0, v6, vcc
    v_cmp_eq_u32 vcc, 1, v4
    s_nop 1
    v_cndmask_b32 v66, 0, v6, vcc
    v_cndmask_b32 v67, 0, v6, vcc
    v_and_b32 v5, 3, v0
    v_mul_u32_u24 v68, 0x5555, v5

    s_cmp_lt_u32 s3, 4
    s_cbranch_scc1 k1_kernel_k2n
    buffer_load_dwordx4 v[0:3], v69, s[12:15], s21 offen offset:0
    buffer_load_dwordx4 v[4:7], v69, s[12:15], s21 offen offset:1024
    buffer_load_dwordx4 v[8:11], v69, s[12:15], s19 offen offset:0
    buffer_load_dwordx4 v[12:15], v69, s[12:15], s19 offen offset:1024
    s_add_u32 s21, s21, 4096
    s_add_u32 s19, s19, 4096
    buffer_load_dwordx4 v[16:19], v69, s[12:15], s21 offen offset:0
    buffer_load_dwordx4 v[20:23], v69, s[12:15], s21 offen offset:1024
    buffer_load_dwordx4 v[24:27], v69, s[12:15], s19 offen offset:0
    buffer_load_dwordx4 v[28:31], v69, s[12:15], s19 offen offset:1024
    s_add_u32 s21, s21, 4096
    s_add_u32 s19, s19, 4096
    s_mov_b32 s44, s21
    s_mov_b32 s45, s19
    s_add_u32 s21, s21, 4096
    s_add_u32 s19, s19, 4096
    buffer_load_dwordx4 v[72:75], v69, s[12:15], s21 offen offset:0
    buffer_load_dwordx4 v[76:79], v69, s[12:15], s21 offen offset:1024
    buffer_load_dwordx4 v[80:83], v69, s[12:15], s19 offen offset:0
    buffer_load_dwordx4 v[84:87], v69, s[12:15], s19 offen offset:1024
    s_add_u32 s21, s21, 4096
    s_add_u32 s19, s19, 4096
    buffer_load_dwordx4 v[116:119], v69, s[12:15], s20 offen offset:0 sc1
    buffer_load_dwordx4 v[120:123], v69, s[12:15], s20 offen offset:1024 sc1
k1_kernel_k2n:

    s_and_b32 s35, s3, 3
    s_lshl_b32 s35, s35, 14
    s_add_u32 s35, s35, 98304
    v_add_u32 v71, s35, v69
    s_lshl_b32 s35, s33, 3
    s_waitcnt lgkmcnt(0)
    s_add_u32 s8, s8, s35
    s_addc_u32 s9, s9, 0
    s_add_u32 s10, s10, s35
    s_addc_u32 s11, s11, 0
    s_barrier

    s_load_dwordx2 s[36:37], s[8:9], 0
    s_load_dwordx2 s[38:39], s[10:11], 0
    s_cmp_lt_u32 s3, 4
    s_cbranch_scc1 k1_kernel_k2m

    s_waitcnt vmcnt(10)
    ds_write_b128 v71, v[32:35] offset:0
    ds_write_b128 v71, v[36:39] offset:1024
    ds_write_b128 v71, v[40:43] offset:2048
    ds_write_b128 v71, v[44:47] offset:3072
    v_mfma_f32_16x16x32_bf16 v[32:35], v[0:3], v[128:131], 0
    v_mfma_f32_16x16x32_bf16 v[36:39], v[0:3], v[144:147], 0
    ds_write_b128 v71, v[48:51] offset:4096
    v_mfma_f32_16x16x32_bf16 v[40:43], v[0:3], v[160:163], 0
    v_mfma_f32_16x16x32_bf16 v[44:47], v[0:3], v[176:179], 0
    ds_write_b128 v71, v[52:55] offset:5120
    v_mfma_f32_16x16x32_bf16 v[32:35], v[4:7], v[132:135], v[32:35]
    v_mfma_f32_16x16x32_bf16 v[36:39], v[4:7], v[148:151], v[36:39]
    ds_write_b128 v71, v[56:59] offset:6144
    v_mfma_f32_16x16x32_bf16 v[40:43], v[4:7], v[164:167], v[40:43]
    v_mfma_f32_16x16x32_bf16 v[44:47], v[4:7], v[180:183], v[44:47]
    ds_write_b128 v71, v[60:63] offset:7168
    v_mfma_f32_16x16x32_bf16 v[32:35], v[8:11], v[136:139], v[32:35]
    v_mfma_f32_16x16x32_bf16 v[36:39], v[8:11], v[152:155], v[36:39]
    ds_write_b128 v71, v[88:91] offset:8192
    v_mfma_f32_16x16x32_bf16 v[40:43], v[8:11], v[168:171], v[40:43]
    v_mfma_f32_16x16x32_bf16 v[44:47], v[8:11], v[184:187], v[44:47]
    ds_write_b128 v71, v[92:95] offset:9216
    v_mfma_f32_16x16x32_bf16 v[32:35], v[12:15], v[140:143], v[32:35]
    v_mfma_f32_16x16x32_bf16 v[36:39], v[12:15], v[156:159], v[36:39]
    ds_write_b128 v71, v[96:99] offset:10240
    v_mfma_f32_16x16x32_bf16 v[40:43], v[12:15], v[172:175], v[40:43]
    v_mfma_f32_16x16x32_bf16 v[44:47], v[12:15], v[188:191], v[44:47]
    ds_write_b128 v71, v[100:103] offset:11264
    v_mfma_f32_16x16x32_bf16 v[48:51], v[0:3], v[192:195], 0
    v_mfma_f32_16x16x32_bf16 v[52:55], v[0:3], v[208:211], 0
    ds_write_b128 v71, v[104:107] offset:12288
    v_mfma_f32_16x16x32_bf16 v[56:59], v[0:3], v[224:227], 0
    v_mfma_f32_16x16x32_bf16 v[60:63], v[0:3], v[240:243], 0
    ds_write_b128 v71, v[108:111] offset:13312
    v_mfma_f32_16x16x32_bf16 v[48:51], v[4:7], v[196:199], v[48:51]
    v_mfma_f32_16x16x32_bf16 v[52:55], v[4:7], v[212:215], v[52:55]
    ds_write_b128 v71, v[112:115] offset:14336
    v_mfma_f32_16x16x32_bf16 v[56:59], v[4:7], v[228:231], v[56:59]
    v_mfma_f32_16x16x32_bf16 v[60:63], v[4:7], v[244:247], v[60:63]
    ds_write_b128 v71, v[124:127] offset:15360
    v_mfma_f32_16x16x32_bf16 v[48:51], v[8:11], v[200:203], v[48:51]
    v_mfma_f32_16x16x32_bf16 v[52:55], v[8:11], v[216:219], v[52:55]
    v_mfma_f32_16x16x32_bf16 v[56:59], v[8:11], v[232:235], v[56:59]
    v_mfma_f32_16x16x32_bf16 v[60:63], v[8:11], v[248:251], v[60:63]
    s_waitcnt lgkmcnt(0)
    s_barrier
    v_mfma_f32_16x16x32_bf16 v[48:51], v[12:15], v[204:207], v[48:51]
    v_mfma_f32_16x16x32_bf16 v[52:55], v[12:15], v[220:223], v[52:55]
    v_mfma_f32_16x16x32_bf16 v[56:59], v[12:15], v[236:239], v[56:59]
    v_mfma_f32_16x16x32_bf16 v[60:63], v[12:15], v[252:255], v[60:63]
    buffer_load_dwordx4 v[124:127], v69, s[12:15], s20 offen offset:2048 sc1
    buffer_load_dwordx4 v[0:3], v69, s[12:15], s44 offen offset:0
    buffer_load_dwordx4 v[4:7], v69, s[12:15], s44 offen offset:1024
    buffer_load_dwordx4 v[8:11], v69, s[12:15], s45 offen offset:0
    buffer_load_dwordx4 v[12:15], v69, s[12:15], s45 offen offset:1024
    s_waitcnt vmcnt(11)
    s_lshl_b32 s24, s36, 16
    s_and_b32 s25, s36, 0xffff0000
    s_lshl_b32 s26, s37, 16
    s_and_b32 s27, s37, 0xffff0000

    v_mfma_f32_16x16x32_bf16 v[88:91], v[16:19], v[128:131], 0
    v_mfma_f32_16x16x32_bf16 v[92:95], v[16:19], v[144:147], 0
    v_mfma_f32_16x16x32_bf16 v[88:91], v[20:23], v[132:135], v[88:91]
    v_mfma_f32_16x16x32_bf16 v[92:95], v[20:23], v[148:151], v[92:95]
    v_mfma_f32_16x16x32_bf16 v[88:91], v[24:27], v[136:139], v[88:91]
    v_cvt_pk_bf16_f32 v32, v32, v33
    v_mfma_f32_16x16x32_bf16 v[92:95], v[24:27], v[152:155], v[92:95]
    v_cvt_pk_bf16_f32 v33, v34, v35
    v_mfma_f32_16x16x32_bf16 v[88:91], v[28:31], v[140:143], v[88:91]
    ds_write_b64 v70, v[32:33] offset:0
    v_mfma_f32_16x16x32_bf16 v[92:95], v[28:31], v[156:159], v[92:95]
    v_cvt_pk_bf16_f32 v36, v36, v37
    v_mfma_f32_16x16x32_bf16 v[96:99], v[16:19], v[160:163], 0
    v_cvt_pk_bf16_f32 v37, v38, v39
    v_mfma_f32_16x16x32_bf16 v[100:103], v[16:19], v[176:179], 0
    ds_write_b64 v70, v[36:37] offset:128
    v_mfma_f32_16x16x32_bf16 v[96:99], v[20:23], v[164:167], v[96:99]
    v_cvt_pk_bf16_f32 v88, v88, v89
    v_cvt_pk_bf16_f32 v40, v40, v41
    v_mfma_f32_16x16x32_bf16 v[100:103], v[20:23], v[180:183], v[100:103]
    v_cvt_pk_bf16_f32 v89, v90, v91
    v_cvt_pk_bf16_f32 v41, v42, v43
    v_mfma_f32_16x16x32_bf16 v[96:99], v[24:27], v[168:171], v[96:99]
    ds_write_b64 v70, v[88:89] offset:32768
    ds_write_b64 v70, v[40:41] offset:256
    v_mfma_f32_16x16x32_bf16 v[100:103], v[24:27], v[184:187], v[100:103]
    v_cvt_pk_bf16_f32 v92, v92, v93
    v_cvt_pk_bf16_f32 v44, v44, v45
    v_mfma_f32_16x16x32_bf16 v[96:99], v[28:31], v[172:175], v[96:99]
    v_cvt_pk_bf16_f32 v93, v94, v95
    v_cvt_pk_bf16_f32 v45, v46, v47
    v_mfma_f32_16x16x32_bf16 v[100:103], v[28:31], v[188:191], v[100:103]
    ds_write_b64 v70, v[92:93] offset:32896
    ds_write_b64 v70, v[44:45] offset:384
    v_mfma_f32_16x16x32_bf16 v[104:107], v[16:19], v[192:195], 0
    v_cvt_pk_bf16_f32 v48, v48, v49
    v_mfma_f32_16x16x32_bf16 v[108:111], v[16:19], v[208:211], 0
    v_cvt_pk_bf16_f32 v49, v50, v51
    v_mfma_f32_16x16x32_bf16 v[104:107], v[20:23], v[196:199], v[104:107]
    v_cvt_pk_bf16_f32 v96, v96, v97
    ds_write_b64 v70, v[48:49] offset:512
    v_mfma_f32_16x16x32_bf16 v[108:111], v[20:23], v[212:215], v[108:111]
    v_cvt_pk_bf16_f32 v97, v98, v99
    v_cvt_pk_bf16_f32 v52, v52, v53
    v_mfma_f32_16x16x32_bf16 v[104:107], v[24:27], v[200:203], v[104:107]
    ds_write_b64 v70, v[96:97] offset:33024
    v_cvt_pk_bf16_f32 v53, v54, v55
    v_mfma_f32_16x16x32_bf16 v[108:111], v[24:27], v[216:219], v[108:111]
    v_cvt_pk_bf16_f32 v100, v100, v101
    ds_write_b64 v70, v[52:53] offset:640
    v_mfma_f32_16x16x32_bf16 v[104:107], v[28:31], v[204:207], v[104:107]
    v_cvt_pk_bf16_f32 v101, v102, v103
    v_cvt_pk_bf16_f32 v56, v56, v57
    v_mfma_f32_16x16x32_bf16 v[108:111], v[28:31], v[220:223], v[108:111]
    ds_write_b64 v70, v[100:101] offset:33152
    v_cvt_pk_bf16_f32 v57, v58, v59
    v_mfma_f32_16x16x32_bf16 v[88:91], v[16:19], v[224:227], 0
    ds_write_b64 v70, v[56:57] offset:768
    v_mfma_f32_16x16x32_bf16 v[92:95], v[16:19], v[240:243], 0
    v_cvt_pk_bf16_f32 v60, v60, v61
    v_mfma_f32_16x16x32_bf16 v[88:91], v[20:23], v[228:231], v[88:91]
    v_cvt_pk_bf16_f32 v104, v104, v105
    v_cvt_pk_bf16_f32 v61, v62, v63
    v_mfma_f32_16x16x32_bf16 v[92:95], v[20:23], v[244:247], v[92:95]
    v_cvt_pk_bf16_f32 v105, v106, v107
    ds_write_b64 v70, v[60:61] offset:896
    v_mfma_f32_16x16x32_bf16 v[88:91], v[24:27], v[232:235], v[88:91]
    ds_write_b64 v70, v[104:105] offset:33280
    v_mfma_f32_16x16x32_bf16 v[92:95], v[24:27], v[248:251], v[92:95]
    v_cvt_pk_bf16_f32 v108, v108, v109
    v_mfma_f32_16x16x32_bf16 v[88:91], v[28:31], v[236:239], v[88:91]
    v_cvt_pk_bf16_f32 v109, v110, v111
    v_mfma_f32_16x16x32_bf16 v[92:95], v[28:31], v[252:255], v[92:95]
    ds_write_b64 v70, v[108:109] offset:33408
    v_add_u32 v70, 0x8000, v70
    s_waitcnt vmcnt(0)
    v_mfma_f32_16x16x32_bf16 v[96:99], v[0:3], v[128:131], 0
    v_mfma_f32_16x16x32_bf16 v[100:103], v[0:3], v[144:147], 0
    v_mfma_f32_16x16x32_bf16 v[96:99], v[4:7], v[132:135], v[96:99]
    v_cvt_pk_bf16_f32 v88, v88, v89
    v_mfma_f32_16x16x32_bf16 v[100:103], v[4:7], v[148:151], v[100:103]
    v_cvt_pk_bf16_f32 v89, v90, v91
    v_mfma_f32_16x16x32_bf16 v[96:99], v[8:11], v[136:139], v[96:99]
    ds_write_b64 v70, v[88:89] offset:768
    v_mov_b32 v16, s24
    v_mov_b32 v40, s24
    v_mfma_f32_16x16x32_bf16 v[100:103], v[8:11], v[152:155], v[100:103]
    v_cvt_pk_bf16_f32 v92, v92, v93
    v_mov_b32 v17, s25
    v_mov_b32 v41, s25
    v_mfma_f32_16x16x32_bf16 v[96:99], v[12:15], v[140:143], v[96:99]
    v_cvt_pk_bf16_f32 v93, v94, v95
    v_mov_b32 v18, s26
    v_mov_b32 v42, s26
    v_mfma_f32_16x16x32_bf16 v[100:103], v[12:15], v[156:159], v[100:103]
    ds_write_b64 v70, v[92:93] offset:896
    v_mov_b32 v19, s27
    v_mov_b32 v43, s27
    v_mfma_f32_16x16x32_bf16 v[104:107], v[0:3], v[160:163], 0
    v_mov_b32 v20, s24
    v_mov_b32 v44, s24
    v_mfma_f32_16x16x32_bf16 v[108:111], v[0:3], v[176:179], 0
    v_mov_b32 v21, s25
    v_mov_b32 v45, s25
    v_mfma_f32_16x16x32_bf16 v[104:107], v[4:7], v[164:167], v[104:107]
    v_cvt_pk_bf16_f32 v96, v96, v97
    v_mov_b32 v22, s26
    v_mov_b32 v46, s26
    v_mfma_f32_16x16x32_bf16 v[108:111], v[4:7], v[180:183], v[108:111]
    v_cvt_pk_bf16_f32 v97, v98, v99
    v_mov_b32 v23, s27
    v_mov_b32 v47, s27
    v_mfma_f32_16x16x32_bf16 v[104:107], v[8:11], v[168:171], v[104:107]
    ds_write_b64 v70, v[96:97] offset:32768
    v_mov_b32 v24, s24
    v_mov_b32 v48, s24
    v_mfma_f32_16x16x32_bf16 v[108:111], v[8:11], v[184:187], v[108:111]
    v_cvt_pk_bf16_f32 v100, v100, v101
    v_mov_b32 v25, s25
    v_mov_b32 v49, s25
    v_mfma_f32_16x16x32_bf16 v[104:107], v[12:15], v[172:175], v[104:107]
    v_cvt_pk_bf16_f32 v101, v102, v103
    v_mov_b32 v26, s26
    v_mov_b32 v50, s26
    v_mfma_f32_16x16x32_bf16 v[108:111], v[12:15], v[188:191], v[108:111]
    ds_write_b64 v70, v[100:101] offset:32896
    v_mov_b32 v27, s27
    v_mov_b32 v51, s27
    v_mfma_f32_16x16x32_bf16 v[88:91], v[0:3], v[192:195], 0
    v_mov_b32 v28, s24
    v_mov_b32 v52, s24
    v_mfma_f32_16x16x32_bf16 v[92:95], v[0:3], v[208:211], 0
    v_mov_b32 v29, s25
    v_mov_b32 v53, s25
    v_mfma_f32_16x16x32_bf16 v[88:91], v[4:7], v[196:199], v[88:91]
    v_cvt_pk_bf16_f32 v104, v104, v105
    v_mov_b32 v30, s26
    v_mov_b32 v54, s26
    v_mfma_f32_16x16x32_bf16 v[92:95], v[4:7], v[212:215], v[92:95]
    v_cvt_pk_bf16_f32 v105, v106, v107
    v_mov_b32 v31, s27
    v_mov_b32 v55, s27
    v_mfma_f32_16x16x32_bf16 v[88:91], v[8:11], v[200:203], v[88:91]
    ds_write_b64 v70, v[104:105] offset:33024
    v_mov_b32 v32, s24
    v_mov_b32 v56, s24
    v_mfma_f32_16x16x32_bf16 v[92:95], v[8:11], v[216:219], v[92:95]
    v_cvt_pk_bf16_f32 v108, v108, v109
    v_mov_b32 v33, s25
    v_mov_b32 v57, s25
    v_mfma_f32_16x16x32_bf16 v[88:91], v[12:15], v[204:207], v[88:91]
    v_cvt_pk_bf16_f32 v109, v110, v111
    v_mov_b32 v34, s26
    v_mov_b32 v58, s26
    v_mfma_f32_16x16x32_bf16 v[92:95], v[12:15], v[220:223], v[92:95]
    ds_write_b64 v70, v[108:109] offset:33152
    v_mov_b32 v35, s27
    v_mov_b32 v59, s27
    v_mfma_f32_16x16x32_bf16 v[96:99], v[0:3], v[224:227], 0
    v_mov_b32 v36, s24
    v_mov_b32 v60, s24
    v_mfma_f32_16x16x32_bf16 v[100:103], v[0:3], v[240:243], 0
    v_mov_b32 v37, s25
    v_mov_b32 v61, s25
    v_mfma_f32_16x16x32_bf16 v[96:99], v[4:7], v[228:231], v[96:99]
    v_cvt_pk_bf16_f32 v88, v88, v89
    v_mov_b32 v38, s26
    v_mov_b32 v62, s26
    v_mfma_f32_16x16x32_bf16 v[100:103], v[4:7], v[244:247], v[100:103]
    v_cvt_pk_bf16_f32 v89, v90, v91
    v_mov_b32 v39, s27
    v_mov_b32 v63, s27
    v_mfma_f32_16x16x32_bf16 v[96:99], v[8:11], v[232:235], v[96:99]
    ds_write_b64 v70, v[88:89] offset:33280
    s_nop 0
    v_mfma_f32_16x16x32_bf16 v[100:103], v[8:11], v[248:251], v[100:103]
    v_cvt_pk_bf16_f32 v92, v92, v93
    s_nop 0
    v_mfma_f32_16x16x32_bf16 v[96:99], v[12:15], v[236:239], v[96:99]
    v_cvt_pk_bf16_f32 v93, v94, v95
    s_nop 0
    v_mfma_f32_16x16x32_bf16 v[100:103], v[12:15], v[252:255], v[100:103]
    ds_write_b64 v70, v[92:93] offset:33408
    s_nop 0
    v_mov_b32 v0, s24
    v_mov_b32 v1, s25
    v_mov_b32 v2, s26
    v_mov_b32 v3, s27
    v_mov_b32 v4, s24
    v_mov_b32 v5, s25
    v_mov_b32 v6, s26
    v_mov_b32 v7, s27
    v_mov_b32 v8, s24
    v_mov_b32 v9, s25
    v_mov_b32 v10, s26
    v_mov_b32 v11, s27
    v_mov_b32 v12, s24
    v_mov_b32 v13, s25
    v_mov_b32 v14, s26
    v_mov_b32 v15, s27
    s_nop 7
    v_cvt_pk_bf16_f32 v96, v96, v97
    v_cvt_pk_bf16_f32 v97, v98, v99
    ds_write_b64 v70, v[96:97] offset:33536
    v_cvt_pk_bf16_f32 v100, v100, v101
    v_cvt_pk_bf16_f32 v101, v102, v103
    ds_write_b64 v70, v[100:101] offset:33664
    v_add_u32 v70, 0x10000, v70
    s_branch k1_kernel_k2j
k1_kernel_k2m:
    buffer_load_dwordx4 v[0:3], v69, s[12:15], s21 offen offset:0
    buffer_load_dwordx4 v[4:7], v69, s[12:15], s21 offen offset:1024
    buffer_load_dwordx4 v[8:11], v69, s[12:15], s19 offen offset:0
    buffer_load_dwordx4 v[12:15], v69, s[12:15], s19 offen offset:1024
    s_add_u32 s21, s21, 4096
    s_add_u32 s19, s19, 4096
    buffer_load_dwordx4 v[16:19], v69, s[12:15], s21 offen offset:0
    buffer_load_dwordx4 v[20:23], v69, s[12:15], s21 offen offset:1024
    buffer_load_dwordx4 v[24:27], v69, s[12:15], s19 offen offset:0
    buffer_load_dwordx4 v[28:31], v69, s[12:15], s19 offen offset:1024
    s_add_u32 s21, s21, 4096
    s_add_u32 s19, s19, 4096
    s_mov_b32 s44, s21
    s_mov_b32 s45, s19
    s_add_u32 s21, s21, 4096
    s_add_u32 s19, s19, 4096
    buffer_load_dwordx4 v[72:75], v69, s[12:15], s21 offen offset:0
    buffer_load_dwordx4 v[76:79], v69, s[12:15], s21 offen offset:1024
    buffer_load_dwordx4 v[80:83], v69, s[12:15], s19 offen offset:0
    buffer_load_dwordx4 v[84:87], v69, s[12:15], s19 offen offset:1024
    s_add_u32 s21, s21, 4096
    s_add_u32 s19, s19, 4096
    buffer_load_dwordx4 v[116:119], v69, s[12:15], s20 offen offset:0 sc1
    buffer_load_dwordx4 v[120:123], v69, s[12:15], s20 offen offset:1024 sc1
    buffer_load_dwordx4 v[124:127], v69, s[12:15], s20 offen offset:2048 sc1
    buffer_load_dwordx4 v[32:35], v69, s[12:15], s44 offen offset:0
    buffer_load_dwordx4 v[36:39], v69, s[12:15], s44 offen offset:1024
    buffer_load_dwordx4 v[40:43], v69, s[12:15], s45 offen offset:0
    buffer_load_dwordx4 v[44:47], v69, s[12:15], s45 offen offset:1024
    s_mov_b32 exec_lo, 0x00ff00ff
    s_mov_b32 exec_hi, 0x00ff00ff
    buffer_store_dword v112, v113, s[12:15], s74 offen sc1
    s_mov_b64 exec, -1
    s_waitcnt lgkmcnt(0)
    s_barrier
    ds_read_b128 v[136:139], v71 offset:0
    ds_read_b128 v[140:143], v71 offset:1024
    ds_read_b128 v[152:155], v71 offset:2048
    ds_read_b128 v[156:159], v71 offset:3072
    ds_read_b128 v[168:171], v71 offset:4096
    ds_read_b128 v[172:175], v71 offset:5120
    ds_read_b128 v[184:187], v71 offset:6144
    ds_read_b128 v[188:191], v71 offset:7168
    ds_read_b128 v[200:203], v71 offset:8192
    ds_read_b128 v[204:207], v71 offset:9216
    ds_read_b128 v[216:219], v71 offset:10240
    ds_read_b128 v[220:223], v71 offset:11264
    ds_read_b128 v[232:235], v71 offset:12288
    ds_read_b128 v[236:239], v71 offset:13312
    ds_read_b128 v[248:251], v71 offset:14336
    ds_read_b128 v[252:255], v71 offset:15360
    s_waitcnt vmcnt(16)
    v_mfma_f32_16x16x32_bf16 v[48:51], v[0:3], v[128:131], 0
    v_mfma_f32_16x16x32_bf16 v[52:55], v[0:3], v[144:147], 0
    v_mfma_f32_16x16x32_bf16 v[56:59], v[0:3], v[160:163], 0
    v_mfma_f32_16x16x32_bf16 v[60:63], v[0:3], v[176:179], 0
    v_mfma_f32_16x16x32_bf16 v[88:91], v[0:3], v[192:195], 0
    v_mfma_f32_16x16x32_bf16 v[92:95], v[0:3], v[208:211], 0
    v_mfma_f32_16x16x32_bf16 v[96:99], v[0:3], v[224:227], 0
    v_mfma_f32_16x16x32_bf16 v[100:103], v[0:3], v[240:243], 0
    v_mfma_f32_16x16x32_bf16 v[48:51], v[4:7], v[132:135], v[48:51]
    v_mfma_f32_16x16x32_bf16 v[52:55], v[4:7], v[148:151], v[52:55]
    v_mfma_f32_16x16x32_bf16 v[56:59], v[4:7], v[164:167], v[56:59]
    v_mfma_f32_16x16x32_bf16 v[60:63], v[4:7], v[180:183], v[60:63]
    v_mfma_f32_16x16x32_bf16 v[88:91], v[4:7], v[196:199], v[88:91]
    v_mfma_f32_16x16x32_bf16 v[92:95], v[4:7], v[212:215], v[92:95]
    v_mfma_f32_16x16x32_bf16 v[96:99], v[4:7], v[228:231], v[96:99]
    v_mfma_f32_16x16x32_bf16 v[100:103], v[4:7], v[244:247], v[100:103]

    s_lshl_b32 s24, s36, 16
    s_and_b32 s25, s36, 0xffff0000
    s_lshl_b32 s26, s37, 16
    s_and_b32 s27, s37, 0xffff0000

    s_waitcnt lgkmcnt(12)
    v_mfma_f32_16x16x32_bf16 v[48:51], v[8:11], v[136:139], v[48:51]
    v_mfma_f32_16x16x32_bf16 v[52:55], v[8:11], v[152:155], v[52:55]
    v_mfma_f32_16x16x32_bf16 v[48:51], v[12:15], v[140:143], v[48:51]
    v_mfma_f32_16x16x32_bf16 v[52:55], v[12:15], v[156:159], v[52:55]
    s_waitcnt lgkmcnt(8)
    v_mfma_f32_16x16x32_bf16 v[56:59], v[8:11], v[168:171], v[56:59]
    v_mfma_f32_16x16x32_bf16 v[60:63], v[8:11], v[184:187], v[60:63]
    v_mfma_f32_16x16x32_bf16 v[56:59], v[12:15], v[172:175], v[56:59]
    v_mfma_f32_16x16x32_bf16 v[60:63], v[12:15], v[188:191], v[60:63]
    s_waitcnt lgkmcnt(4)
    v_mfma_f32_16x16x32_bf16 v[88:91], v[8:11], v[200:203], v[88:91]
    v_mfma_f32_16x16x32_bf16 v[92:95], v[8:11], v[216:219], v[92:95]
    v_mfma_f32_16x16x32_bf16 v[88:91], v[12:15], v[204:207], v[88:91]
    v_mfma_f32_16x16x32_bf16 v[92:95], v[12:15], v[220:223], v[92:95]
    v_cvt_pk_bf16_f32 v48, v48, v49
    v_cvt_pk_bf16_f32 v49, v50, v51
    ds_write_b64 v70, v[48:49] offset:0
    v_cvt_pk_bf16_f32 v52, v52, v53
    v_cvt_pk_bf16_f32 v53, v54, v55
    ds_write_b64 v70, v[52:53] offset:128
    s_waitcnt lgkmcnt(2)
    v_mfma_f32_16x16x32_bf16 v[96:99], v[8:11], v[232:235], v[96:99]
    v_mfma_f32_16x16x32_bf16 v[100:103], v[8:11], v[248:251], v[100:103]
    v_mfma_f32_16x16x32_bf16 v[96:99], v[12:15], v[236:239], v[96:99]
    v_mfma_f32_16x16x32_bf16 v[100:103], v[12:15], v[252:255], v[100:103]
    v_cvt_pk_bf16_f32 v56, v56, v57
    v_cvt_pk_bf16_f32 v57, v58, v59
    ds_write_b64 v70, v[56:57] offset:256
    v_cvt_pk_bf16_f32 v60, v60, v61
    v_cvt_pk_bf16_f32 v61, v62, v63
    ds_write_b64 v70, v[60:61] offset:384
    s_nop 3
    v_cvt_pk_bf16_f32 v88, v88, v89
    v_cvt_pk_bf16_f32 v89, v90, v91
    ds_write_b64 v70, v[88:89] offset:512
    v_cvt_pk_bf16_f32 v92, v92, v93
    v_cvt_pk_bf16_f32 v93, v94, v95
    ds_write_b64 v70, v[92:93] offset:640
    s_nop 3
    v_cvt_pk_bf16_f32 v96, v96, v97
    v_cvt_pk_bf16_f32 v97, v98, v99
    ds_write_b64 v70, v[96:97] offset:768
    v_cvt_pk_bf16_f32 v100, v100, v101
    v_cvt_pk_bf16_f32 v101, v102, v103
    ds_write_b64 v70, v[100:101] offset:896
    v_add_u32 v70, 0x8000, v70
    s_waitcnt vmcnt(12)
    v_mfma_f32_16x16x32_bf16 v[104:107], v[16:19], v[128:131], 0
    v_mfma_f32_16x16x32_bf16 v[108:111], v[16:19], v[144:147], 0
    v_mfma_f32_16x16x32_bf16 v[104:107], v[20:23], v[132:135], v[104:107]
    v_mfma_f32_16x16x32_bf16 v[108:111], v[20:23], v[148:151], v[108:111]
    v_mfma_f32_16x16x32_bf16 v[104:107], v[24:27], v[136:139], v[104:107]
    v_mov_b32 v48, s24
    v_mfma_f32_16x16x32_bf16 v[108:111], v[24:27], v[152:155], v[108:111]
    v_mov_b32 v49, s25
    v_mfma_f32_16x16x32_bf16 v[104:107], v[28:31], v[140:143], v[104:107]
    v_mov_b32 v50, s26
    v_mfma_f32_16x16x32_bf16 v[108:111], v[28:31], v[156:159], v[108:111]
    v_mov_b32 v51, s27
    v_mfma_f32_16x16x32_bf16 v[88:91], v[16:19], v[160:163], 0
    v_mov_b32 v52, s24
    v_mfma_f32_16x16x32_bf16 v[92:95], v[16:19], v[176:179], 0
    v_mov_b32 v53, s25
    v_mfma_f32_16x16x32_bf16 v[88:91], v[20:23], v[164:167], v[88:91]
    v_cvt_pk_bf16_f32 v104, v104, v105
    v_mov_b32 v54, s26
    v_mfma_f32_16x16x32_bf16 v[92:95], v[20:23], v[180:183], v[92:95]
    v_cvt_pk_bf16_f32 v105, v106, v107
    v_mov_b32 v55, s27
    v_mfma_f32_16x16x32_bf16 v[88:91], v[24:27], v[168:171], v[88:91]
    ds_write_b64 v70, v[104:105] offset:0
    v_mov_b32 v56, s24
    v_mfma_f32_16x16x32_bf16 v[92:95], v[24:27], v[184:187], v[92:95]
    v_cvt_pk_bf16_f32 v108, v108, v109
    v_mov_b32 v57, s25
    v_mfma_f32_16x16x32_bf16 v[88:91], v[28:31], v[172:175], v[88:91]
    v_cvt_pk_bf16_f32 v109, v110, v111
    v_mov_b32 v58, s26
    v_mfma_f32_16x16x32_bf16 v[92:95], v[28:31], v[188:191], v[92:95]
    ds_write_b64 v70, v[108:109] offset:128
    v_mov_b32 v59, s27
    v_mfma_f32_16x16x32_bf16 v[96:99], v[16:19], v[192:195], 0
    v_mov_b32 v60, s24
    v_mfma_f32_16x16x32_bf16 v[100:103], v[16:19], v[208:211], 0
    v_mov_b32 v61, s25
    v_mfma_f32_16x16x32_bf16 v[96:99], v[20:23], v[196:199], v[96:99]
    v_cvt_pk_bf16_f32 v88, v88, v89
    v_mov_b32 v62, s26
    v_mfma_f32_16x16x32_bf16 v[100:103], v[20:23], v[212:215], v[100:103]
    v_cvt_pk_bf16_f32 v89, v90, v91
    v_mov_b32 v63, s27
    v_mfma_f32_16x16x32_bf16 v[96:99], v[24:27], v[200:203], v[96:99]
    ds_write_b64 v70, v[88:89] offset:256
    v_mov_b32 v0, s24
    v_mfma_f32_16x16x32_bf16 v[100:103], v[24:27], v[216:219], v[100:103]
    v_cvt_pk_bf16_f32 v92, v92, v93
    v_mov_b32 v1, s25
    v_mfma_f32_16x16x32_bf16 v[96:99], v[28:31], v[204:207], v[96:99]
    v_cvt_pk_bf16_f32 v93, v94, v95
    v_mov_b32 v2, s26
    v_mfma_f32_16x16x32_bf16 v[100:103], v[28:31], v[220:223], v[100:103]
    ds_write_b64 v70, v[92:93] offset:384
    v_mov_b32 v3, s27
    v_mfma_f32_16x16x32_bf16 v[104:107], v[16:19], v[224:227], 0
    v_mov_b32 v4, s24
    v_mfma_f32_16x16x32_bf16 v[108:111], v[16:19], v[240:243], 0
    v_mov_b32 v5, s25
    v_mfma_f32_16x16x32_bf16 v[104:107], v[20:23], v[228:231], v[104:107]
    v_cvt_pk_bf16_f32 v96, v96, v97
    v_mov_b32 v6, s26
    v_mfma_f32_16x16x32_bf16 v[108:111], v[20:23], v[244:247], v[108:111]
    v_cvt_pk_bf16_f32 v97, v98, v99
    v_mov_b32 v7, s27
    v_mfma_f32_16x16x32_bf16 v[104:107], v[24:27], v[232:235], v[104:107]
    ds_write_b64 v70, v[96:97] offset:512
    v_mov_b32 v8, s24
    v_mfma_f32_16x16x32_bf16 v[108:111], v[24:27], v[248:251], v[108:111]
    v_cvt_pk_bf16_f32 v100, v100, v101
    v_mov_b32 v9, s25
    v_mfma_f32_16x16x32_bf16 v[104:107], v[28:31], v[236:239], v[104:107]
    v_cvt_pk_bf16_f32 v101, v102, v103
    v_mov_b32 v10, s26
    v_mfma_f32_16x16x32_bf16 v[108:111], v[28:31], v[252:255], v[108:111]
    ds_write_b64 v70, v[100:101] offset:640
    v_mov_b32 v11, s27
    s_waitcnt vmcnt(1)
    v_mfma_f32_16x16x32_bf16 v[88:91], v[32:35], v[128:131], 0
    v_mfma_f32_16x16x32_bf16 v[92:95], v[32:35], v[144:147], 0
    v_mfma_f32_16x16x32_bf16 v[88:91], v[36:39], v[132:135], v[88:91]
    v_cvt_pk_bf16_f32 v104, v104, v105
    v_mfma_f32_16x16x32_bf16 v[92:95], v[36:39], v[148:151], v[92:95]
    v_cvt_pk_bf16_f32 v105, v106, v107
    v_mfma_f32_16x16x32_bf16 v[88:91], v[40:43], v[136:139], v[88:91]
    ds_write_b64 v70, v[104:105] offset:768
    v_mov_b32 v12, s24
    v_mfma_f32_16x16x32_bf16 v[92:95], v[40:43], v[152:155], v[92:95]
    v_cvt_pk_bf16_f32 v108, v108, v109
    v_mov_b32 v13, s25
    v_mfma_f32_16x16x32_bf16 v[88:91], v[44:47], v[140:143], v[88:91]
    v_cvt_pk_bf16_f32 v109, v110, v111
    v_mov_b32 v14, s26
    v_mfma_f32_16x16x32_bf16 v[92:95], v[44:47], v[156:159], v[92:95]
    ds_write_b64 v70, v[108:109] offset:896
    v_mov_b32 v15, s27
    v_mfma_f32_16x16x32_bf16 v[96:99], v[32:35], v[160:163], 0
    v_mov_b32 v16, s24
    v_mfma_f32_16x16x32_bf16 v[100:103], v[32:35], v[176:179], 0
    v_mov_b32 v17, s25
    v_mfma_f32_16x16x32_bf16 v[96:99], v[36:39], v[164:167], v[96:99]
    v_cvt_pk_bf16_f32 v88, v88, v89
    v_mov_b32 v18, s26
    v_mfma_f32_16x16x32_bf16 v[100:103], v[36:39], v[180:183], v[100:103]
    v_cvt_pk_bf16_f32 v89, v90, v91
    v_mov_b32 v19, s27
    v_mfma_f32_16x16x32_bf16 v[96:99], v[40:43], v[168:171], v[96:99]
    ds_write_b64 v70, v[88:89] offset:32768
    v_mov_b32 v20, s24
    v_mfma_f32_16x16x32_bf16 v[100:103], v[40:43], v[184:187], v[100:103]
    v_cvt_pk_bf16_f32 v92, v92, v93
    v_mov_b32 v21, s25
    v_mfma_f32_16x16x32_bf16 v[96:99], v[44:47], v[172:175], v[96:99]
    v_cvt_pk_bf16_f32 v93, v94, v95
    v_mov_b32 v22, s26
    v_mfma_f32_16x16x32_bf16 v[100:103], v[44:47], v[188:191], v[100:103]
    ds_write_b64 v70, v[92:93] offset:32896
    v_mov_b32 v23, s27
    v_mfma_f32_16x16x32_bf16 v[104:107], v[32:35], v[192:195], 0
    v_mov_b32 v24, s24
    v_mfma_f32_16x16x32_bf16 v[108:111], v[32:35], v[208:211], 0
    v_mov_b32 v25, s25
    v_mfma_f32_16x16x32_bf16 v[104:107], v[36:39], v[196:199], v[104:107]
    v_cvt_pk_bf16_f32 v96, v96, v97
    v_mov_b32 v26, s26
    v_mfma_f32_16x16x32_bf16 v[108:111], v[36:39], v[212:215], v[108:111]
    v_cvt_pk_bf16_f32 v97, v98, v99
    v_mov_b32 v27, s27
    v_mfma_f32_16x16x32_bf16 v[104:107], v[40:43], v[200:203], v[104:107]
    ds_write_b64 v70, v[96:97] offset:33024
    v_mov_b32 v28, s24
    v_mfma_f32_16x16x32_bf16 v[108:111], v[40:43], v[216:219], v[108:111]
    v_cvt_pk_bf16_f32 v100, v100, v101
    v_mov_b32 v29, s25
    v_mfma_f32_16x16x32_bf16 v[104:107], v[44:47], v[204:207], v[104:107]
    v_cvt_pk_bf16_f32 v101, v102, v103
    v_mov_b32 v30, s26
    v_mfma_f32_16x16x32_bf16 v[108:111], v[44:47], v[220:223], v[108:111]
    ds_write_b64 v70, v[100:101] offset:33152
    v_mov_b32 v31, s27
    v_mfma_f32_16x16x32_bf16 v[88:91], v[32:35], v[224:227], 0
    s_nop 0
    v_mfma_f32_16x16x32_bf16 v[92:95], v[32:35], v[240:243], 0
    s_nop 0
    v_mfma_f32_16x16x32_bf16 v[88:91], v[36:39], v[228:231], v[88:91]
    v_cvt_pk_bf16_f32 v104, v104, v105
    s_nop 0
    v_mfma_f32_16x16x32_bf16 v[92:95], v[36:39], v[244:247], v[92:95]
    v_cvt_pk_bf16_f32 v105, v106, v107
    s_nop 0
    v_mfma_f32_16x16x32_bf16 v[88:91], v[40:43], v[232:235], v[88:91]
    ds_write_b64 v70, v[104:105] offset:33280
    s_nop 0
    v_mfma_f32_16x16x32_bf16 v[92:95], v[40:43], v[248:251], v[92:95]
    v_cvt_pk_bf16_f32 v108, v108, v109
    s_nop 0
    v_mfma_f32_16x16x32_bf16 v[88:91], v[44:47], v[236:239], v[88:91]
    v_cvt_pk_bf16_f32 v109, v110, v111
    s_nop 0
    v_mfma_f32_16x16x32_bf16 v[92:95], v[44:47], v[252:255], v[92:95]
    ds_write_b64 v70, v[108:109] offset:33408
    s_nop 0
    v_mov_b32 v32, s24
    v_mov_b32 v33, s25
    v_mov_b32 v34, s26
    v_mov_b32 v35, s27
    v_mov_b32 v36, s24
    v_mov_b32 v37, s25
    v_mov_b32 v38, s26
    v_mov_b32 v39, s27
    v_mov_b32 v40, s24
    v_mov_b32 v41, s25
    v_mov_b32 v42, s26
    v_mov_b32 v43, s27
    v_mov_b32 v44, s24
    v_mov_b32 v45, s25
    v_mov_b32 v46, s26
    v_mov_b32 v47, s27
    s_nop 7
    v_cvt_pk_bf16_f32 v88, v88, v89
    v_cvt_pk_bf16_f32 v89, v90, v91
    ds_write_b64 v70, v[88:89] offset:33536
    v_cvt_pk_bf16_f32 v92, v92, v93
    v_cvt_pk_bf16_f32 v93, v94, v95
    ds_write_b64 v70, v[92:93] offset:33664
    v_add_u32 v70, 0x10000, v70
k1_kernel_k2j:

    s_mov_b32 s22, 0
    s_mov_b32 s23, 3
    s_waitcnt lgkmcnt(0)
    s_barrier

    v_lshlrev_b32_sdwa v88, 3, v116 dst_sel:DWORD dst_unused:UNUSED_PAD src0_sel:DWORD src1_sel:WORD_0
    v_lshlrev_b32_sdwa v90, 3, v116 dst_sel:DWORD dst_unused:UNUSED_PAD src0_sel:DWORD src1_sel:WORD_1
    v_lshlrev_b32_sdwa v92, 3, v117 dst_sel:DWORD dst_unused:UNUSED_PAD src0_sel:DWORD src1_sel:WORD_0
    v_lshlrev_b32_sdwa v94, 3, v117 dst_sel:DWORD dst_unused:UNUSED_PAD src0_sel:DWORD src1_sel:WORD_1
    ds_read_b64 v[88:89], v88
    ds_read_b64 v[90:91], v90
    ds_read_b64 v[92:93], v92
    ds_read_b64 v[94:95], v94
    v_lshlrev_b32_sdwa v96, 3, v118 dst_sel:DWORD dst_unused:UNUSED_PAD src0_sel:DWORD src1_sel:WORD_0
    v_lshlrev_b32_sdwa v98, 3, v118 dst_sel:DWORD dst_unused:UNUSED_PAD src0_sel:DWORD src1_sel:WORD_1
    v_lshlrev_b32_sdwa v100, 3, v119 dst_sel:DWORD dst_unused:UNUSED_PAD src0_sel:DWORD src1_sel:WORD_0
    v_lshlrev_b32_sdwa v102, 3, v119 dst_sel:DWORD dst_unused:UNUSED_PAD src0_sel:DWORD src1_sel:WORD_1
    ds_read_b64 v[96:97], v96
    ds_read_b64 v[98:99], v98
    ds_read_b64 v[100:101], v100
    ds_read_b64 v[102:103], v102
    buffer_load_dwordx4 v[116:119], v69, s[12:15], s20 offen offset:3072 sc1
    s_add_u32 s20, s20, 4096
k1_kernel_gloop:
    s_setprio 3
    s_waitcnt vmcnt(6)
    v_lshlrev_b32_sdwa v104, 3, v120 dst_sel:DWORD dst_unused:UNUSED_PAD src0_sel:DWORD src1_sel:WORD_0
    v_lshlrev_b32_sdwa v106, 3, v120 dst_sel:DWORD dst_unused:UNUSED_PAD src0_sel:DWORD src1_sel:WORD_1
    ds_read_b64 v[104:105], v104
    ds_read_b64 v[106:107], v106
    v_lshlrev_b32_sdwa v108, 3, v121 dst_sel:DWORD dst_unused:UNUSED_PAD src0_sel:DWORD src1_sel:WORD_0
    v_lshlrev_b32_sdwa v110, 3, v121 dst_sel:DWORD dst_unused:UNUSED_PAD src0_sel:DWORD src1_sel:WORD_1
    ds_read_b64 v[108:109], v108
    ds_read_b64 v[110:111], v110
    s_waitcnt lgkmcnt(8)
    v_smfmac_f32_16x16x64_bf16 v[0:3], v[64:67], v[88:95], v68
    s_waitcnt vmcnt(5)
    v_mfma_f32_16x16x32_bf16 v[112:115], v[72:75], v[128:131], 0
    v_lshlrev_b32_sdwa v88, 3, v122 dst_sel:DWORD dst_unused:UNUSED_PAD src0_sel:DWORD src1_sel:WORD_0
    v_lshlrev_b32_sdwa v90, 3, v122 dst_sel:DWORD dst_unused:UNUSED_PAD src0_sel:DWORD src1_sel:WORD_1
    ds_read_b64 v[88:89], v88
    ds_read_b64 v[90:91], v90
    s_waitcnt vmcnt(4)
    v_mfma_f32_16x16x32_bf16 v[112:115], v[76:79], v[132:135], v[112:115]
    v_lshlrev_b32_sdwa v92, 3, v123 dst_sel:DWORD dst_unused:UNUSED_PAD src0_sel:DWORD src1_sel:WORD_0
    v_lshlrev_b32_sdwa v94, 3, v123 dst_sel:DWORD dst_unused:UNUSED_PAD src0_sel:DWORD src1_sel:WORD_1
    ds_read_b64 v[92:93], v92
    ds_read_b64 v[94:95], v94
    buffer_load_dwordx4 v[120:123], v69, s[12:15], s20 offen offset:0 sc1
    s_waitcnt lgkmcnt(8)
    v_smfmac_f32_16x16x64_bf16 v[4:7], v[64:67], v[96:103], v68
    s_waitcnt vmcnt(4)
    v_mfma_f32_16x16x32_bf16 v[112:115], v[80:83], v[136:139], v[112:115]
    s_waitcnt vmcnt(2)
    v_lshlrev_b32_sdwa v96, 3, v124 dst_sel:DWORD dst_unused:UNUSED_PAD src0_sel:DWORD src1_sel:WORD_0
    v_lshlrev_b32_sdwa v98, 3, v124 dst_sel:DWORD dst_unused:UNUSED_PAD src0_sel:DWORD src1_sel:WORD_1
    ds_read_b64 v[96:97], v96
    ds_read_b64 v[98:99], v98
    s_waitcnt vmcnt(3)
    v_mfma_f32_16x16x32_bf16 v[112:115], v[84:87], v[140:143], v[112:115]
    v_lshlrev_b32_sdwa v100, 3, v125 dst_sel:DWORD dst_unused:UNUSED_PAD src0_sel:DWORD src1_sel:WORD_0
    v_lshlrev_b32_sdwa v102, 3, v125 dst_sel:DWORD dst_unused:UNUSED_PAD src0_sel:DWORD src1_sel:WORD_1
    ds_read_b64 v[100:101], v100
    ds_read_b64 v[102:103], v102
    s_waitcnt lgkmcnt(8)
    v_smfmac_f32_16x16x64_bf16 v[8:11], v[64:67], v[104:111], v68
    s_nop 1
    v_cvt_pk_bf16_f32 v112, v112, v113
    v_cvt_pk_bf16_f32 v113, v114, v115
    ds_write_b64 v70, v[112:113] offset:0
    v_mfma_f32_16x16x32_bf16 v[112:115], v[72:75], v[144:147], 0
    v_mfma_f32_16x16x32_bf16 v[112:115], v[76:79], v[148:151], v[112:115]
    v_lshlrev_b32_sdwa v104, 3, v126 dst_sel:DWORD dst_unused:UNUSED_PAD src0_sel:DWORD src1_sel:WORD_0
    v_lshlrev_b32_sdwa v106, 3, v126 dst_sel:DWORD dst_unused:UNUSED_PAD src0_sel:DWORD src1_sel:WORD_1
    ds_read_b64 v[104:105], v104
    ds_read_b64 v[106:107], v106
    v_mfma_f32_16x16x32_bf16 v[112:115], v[80:83], v[152:155], v[112:115]
    v_mfma_f32_16x16x32_bf16 v[112:115], v[84:87], v[156:159], v[112:115]
    v_lshlrev_b32_sdwa v108, 3, v127 dst_sel:DWORD dst_unused:UNUSED_PAD src0_sel:DWORD src1_sel:WORD_0
    v_lshlrev_b32_sdwa v110, 3, v127 dst_sel:DWORD dst_unused:UNUSED_PAD src0_sel:DWORD src1_sel:WORD_1
    ds_read_b64 v[108:109], v108
    ds_read_b64 v[110:111], v110
    buffer_load_dwordx4 v[124:127], v69, s[12:15], s20 offen offset:1024 sc1
    s_waitcnt lgkmcnt(9)
    v_smfmac_f32_16x16x64_bf16 v[12:15], v[64:67], v[88:95], v68
    s_nop 0
    v_cvt_pk_bf16_f32 v112, v112, v113
    v_cvt_pk_bf16_f32 v113, v114, v115
    ds_write_b64 v70, v[112:113] offset:128
    v_mfma_f32_16x16x32_bf16 v[112:115], v[72:75], v[160:163], 0
    s_waitcnt vmcnt(2)
    v_lshlrev_b32_sdwa v88, 3, v116 dst_sel:DWORD dst_unused:UNUSED_PAD src0_sel:DWORD src1_sel:WORD_0
    v_lshlrev_b32_sdwa v90, 3, v116 dst_sel:DWORD dst_unused:UNUSED_PAD src0_sel:DWORD src1_sel:WORD_1
    ds_read_b64 v[88:89], v88
    ds_read_b64 v[90:91], v90
    v_mfma_f32_16x16x32_bf16 v[112:115], v[76:79], v[164:167], v[112:115]
    v_lshlrev_b32_sdwa v92, 3, v117 dst_sel:DWORD dst_unused:UNUSED_PAD src0_sel:DWORD src1_sel:WORD_0
    v_lshlrev_b32_sdwa v94, 3, v117 dst_sel:DWORD dst_unused:UNUSED_PAD src0_sel:DWORD src1_sel:WORD_1
    ds_read_b64 v[92:93], v92
    ds_read_b64 v[94:95], v94
    s_waitcnt lgkmcnt(10)
    v_smfmac_f32_16x16x64_bf16 v[16:19], v[64:67], v[96:103], v68
    v_mfma_f32_16x16x32_bf16 v[112:115], v[80:83], v[168:171], v[112:115]
    v_lshlrev_b32_sdwa v96, 3, v118 dst_sel:DWORD dst_unused:UNUSED_PAD src0_sel:DWORD src1_sel:WORD_0
    v_lshlrev_b32_sdwa v98, 3, v118 dst_sel:DWORD dst_unused:UNUSED_PAD src0_sel:DWORD src1_sel:WORD_1
    ds_read_b64 v[96:97], v96
    ds_read_b64 v[98:99], v98
    v_mfma_f32_16x16x32_bf16 v[112:115], v[84:87], v[172:175], v[112:115]
    v_lshlrev_b32_sdwa v100, 3, v119 dst_sel:DWORD dst_unused:UNUSED_PAD src0_sel:DWORD src1_sel:WORD_0
    v_lshlrev_b32_sdwa v102, 3, v119 dst_sel:DWORD dst_unused:UNUSED_PAD src0_sel:DWORD src1_sel:WORD_1
    ds_read_b64 v[100:101], v100
    ds_read_b64 v[102:103], v102
    buffer_load_dwordx4 v[116:119], v69, s[12:15], s20 offen offset:2048 sc1
    s_waitcnt lgkmcnt(9)
    v_smfmac_f32_16x16x64_bf16 v[20:23], v[64:67], v[104:111], v68
    s_nop 0
    v_cvt_pk_bf16_f32 v112, v112, v113
    v_cvt_pk_bf16_f32 v113, v114, v115
    ds_write_b64 v70, v[112:113] offset:256
    v_mfma_f32_16x16x32_bf16 v[112:115], v[72:75], v[176:179], 0
    v_mfma_f32_16x16x32_bf16 v[112:115], v[76:79], v[180:183], v[112:115]
    s_waitcnt vmcnt(2)
    v_lshlrev_b32_sdwa v104, 3, v120 dst_sel:DWORD dst_unused:UNUSED_PAD src0_sel:DWORD src1_sel:WORD_0
    v_lshlrev_b32_sdwa v106, 3, v120 dst_sel:DWORD dst_unused:UNUSED_PAD src0_sel:DWORD src1_sel:WORD_1
    ds_read_b64 v[104:105], v104
    ds_read_b64 v[106:107], v106
    v_mfma_f32_16x16x32_bf16 v[112:115], v[80:83], v[184:187], v[112:115]
    v_mfma_f32_16x16x32_bf16 v[112:115], v[84:87], v[188:191], v[112:115]
    v_lshlrev_b32_sdwa v108, 3, v121 dst_sel:DWORD dst_unused:UNUSED_PAD src0_sel:DWORD src1_sel:WORD_0
    v_lshlrev_b32_sdwa v110, 3, v121 dst_sel:DWORD dst_unused:UNUSED_PAD src0_sel:DWORD src1_sel:WORD_1
    ds_read_b64 v[108:109], v108
    ds_read_b64 v[110:111], v110
    s_waitcnt lgkmcnt(9)
    v_smfmac_f32_16x16x64_bf16 v[24:27], v[64:67], v[88:95], v68
    s_nop 1
    v_cvt_pk_bf16_f32 v112, v112, v113
    v_cvt_pk_bf16_f32 v113, v114, v115
    ds_write_b64 v70, v[112:113] offset:384
    v_mfma_f32_16x16x32_bf16 v[112:115], v[72:75], v[192:195], 0
    v_lshlrev_b32_sdwa v88, 3, v122 dst_sel:DWORD dst_unused:UNUSED_PAD src0_sel:DWORD src1_sel:WORD_0
    v_lshlrev_b32_sdwa v90, 3, v122 dst_sel:DWORD dst_unused:UNUSED_PAD src0_sel:DWORD src1_sel:WORD_1
    ds_read_b64 v[88:89], v88
    ds_read_b64 v[90:91], v90
    v_mfma_f32_16x16x32_bf16 v[112:115], v[76:79], v[196:199], v[112:115]
    v_lshlrev_b32_sdwa v92, 3, v123 dst_sel:DWORD dst_unused:UNUSED_PAD src0_sel:DWORD src1_sel:WORD_0
    v_lshlrev_b32_sdwa v94, 3, v123 dst_sel:DWORD dst_unused:UNUSED_PAD src0_sel:DWORD src1_sel:WORD_1
    ds_read_b64 v[92:93], v92
    ds_read_b64 v[94:95], v94
    buffer_load_dwordx4 v[120:123], v69, s[12:15], s20 offen offset:3072 sc1
    s_add_u32 s20, s20, 61440
    s_waitcnt lgkmcnt(10)
    v_smfmac_f32_16x16x64_bf16 v[28:31], v[64:67], v[96:103], v68
    s_setprio 2
    v_mfma_f32_16x16x32_bf16 v[112:115], v[80:83], v[200:203], v[112:115]
    s_waitcnt vmcnt(2)
    v_lshlrev_b32_sdwa v96, 3, v124 dst_sel:DWORD dst_unused:UNUSED_PAD src0_sel:DWORD src1_sel:WORD_0
    v_lshlrev_b32_sdwa v98, 3, v124 dst_sel:DWORD dst_unused:UNUSED_PAD src0_sel:DWORD src1_sel:WORD_1
    ds_read_b64 v[96:97], v96
    ds_read_b64 v[98:99], v98
    v_mfma_f32_16x16x32_bf16 v[112:115], v[84:87], v[204:207], v[112:115]
    v_lshlrev_b32_sdwa v100, 3, v125 dst_sel:DWORD dst_unused:UNUSED_PAD src0_sel:DWORD src1_sel:WORD_0
    v_lshlrev_b32_sdwa v102, 3, v125 dst_sel:DWORD dst_unused:UNUSED_PAD src0_sel:DWORD src1_sel:WORD_1
    ds_read_b64 v[100:101], v100
    ds_read_b64 v[102:103], v102
    s_waitcnt lgkmcnt(9)
    v_smfmac_f32_16x16x64_bf16 v[32:35], v[64:67], v[104:111], v68
    s_nop 1
    v_cvt_pk_bf16_f32 v112, v112, v113
    v_cvt_pk_bf16_f32 v113, v114, v115
    ds_write_b64 v70, v[112:113] offset:512
    v_mfma_f32_16x16x32_bf16 v[112:115], v[72:75], v[208:211], 0
    v_lshlrev_b32_sdwa v104, 3, v126 dst_sel:DWORD dst_unused:UNUSED_PAD src0_sel:DWORD src1_sel:WORD_0
    v_lshlrev_b32_sdwa v106, 3, v126 dst_sel:DWORD dst_unused:UNUSED_PAD src0_sel:DWORD src1_sel:WORD_1
    ds_read_b64 v[104:105], v104
    ds_read_b64 v[106:107], v106
    v_mfma_f32_16x16x32_bf16 v[112:115], v[76:79], v[212:215], v[112:115]
    v_lshlrev_b32_sdwa v108, 3, v127 dst_sel:DWORD dst_unused:UNUSED_PAD src0_sel:DWORD src1_sel:WORD_0
    v_lshlrev_b32_sdwa v110, 3, v127 dst_sel:DWORD dst_unused:UNUSED_PAD src0_sel:DWORD src1_sel:WORD_1
    ds_read_b64 v[108:109], v108
    ds_read_b64 v[110:111], v110
    buffer_load_dwordx4 v[124:127], v69, s[12:15], s20 offen offset:0 sc1
    s_waitcnt lgkmcnt(9)
    v_smfmac_f32_16x16x64_bf16 v[36:39], v[64:67], v[88:95], v68
    v_mfma_f32_16x16x32_bf16 v[112:115], v[80:83], v[216:219], v[112:115]
    s_waitcnt vmcnt(2)
    v_lshlrev_b32_sdwa v88, 3, v116 dst_sel:DWORD dst_unused:UNUSED_PAD src0_sel:DWORD src1_sel:WORD_0
    v_lshlrev_b32_sdwa v90, 3, v116 dst_sel:DWORD dst_unused:UNUSED_PAD src0_sel:DWORD src1_sel:WORD_1
    ds_read_b64 v[88:89], v88
    ds_read_b64 v[90:91], v90
    v_mfma_f32_16x16x32_bf16 v[112:115], v[84:87], v[220:223], v[112:115]
    v_lshlrev_b32_sdwa v92, 3, v117 dst_sel:DWORD dst_unused:UNUSED_PAD src0_sel:DWORD src1_sel:WORD_0
    v_lshlrev_b32_sdwa v94, 3, v117 dst_sel:DWORD dst_unused:UNUSED_PAD src0_sel:DWORD src1_sel:WORD_1
    ds_read_b64 v[92:93], v92
    ds_read_b64 v[94:95], v94
    s_waitcnt lgkmcnt(9)
    v_smfmac_f32_16x16x64_bf16 v[40:43], v[64:67], v[96:103], v68
    s_nop 1
    v_cvt_pk_bf16_f32 v112, v112, v113
    v_cvt_pk_bf16_f32 v113, v114, v115
    ds_write_b64 v70, v[112:113] offset:640
    v_mfma_f32_16x16x32_bf16 v[112:115], v[72:75], v[224:227], 0
    v_mfma_f32_16x16x32_bf16 v[112:115], v[76:79], v[228:231], v[112:115]
    v_lshlrev_b32_sdwa v96, 3, v118 dst_sel:DWORD dst_unused:UNUSED_PAD src0_sel:DWORD src1_sel:WORD_0
    v_lshlrev_b32_sdwa v98, 3, v118 dst_sel:DWORD dst_unused:UNUSED_PAD src0_sel:DWORD src1_sel:WORD_1
    ds_read_b64 v[96:97], v96
    ds_read_b64 v[98:99], v98
    v_mfma_f32_16x16x32_bf16 v[112:115], v[80:83], v[232:235], v[112:115]
    v_mfma_f32_16x16x32_bf16 v[112:115], v[84:87], v[236:239], v[112:115]
    v_lshlrev_b32_sdwa v100, 3, v119 dst_sel:DWORD dst_unused:UNUSED_PAD src0_sel:DWORD src1_sel:WORD_0
    v_lshlrev_b32_sdwa v102, 3, v119 dst_sel:DWORD dst_unused:UNUSED_PAD src0_sel:DWORD src1_sel:WORD_1
    ds_read_b64 v[100:101], v100
    ds_read_b64 v[102:103], v102
    buffer_load_dwordx4 v[116:119], v69, s[12:15], s20 offen offset:1024 sc1
    s_waitcnt lgkmcnt(9)
    v_smfmac_f32_16x16x64_bf16 v[44:47], v[64:67], v[104:111], v68
    s_nop 0
    v_cvt_pk_bf16_f32 v112, v112, v113
    v_cvt_pk_bf16_f32 v113, v114, v115
    ds_write_b64 v70, v[112:113] offset:768
    s_setprio 1
    v_mfma_f32_16x16x32_bf16 v[112:115], v[72:75], v[240:243], 0
    buffer_load_dwordx4 v[72:75], v69, s[12:15], s21 offen offset:0
    s_waitcnt vmcnt(3)
    v_lshlrev_b32_sdwa v104, 3, v120 dst_sel:DWORD dst_unused:UNUSED_PAD src0_sel:DWORD src1_sel:WORD_0
    v_lshlrev_b32_sdwa v106, 3, v120 dst_sel:DWORD dst_unused:UNUSED_PAD src0_sel:DWORD src1_sel:WORD_1
    ds_read_b64 v[104:105], v104
    ds_read_b64 v[106:107], v106
    v_mfma_f32_16x16x32_bf16 v[112:115], v[76:79], v[244:247], v[112:115]
    buffer_load_dwordx4 v[76:79], v69, s[12:15], s21 offen offset:1024
    v_lshlrev_b32_sdwa v108, 3, v121 dst_sel:DWORD dst_unused:UNUSED_PAD src0_sel:DWORD src1_sel:WORD_0
    v_lshlrev_b32_sdwa v110, 3, v121 dst_sel:DWORD dst_unused:UNUSED_PAD src0_sel:DWORD src1_sel:WORD_1
    ds_read_b64 v[108:109], v108
    ds_read_b64 v[110:111], v110
    s_waitcnt lgkmcnt(10)
    v_smfmac_f32_16x16x64_bf16 v[48:51], v[64:67], v[88:95], v68
    v_mfma_f32_16x16x32_bf16 v[112:115], v[80:83], v[248:251], v[112:115]
    buffer_load_dwordx4 v[80:83], v69, s[12:15], s19 offen offset:0
    v_lshlrev_b32_sdwa v88, 3, v122 dst_sel:DWORD dst_unused:UNUSED_PAD src0_sel:DWORD src1_sel:WORD_0
    v_lshlrev_b32_sdwa v90, 3, v122 dst_sel:DWORD dst_unused:UNUSED_PAD src0_sel:DWORD src1_sel:WORD_1
    ds_read_b64 v[88:89], v88
    ds_read_b64 v[90:91], v90
    v_mfma_f32_16x16x32_bf16 v[112:115], v[84:87], v[252:255], v[112:115]
    buffer_load_dwordx4 v[84:87], v69, s[12:15], s19 offen offset:1024
    s_add_u32 s21, s21, 4096
    s_add_u32 s19, s19, 4096
    v_lshlrev_b32_sdwa v92, 3, v123 dst_sel:DWORD dst_unused:UNUSED_PAD src0_sel:DWORD src1_sel:WORD_0
    v_lshlrev_b32_sdwa v94, 3, v123 dst_sel:DWORD dst_unused:UNUSED_PAD src0_sel:DWORD src1_sel:WORD_1
    ds_read_b64 v[92:93], v92
    ds_read_b64 v[94:95], v94
    buffer_load_dwordx4 v[120:123], v69, s[12:15], s20 offen offset:2048 sc1
    s_waitcnt lgkmcnt(9)
    v_smfmac_f32_16x16x64_bf16 v[52:55], v[64:67], v[96:103], v68
    v_cvt_pk_bf16_f32 v112, v112, v113
    v_cvt_pk_bf16_f32 v113, v114, v115
    ds_write_b64 v70, v[112:113] offset:896
    s_add_u32 s23, s23, 1
    s_cmp_eq_u32 s23, 5
    s_cselect_b32 s35, 4294836224, s32
    s_cselect_b32 s23, 0, s23
    v_add_u32 v70, s35, v70
    s_waitcnt vmcnt(6)
    v_lshlrev_b32_sdwa v96, 3, v124 dst_sel:DWORD dst_unused:UNUSED_PAD src0_sel:DWORD src1_sel:WORD_0
    v_lshlrev_b32_sdwa v98, 3, v124 dst_sel:DWORD dst_unused:UNUSED_PAD src0_sel:DWORD src1_sel:WORD_1
    ds_read_b64 v[96:97], v96
    ds_read_b64 v[98:99], v98
    v_lshlrev_b32_sdwa v100, 3, v125 dst_sel:DWORD dst_unused:UNUSED_PAD src0_sel:DWORD src1_sel:WORD_0
    v_lshlrev_b32_sdwa v102, 3, v125 dst_sel:DWORD dst_unused:UNUSED_PAD src0_sel:DWORD src1_sel:WORD_1
    ds_read_b64 v[100:101], v100
    ds_read_b64 v[102:103], v102
    s_waitcnt lgkmcnt(9)
    v_smfmac_f32_16x16x64_bf16 v[56:59], v[64:67], v[104:111], v68
    s_setprio 0
    v_lshlrev_b32_sdwa v104, 3, v126 dst_sel:DWORD dst_unused:UNUSED_PAD src0_sel:DWORD src1_sel:WORD_0
    v_lshlrev_b32_sdwa v106, 3, v126 dst_sel:DWORD dst_unused:UNUSED_PAD src0_sel:DWORD src1_sel:WORD_1
    ds_read_b64 v[104:105], v104
    ds_read_b64 v[106:107], v106
    v_lshlrev_b32_sdwa v108, 3, v127 dst_sel:DWORD dst_unused:UNUSED_PAD src0_sel:DWORD src1_sel:WORD_0
    v_lshlrev_b32_sdwa v110, 3, v127 dst_sel:DWORD dst_unused:UNUSED_PAD src0_sel:DWORD src1_sel:WORD_1
    ds_read_b64 v[108:109], v108
    ds_read_b64 v[110:111], v110
    buffer_load_dwordx4 v[124:127], v69, s[12:15], s20 offen offset:3072 sc1
    s_add_u32 s20, s20, 4096
    s_waitcnt lgkmcnt(9)
    v_smfmac_f32_16x16x64_bf16 v[60:63], v[64:67], v[88:95], v68
    s_waitcnt lgkmcnt(8)
    s_barrier

    s_cmp_eq_u32 s22, 7
    s_cbranch_scc1 k1_kernel_fin

    s_setprio 3
    s_waitcnt vmcnt(6)
    v_lshlrev_b32_sdwa v88, 3, v116 dst_sel:DWORD dst_unused:UNUSED_PAD src0_sel:DWORD src1_sel:WORD_0
    v_lshlrev_b32_sdwa v90, 3, v116 dst_sel:DWORD dst_unused:UNUSED_PAD src0_sel:DWORD src1_sel:WORD_1
    ds_read_b64 v[88:89], v88
    ds_read_b64 v[90:91], v90
    v_lshlrev_b32_sdwa v92, 3, v117 dst_sel:DWORD dst_unused:UNUSED_PAD src0_sel:DWORD src1_sel:WORD_0
    v_lshlrev_b32_sdwa v94, 3, v117 dst_sel:DWORD dst_unused:UNUSED_PAD src0_sel:DWORD src1_sel:WORD_1
    ds_read_b64 v[92:93], v92
    ds_read_b64 v[94:95], v94
    s_waitcnt lgkmcnt(8)
    v_smfmac_f32_16x16x64_bf16 v[0:3], v[64:67], v[96:103], v68
    s_waitcnt vmcnt(5)
    v_mfma_f32_16x16x32_bf16 v[112:115], v[72:75], v[128:131], 0
    v_lshlrev_b32_sdwa v96, 3, v118 dst_sel:DWORD dst_unused:UNUSED_PAD src0_sel:DWORD src1_sel:WORD_0
    v_lshlrev_b32_sdwa v98, 3, v118 dst_sel:DWORD dst_unused:UNUSED_PAD src0_sel:DWORD src1_sel:WORD_1
    ds_read_b64 v[96:97], v96
    ds_read_b64 v[98:99], v98
    s_waitcnt vmcnt(4)
    v_mfma_f32_16x16x32_bf16 v[112:115], v[76:79], v[132:135], v[112:115]
    v_lshlrev_b32_sdwa v100, 3, v119 dst_sel:DWORD dst_unused:UNUSED_PAD src0_sel:DWORD src1_sel:WORD_0
    v_lshlrev_b32_sdwa v102, 3, v119 dst_sel:DWORD dst_unused:UNUSED_PAD src0_sel:DWORD src1_sel:WORD_1
    ds_read_b64 v[100:101], v100
    ds_read_b64 v[102:103], v102
    buffer_load_dwordx4 v[116:119], v69, s[12:15], s20 offen offset:0 sc1
    s_waitcnt lgkmcnt(8)
    v_smfmac_f32_16x16x64_bf16 v[4:7], v[64:67], v[104:111], v68
    s_waitcnt vmcnt(4)
    v_mfma_f32_16x16x32_bf16 v[112:115], v[80:83], v[136:139], v[112:115]
    s_waitcnt vmcnt(2)
    v_lshlrev_b32_sdwa v104, 3, v120 dst_sel:DWORD dst_unused:UNUSED_PAD src0_sel:DWORD src1_sel:WORD_0
    v_lshlrev_b32_sdwa v106, 3, v120 dst_sel:DWORD dst_unused:UNUSED_PAD src0_sel:DWORD src1_sel:WORD_1
    ds_read_b64 v[104:105], v104
    ds_read_b64 v[106:107], v106
    s_waitcnt vmcnt(3)
    v_mfma_f32_16x16x32_bf16 v[112:115], v[84:87], v[140:143], v[112:115]
    v_lshlrev_b32_sdwa v108, 3, v121 dst_sel:DWORD dst_unused:UNUSED_PAD src0_sel:DWORD src1_sel:WORD_0
    v_lshlrev_b32_sdwa v110, 3, v121 dst_sel:DWORD dst_unused:UNUSED_PAD src0_sel:DWORD src1_sel:WORD_1
    ds_read_b64 v[108:109], v108
    ds_read_b64 v[110:111], v110
    s_waitcnt lgkmcnt(8)
    v_smfmac_f32_16x16x64_bf16 v[8:11], v[64:67], v[88:95], v68
    s_nop 1
    v_cvt_pk_bf16_f32 v112, v112, v113
    v_cvt_pk_bf16_f32 v113, v114, v115
    ds_write_b64 v70, v[112:113] offset:0
    v_mfma_f32_16x16x32_bf16 v[112:115], v[72:75], v[144:147], 0
    v_mfma_f32_16x16x32_bf16 v[112:115], v[76:79], v[148:151], v[112:115]
    v_lshlrev_b32_sdwa v88, 3, v122 dst_sel:DWORD dst_unused:UNUSED_PAD src0_sel:DWORD src1_sel:WORD_0
    v_lshlrev_b32_sdwa v90, 3, v122 dst_sel:DWORD dst_unused:UNUSED_PAD src0_sel:DWORD src1_sel:WORD_1
    ds_read_b64 v[88:89], v88
    ds_read_b64 v[90:91], v90
    v_mfma_f32_16x16x32_bf16 v[112:115], v[80:83], v[152:155], v[112:115]
    v_mfma_f32_16x16x32_bf16 v[112:115], v[84:87], v[156:159], v[112:115]
    v_lshlrev_b32_sdwa v92, 3, v123 dst_sel:DWORD dst_unused:UNUSED_PAD src0_sel:DWORD src1_sel:WORD_0
    v_lshlrev_b32_sdwa v94, 3, v123 dst_sel:DWORD dst_unused:UNUSED_PAD src0_sel:DWORD src1_sel:WORD_1
    ds_read_b64 v[92:93], v92
    ds_read_b64 v[94:95], v94
    buffer_load_dwordx4 v[120:123], v69, s[12:15], s20 offen offset:1024 sc1
    s_waitcnt lgkmcnt(9)
    v_smfmac_f32_16x16x64_bf16 v[12:15], v[64:67], v[96:103], v68
    s_nop 0
    v_cvt_pk_bf16_f32 v112, v112, v113
    v_cvt_pk_bf16_f32 v113, v114, v115
    ds_write_b64 v70, v[112:113] offset:128
    v_mfma_f32_16x16x32_bf16 v[112:115], v[72:75], v[160:163], 0
    s_waitcnt vmcnt(2)
    v_lshlrev_b32_sdwa v96, 3, v124 dst_sel:DWORD dst_unused:UNUSED_PAD src0_sel:DWORD src1_sel:WORD_0
    v_lshlrev_b32_sdwa v98, 3, v124 dst_sel:DWORD dst_unused:UNUSED_PAD src0_sel:DWORD src1_sel:WORD_1
    ds_read_b64 v[96:97], v96
    ds_read_b64 v[98:99], v98
    v_mfma_f32_16x16x32_bf16 v[112:115], v[76:79], v[164:167], v[112:115]
    v_lshlrev_b32_sdwa v100, 3, v125 dst_sel:DWORD dst_unused:UNUSED_PAD src0_sel:DWORD src1_sel:WORD_0
    v_lshlrev_b32_sdwa v102, 3, v125 dst_sel:DWORD dst_unused:UNUSED_PAD src0_sel:DWORD src1_sel:WORD_1
    ds_read_b64 v[100:101], v100
    ds_read_b64 v[102:103], v102
    s_waitcnt lgkmcnt(10)
    v_smfmac_f32_16x16x64_bf16 v[16:19], v[64:67], v[104:111], v68
    v_mfma_f32_16x16x32_bf16 v[112:115], v[80:83], v[168:171], v[112:115]
    v_lshlrev_b32_sdwa v104, 3, v126 dst_sel:DWORD dst_unused:UNUSED_PAD src0_sel:DWORD src1_sel:WORD_0
    v_lshlrev_b32_sdwa v106, 3, v126 dst_sel:DWORD dst_unused:UNUSED_PAD src0_sel:DWORD src1_sel:WORD_1
    ds_read_b64 v[104:105], v104
    ds_read_b64 v[106:107], v106
    v_mfma_f32_16x16x32_bf16 v[112:115], v[84:87], v[172:175], v[112:115]
    v_lshlrev_b32_sdwa v108, 3, v127 dst_sel:DWORD dst_unused:UNUSED_PAD src0_sel:DWORD src1_sel:WORD_0
    v_lshlrev_b32_sdwa v110, 3, v127 dst_sel:DWORD dst_unused:UNUSED_PAD src0_sel:DWORD src1_sel:WORD_1
    ds_read_b64 v[108:109], v108
    ds_read_b64 v[110:111], v110
    buffer_load_dwordx4 v[124:127], v69, s[12:15], s20 offen offset:2048 sc1
    s_waitcnt lgkmcnt(9)
    v_smfmac_f32_16x16x64_bf16 v[20:23], v[64:67], v[88:95], v68
    s_nop 0
    v_cvt_pk_bf16_f32 v112, v112, v113
    v_cvt_pk_bf16_f32 v113, v114, v115
    ds_write_b64 v70, v[112:113] offset:256
    v_mfma_f32_16x16x32_bf16 v[112:115], v[72:75], v[176:179], 0
    v_mfma_f32_16x16x32_bf16 v[112:115], v[76:79], v[180:183], v[112:115]
    s_waitcnt vmcnt(2)
    v_lshlrev_b32_sdwa v88, 3, v116 dst_sel:DWORD dst_unused:UNUSED_PAD src0_sel:DWORD src1_sel:WORD_0
    v_lshlrev_b32_sdwa v90, 3, v116 dst_sel:DWORD dst_unused:UNUSED_PAD src0_sel:DWORD src1_sel:WORD_1
    ds_read_b64 v[88:89], v88
    ds_read_b64 v[90:91], v90
    v_mfma_f32_16x16x32_bf16 v[112:115], v[80:83], v[184:187], v[112:115]
    v_mfma_f32_16x16x32_bf16 v[112:115], v[84:87], v[188:191], v[112:115]
    v_lshlrev_b32_sdwa v92, 3, v117 dst_sel:DWORD dst_unused:UNUSED_PAD src0_sel:DWORD src1_sel:WORD_0
    v_lshlrev_b32_sdwa v94, 3, v117 dst_sel:DWORD dst_unused:UNUSED_PAD src0_sel:DWORD src1_sel:WORD_1
    ds_read_b64 v[92:93], v92
    ds_read_b64 v[94:95], v94
    s_waitcnt lgkmcnt(9)
    v_smfmac_f32_16x16x64_bf16 v[24:27], v[64:67], v[96:103], v68
    s_nop 1
    v_cvt_pk_bf16_f32 v112, v112, v113
    v_cvt_pk_bf16_f32 v113, v114, v115
    ds_write_b64 v70, v[112:113] offset:384
    v_mfma_f32_16x16x32_bf16 v[112:115], v[72:75], v[192:195], 0
    v_lshlrev_b32_sdwa v96, 3, v118 dst_sel:DWORD dst_unused:UNUSED_PAD src0_sel:DWORD src1_sel:WORD_0
    v_lshlrev_b32_sdwa v98, 3, v118 dst_sel:DWORD dst_unused:UNUSED_PAD src0_sel:DWORD src1_sel:WORD_1
    ds_read_b64 v[96:97], v96
    ds_read_b64 v[98:99], v98
    v_mfma_f32_16x16x32_bf16 v[112:115], v[76:79], v[196:199], v[112:115]
    v_lshlrev_b32_sdwa v100, 3, v119 dst_sel:DWORD dst_unused:UNUSED_PAD src0_sel:DWORD src1_sel:WORD_0
    v_lshlrev_b32_sdwa v102, 3, v119 dst_sel:DWORD dst_unused:UNUSED_PAD src0_sel:DWORD src1_sel:WORD_1
    ds_read_b64 v[100:101], v100
    ds_read_b64 v[102:103], v102
    buffer_load_dwordx4 v[116:119], v69, s[12:15], s20 offen offset:3072 sc1
    s_add_u32 s20, s20, 61440
    s_waitcnt lgkmcnt(10)
    v_smfmac_f32_16x16x64_bf16 v[28:31], v[64:67], v[104:111], v68
    s_setprio 2
    v_mfma_f32_16x16x32_bf16 v[112:115], v[80:83], v[200:203], v[112:115]
    s_waitcnt vmcnt(2)
    v_lshlrev_b32_sdwa v104, 3, v120 dst_sel:DWORD dst_unused:UNUSED_PAD src0_sel:DWORD src1_sel:WORD_0
    v_lshlrev_b32_sdwa v106, 3, v120 dst_sel:DWORD dst_unused:UNUSED_PAD src0_sel:DWORD src1_sel:WORD_1
    ds_read_b64 v[104:105], v104
    ds_read_b64 v[106:107], v106
    v_mfma_f32_16x16x32_bf16 v[112:115], v[84:87], v[204:207], v[112:115]
    v_lshlrev_b32_sdwa v108, 3, v121 dst_sel:DWORD dst_unused:UNUSED_PAD src0_sel:DWORD src1_sel:WORD_0
    v_lshlrev_b32_sdwa v110, 3, v121 dst_sel:DWORD dst_unused:UNUSED_PAD src0_sel:DWORD src1_sel:WORD_1
    ds_read_b64 v[108:109], v108
    ds_read_b64 v[110:111], v110
    s_waitcnt lgkmcnt(9)
    v_smfmac_f32_16x16x64_bf16 v[32:35], v[64:67], v[88:95], v68
    s_nop 1
    v_cvt_pk_bf16_f32 v112, v112, v113
    v_cvt_pk_bf16_f32 v113, v114, v115
    ds_write_b64 v70, v[112:113] offset:512
    v_mfma_f32_16x16x32_bf16 v[112:115], v[72:75], v[208:211], 0
    v_lshlrev_b32_sdwa v88, 3, v122 dst_sel:DWORD dst_unused:UNUSED_PAD src0_sel:DWORD src1_sel:WORD_0
    v_lshlrev_b32_sdwa v90, 3, v122 dst_sel:DWORD dst_unused:UNUSED_PAD src0_sel:DWORD src1_sel:WORD_1
    ds_read_b64 v[88:89], v88
    ds_read_b64 v[90:91], v90
    v_mfma_f32_16x16x32_bf16 v[112:115], v[76:79], v[212:215], v[112:115]
    v_lshlrev_b32_sdwa v92, 3, v123 dst_sel:DWORD dst_unused:UNUSED_PAD src0_sel:DWORD src1_sel:WORD_0
    v_lshlrev_b32_sdwa v94, 3, v123 dst_sel:DWORD dst_unused:UNUSED_PAD src0_sel:DWORD src1_sel:WORD_1
    ds_read_b64 v[92:93], v92
    ds_read_b64 v[94:95], v94
    buffer_load_dwordx4 v[120:123], v69, s[12:15], s20 offen offset:0 sc1
    s_waitcnt lgkmcnt(9)
    v_smfmac_f32_16x16x64_bf16 v[36:39], v[64:67], v[96:103], v68
    v_mfma_f32_16x16x32_bf16 v[112:115], v[80:83], v[216:219], v[112:115]
    s_waitcnt vmcnt(2)
    v_lshlrev_b32_sdwa v96, 3, v124 dst_sel:DWORD dst_unused:UNUSED_PAD src0_sel:DWORD src1_sel:WORD_0
    v_lshlrev_b32_sdwa v98, 3, v124 dst_sel:DWORD dst_unused:UNUSED_PAD src0_sel:DWORD src1_sel:WORD_1
    ds_read_b64 v[96:97], v96
    ds_read_b64 v[98:99], v98
    v_mfma_f32_16x16x32_bf16 v[112:115], v[84:87], v[220:223], v[112:115]
    v_lshlrev_b32_sdwa v100, 3, v125 dst_sel:DWORD dst_unused:UNUSED_PAD src0_sel:DWORD src1_sel:WORD_0
    v_lshlrev_b32_sdwa v102, 3, v125 dst_sel:DWORD dst_unused:UNUSED_PAD src0_sel:DWORD src1_sel:WORD_1
    ds_read_b64 v[100:101], v100
    ds_read_b64 v[102:103], v102
    s_waitcnt lgkmcnt(9)
    v_smfmac_f32_16x16x64_bf16 v[40:43], v[64:67], v[104:111], v68
    s_nop 1
    v_cvt_pk_bf16_f32 v112, v112, v113
    v_cvt_pk_bf16_f32 v113, v114, v115
    ds_write_b64 v70, v[112:113] offset:640
    v_mfma_f32_16x16x32_bf16 v[112:115], v[72:75], v[224:227], 0
    v_mfma_f32_16x16x32_bf16 v[112:115], v[76:79], v[228:231], v[112:115]
    v_lshlrev_b32_sdwa v104, 3, v126 dst_sel:DWORD dst_unused:UNUSED_PAD src0_sel:DWORD src1_sel:WORD_0
    v_lshlrev_b32_sdwa v106, 3, v126 dst_sel:DWORD dst_unused:UNUSED_PAD src0_sel:DWORD src1_sel:WORD_1
    ds_read_b64 v[104:105], v104
    ds_read_b64 v[106:107], v106
    v_mfma_f32_16x16x32_bf16 v[112:115], v[80:83], v[232:235], v[112:115]
    v_mfma_f32_16x16x32_bf16 v[112:115], v[84:87], v[236:239], v[112:115]
    v_lshlrev_b32_sdwa v108, 3, v127 dst_sel:DWORD dst_unused:UNUSED_PAD src0_sel:DWORD src1_sel:WORD_0
    v_lshlrev_b32_sdwa v110, 3, v127 dst_sel:DWORD dst_unused:UNUSED_PAD src0_sel:DWORD src1_sel:WORD_1
    ds_read_b64 v[108:109], v108
    ds_read_b64 v[110:111], v110
    buffer_load_dwordx4 v[124:127], v69, s[12:15], s20 offen offset:1024 sc1
    s_waitcnt lgkmcnt(9)
    v_smfmac_f32_16x16x64_bf16 v[44:47], v[64:67], v[88:95], v68
    s_nop 0
    v_cvt_pk_bf16_f32 v112, v112, v113
    v_cvt_pk_bf16_f32 v113, v114, v115
    ds_write_b64 v70, v[112:113] offset:768
    s_setprio 1
    v_mfma_f32_16x16x32_bf16 v[112:115], v[72:75], v[240:243], 0
    buffer_load_dwordx4 v[72:75], v69, s[12:15], s21 offen offset:0
    s_waitcnt vmcnt(3)
    v_lshlrev_b32_sdwa v88, 3, v116 dst_sel:DWORD dst_unused:UNUSED_PAD src0_sel:DWORD src1_sel:WORD_0
    v_lshlrev_b32_sdwa v90, 3, v116 dst_sel:DWORD dst_unused:UNUSED_PAD src0_sel:DWORD src1_sel:WORD_1
    ds_read_b64 v[88:89], v88
    ds_read_b64 v[90:91], v90
    v_mfma_f32_16x16x32_bf16 v[112:115], v[76:79], v[244:247], v[112:115]
    buffer_load_dwordx4 v[76:79], v69, s[12:15], s21 offen offset:1024
    v_lshlrev_b32_sdwa v92, 3, v117 dst_sel:DWORD dst_unused:UNUSED_PAD src0_sel:DWORD src1_sel:WORD_0
    v_lshlrev_b32_sdwa v94, 3, v117 dst_sel:DWORD dst_unused:UNUSED_PAD src0_sel:DWORD src1_sel:WORD_1
    ds_read_b64 v[92:93], v92
    ds_read_b64 v[94:95], v94
    s_waitcnt lgkmcnt(10)
    v_smfmac_f32_16x16x64_bf16 v[48:51], v[64:67], v[96:103], v68
    v_mfma_f32_16x16x32_bf16 v[112:115], v[80:83], v[248:251], v[112:115]
    buffer_load_dwordx4 v[80:83], v69, s[12:15], s19 offen offset:0
    v_lshlrev_b32_sdwa v96, 3, v118 dst_sel:DWORD dst_unused:UNUSED_PAD src0_sel:DWORD src1_sel:WORD_0
    v_lshlrev_b32_sdwa v98, 3, v118 dst_sel:DWORD dst_unused:UNUSED_PAD src0_sel:DWORD src1_sel:WORD_1
    ds_read_b64 v[96:97], v96
    ds_read_b64 v[98:99], v98
    v_mfma_f32_16x16x32_bf16 v[112:115], v[84:87], v[252:255], v[112:115]
    buffer_load_dwordx4 v[84:87], v69, s[12:15], s19 offen offset:1024
    s_add_u32 s21, s21, 4096
    s_add_u32 s19, s19, 4096
    v_lshlrev_b32_sdwa v100, 3, v119 dst_sel:DWORD dst_unused:UNUSED_PAD src0_sel:DWORD src1_sel:WORD_0
    v_lshlrev_b32_sdwa v102, 3, v119 dst_sel:DWORD dst_unused:UNUSED_PAD src0_sel:DWORD src1_sel:WORD_1
    ds_read_b64 v[100:101], v100
    ds_read_b64 v[102:103], v102
    buffer_load_dwordx4 v[116:119], v69, s[12:15], s20 offen offset:2048 sc1
    s_waitcnt lgkmcnt(9)
    v_smfmac_f32_16x16x64_bf16 v[52:55], v[64:67], v[104:111], v68
    v_cvt_pk_bf16_f32 v112, v112, v113
    v_cvt_pk_bf16_f32 v113, v114, v115
    ds_write_b64 v70, v[112:113] offset:896
    s_add_u32 s23, s23, 1
    s_cmp_eq_u32 s23, 5
    s_cselect_b32 s35, 4294836224, s32
    s_cselect_b32 s23, 0, s23
    v_add_u32 v70, s35, v70
    s_waitcnt vmcnt(6)
    v_lshlrev_b32_sdwa v104, 3, v120 dst_sel:DWORD dst_unused:UNUSED_PAD src0_sel:DWORD src1_sel:WORD_0
    v_lshlrev_b32_sdwa v106, 3, v120 dst_sel:DWORD dst_unused:UNUSED_PAD src0_sel:DWORD src1_sel:WORD_1
    ds_read_b64 v[104:105], v104
    ds_read_b64 v[106:107], v106
    v_lshlrev_b32_sdwa v108, 3, v121 dst_sel:DWORD dst_unused:UNUSED_PAD src0_sel:DWORD src1_sel:WORD_0
    v_lshlrev_b32_sdwa v110, 3, v121 dst_sel:DWORD dst_unused:UNUSED_PAD src0_sel:DWORD src1_sel:WORD_1
    ds_read_b64 v[108:109], v108
    ds_read_b64 v[110:111], v110
    s_waitcnt lgkmcnt(9)
    v_smfmac_f32_16x16x64_bf16 v[56:59], v[64:67], v[88:95], v68
    s_setprio 0
    v_lshlrev_b32_sdwa v88, 3, v122 dst_sel:DWORD dst_unused:UNUSED_PAD src0_sel:DWORD src1_sel:WORD_0
    v_lshlrev_b32_sdwa v90, 3, v122 dst_sel:DWORD dst_unused:UNUSED_PAD src0_sel:DWORD src1_sel:WORD_1
    ds_read_b64 v[88:89], v88
    ds_read_b64 v[90:91], v90
    v_lshlrev_b32_sdwa v92, 3, v123 dst_sel:DWORD dst_unused:UNUSED_PAD src0_sel:DWORD src1_sel:WORD_0
    v_lshlrev_b32_sdwa v94, 3, v123 dst_sel:DWORD dst_unused:UNUSED_PAD src0_sel:DWORD src1_sel:WORD_1
    ds_read_b64 v[92:93], v92
    ds_read_b64 v[94:95], v94
    buffer_load_dwordx4 v[120:123], v69, s[12:15], s20 offen offset:3072 sc1
    s_add_u32 s20, s20, 4096
    s_waitcnt lgkmcnt(9)
    v_smfmac_f32_16x16x64_bf16 v[60:63], v[64:67], v[96:103], v68
    s_waitcnt lgkmcnt(8)
    s_barrier
    s_setprio 3
    s_waitcnt vmcnt(6)
    v_lshlrev_b32_sdwa v96, 3, v124 dst_sel:DWORD dst_unused:UNUSED_PAD src0_sel:DWORD src1_sel:WORD_0
    v_lshlrev_b32_sdwa v98, 3, v124 dst_sel:DWORD dst_unused:UNUSED_PAD src0_sel:DWORD src1_sel:WORD_1
    ds_read_b64 v[96:97], v96
    ds_read_b64 v[98:99], v98
    v_lshlrev_b32_sdwa v100, 3, v125 dst_sel:DWORD dst_unused:UNUSED_PAD src0_sel:DWORD src1_sel:WORD_0
    v_lshlrev_b32_sdwa v102, 3, v125 dst_sel:DWORD dst_unused:UNUSED_PAD src0_sel:DWORD src1_sel:WORD_1
    ds_read_b64 v[100:101], v100
    ds_read_b64 v[102:103], v102
    s_waitcnt lgkmcnt(8)
    v_smfmac_f32_16x16x64_bf16 v[0:3], v[64:67], v[104:111], v68
    s_waitcnt vmcnt(5)
    v_mfma_f32_16x16x32_bf16 v[112:115], v[72:75], v[128:131], 0
    v_lshlrev_b32_sdwa v104, 3, v126 dst_sel:DWORD dst_unused:UNUSED_PAD src0_sel:DWORD src1_sel:WORD_0
    v_lshlrev_b32_sdwa v106, 3, v126 dst_sel:DWORD dst_unused:UNUSED_PAD src0_sel:DWORD src1_sel:WORD_1
    ds_read_b64 v[104:105], v104
    ds_read_b64 v[106:107], v106
    s_waitcnt vmcnt(4)
    v_mfma_f32_16x16x32_bf16 v[112:115], v[76:79], v[132:135], v[112:115]
    v_lshlrev_b32_sdwa v108, 3, v127 dst_sel:DWORD dst_unused:UNUSED_PAD src0_sel:DWORD src1_sel:WORD_0
    v_lshlrev_b32_sdwa v110, 3, v127 dst_sel:DWORD dst_unused:UNUSED_PAD src0_sel:DWORD src1_sel:WORD_1
    ds_read_b64 v[108:109], v108
    ds_read_b64 v[110:111], v110
    buffer_load_dwordx4 v[124:127], v69, s[12:15], s20 offen offset:0 sc1
    s_waitcnt lgkmcnt(8)
    v_smfmac_f32_16x16x64_bf16 v[4:7], v[64:67], v[88:95], v68
    s_waitcnt vmcnt(4)
    v_mfma_f32_16x16x32_bf16 v[112:115], v[80:83], v[136:139], v[112:115]
    s_waitcnt vmcnt(2)
    v_lshlrev_b32_sdwa v88, 3, v116 dst_sel:DWORD dst_unused:UNUSED_PAD src0_sel:DWORD src1_sel:WORD_0
    v_lshlrev_b32_sdwa v90, 3, v116 dst_sel:DWORD dst_unused:UNUSED_PAD src0_sel:DWORD src1_sel:WORD_1
    ds_read_b64 v[88:89], v88
    ds_read_b64 v[90:91], v90
    s_waitcnt vmcnt(3)
    v_mfma_f32_16x16x32_bf16 v[112:115], v[84:87], v[140:143], v[112:115]
    v_lshlrev_b32_sdwa v92, 3, v117 dst_sel:DWORD dst_unused:UNUSED_PAD src0_sel:DWORD src1_sel:WORD_0
    v_lshlrev_b32_sdwa v94, 3, v117 dst_sel:DWORD dst_unused:UNUSED_PAD src0_sel:DWORD src1_sel:WORD_1
    ds_read_b64 v[92:93], v92
    ds_read_b64 v[94:95], v94
    s_waitcnt lgkmcnt(8)
    v_smfmac_f32_16x16x64_bf16 v[8:11], v[64:67], v[96:103], v68
    s_nop 1
    v_cvt_pk_bf16_f32 v112, v112, v113
    v_cvt_pk_bf16_f32 v113, v114, v115
    ds_write_b64 v70, v[112:113] offset:0
    v_mfma_f32_16x16x32_bf16 v[112:115], v[72:75], v[144:147], 0
    v_mfma_f32_16x16x32_bf16 v[112:115], v[76:79], v[148:151], v[112:115]
    v_lshlrev_b32_sdwa v96, 3, v118 dst_sel:DWORD dst_unused:UNUSED_PAD src0_sel:DWORD src1_sel:WORD_0
    v_lshlrev_b32_sdwa v98, 3, v118 dst_sel:DWORD dst_unused:UNUSED_PAD src0_sel:DWORD src1_sel:WORD_1
    ds_read_b64 v[96:97], v96
    ds_read_b64 v[98:99], v98
    v_mfma_f32_16x16x32_bf16 v[112:115], v[80:83], v[152:155], v[112:115]
    v_mfma_f32_16x16x32_bf16 v[112:115], v[84:87], v[156:159], v[112:115]
    v_lshlrev_b32_sdwa v100, 3, v119 dst_sel:DWORD dst_unused:UNUSED_PAD src0_sel:DWORD src1_sel:WORD_0
    v_lshlrev_b32_sdwa v102, 3, v119 dst_sel:DWORD dst_unused:UNUSED_PAD src0_sel:DWORD src1_sel:WORD_1
    ds_read_b64 v[100:101], v100
    ds_read_b64 v[102:103], v102
    buffer_load_dwordx4 v[116:119], v69, s[12:15], s20 offen offset:1024 sc1
    s_waitcnt lgkmcnt(9)
    v_smfmac_f32_16x16x64_bf16 v[12:15], v[64:67], v[104:111], v68
    s_nop 0
    v_cvt_pk_bf16_f32 v112, v112, v113
    v_cvt_pk_bf16_f32 v113, v114, v115
    ds_write_b64 v70, v[112:113] offset:128
    v_mfma_f32_16x16x32_bf16 v[112:115], v[72:75], v[160:163], 0
    s_waitcnt vmcnt(2)
    v_lshlrev_b32_sdwa v104, 3, v120 dst_sel:DWORD dst_unused:UNUSED_PAD src0_sel:DWORD src1_sel:WORD_0
    v_lshlrev_b32_sdwa v106, 3, v120 dst_sel:DWORD dst_unused:UNUSED_PAD src0_sel:DWORD src1_sel:WORD_1
    ds_read_b64 v[104:105], v104
    ds_read_b64 v[106:107], v106
    v_mfma_f32_16x16x32_bf16 v[112:115], v[76:79], v[164:167], v[112:115]
    v_lshlrev_b32_sdwa v108, 3, v121 dst_sel:DWORD dst_unused:UNUSED_PAD src0_sel:DWORD src1_sel:WORD_0
    v_lshlrev_b32_sdwa v110, 3, v121 dst_sel:DWORD dst_unused:UNUSED_PAD src0_sel:DWORD src1_sel:WORD_1
    ds_read_b64 v[108:109], v108
    ds_read_b64 v[110:111], v110
    s_waitcnt lgkmcnt(10)
    v_smfmac_f32_16x16x64_bf16 v[16:19], v[64:67], v[88:95], v68
    v_mfma_f32_16x16x32_bf16 v[112:115], v[80:83], v[168:171], v[112:115]
    v_lshlrev_b32_sdwa v88, 3, v122 dst_sel:DWORD dst_unused:UNUSED_PAD src0_sel:DWORD src1_sel:WORD_0
    v_lshlrev_b32_sdwa v90, 3, v122 dst_sel:DWORD dst_unused:UNUSED_PAD src0_sel:DWORD src1_sel:WORD_1
    ds_read_b64 v[88:89], v88
    ds_read_b64 v[90:91], v90
    v_mfma_f32_16x16x32_bf16 v[112:115], v[84:87], v[172:175], v[112:115]
    v_lshlrev_b32_sdwa v92, 3, v123 dst_sel:DWORD dst_unused:UNUSED_PAD src0_sel:DWORD src1_sel:WORD_0
    v_lshlrev_b32_sdwa v94, 3, v123 dst_sel:DWORD dst_unused:UNUSED_PAD src0_sel:DWORD src1_sel:WORD_1
    ds_read_b64 v[92:93], v92
    ds_read_b64 v[94:95], v94
    buffer_load_dwordx4 v[120:123], v69, s[12:15], s20 offen offset:2048 sc1
    s_waitcnt lgkmcnt(9)
    v_smfmac_f32_16x16x64_bf16 v[20:23], v[64:67], v[96:103], v68
    s_nop 0
    v_cvt_pk_bf16_f32 v112, v112, v113
    v_cvt_pk_bf16_f32 v113, v114, v115
    ds_write_b64 v70, v[112:113] offset:256
    v_mfma_f32_16x16x32_bf16 v[112:115], v[72:75], v[176:179], 0
    v_mfma_f32_16x16x32_bf16 v[112:115], v[76:79], v[180:183], v[112:115]
    s_waitcnt vmcnt(2)
    v_lshlrev_b32_sdwa v96, 3, v124 dst_sel:DWORD dst_unused:UNUSED_PAD src0_sel:DWORD src1_sel:WORD_0
    v_lshlrev_b32_sdwa v98, 3, v124 dst_sel:DWORD dst_unused:UNUSED_PAD src0_sel:DWORD src1_sel:WORD_1
    ds_read_b64 v[96:97], v96
    ds_read_b64 v[98:99], v98
    v_mfma_f32_16x16x32_bf16 v[112:115], v[80:83], v[184:187], v[112:115]
    v_mfma_f32_16x16x32_bf16 v[112:115], v[84:87], v[188:191], v[112:115]
    v_lshlrev_b32_sdwa v100, 3, v125 dst_sel:DWORD dst_unused:UNUSED_PAD src0_sel:DWORD src1_sel:WORD_0
    v_lshlrev_b32_sdwa v102, 3, v125 dst_sel:DWORD dst_unused:UNUSED_PAD src0_sel:DWORD src1_sel:WORD_1
    ds_read_b64 v[100:101], v100
    ds_read_b64 v[102:103], v102
    s_waitcnt lgkmcnt(9)
    v_smfmac_f32_16x16x64_bf16 v[24:27], v[64:67], v[104:111], v68
    s_nop 1
    v_cvt_pk_bf16_f32 v112, v112, v113
    v_cvt_pk_bf16_f32 v113, v114, v115
    ds_write_b64 v70, v[112:113] offset:384
    v_mfma_f32_16x16x32_bf16 v[112:115], v[72:75], v[192:195], 0
    v_lshlrev_b32_sdwa v104, 3, v126 dst_sel:DWORD dst_unused:UNUSED_PAD src0_sel:DWORD src1_sel:WORD_0
    v_lshlrev_b32_sdwa v106, 3, v126 dst_sel:DWORD dst_unused:UNUSED_PAD src0_sel:DWORD src1_sel:WORD_1
    ds_read_b64 v[104:105], v104
    ds_read_b64 v[106:107], v106
    v_mfma_f32_16x16x32_bf16 v[112:115], v[76:79], v[196:199], v[112:115]
    v_lshlrev_b32_sdwa v108, 3, v127 dst_sel:DWORD dst_unused:UNUSED_PAD src0_sel:DWORD src1_sel:WORD_0
    v_lshlrev_b32_sdwa v110, 3, v127 dst_sel:DWORD dst_unused:UNUSED_PAD src0_sel:DWORD src1_sel:WORD_1
    ds_read_b64 v[108:109], v108
    ds_read_b64 v[110:111], v110
    buffer_load_dwordx4 v[124:127], v69, s[12:15], s20 offen offset:3072 sc1
    s_add_u32 s20, s20, 61440
    s_waitcnt lgkmcnt(10)
    v_smfmac_f32_16x16x64_bf16 v[28:31], v[64:67], v[88:95], v68
    s_setprio 2
    v_mfma_f32_16x16x32_bf16 v[112:115], v[80:83], v[200:203], v[112:115]
    s_waitcnt vmcnt(2)
    v_lshlrev_b32_sdwa v88, 3, v116 dst_sel:DWORD dst_unused:UNUSED_PAD src0_sel:DWORD src1_sel:WORD_0
    v_lshlrev_b32_sdwa v90, 3, v116 dst_sel:DWORD dst_unused:UNUSED_PAD src0_sel:DWORD src1_sel:WORD_1
    ds_read_b64 v[88:89], v88
    ds_read_b64 v[90:91], v90
    v_mfma_f32_16x16x32_bf16 v[112:115], v[84:87], v[204:207], v[112:115]
    v_lshlrev_b32_sdwa v92, 3, v117 dst_sel:DWORD dst_unused:UNUSED_PAD src0_sel:DWORD src1_sel:WORD_0
    v_lshlrev_b32_sdwa v94, 3, v117 dst_sel:DWORD dst_unused:UNUSED_PAD src0_sel:DWORD src1_sel:WORD_1
    ds_read_b64 v[92:93], v92
    ds_read_b64 v[94:95], v94
    s_waitcnt lgkmcnt(9)
    v_smfmac_f32_16x16x64_bf16 v[32:35], v[64:67], v[96:103], v68
    s_nop 1
    v_cvt_pk_bf16_f32 v112, v112, v113
    v_cvt_pk_bf16_f32 v113, v114, v115
    ds_write_b64 v70, v[112:113] offset:512
    v_mfma_f32_16x16x32_bf16 v[112:115], v[72:75], v[208:211], 0
    v_lshlrev_b32_sdwa v96, 3, v118 dst_sel:DWORD dst_unused:UNUSED_PAD src0_sel:DWORD src1_sel:WORD_0
    v_lshlrev_b32_sdwa v98, 3, v118 dst_sel:DWORD dst_unused:UNUSED_PAD src0_sel:DWORD src1_sel:WORD_1
    ds_read_b64 v[96:97], v96
    ds_read_b64 v[98:99], v98
    v_mfma_f32_16x16x32_bf16 v[112:115], v[76:79], v[212:215], v[112:115]
    v_lshlrev_b32_sdwa v100, 3, v119 dst_sel:DWORD dst_unused:UNUSED_PAD src0_sel:DWORD src1_sel:WORD_0
    v_lshlrev_b32_sdwa v102, 3, v119 dst_sel:DWORD dst_unused:UNUSED_PAD src0_sel:DWORD src1_sel:WORD_1
    ds_read_b64 v[100:101], v100
    ds_read_b64 v[102:103], v102
    buffer_load_dwordx4 v[116:119], v69, s[12:15], s20 offen offset:0 sc1
    s_waitcnt lgkmcnt(9)
    v_smfmac_f32_16x16x64_bf16 v[36:39], v[64:67], v[104:111], v68
    v_mfma_f32_16x16x32_bf16 v[112:115], v[80:83], v[216:219], v[112:115]
    s_waitcnt vmcnt(2)
    v_lshlrev_b32_sdwa v104, 3, v120 dst_sel:DWORD dst_unused:UNUSED_PAD src0_sel:DWORD src1_sel:WORD_0
    v_lshlrev_b32_sdwa v106, 3, v120 dst_sel:DWORD dst_unused:UNUSED_PAD src0_sel:DWORD src1_sel:WORD_1
    ds_read_b64 v[104:105], v104
    ds_read_b64 v[106:107], v106
    v_mfma_f32_16x16x32_bf16 v[112:115], v[84:87], v[220:223], v[112:115]
    v_lshlrev_b32_sdwa v108, 3, v121 dst_sel:DWORD dst_unused:UNUSED_PAD src0_sel:DWORD src1_sel:WORD_0
    v_lshlrev_b32_sdwa v110, 3, v121 dst_sel:DWORD dst_unused:UNUSED_PAD src0_sel:DWORD src1_sel:WORD_1
    ds_read_b64 v[108:109], v108
    ds_read_b64 v[110:111], v110
    s_waitcnt lgkmcnt(9)
    v_smfmac_f32_16x16x64_bf16 v[40:43], v[64:67], v[88:95], v68
    s_nop 1
    v_cvt_pk_bf16_f32 v112, v112, v113
    v_cvt_pk_bf16_f32 v113, v114, v115
    ds_write_b64 v70, v[112:113] offset:640
    v_mfma_f32_16x16x32_bf16 v[112:115], v[72:75], v[224:227], 0
    v_mfma_f32_16x16x32_bf16 v[112:115], v[76:79], v[228:231], v[112:115]
    v_lshlrev_b32_sdwa v88, 3, v122 dst_sel:DWORD dst_unused:UNUSED_PAD src0_sel:DWORD src1_sel:WORD_0
    v_lshlrev_b32_sdwa v90, 3, v122 dst_sel:DWORD dst_unused:UNUSED_PAD src0_sel:DWORD src1_sel:WORD_1
    ds_read_b64 v[88:89], v88
    ds_read_b64 v[90:91], v90
    v_mfma_f32_16x16x32_bf16 v[112:115], v[80:83], v[232:235], v[112:115]
    v_mfma_f32_16x16x32_bf16 v[112:115], v[84:87], v[236:239], v[112:115]
    v_lshlrev_b32_sdwa v92, 3, v123 dst_sel:DWORD dst_unused:UNUSED_PAD src0_sel:DWORD src1_sel:WORD_0
    v_lshlrev_b32_sdwa v94, 3, v123 dst_sel:DWORD dst_unused:UNUSED_PAD src0_sel:DWORD src1_sel:WORD_1
    ds_read_b64 v[92:93], v92
    ds_read_b64 v[94:95], v94
    buffer_load_dwordx4 v[120:123], v69, s[12:15], s20 offen offset:1024 sc1
    s_waitcnt lgkmcnt(9)
    v_smfmac_f32_16x16x64_bf16 v[44:47], v[64:67], v[96:103], v68
    s_nop 0
    v_cvt_pk_bf16_f32 v112, v112, v113
    v_cvt_pk_bf16_f32 v113, v114, v115
    ds_write_b64 v70, v[112:113] offset:768
    s_setprio 1
    v_mfma_f32_16x16x32_bf16 v[112:115], v[72:75], v[240:243], 0
    buffer_load_dwordx4 v[72:75], v69, s[12:15], s21 offen offset:0
    s_waitcnt vmcnt(3)
    v_lshlrev_b32_sdwa v96, 3, v124 dst_sel:DWORD dst_unused:UNUSED_PAD src0_sel:DWORD src1_sel:WORD_0
    v_lshlrev_b32_sdwa v98, 3, v124 dst_sel:DWORD dst_unused:UNUSED_PAD src0_sel:DWORD src1_sel:WORD_1
    ds_read_b64 v[96:97], v96
    ds_read_b64 v[98:99], v98
    v_mfma_f32_16x16x32_bf16 v[112:115], v[76:79], v[244:247], v[112:115]
    buffer_load_dwordx4 v[76:79], v69, s[12:15], s21 offen offset:1024
    v_lshlrev_b32_sdwa v100, 3, v125 dst_sel:DWORD dst_unused:UNUSED_PAD src0_sel:DWORD src1_sel:WORD_0
    v_lshlrev_b32_sdwa v102, 3, v125 dst_sel:DWORD dst_unused:UNUSED_PAD src0_sel:DWORD src1_sel:WORD_1
    ds_read_b64 v[100:101], v100
    ds_read_b64 v[102:103], v102
    s_waitcnt lgkmcnt(10)
    v_smfmac_f32_16x16x64_bf16 v[48:51], v[64:67], v[104:111], v68
    v_mfma_f32_16x16x32_bf16 v[112:115], v[80:83], v[248:251], v[112:115]
    buffer_load_dwordx4 v[80:83], v69, s[12:15], s19 offen offset:0
    v_lshlrev_b32_sdwa v104, 3, v126 dst_sel:DWORD dst_unused:UNUSED_PAD src0_sel:DWORD src1_sel:WORD_0
    v_lshlrev_b32_sdwa v106, 3, v126 dst_sel:DWORD dst_unused:UNUSED_PAD src0_sel:DWORD src1_sel:WORD_1
    ds_read_b64 v[104:105], v104
    ds_read_b64 v[106:107], v106
    v_mfma_f32_16x16x32_bf16 v[112:115], v[84:87], v[252:255], v[112:115]
    buffer_load_dwordx4 v[84:87], v69, s[12:15], s19 offen offset:1024
    s_add_u32 s21, s21, 4096
    s_add_u32 s19, s19, 4096
    v_lshlrev_b32_sdwa v108, 3, v127 dst_sel:DWORD dst_unused:UNUSED_PAD src0_sel:DWORD src1_sel:WORD_0
    v_lshlrev_b32_sdwa v110, 3, v127 dst_sel:DWORD dst_unused:UNUSED_PAD src0_sel:DWORD src1_sel:WORD_1
    ds_read_b64 v[108:109], v108
    ds_read_b64 v[110:111], v110
    buffer_load_dwordx4 v[124:127], v69, s[12:15], s20 offen offset:2048 sc1
    s_waitcnt lgkmcnt(9)
    v_smfmac_f32_16x16x64_bf16 v[52:55], v[64:67], v[88:95], v68
    v_cvt_pk_bf16_f32 v112, v112, v113
    v_cvt_pk_bf16_f32 v113, v114, v115
    ds_write_b64 v70, v[112:113] offset:896
    s_add_u32 s23, s23, 1
    s_cmp_eq_u32 s23, 5
    s_cselect_b32 s35, 4294836224, s32
    s_cselect_b32 s23, 0, s23
    v_add_u32 v70, s35, v70
    s_waitcnt vmcnt(6)
    v_lshlrev_b32_sdwa v88, 3, v116 dst_sel:DWORD dst_unused:UNUSED_PAD src0_sel:DWORD src1_sel:WORD_0
    v_lshlrev_b32_sdwa v90, 3, v116 dst_sel:DWORD dst_unused:UNUSED_PAD src0_sel:DWORD src1_sel:WORD_1
    ds_read_b64 v[88:89], v88
    ds_read_b64 v[90:91], v90
    v_lshlrev_b32_sdwa v92, 3, v117 dst_sel:DWORD dst_unused:UNUSED_PAD src0_sel:DWORD src1_sel:WORD_0
    v_lshlrev_b32_sdwa v94, 3, v117 dst_sel:DWORD dst_unused:UNUSED_PAD src0_sel:DWORD src1_sel:WORD_1
    ds_read_b64 v[92:93], v92
    ds_read_b64 v[94:95], v94
    s_waitcnt lgkmcnt(9)
    v_smfmac_f32_16x16x64_bf16 v[56:59], v[64:67], v[96:103], v68
    s_setprio 0
    v_lshlrev_b32_sdwa v96, 3, v118 dst_sel:DWORD dst_unused:UNUSED_PAD src0_sel:DWORD src1_sel:WORD_0
    v_lshlrev_b32_sdwa v98, 3, v118 dst_sel:DWORD dst_unused:UNUSED_PAD src0_sel:DWORD src1_sel:WORD_1
    ds_read_b64 v[96:97], v96
    ds_read_b64 v[98:99], v98
    v_lshlrev_b32_sdwa v100, 3, v119 dst_sel:DWORD dst_unused:UNUSED_PAD src0_sel:DWORD src1_sel:WORD_0
    v_lshlrev_b32_sdwa v102, 3, v119 dst_sel:DWORD dst_unused:UNUSED_PAD src0_sel:DWORD src1_sel:WORD_1
    ds_read_b64 v[100:101], v100
    ds_read_b64 v[102:103], v102
    buffer_load_dwordx4 v[116:119], v69, s[12:15], s20 offen offset:3072 sc1
    s_add_u32 s20, s20, 4096
    s_waitcnt lgkmcnt(9)
    v_smfmac_f32_16x16x64_bf16 v[60:63], v[64:67], v[104:111], v68
    s_waitcnt lgkmcnt(8)
    s_barrier

    s_add_u32 s22, s22, 1
    s_branch k1_kernel_gloop

k1_kernel_fin:

    s_add_u32 s40, s20, 61440
    s_add_u32 s41, s20, 65536
    s_add_u32 s44, s20, 126976
    s_add_u32 s45, s20, 131072

    s_lshl_b32 s28, s38, 16
    s_and_b32 s29, s38, 0xffff0000
    s_lshl_b32 s30, s39, 16
    s_and_b32 s31, s39, 0xffff0000
    s_lshl_b32 s35, s33, 16
    s_lshl_b32 s42, s34, 15
    s_add_u32 s35, s35, s42
    s_lshl_b32 s42, s3, 12
    s_add_u32 s35, s35, s42
    s_add_u32 s35, s35, 20971520

    s_and_b32 s57, s57, 0xffff
    s_mov_b32 s58, 2
    s_mov_b32 s59, 0x00020000
    s_and_b32 s61, s61, 0xffff
    s_mov_b32 s62, 32768
    s_mov_b32 s63, 0x00020000
    s_xor_b32 s64, s34, 1
    s_lshl_b32 s64, s64, 7
    s_add_u32 s64, s64, s33
    s_lshl_b32 s65, s3, 20
    s_add_u32 s66, s65, 1048576
    s_lshl_b32 s67, s3, 8
    s_lshl_b32 s68, s64, 7
    s_lshl_b32 s69, s64, 8
    s_add_u32 s69, s69, s65
    s_add_u32 s69, s69, 20971520
    s_mov_b32 s42, 0
    s_mov_b32 s43, 0

    s_setprio 3
    v_mov_b32 v128, 0xbdd2d3e8
    v_mov_b32 v129, 0xbdd2d3e8
    v_mov_b32 v130, 0xc0135761
    v_mov_b32 v131, 0xc0135761
    v_mov_b32 v132, 1.0
    v_mov_b32 v133, 1.0
    v_mov_b32 v134, s28
    v_mov_b32 v135, s29
    v_mov_b32 v136, s30
    s_waitcnt vmcnt(6)
    v_lshlrev_b32_sdwa v88, 3, v116 dst_sel:DWORD dst_unused:UNUSED_PAD src0_sel:DWORD src1_sel:WORD_0
    v_lshlrev_b32_sdwa v90, 3, v116 dst_sel:DWORD dst_unused:UNUSED_PAD src0_sel:DWORD src1_sel:WORD_1
    ds_read_b64 v[88:89], v88
    ds_read_b64 v[90:91], v90
    v_lshlrev_b32_sdwa v92, 3, v117 dst_sel:DWORD dst_unused:UNUSED_PAD src0_sel:DWORD src1_sel:WORD_0
    v_lshlrev_b32_sdwa v94, 3, v117 dst_sel:DWORD dst_unused:UNUSED_PAD src0_sel:DWORD src1_sel:WORD_1
    ds_read_b64 v[92:93], v92
    ds_read_b64 v[94:95], v94
    s_waitcnt lgkmcnt(8)
    v_smfmac_f32_16x16x64_bf16 v[0:3], v[64:67], v[96:103], v68
    v_mov_b32 v137, s31
    v_lshrrev_b32 v70, 2, v69
    v_and_b32 v71, 128, v70
    v_add_u32 v70, v70, v71
    v_rcp_f32 v134, v134
    v_rcp_f32 v135, v135
    v_rcp_f32 v136, v136
    v_rcp_f32 v137, v137
    v_mov_b32 v132, 0x7f7fffff
    v_lshlrev_b32_sdwa v96, 3, v118 dst_sel:DWORD dst_unused:UNUSED_PAD src0_sel:DWORD src1_sel:WORD_0
    v_lshlrev_b32_sdwa v98, 3, v118 dst_sel:DWORD dst_unused:UNUSED_PAD src0_sel:DWORD src1_sel:WORD_1
    ds_read_b64 v[96:97], v96
    ds_read_b64 v[98:99], v98
    v_lshlrev_b32_sdwa v100, 3, v119 dst_sel:DWORD dst_unused:UNUSED_PAD src0_sel:DWORD src1_sel:WORD_0
    v_lshlrev_b32_sdwa v102, 3, v119 dst_sel:DWORD dst_unused:UNUSED_PAD src0_sel:DWORD src1_sel:WORD_1
    ds_read_b64 v[100:101], v100
    ds_read_b64 v[102:103], v102
    buffer_load_dwordx4 v[116:119], v69, s[12:15], s40 offen offset:0 sc1
    s_waitcnt lgkmcnt(8)
    v_smfmac_f32_16x16x64_bf16 v[4:7], v[64:67], v[104:111], v68
    v_mov_b32 v133, 0xff7fffff
    v_med3_f32 v134, v134, v132, v133
    v_med3_f32 v135, v135, v132, v133
    v_med3_f32 v136, v136, v132, v133
    v_med3_f32 v137, v137, v132, v133
    s_waitcnt vmcnt(3)
    v_mov_b32 v73, 0
    v_lshrrev_b32 v76, 2, v69
    v_mov_b32 v79, 0
    v_and_b32 v75, 0xf0, v69
    s_waitcnt vmcnt(2)
    v_lshlrev_b32_sdwa v104, 3, v120 dst_sel:DWORD dst_unused:UNUSED_PAD src0_sel:DWORD src1_sel:WORD_0
    v_lshlrev_b32_sdwa v106, 3, v120 dst_sel:DWORD dst_unused:UNUSED_PAD src0_sel:DWORD src1_sel:WORD_1
    ds_read_b64 v[104:105], v104
    ds_read_b64 v[106:107], v106
    v_lshlrev_b32_sdwa v108, 3, v121 dst_sel:DWORD dst_unused:UNUSED_PAD src0_sel:DWORD src1_sel:WORD_0
    v_lshlrev_b32_sdwa v110, 3, v121 dst_sel:DWORD dst_unused:UNUSED_PAD src0_sel:DWORD src1_sel:WORD_1
    ds_read_b64 v[108:109], v108
    ds_read_b64 v[110:111], v110
    s_waitcnt lgkmcnt(8)
    v_smfmac_f32_16x16x64_bf16 v[8:11], v[64:67], v[88:95], v68
    v_lshrrev_b32 v80, 8, v69
    v_lshl_add_u32 v74, v80, 16, v75
    v_lshl_add_u32 v75, v80, 2, v75
    v_add_u32 v77, s67, v76
    v_lshrrev_b32 v78, 1, v75
    v_lshlrev_b32_sdwa v88, 3, v122 dst_sel:DWORD dst_unused:UNUSED_PAD src0_sel:DWORD src1_sel:WORD_0
    v_lshlrev_b32_sdwa v90, 3, v122 dst_sel:DWORD dst_unused:UNUSED_PAD src0_sel:DWORD src1_sel:WORD_1
    ds_read_b64 v[88:89], v88
    ds_read_b64 v[90:91], v90
    v_lshlrev_b32_sdwa v92, 3, v123 dst_sel:DWORD dst_unused:UNUSED_PAD src0_sel:DWORD src1_sel:WORD_0
    v_lshlrev_b32_sdwa v94, 3, v123 dst_sel:DWORD dst_unused:UNUSED_PAD src0_sel:DWORD src1_sel:WORD_1
    ds_read_b64 v[92:93], v92
    ds_read_b64 v[94:95], v94
    buffer_load_dwordx4 v[120:123], v69, s[12:15], s44 offen offset:0 sc1
    s_waitcnt lgkmcnt(8)
    v_smfmac_f32_16x16x64_bf16 v[12:15], v[64:67], v[96:103], v68
    s_waitcnt vmcnt(2)
    v_lshlrev_b32_sdwa v96, 3, v124 dst_sel:DWORD dst_unused:UNUSED_PAD src0_sel:DWORD src1_sel:WORD_0
    v_lshlrev_b32_sdwa v98, 3, v124 dst_sel:DWORD dst_unused:UNUSED_PAD src0_sel:DWORD src1_sel:WORD_1
    ds_read_b64 v[96:97], v96
    ds_read_b64 v[98:99], v98
    v_lshlrev_b32_sdwa v100, 3, v125 dst_sel:DWORD dst_unused:UNUSED_PAD src0_sel:DWORD src1_sel:WORD_0
    v_lshlrev_b32_sdwa v102, 3, v125 dst_sel:DWORD dst_unused:UNUSED_PAD src0_sel:DWORD src1_sel:WORD_1
    ds_read_b64 v[100:101], v100
    ds_read_b64 v[102:103], v102
    s_waitcnt lgkmcnt(8)
    v_smfmac_f32_16x16x64_bf16 v[16:19], v[64:67], v[104:111], v68
    v_lshlrev_b32_sdwa v104, 3, v126 dst_sel:DWORD dst_unused:UNUSED_PAD src0_sel:DWORD src1_sel:WORD_0
    v_lshlrev_b32_sdwa v106, 3, v126 dst_sel:DWORD dst_unused:UNUSED_PAD src0_sel:DWORD src1_sel:WORD_1
    ds_read_b64 v[104:105], v104
    ds_read_b64 v[106:107], v106
    v_lshlrev_b32_sdwa v108, 3, v127 dst_sel:DWORD dst_unused:UNUSED_PAD src0_sel:DWORD src1_sel:WORD_0
    v_lshlrev_b32_sdwa v110, 3, v127 dst_sel:DWORD dst_unused:UNUSED_PAD src0_sel:DWORD src1_sel:WORD_1
    ds_read_b64 v[108:109], v108
    ds_read_b64 v[110:111], v110
    buffer_load_dwordx4 v[124:127], v69, s[12:15], s40 offen offset:1024 sc1
    s_waitcnt lgkmcnt(8)
    v_smfmac_f32_16x16x64_bf16 v[20:23], v[64:67], v[88:95], v68
    s_waitcnt vmcnt(2)
    v_lshlrev_b32_sdwa v88, 3, v116 dst_sel:DWORD dst_unused:UNUSED_PAD src0_sel:DWORD src1_sel:WORD_0
    v_lshlrev_b32_sdwa v90, 3, v116 dst_sel:DWORD dst_unused:UNUSED_PAD src0_sel:DWORD src1_sel:WORD_1
    ds_read_b64 v[88:89], v88
    ds_read_b64 v[90:91], v90
    v_lshlrev_b32_sdwa v92, 3, v117 dst_sel:DWORD dst_unused:UNUSED_PAD src0_sel:DWORD src1_sel:WORD_0
    v_lshlrev_b32_sdwa v94, 3, v117 dst_sel:DWORD dst_unused:UNUSED_PAD src0_sel:DWORD src1_sel:WORD_1
    ds_read_b64 v[92:93], v92
    ds_read_b64 v[94:95], v94
    s_waitcnt lgkmcnt(8)
    v_smfmac_f32_16x16x64_bf16 v[24:27], v[64:67], v[96:103], v68
    v_lshlrev_b32_sdwa v96, 3, v118 dst_sel:DWORD dst_unused:UNUSED_PAD src0_sel:DWORD src1_sel:WORD_0
    v_lshlrev_b32_sdwa v98, 3, v118 dst_sel:DWORD dst_unused:UNUSED_PAD src0_sel:DWORD src1_sel:WORD_1
    ds_read_b64 v[96:97], v96
    ds_read_b64 v[98:99], v98
    v_lshlrev_b32_sdwa v100, 3, v119 dst_sel:DWORD dst_unused:UNUSED_PAD src0_sel:DWORD src1_sel:WORD_0
    v_lshlrev_b32_sdwa v102, 3, v119 dst_sel:DWORD dst_unused:UNUSED_PAD src0_sel:DWORD src1_sel:WORD_1
    ds_read_b64 v[100:101], v100
    ds_read_b64 v[102:103], v102
    buffer_load_dwordx4 v[116:119], v69, s[12:15], s44 offen offset:1024 sc1
    s_waitcnt lgkmcnt(8)
    v_smfmac_f32_16x16x64_bf16 v[28:31], v[64:67], v[104:111], v68
    s_waitcnt vmcnt(2)
    v_lshlrev_b32_sdwa v104, 3, v120 dst_sel:DWORD dst_unused:UNUSED_PAD src0_sel:DWORD src1_sel:WORD_0
    v_lshlrev_b32_sdwa v106, 3, v120 dst_sel:DWORD dst_unused:UNUSED_PAD src0_sel:DWORD src1_sel:WORD_1
    ds_read_b64 v[104:105], v104
    ds_read_b64 v[106:107], v106
    v_lshlrev_b32_sdwa v108, 3, v121 dst_sel:DWORD dst_unused:UNUSED_PAD src0_sel:DWORD src1_sel:WORD_0
    v_lshlrev_b32_sdwa v110, 3, v121 dst_sel:DWORD dst_unused:UNUSED_PAD src0_sel:DWORD src1_sel:WORD_1
    ds_read_b64 v[108:109], v108
    ds_read_b64 v[110:111], v110
    s_waitcnt lgkmcnt(8)
    v_smfmac_f32_16x16x64_bf16 v[0:3], v[64:67], v[88:95], v68
    v_lshlrev_b32_sdwa v88, 3, v122 dst_sel:DWORD dst_unused:UNUSED_PAD src0_sel:DWORD src1_sel:WORD_0
    v_lshlrev_b32_sdwa v90, 3, v122 dst_sel:DWORD dst_unused:UNUSED_PAD src0_sel:DWORD src1_sel:WORD_1
    ds_read_b64 v[88:89], v88
    ds_read_b64 v[90:91], v90
    v_lshlrev_b32_sdwa v92, 3, v123 dst_sel:DWORD dst_unused:UNUSED_PAD src0_sel:DWORD src1_sel:WORD_0
    v_lshlrev_b32_sdwa v94, 3, v123 dst_sel:DWORD dst_unused:UNUSED_PAD src0_sel:DWORD src1_sel:WORD_1
    ds_read_b64 v[92:93], v92
    ds_read_b64 v[94:95], v94
    buffer_load_dwordx4 v[120:123], v69, s[12:15], s40 offen offset:2048 sc1
    s_waitcnt lgkmcnt(8)
    v_smfmac_f32_16x16x64_bf16 v[4:7], v[64:67], v[96:103], v68
    s_waitcnt vmcnt(2)
    v_lshlrev_b32_sdwa v96, 3, v124 dst_sel:DWORD dst_unused:UNUSED_PAD src0_sel:DWORD src1_sel:WORD_0
    v_lshlrev_b32_sdwa v98, 3, v124 dst_sel:DWORD dst_unused:UNUSED_PAD src0_sel:DWORD src1_sel:WORD_1
    ds_read_b64 v[96:97], v96
    ds_read_b64 v[98:99], v98
    v_lshlrev_b32_sdwa v100, 3, v125 dst_sel:DWORD dst_unused:UNUSED_PAD src0_sel:DWORD src1_sel:WORD_0
    v_lshlrev_b32_sdwa v102, 3, v125 dst_sel:DWORD dst_unused:UNUSED_PAD src0_sel:DWORD src1_sel:WORD_1
    ds_read_b64 v[100:101], v100
    ds_read_b64 v[102:103], v102
    s_waitcnt lgkmcnt(8)
    v_smfmac_f32_16x16x64_bf16 v[0:3], v[64:67], v[104:111], v68
    v_lshlrev_b32_sdwa v104, 3, v126 dst_sel:DWORD dst_unused:UNUSED_PAD src0_sel:DWORD src1_sel:WORD_0
    v_lshlrev_b32_sdwa v106, 3, v126 dst_sel:DWORD dst_unused:UNUSED_PAD src0_sel:DWORD src1_sel:WORD_1
    ds_read_b64 v[104:105], v104
    ds_read_b64 v[106:107], v106
    v_lshlrev_b32_sdwa v108, 3, v127 dst_sel:DWORD dst_unused:UNUSED_PAD src0_sel:DWORD src1_sel:WORD_0
    v_lshlrev_b32_sdwa v110, 3, v127 dst_sel:DWORD dst_unused:UNUSED_PAD src0_sel:DWORD src1_sel:WORD_1
    ds_read_b64 v[108:109], v108
    ds_read_b64 v[110:111], v110
    buffer_load_dwordx4 v[124:127], v69, s[12:15], s44 offen offset:2048 sc1
    s_waitcnt lgkmcnt(8)
    v_smfmac_f32_16x16x64_bf16 v[4:7], v[64:67], v[88:95], v68
    s_waitcnt vmcnt(2)
    v_lshlrev_b32_sdwa v88, 3, v116 dst_sel:DWORD dst_unused:UNUSED_PAD src0_sel:DWORD src1_sel:WORD_0
    v_lshlrev_b32_sdwa v90, 3, v116 dst_sel:DWORD dst_unused:UNUSED_PAD src0_sel:DWORD src1_sel:WORD_1
    ds_read_b64 v[88:89], v88
    ds_read_b64 v[90:91], v90
    v_lshlrev_b32_sdwa v92, 3, v117 dst_sel:DWORD dst_unused:UNUSED_PAD src0_sel:DWORD src1_sel:WORD_0
    v_lshlrev_b32_sdwa v94, 3, v117 dst_sel:DWORD dst_unused:UNUSED_PAD src0_sel:DWORD src1_sel:WORD_1
    ds_read_b64 v[92:93], v92
    ds_read_b64 v[94:95], v94
    s_waitcnt lgkmcnt(8)
    v_smfmac_f32_16x16x64_bf16 v[8:11], v[64:67], v[96:103], v68
    v_pk_mul_f32 v[140:141], v[0:1], v[0:1]
    v_pk_mul_f32 v[142:143], v[2:3], v[2:3]
    v_pk_fma_f32 v[140:141], v[140:141], v[128:129], v[130:131]
    v_pk_fma_f32 v[142:143], v[142:143], v[128:129], v[130:131]
    v_pk_mul_f32 v[140:141], v[140:141], v[0:1]
    v_pk_mul_f32 v[142:143], v[142:143], v[2:3]
    v_exp_f32 v140, v140
    v_pk_mul_f32 v[146:147], v[4:5], v[4:5]
    v_pk_mul_f32 v[148:149], v[6:7], v[6:7]
    v_lshlrev_b32_sdwa v96, 3, v118 dst_sel:DWORD dst_unused:UNUSED_PAD src0_sel:DWORD src1_sel:WORD_0
    v_lshlrev_b32_sdwa v98, 3, v118 dst_sel:DWORD dst_unused:UNUSED_PAD src0_sel:DWORD src1_sel:WORD_1
    ds_read_b64 v[96:97], v96
    ds_read_b64 v[98:99], v98
    v_lshlrev_b32_sdwa v100, 3, v119 dst_sel:DWORD dst_unused:UNUSED_PAD src0_sel:DWORD src1_sel:WORD_0
    v_lshlrev_b32_sdwa v102, 3, v119 dst_sel:DWORD dst_unused:UNUSED_PAD src0_sel:DWORD src1_sel:WORD_1
    ds_read_b64 v[100:101], v100
    ds_read_b64 v[102:103], v102
    buffer_load_dwordx4 v[116:119], v69, s[12:15], s40 offen offset:3072 sc1
    s_waitcnt lgkmcnt(8)
    v_smfmac_f32_16x16x64_bf16 v[12:15], v[64:67], v[104:111], v68
    v_exp_f32 v141, v141
    v_pk_fma_f32 v[146:147], v[146:147], v[128:129], v[130:131]
    v_pk_fma_f32 v[148:149], v[148:149], v[128:129], v[130:131]
    v_exp_f32 v142, v142
    v_pk_fma_f32 v[140:141], v[140:141], v[134:135], v[134:135]
    v_pk_mul_f32 v[146:147], v[146:147], v[4:5]
    v_rcp_f32 v140, v140
    v_pk_mul_f32 v[148:149], v[148:149], v[6:7]
    v_rcp_f32 v141, v141
    s_waitcnt vmcnt(2)
    v_lshlrev_b32_sdwa v104, 3, v120 dst_sel:DWORD dst_unused:UNUSED_PAD src0_sel:DWORD src1_sel:WORD_0
    v_lshlrev_b32_sdwa v106, 3, v120 dst_sel:DWORD dst_unused:UNUSED_PAD src0_sel:DWORD src1_sel:WORD_1
    ds_read_b64 v[104:105], v104
    ds_read_b64 v[106:107], v106
    v_lshlrev_b32_sdwa v108, 3, v121 dst_sel:DWORD dst_unused:UNUSED_PAD src0_sel:DWORD src1_sel:WORD_0
    v_lshlrev_b32_sdwa v110, 3, v121 dst_sel:DWORD dst_unused:UNUSED_PAD src0_sel:DWORD src1_sel:WORD_1
    ds_read_b64 v[108:109], v108
    ds_read_b64 v[110:111], v110
    s_waitcnt lgkmcnt(8)
    v_smfmac_f32_16x16x64_bf16 v[8:11], v[64:67], v[88:95], v68
    v_exp_f32 v143, v143
    v_pk_mul_f32 v[144:145], v[0:1], v[140:141]
    v_exp_f32 v146, v146
    v_pk_fma_f32 v[142:143], v[142:143], v[136:137], v[136:137]
    v_exp_f32 v147, v147
    v_rcp_f32 v142, v142
    v_rcp_f32 v143, v143
    v_pk_fma_f32 v[146:147], v[146:147], v[134:135], v[134:135]
    v_exp_f32 v148, v148
    v_lshlrev_b32_sdwa v88, 3, v122 dst_sel:DWORD dst_unused:UNUSED_PAD src0_sel:DWORD src1_sel:WORD_0
    v_lshlrev_b32_sdwa v90, 3, v122 dst_sel:DWORD dst_unused:UNUSED_PAD src0_sel:DWORD src1_sel:WORD_1
    ds_read_b64 v[88:89], v88
    ds_read_b64 v[90:91], v90
    v_lshlrev_b32_sdwa v92, 3, v123 dst_sel:DWORD dst_unused:UNUSED_PAD src0_sel:DWORD src1_sel:WORD_0
    v_lshlrev_b32_sdwa v94, 3, v123 dst_sel:DWORD dst_unused:UNUSED_PAD src0_sel:DWORD src1_sel:WORD_1
    ds_read_b64 v[92:93], v92
    ds_read_b64 v[94:95], v94
    buffer_load_dwordx4 v[120:123], v69, s[12:15], s44 offen offset:3072 sc1
    s_waitcnt lgkmcnt(8)
    v_smfmac_f32_16x16x64_bf16 v[12:15], v[64:67], v[96:103], v68
    v_rcp_f32 v146, v146
    v_pk_fma_f32 v[144:145], v[2:3], v[142:143], v[144:145]
    v_pk_mul_f32 v[152:153], v[8:9], v[8:9]
    v_rcp_f32 v147, v147
    v_add_f32 v144, v144, v145
    v_pk_fma_f32 v[152:153], v[152:153], v[128:129], v[130:131]
    v_exp_f32 v149, v149
    v_min_u32 v144, -2, v144
    v_pk_mul_f32 v[150:151], v[4:5], v[146:147]
    s_waitcnt vmcnt(2)
    v_lshlrev_b32_sdwa v96, 3, v124 dst_sel:DWORD dst_unused:UNUSED_PAD src0_sel:DWORD src1_sel:WORD_0
    v_lshlrev_b32_sdwa v98, 3, v124 dst_sel:DWORD dst_unused:UNUSED_PAD src0_sel:DWORD src1_sel:WORD_1
    ds_read_b64 v[96:97], v96
    ds_read_b64 v[98:99], v98
    v_lshlrev_b32_sdwa v100, 3, v125 dst_sel:DWORD dst_unused:UNUSED_PAD src0_sel:DWORD src1_sel:WORD_0
    v_lshlrev_b32_sdwa v102, 3, v125 dst_sel:DWORD dst_unused:UNUSED_PAD src0_sel:DWORD src1_sel:WORD_1
    ds_read_b64 v[100:101], v100
    ds_read_b64 v[102:103], v102
    s_waitcnt lgkmcnt(8)
    v_smfmac_f32_16x16x64_bf16 v[16:19], v[64:67], v[104:111], v68
    buffer_store_dword v144, v70, s[12:15], s35 offen offset:0 sc1
    v_pk_fma_f32 v[148:149], v[148:149], v[136:137], v[136:137]
    v_pk_mul_f32 v[152:153], v[152:153], v[8:9]
    v_rcp_f32 v148, v148
    v_pk_mul_f32 v[154:155], v[10:11], v[10:11]
    v_pk_mul_f32 v[158:159], v[12:13], v[12:13]
    v_rcp_f32 v149, v149
    v_pk_fma_f32 v[154:155], v[154:155], v[128:129], v[130:131]
    v_pk_fma_f32 v[158:159], v[158:159], v[128:129], v[130:131]
    v_lshlrev_b32_sdwa v104, 3, v126 dst_sel:DWORD dst_unused:UNUSED_PAD src0_sel:DWORD src1_sel:WORD_0
    v_lshlrev_b32_sdwa v106, 3, v126 dst_sel:DWORD dst_unused:UNUSED_PAD src0_sel:DWORD src1_sel:WORD_1
    ds_read_b64 v[104:105], v104
    ds_read_b64 v[106:107], v106
    v_lshlrev_b32_sdwa v108, 3, v127 dst_sel:DWORD dst_unused:UNUSED_PAD src0_sel:DWORD src1_sel:WORD_0
    v_lshlrev_b32_sdwa v110, 3, v127 dst_sel:DWORD dst_unused:UNUSED_PAD src0_sel:DWORD src1_sel:WORD_1
    ds_read_b64 v[108:109], v108
    ds_read_b64 v[110:111], v110
    buffer_load_dwordx4 v[124:127], v69, s[12:15], s20 offen offset:0 sc1
    s_waitcnt lgkmcnt(8)
    v_smfmac_f32_16x16x64_bf16 v[20:23], v[64:67], v[88:95], v68
    v_exp_f32 v152, v152
    v_pk_fma_f32 v[150:151], v[6:7], v[148:149], v[150:151]
    v_pk_mul_f32 v[154:155], v[154:155], v[10:11]
    v_exp_f32 v153, v153
    v_add_f32 v150, v150, v151
    v_pk_mul_f32 v[158:159], v[158:159], v[12:13]
    v_exp_f32 v154, v154
    v_min_u32 v150, -2, v150
    v_pk_fma_f32 v[152:153], v[152:153], v[134:135], v[134:135]
    s_waitcnt vmcnt(3)
    v_lshlrev_b32_sdwa v88, 3, v116 dst_sel:DWORD dst_unused:UNUSED_PAD src0_sel:DWORD src1_sel:WORD_0
    v_lshlrev_b32_sdwa v90, 3, v116 dst_sel:DWORD dst_unused:UNUSED_PAD src0_sel:DWORD src1_sel:WORD_1
    ds_read_b64 v[88:89], v88
    ds_read_b64 v[90:91], v90
    v_lshlrev_b32_sdwa v92, 3, v117 dst_sel:DWORD dst_unused:UNUSED_PAD src0_sel:DWORD src1_sel:WORD_0
    v_lshlrev_b32_sdwa v94, 3, v117 dst_sel:DWORD dst_unused:UNUSED_PAD src0_sel:DWORD src1_sel:WORD_1
    ds_read_b64 v[92:93], v92
    ds_read_b64 v[94:95], v94
    s_waitcnt lgkmcnt(8)
    v_smfmac_f32_16x16x64_bf16 v[16:19], v[64:67], v[96:103], v68
    v_rcp_f32 v152, v152
    buffer_store_dword v150, v70, s[12:15], s35 offen offset:128 sc1
    v_pk_mul_f32 v[160:161], v[14:15], v[14:15]
    v_rcp_f32 v153, v153
    v_pk_fma_f32 v[160:161], v[160:161], v[128:129], v[130:131]
    v_exp_f32 v155, v155
    v_pk_mul_f32 v[156:157], v[8:9], v[152:153]
    v_pk_mul_f32 v[160:161], v[160:161], v[14:15]
    v_exp_f32 v158, v158
    v_lshlrev_b32_sdwa v96, 3, v118 dst_sel:DWORD dst_unused:UNUSED_PAD src0_sel:DWORD src1_sel:WORD_0
    v_lshlrev_b32_sdwa v98, 3, v118 dst_sel:DWORD dst_unused:UNUSED_PAD src0_sel:DWORD src1_sel:WORD_1
    ds_read_b64 v[96:97], v96
    ds_read_b64 v[98:99], v98
    v_lshlrev_b32_sdwa v100, 3, v119 dst_sel:DWORD dst_unused:UNUSED_PAD src0_sel:DWORD src1_sel:WORD_0
    v_lshlrev_b32_sdwa v102, 3, v119 dst_sel:DWORD dst_unused:UNUSED_PAD src0_sel:DWORD src1_sel:WORD_1
    ds_read_b64 v[100:101], v100
    ds_read_b64 v[102:103], v102
    buffer_load_dwordx4 v[116:119], v69, s[12:15], s41 offen offset:0 sc1
    s_waitcnt lgkmcnt(8)
    v_smfmac_f32_16x16x64_bf16 v[20:23], v[64:67], v[104:111], v68
    v_exp_f32 v159, v159
    v_pk_fma_f32 v[154:155], v[154:155], v[136:137], v[136:137]
    v_pk_mul_f32 v[164:165], v[16:17], v[16:17]
    v_rcp_f32 v154, v154
    v_pk_fma_f32 v[158:159], v[158:159], v[134:135], v[134:135]
    v_pk_fma_f32 v[164:165], v[164:165], v[128:129], v[130:131]
    v_rcp_f32 v155, v155
    v_pk_mul_f32 v[164:165], v[164:165], v[16:17]
    v_pk_mul_f32 v[166:167], v[18:19], v[18:19]
    s_waitcnt vmcnt(4)
    v_lshlrev_b32_sdwa v104, 3, v120 dst_sel:DWORD dst_unused:UNUSED_PAD src0_sel:DWORD src1_sel:WORD_0
    v_lshlrev_b32_sdwa v106, 3, v120 dst_sel:DWORD dst_unused:UNUSED_PAD src0_sel:DWORD src1_sel:WORD_1
    ds_read_b64 v[104:105], v104
    ds_read_b64 v[106:107], v106
    v_lshlrev_b32_sdwa v108, 3, v121 dst_sel:DWORD dst_unused:UNUSED_PAD src0_sel:DWORD src1_sel:WORD_0
    v_lshlrev_b32_sdwa v110, 3, v121 dst_sel:DWORD dst_unused:UNUSED_PAD src0_sel:DWORD src1_sel:WORD_1
    ds_read_b64 v[108:109], v108
    ds_read_b64 v[110:111], v110
    s_waitcnt lgkmcnt(8)
    v_smfmac_f32_16x16x64_bf16 v[24:27], v[64:67], v[88:95], v68
    v_rcp_f32 v158, v158
    v_pk_fma_f32 v[156:157], v[10:11], v[154:155], v[156:157]
    v_pk_fma_f32 v[166:167], v[166:167], v[128:129], v[130:131]
    v_rcp_f32 v159, v159
    v_add_f32 v156, v156, v157
    v_pk_mul_f32 v[166:167], v[166:167], v[18:19]
    v_exp_f32 v160, v160
    v_min_u32 v156, -2, v156
    v_pk_mul_f32 v[162:163], v[12:13], v[158:159]
    v_lshlrev_b32_sdwa v88, 3, v122 dst_sel:DWORD dst_unused:UNUSED_PAD src0_sel:DWORD src1_sel:WORD_0
    v_lshlrev_b32_sdwa v90, 3, v122 dst_sel:DWORD dst_unused:UNUSED_PAD src0_sel:DWORD src1_sel:WORD_1
    ds_read_b64 v[88:89], v88
    ds_read_b64 v[90:91], v90
    v_lshlrev_b32_sdwa v92, 3, v123 dst_sel:DWORD dst_unused:UNUSED_PAD src0_sel:DWORD src1_sel:WORD_0
    v_lshlrev_b32_sdwa v94, 3, v123 dst_sel:DWORD dst_unused:UNUSED_PAD src0_sel:DWORD src1_sel:WORD_1
    ds_read_b64 v[92:93], v92
    ds_read_b64 v[94:95], v94
    buffer_load_dwordx4 v[120:123], v69, s[12:15], s45 offen offset:0 sc1
    s_waitcnt lgkmcnt(8)
    v_smfmac_f32_16x16x64_bf16 v[28:31], v[64:67], v[96:103], v68
    v_exp_f32 v161, v161
    buffer_store_dword v156, v70, s[12:15], s35 offen offset:512 sc1
    v_pk_mul_f32 v[170:171], v[20:21], v[20:21]
    v_exp_f32 v164, v164
    v_pk_fma_f32 v[160:161], v[160:161], v[136:137], v[136:137]
    v_pk_fma_f32 v[170:171], v[170:171], v[128:129], v[130:131]
    v_rcp_f32 v160, v160
    v_pk_mul_f32 v[170:171], v[170:171], v[20:21]
    v_pk_mul_f32 v[172:173], v[22:23], v[22:23]
    s_waitcnt vmcnt(4)
    v_lshlrev_b32_sdwa v96, 3, v124 dst_sel:DWORD dst_unused:UNUSED_PAD src0_sel:DWORD src1_sel:WORD_0
    v_lshlrev_b32_sdwa v98, 3, v124 dst_sel:DWORD dst_unused:UNUSED_PAD src0_sel:DWORD src1_sel:WORD_1
    ds_read_b64 v[96:97], v96
    ds_read_b64 v[98:99], v98
    v_lshlrev_b32_sdwa v100, 3, v125 dst_sel:DWORD dst_unused:UNUSED_PAD src0_sel:DWORD src1_sel:WORD_0
    v_lshlrev_b32_sdwa v102, 3, v125 dst_sel:DWORD dst_unused:UNUSED_PAD src0_sel:DWORD src1_sel:WORD_1
    ds_read_b64 v[100:101], v100
    ds_read_b64 v[102:103], v102
    s_waitcnt lgkmcnt(8)
    v_smfmac_f32_16x16x64_bf16 v[24:27], v[64:67], v[104:111], v68
    v_rcp_f32 v161, v161
    v_pk_fma_f32 v[172:173], v[172:173], v[128:129], v[130:131]
    v_exp_f32 v165, v165
    v_pk_fma_f32 v[162:163], v[14:15], v[160:161], v[162:163]
    v_pk_mul_f32 v[172:173], v[172:173], v[22:23]
    v_exp_f32 v166, v166
    v_add_f32 v162, v162, v163
    v_pk_fma_f32 v[164:165], v[164:165], v[134:135], v[134:135]
    v_exp_f32 v167, v167
    v_lshlrev_b32_sdwa v104, 3, v126 dst_sel:DWORD dst_unused:UNUSED_PAD src0_sel:DWORD src1_sel:WORD_0
    v_lshlrev_b32_sdwa v106, 3, v126 dst_sel:DWORD dst_unused:UNUSED_PAD src0_sel:DWORD src1_sel:WORD_1
    ds_read_b64 v[104:105], v104
    ds_read_b64 v[106:107], v106
    v_lshlrev_b32_sdwa v108, 3, v127 dst_sel:DWORD dst_unused:UNUSED_PAD src0_sel:DWORD src1_sel:WORD_0
    v_lshlrev_b32_sdwa v110, 3, v127 dst_sel:DWORD dst_unused:UNUSED_PAD src0_sel:DWORD src1_sel:WORD_1
    ds_read_b64 v[108:109], v108
    ds_read_b64 v[110:111], v110
    buffer_load_dwordx4 v[124:127], v69, s[12:15], s20 offen offset:1024 sc1
    s_waitcnt lgkmcnt(8)
    v_smfmac_f32_16x16x64_bf16 v[28:31], v[64:67], v[88:95], v68
    s_setprio 2
    v_rcp_f32 v164, v164
    v_min_u32 v162, -2, v162
    v_pk_fma_f32 v[166:167], v[166:167], v[136:137], v[136:137]
    v_rcp_f32 v165, v165
    buffer_store_dword v162, v70, s[12:15], s35 offen offset:640 sc1
    v_pk_mul_f32 v[140:141], v[24:25], v[24:25]
    v_rcp_f32 v166, v166
    v_pk_mul_f32 v[168:169], v[16:17], v[164:165]
    v_pk_fma_f32 v[140:141], v[140:141], v[128:129], v[130:131]
    s_waitcnt vmcnt(4)
    v_lshlrev_b32_sdwa v88, 3, v116 dst_sel:DWORD dst_unused:UNUSED_PAD src0_sel:DWORD src1_sel:WORD_0
    v_lshlrev_b32_sdwa v90, 3, v116 dst_sel:DWORD dst_unused:UNUSED_PAD src0_sel:DWORD src1_sel:WORD_1
    ds_read_b64 v[88:89], v88
    ds_read_b64 v[90:91], v90
    v_lshlrev_b32_sdwa v92, 3, v117 dst_sel:DWORD dst_unused:UNUSED_PAD src0_sel:DWORD src1_sel:WORD_0
    v_lshlrev_b32_sdwa v94, 3, v117 dst_sel:DWORD dst_unused:UNUSED_PAD src0_sel:DWORD src1_sel:WORD_1
    ds_read_b64 v[92:93], v92
    ds_read_b64 v[94:95], v94
    s_waitcnt lgkmcnt(8)
    v_smfmac_f32_16x16x64_bf16 v[32:35], v[64:67], v[96:103], v68
    v_rcp_f32 v167, v167
    v_pk_mul_f32 v[140:141], v[140:141], v[24:25]
    v_pk_mul_f32 v[142:143], v[26:27], v[26:27]
    v_exp_f32 v170, v170
    v_pk_fma_f32 v[168:169], v[18:19], v[166:167], v[168:169]
    v_pk_fma_f32 v[142:143], v[142:143], v[128:129], v[130:131]
    v_exp_f32 v171, v171
    v_add_f32 v168, v168, v169
    v_pk_mul_f32 v[142:143], v[142:143], v[26:27]
    v_lshlrev_b32_sdwa v96, 3, v118 dst_sel:DWORD dst_unused:UNUSED_PAD src0_sel:DWORD src1_sel:WORD_0
    v_lshlrev_b32_sdwa v98, 3, v118 dst_sel:DWORD dst_unused:UNUSED_PAD src0_sel:DWORD src1_sel:WORD_1
    ds_read_b64 v[96:97], v96
    ds_read_b64 v[98:99], v98
    v_lshlrev_b32_sdwa v100, 3, v119 dst_sel:DWORD dst_unused:UNUSED_PAD src0_sel:DWORD src1_sel:WORD_0
    v_lshlrev_b32_sdwa v102, 3, v119 dst_sel:DWORD dst_unused:UNUSED_PAD src0_sel:DWORD src1_sel:WORD_1
    ds_read_b64 v[100:101], v100
    ds_read_b64 v[102:103], v102
    buffer_load_dwordx4 v[116:119], v69, s[12:15], s41 offen offset:1024 sc1
    s_waitcnt lgkmcnt(8)
    v_smfmac_f32_16x16x64_bf16 v[36:39], v[64:67], v[104:111], v68
    v_exp_f32 v172, v172
    v_min_u32 v168, -2, v168
    v_pk_fma_f32 v[170:171], v[170:171], v[134:135], v[134:135]
    v_exp_f32 v173, v173
    buffer_store_dword v168, v70, s[12:15], s35 offen offset:1024 sc1
    v_pk_mul_f32 v[146:147], v[28:29], v[28:29]
    v_rcp_f32 v170, v170
    v_pk_fma_f32 v[172:173], v[172:173], v[136:137], v[136:137]
    v_pk_fma_f32 v[146:147], v[146:147], v[128:129], v[130:131]
    s_waitcnt vmcnt(5)
    v_lshlrev_b32_sdwa v104, 3, v120 dst_sel:DWORD dst_unused:UNUSED_PAD src0_sel:DWORD src1_sel:WORD_0
    v_lshlrev_b32_sdwa v106, 3, v120 dst_sel:DWORD dst_unused:UNUSED_PAD src0_sel:DWORD src1_sel:WORD_1
    ds_read_b64 v[104:105], v104
    ds_read_b64 v[106:107], v106
    v_lshlrev_b32_sdwa v108, 3, v121 dst_sel:DWORD dst_unused:UNUSED_PAD src0_sel:DWORD src1_sel:WORD_0
    v_lshlrev_b32_sdwa v110, 3, v121 dst_sel:DWORD dst_unused:UNUSED_PAD src0_sel:DWORD src1_sel:WORD_1
    ds_read_b64 v[108:109], v108
    ds_read_b64 v[110:111], v110
    s_waitcnt lgkmcnt(8)
    v_smfmac_f32_16x16x64_bf16 v[32:35], v[64:67], v[88:95], v68
    v_rcp_f32 v171, v171
    v_pk_mul_f32 v[146:147], v[146:147], v[28:29]
    v_pk_mul_f32 v[148:149], v[30:31], v[30:31]
    v_rcp_f32 v172, v172
    v_pk_mul_f32 v[174:175], v[20:21], v[170:171]
    v_pk_fma_f32 v[148:149], v[148:149], v[128:129], v[130:131]
    v_rcp_f32 v173, v173
    v_pk_mul_f32 v[148:149], v[148:149], v[30:31]
    v_exp_f32 v140, v140
    v_lshlrev_b32_sdwa v88, 3, v122 dst_sel:DWORD dst_unused:UNUSED_PAD src0_sel:DWORD src1_sel:WORD_0
    v_lshlrev_b32_sdwa v90, 3, v122 dst_sel:DWORD dst_unused:UNUSED_PAD src0_sel:DWORD src1_sel:WORD_1
    ds_read_b64 v[88:89], v88
    ds_read_b64 v[90:91], v90
    v_lshlrev_b32_sdwa v92, 3, v123 dst_sel:DWORD dst_unused:UNUSED_PAD src0_sel:DWORD src1_sel:WORD_0
    v_lshlrev_b32_sdwa v94, 3, v123 dst_sel:DWORD dst_unused:UNUSED_PAD src0_sel:DWORD src1_sel:WORD_1
    ds_read_b64 v[92:93], v92
    ds_read_b64 v[94:95], v94
    buffer_load_dwordx4 v[120:123], v69, s[12:15], s45 offen offset:1024 sc1
    s_waitcnt lgkmcnt(8)
    v_smfmac_f32_16x16x64_bf16 v[36:39], v[64:67], v[96:103], v68
    v_exp_f32 v141, v141
    v_pk_fma_f32 v[174:175], v[22:23], v[172:173], v[174:175]
    v_exp_f32 v142, v142
    v_add_f32 v174, v174, v175
    v_pk_fma_f32 v[140:141], v[140:141], v[134:135], v[134:135]
    v_exp_f32 v143, v143
    v_min_u32 v174, -2, v174
    v_rcp_f32 v140, v140
    buffer_store_dword v174, v70, s[12:15], s35 offen offset:1152 sc1
    s_waitcnt vmcnt(5)
    v_lshlrev_b32_sdwa v96, 3, v124 dst_sel:DWORD dst_unused:UNUSED_PAD src0_sel:DWORD src1_sel:WORD_0
    v_lshlrev_b32_sdwa v98, 3, v124 dst_sel:DWORD dst_unused:UNUSED_PAD src0_sel:DWORD src1_sel:WORD_1
    ds_read_b64 v[96:97], v96
    ds_read_b64 v[98:99], v98
    v_lshlrev_b32_sdwa v100, 3, v125 dst_sel:DWORD dst_unused:UNUSED_PAD src0_sel:DWORD src1_sel:WORD_0
    v_lshlrev_b32_sdwa v102, 3, v125 dst_sel:DWORD dst_unused:UNUSED_PAD src0_sel:DWORD src1_sel:WORD_1
    ds_read_b64 v[100:101], v100
    ds_read_b64 v[102:103], v102
    s_waitcnt lgkmcnt(8)
    v_smfmac_f32_16x16x64_bf16 v[32:35], v[64:67], v[104:111], v68
    v_rcp_f32 v141, v141
    v_pk_fma_f32 v[142:143], v[142:143], v[136:137], v[136:137]
    v_exp_f32 v146, v146
    v_pk_mul_f32 v[144:145], v[24:25], v[140:141]
    v_rcp_f32 v142, v142
    v_rcp_f32 v143, v143
    v_exp_f32 v147, v147
    v_exp_f32 v148, v148
    v_pk_fma_f32 v[144:145], v[26:27], v[142:143], v[144:145]
    v_lshlrev_b32_sdwa v104, 3, v126 dst_sel:DWORD dst_unused:UNUSED_PAD src0_sel:DWORD src1_sel:WORD_0
    v_lshlrev_b32_sdwa v106, 3, v126 dst_sel:DWORD dst_unused:UNUSED_PAD src0_sel:DWORD src1_sel:WORD_1
    ds_read_b64 v[104:105], v104
    ds_read_b64 v[106:107], v106
    v_lshlrev_b32_sdwa v108, 3, v127 dst_sel:DWORD dst_unused:UNUSED_PAD src0_sel:DWORD src1_sel:WORD_0
    v_lshlrev_b32_sdwa v110, 3, v127 dst_sel:DWORD dst_unused:UNUSED_PAD src0_sel:DWORD src1_sel:WORD_1
    ds_read_b64 v[108:109], v108
    ds_read_b64 v[110:111], v110
    buffer_load_dwordx4 v[124:127], v69, s[12:15], s20 offen offset:2048 sc1
    s_waitcnt lgkmcnt(8)
    v_smfmac_f32_16x16x64_bf16 v[36:39], v[64:67], v[88:95], v68
    v_exp_f32 v149, v149
    v_add_f32 v144, v144, v145
    v_pk_fma_f32 v[146:147], v[146:147], v[134:135], v[134:135]
    v_min_u32 v144, -2, v144
    v_rcp_f32 v146, v146
    buffer_store_dword v144, v70, s[12:15], s35 offen offset:1536 sc1
    v_pk_fma_f32 v[148:149], v[148:149], v[136:137], v[136:137]
    v_rcp_f32 v147, v147
    v_pk_mul_f32 v[152:153], v[32:33], v[32:33]
    s_waitcnt vmcnt(5)
    v_lshlrev_b32_sdwa v88, 3, v116 dst_sel:DWORD dst_unused:UNUSED_PAD src0_sel:DWORD src1_sel:WORD_0
    v_lshlrev_b32_sdwa v90, 3, v116 dst_sel:DWORD dst_unused:UNUSED_PAD src0_sel:DWORD src1_sel:WORD_1
    ds_read_b64 v[88:89], v88
    ds_read_b64 v[90:91], v90
    v_lshlrev_b32_sdwa v92, 3, v117 dst_sel:DWORD dst_unused:UNUSED_PAD src0_sel:DWORD src1_sel:WORD_0
    v_lshlrev_b32_sdwa v94, 3, v117 dst_sel:DWORD dst_unused:UNUSED_PAD src0_sel:DWORD src1_sel:WORD_1
    ds_read_b64 v[92:93], v92
    ds_read_b64 v[94:95], v94
    s_waitcnt lgkmcnt(8)
    v_smfmac_f32_16x16x64_bf16 v[40:43], v[64:67], v[96:103], v68
    v_rcp_f32 v148, v148
    v_pk_mul_f32 v[150:151], v[28:29], v[146:147]
    v_pk_fma_f32 v[152:153], v[152:153], v[128:129], v[130:131]
    v_rcp_f32 v149, v149
    v_pk_mul_f32 v[152:153], v[152:153], v[32:33]
    v_pk_mul_f32 v[154:155], v[34:35], v[34:35]
    v_exp_f32 v152, v152
    v_pk_fma_f32 v[150:151], v[30:31], v[148:149], v[150:151]
    v_pk_fma_f32 v[154:155], v[154:155], v[128:129], v[130:131]
    v_lshlrev_b32_sdwa v96, 3, v118 dst_sel:DWORD dst_unused:UNUSED_PAD src0_sel:DWORD src1_sel:WORD_0
    v_lshlrev_b32_sdwa v98, 3, v118 dst_sel:DWORD dst_unused:UNUSED_PAD src0_sel:DWORD src1_sel:WORD_1
    ds_read_b64 v[96:97], v96
    ds_read_b64 v[98:99], v98
    v_lshlrev_b32_sdwa v100, 3, v119 dst_sel:DWORD dst_unused:UNUSED_PAD src0_sel:DWORD src1_sel:WORD_0
    v_lshlrev_b32_sdwa v102, 3, v119 dst_sel:DWORD dst_unused:UNUSED_PAD src0_sel:DWORD src1_sel:WORD_1
    ds_read_b64 v[100:101], v100
    ds_read_b64 v[102:103], v102
    buffer_load_dwordx4 v[116:119], v69, s[12:15], s41 offen offset:2048 sc1
    s_waitcnt lgkmcnt(8)
    v_smfmac_f32_16x16x64_bf16 v[44:47], v[64:67], v[104:111], v68
    v_exp_f32 v153, v153
    v_add_f32 v150, v150, v151
    v_pk_mul_f32 v[154:155], v[154:155], v[34:35]
    v_min_u32 v150, -2, v150
    v_exp_f32 v154, v154
    buffer_store_dword v150, v70, s[12:15], s35 offen offset:1664 sc1
    v_pk_fma_f32 v[152:153], v[152:153], v[134:135], v[134:135]
    v_exp_f32 v155, v155
    v_pk_mul_f32 v[158:159], v[36:37], v[36:37]
    s_waitcnt vmcnt(5)
    v_lshlrev_b32_sdwa v104, 3, v120 dst_sel:DWORD dst_unused:UNUSED_PAD src0_sel:DWORD src1_sel:WORD_0
    v_lshlrev_b32_sdwa v106, 3, v120 dst_sel:DWORD dst_unused:UNUSED_PAD src0_sel:DWORD src1_sel:WORD_1
    ds_read_b64 v[104:105], v104
    ds_read_b64 v[106:107], v106
    v_lshlrev_b32_sdwa v108, 3, v121 dst_sel:DWORD dst_unused:UNUSED_PAD src0_sel:DWORD src1_sel:WORD_0
    v_lshlrev_b32_sdwa v110, 3, v121 dst_sel:DWORD dst_unused:UNUSED_PAD src0_sel:DWORD src1_sel:WORD_1
    ds_read_b64 v[108:109], v108
    ds_read_b64 v[110:111], v110
    s_waitcnt lgkmcnt(8)
    v_smfmac_f32_16x16x64_bf16 v[40:43], v[64:67], v[88:95], v68
    v_rcp_f32 v152, v152
    v_pk_fma_f32 v[154:155], v[154:155], v[136:137], v[136:137]
    v_pk_fma_f32 v[158:159], v[158:159], v[128:129], v[130:131]
    v_rcp_f32 v153, v153
    v_pk_mul_f32 v[158:159], v[158:159], v[36:37]
    v_pk_mul_f32 v[160:161], v[38:39], v[38:39]
    v_rcp_f32 v154, v154
    v_pk_mul_f32 v[156:157], v[32:33], v[152:153]
    v_pk_fma_f32 v[160:161], v[160:161], v[128:129], v[130:131]
    v_lshlrev_b32_sdwa v88, 3, v122 dst_sel:DWORD dst_unused:UNUSED_PAD src0_sel:DWORD src1_sel:WORD_0
    v_lshlrev_b32_sdwa v90, 3, v122 dst_sel:DWORD dst_unused:UNUSED_PAD src0_sel:DWORD src1_sel:WORD_1
    ds_read_b64 v[88:89], v88
    ds_read_b64 v[90:91], v90
    v_lshlrev_b32_sdwa v92, 3, v123 dst_sel:DWORD dst_unused:UNUSED_PAD src0_sel:DWORD src1_sel:WORD_0
    v_lshlrev_b32_sdwa v94, 3, v123 dst_sel:DWORD dst_unused:UNUSED_PAD src0_sel:DWORD src1_sel:WORD_1
    ds_read_b64 v[92:93], v92
    ds_read_b64 v[94:95], v94
    buffer_load_dwordx4 v[120:123], v69, s[12:15], s45 offen offset:2048 sc1
    s_waitcnt lgkmcnt(8)
    v_smfmac_f32_16x16x64_bf16 v[44:47], v[64:67], v[96:103], v68
    v_rcp_f32 v155, v155
    v_pk_mul_f32 v[160:161], v[160:161], v[38:39]
    v_exp_f32 v158, v158
    v_pk_fma_f32 v[156:157], v[34:35], v[154:155], v[156:157]
    v_exp_f32 v159, v159
    v_add_f32 v156, v156, v157
    v_exp_f32 v160, v160
    v_min_u32 v156, -2, v156
    v_pk_fma_f32 v[158:159], v[158:159], v[134:135], v[134:135]
    s_waitcnt vmcnt(4)
    v_lshlrev_b32_sdwa v96, 3, v124 dst_sel:DWORD dst_unused:UNUSED_PAD src0_sel:DWORD src1_sel:WORD_0
    v_lshlrev_b32_sdwa v98, 3, v124 dst_sel:DWORD dst_unused:UNUSED_PAD src0_sel:DWORD src1_sel:WORD_1
    ds_read_b64 v[96:97], v96
    ds_read_b64 v[98:99], v98
    v_lshlrev_b32_sdwa v100, 3, v125 dst_sel:DWORD dst_unused:UNUSED_PAD src0_sel:DWORD src1_sel:WORD_0
    v_lshlrev_b32_sdwa v102, 3, v125 dst_sel:DWORD dst_unused:UNUSED_PAD src0_sel:DWORD src1_sel:WORD_1
    ds_read_b64 v[100:101], v100
    ds_read_b64 v[102:103], v102
    s_waitcnt lgkmcnt(8)
    v_smfmac_f32_16x16x64_bf16 v[40:43], v[64:67], v[104:111], v68
    v_rcp_f32 v158, v158
    buffer_store_dword v156, v70, s[12:15], s35 offen offset:2048 sc1
    v_rcp_f32 v159, v159
    v_exp_f32 v161, v161
    v_lshlrev_b32_sdwa v104, 3, v126 dst_sel:DWORD dst_unused:UNUSED_PAD src0_sel:DWORD src1_sel:WORD_0
    v_lshlrev_b32_sdwa v106, 3, v126 dst_sel:DWORD dst_unused:UNUSED_PAD src0_sel:DWORD src1_sel:WORD_1
    ds_read_b64 v[104:105], v104
    ds_read_b64 v[106:107], v106
    v_lshlrev_b32_sdwa v108, 3, v127 dst_sel:DWORD dst_unused:UNUSED_PAD src0_sel:DWORD src1_sel:WORD_0
    v_lshlrev_b32_sdwa v110, 3, v127 dst_sel:DWORD dst_unused:UNUSED_PAD src0_sel:DWORD src1_sel:WORD_1
    ds_read_b64 v[108:109], v108
    ds_read_b64 v[110:111], v110
    buffer_load_dwordx4 v[124:127], v69, s[12:15], s20 offen offset:3072 sc1
    s_waitcnt lgkmcnt(8)
    v_smfmac_f32_16x16x64_bf16 v[44:47], v[64:67], v[88:95], v68
    v_pk_fma_f32 v[160:161], v[160:161], v[136:137], v[136:137]
    v_pk_mul_f32 v[162:163], v[36:37], v[158:159]
    v_rcp_f32 v160, v160
    v_pk_mul_f32 v[164:165], v[40:41], v[40:41]
    v_pk_mul_f32 v[166:167], v[42:43], v[42:43]
    v_rcp_f32 v161, v161
    v_pk_fma_f32 v[164:165], v[164:165], v[128:129], v[130:131]
    v_pk_fma_f32 v[166:167], v[166:167], v[128:129], v[130:131]
    v_pk_fma_f32 v[162:163], v[38:39], v[160:161], v[162:163]
    s_waitcnt vmcnt(4)
    v_lshlrev_b32_sdwa v88, 3, v116 dst_sel:DWORD dst_unused:UNUSED_PAD src0_sel:DWORD src1_sel:WORD_0
    v_lshlrev_b32_sdwa v90, 3, v116 dst_sel:DWORD dst_unused:UNUSED_PAD src0_sel:DWORD src1_sel:WORD_1
    ds_read_b64 v[88:89], v88
    ds_read_b64 v[90:91], v90
    v_lshlrev_b32_sdwa v92, 3, v117 dst_sel:DWORD dst_unused:UNUSED_PAD src0_sel:DWORD src1_sel:WORD_0
    v_lshlrev_b32_sdwa v94, 3, v117 dst_sel:DWORD dst_unused:UNUSED_PAD src0_sel:DWORD src1_sel:WORD_1
    ds_read_b64 v[92:93], v92
    ds_read_b64 v[94:95], v94
    s_waitcnt lgkmcnt(8)
    v_smfmac_f32_16x16x64_bf16 v[48:51], v[64:67], v[96:103], v68
    v_add_f32 v162, v162, v163
    v_pk_mul_f32 v[164:165], v[164:165], v[40:41]
    v_min_u32 v162, -2, v162
    v_exp_f32 v164, v164
    buffer_store_dword v162, v70, s[12:15], s35 offen offset:2176 sc1
    v_pk_mul_f32 v[166:167], v[166:167], v[42:43]
    v_exp_f32 v165, v165
    v_pk_mul_f32 v[170:171], v[44:45], v[44:45]
    v_pk_mul_f32 v[172:173], v[46:47], v[46:47]
    v_lshlrev_b32_sdwa v96, 3, v118 dst_sel:DWORD dst_unused:UNUSED_PAD src0_sel:DWORD src1_sel:WORD_0
    v_lshlrev_b32_sdwa v98, 3, v118 dst_sel:DWORD dst_unused:UNUSED_PAD src0_sel:DWORD src1_sel:WORD_1
    ds_read_b64 v[96:97], v96
    ds_read_b64 v[98:99], v98
    v_lshlrev_b32_sdwa v100, 3, v119 dst_sel:DWORD dst_unused:UNUSED_PAD src0_sel:DWORD src1_sel:WORD_0
    v_lshlrev_b32_sdwa v102, 3, v119 dst_sel:DWORD dst_unused:UNUSED_PAD src0_sel:DWORD src1_sel:WORD_1
    ds_read_b64 v[100:101], v100
    ds_read_b64 v[102:103], v102
    buffer_load_dwordx4 v[116:119], v69, s[12:15], s41 offen offset:3072 sc1
    s_waitcnt lgkmcnt(8)
    v_smfmac_f32_16x16x64_bf16 v[52:55], v[64:67], v[104:111], v68
    s_setprio 1
    v_exp_f32 v166, v166
    v_pk_fma_f32 v[164:165], v[164:165], v[134:135], v[134:135]
    v_pk_fma_f32 v[170:171], v[170:171], v[128:129], v[130:131]
    v_rcp_f32 v164, v164
    v_pk_mul_f32 v[170:171], v[170:171], v[44:45]
    v_pk_fma_f32 v[172:173], v[172:173], v[128:129], v[130:131]
    v_rcp_f32 v165, v165
    v_pk_mul_f32 v[172:173], v[172:173], v[46:47]
    v_exp_f32 v167, v167
    s_waitcnt vmcnt(4)
    v_lshlrev_b32_sdwa v104, 3, v120 dst_sel:DWORD dst_unused:UNUSED_PAD src0_sel:DWORD src1_sel:WORD_0
    v_lshlrev_b32_sdwa v106, 3, v120 dst_sel:DWORD dst_unused:UNUSED_PAD src0_sel:DWORD src1_sel:WORD_1
    ds_read_b64 v[104:105], v104
    ds_read_b64 v[106:107], v106
    v_lshlrev_b32_sdwa v108, 3, v121 dst_sel:DWORD dst_unused:UNUSED_PAD src0_sel:DWORD src1_sel:WORD_0
    v_lshlrev_b32_sdwa v110, 3, v121 dst_sel:DWORD dst_unused:UNUSED_PAD src0_sel:DWORD src1_sel:WORD_1
    ds_read_b64 v[108:109], v108
    ds_read_b64 v[110:111], v110
    s_waitcnt lgkmcnt(8)
    v_smfmac_f32_16x16x64_bf16 v[48:51], v[64:67], v[88:95], v68
    v_exp_f32 v170, v170
    v_pk_fma_f32 v[166:167], v[166:167], v[136:137], v[136:137]
    v_pk_mul_f32 v[168:169], v[40:41], v[164:165]
    v_rcp_f32 v166, v166
    v_rcp_f32 v167, v167
    v_exp_f32 v171, v171
    v_exp_f32 v172, v172
    v_pk_fma_f32 v[168:169], v[42:43], v[166:167], v[168:169]
    v_pk_fma_f32 v[170:171], v[170:171], v[134:135], v[134:135]
    v_lshlrev_b32_sdwa v88, 3, v122 dst_sel:DWORD dst_unused:UNUSED_PAD src0_sel:DWORD src1_sel:WORD_0
    v_lshlrev_b32_sdwa v90, 3, v122 dst_sel:DWORD dst_unused:UNUSED_PAD src0_sel:DWORD src1_sel:WORD_1
    ds_read_b64 v[88:89], v88
    ds_read_b64 v[90:91], v90
    v_lshlrev_b32_sdwa v92, 3, v123 dst_sel:DWORD dst_unused:UNUSED_PAD src0_sel:DWORD src1_sel:WORD_0
    v_lshlrev_b32_sdwa v94, 3, v123 dst_sel:DWORD dst_unused:UNUSED_PAD src0_sel:DWORD src1_sel:WORD_1
    ds_read_b64 v[92:93], v92
    ds_read_b64 v[94:95], v94
    buffer_load_dwordx4 v[120:123], v69, s[12:15], s45 offen offset:3072 sc1
    s_waitcnt lgkmcnt(8)
    v_smfmac_f32_16x16x64_bf16 v[52:55], v[64:67], v[96:103], v68
    v_rcp_f32 v170, v170
    v_add_f32 v168, v168, v169
    v_rcp_f32 v171, v171
    v_min_u32 v168, -2, v168
    v_exp_f32 v173, v173
    buffer_store_dword v168, v70, s[12:15], s35 offen offset:2560 sc1
    v_pk_mul_f32 v[174:175], v[44:45], v[170:171]
    v_pk_fma_f32 v[172:173], v[172:173], v[136:137], v[136:137]
    s_waitcnt vmcnt(4)
    v_lshlrev_b32_sdwa v96, 3, v124 dst_sel:DWORD dst_unused:UNUSED_PAD src0_sel:DWORD src1_sel:WORD_0
    v_lshlrev_b32_sdwa v98, 3, v124 dst_sel:DWORD dst_unused:UNUSED_PAD src0_sel:DWORD src1_sel:WORD_1
    ds_read_b64 v[96:97], v96
    ds_read_b64 v[98:99], v98
    v_lshlrev_b32_sdwa v100, 3, v125 dst_sel:DWORD dst_unused:UNUSED_PAD src0_sel:DWORD src1_sel:WORD_0
    v_lshlrev_b32_sdwa v102, 3, v125 dst_sel:DWORD dst_unused:UNUSED_PAD src0_sel:DWORD src1_sel:WORD_1
    ds_read_b64 v[100:101], v100
    ds_read_b64 v[102:103], v102
    s_waitcnt lgkmcnt(8)
    v_smfmac_f32_16x16x64_bf16 v[48:51], v[64:67], v[104:111], v68
    buffer_load_dword v72, v76, s[52:55], 0 offen offset:32 sc1
    buffer_load_short_d16_hi v73, v79, s[56:59], 0 offen
    buffer_load_ushort v81, v78, s[60:63], s68 offen
    buffer_load_dword v82, v79, s[12:15], s69 offen sc1
    v_rcp_f32 v172, v172
    v_rcp_f32 v173, v173
    v_lshlrev_b32_sdwa v104, 3, v126 dst_sel:DWORD dst_unused:UNUSED_PAD src0_sel:DWORD src1_sel:WORD_0
    v_lshlrev_b32_sdwa v106, 3, v126 dst_sel:DWORD dst_unused:UNUSED_PAD src0_sel:DWORD src1_sel:WORD_1
    ds_read_b64 v[104:105], v104
    ds_read_b64 v[106:107], v106
    v_lshlrev_b32_sdwa v108, 3, v127 dst_sel:DWORD dst_unused:UNUSED_PAD src0_sel:DWORD src1_sel:WORD_0
    v_lshlrev_b32_sdwa v110, 3, v127 dst_sel:DWORD dst_unused:UNUSED_PAD src0_sel:DWORD src1_sel:WORD_1
    ds_read_b64 v[108:109], v108
    ds_read_b64 v[110:111], v110
    s_waitcnt lgkmcnt(8)
    v_smfmac_f32_16x16x64_bf16 v[52:55], v[64:67], v[88:95], v68
    v_pk_fma_f32 v[174:175], v[46:47], v[172:173], v[174:175]
    v_pk_mul_f32 v[140:141], v[48:49], v[48:49]
    v_add_f32 v174, v174, v175
    v_pk_fma_f32 v[140:141], v[140:141], v[128:129], v[130:131]
    v_min_u32 v174, -2, v174
    v_pk_mul_f32 v[140:141], v[140:141], v[48:49]
    buffer_store_dword v174, v70, s[12:15], s35 offen offset:2688 sc1
    v_exp_f32 v140, v140
    v_pk_mul_f32 v[142:143], v[50:51], v[50:51]
    s_waitcnt vmcnt(7)
    v_lshlrev_b32_sdwa v88, 3, v116 dst_sel:DWORD dst_unused:UNUSED_PAD src0_sel:DWORD src1_sel:WORD_0
    v_lshlrev_b32_sdwa v90, 3, v116 dst_sel:DWORD dst_unused:UNUSED_PAD src0_sel:DWORD src1_sel:WORD_1
    ds_read_b64 v[88:89], v88
    ds_read_b64 v[90:91], v90
    v_lshlrev_b32_sdwa v92, 3, v117 dst_sel:DWORD dst_unused:UNUSED_PAD src0_sel:DWORD src1_sel:WORD_0
    v_lshlrev_b32_sdwa v94, 3, v117 dst_sel:DWORD dst_unused:UNUSED_PAD src0_sel:DWORD src1_sel:WORD_1
    ds_read_b64 v[92:93], v92
    ds_read_b64 v[94:95], v94
    s_waitcnt lgkmcnt(8)
    v_smfmac_f32_16x16x64_bf16 v[56:59], v[64:67], v[96:103], v68
    v_exp_f32 v141, v141
    v_pk_fma_f32 v[142:143], v[142:143], v[128:129], v[130:131]
    v_pk_mul_f32 v[146:147], v[52:53], v[52:53]
    v_pk_fma_f32 v[140:141], v[140:141], v[134:135], v[134:135]
    v_pk_mul_f32 v[142:143], v[142:143], v[50:51]
    v_rcp_f32 v140, v140
    v_pk_fma_f32 v[146:147], v[146:147], v[128:129], v[130:131]
    v_pk_mul_f32 v[148:149], v[54:55], v[54:55]
    v_rcp_f32 v141, v141
    v_lshlrev_b32_sdwa v96, 3, v118 dst_sel:DWORD dst_unused:UNUSED_PAD src0_sel:DWORD src1_sel:WORD_0
    v_lshlrev_b32_sdwa v98, 3, v118 dst_sel:DWORD dst_unused:UNUSED_PAD src0_sel:DWORD src1_sel:WORD_1
    ds_read_b64 v[96:97], v96
    ds_read_b64 v[98:99], v98
    v_lshlrev_b32_sdwa v100, 3, v119 dst_sel:DWORD dst_unused:UNUSED_PAD src0_sel:DWORD src1_sel:WORD_0
    v_lshlrev_b32_sdwa v102, 3, v119 dst_sel:DWORD dst_unused:UNUSED_PAD src0_sel:DWORD src1_sel:WORD_1
    ds_read_b64 v[100:101], v100
    ds_read_b64 v[102:103], v102
    s_waitcnt lgkmcnt(8)
    v_smfmac_f32_16x16x64_bf16 v[60:63], v[64:67], v[104:111], v68
    v_exp_f32 v142, v142
    v_pk_mul_f32 v[144:145], v[48:49], v[140:141]
    v_pk_mul_f32 v[146:147], v[146:147], v[52:53]
    v_exp_f32 v143, v143
    v_pk_fma_f32 v[148:149], v[148:149], v[128:129], v[130:131]
    v_exp_f32 v146, v146
    v_pk_fma_f32 v[142:143], v[142:143], v[136:137], v[136:137]
    v_pk_mul_f32 v[148:149], v[148:149], v[54:55]
    v_rcp_f32 v142, v142
    s_waitcnt vmcnt(6)
    v_lshlrev_b32_sdwa v104, 3, v120 dst_sel:DWORD dst_unused:UNUSED_PAD src0_sel:DWORD src1_sel:WORD_0
    v_lshlrev_b32_sdwa v106, 3, v120 dst_sel:DWORD dst_unused:UNUSED_PAD src0_sel:DWORD src1_sel:WORD_1
    ds_read_b64 v[104:105], v104
    ds_read_b64 v[106:107], v106
    v_lshlrev_b32_sdwa v108, 3, v121 dst_sel:DWORD dst_unused:UNUSED_PAD src0_sel:DWORD src1_sel:WORD_0
    v_lshlrev_b32_sdwa v110, 3, v121 dst_sel:DWORD dst_unused:UNUSED_PAD src0_sel:DWORD src1_sel:WORD_1
    ds_read_b64 v[108:109], v108
    ds_read_b64 v[110:111], v110
    s_waitcnt lgkmcnt(8)
    v_smfmac_f32_16x16x64_bf16 v[56:59], v[64:67], v[88:95], v68
    v_rcp_f32 v143, v143
    v_exp_f32 v147, v147
    v_exp_f32 v148, v148
    v_pk_fma_f32 v[144:145], v[50:51], v[142:143], v[144:145]
    v_pk_fma_f32 v[146:147], v[146:147], v[134:135], v[134:135]
    v_exp_f32 v149, v149
    v_add_f32 v144, v144, v145
    v_rcp_f32 v146, v146
    v_min_u32 v144, -2, v144
    v_lshlrev_b32_sdwa v88, 3, v122 dst_sel:DWORD dst_unused:UNUSED_PAD src0_sel:DWORD src1_sel:WORD_0
    v_lshlrev_b32_sdwa v90, 3, v122 dst_sel:DWORD dst_unused:UNUSED_PAD src0_sel:DWORD src1_sel:WORD_1
    ds_read_b64 v[88:89], v88
    ds_read_b64 v[90:91], v90
    v_lshlrev_b32_sdwa v92, 3, v123 dst_sel:DWORD dst_unused:UNUSED_PAD src0_sel:DWORD src1_sel:WORD_0
    v_lshlrev_b32_sdwa v94, 3, v123 dst_sel:DWORD dst_unused:UNUSED_PAD src0_sel:DWORD src1_sel:WORD_1
    ds_read_b64 v[92:93], v92
    ds_read_b64 v[94:95], v94
    s_waitcnt lgkmcnt(8)
    v_smfmac_f32_16x16x64_bf16 v[60:63], v[64:67], v[96:103], v68
    s_setprio 0
    v_rcp_f32 v147, v147
    buffer_store_dword v144, v70, s[12:15], s35 offen offset:3072 sc1
    v_pk_fma_f32 v[148:149], v[148:149], v[136:137], v[136:137]
    v_pk_mul_f32 v[150:151], v[52:53], v[146:147]
    v_rcp_f32 v148, v148
    v_rcp_f32 v149, v149
    s_waitcnt lgkmcnt(4)
    v_smfmac_f32_16x16x64_bf16 v[56:59], v[64:67], v[104:111], v68
    v_pk_fma_f32 v[150:151], v[54:55], v[148:149], v[150:151]
    s_waitcnt lgkmcnt(0)
    v_smfmac_f32_16x16x64_bf16 v[60:63], v[64:67], v[88:95], v68
    v_add_f32 v150, v150, v151
    s_nop 0
    v_min_u32 v150, -2, v150
    s_nop 0
    buffer_store_dword v150, v70, s[12:15], s35 offen offset:3200 sc1
    s_nop 0
    s_nop 0
    s_nop 0
    s_nop 0
    v_pk_mul_f32 v[152:153], v[56:57], v[56:57]
    v_pk_mul_f32 v[154:155], v[58:59], v[58:59]
    v_pk_fma_f32 v[152:153], v[152:153], v[128:129], v[130:131]
    v_pk_fma_f32 v[154:155], v[154:155], v[128:129], v[130:131]
    v_pk_mul_f32 v[152:153], v[152:153], v[56:57]
    v_pk_mul_f32 v[154:155], v[154:155], v[58:59]
    v_exp_f32 v152, v152
    v_pk_mul_f32 v[158:159], v[60:61], v[60:61]
    v_pk_mul_f32 v[160:161], v[62:63], v[62:63]
    v_exp_f32 v153, v153
    v_pk_fma_f32 v[158:159], v[158:159], v[128:129], v[130:131]
    v_pk_fma_f32 v[160:161], v[160:161], v[128:129], v[130:131]
    v_exp_f32 v154, v154
    v_pk_fma_f32 v[152:153], v[152:153], v[134:135], v[134:135]
    v_pk_mul_f32 v[158:159], v[158:159], v[60:61]
    v_rcp_f32 v152, v152
    v_pk_mul_f32 v[160:161], v[160:161], v[62:63]
    v_rcp_f32 v153, v153
    v_exp_f32 v155, v155
    v_exp_f32 v158, v158
    v_pk_mul_f32 v[156:157], v[56:57], v[152:153]
    v_pk_fma_f32 v[154:155], v[154:155], v[136:137], v[136:137]
    v_exp_f32 v159, v159
    v_rcp_f32 v154, v154
    v_rcp_f32 v155, v155
    v_pk_fma_f32 v[158:159], v[158:159], v[134:135], v[134:135]
    v_exp_f32 v160, v160
    v_pk_fma_f32 v[156:157], v[58:59], v[154:155], v[156:157]
    v_rcp_f32 v158, v158
    v_add_f32 v156, v156, v157
    v_rcp_f32 v159, v159
    v_min_u32 v156, -2, v156
    v_exp_f32 v161, v161
    buffer_store_dword v156, v70, s[12:15], s35 offen offset:3584 sc1
    v_pk_mul_f32 v[162:163], v[60:61], v[158:159]
    v_pk_fma_f32 v[160:161], v[160:161], v[136:137], v[136:137]
    s_nop 0
    v_rcp_f32 v160, v160
    v_rcp_f32 v161, v161
    s_nop 0
    s_nop 0
    v_pk_fma_f32 v[162:163], v[62:63], v[160:161], v[162:163]
    s_nop 0
    v_add_f32 v162, v162, v163
    s_nop 0
    v_min_u32 v162, -2, v162
    s_nop 0
    buffer_store_dword v162, v70, s[12:15], s35 offen offset:3712 sc1
    s_waitcnt vmcnt(5)

    v_cmp_ne_u32 vcc, 128, v72
    s_and_b32 s44, vcc_hi, 0x1
    s_and_b32 s45, vcc_lo, 0x1
    s_or_b32 s45, s45, s44
    s_cbranch_scc1 k1_kernel_rslow

k1_kernel_rjob:

    s_lshl_b32 s67, s64, 8
    s_add_u32 s68, s67, 29360128
    s_add_u32 s69, s68, 65536
    s_add_u32 s67, s67, 20971520

k1_kernel_rgrp:

    s_add_u32 s70, s67, s65
    s_add_u32 s71, s70, 262144
    s_add_u32 s72, s70, 524288
    s_add_u32 s73, s70, 786432
    s_add_u32 s65, s65, 1048576

    buffer_load_dwordx4 v[0:3], v74, s[12:15], s70 offen sc1
    buffer_load_dwordx4 v[4:7], v74, s[12:15], s71 offen sc1
    buffer_load_dwordx4 v[8:11], v74, s[12:15], s72 offen sc1
    buffer_load_dwordx4 v[12:15], v74, s[12:15], s73 offen sc1
    buffer_load_dword v16, v75, s[12:15], s68 offen sc1
    buffer_load_dword v17, v75, s[12:15], s69 offen sc1
    s_branch k1_kernel_rchk
k1_kernel_rpoll:
    s_mov_b64 exec, s[74:75]
    s_cbranch_execz k1_kernel_rsk0
    buffer_load_dwordx4 v[0:3], v74, s[12:15], s70 offen sc1
k1_kernel_rsk0:
    s_mov_b64 exec, s[76:77]
    s_cbranch_execz k1_kernel_rsk1
    buffer_load_dwordx4 v[4:7], v74, s[12:15], s71 offen sc1
k1_kernel_rsk1:
    s_mov_b64 exec, s[78:79]
    s_cbranch_execz k1_kernel_rsk2
    buffer_load_dwordx4 v[8:11], v74, s[12:15], s72 offen sc1
k1_kernel_rsk2:
    s_mov_b64 exec, s[80:81]
    s_cbranch_execz k1_kernel_rsk3
    buffer_load_dwordx4 v[12:15], v74, s[12:15], s73 offen sc1
k1_kernel_rsk3:
    s_mov_b64 exec, -1
k1_kernel_rchk:
    s_waitcnt vmcnt(0)
k1_kernel_rchk0:
    v_max3_u32 v20, v0, v1, v2
    v_max3_u32 v21, v4, v5, v6
    v_max3_u32 v22, v8, v9, v10
    v_max3_u32 v23, v12, v13, v14
    v_max_u32 v20, v20, v3
    v_max_u32 v21, v21, v7
    v_max_u32 v22, v22, v11
    v_max_u32 v23, v23, v15
    v_cmp_eq_u32 s[74:75], -1, v20
    v_cmp_eq_u32 s[76:77], -1, v21
    v_cmp_eq_u32 s[78:79], -1, v22
    v_cmp_eq_u32 s[80:81], -1, v23

    v_pk_add_f32 v[26:27], v[0:1], v[4:5]
    v_pk_add_f32 v[28:29], v[2:3], v[6:7]
    v_pk_add_f32 v[30:31], v[8:9], v[12:13]
    v_pk_add_f32 v[32:33], v[10:11], v[14:15]
    s_or_b64 s[82:83], s[74:75], s[76:77]
    s_or_b64 s[84:85], s[78:79], s[80:81]
    v_pk_add_f32 v[26:27], v[26:27], v[30:31]
    v_pk_add_f32 v[28:29], v[28:29], v[32:33]
    s_or_b64 s[82:83], s[82:83], s[84:85]
    s_cbranch_scc1 k1_kernel_rpoll
    v_permlane32_swap_b32 v26, v28
    v_permlane32_swap_b32 v27, v29
    s_cmp_lt_u32 s65, s66
    s_nop 0
    v_pk_add_f32 v[26:27], v[26:27], v[28:29]
    s_nop 1
    v_permlane16_swap_b32 v26, v27
    s_nop 1
    v_add_f32 v26, v26, v27
    v_add_f32 v79, v79, v26
    s_cbranch_scc1 k1_kernel_rgrp
    s_cmp_lg_u32 s43, 0
    s_cbranch_scc1 k1_kernel_rpn
    ds_write_b32 v77, v79
    s_cmp_lg_u32 s3, 0
    s_waitcnt lgkmcnt(0)
    s_barrier
    s_cbranch_scc1 k1_kernel_rend

    ds_read2st64_b32 v[40:41], v77 offset0:0 offset1:1
    ds_read2st64_b32 v[42:43], v77 offset0:2 offset1:3
    ds_read2st64_b32 v[44:45], v77 offset0:4 offset1:5
    ds_read2st64_b32 v[46:47], v77 offset0:6 offset1:7

    s_waitcnt lgkmcnt(2)
    v_pk_add_f32 v[26:27], v[40:41], v[42:43]
    v_max3_u32 v20, v41, v42, v43
    s_waitcnt lgkmcnt(0)
    v_pk_add_f32 v[28:29], v[44:45], v[46:47]
    v_max3_u32 v20, v20, v44, v45
    v_pk_add_f32 v[26:27], v[26:27], v[28:29]
    v_max3_u32 v20, v20, v46, v47
    v_add_f32 v79, v26, v27
    v_cmp_eq_u32 vcc, -1, v20
    s_cbranch_vccnz k1_kernel_rnext

k1_kernel_rpn:

    v_max_u32 v20, v16, v17
    v_add_f32 v21, v16, v17
    v_cmp_eq_u32 vcc, -1, v20
    v_cvt_pk_bf16_f32 v21, v79, v21
    s_cbranch_vccnz k1_kernel_rpn2
    v_lshlrev_b32 v22, 16, v21
    v_and_b32 v21, 0xffff0000, v21
    v_add_f32 v22, v22, v73
    v_cvt_pk_bf16_f32 v22, v22, v22
    v_lshlrev_b32 v22, 16, v22
    v_add_f32 v22, v22, v21
    s_lshl_b32 s45, s64, 7
    v_cvt_pk_bf16_f32 v22, v22, v22
    buffer_store_short v22, v78, s[60:63], s45 offen

k1_kernel_rnext:

    v_cmp_ne_u32 vcc, 0, v72
    s_and_b32 s45, vcc_lo, 0xff00
    s_cbranch_scc1 k1_kernel_rmore

k1_kernel_rend:
    s_endpgm
k1_kernel_rpn2:
    buffer_load_dword v16, v75, s[12:15], s68 offen sc1
    buffer_load_dword v17, v75, s[12:15], s69 offen sc1
    s_waitcnt vmcnt(0)
    s_branch k1_kernel_rpn
k1_kernel_rmore:

    s_ff1_i32_b32 s45, s45
    s_mov_b32 s43, 1
    s_mov_b32 s65, 0
    s_mov_b32 s66, 8388608
    v_readlane_b32 s44, v72, s45
    v_mov_b32 v79, 0
    s_mov_b32 m0, s45
    s_ff1_i32_b32 s64, s44
    s_bitset0_b32 s44, s64
    s_sub_u32 s45, s45, 8
    s_lshl_b32 s45, s45, 5
    s_add_u32 s64, s64, s45
    v_writelane_b32 v72, s44, m0
    s_branch k1_kernel_rjob

k1_kernel_rslow:
    s_lshl_b32 s65, s3, 20
    buffer_load_dword v72, v76, s[52:55], 0 offen offset:32 sc1
    s_waitcnt vmcnt(0)

    v_cmp_ne_u32 vcc, 128, v72
    s_and_b32 s44, vcc_hi, 0x1
    s_and_b32 s45, vcc_lo, 0x1
    s_or_b32 s45, s45, s44
    s_cbranch_scc0 k1_kernel_rjob

    s_add_u32 s42, s42, 1
    s_cmp_lt_u32 s42, 200
    s_cbranch_scc1 k1_kernel_rslow
    s_lshl_b32 s44, 1, s64
    s_lshr_b32 s45, s64, 5
    s_lshl_b32 s45, s45, 2
    v_mov_b32 v20, s44
    s_mov_b64 exec, 1
    buffer_atomic_or v20, v76, s[52:55], s45 offen offset:64 sc0
    s_mov_b64 exec, -1
    s_waitcnt vmcnt(0)
    buffer_load_dword v72, v76, s[52:55], 0 offen offset:32 sc1
    s_waitcnt vmcnt(0)

    v_cmp_ne_u32 vcc, 128, v72
    s_and_b32 s44, vcc_hi, 0x1
    s_and_b32 s45, vcc_lo, 0x1
    s_or_b32 s45, s45, s44
    s_cbranch_scc0 k1_kernel_rjob

    v_mov_b32 v20, -1
    ds_write_b32 v77, v20
    s_waitcnt lgkmcnt(0)
    s_endpgm

k1_kernel_end:
    s_endpgm
k1_kernel_main:
    s_setprio 3
    s_mov_b32 s16, s4
    s_and_b32 s17, s5, 0xffff
    s_mov_b32 s20, s6
    s_and_b32 s21, s7, 0xffff
    s_mov_b32 s28, s10
    s_and_b32 s29, s11, 0xffff
    s_mov_b32 s32, s12
    s_and_b32 s33, s13, 0xffff
    s_and_b32 s13, s13, 0xffff
    s_and_b32 s53, s53, 0xffff

    v_and_b32 v5, 15, v255
    v_lshrrev_b32 v6, 4, v255
    v_and_b32 v7, 3, v255
    v_bfe_u32 v8, v255, 2, 2
    v_lshl_add_u32 v9, v7, 2, v8
    v_cmp_eq_u32 s[46:47], 0, v7
    s_movk_i32 s45, 200
    v_mov_b32 v10, 144384
    v_mad_u32_u24 v11, v9, s45, v10
    v_and_b32 v213, 48, v255
    v_add_u32 v128, v11, v213
    v_mul_u32_u24 v12, 6400, v6
    v_add_u32 v132, v11, v12
    v_and_b32 v12, 16, v255
    v_add_u32 v10, v10, v12
    v_add_u32 v11, v11, v12
    v_and_b32 v12, 32, v255
    v_mul_u32_u24 v12, 100, v12
    v_add_u32 v131, v11, v12
    v_and_b32 v12, 8, v255
    v_lshl_add_u32 v13, v7, 1, v12
    v_and_b32 v14, 1, v8
    v_add_u32 v13, v13, v14
    v_lshrrev_b32 v14, 5, v255
    v_lshl_add_u32 v14, v13, 1, v14
    v_mad_u32_u24 v129, v14, s45, v10
    v_lshl_add_u32 v130, v12, 2, v129
    v_lshlrev_b32 v15, 2, v6
    v_sub_u32 v13, v13, v15
    v_lshrrev_b32 v14, 1, v9
    v_sub_u32 v14, v14, v15
    v_sub_u32 v15, v5, v15
    v_and_b32 v12, 1, v9
    v_lshlrev_b32 v12, 4, v12
    v_mov_b32 v16, 0x3f80
    v_lshlrev_b32 v12, v12, v16
    v_mov_b32 v17, 0x3f800000

    v_cmp_eq_u32 vcc, 0, v13
    v_cndmask_b32 v120, 0, v16, vcc
    v_cmp_eq_u32 vcc, 0, v14
    v_cndmask_b32 v112, 0, v12, vcc
    v_cmp_eq_u32 vcc, -8, v14
    v_cndmask_b32 v116, 0, v12, vcc
    v_cmp_eq_u32 vcc, 0, v15
    v_cndmask_b32 v200, 0, v17, vcc
    v_lshlrev_b32 v124, 16, v120

    v_cmp_eq_u32 vcc, 1, v13
    v_cndmask_b32 v121, 0, v16, vcc
    v_cmp_eq_u32 vcc, 1, v14
    v_cndmask_b32 v113, 0, v12, vcc
    v_cmp_eq_u32 vcc, -7, v14
    v_cndmask_b32 v117, 0, v12, vcc
    v_cmp_eq_u32 vcc, 1, v15
    v_cndmask_b32 v201, 0, v17, vcc
    v_lshlrev_b32 v125, 16, v121

    v_cmp_eq_u32 vcc, 2, v13
    v_cndmask_b32 v122, 0, v16, vcc
    v_cmp_eq_u32 vcc, 2, v14
    v_cndmask_b32 v114, 0, v12, vcc
    v_cmp_eq_u32 vcc, -6, v14
    v_cndmask_b32 v118, 0, v12, vcc
    v_cmp_eq_u32 vcc, 2, v15
    v_cndmask_b32 v202, 0, v17, vcc
    v_lshlrev_b32 v126, 16, v122

    v_cmp_eq_u32 vcc, 3, v13
    v_cndmask_b32 v123, 0, v16, vcc
    v_cmp_eq_u32 vcc, 3, v14
    v_cndmask_b32 v115, 0, v12, vcc
    v_cmp_eq_u32 vcc, -5, v14
    v_cndmask_b32 v119, 0, v12, vcc
    v_cmp_eq_u32 vcc, 3, v15
    v_cndmask_b32 v203, 0, v17, vcc
    v_lshlrev_b32 v127, 16, v123

    s_mul_i32 s45, s3, 36864
    s_add_u32 s45, s45, 128
    s_movk_i32 s57, 144
    v_mov_b32 v10, s45
    v_mad_u32_u24 v214, v5, s57, v10
    v_mad_u32_u24 v218, v255, s57, v10
    v_add_u32 v218, 12, v218
    v_cmp_lt_u32 vcc, 25, v255
    v_subrev_u32 v11, 26, v255
    v_cndmask_b32 v11, v255, v11, vcc
    v_add_u32 v12, 2304, v10
    v_cndmask_b32 v10, v10, v12, vcc
    v_and_b32 v12, 3, v11
    v_mad_u32_u24 v10, v12, s57, v10
    v_lshrrev_b32 v11, 2, v11
    v_lshl_add_u32 v215, v11, 1, v10
    v_cmp_gt_u32 vcc, 52, v255
    v_add_u32 v11, 2304, v218
    v_cndmask_b32 v215, v11, v215, vcc
    v_mov_b32 v216, 0xdddddddd
    v_mov_b32 v219, 1000
    s_mov_b32 s60, 0xff00ff00
    s_mov_b32 s61, 0xff00ff00
    s_mov_b32 s62, -1
    s_mov_b32 s63, 0xffff

    s_waitcnt vmcnt(3)

    s_mov_b64 exec, 1
    ds_add_u32 v252, v253 offset:0
    s_mov_b64 exec, -1

k1_kernel_wf1:

    ds_read_b32 v251, v252 offset:0
    s_waitcnt lgkmcnt(0)
    v_readfirstlane_b32 s45, v251
    s_cmp_lt_u32 s45, 4
    s_cbranch_scc1 k1_kernel_wf1

    v_mov_b32 v72, 0
    v_mov_b32 v73, 0
    v_mov_b32 v74, 0
    v_mov_b32 v75, 0
    s_mov_b64 exec, s[62:63]
    ds_read_b64 v[72:73], v132 offset:192
    ds_read_b64 v[74:75], v132 offset:3392
    s_mov_b64 exec, -1
    ds_read_b64 v[76:77], v128 offset:16160
    ds_read_b64 v[78:79], v128 offset:16168
    ds_read_b64 v[80:81], v128 offset:0
    ds_read_b64 v[82:83], v128 offset:8
    ds_read_b64 v[84:85], v131 offset:0
    ds_read_b64 v[86:87], v131 offset:8
    s_waitcnt vmcnt(2)
    s_waitcnt lgkmcnt(4)
    v_mfma_f32_16x16x32_bf16 v[64:67], v[112:115], v[72:75], 0
    ds_read_b64 v[88:89], v128 offset:3232
    ds_read_b64 v[90:91], v128 offset:3240
    v_mfma_f32_16x16x32_bf16 v[68:71], v[116:119], v[72:75], 0
    v_mfma_f32_16x16x32_bf16 v[60:63], v[112:115], v[76:79], 0
    v_mfma_f32_16x16x32_bf16 v[64:67], v[232:235], v[112:115], v[64:67]
    v_mov_b32 v92, 0
    v_mov_b32 v93, 0
    v_mov_b32 v94, 0
    v_mov_b32 v95, 0
    s_mov_b64 exec, s[60:61]
    ds_read_b64 v[92:93], v129 offset:3232
    ds_read_b64 v[94:95], v129 offset:3240
    s_mov_b64 exec, -1
    v_mfma_f32_16x16x32_bf16 v[68:71], v[232:235], v[116:119], v[68:71]
    s_waitcnt lgkmcnt(4)
    v_mfma_f32_16x16x32_bf16 v[0:3], v[112:115], v[80:83], 0
    ds_read_b64 v[72:73], v128 offset:64
    ds_read_b64 v[74:75], v128 offset:72
    v_mfma_f32_16x16x32_bf16 v[4:7], v[116:119], v[80:83], 0
    v_mfma_f32_16x16x32_bf16 v[4:7], v[84:87], v[116:119], v[4:7]
    v_cndmask_b32 v70, 0, v70, s[46:47]
    ds_read_b64 v[76:77], v131 offset:6400
    ds_read_b64 v[78:79], v131 offset:6408
    s_waitcnt lgkmcnt(4)
    v_mfma_f32_16x16x32_bf16 v[96:99], v[120:123], v[88:91], 0
    ds_read_b64 v[80:81], v128 offset:9632
    ds_read_b64 v[82:83], v128 offset:9640
    v_mfma_f32_16x16x32_bf16 v[100:103], v[124:127], v[88:91], 0
    v_mfma_f32_16x16x32_bf16 v[96:99], v[92:95], v[112:115], v[96:99]
    v_mfma_f32_16x16x32_bf16 v[100:103], v[92:95], v[116:119], v[100:103]
    ds_read_b64 v[84:85], v129 offset:3296
    ds_read_b64 v[86:87], v129 offset:3304
    s_waitcnt lgkmcnt(4)
    v_mfma_f32_16x16x32_bf16 v[12:15], v[112:115], v[72:75], 0
    ds_read_b64 v[88:89], v128 offset:6464
    ds_read_b64 v[90:91], v128 offset:6472
    v_mfma_f32_16x16x32_bf16 v[16:19], v[116:119], v[72:75], 0
    v_cvt_pk_bf16_f32 v8, v96, v97
    v_cvt_pk_bf16_f32 v9, v98, v99
    v_mfma_f32_16x16x32_bf16 v[12:15], v[76:79], v[112:115], v[12:15]
    v_cvt_pk_bf16_f32 v10, v100, v101
    v_cvt_pk_bf16_f32 v11, v102, v103
    v_mfma_f32_16x16x32_bf16 v[16:19], v[76:79], v[116:119], v[16:19]
    ds_read_b64 v[92:93], v128 offset:9696
    ds_read_b64 v[94:95], v128 offset:9704
    s_waitcnt lgkmcnt(4)
    v_mfma_f32_16x16x32_bf16 v[96:99], v[120:123], v[80:83], 0
    ds_read_b64 v[72:73], v128 offset:128
    ds_read_b64 v[74:75], v128 offset:136
    v_mfma_f32_16x16x32_bf16 v[100:103], v[124:127], v[80:83], 0
    v_mfma_f32_16x16x32_bf16 v[96:99], v[84:87], v[112:115], v[96:99]
    v_mfma_f32_16x16x32_bf16 v[100:103], v[84:87], v[116:119], v[100:103]
    ds_read_b64 v[76:77], v129 offset:12800
    ds_read_b64 v[78:79], v129 offset:12808
    s_waitcnt lgkmcnt(4)
    v_mfma_f32_16x16x32_bf16 v[24:27], v[112:115], v[88:91], 0
    ds_read_b64 v[80:81], v128 offset:3328
    ds_read_b64 v[82:83], v128 offset:3336
    v_mfma_f32_16x16x32_bf16 v[28:31], v[112:115], v[92:95], 0
    v_cvt_pk_bf16_f32 v20, v96, v97
    v_cvt_pk_bf16_f32 v21, v98, v99
    s_nop 3
    v_cvt_pk_bf16_f32 v22, v100, v101
    v_cvt_pk_bf16_f32 v23, v102, v103
    ds_read_b64 v[84:85], v131 offset:12832
    ds_read_b64 v[86:87], v131 offset:12840
    s_waitcnt lgkmcnt(4)
    v_mfma_f32_16x16x32_bf16 v[96:99], v[120:123], v[72:75], 0
    ds_read_b64 v[88:89], v128 offset:6528
    ds_read_b64 v[90:91], v128 offset:6536
    v_mfma_f32_16x16x32_bf16 v[100:103], v[124:127], v[72:75], 0
    v_mfma_f32_16x16x32_bf16 v[96:99], v[76:79], v[112:115], v[96:99]
    v_mfma_f32_16x16x32_bf16 v[100:103], v[76:79], v[116:119], v[100:103]
    ds_read_b64 v[92:93], v129 offset:12864
    ds_read_b64 v[94:95], v129 offset:12872
    s_waitcnt lgkmcnt(4)
    v_mfma_f32_16x16x32_bf16 v[36:39], v[112:115], v[80:83], 0
    ds_read_b64 v[72:73], v128 offset:9728
    ds_read_b64 v[74:75], v128 offset:9736
    v_mfma_f32_16x16x32_bf16 v[40:43], v[116:119], v[80:83], 0
    v_cvt_pk_bf16_f32 v32, v96, v97
    v_cvt_pk_bf16_f32 v33, v98, v99
    v_mfma_f32_16x16x32_bf16 v[36:39], v[84:87], v[112:115], v[36:39]
    v_cvt_pk_bf16_f32 v34, v100, v101
    v_cvt_pk_bf16_f32 v35, v102, v103
    v_mfma_f32_16x16x32_bf16 v[40:43], v[84:87], v[116:119], v[40:43]
    ds_read_b64 v[76:77], v131 offset:12896
    ds_read_b64 v[78:79], v131 offset:12904
    s_waitcnt lgkmcnt(4)
    v_mfma_f32_16x16x32_bf16 v[96:99], v[120:123], v[88:91], 0
    ds_read_b64 v[80:81], v128 offset:12928
    ds_read_b64 v[82:83], v128 offset:12936
    v_mfma_f32_16x16x32_bf16 v[100:103], v[124:127], v[88:91], 0
    v_mfma_f32_16x16x32_bf16 v[96:99], v[92:95], v[112:115], v[96:99]
    v_mfma_f32_16x16x32_bf16 v[100:103], v[92:95], v[116:119], v[100:103]
    v_mov_b32 v84, 0
    v_mov_b32 v85, 0
    v_mov_b32 v86, 0
    v_mov_b32 v87, 0
    s_mov_b64 exec, s[60:61]
    ds_read_b64 v[84:85], v129 offset:12928
    ds_read_b64 v[86:87], v129 offset:12936
    s_mov_b64 exec, -1
    s_waitcnt lgkmcnt(4)
    v_mfma_f32_16x16x32_bf16 v[48:51], v[112:115], v[72:75], 0
    v_mfma_f32_16x16x32_bf16 v[52:55], v[116:119], v[72:75], 0
    v_cvt_pk_bf16_f32 v44, v96, v97
    v_cvt_pk_bf16_f32 v45, v98, v99
    v_mfma_f32_16x16x32_bf16 v[48:51], v[76:79], v[112:115], v[48:51]
    v_cvt_pk_bf16_f32 v46, v100, v101
    v_cvt_pk_bf16_f32 v47, v102, v103
    v_mfma_f32_16x16x32_bf16 v[52:55], v[76:79], v[116:119], v[52:55]
    s_waitcnt lgkmcnt(0)

    s_mov_b64 exec, 1
    ds_add_u32 v252, v253 offset:12
    s_mov_b64 exec, -1

    v_mfma_f32_16x16x32_bf16 v[96:99], v[120:123], v[80:83], 0
    v_mfma_f32_16x16x32_bf16 v[100:103], v[124:127], v[80:83], 0
    v_mfma_f32_16x16x32_bf16 v[96:99], v[84:87], v[112:115], v[96:99]
    v_mfma_f32_16x16x32_bf16 v[100:103], v[84:87], v[116:119], v[100:103]
    s_nop 7
    v_cvt_pk_bf16_f32 v56, v96, v97
    v_cvt_pk_bf16_f32 v57, v98, v99
    v_cvt_pk_bf16_f32 v58, v100, v101
    v_cvt_pk_bf16_f32 v59, v102, v103

    v_mov_b32_dpp v71, v70 row_shr:1 row_mask:0xf bank_mask:0xf bound_ctrl:0
    ds_write_b32 v218, v219
    v_and_b32 v217, 1, v255
    v_lshlrev_b32 v248, 1, v213
    v_lshl_add_u32 v248, v217, 2, v248
    v_mul_u32_u24 v208, 0xaaaa, v217
    v_mov_b32 v217, 0
    s_mov_b32 vcc_lo, 0x01010101
    s_mov_b32 vcc_hi, 0x01010101
    s_movk_i32 s58, 7

    v_mov_b64 v[172:173], 0
    v_mov_b64 v[176:177], 0
    v_mov_b64 v[180:181], 0
    v_mov_b64 v[184:185], 0
    v_mov_b64 v[188:189], 0
    v_mov_b64 v[192:193], 0
    v_mov_b64 v[196:197], 0
    v_mov_b64 v[198:199], 0
    s_waitcnt vmcnt(1)
    ds_write_b16 v215, v240 offset:0
    ds_write_b16 v215, v241 offset:576
    ds_write_b16 v215, v242 offset:1152
    ds_write_b16 v215, v243 offset:1728
    v_add_u32 v250, 0x4444, v208
    ds_read_b128 v[204:207], v214 offset:0
k1_kernel_wf2:

    ds_read_b32 v251, v252 offset:16
    s_waitcnt lgkmcnt(0)
    v_readfirstlane_b32 s45, v251
    s_cmp_lt_u32 s45, 4
    s_cbranch_scc1 k1_kernel_wf2

    s_setprio 2
    v_mad_u32_u16 v76, v204, s57, v213 op_sel:[0,0,0,0]
    ds_read_b128 v[72:75], v76 offset:0
    ds_read_b128 v[76:79], v76 offset:64
    v_mad_u32_u16 v84, v204, s57, v213 op_sel:[1,0,0,0]
    ds_read_b128 v[80:83], v84 offset:0
    ds_read_b128 v[84:87], v84 offset:64
    v_mad_u32_u16 v92, v205, s57, v213 op_sel:[0,0,0,0]
    ds_read_b128 v[88:91], v92 offset:0
    ds_read_b128 v[92:95], v92 offset:64
    v_mad_u32_u16 v100, v205, s57, v213 op_sel:[1,0,0,0]
    ds_read_b128 v[96:99], v100 offset:0
    ds_read_b128 v[100:103], v100 offset:64
    v_mad_u32_u16 v108, v206, s57, v213 op_sel:[0,0,0,0]
    ds_read_b128 v[104:107], v108 offset:0
    ds_read_b128 v[108:111], v108 offset:64
    buffer_load_dwordx4 v[240:243], v249, s[16:19], s74 offen offset:0
    s_waitcnt lgkmcnt(4)
    v_mad_u32_u16 v116, v206, s57, v213 op_sel:[1,0,0,0]
    ds_read_b128 v[112:115], v116 offset:0
k1_kernel_loop:
    v_mfma_f32_16x16x32_bf16 v[124:127], v[72:75], v[72:75], 0
    ds_read_b128 v[116:119], v116 offset:64
    v_mad_u32_u16 v122, v207, s57, v248 op_sel:[0,0,0,0]
    ds_read2_b32 v[120:121], v122 offset0:0 offset1:2
    v_mfma_f32_16x16x32_bf16 v[124:127], v[76:79], v[76:79], v[124:127]
    ds_read2_b32 v[122:123], v122 offset0:4 offset1:6
    ds_read_b128 v[204:207], v214 offset:2304
    v_mfma_f32_16x16x32_bf16 v[128:131], v[80:83], v[72:75], 0
    v_fmac_f32 v217, v189, v68
    v_fmac_f32 v217, v196, v200
    v_mfma_f32_16x16x32_bf16 v[128:131], v[84:87], v[76:79], v[128:131]
    v_fmac_f32 v217, v192, v69
    v_fmac_f32 v217, v197, v201
    v_mfma_f32_16x16x32_bf16 v[132:135], v[80:83], v[80:83], 0
    v_fmac_f32 v217, v193, v69
    v_fmac_f32 v217, v198, v202
    v_mfma_f32_16x16x32_bf16 v[132:135], v[84:87], v[84:87], v[132:135]
    v_fmac_f32 v217, v199, v203
    v_fmac_f32 v209, v153, v53
    v_mfma_f32_16x16x32_bf16 v[136:139], v[88:91], v[80:83], 0
    v_fmac_f32 v208, v154, v54
    v_fmac_f32 v209, v155, v55
    v_mfma_f32_16x16x32_bf16 v[136:139], v[92:95], v[84:87], v[136:139]
    v_fmac_f32 v208, v164, v60
    v_fmac_f32 v209, v165, v61
    v_mfma_f32_16x16x32_bf16 v[140:143], v[88:91], v[72:75], 0
    v_fmac_f32 v208, v166, v62
    v_fmac_f32 v209, v167, v63
    v_mfma_f32_16x16x32_bf16 v[140:143], v[92:95], v[76:79], v[140:143]
    s_waitcnt lgkmcnt(7)
    v_add_f32 v209, v209, v217
    v_smfmac_f32_16x16x64_bf16 v[196:199], v[8:11], v[132:139], v216
    v_fmac_f32 v208, v168, v70
    v_mfma_f32_16x16x32_bf16 v[144:147], v[96:99], v[72:75], 0
    v_fmac_f32 v208, v169, v71
    v_add_f32 v211, v208, v209
    v_mfma_f32_16x16x32_bf16 v[144:147], v[100:103], v[76:79], v[144:147]
    v_fma_f32 v208, v124, v0, -v217
    v_mul_f32 v209, v125, v1
    v_mfma_f32_16x16x32_bf16 v[148:151], v[80:83], v[96:99], 0
    v_fmac_f32 v208, v126, v2
    v_fmac_f32 v209, v127, v3
    v_mfma_f32_16x16x32_bf16 v[148:151], v[84:87], v[100:103], v[148:151]
    v_fmac_f32 v208, v128, v4
    v_fmac_f32 v209, v129, v5
    v_mfma_f32_16x16x32_bf16 v[152:155], v[88:91], v[96:99], 0
    v_fmac_f32 v208, v130, v6
    v_fmac_f32 v209, v131, v7
    v_mfma_f32_16x16x32_bf16 v[152:155], v[92:95], v[100:103], v[152:155]
    v_fmac_f32 v208, v140, v12
    v_fmac_f32 v209, v141, v13
    v_mfma_f32_16x16x32_bf16 v[156:159], v[88:91], v[88:91], 0
    v_fmac_f32 v208, v142, v14
    v_fmac_f32 v209, v143, v15
    v_mfma_f32_16x16x32_bf16 v[156:159], v[92:95], v[92:95], v[156:159]
    v_fmac_f32 v208, v144, v16
    v_fmac_f32 v209, v145, v17
    v_smfmac_f32_16x16x64_bf16 v[196:199], v[20:23], v[148:155], v216
    v_fmac_f32 v208, v146, v18
    v_mfma_f32_16x16x32_bf16 v[160:163], v[96:99], v[96:99], 0
    s_waitcnt lgkmcnt(0)
    v_fmac_f32 v209, v147, v19
    v_mfma_f32_16x16x32_bf16 v[160:163], v[100:103], v[100:103], v[160:163]
    v_fmac_f32 v208, v156, v24
    v_fmac_f32 v209, v157, v25
    v_mfma_f32_16x16x32_bf16 v[124:127], v[104:107], v[72:75], 0
    v_fmac_f32 v208, v158, v26
    v_fmac_f32 v209, v159, v27
    v_mfma_f32_16x16x32_bf16 v[124:127], v[108:111], v[76:79], v[124:127]
    v_permlane32_swap_b32 v210, v211
    s_waitcnt vmcnt(1)
    v_mfma_f32_16x16x32_bf16 v[128:131], v[112:115], v[72:75], 0
    v_fmac_f32 v208, v160, v28
    v_fmac_f32 v209, v161, v29
    v_mfma_f32_16x16x32_bf16 v[128:131], v[116:119], v[76:79], v[128:131]
    v_fmac_f32 v208, v162, v30
    v_fmac_f32 v209, v163, v31
    v_smfmac_f32_16x16x64_bf16 v[172:175], v[120:123], v[72:79], v250
    v_mad_u32_u16 v76, v204, s57, v213 op_sel:[0,0,0,0]
    v_mfma_f32_16x16x32_bf16 v[132:135], v[104:107], v[80:83], 0
    ds_read_b128 v[72:75], v76 offset:0
    ds_read_b128 v[76:79], v76 offset:64
    v_smfmac_f32_16x16x64_bf16 v[196:199], v[32:35], v[124:131], v216
    v_add_f32 v219, v210, v211
    v_mfma_f32_16x16x32_bf16 v[132:135], v[108:111], v[84:87], v[132:135]
    v_mul_f32 v217, v172, v64
    ds_write_b16 v215, v244 offset:4608
    v_mfma_f32_16x16x32_bf16 v[136:139], v[112:115], v[80:83], 0
    v_fmac_f32 v217, v173, v64
    ds_write_b16 v215, v245 offset:5184
    v_mfma_f32_16x16x32_bf16 v[136:139], v[116:119], v[84:87], v[136:139]
    ds_write_b16 v215, v246 offset:5760
    ds_write_b16 v215, v247 offset:6336
    v_smfmac_f32_16x16x64_bf16 v[176:179], v[120:123], v[80:87], v250
    v_mad_u32_u16 v84, v204, s57, v213 op_sel:[1,0,0,0]
    v_mfma_f32_16x16x32_bf16 v[140:143], v[104:107], v[88:91], 0
    ds_read_b128 v[80:83], v84 offset:0
    ds_read_b128 v[84:87], v84 offset:64
    v_mfma_f32_16x16x32_bf16 v[140:143], v[108:111], v[92:95], v[140:143]
    v_fmac_f32 v208, v132, v36
    v_fmac_f32 v209, v133, v37
    v_mfma_f32_16x16x32_bf16 v[144:147], v[112:115], v[88:91], 0
    v_fmac_f32 v217, v176, v65
    v_fmac_f32 v208, v134, v38
    v_mfma_f32_16x16x32_bf16 v[144:147], v[116:119], v[92:95], v[144:147]
    v_fmac_f32 v217, v177, v65
    v_fmac_f32 v209, v135, v39
    v_smfmac_f32_16x16x64_bf16 v[180:183], v[120:123], v[88:95], v250
    v_mad_u32_u16 v92, v205, s57, v213 op_sel:[0,0,0,0]
    v_mfma_f32_16x16x32_bf16 v[148:151], v[104:107], v[96:99], 0
    ds_read_b128 v[88:91], v92 offset:0
    ds_read_b128 v[92:95], v92 offset:64
    v_smfmac_f32_16x16x64_bf16 v[196:199], v[44:47], v[140:147], v216
    v_fmac_f32 v208, v136, v40
    v_mfma_f32_16x16x32_bf16 v[148:151], v[108:111], v[100:103], v[148:151]
    v_fmac_f32 v217, v180, v66
    v_fmac_f32 v209, v137, v41
    v_mfma_f32_16x16x32_bf16 v[152:155], v[112:115], v[96:99], 0
    v_fmac_f32 v217, v181, v66
    v_fmac_f32 v208, v138, v42
    v_mfma_f32_16x16x32_bf16 v[152:155], v[116:119], v[100:103], v[152:155]
    v_fmac_f32 v209, v139, v43
    buffer_load_dwordx4 v[244:247], v249, s[16:19], s74 offen offset:800
    v_smfmac_f32_16x16x64_bf16 v[184:187], v[120:123], v[96:103], v250
    v_mad_u32_u16 v100, v205, s57, v213 op_sel:[1,0,0,0]
    v_mfma_f32_16x16x32_bf16 v[156:159], v[104:107], v[104:107], 0
    ds_read_b128 v[96:99], v100 offset:0
    ds_read_b128 v[100:103], v100 offset:64
    v_mfma_f32_16x16x32_bf16 v[156:159], v[108:111], v[108:111], v[156:159]
    v_fmac_f32 v208, v148, v48
    v_fmac_f32 v209, v149, v49
    v_mfma_f32_16x16x32_bf16 v[160:163], v[112:115], v[104:107], 0
    v_fmac_f32 v217, v184, v67
    v_fmac_f32 v208, v150, v50
    v_mfma_f32_16x16x32_bf16 v[160:163], v[116:119], v[108:111], v[160:163]
    v_fmac_f32 v217, v185, v67
    v_fmac_f32 v209, v151, v51
    v_smfmac_f32_16x16x64_bf16 v[188:191], v[120:123], v[104:111], v250
    v_mad_u32_u16 v108, v206, s57, v213 op_sel:[0,0,0,0]
    v_mfma_f32_16x16x32_bf16 v[164:167], v[112:115], v[112:115], 0
    ds_read_b128 v[104:107], v108 offset:0
    ds_read_b128 v[108:111], v108 offset:64
    v_smfmac_f32_16x16x64_bf16 v[196:199], v[56:59], v[156:163], v216
    s_waitcnt lgkmcnt(4)
    v_mfma_f32_16x16x32_bf16 v[164:167], v[116:119], v[116:119], v[164:167]
    v_fmac_f32 v217, v188, v68
    v_fmac_f32 v208, v152, v52
    v_smfmac_f32_16x16x64_bf16 v[192:195], v[120:123], v[112:119], v250
    v_mad_u32_u16 v116, v206, s57, v213 op_sel:[1,0,0,0]
    v_mfma_f32_16x16x32_bf16 v[168:171], v[120:123], v[120:123], 0
    ds_read_b128 v[112:115], v116 offset:0
    v_mfma_f32_16x16x32_bf16 v[124:127], v[72:75], v[72:75], 0
    ds_read_b128 v[116:119], v116 offset:64
    v_mad_u32_u16 v122, v207, s57, v248 op_sel:[0,0,0,0]
    ds_read2_b32 v[120:121], v122 offset0:0 offset1:2
    v_mfma_f32_16x16x32_bf16 v[124:127], v[76:79], v[76:79], v[124:127]
    ds_read2_b32 v[122:123], v122 offset0:4 offset1:6
    ds_read_b128 v[204:207], v214 offset:4608
    v_mfma_f32_16x16x32_bf16 v[128:131], v[80:83], v[72:75], 0
    v_fmac_f32 v217, v189, v68
    v_fmac_f32 v217, v196, v200
    v_mfma_f32_16x16x32_bf16 v[128:131], v[84:87], v[76:79], v[128:131]
    v_fmac_f32 v217, v192, v69
    v_fmac_f32 v217, v197, v201
    v_mfma_f32_16x16x32_bf16 v[132:135], v[80:83], v[80:83], 0
    v_fmac_f32 v217, v193, v69
    v_fmac_f32 v217, v198, v202
    v_mfma_f32_16x16x32_bf16 v[132:135], v[84:87], v[84:87], v[132:135]
    v_fmac_f32 v217, v199, v203
    v_fmac_f32 v209, v153, v53
    v_mfma_f32_16x16x32_bf16 v[136:139], v[88:91], v[80:83], 0
    v_fmac_f32 v208, v154, v54
    v_fmac_f32 v209, v155, v55
    v_mfma_f32_16x16x32_bf16 v[136:139], v[92:95], v[84:87], v[136:139]
    v_fmac_f32 v208, v164, v60
    v_fmac_f32 v209, v165, v61
    v_mfma_f32_16x16x32_bf16 v[140:143], v[88:91], v[72:75], 0
    v_fmac_f32 v208, v166, v62
    v_fmac_f32 v209, v167, v63
    v_mfma_f32_16x16x32_bf16 v[140:143], v[92:95], v[76:79], v[140:143]
    s_waitcnt lgkmcnt(7)
    v_add_f32 v209, v209, v217
    v_smfmac_f32_16x16x64_bf16 v[196:199], v[8:11], v[132:139], v216
    v_fmac_f32 v208, v168, v70
    v_mfma_f32_16x16x32_bf16 v[144:147], v[96:99], v[72:75], 0
    v_fmac_f32 v208, v169, v71
    v_add_f32 v210, v208, v209
    v_mfma_f32_16x16x32_bf16 v[144:147], v[100:103], v[76:79], v[144:147]
    v_fma_f32 v208, v124, v0, -v217
    v_mul_f32 v209, v125, v1
    v_mfma_f32_16x16x32_bf16 v[148:151], v[80:83], v[96:99], 0
    v_fmac_f32 v208, v126, v2
    v_fmac_f32 v209, v127, v3
    v_mfma_f32_16x16x32_bf16 v[148:151], v[84:87], v[100:103], v[148:151]
    v_fmac_f32 v208, v128, v4
    v_fmac_f32 v209, v129, v5
    v_mfma_f32_16x16x32_bf16 v[152:155], v[88:91], v[96:99], 0
    v_fmac_f32 v208, v130, v6
    v_fmac_f32 v209, v131, v7
    v_mfma_f32_16x16x32_bf16 v[152:155], v[92:95], v[100:103], v[152:155]
    v_fmac_f32 v208, v140, v12
    v_fmac_f32 v209, v141, v13
    v_mfma_f32_16x16x32_bf16 v[156:159], v[88:91], v[88:91], 0
    v_fmac_f32 v208, v142, v14
    v_fmac_f32 v209, v143, v15
    v_mfma_f32_16x16x32_bf16 v[156:159], v[92:95], v[92:95], v[156:159]
    v_fmac_f32 v208, v144, v16
    v_fmac_f32 v209, v145, v17
    v_smfmac_f32_16x16x64_bf16 v[196:199], v[20:23], v[148:155], v216
    v_fmac_f32 v208, v146, v18
    v_mfma_f32_16x16x32_bf16 v[160:163], v[96:99], v[96:99], 0
    s_waitcnt lgkmcnt(0)
    v_fmac_f32 v209, v147, v19
    v_mfma_f32_16x16x32_bf16 v[160:163], v[100:103], v[100:103], v[160:163]
    v_fmac_f32 v208, v156, v24
    v_fmac_f32 v209, v157, v25
    v_mfma_f32_16x16x32_bf16 v[124:127], v[104:107], v[72:75], 0
    v_fmac_f32 v208, v158, v26
    v_fmac_f32 v209, v159, v27
    v_mfma_f32_16x16x32_bf16 v[124:127], v[108:111], v[76:79], v[124:127]
    v_permlane16_swap_b32 v218, v219
    s_add_u32 s74, s74, s77
    v_mfma_f32_16x16x32_bf16 v[128:131], v[112:115], v[72:75], 0
    v_fmac_f32 v208, v160, v28
    v_fmac_f32 v209, v161, v29
    v_mfma_f32_16x16x32_bf16 v[128:131], v[116:119], v[76:79], v[128:131]
    v_fmac_f32 v208, v162, v30
    v_fmac_f32 v209, v163, v31
    v_smfmac_f32_16x16x64_bf16 v[172:175], v[120:123], v[72:79], v250
    v_mad_u32_u16 v76, v204, s57, v213 op_sel:[0,0,0,0]
    v_mfma_f32_16x16x32_bf16 v[132:135], v[104:107], v[80:83], 0
    ds_read_b128 v[72:75], v76 offset:0
    ds_read_b128 v[76:79], v76 offset:64
    v_smfmac_f32_16x16x64_bf16 v[196:199], v[32:35], v[124:131], v216
    v_add_f32 v220, v218, v219
    v_mfma_f32_16x16x32_bf16 v[132:135], v[108:111], v[84:87], v[132:135]
    v_mul_f32 v217, v172, v64
    s_min_i32 s74, s74, s79
    v_mfma_f32_16x16x32_bf16 v[136:139], v[112:115], v[80:83], 0
    v_fmac_f32 v217, v173, v64
    s_max_i32 s74, s74, s78
    v_mfma_f32_16x16x32_bf16 v[136:139], v[116:119], v[84:87], v[136:139]
    v_smfmac_f32_16x16x64_bf16 v[176:179], v[120:123], v[80:87], v250
    v_mad_u32_u16 v84, v204, s57, v213 op_sel:[1,0,0,0]
    v_mfma_f32_16x16x32_bf16 v[140:143], v[104:107], v[88:91], 0
    ds_read_b128 v[80:83], v84 offset:0
    ds_read_b128 v[84:87], v84 offset:64
    v_mfma_f32_16x16x32_bf16 v[140:143], v[108:111], v[92:95], v[140:143]
    v_fmac_f32 v208, v132, v36
    v_fmac_f32 v209, v133, v37
    v_mfma_f32_16x16x32_bf16 v[144:147], v[112:115], v[88:91], 0
    v_fmac_f32 v217, v176, v65
    v_fmac_f32 v208, v134, v38
    v_mfma_f32_16x16x32_bf16 v[144:147], v[116:119], v[92:95], v[144:147]
    v_fmac_f32 v217, v177, v65
    v_fmac_f32 v209, v135, v39
    v_smfmac_f32_16x16x64_bf16 v[180:183], v[120:123], v[88:95], v250
    v_mad_u32_u16 v92, v205, s57, v213 op_sel:[0,0,0,0]
    v_mfma_f32_16x16x32_bf16 v[148:151], v[104:107], v[96:99], 0
    ds_read_b128 v[88:91], v92 offset:0
    ds_read_b128 v[92:95], v92 offset:64
    v_smfmac_f32_16x16x64_bf16 v[196:199], v[44:47], v[140:147], v216
    v_fmac_f32 v208, v136, v40
    v_mfma_f32_16x16x32_bf16 v[148:151], v[108:111], v[100:103], v[148:151]
    v_fmac_f32 v217, v180, v66
    v_fmac_f32 v209, v137, v41
    v_mfma_f32_16x16x32_bf16 v[152:155], v[112:115], v[96:99], 0
    v_fmac_f32 v217, v181, v66
    v_fmac_f32 v208, v138, v42
    v_mfma_f32_16x16x32_bf16 v[152:155], v[116:119], v[100:103], v[152:155]
    v_fmac_f32 v209, v139, v43
    v_smfmac_f32_16x16x64_bf16 v[184:187], v[120:123], v[96:103], v250
    v_mad_u32_u16 v100, v205, s57, v213 op_sel:[1,0,0,0]
    v_mfma_f32_16x16x32_bf16 v[156:159], v[104:107], v[104:107], 0
    ds_read_b128 v[96:99], v100 offset:0
    ds_read_b128 v[100:103], v100 offset:64
    v_mfma_f32_16x16x32_bf16 v[156:159], v[108:111], v[108:111], v[156:159]
    v_fmac_f32 v208, v148, v48
    v_fmac_f32 v209, v149, v49
    v_mfma_f32_16x16x32_bf16 v[160:163], v[112:115], v[104:107], 0
    v_fmac_f32 v217, v184, v67
    v_fmac_f32 v208, v150, v50
    v_mfma_f32_16x16x32_bf16 v[160:163], v[116:119], v[108:111], v[160:163]
    v_fmac_f32 v217, v185, v67
    v_fmac_f32 v209, v151, v51
    v_smfmac_f32_16x16x64_bf16 v[188:191], v[120:123], v[104:111], v250
    v_mad_u32_u16 v108, v206, s57, v213 op_sel:[0,0,0,0]
    v_mfma_f32_16x16x32_bf16 v[164:167], v[112:115], v[112:115], 0
    ds_read_b128 v[104:107], v108 offset:0
    ds_read_b128 v[108:111], v108 offset:64
    v_smfmac_f32_16x16x64_bf16 v[196:199], v[56:59], v[156:163], v216
    s_waitcnt lgkmcnt(4)
    v_mfma_f32_16x16x32_bf16 v[164:167], v[116:119], v[116:119], v[164:167]
    v_fmac_f32 v217, v188, v68
    v_fmac_f32 v208, v152, v52
    v_smfmac_f32_16x16x64_bf16 v[192:195], v[120:123], v[112:119], v250
    v_mad_u32_u16 v116, v206, s57, v213 op_sel:[1,0,0,0]
    v_mfma_f32_16x16x32_bf16 v[168:171], v[120:123], v[120:123], 0
    ds_read_b128 v[112:115], v116 offset:0
    v_mfma_f32_16x16x32_bf16 v[124:127], v[72:75], v[72:75], 0
    ds_read_b128 v[116:119], v116 offset:64
    v_mad_u32_u16 v122, v207, s57, v248 op_sel:[0,0,0,0]
    ds_read2_b32 v[120:121], v122 offset0:0 offset1:2
    v_mfma_f32_16x16x32_bf16 v[124:127], v[76:79], v[76:79], v[124:127]
    ds_read2_b32 v[122:123], v122 offset0:4 offset1:6
    ds_read_b128 v[204:207], v214 offset:6912
    v_mfma_f32_16x16x32_bf16 v[128:131], v[80:83], v[72:75], 0
    v_fmac_f32 v217, v189, v68
    v_fmac_f32 v217, v196, v200
    v_mfma_f32_16x16x32_bf16 v[128:131], v[84:87], v[76:79], v[128:131]
    v_fmac_f32 v217, v192, v69
    v_fmac_f32 v217, v197, v201
    v_mfma_f32_16x16x32_bf16 v[132:135], v[80:83], v[80:83], 0
    v_fmac_f32 v217, v193, v69
    v_fmac_f32 v217, v198, v202
    v_mfma_f32_16x16x32_bf16 v[132:135], v[84:87], v[84:87], v[132:135]
    v_fmac_f32 v217, v199, v203
    v_fmac_f32 v209, v153, v53
    v_mfma_f32_16x16x32_bf16 v[136:139], v[88:91], v[80:83], 0
    v_fmac_f32 v208, v154, v54
    v_fmac_f32 v209, v155, v55
    v_mfma_f32_16x16x32_bf16 v[136:139], v[92:95], v[84:87], v[136:139]
    v_fmac_f32 v208, v164, v60
    v_fmac_f32 v209, v165, v61
    v_mfma_f32_16x16x32_bf16 v[140:143], v[88:91], v[72:75], 0
    v_fmac_f32 v208, v166, v62
    v_fmac_f32 v209, v167, v63
    v_mfma_f32_16x16x32_bf16 v[140:143], v[92:95], v[76:79], v[140:143]
    s_waitcnt lgkmcnt(7)
    v_add_f32 v209, v209, v217
    v_smfmac_f32_16x16x64_bf16 v[196:199], v[8:11], v[132:139], v216
    v_fmac_f32 v208, v168, v70
    v_mfma_f32_16x16x32_bf16 v[144:147], v[96:99], v[72:75], 0
    v_fmac_f32 v208, v169, v71
    v_add_f32 v211, v208, v209
    v_mfma_f32_16x16x32_bf16 v[144:147], v[100:103], v[76:79], v[144:147]
    v_fma_f32 v208, v124, v0, -v217
    v_mul_f32 v209, v125, v1
    v_mfma_f32_16x16x32_bf16 v[148:151], v[80:83], v[96:99], 0
    v_fmac_f32 v208, v126, v2
    v_fmac_f32 v209, v127, v3
    v_mfma_f32_16x16x32_bf16 v[148:151], v[84:87], v[100:103], v[148:151]
    v_fmac_f32 v208, v128, v4
    v_fmac_f32 v209, v129, v5
    v_mfma_f32_16x16x32_bf16 v[152:155], v[88:91], v[96:99], 0
    v_fmac_f32 v208, v130, v6
    v_fmac_f32 v209, v131, v7
    v_mfma_f32_16x16x32_bf16 v[152:155], v[92:95], v[100:103], v[152:155]
    v_fmac_f32 v208, v140, v12
    v_fmac_f32 v209, v141, v13
    v_mfma_f32_16x16x32_bf16 v[156:159], v[88:91], v[88:91], 0
    v_fmac_f32 v208, v142, v14
    v_fmac_f32 v209, v143, v15
    v_mfma_f32_16x16x32_bf16 v[156:159], v[92:95], v[92:95], v[156:159]
    v_fmac_f32 v208, v144, v16
    v_fmac_f32 v209, v145, v17
    v_smfmac_f32_16x16x64_bf16 v[196:199], v[20:23], v[148:155], v216
    v_fmac_f32 v208, v146, v18
    v_mfma_f32_16x16x32_bf16 v[160:163], v[96:99], v[96:99], 0
    s_waitcnt lgkmcnt(0)
    v_fmac_f32 v209, v147, v19
    v_mfma_f32_16x16x32_bf16 v[160:163], v[100:103], v[100:103], v[160:163]
    v_fmac_f32 v208, v156, v24
    v_fmac_f32 v209, v157, v25
    v_mfma_f32_16x16x32_bf16 v[124:127], v[104:107], v[72:75], 0
    v_fmac_f32 v208, v158, v26
    v_fmac_f32 v209, v159, v27
    v_mfma_f32_16x16x32_bf16 v[124:127], v[108:111], v[76:79], v[124:127]
    v_permlane32_swap_b32 v210, v211
    s_waitcnt vmcnt(1)
    v_mfma_f32_16x16x32_bf16 v[128:131], v[112:115], v[72:75], 0
    v_fmac_f32 v208, v160, v28
    v_fmac_f32 v209, v161, v29
    v_mfma_f32_16x16x32_bf16 v[128:131], v[116:119], v[76:79], v[128:131]
    v_fmac_f32 v208, v162, v30
    v_fmac_f32 v209, v163, v31
    v_smfmac_f32_16x16x64_bf16 v[172:175], v[120:123], v[72:79], v250
    v_mad_u32_u16 v76, v204, s57, v213 op_sel:[0,0,0,0]
    v_mfma_f32_16x16x32_bf16 v[132:135], v[104:107], v[80:83], 0
    ds_read_b128 v[72:75], v76 offset:0
    ds_read_b128 v[76:79], v76 offset:64
    v_smfmac_f32_16x16x64_bf16 v[196:199], v[32:35], v[124:131], v216
    v_add_f32 v218, v210, v211
    v_mfma_f32_16x16x32_bf16 v[132:135], v[108:111], v[84:87], v[132:135]
    v_mul_f32 v217, v172, v64
    ds_write_b16 v215, v240 offset:0
    v_mfma_f32_16x16x32_bf16 v[136:139], v[112:115], v[80:83], 0
    v_fmac_f32 v217, v173, v64
    ds_write_b16 v215, v241 offset:576
    v_mfma_f32_16x16x32_bf16 v[136:139], v[116:119], v[84:87], v[136:139]
    ds_write_b16 v215, v242 offset:1152
    ds_write_b16 v215, v243 offset:1728
    v_smfmac_f32_16x16x64_bf16 v[176:179], v[120:123], v[80:87], v250
    v_mad_u32_u16 v84, v204, s57, v213 op_sel:[1,0,0,0]
    v_mfma_f32_16x16x32_bf16 v[140:143], v[104:107], v[88:91], 0
    ds_read_b128 v[80:83], v84 offset:0
    ds_read_b128 v[84:87], v84 offset:64
    v_mfma_f32_16x16x32_bf16 v[140:143], v[108:111], v[92:95], v[140:143]
    v_fmac_f32 v208, v132, v36
    v_fmac_f32 v209, v133, v37
    v_mfma_f32_16x16x32_bf16 v[144:147], v[112:115], v[88:91], 0
    v_fmac_f32 v217, v176, v65
    v_fmac_f32 v208, v134, v38
    v_mfma_f32_16x16x32_bf16 v[144:147], v[116:119], v[92:95], v[144:147]
    v_fmac_f32 v217, v177, v65
    v_fmac_f32 v209, v135, v39
    v_smfmac_f32_16x16x64_bf16 v[180:183], v[120:123], v[88:95], v250
    v_mad_u32_u16 v92, v205, s57, v213 op_sel:[0,0,0,0]
    v_mfma_f32_16x16x32_bf16 v[148:151], v[104:107], v[96:99], 0
    ds_read_b128 v[88:91], v92 offset:0
    ds_read_b128 v[92:95], v92 offset:64
    v_smfmac_f32_16x16x64_bf16 v[196:199], v[44:47], v[140:147], v216
    v_fmac_f32 v208, v136, v40
    v_mfma_f32_16x16x32_bf16 v[148:151], v[108:111], v[100:103], v[148:151]
    v_fmac_f32 v217, v180, v66
    v_fmac_f32 v209, v137, v41
    v_mfma_f32_16x16x32_bf16 v[152:155], v[112:115], v[96:99], 0
    v_fmac_f32 v217, v181, v66
    v_fmac_f32 v208, v138, v42
    v_mfma_f32_16x16x32_bf16 v[152:155], v[116:119], v[100:103], v[152:155]
    v_fmac_f32 v209, v139, v43
    buffer_load_dwordx4 v[240:243], v249, s[16:19], s74 offen offset:0
    v_smfmac_f32_16x16x64_bf16 v[184:187], v[120:123], v[96:103], v250
    v_mad_u32_u16 v100, v205, s57, v213 op_sel:[1,0,0,0]
    v_mfma_f32_16x16x32_bf16 v[156:159], v[104:107], v[104:107], 0
    ds_read_b128 v[96:99], v100 offset:0
    ds_read_b128 v[100:103], v100 offset:64
    v_mfma_f32_16x16x32_bf16 v[156:159], v[108:111], v[108:111], v[156:159]
    v_fmac_f32 v208, v148, v48
    v_fmac_f32 v209, v149, v49
    v_mfma_f32_16x16x32_bf16 v[160:163], v[112:115], v[104:107], 0
    v_fmac_f32 v217, v184, v67
    v_fmac_f32 v208, v150, v50
    v_mfma_f32_16x16x32_bf16 v[160:163], v[116:119], v[108:111], v[160:163]
    v_fmac_f32 v217, v185, v67
    v_fmac_f32 v209, v151, v51
    v_smfmac_f32_16x16x64_bf16 v[188:191], v[120:123], v[104:111], v250
    v_mad_u32_u16 v108, v206, s57, v213 op_sel:[0,0,0,0]
    v_mfma_f32_16x16x32_bf16 v[164:167], v[112:115], v[112:115], 0
    ds_read_b128 v[104:107], v108 offset:0
    ds_read_b128 v[108:111], v108 offset:64
    v_smfmac_f32_16x16x64_bf16 v[196:199], v[56:59], v[156:163], v216
    s_waitcnt lgkmcnt(4)
    v_mfma_f32_16x16x32_bf16 v[164:167], v[116:119], v[116:119], v[164:167]
    v_fmac_f32 v217, v188, v68
    v_fmac_f32 v208, v152, v52
    v_smfmac_f32_16x16x64_bf16 v[192:195], v[120:123], v[112:119], v250
    v_mad_u32_u16 v116, v206, s57, v213 op_sel:[1,0,0,0]
    v_mfma_f32_16x16x32_bf16 v[168:171], v[120:123], v[120:123], 0
    ds_read_b128 v[112:115], v116 offset:0
    v_mfma_f32_16x16x32_bf16 v[124:127], v[72:75], v[72:75], 0
    ds_read_b128 v[116:119], v116 offset:64
    v_mad_u32_u16 v122, v207, s57, v248 op_sel:[0,0,0,0]
    ds_read2_b32 v[120:121], v122 offset0:0 offset1:2
    v_mfma_f32_16x16x32_bf16 v[124:127], v[76:79], v[76:79], v[124:127]
    ds_read2_b32 v[122:123], v122 offset0:4 offset1:6
    ds_read_b128 v[204:207], v214 offset:0
    v_mfma_f32_16x16x32_bf16 v[128:131], v[80:83], v[72:75], 0
    v_fmac_f32 v217, v189, v68
    v_fmac_f32 v217, v196, v200
    v_mfma_f32_16x16x32_bf16 v[128:131], v[84:87], v[76:79], v[128:131]
    v_fmac_f32 v217, v192, v69
    v_fmac_f32 v217, v197, v201
    v_mfma_f32_16x16x32_bf16 v[132:135], v[80:83], v[80:83], 0
    v_fmac_f32 v217, v193, v69
    v_fmac_f32 v217, v198, v202
    v_mfma_f32_16x16x32_bf16 v[132:135], v[84:87], v[84:87], v[132:135]
    v_fmac_f32 v217, v199, v203
    v_fmac_f32 v209, v153, v53
    v_mfma_f32_16x16x32_bf16 v[136:139], v[88:91], v[80:83], 0
    v_fmac_f32 v208, v154, v54
    v_fmac_f32 v209, v155, v55
    v_mfma_f32_16x16x32_bf16 v[136:139], v[92:95], v[84:87], v[136:139]
    v_fmac_f32 v208, v164, v60
    v_fmac_f32 v209, v165, v61
    v_mfma_f32_16x16x32_bf16 v[140:143], v[88:91], v[72:75], 0
    v_fmac_f32 v208, v166, v62
    v_fmac_f32 v209, v167, v63
    v_mfma_f32_16x16x32_bf16 v[140:143], v[92:95], v[76:79], v[140:143]
    s_waitcnt lgkmcnt(7)
    v_add_f32 v209, v209, v217
    v_smfmac_f32_16x16x64_bf16 v[196:199], v[8:11], v[132:139], v216
    v_fmac_f32 v208, v168, v70
    v_mfma_f32_16x16x32_bf16 v[144:147], v[96:99], v[72:75], 0
    v_fmac_f32 v208, v169, v71
    v_add_f32 v210, v208, v209
    v_mfma_f32_16x16x32_bf16 v[144:147], v[100:103], v[76:79], v[144:147]
    v_fma_f32 v208, v124, v0, -v217
    v_mul_f32 v209, v125, v1
    v_mfma_f32_16x16x32_bf16 v[148:151], v[80:83], v[96:99], 0
    v_fmac_f32 v208, v126, v2
    v_fmac_f32 v209, v127, v3
    v_mfma_f32_16x16x32_bf16 v[148:151], v[84:87], v[100:103], v[148:151]
    v_fmac_f32 v208, v128, v4
    v_fmac_f32 v209, v129, v5
    v_mfma_f32_16x16x32_bf16 v[152:155], v[88:91], v[96:99], 0
    v_fmac_f32 v208, v130, v6
    v_fmac_f32 v209, v131, v7
    v_mfma_f32_16x16x32_bf16 v[152:155], v[92:95], v[100:103], v[152:155]
    v_fmac_f32 v208, v140, v12
    v_fmac_f32 v209, v141, v13
    v_mfma_f32_16x16x32_bf16 v[156:159], v[88:91], v[88:91], 0
    v_fmac_f32 v208, v142, v14
    v_fmac_f32 v209, v143, v15
    v_mfma_f32_16x16x32_bf16 v[156:159], v[92:95], v[92:95], v[156:159]
    v_fmac_f32 v208, v144, v16
    v_fmac_f32 v209, v145, v17
    v_smfmac_f32_16x16x64_bf16 v[196:199], v[20:23], v[148:155], v216
    v_fmac_f32 v208, v146, v18
    v_mfma_f32_16x16x32_bf16 v[160:163], v[96:99], v[96:99], 0
    s_waitcnt lgkmcnt(0)
    v_fmac_f32 v209, v147, v19
    v_mfma_f32_16x16x32_bf16 v[160:163], v[100:103], v[100:103], v[160:163]
    v_fmac_f32 v208, v156, v24
    v_fmac_f32 v209, v157, v25
    v_mfma_f32_16x16x32_bf16 v[124:127], v[104:107], v[72:75], 0
    v_fmac_f32 v208, v158, v26
    v_fmac_f32 v209, v159, v27
    v_mfma_f32_16x16x32_bf16 v[124:127], v[108:111], v[76:79], v[124:127]
    v_add_f32_dpp v220, v220, v220 quad_perm:[1,0,3,2] row_mask:0xf bank_mask:0xf
    s_sub_u32 s58, s58, 1
    v_mfma_f32_16x16x32_bf16 v[128:131], v[112:115], v[72:75], 0
    v_fmac_f32 v208, v160, v28
    v_fmac_f32 v209, v161, v29
    v_mfma_f32_16x16x32_bf16 v[128:131], v[116:119], v[76:79], v[128:131]
    v_fmac_f32 v208, v162, v30
    v_fmac_f32 v209, v163, v31
    v_smfmac_f32_16x16x64_bf16 v[172:175], v[120:123], v[72:79], v250
    v_mad_u32_u16 v76, v204, s57, v213 op_sel:[0,0,0,0]
    v_mfma_f32_16x16x32_bf16 v[132:135], v[104:107], v[80:83], 0
    ds_read_b128 v[72:75], v76 offset:0
    ds_read_b128 v[76:79], v76 offset:64
    v_smfmac_f32_16x16x64_bf16 v[196:199], v[32:35], v[124:131], v216
    v_add_f32_dpp v220, v220, v220 quad_perm:[2,3,0,1] row_mask:0xf bank_mask:0xf
    v_mfma_f32_16x16x32_bf16 v[132:135], v[108:111], v[84:87], v[132:135]
    v_mul_f32 v217, v172, v64
    v_mfma_f32_16x16x32_bf16 v[136:139], v[112:115], v[80:83], 0
    v_fmac_f32 v217, v173, v64
    v_add_f32_dpp v220, v220, v220 row_half_mirror row_mask:0xf bank_mask:0xf
    v_mfma_f32_16x16x32_bf16 v[136:139], v[116:119], v[84:87], v[136:139]
    v_smfmac_f32_16x16x64_bf16 v[176:179], v[120:123], v[80:87], v250
    v_mad_u32_u16 v84, v204, s57, v213 op_sel:[1,0,0,0]
    v_mfma_f32_16x16x32_bf16 v[140:143], v[104:107], v[88:91], 0
    ds_read_b128 v[80:83], v84 offset:0
    ds_read_b128 v[84:87], v84 offset:64
    v_mfma_f32_16x16x32_bf16 v[140:143], v[108:111], v[92:95], v[140:143]
    v_fmac_f32 v208, v132, v36
    v_fmac_f32 v209, v133, v37
    v_mfma_f32_16x16x32_bf16 v[144:147], v[112:115], v[88:91], 0
    v_fmac_f32 v217, v176, v65
    v_fmac_f32 v208, v134, v38
    v_mfma_f32_16x16x32_bf16 v[144:147], v[116:119], v[92:95], v[144:147]
    v_fmac_f32 v217, v177, v65
    v_fmac_f32 v209, v135, v39
    v_smfmac_f32_16x16x64_bf16 v[180:183], v[120:123], v[88:95], v250
    v_mad_u32_u16 v92, v205, s57, v213 op_sel:[0,0,0,0]
    v_mfma_f32_16x16x32_bf16 v[148:151], v[104:107], v[96:99], 0
    ds_read_b128 v[88:91], v92 offset:0
    ds_read_b128 v[92:95], v92 offset:64
    v_smfmac_f32_16x16x64_bf16 v[196:199], v[44:47], v[140:147], v216
    v_fmac_f32 v208, v136, v40
    v_mfma_f32_16x16x32_bf16 v[148:151], v[108:111], v[100:103], v[148:151]
    v_fmac_f32 v217, v180, v66
    v_fmac_f32 v209, v137, v41
    v_mfma_f32_16x16x32_bf16 v[152:155], v[112:115], v[96:99], 0
    v_fmac_f32 v217, v181, v66
    v_fmac_f32 v208, v138, v42
    v_mfma_f32_16x16x32_bf16 v[152:155], v[116:119], v[100:103], v[152:155]
    v_fmac_f32 v209, v139, v43
    v_cndmask_b32_dpp v212, v212, v220, vcc row_shr:1 row_mask:0xf bank_mask:0xf bound_ctrl:0
    v_smfmac_f32_16x16x64_bf16 v[184:187], v[120:123], v[96:103], v250
    v_mad_u32_u16 v100, v205, s57, v213 op_sel:[1,0,0,0]
    v_mfma_f32_16x16x32_bf16 v[156:159], v[104:107], v[104:107], 0
    ds_read_b128 v[96:99], v100 offset:0
    ds_read_b128 v[100:103], v100 offset:64
    v_mfma_f32_16x16x32_bf16 v[156:159], v[108:111], v[108:111], v[156:159]
    v_fmac_f32 v208, v148, v48
    v_fmac_f32 v209, v149, v49
    v_mfma_f32_16x16x32_bf16 v[160:163], v[112:115], v[104:107], 0
    v_fmac_f32 v217, v184, v67
    v_fmac_f32 v208, v150, v50
    v_mfma_f32_16x16x32_bf16 v[160:163], v[116:119], v[108:111], v[160:163]
    v_fmac_f32 v217, v185, v67
    v_fmac_f32 v209, v151, v51
    v_smfmac_f32_16x16x64_bf16 v[188:191], v[120:123], v[104:111], v250
    v_mad_u32_u16 v108, v206, s57, v213 op_sel:[0,0,0,0]
    v_mfma_f32_16x16x32_bf16 v[164:167], v[112:115], v[112:115], 0
    ds_read_b128 v[104:107], v108 offset:0
    ds_read_b128 v[108:111], v108 offset:64
    v_smfmac_f32_16x16x64_bf16 v[196:199], v[56:59], v[156:163], v216
    s_waitcnt lgkmcnt(4)
    v_mfma_f32_16x16x32_bf16 v[164:167], v[116:119], v[116:119], v[164:167]
    v_fmac_f32 v217, v188, v68
    v_fmac_f32 v208, v152, v52
    v_smfmac_f32_16x16x64_bf16 v[192:195], v[120:123], v[112:119], v250
    v_mad_u32_u16 v116, v206, s57, v213 op_sel:[1,0,0,0]
    v_mfma_f32_16x16x32_bf16 v[168:171], v[120:123], v[120:123], 0
    ds_read_b128 v[112:115], v116 offset:0
    s_cbranch_scc0 k1_kernel_loop
    s_nop 7
    v_fmac_f32 v217, v189, v68
    v_fmac_f32 v217, v196, v200
    v_fmac_f32 v217, v192, v69
    v_fmac_f32 v217, v197, v201
    v_fmac_f32 v217, v193, v69
    v_fmac_f32 v217, v198, v202
    v_fmac_f32 v217, v199, v203
    v_fmac_f32 v209, v153, v53
    v_fmac_f32 v208, v154, v54
    v_fmac_f32 v209, v155, v55
    v_fmac_f32 v208, v164, v60
    v_fmac_f32 v209, v165, v61
    v_fmac_f32 v208, v166, v62
    v_fmac_f32 v209, v167, v63
    v_add_f32 v209, v209, v217
    v_fmac_f32 v208, v168, v70
    v_fmac_f32 v208, v169, v71
    v_add_f32 v211, v208, v209
    v_and_b32 v40, 7, v255
    s_mul_i32 s76, s36, 7
    v_permlane32_swap_b32 v210, v211
    v_add_f32 v219, v210, v211
    s_waitcnt lgkmcnt(0)
    v_lshrrev_b32 v41, 5, v255
    v_permlane16_swap_b32 v218, v219
    v_add_f32 v220, v218, v219
    s_xor_b32 s76, s76, 7
    v_bfe_u32 v42, v255, 4, 1
    v_add_f32_dpp v220, v220, v220 quad_perm:[1,0,3,2] row_mask:0xf bank_mask:0xf
    v_xor_b32 v40, s76, v40
    v_lshl_add_u32 v41, v42, 1, v41
    v_add_f32_dpp v220, v220, v220 quad_perm:[2,3,0,1] row_mask:0xf bank_mask:0xf
    s_lshl_b32 s74, s72, 2
    v_lshl_add_u32 v40, v40, 2, v41
    v_add_f32_dpp v220, v220, v220 row_half_mirror row_mask:0xf bank_mask:0xf
    v_cndmask_b32_dpp v212, v212, v220, vcc row_shr:1 row_mask:0xf bank_mask:0xf bound_ctrl:0
    s_lshl_b32 s76, s36, 16
    v_lshlrev_b32 v113, 2, v40
    v_add_f32_dpp v112, v212, v212 row_ror:8 row_mask:0xf bank_mask:0xf
    s_add_u32 s74, s74, s76
    s_add_u32 s74, s74, 29360128
    s_waitcnt vmcnt(0)
    v_min_u32 v112, -2, v112
    s_branch k1_kernel_k2
k1_kernel_last:
    s_endpgm
.section .rodata,"a"
.p2align 6
.amdhsa_kernel standalone__deep_cross_pnn__recsys_kernel
  .amdhsa_next_free_vgpr 256
  .amdhsa_next_free_sgpr 102
  .amdhsa_accum_offset 256
  .amdhsa_group_segment_fixed_size 0
  .amdhsa_kernarg_size 80
  .amdhsa_user_sgpr_count 2
  .amdhsa_user_sgpr_kernarg_segment_ptr 1
  .amdhsa_system_sgpr_workgroup_id_x 1
.end_amdhsa_kernel
```

```asm
; @launch grid=(256,1,1) block=(512,1,1) lds=163840
.amdgcn_target "amdgcn-amd-amdhsa--gfx950"
.text
.globl standalone__deep_cross_pnn__recsys_kernel
.p2align 8
.type standalone__deep_cross_pnn__recsys_kernel,@function
standalone__deep_cross_pnn__recsys_kernel:

    s_cmp_ge_u32 s2, 256
    s_cbranch_scc1 k1_kernel_end

    s_load_dwordx8 s[4:11], s[0:1], 0
    s_load_dwordx2 s[12:13], s[0:1], 72
    s_load_dwordx2 s[52:53], s[0:1], 64

    v_cmp_gt_u32 vcc, 40, v0
    s_and_saveexec_b64 s[48:49], vcc
    s_cbranch_execz k1_kernel_ncp
    s_getpc_b64 s[46:47]
k1_kernel_pc:
    s_bfe_u32 s38, s2, 0x40003
    s_lshl_b32 s38, s38, 7
    v_lshl_add_u32 v2, v0, 11, s38
    v_min_u32 v2, k1_kernel_last-k1_kernel_pc, v2
    global_load_dword v250, v2, s[46:47]
k1_kernel_ncp:
    s_mov_b64 exec, s[48:49]

    v_lshrrev_b32 v1, 6, v0
    v_and_b32 v255, 63, v0
    s_bfe_u32 s36, s2, 0x10003
    v_readfirstlane_b32 s3, v1
    s_lshr_b32 s37, s2, 4
    s_lshl_b32 s37, s37, 3
    s_and_b32 s38, s2, 7
    s_or_b32 s37, s37, s38
    v_lshlrev_b32 v254, 4, v255
    v_mov_b32 v252, 144144
    v_mov_b32 v253, 1
    v_mov_b32 v40, 0
    v_lshl_add_u32 v41, v0, 2, v252
    v_cmp_gt_u32 vcc, 8, v0
    s_and_saveexec_b64 s[46:47], vcc
    ds_write_b32 v41, v40
    s_mov_b64 exec, s[46:47]
    v_mul_u32_u24 v6, 57, v255
    v_lshrrev_b32 v6, 9, v6
    v_mul_u32_u24 v5, 9, v6
    v_sub_u32 v5, v255, v5
    v_cmp_gt_u32 s[40:41], 8, v5
    s_lshl_b32 s38, s36, 7
    v_lshl_add_u32 v5, v5, 4, s38
    v_lshl_add_u32 v83, v6, 8, v5
    s_and_b32 s56, s3, 3
    s_bitset0_b32 s41, 31
    s_lshr_b32 s42, s2, 3
    s_mul_i32 s42, s42, 36
    s_lshr_b32 s42, s42, 5
    s_lshl_b32 s42, s42, 2
    s_add_u32 s42, s42, s56
    s_mov_b32 s43, s42
    s_mov_b32 s50, s36
    s_lshl_b32 s72, s37, 7
    s_lshl_b32 s73, s3, 5
    s_add_u32 s72, s72, s73
    s_mul_i32 s74, s72, 400
    s_mul_i32 s45, s36, 11200
    s_add_u32 s74, s74, s45
    s_lshl_b32 s38, s3, 10
    s_add_u32 m0, s38, 144384

    s_mov_b32 s18, 6553600
    s_mov_b32 s19, 0x00020000
    s_mov_b32 s22, 256000
    s_mov_b32 s23, 0x00020000
    s_mov_b32 s26, 20000
    s_mov_b32 s27, 0x00020000
    s_mov_b32 s30, 13107200
    s_mov_b32 s31, 0x00020000
    s_mov_b32 s34, 268435456
    s_mov_b32 s35, 0x00020000
    s_mov_b32 s14, 268435456
    s_mov_b32 s15, 0x00020000
    s_mov_b32 s54, 256
    s_mov_b32 s55, 0x00020000

    v_bfe_u32 v5, v255, 2, 2
    v_mul_u32_u24 v5, 200, v5
    v_and_b32 v6, 3, v255
    v_lshl_add_u32 v5, v6, 5, v5
    v_and_b32 v6, 32, v255
    v_lshl_add_u32 v5, v6, 2, v5
    v_and_b32 v6, 16, v255
    v_add_u32 v5, v5, v6
    s_movk_i32 s39, 19200
    s_cmp_ge_u32 s3, 4
    s_waitcnt lgkmcnt(0)
    s_barrier
    s_cbranch_scc1 k1_kernel_dma

    s_mov_b32 s24, s8
    s_and_b32 s25, s9, 0xffff
    buffer_load_dwordx4 v254, s[24:27], s38 offen lds
    s_add_u32 s38, s38, 4096
    s_add_u32 m0, s38, 144384
    s_mov_b32 s16, s4
    s_and_b32 s17, s5, 0xffff
    buffer_load_dwordx4 v254, s[24:27], s38 offen lds
    s_add_u32 s38, s38, 4096
    s_add_u32 m0, s38, 144384
    v_cmp_lt_u32 vcc, 24, v255
    buffer_load_dwordx4 v254, s[24:27], s38 offen lds
    s_add_u32 s38, s38, 4096
    s_add_u32 m0, s38, 144384
    v_subbrev_co_u32 v249, vcc, 0, v255, vcc
    buffer_load_dwordx4 v254, s[24:27], s38 offen lds
    s_add_u32 s38, s38, 4096
    s_min_u32 s38, s38, 18432
    s_add_u32 m0, s38, 144384
    v_min_u32 v249, 49, v249
    v_lshlrev_b32 v249, 4, v249
    buffer_load_dwordx4 v254, s[24:27], s38 offen lds
    buffer_load_dwordx4 v[232:235], v5, s[24:27], s39 offen
    buffer_load_dwordx4 v[240:243], v249, s[16:19], s74 offen offset:0
    buffer_load_dwordx4 v[244:247], v249, s[16:19], s74 offen offset:800

    s_mul_i32 s77, s36, -3200
    s_mul_i32 s78, s72, 400
    s_addk_i32 s77, 1600
    s_add_u32 s79, s78, 11200
    s_add_u32 s74, s74, s77

    s_branch k1_kernel_main
k1_kernel_dma:
    s_mov_b32 s20, s6
    s_and_b32 s21, s7, 0xffff
    s_mov_b64 exec, s[40:41]
k1_kernel_dml:

    s_min_u32 s38, s42, 142
    s_mul_i32 m0, s38, 1008
    s_mul_i32 s39, s38, 1792
    s_add_u32 s42, s42, 4
    buffer_load_dwordx4 v83, s[20:23], s39 offen lds
    s_cmp_ge_u32 s42, 144
    s_cselect_b32 s38, 144, 0
    s_sub_u32 s42, s42, s38
    s_cmp_lg_u32 s42, s43
    s_cbranch_scc1 k1_kernel_dml
    s_mov_b64 exec, -1

    s_mov_b32 s16, s4
    s_and_b32 s17, s5, 0xffff
    s_mov_b32 s20, s6
    s_and_b32 s21, s7, 0xffff
    s_mov_b32 s28, s10
    s_and_b32 s29, s11, 0xffff
    s_mov_b32 s32, s12
    s_and_b32 s33, s13, 0xffff
    s_and_b32 s13, s13, 0xffff
    s_and_b32 s53, s53, 0xffff
k1_kernel_aux:

    s_setprio 0
    v_mov_b32 v8, v255
    v_mov_b32 v9, v254
    v_mov_b32 v10, v253
    v_mov_b32 v11, v252
    s_mov_b32 s51, s2
    s_mov_b32 s64, 0
    s_mov_b32 s65, 0

k1_kernel_unit:

    s_bfe_u32 s60, s51, 0x10003
    s_lshr_b32 s38, s51, 7
    s_xnor_b32 s36, s60, s38
    s_and_b32 s36, s36, 1

    s_lshr_b32 s38, s51, 4
    s_and_b32 s39, s51, 7
    s_sub_u32 s57, 2, s36
    s_lshl_b32 s57, s39, s57
    s_lshl_b32 s37, s36, 5
    s_add_u32 s57, s57, s37
    s_add_u32 s57, s57, s56
    s_mul_i32 s37, s38, 48
    s_add_u32 s37, s37, s57
    s_lshl_b32 s38, s38, 1
    s_lshr_b32 s39, s39, 2
    s_add_u32 s38, s38, s39
    s_add_u32 s38, s38, 768
    s_and_b32 s57, s57, 7
    s_cmp_eq_u32 s57, 2
    s_cselect_b32 s38, s38, 1000
    s_lshl_b32 s39, s36, 1
    s_and_b32 s39, s39, s56
    s_cselect_b32 s57, s38, s37

    s_mov_b32 s63, s36
    s_mov_b32 s36, s60
    s_lshr_b32 s37, s51, 4
    s_lshl_b32 s37, s37, 3
    s_and_b32 s38, s51, 7
    s_or_b32 s37, s37, s38
    s_and_b32 s58, s56, 1
    s_lshl_b32 s59, s37, 1
    s_add_u32 s58, s58, s59
    s_lshr_b32 s59, s56, 1
    s_xor_b32 s62, s59, 1
    s_and_b32 s59, s59, s63
    s_add_u32 s61, s63, 6
    s_mul_i32 s61, s61, s62
    s_mul_i32 s60, s36, 12
    s_add_u32 s61, s61, s60
    s_mul_i32 s60, s58, 25600
    s_lshl4_add_u32 s60, s61, s60
    s_cmp_eq_u32 s61, 7
    s_cselect_b32 s38, 5, 99
    s_movk_i32 s61, 400
    v_lshrrev_b32 v1, 3, v8
    v_and_b32 v2, 7, v8
    v_cmp_ne_u32 vcc, s38, v2
    v_mul_u32_u24 v0, s61, v1
    v_cmp_gt_u32 s[48:49], 7, v2
    v_cndmask_b32 v5, 17, v2, vcc
    v_lshl_add_u32 v0, v5, 4, v0
    v_and_b32 v5, 15, v8
    v_and_b32 v6, 48, v8
    v_lshl_add_u32 v7, v5, 8, v6
    s_lshl_b32 s44, s56, 15
    s_xor_b32 s38, s50, 1
    s_lshl_b32 s38, s38, 7
    s_add_u32 s44, s44, s38

    s_mov_b64 exec, s[48:49]
    buffer_load_dwordx4 v[224:227], v0, s[16:19], s60 offen
    s_add_u32 s60, s60, 3200
    buffer_load_dwordx4 v[228:231], v0, s[16:19], s60 offen
    s_add_u32 s60, s60, 3200
    buffer_load_dwordx4 v[232:235], v0, s[16:19], s60 offen
    s_add_u32 s60, s60, 3200
    buffer_load_dwordx4 v[236:239], v0, s[16:19], s60 offen
    s_add_u32 s60, s60, 3200
    buffer_load_dwordx4 v[240:243], v0, s[16:19], s60 offen
    s_add_u32 s60, s60, 3200
    buffer_load_dwordx4 v[244:247], v0, s[16:19], s60 offen
    s_add_u32 s60, s60, 3200
    buffer_load_dwordx4 v[248:251], v0, s[16:19], s60 offen
    s_add_u32 s60, s60, 3200
    buffer_load_dwordx4 v[252:255], v0, s[16:19], s60 offen
    s_add_u32 s60, s60, 3200
    s_mov_b64 exec, -1

    s_lshr_b32 s78, s57, 5
    s_bfe_u32 s79, s57, 0x20003
    s_bfe_u32 s80, s57, 0x20001
    s_and_b32 s81, s57, 1
    s_lshl_b32 s77, s78, 2
    s_lshl_b32 s83, s81, 1
    s_add_u32 s77, s77, s83
    s_lshl_b32 s77, s77, 7
    s_lshl_b32 s83, s79, 5
    s_add_u32 s77, s77, s83
    s_lshl_b32 s83, s80, 3
    s_add_u32 s77, s77, s83
    s_lshl_b32 s77, s77, 10
    s_lshl_b32 s82, s78, 12
    s_lshl_b32 s83, s79, 10
    s_add_u32 s82, s82, s83
    s_lshl_b32 s83, s80, 8
    s_add_u32 s82, s82, s83
    s_lshl_b32 s83, s81, 7
    s_add_u32 s82, s82, s83
    s_mov_b32 s84, 205312
    v_lshrrev_b32 v3, 2, v8
    v_and_b32 v4, 3, v8
    v_mul_lo_u32 v14, v3, s84
    v_lshl_add_u32 v14, v4, 4, v14
    s_lshl_b32 s61, s56, 12
    s_add_u32 s61, s61, 147456
    v_and_b32 v3, 3, v3
    v_lshlrev_b32 v36, 6, v8
    v_lshl_add_u32 v36, v3, 4, v36
    v_add_u32 v36, s61, v36
    v_xor_b32 v37, 16, v36
    v_xor_b32 v38, 32, v36
    v_xor_b32 v39, 48, v36
    v_and_b32 v3, 48, v8
    v_xor_b32 v15, v3, v9
    v_add_u32 v15, s61, v15
    s_mov_b32 s84, 0x05040100
    s_mov_b32 s85, 0x07060302
    s_cmp_eq_u32 s64, 0
    s_cbranch_scc1 k1_kernel_nsig0
    s_waitcnt vmcnt(0)

k1_kernel_nsig0:

    s_waitcnt vmcnt(8)
    s_cmp_lg_u32 s64, 0
    s_cbranch_scc1 k1_kernel_nsig

    s_mov_b64 exec, 1
    ds_add_u32 v11, v10 offset:16
    s_mov_b64 exec, -1

k1_kernel_nsig:
    s_setprio 3

    s_lshl_b32 s61, s56, 12
    s_add_u32 s61, s61, 147456
    v_lshlrev_b32 v86, 2, v8
    v_add_u32 v86, s61, v86
    v_and_b32 v85, 0xffffff80, v86
    v_and_b32 v123, 32, v8
    s_add_u32 s61, s61, 256
    v_mul_u32_u24 v31, 56, v8
    v_add_u32 v31, s61, v31
    v_mul_u32_u24 v34, 56, v1
    v_lshl_add_u32 v34, v2, 3, v34
    v_add_u32 v34, s61, v34
    s_lshl_b32 s61, s62, s63
    v_add_u32 v2, s61, v2
    v_subrev_u32 v3, 5, v2
    v_min_u32 v2, v2, v3
    v_mov_b32 v13, 0
    v_mul_u32_u24 v2, 0x10001, v2
    v_lshlrev_b32 v2, 12, v2
    v_add_u32 v32, 67108864, v2
    v_add_u32 v33, 201328640, v2
    v_mov_b32 v71, 0xf00
    s_add_u32 s61, s63, 7
    s_xor_b32 s63, s63, 1
    s_cmp_eq_u32 s62, 1
    s_cselect_b32 s62, s61, s63
    s_mul_i32 s63, s36, 13
    s_add_u32 s62, s62, s63
    s_lshl_b32 s62, s62, 7
    s_and_b32 s63, s58, 127
    s_add_u32 s62, s62, s63
    s_lshl_b32 s62, s62, 10
    s_add_u32 s62, s62, 16777216
    s_cmp_eq_u32 s59, 1
    s_cselect_b32 s63, -16, 0x0ffffff0
    s_movk_i32 s66, 0x7c
    s_mov_b32 s67, 0x001f001f
    s_mov_b32 s75, 0x06040200
    v_mov_b32 v54, 0x08040201
    v_mov_b32 v55, 0x80402010

    s_lshl_b32 s72, s2, 15
    s_lshl_b32 s73, s56, 13
    s_add_u32 s72, s72, s73
    s_add_u32 s72, s72, 20971520
    s_lshl_b32 s73, s36, 9
    s_lshl2_add_u32 s73, s37, s73
    s_add_u32 s73, s73, s56
    s_lshl_b32 s73, s73, 7
    s_add_u32 s73, s73, 29360128

k1_kernel_wf3:

    ds_read_b32 v12, v11 offset:12
    s_waitcnt lgkmcnt(0)
    v_readfirstlane_b32 s45, v12
    s_cmp_lt_u32 s45, 4
    s_cbranch_scc1 k1_kernel_wf3

    s_mov_b64 exec, s[48:49]

    s_waitcnt vmcnt(7)
    v_lshl_or_b32 v224, v225, 16, v224
    v_lshl_or_b32 v225, v227, 16, v226
    v_add_u32 v224, v32, v224
    v_add_u32 v225, v33, v225
    ds_write_b64 v34, v[224:225] offset:0

    s_waitcnt vmcnt(6)
    v_lshl_or_b32 v228, v229, 16, v228
    v_lshl_or_b32 v229, v231, 16, v230
    v_add_u32 v228, v32, v228
    v_add_u32 v229, v33, v229
    ds_write_b64 v34, v[228:229] offset:448

    s_waitcnt vmcnt(5)
    v_lshl_or_b32 v232, v233, 16, v232
    v_lshl_or_b32 v233, v235, 16, v234
    v_add_u32 v232, v32, v232
    v_add_u32 v233, v33, v233
    ds_write_b64 v34, v[232:233] offset:896

    s_waitcnt vmcnt(4)
    v_lshl_or_b32 v236, v237, 16, v236
    v_lshl_or_b32 v237, v239, 16, v238
    v_add_u32 v236, v32, v236
    v_add_u32 v237, v33, v237
    ds_write_b64 v34, v[236:237] offset:1344

    s_waitcnt vmcnt(3)
    v_lshl_or_b32 v240, v241, 16, v240
    v_lshl_or_b32 v241, v243, 16, v242
    v_add_u32 v240, v32, v240
    v_add_u32 v241, v33, v241
    ds_write_b64 v34, v[240:241] offset:1792

    s_waitcnt vmcnt(2)
    v_lshl_or_b32 v244, v245, 16, v244
    v_lshl_or_b32 v245, v247, 16, v246
    v_add_u32 v244, v32, v244
    v_add_u32 v245, v33, v245
    ds_write_b64 v34, v[244:245] offset:2240

    s_waitcnt vmcnt(1)
    v_lshl_or_b32 v248, v249, 16, v248
    v_lshl_or_b32 v249, v251, 16, v250
    v_add_u32 v248, v32, v248
    v_add_u32 v249, v33, v249
    ds_write_b64 v34, v[248:249] offset:2688

    s_waitcnt vmcnt(0)
    v_lshl_or_b32 v252, v253, 16, v252
    v_lshl_or_b32 v253, v255, 16, v254
    v_add_u32 v252, v32, v252
    v_add_u32 v253, v33, v253
    ds_write_b64 v34, v[252:253] offset:3136

    s_mov_b64 exec, -1
    ds_read_b64 v[40:41], v31 offset:0
    ds_read_b64 v[42:43], v31 offset:8
    ds_read_b64 v[44:45], v31 offset:16
    ds_read_b64 v[46:47], v31 offset:24
    ds_read_b64 v[48:49], v31 offset:32
    ds_read_b64 v[50:51], v31 offset:40
    ds_read_b64 v[52:53], v31 offset:48

    s_waitcnt lgkmcnt(6)
    v_perm_b32 v72, v41, v40, s75
    v_lshrrev_b32 v73, 3, v72
    v_lshlrev_b32 v64, 2, v72
    v_and_b32 v72, 0x07070707, v72
    v_and_b32 v0, 0x03030303, v73
    v_perm_b32 v16, v55, v54, v72
    v_xor_b32 v23, v55, v16

    s_waitcnt lgkmcnt(5)
    v_perm_b32 v72, v43, v42, s75
    v_lshrrev_b32 v73, 3, v72
    v_lshlrev_b32 v65, 2, v72
    v_and_b32 v72, 0x07070707, v72
    v_and_b32 v1, 0x03030303, v73
    v_perm_b32 v17, v55, v54, v72
    v_xor_b32 v24, v55, v17

    s_waitcnt lgkmcnt(4)
    v_perm_b32 v72, v45, v44, s75
    v_lshrrev_b32 v73, 3, v72
    v_lshlrev_b32 v66, 2, v72
    v_and_b32 v72, 0x07070707, v72
    v_and_b32 v2, 0x03030303, v73
    v_perm_b32 v18, v55, v54, v72
    v_xor_b32 v25, v55, v18

    s_waitcnt lgkmcnt(3)
    v_perm_b32 v72, v47, v46, s75
    v_lshrrev_b32 v73, 3, v72
    v_lshlrev_b32 v67, 2, v72
    v_and_b32 v72, 0x07070707, v72
    v_and_b32 v3, 0x03030303, v73
    v_perm_b32 v19, v55, v54, v72
    v_xor_b32 v26, v55, v19

    s_waitcnt lgkmcnt(2)
    v_perm_b32 v72, v49, v48, s75
    v_lshrrev_b32 v73, 3, v72
    v_lshlrev_b32 v68, 2, v72
    v_and_b32 v72, 0x07070707, v72
    v_and_b32 v4, 0x03030303, v73
    v_perm_b32 v20, v55, v54, v72
    v_xor_b32 v27, v55, v20

    s_waitcnt lgkmcnt(1)
    v_perm_b32 v72, v51, v50, s75
    v_lshrrev_b32 v73, 3, v72
    v_lshlrev_b32 v69, 2, v72
    v_and_b32 v72, 0x07070707, v72
    v_and_b32 v5, 0x03030303, v73
    v_perm_b32 v21, v55, v54, v72
    v_xor_b32 v28, v55, v21

    s_waitcnt lgkmcnt(0)
    v_perm_b32 v72, v53, v52, s75
    v_lshrrev_b32 v73, 3, v72
    v_lshlrev_b32 v70, 2, v72
    v_and_b32 v72, 0x07070707, v72
    v_and_b32 v6, 0x03030303, v73
    v_perm_b32 v22, v55, v54, v72
    v_xor_b32 v29, v55, v22

    ds_write_b32 v86, v13
    v_mov_b32 v71, s63
    v_subrev_u32 v30, 8, v31
    s_setprio 0
    v_ffbl_b32 v84, v71

    v_perm_b32 v72, v64, v64, v84
    v_and_or_b32 v72, v72, s66, v85
    ds_add_rtn_u32 v87, v72, v10
    ds_wrxchg_rtn_b32 v116, v86, v13

    s_waitcnt lgkmcnt(0)
    v_cmp_gt_u32 s[68:69], 2, v116

    v_cmpx_lt_u32 vcc, 1, v87
    s_nop 0
    v_lshrrev_b64 v[74:75], v123, s[68:69]
    v_perm_b32 v121, v74, v74, v1
    v_perm_b32 v122, v74, v74, v0
    v_and_b32 v121, v121, v17
    v_and_b32 v122, v122, v16
    v_msad_u8 v120, v24, v121, 0
    v_lshlrev_b32 v120, 4, v120
    v_msad_u8 v120, v23, v122, v120
    v_and_b32 v120, v120, v71

    v_ffbl_b32 v120, v120
    v_max_i32 v84, v120, v84
    s_mov_b64 exec, -1

    v_lshl_add_u32 v73, v84, 1, v30
    v_lshl_add_u32 v71, -1, v84, v71
    ds_read_u16 v80, v73 offset:0
    v_ffbl_b32 v84, v71

    v_perm_b32 v72, v64, v64, v84
    v_and_or_b32 v72, v72, s66, v85
    ds_add_rtn_u32 v87, v72, v10
    ds_wrxchg_rtn_b32 v116, v86, v13

    s_lshl_b32 s45, s2, 8
    s_add_u32 s45, s45, 14680064
    s_mov_b64 exec, 3
    buffer_store_dword v13, v9, s[12:15], s45 offen sc1
    s_mov_b64 exec, -1
    buffer_load_dwordx4 v[128:131], v9, s[28:31], s77 offen offset:0

    s_waitcnt lgkmcnt(0)
    v_cmp_gt_u32 s[68:69], 2, v116

    v_cmpx_lt_u32 vcc, 1, v87
    s_nop 0
    v_lshrrev_b64 v[74:75], v123, s[68:69]
    v_perm_b32 v121, v74, v74, v1
    v_perm_b32 v122, v74, v74, v0
    v_and_b32 v121, v121, v17
    v_and_b32 v122, v122, v16
    v_msad_u8 v120, v24, v121, 0
    v_lshlrev_b32 v120, 4, v120
    v_msad_u8 v120, v23, v122, v120
    v_and_b32 v120, v120, v71

    v_ffbl_b32 v120, v120
    v_max_i32 v84, v120, v84
    s_mov_b64 exec, -1

    v_lshl_add_u32 v73, v84, 1, v30
    v_lshl_add_u32 v71, -1, v84, v71
    ds_read_u16 v81, v73 offset:0
    v_ffbl_b32 v84, v71

    v_perm_b32 v72, v64, v64, v84
    v_and_or_b32 v72, v72, s66, v85
    ds_add_rtn_u32 v87, v72, v10
    ds_wrxchg_rtn_b32 v116, v86, v13

    s_lshl_b32 s45, s2, 10
    s_add_u32 s45, s45, 30408704
    s_mov_b32 exec_lo, 0x01010101
    s_mov_b32 exec_hi, 0x01010101
    buffer_store_dword v13, v9, s[12:15], s45 offen sc1
    s_lshl_b32 s45, s2, 16
    s_add_u32 s45, s45, 33554432
    s_mov_b64 exec, 1
    buffer_load_dword v117, v13, s[12:15], s45 offen
    s_mov_b64 exec, -1
    buffer_load_dwordx4 v[132:135], v9, s[28:31], s77 offen offset:1024

    s_waitcnt lgkmcnt(0)
    v_cmp_gt_u32 s[68:69], 2, v116

    v_cmpx_lt_u32 vcc, 1, v87
    s_nop 0
    v_lshrrev_b64 v[74:75], v123, s[68:69]
    v_perm_b32 v121, v74, v74, v1
    v_perm_b32 v122, v74, v74, v0
    v_and_b32 v121, v121, v17
    v_and_b32 v122, v122, v16
    v_msad_u8 v120, v24, v121, 0
    v_lshlrev_b32 v120, 4, v120
    v_msad_u8 v120, v23, v122, v120
    v_and_b32 v120, v120, v71

    v_ffbl_b32 v120, v120
    v_max_i32 v84, v120, v84
    s_mov_b64 exec, -1

    v_lshl_add_u32 v73, v84, 1, v30
    v_lshl_add_u32 v71, -1, v84, v71
    ds_read_u16 v82, v73 offset:0
    v_ffbl_b32 v84, v71

    v_perm_b32 v72, v64, v64, v84
    v_and_or_b32 v72, v72, s66, v85
    ds_add_rtn_u32 v87, v72, v10
    ds_wrxchg_rtn_b32 v116, v86, v13

    buffer_load_dwordx4 v[144:147], v9, s[28:31], s77 offen offset:2048

    s_waitcnt lgkmcnt(0)
    v_cmp_gt_u32 s[68:69], 2, v116

    v_cmpx_lt_u32 vcc, 1, v87
    s_nop 0
    v_lshrrev_b64 v[74:75], v123, s[68:69]
    v_perm_b32 v121, v74, v74, v1
    v_and_b32 v121, v121, v17
    v_msad_u8 v120, v24, v121, 0
    v_lshlrev_b32 v120, 4, v120
    v_and_b32 v120, v120, v71

    v_ffbl_b32 v120, v120
    v_max_i32 v84, v120, v84
    s_mov_b64 exec, -1

    v_lshl_add_u32 v73, v84, 1, v30
    v_lshl_add_u32 v71, -1, v84, v71
    ds_read_u16 v83, v73 offset:0
    v_lshrrev_b32 v71, 4, v71
    v_ffbl_b32 v84, v71

    v_perm_b32 v72, v65, v64, v84
    v_and_or_b32 v72, v72, s66, v85
    ds_add_rtn_u32 v87, v72, v10
    ds_wrxchg_rtn_b32 v116, v86, v13

    buffer_load_dwordx4 v[148:151], v9, s[28:31], s77 offen offset:3072
    s_add_u32 s77, s77, 4096
    s_mov_b32 s70, 0x7fff7fff

    s_waitcnt lgkmcnt(0)
    v_cmp_gt_u32 s[68:69], 2, v116

    s_cmp_eq_u32 s59, 0
    v_lshl_or_b32 v76, v81, 16, v80
    v_lshl_or_b32 v77, v83, 16, v82
    s_cbranch_scc1 k1_kernel_nf0
    buffer_store_dwordx4 v[76:79], v9, s[32:35], s62 offen sc1
    s_add_u32 s62, s62, 262144
k1_kernel_nf0:
    v_cmpx_lt_u32 vcc, 1, v87
    v_bfe_i32 v119, s70, v71, 1
    v_lshrrev_b64 v[74:75], v123, s[68:69]
    v_perm_b32 v121, v74, v74, v2
    v_perm_b32 v122, v74, v74, v1
    v_and_b32 v121, v121, v18
    v_and_b32 v122, v122, v17
    v_msad_u8 v120, v25, v121, 0
    v_lshlrev_b32 v120, 4, v120
    v_msad_u8 v120, v24, v122, v120
    v_bitop3_b32 v120, v120, v71, v119 bitop3:0x80

    v_ffbl_b32 v120, v120
    v_max_i32 v84, v120, v84
    s_mov_b64 exec, -1

    v_lshl_add_u32 v73, v84, 1, v30
    v_lshl_add_u32 v71, -1, v84, v71
    ds_read_u16 v80, v73 offset:8
    v_ffbl_b32 v84, v71

    v_perm_b32 v72, v65, v64, v84
    v_and_or_b32 v72, v72, s66, v85
    ds_add_rtn_u32 v87, v72, v10
    ds_wrxchg_rtn_b32 v116, v86, v13

    buffer_load_dwordx4 v[160:163], v9, s[28:31], s77 offen offset:0
    s_mov_b32 s70, 0x977f977f

    s_waitcnt lgkmcnt(0)
    v_cmp_gt_u32 s[68:69], 2, v116

    v_cmpx_lt_u32 vcc, 1, v87
    v_bfe_i32 v119, s70, v71, 1
    v_lshrrev_b64 v[74:75], v123, s[68:69]
    v_perm_b32 v121, v74, v74, v2
    v_perm_b32 v122, v74, v74, v1
    v_and_b32 v121, v121, v18
    v_and_b32 v122, v122, v17
    v_msad_u8 v120, v25, v121, 0
    v_lshlrev_b32 v120, 4, v120
    v_msad_u8 v120, v24, v122, v120
    v_bitop3_b32 v120, v120, v71, v119 bitop3:0x80

    v_ffbl_b32 v120, v120
    v_max_i32 v84, v120, v84
    s_mov_b64 exec, -1

    v_lshl_add_u32 v73, v84, 1, v30
    v_lshl_add_u32 v71, -1, v84, v71
    ds_read_u16 v81, v73 offset:8
    v_ffbl_b32 v84, v71

    v_perm_b32 v72, v65, v64, v84
    v_and_or_b32 v72, v72, s66, v85
    ds_add_rtn_u32 v87, v72, v10
    ds_wrxchg_rtn_b32 v116, v86, v13

    buffer_load_dwordx4 v[164:167], v9, s[28:31], s77 offen offset:1024
    s_mov_b32 s70, 0xe997e997

    s_waitcnt lgkmcnt(0)
    v_cmp_gt_u32 s[68:69], 2, v116

    v_cmpx_lt_u32 vcc, 1, v87
    v_bfe_i32 v119, s70, v71, 1
    v_lshrrev_b64 v[74:75], v123, s[68:69]
    v_perm_b32 v121, v74, v74, v2
    v_perm_b32 v122, v74, v74, v1
    v_and_b32 v121, v121, v18
    v_and_b32 v122, v122, v17
    v_msad_u8 v120, v25, v121, 0
    v_lshlrev_b32 v120, 4, v120
    v_msad_u8 v120, v24, v122, v120
    v_bitop3_b32 v120, v120, v71, v119 bitop3:0x80

    v_ffbl_b32 v120, v120
    v_max_i32 v84, v120, v84
    s_mov_b64 exec, -1

    v_lshl_add_u32 v73, v84, 1, v30
    v_lshl_add_u32 v71, -1, v84, v71
    ds_read_u16 v82, v73 offset:8
    v_ffbl_b32 v84, v71

    v_perm_b32 v72, v65, v64, v84
    v_and_or_b32 v72, v72, s66, v85
    ds_add_rtn_u32 v87, v72, v10
    ds_wrxchg_rtn_b32 v116, v86, v13

    buffer_load_dwordx4 v[176:179], v9, s[28:31], s77 offen offset:2048
    s_add_u32 s47, s44, 12288
    buffer_load_dwordx4 v[56:59], v7, s[20:23], s47 offen offset:0
    buffer_load_dwordx4 v[60:63], v7, s[20:23], s47 offen offset:64
    s_mov_b32 s70, 0xfee9fee9

    s_waitcnt lgkmcnt(0)
    v_cmp_gt_u32 s[68:69], 2, v116

    v_cmpx_lt_u32 vcc, 1, v87
    v_bfe_i32 v119, s70, v71, 1
    v_lshrrev_b64 v[74:75], v123, s[68:69]
    v_perm_b32 v121, v74, v74, v2
    v_and_b32 v121, v121, v18
    v_msad_u8 v120, v25, v121, 0
    v_lshlrev_b32 v120, 4, v120
    v_bitop3_b32 v120, v120, v71, v119 bitop3:0x80

    v_ffbl_b32 v120, v120
    v_max_i32 v84, v120, v84
    s_mov_b64 exec, -1

    v_lshl_add_u32 v73, v84, 1, v30
    v_lshl_add_u32 v71, -1, v84, v71
    ds_read_u16 v83, v73 offset:8
    v_lshrrev_b32 v71, 4, v71
    v_ffbl_b32 v84, v71

    v_perm_b32 v72, v66, v65, v84
    v_and_or_b32 v72, v72, s66, v85
    ds_add_rtn_u32 v87, v72, v10
    ds_wrxchg_rtn_b32 v116, v86, v13

    buffer_load_dwordx4 v[180:183], v9, s[28:31], s77 offen offset:3072
    s_add_u32 s77, s77, 126976
    s_cmp_lg_u32 s64, 0
    s_cbranch_scc1 k1_kernel_nc8
    v_mov_b32 v121, -1
    v_lshlrev_b32 v122, 1, v8
    buffer_store_short v121, v122, s[12:15], s73 offen sc1
k1_kernel_nc8:
    s_add_u32 s47, s44, 16384
    buffer_load_dwordx4 v[88:91], v7, s[20:23], s47 offen offset:0
    buffer_load_dwordx4 v[92:95], v7, s[20:23], s47 offen offset:64
    s_mov_b32 s70, 0x7fff7fff

    s_waitcnt lgkmcnt(0)
    v_cmp_gt_u32 s[68:69], 2, v116

    s_cmp_eq_u32 s59, 1
    v_lshl_or_b32 v78, v81, 16, v80
    v_lshl_or_b32 v79, v83, 16, v82
    s_cbranch_scc1 k1_kernel_nf1
    buffer_store_dwordx4 v[76:79], v9, s[32:35], s62 offen sc1
    s_add_u32 s62, s62, 262144
k1_kernel_nf1:
    v_cmpx_lt_u32 vcc, 1, v87
    v_bfe_i32 v119, s70, v71, 1
    v_lshrrev_b64 v[74:75], v123, s[68:69]
    v_perm_b32 v121, v74, v74, v3
    v_perm_b32 v122, v74, v74, v2
    v_and_b32 v121, v121, v19
    v_and_b32 v122, v122, v18
    v_msad_u8 v120, v26, v121, 0
    v_lshlrev_b32 v120, 4, v120
    v_msad_u8 v120, v25, v122, v120
    v_bitop3_b32 v120, v120, v71, v119 bitop3:0x80

    v_ffbl_b32 v120, v120
    v_max_i32 v84, v120, v84
    s_mov_b64 exec, -1

    v_lshl_add_u32 v73, v84, 1, v30
    v_lshl_add_u32 v71, -1, v84, v71
    ds_read_u16 v80, v73 offset:16
    v_ffbl_b32 v84, v71

    v_perm_b32 v72, v66, v65, v84
    v_and_or_b32 v72, v72, s66, v85
    ds_add_rtn_u32 v87, v72, v10
    ds_wrxchg_rtn_b32 v116, v86, v13

    buffer_load_dwordx4 v[192:195], v9, s[28:31], s77 offen offset:0
    s_add_u32 s47, s44, 20480
    buffer_load_dwordx4 v[96:99], v7, s[20:23], s47 offen offset:0
    buffer_load_dwordx4 v[100:103], v7, s[20:23], s47 offen offset:64
    s_mov_b32 s70, 0x977f977f

    s_waitcnt lgkmcnt(0)
    v_cmp_gt_u32 s[68:69], 2, v116

    v_cmpx_lt_u32 vcc, 1, v87
    v_bfe_i32 v119, s70, v71, 1
    v_lshrrev_b64 v[74:75], v123, s[68:69]
    v_perm_b32 v121, v74, v74, v3
    v_perm_b32 v122, v74, v74, v2
    v_and_b32 v121, v121, v19
    v_and_b32 v122, v122, v18
    v_msad_u8 v120, v26, v121, 0
    v_lshlrev_b32 v120, 4, v120
    v_msad_u8 v120, v25, v122, v120
    v_bitop3_b32 v120, v120, v71, v119 bitop3:0x80

    v_ffbl_b32 v120, v120
    v_max_i32 v84, v120, v84
    s_mov_b64 exec, -1

    v_lshl_add_u32 v73, v84, 1, v30
    v_lshl_add_u32 v71, -1, v84, v71
    ds_read_u16 v81, v73 offset:16
    v_ffbl_b32 v84, v71

    v_perm_b32 v72, v66, v65, v84
    v_and_or_b32 v72, v72, s66, v85
    ds_add_rtn_u32 v87, v72, v10
    ds_wrxchg_rtn_b32 v116, v86, v13

    buffer_load_dwordx4 v[196:199], v9, s[28:31], s77 offen offset:1024
    s_add_u32 s47, s44, 24576
    buffer_load_dwordx4 v[104:107], v7, s[20:23], s47 offen offset:0
    buffer_load_dwordx4 v[108:111], v7, s[20:23], s47 offen offset:64
    s_mov_b32 s70, 0xe997e997

    s_waitcnt lgkmcnt(0)
    v_cmp_gt_u32 s[68:69], 2, v116

    v_cmpx_lt_u32 vcc, 1, v87
    v_bfe_i32 v119, s70, v71, 1
    v_lshrrev_b64 v[74:75], v123, s[68:69]
    v_perm_b32 v121, v74, v74, v3
    v_perm_b32 v122, v74, v74, v2
    v_and_b32 v121, v121, v19
    v_and_b32 v122, v122, v18
    v_msad_u8 v120, v26, v121, 0
    v_lshlrev_b32 v120, 4, v120
    v_msad_u8 v120, v25, v122, v120
    v_bitop3_b32 v120, v120, v71, v119 bitop3:0x80

    v_ffbl_b32 v120, v120
    v_max_i32 v84, v120, v84
    s_mov_b64 exec, -1

    v_lshl_add_u32 v73, v84, 1, v30
    v_lshl_add_u32 v71, -1, v84, v71
    ds_read_u16 v82, v73 offset:16
    v_ffbl_b32 v84, v71

    v_perm_b32 v72, v66, v65, v84
    v_and_or_b32 v72, v72, s66, v85
    ds_add_rtn_u32 v87, v72, v10
    ds_wrxchg_rtn_b32 v116, v86, v13

    buffer_load_dwordx4 v[208:211], v9, s[28:31], s77 offen offset:2048
    s_add_u32 s47, s44, 28672
    buffer_load_dwordx4 v[112:115], v7, s[20:23], s47 offen offset:0
    buffer_load_dwordx4 v[124:127], v7, s[20:23], s47 offen offset:64
    s_mov_b32 s70, 0xfee9fee9

    s_waitcnt lgkmcnt(0)
    v_cmp_gt_u32 s[68:69], 2, v116

    v_cmpx_lt_u32 vcc, 1, v87
    v_bfe_i32 v119, s70, v71, 1
    v_lshrrev_b64 v[74:75], v123, s[68:69]
    v_perm_b32 v121, v74, v74, v3
    v_and_b32 v121, v121, v19
    v_msad_u8 v120, v26, v121, 0
    v_lshlrev_b32 v120, 4, v120
    v_bitop3_b32 v120, v120, v71, v119 bitop3:0x80

    v_ffbl_b32 v120, v120
    v_max_i32 v84, v120, v84
    s_mov_b64 exec, -1

    v_lshl_add_u32 v73, v84, 1, v30
    v_lshl_add_u32 v71, -1, v84, v71
    ds_read_u16 v83, v73 offset:16
    v_lshrrev_b32 v71, 4, v71
    v_ffbl_b32 v84, v71

    v_perm_b32 v72, v67, v66, v84
    v_and_or_b32 v72, v72, s66, v85
    ds_add_rtn_u32 v87, v72, v10
    ds_wrxchg_rtn_b32 v116, v86, v13

    buffer_load_dwordx4 v[212:215], v9, s[28:31], s77 offen offset:3072
    s_add_u32 s77, s77, 4096
    s_add_u32 s47, s44, 131072
    buffer_load_dwordx4 v[136:139], v7, s[20:23], s47 offen offset:0
    buffer_load_dwordx4 v[140:143], v7, s[20:23], s47 offen offset:64
    s_mov_b32 s70, 0x7fff7fff

    s_waitcnt lgkmcnt(0)
    v_cmp_gt_u32 s[68:69], 2, v116

    s_cmp_eq_u32 s59, 0
    v_lshl_or_b32 v76, v81, 16, v80
    v_lshl_or_b32 v77, v83, 16, v82
    s_cbranch_scc1 k1_kernel_nf2
    buffer_store_dwordx4 v[76:79], v9, s[32:35], s62 offen sc1
    s_add_u32 s62, s62, 262144
k1_kernel_nf2:
    v_cmpx_lt_u32 vcc, 1, v87
    v_bfe_i32 v119, s70, v71, 1
    v_lshrrev_b64 v[74:75], v123, s[68:69]
    v_perm_b32 v121, v74, v74, v4
    v_perm_b32 v122, v74, v74, v3
    v_and_b32 v121, v121, v20
    v_and_b32 v122, v122, v19
    v_msad_u8 v120, v27, v121, 0
    v_lshlrev_b32 v120, 4, v120
    v_msad_u8 v120, v26, v122, v120
    v_bitop3_b32 v120, v120, v71, v119 bitop3:0x80

    v_ffbl_b32 v120, v120
    v_max_i32 v84, v120, v84
    s_mov_b64 exec, -1

    v_lshl_add_u32 v73, v84, 1, v30
    v_lshl_add_u32 v71, -1, v84, v71
    ds_read_u16 v80, v73 offset:24
    v_ffbl_b32 v84, v71

    v_perm_b32 v72, v67, v66, v84
    v_and_or_b32 v72, v72, s66, v85
    ds_add_rtn_u32 v87, v72, v10
    ds_wrxchg_rtn_b32 v116, v86, v13

    buffer_load_dwordx4 v[224:227], v9, s[28:31], s77 offen offset:0
    s_add_u32 s47, s44, 135168
    buffer_load_dwordx4 v[152:155], v7, s[20:23], s47 offen offset:0
    buffer_load_dwordx4 v[156:159], v7, s[20:23], s47 offen offset:64
    s_mov_b32 s70, 0x977f977f

    s_waitcnt lgkmcnt(0)
    v_cmp_gt_u32 s[68:69], 2, v116

    v_cmpx_lt_u32 vcc, 1, v87
    v_bfe_i32 v119, s70, v71, 1
    v_lshrrev_b64 v[74:75], v123, s[68:69]
    v_perm_b32 v121, v74, v74, v4
    v_perm_b32 v122, v74, v74, v3
    v_and_b32 v121, v121, v20
    v_and_b32 v122, v122, v19
    v_msad_u8 v120, v27, v121, 0
    v_lshlrev_b32 v120, 4, v120
    v_msad_u8 v120, v26, v122, v120
    v_bitop3_b32 v120, v120, v71, v119 bitop3:0x80

    v_ffbl_b32 v120, v120
    v_max_i32 v84, v120, v84
    s_mov_b64 exec, -1

    v_lshl_add_u32 v73, v84, 1, v30
    v_lshl_add_u32 v71, -1, v84, v71
    ds_read_u16 v81, v73 offset:24
    v_ffbl_b32 v84, v71

    v_perm_b32 v72, v67, v66, v84
    v_and_or_b32 v72, v72, s66, v85
    ds_add_rtn_u32 v87, v72, v10
    ds_wrxchg_rtn_b32 v116, v86, v13

    buffer_load_dwordx4 v[228:231], v9, s[28:31], s77 offen offset:1024
    s_add_u32 s47, s44, 139264
    buffer_load_dwordx4 v[168:171], v7, s[20:23], s47 offen offset:0
    buffer_load_dwordx4 v[172:175], v7, s[20:23], s47 offen offset:64
    s_mov_b32 s70, 0xe997e997

    s_waitcnt lgkmcnt(0)
    v_cmp_gt_u32 s[68:69], 2, v116

    v_cmpx_lt_u32 vcc, 1, v87
    v_bfe_i32 v119, s70, v71, 1
    v_lshrrev_b64 v[74:75], v123, s[68:69]
    v_perm_b32 v121, v74, v74, v4
    v_perm_b32 v122, v74, v74, v3
    v_and_b32 v121, v121, v20
    v_and_b32 v122, v122, v19
    v_msad_u8 v120, v27, v121, 0
    v_lshlrev_b32 v120, 4, v120
    v_msad_u8 v120, v26, v122, v120
    v_bitop3_b32 v120, v120, v71, v119 bitop3:0x80

    v_ffbl_b32 v120, v120
    v_max_i32 v84, v120, v84
    s_mov_b64 exec, -1

    v_lshl_add_u32 v73, v84, 1, v30
    v_lshl_add_u32 v71, -1, v84, v71
    ds_read_u16 v82, v73 offset:24
    v_ffbl_b32 v84, v71

    v_perm_b32 v72, v67, v66, v84
    v_and_or_b32 v72, v72, s66, v85
    ds_add_rtn_u32 v87, v72, v10
    ds_wrxchg_rtn_b32 v116, v86, v13

    buffer_load_dwordx4 v[240:243], v9, s[28:31], s77 offen offset:2048
    s_add_u32 s47, s44, 143360
    buffer_load_dwordx4 v[184:187], v7, s[20:23], s47 offen offset:0
    buffer_load_dwordx4 v[188:191], v7, s[20:23], s47 offen offset:64
    s_mov_b32 s70, 0xfee9fee9

    s_waitcnt lgkmcnt(0)
    v_cmp_gt_u32 s[68:69], 2, v116

    v_cmpx_lt_u32 vcc, 1, v87
    v_bfe_i32 v119, s70, v71, 1
    v_lshrrev_b64 v[74:75], v123, s[68:69]
    v_perm_b32 v121, v74, v74, v4
    v_and_b32 v121, v121, v20
    v_msad_u8 v120, v27, v121, 0
    v_lshlrev_b32 v120, 4, v120
    v_bitop3_b32 v120, v120, v71, v119 bitop3:0x80

    v_ffbl_b32 v120, v120
    v_max_i32 v84, v120, v84
    s_mov_b64 exec, -1

    v_lshl_add_u32 v73, v84, 1, v30
    v_lshl_add_u32 v71, -1, v84, v71
    ds_read_u16 v83, v73 offset:24
    v_lshrrev_b32 v71, 4, v71
    v_ffbl_b32 v84, v71

    v_perm_b32 v72, v68, v67, v84
    v_and_or_b32 v72, v72, s66, v85
    ds_add_rtn_u32 v87, v72, v10
    ds_wrxchg_rtn_b32 v116, v86, v13

    buffer_load_dwordx4 v[244:247], v9, s[28:31], s77 offen offset:3072
    s_add_u32 s47, s44, 147456
    buffer_load_dwordx4 v[200:203], v7, s[20:23], s47 offen offset:0
    buffer_load_dwordx4 v[204:207], v7, s[20:23], s47 offen offset:64
    s_mov_b32 s70, 0x7fff7fff

    s_waitcnt lgkmcnt(0)
    v_cmp_gt_u32 s[68:69], 2, v116

    s_cmp_eq_u32 s59, 1
    v_lshl_or_b32 v78, v81, 16, v80
    v_lshl_or_b32 v79, v83, 16, v82
    s_cbranch_scc1 k1_kernel_nf3
    buffer_store_dwordx4 v[76:79], v9, s[32:35], s62 offen sc1
    s_add_u32 s62, s62, 262144
k1_kernel_nf3:
    v_cmpx_lt_u32 vcc, 1, v87
    v_bfe_i32 v119, s70, v71, 1
    v_lshrrev_b64 v[74:75], v123, s[68:69]
    v_perm_b32 v121, v74, v74, v5
    v_perm_b32 v122, v74, v74, v4
    v_and_b32 v121, v121, v21
    v_and_b32 v122, v122, v20
    v_msad_u8 v120, v28, v121, 0
    v_lshlrev_b32 v120, 4, v120
    v_msad_u8 v120, v27, v122, v120
    v_bitop3_b32 v120, v120, v71, v119 bitop3:0x80

    v_ffbl_b32 v120, v120
    v_max_i32 v84, v120, v84
    s_mov_b64 exec, -1

    v_lshl_add_u32 v73, v84, 1, v30
    v_lshl_add_u32 v71, -1, v84, v71
    ds_read_u16 v80, v73 offset:32
    v_ffbl_b32 v84, v71

    v_perm_b32 v72, v68, v67, v84
    v_and_or_b32 v72, v72, s66, v85
    ds_add_rtn_u32 v87, v72, v10
    ds_wrxchg_rtn_b32 v116, v86, v13

    s_add_u32 s47, s44, 151552
    buffer_load_dwordx4 v[216:219], v7, s[20:23], s47 offen offset:0
    buffer_load_dwordx4 v[220:223], v7, s[20:23], s47 offen offset:64
    s_mov_b32 s70, 0x977f977f

    s_waitcnt lgkmcnt(0)
    v_cmp_gt_u32 s[68:69], 2, v116

    v_cmpx_lt_u32 vcc, 1, v87
    v_bfe_i32 v119, s70, v71, 1
    v_lshrrev_b64 v[74:75], v123, s[68:69]
    v_perm_b32 v121, v74, v74, v5
    v_perm_b32 v122, v74, v74, v4
    v_and_b32 v121, v121, v21
    v_and_b32 v122, v122, v20
    v_msad_u8 v120, v28, v121, 0
    v_lshlrev_b32 v120, 4, v120
    v_msad_u8 v120, v27, v122, v120
    v_bitop3_b32 v120, v120, v71, v119 bitop3:0x80

    v_ffbl_b32 v120, v120
    v_max_i32 v84, v120, v84
    s_mov_b64 exec, -1

    v_lshl_add_u32 v73, v84, 1, v30
    v_lshl_add_u32 v71, -1, v84, v71
    ds_read_u16 v81, v73 offset:32
    v_ffbl_b32 v84, v71

    v_perm_b32 v72, v68, v67, v84
    v_and_or_b32 v72, v72, s66, v85
    ds_add_rtn_u32 v87, v72, v10
    ds_wrxchg_rtn_b32 v116, v86, v13

    s_add_u32 s47, s44, 155648
    buffer_load_dwordx4 v[232:235], v7, s[20:23], s47 offen offset:0
    buffer_load_dwordx4 v[236:239], v7, s[20:23], s47 offen offset:64
    s_mov_b32 s70, 0xe997e997

    s_waitcnt lgkmcnt(0)
    v_cmp_gt_u32 s[68:69], 2, v116

    v_cmpx_lt_u32 vcc, 1, v87
    v_bfe_i32 v119, s70, v71, 1
    v_lshrrev_b64 v[74:75], v123, s[68:69]
    v_perm_b32 v121, v74, v74, v5
    v_perm_b32 v122, v74, v74, v4
    v_and_b32 v121, v121, v21
    v_and_b32 v122, v122, v20
    v_msad_u8 v120, v28, v121, 0
    v_lshlrev_b32 v120, 4, v120
    v_msad_u8 v120, v27, v122, v120
    v_bitop3_b32 v120, v120, v71, v119 bitop3:0x80

    v_ffbl_b32 v120, v120
    v_max_i32 v84, v120, v84
    s_mov_b64 exec, -1

    v_lshl_add_u32 v73, v84, 1, v30
    v_lshl_add_u32 v71, -1, v84, v71
    ds_read_u16 v82, v73 offset:32
    v_ffbl_b32 v84, v71

    v_perm_b32 v72, v68, v67, v84
    v_and_or_b32 v72, v72, s66, v85
    ds_add_rtn_u32 v87, v72, v10
    ds_wrxchg_rtn_b32 v116, v86, v13

    s_add_u32 s47, s44, 159744
    buffer_load_dwordx4 v[248:251], v7, s[20:23], s47 offen offset:0
    buffer_load_dwordx4 v[252:255], v7, s[20:23], s47 offen offset:64
    s_mov_b32 s70, 0xfee9fee9

    s_waitcnt lgkmcnt(0)
    v_cmp_gt_u32 s[68:69], 2, v116

    v_cmpx_lt_u32 vcc, 1, v87
    v_bfe_i32 v119, s70, v71, 1
    v_lshrrev_b64 v[74:75], v123, s[68:69]
    v_perm_b32 v121, v74, v74, v5
    v_and_b32 v121, v121, v21
    v_msad_u8 v120, v28, v121, 0
    v_lshlrev_b32 v120, 4, v120
    v_bitop3_b32 v120, v120, v71, v119 bitop3:0x80

    v_ffbl_b32 v120, v120
    v_max_i32 v84, v120, v84
    s_mov_b64 exec, -1

    v_lshl_add_u32 v73, v84, 1, v30
    v_lshl_add_u32 v71, -1, v84, v71
    ds_read_u16 v83, v73 offset:32
    v_lshrrev_b32 v71, 4, v71

    s_cmp_ge_u32 s57, 800
    s_cbranch_scc1 k1_kernel_norl
    s_waitcnt vmcnt(0)

    v_perm_b32 v0, v132, v128, s84
    v_perm_b32 v1, v148, v144, s84
    v_perm_b32 v2, v164, v160, s84
    v_perm_b32 v3, v180, v176, s84
    v_perm_b32 v16, v132, v128, s85
    v_perm_b32 v17, v148, v144, s85
    v_perm_b32 v18, v164, v160, s85
    v_perm_b32 v19, v180, v176, s85
    v_perm_b32 v32, v133, v129, s84
    v_perm_b32 v33, v149, v145, s84
    v_perm_b32 v34, v165, v161, s84
    v_perm_b32 v35, v181, v177, s84
    v_perm_b32 v64, v133, v129, s85
    v_perm_b32 v65, v149, v145, s85
    v_perm_b32 v66, v165, v161, s85
    v_perm_b32 v67, v181, v177, s85
    ds_write_b128 v36, v[0:3]
    ds_write_b128 v37, v[16:19]
    ds_write_b128 v38, v[32:35]
    ds_write_b128 v39, v[64:67]
    ds_read_b128 v[40:43], v15 offset:0
    ds_read_b128 v[44:47], v15 offset:1024
    ds_read_b128 v[72:75], v15 offset:2048
    ds_read_b128 v[116:119], v15 offset:3072
    v_perm_b32 v0, v196, v192, s84
    v_perm_b32 v1, v212, v208, s84
    v_perm_b32 v2, v228, v224, s84
    v_perm_b32 v3, v244, v240, s84
    v_perm_b32 v16, v196, v192, s85
    v_perm_b32 v17, v212, v208, s85
    v_perm_b32 v18, v228, v224, s85
    v_perm_b32 v19, v244, v240, s85
    v_perm_b32 v32, v197, v193, s84
    v_perm_b32 v33, v213, v209, s84
    v_perm_b32 v34, v229, v225, s84
    v_perm_b32 v35, v245, v241, s84
    v_perm_b32 v64, v197, v193, s85
    v_perm_b32 v65, v213, v209, s85
    v_perm_b32 v66, v229, v225, s85
    v_perm_b32 v67, v245, v241, s85
    s_waitcnt lgkmcnt(0)
    s_add_u32 s83, s82, 0
    buffer_store_dwordx4 v[40:43], v14, s[32:35], s83 offen sc1
    s_add_u32 s83, s82, 3284992
    buffer_store_dwordx4 v[44:47], v14, s[32:35], s83 offen sc1
    s_add_u32 s83, s82, 6569984
    buffer_store_dwordx4 v[72:75], v14, s[32:35], s83 offen sc1
    s_add_u32 s83, s82, 9854976
    buffer_store_dwordx4 v[116:119], v14, s[32:35], s83 offen sc1
    ds_write_b128 v36, v[0:3]
    ds_write_b128 v37, v[16:19]
    ds_write_b128 v38, v[32:35]
    ds_write_b128 v39, v[64:67]
    ds_read_b128 v[40:43], v15 offset:0
    ds_read_b128 v[44:47], v15 offset:1024
    ds_read_b128 v[72:75], v15 offset:2048
    ds_read_b128 v[116:119], v15 offset:3072
    v_perm_b32 v0, v134, v130, s84
    v_perm_b32 v1, v150, v146, s84
    v_perm_b32 v2, v166, v162, s84
    v_perm_b32 v3, v182, v178, s84
    v_perm_b32 v16, v134, v130, s85
    v_perm_b32 v17, v150, v146, s85
    v_perm_b32 v18, v166, v162, s85
    v_perm_b32 v19, v182, v178, s85
    v_perm_b32 v32, v135, v131, s84
    v_perm_b32 v33, v151, v147, s84
    v_perm_b32 v34, v167, v163, s84
    v_perm_b32 v35, v183, v179, s84
    v_perm_b32 v64, v135, v131, s85
    v_perm_b32 v65, v151, v147, s85
    v_perm_b32 v66, v167, v163, s85
    v_perm_b32 v67, v183, v179, s85
    s_waitcnt lgkmcnt(0)
    s_add_u32 s83, s82, 64
    buffer_store_dwordx4 v[40:43], v14, s[32:35], s83 offen sc1
    s_add_u32 s83, s82, 3285056
    buffer_store_dwordx4 v[44:47], v14, s[32:35], s83 offen sc1
    s_add_u32 s83, s82, 6570048
    buffer_store_dwordx4 v[72:75], v14, s[32:35], s83 offen sc1
    s_add_u32 s83, s82, 9855040
    buffer_store_dwordx4 v[116:119], v14, s[32:35], s83 offen sc1
    ds_write_b128 v36, v[0:3]
    ds_write_b128 v37, v[16:19]
    ds_write_b128 v38, v[32:35]
    ds_write_b128 v39, v[64:67]
    ds_read_b128 v[40:43], v15 offset:0
    ds_read_b128 v[44:47], v15 offset:1024
    ds_read_b128 v[72:75], v15 offset:2048
    ds_read_b128 v[116:119], v15 offset:3072
    v_perm_b32 v0, v198, v194, s84
    v_perm_b32 v1, v214, v210, s84
    v_perm_b32 v2, v230, v226, s84
    v_perm_b32 v3, v246, v242, s84
    v_perm_b32 v16, v198, v194, s85
    v_perm_b32 v17, v214, v210, s85
    v_perm_b32 v18, v230, v226, s85
    v_perm_b32 v19, v246, v242, s85
    v_perm_b32 v32, v199, v195, s84
    v_perm_b32 v33, v215, v211, s84
    v_perm_b32 v34, v231, v227, s84
    v_perm_b32 v35, v247, v243, s84
    v_perm_b32 v64, v199, v195, s85
    v_perm_b32 v65, v215, v211, s85
    v_perm_b32 v66, v231, v227, s85
    v_perm_b32 v67, v247, v243, s85
    s_waitcnt lgkmcnt(0)
    s_add_u32 s83, s82, 102656
    buffer_store_dwordx4 v[40:43], v14, s[32:35], s83 offen sc1
    s_add_u32 s83, s82, 3387648
    buffer_store_dwordx4 v[44:47], v14, s[32:35], s83 offen sc1
    s_add_u32 s83, s82, 6672640
    buffer_store_dwordx4 v[72:75], v14, s[32:35], s83 offen sc1
    s_add_u32 s83, s82, 9957632
    buffer_store_dwordx4 v[116:119], v14, s[32:35], s83 offen sc1
    ds_write_b128 v36, v[0:3]
    ds_write_b128 v37, v[16:19]
    ds_write_b128 v38, v[32:35]
    ds_write_b128 v39, v[64:67]
    ds_read_b128 v[40:43], v15 offset:0
    ds_read_b128 v[44:47], v15 offset:1024
    ds_read_b128 v[72:75], v15 offset:2048
    ds_read_b128 v[116:119], v15 offset:3072
    ds_write_b64 v31, v[48:49] offset:32
    ds_write_b64 v31, v[50:51] offset:40
    ds_write_b64 v31, v[52:53] offset:48
    s_waitcnt lgkmcnt(3)
    s_add_u32 s83, s82, 102720
    buffer_store_dwordx4 v[40:43], v14, s[32:35], s83 offen sc1
    s_add_u32 s83, s82, 3387712
    buffer_store_dwordx4 v[44:47], v14, s[32:35], s83 offen sc1
    s_add_u32 s83, s82, 6672704
    buffer_store_dwordx4 v[72:75], v14, s[32:35], s83 offen sc1
    s_add_u32 s83, s82, 9957696
    buffer_store_dwordx4 v[116:119], v14, s[32:35], s83 offen sc1
k1_kernel_norl:
k1_kernel_rld:
    ds_write_b32 v86, v13
    v_ffbl_b32 v84, v71

    v_perm_b32 v72, v69, v68, v84
    v_and_or_b32 v72, v72, s66, v85
    ds_add_rtn_u32 v87, v72, v10
    ds_wrxchg_rtn_b32 v116, v86, v13

    s_mov_b32 s70, 0x7fff7fff

    s_waitcnt lgkmcnt(0)
    v_cmp_gt_u32 s[68:69], 2, v116

    s_cmp_eq_u32 s59, 0
    v_lshl_or_b32 v76, v81, 16, v80
    v_lshl_or_b32 v77, v83, 16, v82
    s_cbranch_scc1 k1_kernel_nf4
    buffer_store_dwordx4 v[76:79], v9, s[32:35], s62 offen sc1
    s_add_u32 s62, s62, 262144
k1_kernel_nf4:
    v_cmpx_lt_u32 vcc, 1, v87
    v_bfe_i32 v119, s70, v71, 1
    v_lshrrev_b64 v[74:75], v123, s[68:69]
    v_perm_b32 v121, v74, v74, v6
    v_perm_b32 v122, v74, v74, v5
    v_and_b32 v121, v121, v22
    v_and_b32 v122, v122, v21
    v_msad_u8 v120, v29, v121, 0
    v_lshlrev_b32 v120, 4, v120
    v_msad_u8 v120, v28, v122, v120
    v_bitop3_b32 v120, v120, v71, v119 bitop3:0x80

    v_ffbl_b32 v120, v120
    v_max_i32 v84, v120, v84
    s_mov_b64 exec, -1

    v_lshl_add_u32 v73, v84, 1, v30
    v_lshl_add_u32 v71, -1, v84, v71
    ds_read_u16 v80, v73 offset:40
    v_ffbl_b32 v84, v71

    v_perm_b32 v72, v69, v68, v84
    v_and_or_b32 v72, v72, s66, v85
    ds_add_rtn_u32 v87, v72, v10
    ds_wrxchg_rtn_b32 v116, v86, v13

    s_mov_b32 s70, 0x977f977f

    s_waitcnt lgkmcnt(0)
    v_cmp_gt_u32 s[68:69], 2, v116

    v_cmpx_lt_u32 vcc, 1, v87
    v_bfe_i32 v119, s70, v71, 1
    v_lshrrev_b64 v[74:75], v123, s[68:69]
    v_perm_b32 v121, v74, v74, v6
    v_perm_b32 v122, v74, v74, v5
    v_and_b32 v121, v121, v22
    v_and_b32 v122, v122, v21
    v_msad_u8 v120, v29, v121, 0
    v_lshlrev_b32 v120, 4, v120
    v_msad_u8 v120, v28, v122, v120
    v_bitop3_b32 v120, v120, v71, v119 bitop3:0x80

    v_ffbl_b32 v120, v120
    v_max_i32 v84, v120, v84
    s_mov_b64 exec, -1

    v_lshl_add_u32 v73, v84, 1, v30
    v_lshl_add_u32 v71, -1, v84, v71
    ds_read_u16 v81, v73 offset:40
    v_ffbl_b32 v84, v71

    v_perm_b32 v72, v69, v68, v84
    v_and_or_b32 v72, v72, s66, v85
    ds_add_rtn_u32 v87, v72, v10
    ds_wrxchg_rtn_b32 v116, v86, v13

    s_mov_b32 s70, 0xe997e997

    s_waitcnt lgkmcnt(0)
    v_cmp_gt_u32 s[68:69], 2, v116

    v_cmpx_lt_u32 vcc, 1, v87
    v_bfe_i32 v119, s70, v71, 1
    v_lshrrev_b64 v[74:75], v123, s[68:69]
    v_perm_b32 v121, v74, v74, v6
    v_perm_b32 v122, v74, v74, v5
    v_and_b32 v121, v121, v22
    v_and_b32 v122, v122, v21
    v_msad_u8 v120, v29, v121, 0
    v_lshlrev_b32 v120, 4, v120
    v_msad_u8 v120, v28, v122, v120
    v_bitop3_b32 v120, v120, v71, v119 bitop3:0x80

    v_ffbl_b32 v120, v120
    v_max_i32 v84, v120, v84
    s_mov_b64 exec, -1

    v_lshl_add_u32 v73, v84, 1, v30
    v_lshl_add_u32 v71, -1, v84, v71
    ds_read_u16 v82, v73 offset:40
    v_ffbl_b32 v84, v71

    v_perm_b32 v72, v69, v68, v84
    v_and_or_b32 v72, v72, s66, v85
    ds_add_rtn_u32 v87, v72, v10
    ds_wrxchg_rtn_b32 v116, v86, v13

    s_mov_b32 s70, 0xfee9fee9

    s_waitcnt lgkmcnt(0)
    v_cmp_gt_u32 s[68:69], 2, v116

    v_cmpx_lt_u32 vcc, 1, v87
    v_bfe_i32 v119, s70, v71, 1
    v_lshrrev_b64 v[74:75], v123, s[68:69]
    v_perm_b32 v121, v74, v74, v6
    v_and_b32 v121, v121, v22
    v_msad_u8 v120, v29, v121, 0
    v_lshlrev_b32 v120, 4, v120
    v_bitop3_b32 v120, v120, v71, v119 bitop3:0x80

    v_ffbl_b32 v120, v120
    v_max_i32 v84, v120, v84
    s_mov_b64 exec, -1

    v_lshl_add_u32 v73, v84, 1, v30
    v_lshl_add_u32 v71, -1, v84, v71
    ds_read_u16 v83, v73 offset:40
    s_cmp_lg_u32 s59, 1
    s_cbranch_scc1 k1_kernel_sdone
    v_lshrrev_b32 v71, 4, v71
    v_ffbl_b32 v84, v71

    v_perm_b32 v72, v70, v69, v84
    v_and_or_b32 v72, v72, s66, v85
    ds_add_rtn_u32 v87, v72, v10
    ds_wrxchg_rtn_b32 v116, v86, v13

    s_waitcnt lgkmcnt(0)
    v_cmp_gt_u32 s[68:69], 2, v116

    v_lshl_or_b32 v78, v81, 16, v80
    v_lshl_or_b32 v79, v83, 16, v82
    v_cmpx_lt_u32 vcc, 1, v87
    v_lshrrev_b64 v[74:75], v123, s[68:69]
    v_perm_b32 v121, v74, v74, v6
    v_and_b32 v121, v121, v22
    v_msad_u8 v120, v29, v121, 0
    v_and_b32 v120, v120, v71

    v_ffbl_b32 v120, v120
    v_max_i32 v84, v120, v84
    s_mov_b64 exec, -1

    v_lshl_add_u32 v73, v84, 1, v30
    v_lshl_add_u32 v71, -1, v84, v71
    ds_read_u16 v80, v73 offset:48
    v_ffbl_b32 v84, v71

    v_perm_b32 v72, v70, v69, v84
    v_and_or_b32 v72, v72, s66, v85
    ds_add_rtn_u32 v87, v72, v10
    ds_wrxchg_rtn_b32 v116, v86, v13

    s_waitcnt lgkmcnt(0)
    v_cmp_gt_u32 s[68:69], 2, v116

    v_cmpx_lt_u32 vcc, 1, v87
    s_nop 0
    v_lshrrev_b64 v[74:75], v123, s[68:69]
    v_perm_b32 v121, v74, v74, v6
    v_and_b32 v121, v121, v22
    v_msad_u8 v120, v29, v121, 0
    v_and_b32 v120, v120, v71

    v_ffbl_b32 v120, v120
    v_max_i32 v84, v120, v84
    s_mov_b64 exec, -1

    v_lshl_add_u32 v73, v84, 1, v30
    v_lshl_add_u32 v71, -1, v84, v71
    ds_read_u16 v81, v73 offset:48
    v_ffbl_b32 v84, v71

    v_perm_b32 v72, v70, v69, v84
    v_and_or_b32 v72, v72, s66, v85
    ds_add_rtn_u32 v87, v72, v10
    ds_wrxchg_rtn_b32 v116, v86, v13

    s_waitcnt lgkmcnt(0)
    v_cmp_gt_u32 s[68:69], 2, v116

    v_cmpx_lt_u32 vcc, 1, v87
    s_nop 0
    v_lshrrev_b64 v[74:75], v123, s[68:69]
    v_perm_b32 v121, v74, v74, v6
    v_and_b32 v121, v121, v22
    v_msad_u8 v120, v29, v121, 0
    v_and_b32 v120, v120, v71

    v_ffbl_b32 v120, v120
    v_max_i32 v84, v120, v84
    s_mov_b64 exec, -1

    v_lshl_add_u32 v73, v84, 1, v30
    v_lshl_add_u32 v71, -1, v84, v71
    ds_read_u16 v82, v73 offset:48
    v_ffbl_b32 v84, v71
    v_lshl_add_u32 v73, v84, 1, v30
    ds_read_u16 v83, v73 offset:48
    s_waitcnt lgkmcnt(0)
    v_lshl_or_b32 v76, v81, 16, v80
    v_lshl_or_b32 v77, v83, 16, v82
    s_branch k1_kernel_sst
k1_kernel_sdone:
    s_waitcnt lgkmcnt(0)
    v_lshl_or_b32 v78, v81, 16, v80
    v_lshl_or_b32 v79, v83, 16, v82
k1_kernel_sst:
    buffer_store_dwordx4 v[76:79], v9, s[32:35], s62 offen sc1
    s_add_u32 s62, s62, 262144
k1_kernel_udone:
    s_setprio 3

    s_mov_b64 exec, 1
    ds_add_rtn_u32 v12, v11, v10 offset:28
    s_waitcnt lgkmcnt(0)
    v_readfirstlane_b32 s45, v12
    s_cmp_ge_u32 s45, 2
    s_cbranch_scc1 k1_kernel_ncl
    s_mov_b64 exec, -1
    s_mul_i32 s45, s45, 16384
    s_min_u32 s45, s45, 16384
    s_lshl_b32 s72, s2, 15
    s_add_u32 s72, s72, s45
    s_add_u32 s72, s72, 20971520
    v_mov_b32 v192, -1
    v_mov_b32 v193, -1
    v_mov_b32 v194, -1
    v_mov_b32 v195, -1
    buffer_store_dwordx4 v[192:195], v9, s[12:15], s72 offen offset:0 sc1
    buffer_store_dwordx4 v[192:195], v9, s[12:15], s72 offen offset:1024 sc1
    buffer_store_dwordx4 v[192:195], v9, s[12:15], s72 offen offset:2048 sc1
    buffer_store_dwordx4 v[192:195], v9, s[12:15], s72 offen offset:3072 sc1
    s_add_u32 s72, s72, 4096
    buffer_store_dwordx4 v[192:195], v9, s[12:15], s72 offen offset:0 sc1
    buffer_store_dwordx4 v[192:195], v9, s[12:15], s72 offen offset:1024 sc1
    buffer_store_dwordx4 v[192:195], v9, s[12:15], s72 offen offset:2048 sc1
    buffer_store_dwordx4 v[192:195], v9, s[12:15], s72 offen offset:3072 sc1
    s_add_u32 s72, s72, 4096
    buffer_store_dwordx4 v[192:195], v9, s[12:15], s72 offen offset:0 sc1
    buffer_store_dwordx4 v[192:195], v9, s[12:15], s72 offen offset:1024 sc1
    buffer_store_dwordx4 v[192:195], v9, s[12:15], s72 offen offset:2048 sc1
    buffer_store_dwordx4 v[192:195], v9, s[12:15], s72 offen offset:3072 sc1
    s_add_u32 s72, s72, 4096
    buffer_store_dwordx4 v[192:195], v9, s[12:15], s72 offen offset:0 sc1
    buffer_store_dwordx4 v[192:195], v9, s[12:15], s72 offen offset:1024 sc1
    buffer_store_dwordx4 v[192:195], v9, s[12:15], s72 offen offset:2048 sc1
    buffer_store_dwordx4 v[192:195], v9, s[12:15], s72 offen offset:3072 sc1
    s_add_u32 s72, s72, 4096
k1_kernel_ncl:

    s_waitcnt vmcnt(0)

    s_mov_b64 exec, 1
    ds_add_rtn_u32 v12, v11, v10 offset:20
    v_mov_b32 v3, 1
    s_bfe_u32 s39, s2, 0x10004
    s_mul_i32 s38, s39, 128
    s_waitcnt lgkmcnt(0)
    v_readfirstlane_b32 s45, v12
    s_cmp_eq_u32 s45, 3
    s_cbranch_scc0 k1_kernel_tld0
    buffer_atomic_add v3, v13, s[52:55], s38 offen offset:32 sc0
k1_kernel_tld0:
    s_and_b32 s45, s45, 3
k1_kernel_tld:
    s_mov_b64 exec, -1
    s_add_u32 s47, s44, 0
    buffer_load_dwordx4 v[32:35], v7, s[20:23], s47 offen offset:0
    buffer_load_dwordx4 v[36:39], v7, s[20:23], s47 offen offset:64
    s_add_u32 s47, s44, 4096
    buffer_load_dwordx4 v[40:43], v7, s[20:23], s47 offen offset:0
    buffer_load_dwordx4 v[44:47], v7, s[20:23], s47 offen offset:64
    s_add_u32 s47, s44, 8192
    buffer_load_dwordx4 v[48:51], v7, s[20:23], s47 offen offset:0
    buffer_load_dwordx4 v[52:55], v7, s[20:23], s47 offen offset:64
    s_cmp_eq_u32 s45, 3
    s_cbranch_scc0 k1_kernel_wdec
    s_lshl_b32 s45, s2, 8
    s_add_u32 s45, s45, 14680064
    v_lshlrev_b32 v0, 8, v8
    v_mov_b32 v116, 0
    s_lshl4_add_u32 s38, s39, 14680064
    s_cmp_lg_u32 s64, 0
    s_cbranch_scc1 k1_kernel_bits
    s_waitcnt vmcnt(6)
    v_readfirstlane_b32 s39, v3

    s_cmp_eq_u32 s39, 127
    s_cbranch_scc0 k1_kernel_poll0

    buffer_store_dword v10, v0, s[12:15], s38 offen sc1
    s_add_u32 s38, s38, 16384
    buffer_store_dword v10, v0, s[12:15], s38 offen sc1
    s_add_u32 s38, s38, 16384
    buffer_store_dword v10, v0, s[12:15], s38 offen sc1
    s_add_u32 s38, s38, 16384
    buffer_store_dword v10, v0, s[12:15], s38 offen sc1

k1_kernel_poll0:
    s_mov_b64 exec, 3
k1_kernel_poll:
    buffer_load_dword v116, v9, s[12:15], s45 offen sc1
    s_add_u32 s65, s65, 1
    s_waitcnt vmcnt(0)
    v_cmp_ne_u32 vcc, 1, v116
    s_cbranch_vccz k1_kernel_go

    s_cmp_lt_u32 s65, 200
    s_cbranch_scc1 k1_kernel_poll
k1_kernel_bits:
    s_mov_b64 exec, -1
    s_lshr_b32 s38, s51, 5
    s_lshl_b32 s39, 1, s51
    v_cmp_eq_u32 vcc, s38, v8
    v_mov_b32 v2, s39
    v_lshlrev_b32 v0, 2, v8
    v_cndmask_b32 v2, 0, v2, vcc
    v_mov_b32 v1, v2
    buffer_atomic_or v1, v0, s[52:55], 0 offen sc0
    s_waitcnt vmcnt(0)
    v_cmp_ne_u32 vcc, 128, v1
    v_or_b32 v1, v1, v2
    s_and_b32 s38, vcc_lo, 0x100
    s_and_b32 s39, vcc_hi, 0x100
    v_cmp_ne_u32 vcc, -1, v1
    s_or_b32 s38, s38, s39
    s_cbranch_scc0 k1_kernel_go
    s_and_b32 s39, vcc_lo, 0xff
    s_mov_b32 s38, 0xc0000000
    s_cbranch_scc0 k1_kernel_dec
    s_ff1_i32_b32 s38, s39
    s_nop 3
    v_readlane_b32 s39, v1, s38
    s_ff0_i32_b32 s39, s39
    s_lshl_b32 s38, s38, 5
    s_add_u32 s38, s38, s39
    s_andn2_b32 s39, s64, 255
    s_add_u32 s39, s39, 256
    s_or_b32 s38, s38, s39
    s_branch k1_kernel_dec

k1_kernel_go:

    s_mov_b32 s38, 0x80000000

k1_kernel_dec:

    v_mov_b32 v1, s38
    s_mov_b64 exec, 1
    ds_write_b32 v11, v1 offset:24

k1_kernel_wdec:

    s_mov_b64 exec, -1
    ds_read_b32 v12, v11 offset:24
    s_waitcnt lgkmcnt(0)
    v_readfirstlane_b32 s45, v12
    s_cmp_lg_u32 s45, s64
    s_cbranch_scc1 k1_kernel_gotd
    s_sleep 2
    s_branch k1_kernel_wdec
k1_kernel_redo:
    s_waitcnt vmcnt(0) lgkmcnt(0)
    s_branch k1_kernel_unit

k1_kernel_gotd:

    s_mov_b32 s64, s45
    s_and_b32 s51, s45, 255
    s_mov_b32 s65, 0x10000
    s_bitcmp0_b32 s45, 31
    s_cbranch_scc1 k1_kernel_redo

k1_kernel_k2:

    s_setprio 0
    s_load_dwordx4 s[8:11], s[0:1], 32
    s_load_dwordx2 s[56:57], s[0:1], 48
    s_load_dwordx2 s[60:61], s[0:1], 56
    v_mbcnt_lo_u32_b32 v0, -1, 0
    v_mbcnt_hi_u32_b32 v0, -1, v0
    s_mul_i32 s35, s3, 18432
    v_and_b32 v1, 15, v0
    v_lshrrev_b32 v2, 4, v0
    v_mul_u32_u24 v65, 144, v1
    v_lshl_add_u32 v65, v2, 4, v65
    v_add_u32 v65, s35, v65

    ds_read_b128 v[128:131], v65 offset:0
    ds_read_b128 v[132:135], v65 offset:64
    ds_read_b128 v[144:147], v65 offset:2304
    ds_read_b128 v[148:151], v65 offset:2368
    ds_read_b128 v[160:163], v65 offset:4608
    ds_read_b128 v[164:167], v65 offset:4672
    ds_read_b128 v[176:179], v65 offset:6912
    ds_read_b128 v[180:183], v65 offset:6976
    ds_read_b128 v[192:195], v65 offset:9216
    ds_read_b128 v[196:199], v65 offset:9280
    ds_read_b128 v[208:211], v65 offset:11520
    ds_read_b128 v[212:215], v65 offset:11584
    ds_read_b128 v[224:227], v65 offset:13824
    ds_read_b128 v[228:231], v65 offset:13888
    ds_read_b128 v[240:243], v65 offset:16128
    ds_read_b128 v[244:247], v65 offset:16192

    s_lshr_b32 s33, s2, 1
    s_and_b32 s34, s2, 1
    v_lshlrev_b32 v71, 4, v0

    s_mul_i32 s21, s33, 102656
    s_mul_i32 s35, s34, 49152
    s_sub_u32 s22, 53248, s35
    s_add_u32 s21, s21, s35
    s_lshl_b32 s35, s50, 11
    s_xor_b32 s19, s35, 2048
    s_add_u32 s19, s19, s21
    s_add_u32 s21, s21, s35
    s_mul_i32 s20, s34, 1703936
    s_add_u32 s20, s20, 16777216
    s_lshl_b32 s35, s3, 14
    s_add_u32 s20, s20, s35

    v_lshlrev_b32 v64, 13, v2
    v_lshl_add_u32 v64, v1, 3, v64
    s_lshl_b32 s35, s3, 10
    v_add_u32 v64, s35, v64
    v_lshrrev_b32 v4, 3, v0
    v_xor_b32 v4, v4, v2
    v_and_b32 v4, 1, v4
    v_bfe_u32 v5, v0, 2, 1
    v_lshl_or_b32 v4, v4, 1, v5
    v_mov_b32 v6, 0x3f80
    v_cmp_eq_u32 vcc, 0, v4
    v_and_b32 v5, 3, v0
    v_mul_u32_u24 v70, 0x5555, v5
    v_cndmask_b32 v66, 0, v6, vcc
    v_cndmask_b32 v67, 0, v6, vcc
    v_cmp_eq_u32 vcc, 1, v4
    v_lshl_add_u32 v70, v64, 13, v70
    s_mov_b32 s23, 0xffff0000
    v_cndmask_b32 v68, 0, v6, vcc
    v_cndmask_b32 v69, 0, v6, vcc

    s_cmp_lt_u32 s3, 4
    s_cbranch_scc1 k1_kernel_k2n
    buffer_load_dwordx4 v[0:3], v71, s[12:15], s21 offen offset:0
    buffer_load_dwordx4 v[4:7], v71, s[12:15], s21 offen offset:1024
    buffer_load_dwordx4 v[8:11], v71, s[12:15], s19 offen offset:0
    buffer_load_dwordx4 v[12:15], v71, s[12:15], s19 offen offset:1024
    s_add_u32 s21, s21, 4096
    s_add_u32 s19, s19, 4096
    buffer_load_dwordx4 v[16:19], v71, s[12:15], s21 offen offset:0
    buffer_load_dwordx4 v[20:23], v71, s[12:15], s21 offen offset:1024
    buffer_load_dwordx4 v[24:27], v71, s[12:15], s19 offen offset:0
    buffer_load_dwordx4 v[28:31], v71, s[12:15], s19 offen offset:1024
    s_add_u32 s21, s21, 4096
    s_add_u32 s19, s19, 4096
    s_mov_b32 s44, s21
    s_mov_b32 s45, s19
    s_add_u32 s21, s21, 4096
    s_add_u32 s19, s19, 4096
    buffer_load_dwordx4 v[72:75], v71, s[12:15], s21 offen offset:0
    buffer_load_dwordx4 v[76:79], v71, s[12:15], s21 offen offset:1024
    buffer_load_dwordx4 v[80:83], v71, s[12:15], s19 offen offset:0
    buffer_load_dwordx4 v[84:87], v71, s[12:15], s19 offen offset:1024
    s_add_u32 s21, s21, 4096
    s_add_u32 s19, s19, 4096
    buffer_load_dwordx2 v[116:117], v71, s[12:15], s20 offen offset:0 sc1
    buffer_load_dwordx2 v[118:119], v71, s[12:15], s20 offen offset:1024 sc1
    buffer_load_dwordx2 v[120:121], v71, s[12:15], s20 offen offset:2048 sc1
    buffer_load_dwordx2 v[122:123], v71, s[12:15], s20 offen offset:3072 sc1
k1_kernel_k2n:

    s_and_b32 s35, s3, 3
    s_lshl_b32 s35, s35, 14
    s_add_u32 s35, s35, 98304
    v_add_u32 v65, s35, v71

    s_lshl_b32 s16, s2, 3
    s_add_u32 s16, s16, s3
    s_lshl_b32 s46, s16, 7
    s_lshl_b32 s16, s16, 13
    s_add_u32 s46, s46, 30408704
    s_add_u32 s16, s16, 33554432

    s_xor_b32 s47, s46, 1024
    s_xor_b32 s18, s16, 65536
    s_mov_b32 s48, 0
    s_lshl_b32 s35, s33, 3
    s_waitcnt lgkmcnt(0)
    s_add_u32 s8, s8, s35
    s_addc_u32 s9, s9, 0
    s_add_u32 s10, s10, s35
    s_addc_u32 s11, s11, 0
    s_barrier

    s_load_dwordx2 s[36:37], s[8:9], 0
    s_load_dwordx2 s[38:39], s[10:11], 0
    s_cmp_lt_u32 s3, 4
    s_cbranch_scc1 k1_kernel_k2m

    s_waitcnt vmcnt(12)
    ds_write_b128 v65, v[32:35] offset:0
    ds_write_b128 v65, v[36:39] offset:1024
    ds_write_b128 v65, v[40:43] offset:2048
    ds_write_b128 v65, v[44:47] offset:3072
    v_mfma_f32_16x16x32_bf16 v[32:35], v[0:3], v[128:131], 0
    v_mfma_f32_16x16x32_bf16 v[36:39], v[0:3], v[144:147], 0
    ds_write_b128 v65, v[48:51] offset:4096
    v_mfma_f32_16x16x32_bf16 v[40:43], v[0:3], v[160:163], 0
    v_mfma_f32_16x16x32_bf16 v[44:47], v[0:3], v[176:179], 0
    ds_write_b128 v65, v[52:55] offset:5120
    v_mfma_f32_16x16x32_bf16 v[32:35], v[4:7], v[132:135], v[32:35]
    v_mfma_f32_16x16x32_bf16 v[36:39], v[4:7], v[148:151], v[36:39]
    ds_write_b128 v65, v[56:59] offset:6144
    v_mfma_f32_16x16x32_bf16 v[40:43], v[4:7], v[164:167], v[40:43]
    v_mfma_f32_16x16x32_bf16 v[44:47], v[4:7], v[180:183], v[44:47]
    ds_write_b128 v65, v[60:63] offset:7168
    v_mfma_f32_16x16x32_bf16 v[32:35], v[8:11], v[136:139], v[32:35]
    v_mfma_f32_16x16x32_bf16 v[36:39], v[8:11], v[152:155], v[36:39]
    ds_write_b128 v65, v[88:91] offset:8192
    v_mfma_f32_16x16x32_bf16 v[40:43], v[8:11], v[168:171], v[40:43]
    v_mfma_f32_16x16x32_bf16 v[44:47], v[8:11], v[184:187], v[44:47]
    ds_write_b128 v65, v[92:95] offset:9216
    v_mfma_f32_16x16x32_bf16 v[32:35], v[12:15], v[140:143], v[32:35]
    v_mfma_f32_16x16x32_bf16 v[36:39], v[12:15], v[156:159], v[36:39]
    ds_write_b128 v65, v[96:99] offset:10240
    v_mfma_f32_16x16x32_bf16 v[40:43], v[12:15], v[172:175], v[40:43]
    v_mfma_f32_16x16x32_bf16 v[44:47], v[12:15], v[188:191], v[44:47]
    ds_write_b128 v65, v[100:103] offset:11264
    v_mfma_f32_16x16x32_bf16 v[48:51], v[0:3], v[192:195], 0
    v_mfma_f32_16x16x32_bf16 v[52:55], v[0:3], v[208:211], 0
    ds_write_b128 v65, v[104:107] offset:12288
    v_mfma_f32_16x16x32_bf16 v[56:59], v[0:3], v[224:227], 0
    v_mfma_f32_16x16x32_bf16 v[60:63], v[0:3], v[240:243], 0
    ds_write_b128 v65, v[108:111] offset:13312
    v_mfma_f32_16x16x32_bf16 v[48:51], v[4:7], v[196:199], v[48:51]
    v_mfma_f32_16x16x32_bf16 v[52:55], v[4:7], v[212:215], v[52:55]
    ds_write_b128 v65, v[112:115] offset:14336
    v_mfma_f32_16x16x32_bf16 v[56:59], v[4:7], v[228:231], v[56:59]
    v_mfma_f32_16x16x32_bf16 v[60:63], v[4:7], v[244:247], v[60:63]
    ds_write_b128 v65, v[124:127] offset:15360
    v_mfma_f32_16x16x32_bf16 v[48:51], v[8:11], v[200:203], v[48:51]
    v_mfma_f32_16x16x32_bf16 v[52:55], v[8:11], v[216:219], v[52:55]
    v_mfma_f32_16x16x32_bf16 v[56:59], v[8:11], v[232:235], v[56:59]
    v_mfma_f32_16x16x32_bf16 v[60:63], v[8:11], v[248:251], v[60:63]
    s_waitcnt lgkmcnt(0)
    s_barrier
    v_mfma_f32_16x16x32_bf16 v[48:51], v[12:15], v[204:207], v[48:51]
    v_mfma_f32_16x16x32_bf16 v[52:55], v[12:15], v[220:223], v[52:55]
    v_mfma_f32_16x16x32_bf16 v[56:59], v[12:15], v[236:239], v[56:59]
    v_mfma_f32_16x16x32_bf16 v[60:63], v[12:15], v[252:255], v[60:63]
    s_add_u32 s20, s20, 4096
    buffer_load_dwordx2 v[124:125], v71, s[12:15], s20 offen offset:0 sc1
    buffer_load_dwordx2 v[126:127], v71, s[12:15], s20 offen offset:1024 sc1
    buffer_load_dwordx4 v[0:3], v71, s[12:15], s44 offen offset:0
    buffer_load_dwordx4 v[4:7], v71, s[12:15], s44 offen offset:1024
    buffer_load_dwordx4 v[8:11], v71, s[12:15], s45 offen offset:0
    buffer_load_dwordx4 v[12:15], v71, s[12:15], s45 offen offset:1024
    s_waitcnt vmcnt(14)
    s_lshl_b32 s24, s36, 16
    s_and_b32 s25, s36, 0xffff0000
    s_lshl_b32 s26, s37, 16
    s_and_b32 s27, s37, 0xffff0000

    v_mfma_f32_16x16x32_bf16 v[88:91], v[16:19], v[128:131], 0
    v_mfma_f32_16x16x32_bf16 v[92:95], v[16:19], v[144:147], 0
    v_mfma_f32_16x16x32_bf16 v[88:91], v[20:23], v[132:135], v[88:91]
    v_mfma_f32_16x16x32_bf16 v[92:95], v[20:23], v[148:151], v[92:95]
    v_mfma_f32_16x16x32_bf16 v[88:91], v[24:27], v[136:139], v[88:91]
    v_cvt_pk_bf16_f32 v32, v32, v33
    v_mfma_f32_16x16x32_bf16 v[92:95], v[24:27], v[152:155], v[92:95]
    v_cvt_pk_bf16_f32 v33, v34, v35
    v_mfma_f32_16x16x32_bf16 v[88:91], v[28:31], v[140:143], v[88:91]
    ds_write_b64 v64, v[32:33] offset:0
    v_mfma_f32_16x16x32_bf16 v[92:95], v[28:31], v[156:159], v[92:95]
    v_cvt_pk_bf16_f32 v36, v36, v37
    v_mfma_f32_16x16x32_bf16 v[96:99], v[16:19], v[160:163], 0
    v_cvt_pk_bf16_f32 v37, v38, v39
    v_mfma_f32_16x16x32_bf16 v[100:103], v[16:19], v[176:179], 0
    ds_write_b64 v64, v[36:37] offset:128
    v_mfma_f32_16x16x32_bf16 v[96:99], v[20:23], v[164:167], v[96:99]
    v_cvt_pk_bf16_f32 v88, v88, v89
    v_cvt_pk_bf16_f32 v40, v40, v41
    v_mfma_f32_16x16x32_bf16 v[100:103], v[20:23], v[180:183], v[100:103]
    v_cvt_pk_bf16_f32 v89, v90, v91
    v_cvt_pk_bf16_f32 v41, v42, v43
    v_mfma_f32_16x16x32_bf16 v[96:99], v[24:27], v[168:171], v[96:99]
    ds_write_b64 v64, v[88:89] offset:32768
    ds_write_b64 v64, v[40:41] offset:256
    v_mfma_f32_16x16x32_bf16 v[100:103], v[24:27], v[184:187], v[100:103]
    v_cvt_pk_bf16_f32 v92, v92, v93
    v_cvt_pk_bf16_f32 v44, v44, v45
    v_mfma_f32_16x16x32_bf16 v[96:99], v[28:31], v[172:175], v[96:99]
    v_cvt_pk_bf16_f32 v93, v94, v95
    v_cvt_pk_bf16_f32 v45, v46, v47
    v_mfma_f32_16x16x32_bf16 v[100:103], v[28:31], v[188:191], v[100:103]
    ds_write_b64 v64, v[92:93] offset:32896
    ds_write_b64 v64, v[44:45] offset:384
    v_mfma_f32_16x16x32_bf16 v[104:107], v[16:19], v[192:195], 0
    v_cvt_pk_bf16_f32 v48, v48, v49
    v_mfma_f32_16x16x32_bf16 v[108:111], v[16:19], v[208:211], 0
    v_cvt_pk_bf16_f32 v49, v50, v51
    v_mfma_f32_16x16x32_bf16 v[104:107], v[20:23], v[196:199], v[104:107]
    v_cvt_pk_bf16_f32 v96, v96, v97
    ds_write_b64 v64, v[48:49] offset:512
    v_mfma_f32_16x16x32_bf16 v[108:111], v[20:23], v[212:215], v[108:111]
    v_cvt_pk_bf16_f32 v97, v98, v99
    v_cvt_pk_bf16_f32 v52, v52, v53
    v_mfma_f32_16x16x32_bf16 v[104:107], v[24:27], v[200:203], v[104:107]
    ds_write_b64 v64, v[96:97] offset:33024
    v_cvt_pk_bf16_f32 v53, v54, v55
    v_mfma_f32_16x16x32_bf16 v[108:111], v[24:27], v[216:219], v[108:111]
    v_cvt_pk_bf16_f32 v100, v100, v101
    ds_write_b64 v64, v[52:53] offset:640
    v_mfma_f32_16x16x32_bf16 v[104:107], v[28:31], v[204:207], v[104:107]
    v_cvt_pk_bf16_f32 v101, v102, v103
    v_cvt_pk_bf16_f32 v56, v56, v57
    v_mfma_f32_16x16x32_bf16 v[108:111], v[28:31], v[220:223], v[108:111]
    ds_write_b64 v64, v[100:101] offset:33152
    v_cvt_pk_bf16_f32 v57, v58, v59
    v_mfma_f32_16x16x32_bf16 v[88:91], v[16:19], v[224:227], 0
    ds_write_b64 v64, v[56:57] offset:768
    v_mfma_f32_16x16x32_bf16 v[92:95], v[16:19], v[240:243], 0
    v_cvt_pk_bf16_f32 v60, v60, v61
    v_mfma_f32_16x16x32_bf16 v[88:91], v[20:23], v[228:231], v[88:91]
    v_cvt_pk_bf16_f32 v104, v104, v105
    v_cvt_pk_bf16_f32 v61, v62, v63
    v_mfma_f32_16x16x32_bf16 v[92:95], v[20:23], v[244:247], v[92:95]
    v_cvt_pk_bf16_f32 v105, v106, v107
    ds_write_b64 v64, v[60:61] offset:896
    v_mfma_f32_16x16x32_bf16 v[88:91], v[24:27], v[232:235], v[88:91]
    ds_write_b64 v64, v[104:105] offset:33280
    v_mfma_f32_16x16x32_bf16 v[92:95], v[24:27], v[248:251], v[92:95]
    v_cvt_pk_bf16_f32 v108, v108, v109
    v_mfma_f32_16x16x32_bf16 v[88:91], v[28:31], v[236:239], v[88:91]
    v_cvt_pk_bf16_f32 v109, v110, v111
    v_mfma_f32_16x16x32_bf16 v[92:95], v[28:31], v[252:255], v[92:95]
    ds_write_b64 v64, v[108:109] offset:33408
    v_add_u32 v64, 0x8000, v64
    s_waitcnt vmcnt(0)
    v_mfma_f32_16x16x32_bf16 v[96:99], v[0:3], v[128:131], 0
    v_mfma_f32_16x16x32_bf16 v[100:103], v[0:3], v[144:147], 0
    v_mfma_f32_16x16x32_bf16 v[96:99], v[4:7], v[132:135], v[96:99]
    v_cvt_pk_bf16_f32 v88, v88, v89
    v_mfma_f32_16x16x32_bf16 v[100:103], v[4:7], v[148:151], v[100:103]
    v_cvt_pk_bf16_f32 v89, v90, v91
    v_mfma_f32_16x16x32_bf16 v[96:99], v[8:11], v[136:139], v[96:99]
    ds_write_b64 v64, v[88:89] offset:768
    v_mov_b32 v16, s24
    v_mov_b32 v40, s24
    v_mfma_f32_16x16x32_bf16 v[100:103], v[8:11], v[152:155], v[100:103]
    v_cvt_pk_bf16_f32 v92, v92, v93
    v_mov_b32 v17, s25
    v_mov_b32 v41, s25
    v_mfma_f32_16x16x32_bf16 v[96:99], v[12:15], v[140:143], v[96:99]
    v_cvt_pk_bf16_f32 v93, v94, v95
    v_mov_b32 v18, s26
    v_mov_b32 v42, s26
    v_mfma_f32_16x16x32_bf16 v[100:103], v[12:15], v[156:159], v[100:103]
    ds_write_b64 v64, v[92:93] offset:896
    v_mov_b32 v19, s27
    v_mov_b32 v43, s27
    v_mfma_f32_16x16x32_bf16 v[104:107], v[0:3], v[160:163], 0
    v_mov_b32 v20, s24
    v_mov_b32 v44, s24
    v_mfma_f32_16x16x32_bf16 v[108:111], v[0:3], v[176:179], 0
    v_mov_b32 v21, s25
    v_mov_b32 v45, s25
    v_mfma_f32_16x16x32_bf16 v[104:107], v[4:7], v[164:167], v[104:107]
    v_cvt_pk_bf16_f32 v96, v96, v97
    v_mov_b32 v22, s26
    v_mov_b32 v46, s26
    v_mfma_f32_16x16x32_bf16 v[108:111], v[4:7], v[180:183], v[108:111]
    v_cvt_pk_bf16_f32 v97, v98, v99
    v_mov_b32 v23, s27
    v_mov_b32 v47, s27
    v_mfma_f32_16x16x32_bf16 v[104:107], v[8:11], v[168:171], v[104:107]
    ds_write_b64 v64, v[96:97] offset:32768
    v_mov_b32 v24, s24
    v_mov_b32 v48, s24
    v_mfma_f32_16x16x32_bf16 v[108:111], v[8:11], v[184:187], v[108:111]
    v_cvt_pk_bf16_f32 v100, v100, v101
    v_mov_b32 v25, s25
    v_mov_b32 v49, s25
    v_mfma_f32_16x16x32_bf16 v[104:107], v[12:15], v[172:175], v[104:107]
    v_cvt_pk_bf16_f32 v101, v102, v103
    v_mov_b32 v26, s26
    v_mov_b32 v50, s26
    v_mfma_f32_16x16x32_bf16 v[108:111], v[12:15], v[188:191], v[108:111]
    ds_write_b64 v64, v[100:101] offset:32896
    v_mov_b32 v27, s27
    v_mov_b32 v51, s27
    v_mfma_f32_16x16x32_bf16 v[88:91], v[0:3], v[192:195], 0
    v_mov_b32 v28, s24
    v_mov_b32 v52, s24
    v_mfma_f32_16x16x32_bf16 v[92:95], v[0:3], v[208:211], 0
    v_mov_b32 v29, s25
    v_mov_b32 v53, s25
    v_mfma_f32_16x16x32_bf16 v[88:91], v[4:7], v[196:199], v[88:91]
    v_cvt_pk_bf16_f32 v104, v104, v105
    v_mov_b32 v30, s26
    v_mov_b32 v54, s26
    v_mfma_f32_16x16x32_bf16 v[92:95], v[4:7], v[212:215], v[92:95]
    v_cvt_pk_bf16_f32 v105, v106, v107
    v_mov_b32 v31, s27
    v_mov_b32 v55, s27
    v_mfma_f32_16x16x32_bf16 v[88:91], v[8:11], v[200:203], v[88:91]
    ds_write_b64 v64, v[104:105] offset:33024
    v_mov_b32 v32, s24
    v_mov_b32 v56, s24
    v_mfma_f32_16x16x32_bf16 v[92:95], v[8:11], v[216:219], v[92:95]
    v_cvt_pk_bf16_f32 v108, v108, v109
    v_mov_b32 v33, s25
    v_mov_b32 v57, s25
    v_mfma_f32_16x16x32_bf16 v[88:91], v[12:15], v[204:207], v[88:91]
    v_cvt_pk_bf16_f32 v109, v110, v111
    v_mov_b32 v34, s26
    v_mov_b32 v58, s26
    v_mfma_f32_16x16x32_bf16 v[92:95], v[12:15], v[220:223], v[92:95]
    ds_write_b64 v64, v[108:109] offset:33152
    v_mov_b32 v35, s27
    v_mov_b32 v59, s27
    v_mfma_f32_16x16x32_bf16 v[96:99], v[0:3], v[224:227], 0
    v_mov_b32 v36, s24
    v_mov_b32 v60, s24
    v_mfma_f32_16x16x32_bf16 v[100:103], v[0:3], v[240:243], 0
    v_mov_b32 v37, s25
    v_mov_b32 v61, s25
    v_mfma_f32_16x16x32_bf16 v[96:99], v[4:7], v[228:231], v[96:99]
    v_cvt_pk_bf16_f32 v88, v88, v89
    v_mov_b32 v38, s26
    v_mov_b32 v62, s26
    v_mfma_f32_16x16x32_bf16 v[100:103], v[4:7], v[244:247], v[100:103]
    v_cvt_pk_bf16_f32 v89, v90, v91
    v_mov_b32 v39, s27
    v_mov_b32 v63, s27
    v_mfma_f32_16x16x32_bf16 v[96:99], v[8:11], v[232:235], v[96:99]
    ds_write_b64 v64, v[88:89] offset:33280
    s_nop 0
    v_mfma_f32_16x16x32_bf16 v[100:103], v[8:11], v[248:251], v[100:103]
    v_cvt_pk_bf16_f32 v92, v92, v93
    s_nop 0
    v_mfma_f32_16x16x32_bf16 v[96:99], v[12:15], v[236:239], v[96:99]
    v_cvt_pk_bf16_f32 v93, v94, v95
    s_nop 0
    v_mfma_f32_16x16x32_bf16 v[100:103], v[12:15], v[252:255], v[100:103]
    ds_write_b64 v64, v[92:93] offset:33408
    s_nop 0
    v_mov_b32 v0, s24
    v_mov_b32 v1, s25
    v_mov_b32 v2, s26
    v_mov_b32 v3, s27
    v_mov_b32 v4, s24
    v_mov_b32 v5, s25
    v_mov_b32 v6, s26
    v_mov_b32 v7, s27
    v_mov_b32 v8, s24
    v_mov_b32 v9, s25
    v_mov_b32 v10, s26
    v_mov_b32 v11, s27
    v_mov_b32 v12, s24
    v_mov_b32 v13, s25
    v_mov_b32 v14, s26
    v_mov_b32 v15, s27
    s_nop 7
    v_cvt_pk_bf16_f32 v96, v96, v97
    v_cvt_pk_bf16_f32 v97, v98, v99
    ds_write_b64 v64, v[96:97] offset:33536
    v_cvt_pk_bf16_f32 v100, v100, v101
    v_cvt_pk_bf16_f32 v101, v102, v103
    ds_write_b64 v64, v[100:101] offset:33664

    s_cmp_lg_u32 s3, 7
    s_cbranch_scc1 k1_kernel_k2j
k1_kernel_k2w:
    s_bfe_u32 s35, s64, 0x1001e
    v_mov_b32 v65, 0
    v_mov_b32 v64, s35
    ds_write_b32 v65, v64 offset:8184
    s_branch k1_kernel_k2j

k1_kernel_k2m:
    buffer_load_dwordx4 v[0:3], v71, s[12:15], s21 offen offset:0
    buffer_load_dwordx4 v[4:7], v71, s[12:15], s21 offen offset:1024
    buffer_load_dwordx4 v[8:11], v71, s[12:15], s19 offen offset:0
    buffer_load_dwordx4 v[12:15], v71, s[12:15], s19 offen offset:1024
    s_add_u32 s21, s21, 4096
    s_add_u32 s19, s19, 4096
    buffer_load_dwordx4 v[16:19], v71, s[12:15], s21 offen offset:0
    buffer_load_dwordx4 v[20:23], v71, s[12:15], s21 offen offset:1024
    buffer_load_dwordx4 v[24:27], v71, s[12:15], s19 offen offset:0
    buffer_load_dwordx4 v[28:31], v71, s[12:15], s19 offen offset:1024
    s_add_u32 s21, s21, 4096
    s_add_u32 s19, s19, 4096
    s_mov_b32 s44, s21
    s_mov_b32 s45, s19
    s_add_u32 s21, s21, 4096
    s_add_u32 s19, s19, 4096
    buffer_load_dwordx4 v[72:75], v71, s[12:15], s21 offen offset:0
    buffer_load_dwordx4 v[76:79], v71, s[12:15], s21 offen offset:1024
    buffer_load_dwordx4 v[80:83], v71, s[12:15], s19 offen offset:0
    buffer_load_dwordx4 v[84:87], v71, s[12:15], s19 offen offset:1024
    s_add_u32 s21, s21, 4096
    s_add_u32 s19, s19, 4096
    buffer_load_dwordx2 v[116:117], v71, s[12:15], s20 offen offset:0 sc1
    buffer_load_dwordx2 v[118:119], v71, s[12:15], s20 offen offset:1024 sc1
    buffer_load_dwordx2 v[120:121], v71, s[12:15], s20 offen offset:2048 sc1
    buffer_load_dwordx2 v[122:123], v71, s[12:15], s20 offen offset:3072 sc1
    s_add_u32 s20, s20, 4096
    buffer_load_dwordx2 v[124:125], v71, s[12:15], s20 offen offset:0 sc1
    buffer_load_dwordx2 v[126:127], v71, s[12:15], s20 offen offset:1024 sc1
    buffer_load_dwordx4 v[32:35], v71, s[12:15], s44 offen offset:0
    buffer_load_dwordx4 v[36:39], v71, s[12:15], s44 offen offset:1024
    buffer_load_dwordx4 v[40:43], v71, s[12:15], s45 offen offset:0
    buffer_load_dwordx4 v[44:47], v71, s[12:15], s45 offen offset:1024
    s_mov_b32 exec_lo, 0x00ff00ff
    s_mov_b32 exec_hi, 0x00ff00ff
    buffer_store_dword v112, v113, s[12:15], s74 offen sc1
    s_mov_b64 exec, -1
    s_waitcnt lgkmcnt(0)
    s_barrier
    ds_read_b128 v[136:139], v65 offset:0
    ds_read_b128 v[140:143], v65 offset:1024
    ds_read_b128 v[152:155], v65 offset:2048
    ds_read_b128 v[156:159], v65 offset:3072
    ds_read_b128 v[168:171], v65 offset:4096
    ds_read_b128 v[172:175], v65 offset:5120
    ds_read_b128 v[184:187], v65 offset:6144
    ds_read_b128 v[188:191], v65 offset:7168
    ds_read_b128 v[200:203], v65 offset:8192
    ds_read_b128 v[204:207], v65 offset:9216
    ds_read_b128 v[216:219], v65 offset:10240
    ds_read_b128 v[220:223], v65 offset:11264
    ds_read_b128 v[232:235], v65 offset:12288
    ds_read_b128 v[236:239], v65 offset:13312
    ds_read_b128 v[248:251], v65 offset:14336
    ds_read_b128 v[252:255], v65 offset:15360
    s_waitcnt vmcnt(19)
    v_mfma_f32_16x16x32_bf16 v[48:51], v[0:3], v[128:131], 0
    v_mfma_f32_16x16x32_bf16 v[52:55], v[0:3], v[144:147], 0
    v_mfma_f32_16x16x32_bf16 v[56:59], v[0:3], v[160:163], 0
    v_mfma_f32_16x16x32_bf16 v[60:63], v[0:3], v[176:179], 0
    v_mfma_f32_16x16x32_bf16 v[88:91], v[0:3], v[192:195], 0
    v_mfma_f32_16x16x32_bf16 v[92:95], v[0:3], v[208:211], 0
    v_mfma_f32_16x16x32_bf16 v[96:99], v[0:3], v[224:227], 0
    v_mfma_f32_16x16x32_bf16 v[100:103], v[0:3], v[240:243], 0
    v_mfma_f32_16x16x32_bf16 v[48:51], v[4:7], v[132:135], v[48:51]
    v_mfma_f32_16x16x32_bf16 v[52:55], v[4:7], v[148:151], v[52:55]
    v_mfma_f32_16x16x32_bf16 v[56:59], v[4:7], v[164:167], v[56:59]
    v_mfma_f32_16x16x32_bf16 v[60:63], v[4:7], v[180:183], v[60:63]
    v_mfma_f32_16x16x32_bf16 v[88:91], v[4:7], v[196:199], v[88:91]
    v_mfma_f32_16x16x32_bf16 v[92:95], v[4:7], v[212:215], v[92:95]
    v_mfma_f32_16x16x32_bf16 v[96:99], v[4:7], v[228:231], v[96:99]
    v_mfma_f32_16x16x32_bf16 v[100:103], v[4:7], v[244:247], v[100:103]

    s_lshl_b32 s24, s36, 16
    s_and_b32 s25, s36, 0xffff0000
    s_lshl_b32 s26, s37, 16
    s_and_b32 s27, s37, 0xffff0000

    s_waitcnt lgkmcnt(12)
    v_mfma_f32_16x16x32_bf16 v[48:51], v[8:11], v[136:139], v[48:51]
    v_mfma_f32_16x16x32_bf16 v[52:55], v[8:11], v[152:155], v[52:55]
    v_mfma_f32_16x16x32_bf16 v[48:51], v[12:15], v[140:143], v[48:51]
    v_mfma_f32_16x16x32_bf16 v[52:55], v[12:15], v[156:159], v[52:55]
    s_waitcnt lgkmcnt(8)
    v_mfma_f32_16x16x32_bf16 v[56:59], v[8:11], v[168:171], v[56:59]
    v_mfma_f32_16x16x32_bf16 v[60:63], v[8:11], v[184:187], v[60:63]
    v_mfma_f32_16x16x32_bf16 v[56:59], v[12:15], v[172:175], v[56:59]
    v_mfma_f32_16x16x32_bf16 v[60:63], v[12:15], v[188:191], v[60:63]
    s_waitcnt lgkmcnt(4)
    v_mfma_f32_16x16x32_bf16 v[88:91], v[8:11], v[200:203], v[88:91]
    v_mfma_f32_16x16x32_bf16 v[92:95], v[8:11], v[216:219], v[92:95]
    v_mfma_f32_16x16x32_bf16 v[88:91], v[12:15], v[204:207], v[88:91]
    v_mfma_f32_16x16x32_bf16 v[92:95], v[12:15], v[220:223], v[92:95]
    v_cvt_pk_bf16_f32 v48, v48, v49
    v_cvt_pk_bf16_f32 v49, v50, v51
    ds_write_b64 v64, v[48:49] offset:0
    v_cvt_pk_bf16_f32 v52, v52, v53
    v_cvt_pk_bf16_f32 v53, v54, v55
    ds_write_b64 v64, v[52:53] offset:128
    s_waitcnt lgkmcnt(2)
    v_mfma_f32_16x16x32_bf16 v[96:99], v[8:11], v[232:235], v[96:99]
    v_mfma_f32_16x16x32_bf16 v[100:103], v[8:11], v[248:251], v[100:103]
    v_mfma_f32_16x16x32_bf16 v[96:99], v[12:15], v[236:239], v[96:99]
    v_mfma_f32_16x16x32_bf16 v[100:103], v[12:15], v[252:255], v[100:103]
    v_cvt_pk_bf16_f32 v56, v56, v57
    v_cvt_pk_bf16_f32 v57, v58, v59
    ds_write_b64 v64, v[56:57] offset:256
    v_cvt_pk_bf16_f32 v60, v60, v61
    v_cvt_pk_bf16_f32 v61, v62, v63
    ds_write_b64 v64, v[60:61] offset:384
    s_nop 3
    v_cvt_pk_bf16_f32 v88, v88, v89
    v_cvt_pk_bf16_f32 v89, v90, v91
    ds_write_b64 v64, v[88:89] offset:512
    v_cvt_pk_bf16_f32 v92, v92, v93
    v_cvt_pk_bf16_f32 v93, v94, v95
    ds_write_b64 v64, v[92:93] offset:640
    s_nop 3
    v_cvt_pk_bf16_f32 v96, v96, v97
    v_cvt_pk_bf16_f32 v97, v98, v99
    ds_write_b64 v64, v[96:97] offset:768
    v_cvt_pk_bf16_f32 v100, v100, v101
    v_cvt_pk_bf16_f32 v101, v102, v103
    ds_write_b64 v64, v[100:101] offset:896
    v_add_u32 v64, 0x8000, v64
    s_waitcnt vmcnt(15)
    v_mfma_f32_16x16x32_bf16 v[104:107], v[16:19], v[128:131], 0
    v_mfma_f32_16x16x32_bf16 v[108:111], v[16:19], v[144:147], 0
    v_mfma_f32_16x16x32_bf16 v[104:107], v[20:23], v[132:135], v[104:107]
    v_mfma_f32_16x16x32_bf16 v[108:111], v[20:23], v[148:151], v[108:111]
    v_mfma_f32_16x16x32_bf16 v[104:107], v[24:27], v[136:139], v[104:107]
    v_mov_b32 v48, s24
    v_mfma_f32_16x16x32_bf16 v[108:111], v[24:27], v[152:155], v[108:111]
    v_mov_b32 v49, s25
    v_mfma_f32_16x16x32_bf16 v[104:107], v[28:31], v[140:143], v[104:107]
    v_mov_b32 v50, s26
    v_mfma_f32_16x16x32_bf16 v[108:111], v[28:31], v[156:159], v[108:111]
    v_mov_b32 v51, s27
    v_mfma_f32_16x16x32_bf16 v[88:91], v[16:19], v[160:163], 0
    v_mov_b32 v52, s24
    v_mfma_f32_16x16x32_bf16 v[92:95], v[16:19], v[176:179], 0
    v_mov_b32 v53, s25
    v_mfma_f32_16x16x32_bf16 v[88:91], v[20:23], v[164:167], v[88:91]
    v_cvt_pk_bf16_f32 v104, v104, v105
    v_mov_b32 v54, s26
    v_mfma_f32_16x16x32_bf16 v[92:95], v[20:23], v[180:183], v[92:95]
    v_cvt_pk_bf16_f32 v105, v106, v107
    v_mov_b32 v55, s27
    v_mfma_f32_16x16x32_bf16 v[88:91], v[24:27], v[168:171], v[88:91]
    ds_write_b64 v64, v[104:105] offset:0
    v_mov_b32 v56, s24
    v_mfma_f32_16x16x32_bf16 v[92:95], v[24:27], v[184:187], v[92:95]
    v_cvt_pk_bf16_f32 v108, v108, v109
    v_mov_b32 v57, s25
    v_mfma_f32_16x16x32_bf16 v[88:91], v[28:31], v[172:175], v[88:91]
    v_cvt_pk_bf16_f32 v109, v110, v111
    v_mov_b32 v58, s26
    v_mfma_f32_16x16x32_bf16 v[92:95], v[28:31], v[188:191], v[92:95]
    ds_write_b64 v64, v[108:109] offset:128
    v_mov_b32 v59, s27
    v_mfma_f32_16x16x32_bf16 v[96:99], v[16:19], v[192:195], 0
    v_mov_b32 v60, s24
    v_mfma_f32_16x16x32_bf16 v[100:103], v[16:19], v[208:211], 0
    v_mov_b32 v61, s25
    v_mfma_f32_16x16x32_bf16 v[96:99], v[20:23], v[196:199], v[96:99]
    v_cvt_pk_bf16_f32 v88, v88, v89
    v_mov_b32 v62, s26
    v_mfma_f32_16x16x32_bf16 v[100:103], v[20:23], v[212:215], v[100:103]
    v_cvt_pk_bf16_f32 v89, v90, v91
    v_mov_b32 v63, s27
    v_mfma_f32_16x16x32_bf16 v[96:99], v[24:27], v[200:203], v[96:99]
    ds_write_b64 v64, v[88:89] offset:256
    v_mov_b32 v0, s24
    v_mfma_f32_16x16x32_bf16 v[100:103], v[24:27], v[216:219], v[100:103]
    v_cvt_pk_bf16_f32 v92, v92, v93
    v_mov_b32 v1, s25
    v_mfma_f32_16x16x32_bf16 v[96:99], v[28:31], v[204:207], v[96:99]
    v_cvt_pk_bf16_f32 v93, v94, v95
    v_mov_b32 v2, s26
    v_mfma_f32_16x16x32_bf16 v[100:103], v[28:31], v[220:223], v[100:103]
    ds_write_b64 v64, v[92:93] offset:384
    v_mov_b32 v3, s27
    v_mfma_f32_16x16x32_bf16 v[104:107], v[16:19], v[224:227], 0
    v_mov_b32 v4, s24
    v_mfma_f32_16x16x32_bf16 v[108:111], v[16:19], v[240:243], 0
    v_mov_b32 v5, s25
    v_mfma_f32_16x16x32_bf16 v[104:107], v[20:23], v[228:231], v[104:107]
    v_cvt_pk_bf16_f32 v96, v96, v97
    v_mov_b32 v6, s26
    v_mfma_f32_16x16x32_bf16 v[108:111], v[20:23], v[244:247], v[108:111]
    v_cvt_pk_bf16_f32 v97, v98, v99
    v_mov_b32 v7, s27
    v_mfma_f32_16x16x32_bf16 v[104:107], v[24:27], v[232:235], v[104:107]
    ds_write_b64 v64, v[96:97] offset:512
    v_mov_b32 v8, s24
    v_mfma_f32_16x16x32_bf16 v[108:111], v[24:27], v[248:251], v[108:111]
    v_cvt_pk_bf16_f32 v100, v100, v101
    v_mov_b32 v9, s25
    v_mfma_f32_16x16x32_bf16 v[104:107], v[28:31], v[236:239], v[104:107]
    v_cvt_pk_bf16_f32 v101, v102, v103
    v_mov_b32 v10, s26
    v_mfma_f32_16x16x32_bf16 v[108:111], v[28:31], v[252:255], v[108:111]
    ds_write_b64 v64, v[100:101] offset:640
    v_mov_b32 v11, s27
    s_waitcnt vmcnt(1)
    v_mfma_f32_16x16x32_bf16 v[88:91], v[32:35], v[128:131], 0
    v_mfma_f32_16x16x32_bf16 v[92:95], v[32:35], v[144:147], 0
    v_mfma_f32_16x16x32_bf16 v[88:91], v[36:39], v[132:135], v[88:91]
    v_cvt_pk_bf16_f32 v104, v104, v105
    v_mfma_f32_16x16x32_bf16 v[92:95], v[36:39], v[148:151], v[92:95]
    v_cvt_pk_bf16_f32 v105, v106, v107
    v_mfma_f32_16x16x32_bf16 v[88:91], v[40:43], v[136:139], v[88:91]
    ds_write_b64 v64, v[104:105] offset:768
    v_mov_b32 v12, s24
    v_mfma_f32_16x16x32_bf16 v[92:95], v[40:43], v[152:155], v[92:95]
    v_cvt_pk_bf16_f32 v108, v108, v109
    v_mov_b32 v13, s25
    v_mfma_f32_16x16x32_bf16 v[88:91], v[44:47], v[140:143], v[88:91]
    v_cvt_pk_bf16_f32 v109, v110, v111
    v_mov_b32 v14, s26
    v_mfma_f32_16x16x32_bf16 v[92:95], v[44:47], v[156:159], v[92:95]
    ds_write_b64 v64, v[108:109] offset:896
    v_mov_b32 v15, s27
    v_mfma_f32_16x16x32_bf16 v[96:99], v[32:35], v[160:163], 0
    v_mov_b32 v16, s24
    v_mfma_f32_16x16x32_bf16 v[100:103], v[32:35], v[176:179], 0
    v_mov_b32 v17, s25
    v_mfma_f32_16x16x32_bf16 v[96:99], v[36:39], v[164:167], v[96:99]
    v_cvt_pk_bf16_f32 v88, v88, v89
    v_mov_b32 v18, s26
    v_mfma_f32_16x16x32_bf16 v[100:103], v[36:39], v[180:183], v[100:103]
    v_cvt_pk_bf16_f32 v89, v90, v91
    v_mov_b32 v19, s27
    v_mfma_f32_16x16x32_bf16 v[96:99], v[40:43], v[168:171], v[96:99]
    ds_write_b64 v64, v[88:89] offset:32768
    v_mov_b32 v20, s24
    v_mfma_f32_16x16x32_bf16 v[100:103], v[40:43], v[184:187], v[100:103]
    v_cvt_pk_bf16_f32 v92, v92, v93
    v_mov_b32 v21, s25
    v_mfma_f32_16x16x32_bf16 v[96:99], v[44:47], v[172:175], v[96:99]
    v_cvt_pk_bf16_f32 v93, v94, v95
    v_mov_b32 v22, s26
    v_mfma_f32_16x16x32_bf16 v[100:103], v[44:47], v[188:191], v[100:103]
    ds_write_b64 v64, v[92:93] offset:32896
    v_mov_b32 v23, s27
    v_mfma_f32_16x16x32_bf16 v[104:107], v[32:35], v[192:195], 0
    v_mov_b32 v24, s24
    v_mfma_f32_16x16x32_bf16 v[108:111], v[32:35], v[208:211], 0
    v_mov_b32 v25, s25
    v_mfma_f32_16x16x32_bf16 v[104:107], v[36:39], v[196:199], v[104:107]
    v_cvt_pk_bf16_f32 v96, v96, v97
    v_mov_b32 v26, s26
    v_mfma_f32_16x16x32_bf16 v[108:111], v[36:39], v[212:215], v[108:111]
    v_cvt_pk_bf16_f32 v97, v98, v99
    v_mov_b32 v27, s27
    v_mfma_f32_16x16x32_bf16 v[104:107], v[40:43], v[200:203], v[104:107]
    ds_write_b64 v64, v[96:97] offset:33024
    v_mov_b32 v28, s24
    v_mfma_f32_16x16x32_bf16 v[108:111], v[40:43], v[216:219], v[108:111]
    v_cvt_pk_bf16_f32 v100, v100, v101
    v_mov_b32 v29, s25
    v_mfma_f32_16x16x32_bf16 v[104:107], v[44:47], v[204:207], v[104:107]
    v_cvt_pk_bf16_f32 v101, v102, v103
    v_mov_b32 v30, s26
    v_mfma_f32_16x16x32_bf16 v[108:111], v[44:47], v[220:223], v[108:111]
    ds_write_b64 v64, v[100:101] offset:33152
    v_mov_b32 v31, s27
    v_mfma_f32_16x16x32_bf16 v[88:91], v[32:35], v[224:227], 0
    s_nop 0
    v_mfma_f32_16x16x32_bf16 v[92:95], v[32:35], v[240:243], 0
    s_nop 0
    v_mfma_f32_16x16x32_bf16 v[88:91], v[36:39], v[228:231], v[88:91]
    v_cvt_pk_bf16_f32 v104, v104, v105
    s_nop 0
    v_mfma_f32_16x16x32_bf16 v[92:95], v[36:39], v[244:247], v[92:95]
    v_cvt_pk_bf16_f32 v105, v106, v107
    s_nop 0
    v_mfma_f32_16x16x32_bf16 v[88:91], v[40:43], v[232:235], v[88:91]
    ds_write_b64 v64, v[104:105] offset:33280
    s_nop 0
    v_mfma_f32_16x16x32_bf16 v[92:95], v[40:43], v[248:251], v[92:95]
    v_cvt_pk_bf16_f32 v108, v108, v109
    s_nop 0
    v_mfma_f32_16x16x32_bf16 v[88:91], v[44:47], v[236:239], v[88:91]
    v_cvt_pk_bf16_f32 v109, v110, v111
    s_nop 0
    v_mfma_f32_16x16x32_bf16 v[92:95], v[44:47], v[252:255], v[92:95]
    ds_write_b64 v64, v[108:109] offset:33408
    s_nop 0
    v_mov_b32 v32, s24
    v_mov_b32 v33, s25
    v_mov_b32 v34, s26
    v_mov_b32 v35, s27
    v_mov_b32 v36, s24
    v_mov_b32 v37, s25
    v_mov_b32 v38, s26
    v_mov_b32 v39, s27
    v_mov_b32 v40, s24
    v_mov_b32 v41, s25
    v_mov_b32 v42, s26
    v_mov_b32 v43, s27
    v_mov_b32 v44, s24
    v_mov_b32 v45, s25
    v_mov_b32 v46, s26
    v_mov_b32 v47, s27
    s_nop 7
    v_cvt_pk_bf16_f32 v88, v88, v89
    v_cvt_pk_bf16_f32 v89, v90, v91
    ds_write_b64 v64, v[88:89] offset:33536
    v_cvt_pk_bf16_f32 v92, v92, v93
    v_cvt_pk_bf16_f32 v93, v94, v95
    ds_write_b64 v64, v[92:93] offset:33664
k1_kernel_k2j:

    v_mov_b32 v65, 0
    s_waitcnt lgkmcnt(0)
    s_barrier
    ds_read_b32 v65, v65 offset:8184

    s_setprio 3
    v_lshlrev_b32_sdwa v88, 3, v116 dst_sel:DWORD dst_unused:UNUSED_PAD src0_sel:DWORD src1_sel:WORD_0
    v_lshlrev_b32_sdwa v90, 3, v116 dst_sel:DWORD dst_unused:UNUSED_PAD src0_sel:DWORD src1_sel:WORD_1
    ds_read_b64 v[88:89], v88
    ds_read_b64 v[90:91], v90
    v_lshlrev_b32_sdwa v92, 3, v117 dst_sel:DWORD dst_unused:UNUSED_PAD src0_sel:DWORD src1_sel:WORD_0
    v_lshlrev_b32_sdwa v94, 3, v117 dst_sel:DWORD dst_unused:UNUSED_PAD src0_sel:DWORD src1_sel:WORD_1
    ds_read_b64 v[92:93], v92
    ds_read_b64 v[94:95], v94
    v_lshlrev_b32_sdwa v96, 3, v118 dst_sel:DWORD dst_unused:UNUSED_PAD src0_sel:DWORD src1_sel:WORD_0
    v_lshlrev_b32_sdwa v98, 3, v118 dst_sel:DWORD dst_unused:UNUSED_PAD src0_sel:DWORD src1_sel:WORD_1
    ds_read_b64 v[96:97], v96
    ds_read_b64 v[98:99], v98
    v_lshlrev_b32_sdwa v100, 3, v119 dst_sel:DWORD dst_unused:UNUSED_PAD src0_sel:DWORD src1_sel:WORD_0
    v_lshlrev_b32_sdwa v102, 3, v119 dst_sel:DWORD dst_unused:UNUSED_PAD src0_sel:DWORD src1_sel:WORD_1
    ds_read_b64 v[100:101], v100
    ds_read_b64 v[102:103], v102
    buffer_load_dwordx2 v[116:117], v71, s[12:15], s20 offen offset:2048 sc1
    buffer_load_dwordx2 v[118:119], v71, s[12:15], s20 offen offset:3072 sc1
    s_waitcnt lgkmcnt(8)
    v_readfirstlane_b32 s44, v65
    s_cmp_lg_u32 s44, 0
    s_cbranch_scc1 k1_kernel_solo1
    v_mfma_f32_16x16x32_bf16 v[112:115], v[72:75], v[128:131], 0
    v_lshlrev_b32_sdwa v104, 3, v120 dst_sel:DWORD dst_unused:UNUSED_PAD src0_sel:DWORD src1_sel:WORD_0
    v_lshlrev_b32_sdwa v106, 3, v120 dst_sel:DWORD dst_unused:UNUSED_PAD src0_sel:DWORD src1_sel:WORD_1
    ds_read_b64 v[104:105], v104
    ds_read_b64 v[106:107], v106
    v_mfma_f32_16x16x32_bf16 v[112:115], v[76:79], v[132:135], v[112:115]
    v_add_u32 v70, 0x20000000, v70
    v_lshlrev_b32_sdwa v108, 3, v121 dst_sel:DWORD dst_unused:UNUSED_PAD src0_sel:DWORD src1_sel:WORD_0
    v_lshlrev_b32_sdwa v110, 3, v121 dst_sel:DWORD dst_unused:UNUSED_PAD src0_sel:DWORD src1_sel:WORD_1
    ds_read_b64 v[108:109], v108
    ds_read_b64 v[110:111], v110
    s_waitcnt lgkmcnt(8)
    v_smfmac_f32_16x16x64_bf16 v[0:3], v[66:69], v[88:95], v70
    v_mfma_f32_16x16x32_bf16 v[112:115], v[80:83], v[136:139], v[112:115]
    v_lshlrev_b32_sdwa v88, 3, v122 dst_sel:DWORD dst_unused:UNUSED_PAD src0_sel:DWORD src1_sel:WORD_0
    v_lshlrev_b32_sdwa v90, 3, v122 dst_sel:DWORD dst_unused:UNUSED_PAD src0_sel:DWORD src1_sel:WORD_1
    ds_read_b64 v[88:89], v88
    ds_read_b64 v[90:91], v90
    v_mfma_f32_16x16x32_bf16 v[112:115], v[84:87], v[140:143], v[112:115]
    v_lshlrev_b32_sdwa v92, 3, v123 dst_sel:DWORD dst_unused:UNUSED_PAD src0_sel:DWORD src1_sel:WORD_0
    v_lshlrev_b32_sdwa v94, 3, v123 dst_sel:DWORD dst_unused:UNUSED_PAD src0_sel:DWORD src1_sel:WORD_1
    v_cvt_pk_bf16_f32 v0, v0, v1
    v_cvt_pk_bf16_f32 v1, v2, v3
    ds_read_b64 v[92:93], v92
    ds_read_b64 v[94:95], v94
    s_add_u32 s20, s20, 0x1000
    buffer_load_dwordx2 v[120:121], v71, s[12:15], s20 offen offset:0 sc1
    buffer_load_dwordx2 v[122:123], v71, s[12:15], s20 offen offset:1024 sc1
    s_waitcnt lgkmcnt(8)
    v_smfmac_f32_16x16x64_bf16 v[4:7], v[66:69], v[96:103], v70
    v_cvt_pk_bf16_f32 v112, v112, v113
    v_cvt_pk_bf16_f32 v113, v114, v115
    v_lshlrev_b32_sdwa v114, 3, v70 dst_sel:DWORD dst_unused:UNUSED_PAD src0_sel:DWORD src1_sel:WORD_1
    ds_write_b64 v114, v[112:113] offset:32768
    v_lshlrev_b32_sdwa v96, 3, v124 dst_sel:DWORD dst_unused:UNUSED_PAD src0_sel:DWORD src1_sel:WORD_0
    v_lshlrev_b32_sdwa v98, 3, v124 dst_sel:DWORD dst_unused:UNUSED_PAD src0_sel:DWORD src1_sel:WORD_1
    ds_read_b64 v[96:97], v96
    ds_read_b64 v[98:99], v98
    v_lshlrev_b32_sdwa v100, 3, v125 dst_sel:DWORD dst_unused:UNUSED_PAD src0_sel:DWORD src1_sel:WORD_0
    v_lshlrev_b32_sdwa v102, 3, v125 dst_sel:DWORD dst_unused:UNUSED_PAD src0_sel:DWORD src1_sel:WORD_1
    v_cvt_pk_bf16_f32 v2, v4, v5
    v_cvt_pk_bf16_f32 v3, v6, v7
    ds_read_b64 v[100:101], v100
    ds_read_b64 v[102:103], v102
    s_waitcnt lgkmcnt(9)
    v_smfmac_f32_16x16x64_bf16 v[8:11], v[66:69], v[104:111], v70
    v_lshlrev_b32_sdwa v104, 3, v126 dst_sel:DWORD dst_unused:UNUSED_PAD src0_sel:DWORD src1_sel:WORD_0
    v_lshlrev_b32_sdwa v106, 3, v126 dst_sel:DWORD dst_unused:UNUSED_PAD src0_sel:DWORD src1_sel:WORD_1
    ds_read_b64 v[104:105], v104
    ds_read_b64 v[106:107], v106
    v_lshlrev_b32_sdwa v108, 3, v127 dst_sel:DWORD dst_unused:UNUSED_PAD src0_sel:DWORD src1_sel:WORD_0
    v_lshlrev_b32_sdwa v110, 3, v127 dst_sel:DWORD dst_unused:UNUSED_PAD src0_sel:DWORD src1_sel:WORD_1
    s_nop 1
    v_cvt_pk_bf16_f32 v4, v8, v9
    v_cvt_pk_bf16_f32 v5, v10, v11
    ds_read_b64 v[108:109], v108
    ds_read_b64 v[110:111], v110
    buffer_load_dwordx2 v[124:125], v71, s[12:15], s20 offen offset:2048 sc1
    buffer_load_dwordx2 v[126:127], v71, s[12:15], s20 offen offset:3072 sc1
    s_waitcnt lgkmcnt(9)
    v_smfmac_f32_16x16x64_bf16 v[12:15], v[66:69], v[88:95], v70
    s_waitcnt vmcnt(4)
    v_lshlrev_b32_sdwa v88, 3, v116 dst_sel:DWORD dst_unused:UNUSED_PAD src0_sel:DWORD src1_sel:WORD_0
    v_lshlrev_b32_sdwa v90, 3, v116 dst_sel:DWORD dst_unused:UNUSED_PAD src0_sel:DWORD src1_sel:WORD_1
    ds_read_b64 v[88:89], v88
    ds_read_b64 v[90:91], v90
    v_lshlrev_b32_sdwa v92, 3, v117 dst_sel:DWORD dst_unused:UNUSED_PAD src0_sel:DWORD src1_sel:WORD_0
    v_lshlrev_b32_sdwa v94, 3, v117 dst_sel:DWORD dst_unused:UNUSED_PAD src0_sel:DWORD src1_sel:WORD_1
    s_nop 0
    v_cvt_pk_bf16_f32 v6, v12, v13
    v_cvt_pk_bf16_f32 v7, v14, v15
    ds_read_b64 v[92:93], v92
    ds_read_b64 v[94:95], v94
    s_waitcnt lgkmcnt(8)
    v_smfmac_f32_16x16x64_bf16 v[16:19], v[66:69], v[96:103], v70
    v_mfma_f32_16x16x32_bf16 v[112:115], v[72:75], v[144:147], 0
    v_lshlrev_b32_sdwa v96, 3, v118 dst_sel:DWORD dst_unused:UNUSED_PAD src0_sel:DWORD src1_sel:WORD_0
    v_lshlrev_b32_sdwa v98, 3, v118 dst_sel:DWORD dst_unused:UNUSED_PAD src0_sel:DWORD src1_sel:WORD_1
    ds_read_b64 v[96:97], v96
    ds_read_b64 v[98:99], v98
    v_mfma_f32_16x16x32_bf16 v[112:115], v[76:79], v[148:151], v[112:115]
    v_lshlrev_b32_sdwa v100, 3, v119 dst_sel:DWORD dst_unused:UNUSED_PAD src0_sel:DWORD src1_sel:WORD_0
    v_lshlrev_b32_sdwa v102, 3, v119 dst_sel:DWORD dst_unused:UNUSED_PAD src0_sel:DWORD src1_sel:WORD_1
    v_cvt_pk_bf16_f32 v8, v16, v17
    v_cvt_pk_bf16_f32 v9, v18, v19
    ds_read_b64 v[100:101], v100
    ds_read_b64 v[102:103], v102
    s_add_u32 s20, s20, 0x1000
    buffer_load_dwordx2 v[116:117], v71, s[12:15], s20 offen offset:0 sc1
    buffer_load_dwordx2 v[118:119], v71, s[12:15], s20 offen offset:1024 sc1
    s_waitcnt lgkmcnt(8)
    v_smfmac_f32_16x16x64_bf16 v[20:23], v[66:69], v[104:111], v70
    v_mfma_f32_16x16x32_bf16 v[112:115], v[80:83], v[152:155], v[112:115]
    s_waitcnt vmcnt(4)
    v_lshlrev_b32_sdwa v104, 3, v120 dst_sel:DWORD dst_unused:UNUSED_PAD src0_sel:DWORD src1_sel:WORD_0
    v_lshlrev_b32_sdwa v106, 3, v120 dst_sel:DWORD dst_unused:UNUSED_PAD src0_sel:DWORD src1_sel:WORD_1
    ds_read_b64 v[104:105], v104
    ds_read_b64 v[106:107], v106
    v_mfma_f32_16x16x32_bf16 v[112:115], v[84:87], v[156:159], v[112:115]
    v_lshlrev_b32_sdwa v108, 3, v121 dst_sel:DWORD dst_unused:UNUSED_PAD src0_sel:DWORD src1_sel:WORD_0
    v_lshlrev_b32_sdwa v110, 3, v121 dst_sel:DWORD dst_unused:UNUSED_PAD src0_sel:DWORD src1_sel:WORD_1
    v_cvt_pk_bf16_f32 v10, v20, v21
    v_cvt_pk_bf16_f32 v11, v22, v23
    ds_read_b64 v[108:109], v108
    ds_read_b64 v[110:111], v110
    s_waitcnt lgkmcnt(8)
    v_smfmac_f32_16x16x64_bf16 v[24:27], v[66:69], v[88:95], v70
    v_cvt_pk_bf16_f32 v112, v112, v113
    v_cvt_pk_bf16_f32 v113, v114, v115
    v_lshlrev_b32_sdwa v114, 3, v70 dst_sel:DWORD dst_unused:UNUSED_PAD src0_sel:DWORD src1_sel:WORD_1
    ds_write_b64 v114, v[112:113] offset:32896
    v_lshlrev_b32_sdwa v88, 3, v122 dst_sel:DWORD dst_unused:UNUSED_PAD src0_sel:DWORD src1_sel:WORD_0
    v_lshlrev_b32_sdwa v90, 3, v122 dst_sel:DWORD dst_unused:UNUSED_PAD src0_sel:DWORD src1_sel:WORD_1
    ds_read_b64 v[88:89], v88
    ds_read_b64 v[90:91], v90
    v_lshlrev_b32_sdwa v92, 3, v123 dst_sel:DWORD dst_unused:UNUSED_PAD src0_sel:DWORD src1_sel:WORD_0
    v_lshlrev_b32_sdwa v94, 3, v123 dst_sel:DWORD dst_unused:UNUSED_PAD src0_sel:DWORD src1_sel:WORD_1
    v_cvt_pk_bf16_f32 v12, v24, v25
    v_cvt_pk_bf16_f32 v13, v26, v27
    ds_read_b64 v[92:93], v92
    ds_read_b64 v[94:95], v94
    buffer_load_dwordx2 v[120:121], v71, s[12:15], s20 offen offset:2048 sc1
    buffer_load_dwordx2 v[122:123], v71, s[12:15], s20 offen offset:3072 sc1
    s_waitcnt lgkmcnt(9)
    v_smfmac_f32_16x16x64_bf16 v[28:31], v[66:69], v[96:103], v70
    s_waitcnt vmcnt(4)
    v_lshlrev_b32_sdwa v96, 3, v124 dst_sel:DWORD dst_unused:UNUSED_PAD src0_sel:DWORD src1_sel:WORD_0
    v_lshlrev_b32_sdwa v98, 3, v124 dst_sel:DWORD dst_unused:UNUSED_PAD src0_sel:DWORD src1_sel:WORD_1
    ds_read_b64 v[96:97], v96
    ds_read_b64 v[98:99], v98
    v_lshlrev_b32_sdwa v100, 3, v125 dst_sel:DWORD dst_unused:UNUSED_PAD src0_sel:DWORD src1_sel:WORD_0
    v_lshlrev_b32_sdwa v102, 3, v125 dst_sel:DWORD dst_unused:UNUSED_PAD src0_sel:DWORD src1_sel:WORD_1
    s_nop 0
    v_cvt_pk_bf16_f32 v14, v28, v29
    v_cvt_pk_bf16_f32 v15, v30, v31
    ds_read_b64 v[100:101], v100
    ds_read_b64 v[102:103], v102
    s_waitcnt lgkmcnt(9)
    v_smfmac_f32_16x16x64_bf16 v[32:35], v[66:69], v[104:111], v70
    v_lshlrev_b32_sdwa v104, 3, v126 dst_sel:DWORD dst_unused:UNUSED_PAD src0_sel:DWORD src1_sel:WORD_0
    v_lshlrev_b32_sdwa v106, 3, v126 dst_sel:DWORD dst_unused:UNUSED_PAD src0_sel:DWORD src1_sel:WORD_1
    ds_read_b64 v[104:105], v104
    ds_read_b64 v[106:107], v106
    v_lshlrev_b32_sdwa v108, 3, v127 dst_sel:DWORD dst_unused:UNUSED_PAD src0_sel:DWORD src1_sel:WORD_0
    v_lshlrev_b32_sdwa v110, 3, v127 dst_sel:DWORD dst_unused:UNUSED_PAD src0_sel:DWORD src1_sel:WORD_1
    s_nop 1
    v_cvt_pk_bf16_f32 v16, v32, v33
    v_cvt_pk_bf16_f32 v17, v34, v35
    ds_read_b64 v[108:109], v108
    ds_read_b64 v[110:111], v110
    s_add_u32 s20, s20, 0x1d000
    buffer_load_dwordx4 v[124:127], v71, s[12:15], s20 offen offset:0 sc1
    s_waitcnt lgkmcnt(8)
    v_smfmac_f32_16x16x64_bf16 v[36:39], v[66:69], v[88:95], v70
    v_mfma_f32_16x16x32_bf16 v[112:115], v[72:75], v[160:163], 0
    s_waitcnt vmcnt(3)
    v_lshlrev_b32_sdwa v88, 3, v116 dst_sel:DWORD dst_unused:UNUSED_PAD src0_sel:DWORD src1_sel:WORD_0
    v_lshlrev_b32_sdwa v90, 3, v116 dst_sel:DWORD dst_unused:UNUSED_PAD src0_sel:DWORD src1_sel:WORD_1
    ds_read_b64 v[88:89], v88
    ds_read_b64 v[90:91], v90
    v_mfma_f32_16x16x32_bf16 v[112:115], v[76:79], v[164:167], v[112:115]
    v_lshlrev_b32_sdwa v92, 3, v117 dst_sel:DWORD dst_unused:UNUSED_PAD src0_sel:DWORD src1_sel:WORD_0
    v_lshlrev_b32_sdwa v94, 3, v117 dst_sel:DWORD dst_unused:UNUSED_PAD src0_sel:DWORD src1_sel:WORD_1
    v_cvt_pk_bf16_f32 v18, v36, v37
    v_cvt_pk_bf16_f32 v19, v38, v39
    ds_read_b64 v[92:93], v92
    ds_read_b64 v[94:95], v94
    s_waitcnt lgkmcnt(8)
    v_smfmac_f32_16x16x64_bf16 v[40:43], v[66:69], v[96:103], v70
    v_mfma_f32_16x16x32_bf16 v[112:115], v[80:83], v[168:171], v[112:115]
    v_lshlrev_b32_sdwa v96, 3, v118 dst_sel:DWORD dst_unused:UNUSED_PAD src0_sel:DWORD src1_sel:WORD_0
    v_lshlrev_b32_sdwa v98, 3, v118 dst_sel:DWORD dst_unused:UNUSED_PAD src0_sel:DWORD src1_sel:WORD_1
    ds_read_b64 v[96:97], v96
    ds_read_b64 v[98:99], v98
    v_mfma_f32_16x16x32_bf16 v[112:115], v[84:87], v[172:175], v[112:115]
    v_lshlrev_b32_sdwa v100, 3, v119 dst_sel:DWORD dst_unused:UNUSED_PAD src0_sel:DWORD src1_sel:WORD_0
    v_lshlrev_b32_sdwa v102, 3, v119 dst_sel:DWORD dst_unused:UNUSED_PAD src0_sel:DWORD src1_sel:WORD_1
    v_cvt_pk_bf16_f32 v20, v40, v41
    v_cvt_pk_bf16_f32 v21, v42, v43
    ds_read_b64 v[100:101], v100
    ds_read_b64 v[102:103], v102
    buffer_load_dwordx4 v[116:119], v71, s[12:15], s20 offen offset:1024 sc1
    s_waitcnt lgkmcnt(8)
    v_smfmac_f32_16x16x64_bf16 v[44:47], v[66:69], v[104:111], v70
    v_cvt_pk_bf16_f32 v112, v112, v113
    v_cvt_pk_bf16_f32 v113, v114, v115
    v_lshlrev_b32_sdwa v114, 3, v70 dst_sel:DWORD dst_unused:UNUSED_PAD src0_sel:DWORD src1_sel:WORD_1
    ds_write_b64 v114, v[112:113] offset:33024
    s_waitcnt vmcnt(2)
    v_lshlrev_b32_sdwa v104, 3, v120 dst_sel:DWORD dst_unused:UNUSED_PAD src0_sel:DWORD src1_sel:WORD_0
    v_lshlrev_b32_sdwa v106, 3, v120 dst_sel:DWORD dst_unused:UNUSED_PAD src0_sel:DWORD src1_sel:WORD_1
    ds_read_b64 v[104:105], v104
    ds_read_b64 v[106:107], v106
    v_lshlrev_b32_sdwa v108, 3, v121 dst_sel:DWORD dst_unused:UNUSED_PAD src0_sel:DWORD src1_sel:WORD_0
    v_lshlrev_b32_sdwa v110, 3, v121 dst_sel:DWORD dst_unused:UNUSED_PAD src0_sel:DWORD src1_sel:WORD_1
    v_cvt_pk_bf16_f32 v22, v44, v45
    v_cvt_pk_bf16_f32 v23, v46, v47
    ds_read_b64 v[108:109], v108
    ds_read_b64 v[110:111], v110
    s_waitcnt lgkmcnt(9)
    v_smfmac_f32_16x16x64_bf16 v[48:51], v[66:69], v[88:95], v70
    v_lshlrev_b32_sdwa v88, 3, v122 dst_sel:DWORD dst_unused:UNUSED_PAD src0_sel:DWORD src1_sel:WORD_0
    v_lshlrev_b32_sdwa v90, 3, v122 dst_sel:DWORD dst_unused:UNUSED_PAD src0_sel:DWORD src1_sel:WORD_1
    ds_read_b64 v[88:89], v88
    ds_read_b64 v[90:91], v90
    v_lshlrev_b32_sdwa v92, 3, v123 dst_sel:DWORD dst_unused:UNUSED_PAD src0_sel:DWORD src1_sel:WORD_0
    v_lshlrev_b32_sdwa v94, 3, v123 dst_sel:DWORD dst_unused:UNUSED_PAD src0_sel:DWORD src1_sel:WORD_1
    s_nop 1
    v_cvt_pk_bf16_f32 v24, v48, v49
    v_cvt_pk_bf16_f32 v25, v50, v51
    ds_read_b64 v[92:93], v92
    ds_read_b64 v[94:95], v94
    buffer_load_dwordx4 v[120:123], v71, s[12:15], s20 offen offset:2048 sc1
    s_waitcnt lgkmcnt(9)
    v_smfmac_f32_16x16x64_bf16 v[52:55], v[66:69], v[96:103], v70
    s_waitcnt vmcnt(2)
    v_lshlrev_b32_sdwa v96, 3, v124 dst_sel:DWORD dst_unused:UNUSED_PAD src0_sel:DWORD src1_sel:WORD_0
    v_lshlrev_b32_sdwa v98, 3, v124 dst_sel:DWORD dst_unused:UNUSED_PAD src0_sel:DWORD src1_sel:WORD_1
    ds_read_b64 v[96:97], v96
    ds_read_b64 v[98:99], v98
    v_lshlrev_b32_sdwa v100, 3, v125 dst_sel:DWORD dst_unused:UNUSED_PAD src0_sel:DWORD src1_sel:WORD_0
    v_lshlrev_b32_sdwa v102, 3, v125 dst_sel:DWORD dst_unused:UNUSED_PAD src0_sel:DWORD src1_sel:WORD_1
    s_nop 0
    v_cvt_pk_bf16_f32 v26, v52, v53
    v_cvt_pk_bf16_f32 v27, v54, v55
    ds_read_b64 v[100:101], v100
    ds_read_b64 v[102:103], v102
    s_waitcnt lgkmcnt(8)
    v_smfmac_f32_16x16x64_bf16 v[56:59], v[66:69], v[104:111], v70
    v_mfma_f32_16x16x32_bf16 v[112:115], v[72:75], v[176:179], 0
    v_lshlrev_b32_sdwa v104, 3, v126 dst_sel:DWORD dst_unused:UNUSED_PAD src0_sel:DWORD src1_sel:WORD_0
    v_lshlrev_b32_sdwa v106, 3, v126 dst_sel:DWORD dst_unused:UNUSED_PAD src0_sel:DWORD src1_sel:WORD_1
    ds_read_b64 v[104:105], v104
    ds_read_b64 v[106:107], v106
    v_mfma_f32_16x16x32_bf16 v[112:115], v[76:79], v[180:183], v[112:115]
    v_lshlrev_b32_sdwa v108, 3, v127 dst_sel:DWORD dst_unused:UNUSED_PAD src0_sel:DWORD src1_sel:WORD_0
    v_lshlrev_b32_sdwa v110, 3, v127 dst_sel:DWORD dst_unused:UNUSED_PAD src0_sel:DWORD src1_sel:WORD_1
    v_cvt_pk_bf16_f32 v28, v56, v57
    v_cvt_pk_bf16_f32 v29, v58, v59
    ds_read_b64 v[108:109], v108
    ds_read_b64 v[110:111], v110
    buffer_load_dwordx4 v[124:127], v71, s[12:15], s20 offen offset:3072 sc1
    s_waitcnt lgkmcnt(8)
    v_smfmac_f32_16x16x64_bf16 v[60:63], v[66:69], v[88:95], v70
    v_mfma_f32_16x16x32_bf16 v[112:115], v[80:83], v[184:187], v[112:115]
    s_waitcnt vmcnt(2)
    v_lshlrev_b32_sdwa v88, 3, v116 dst_sel:DWORD dst_unused:UNUSED_PAD src0_sel:DWORD src1_sel:WORD_0
    v_lshlrev_b32_sdwa v90, 3, v116 dst_sel:DWORD dst_unused:UNUSED_PAD src0_sel:DWORD src1_sel:WORD_1
    ds_read_b64 v[88:89], v88
    ds_read_b64 v[90:91], v90
    v_mfma_f32_16x16x32_bf16 v[112:115], v[84:87], v[188:191], v[112:115]
    v_lshlrev_b32_sdwa v92, 3, v117 dst_sel:DWORD dst_unused:UNUSED_PAD src0_sel:DWORD src1_sel:WORD_0
    v_lshlrev_b32_sdwa v94, 3, v117 dst_sel:DWORD dst_unused:UNUSED_PAD src0_sel:DWORD src1_sel:WORD_1
    v_cvt_pk_bf16_f32 v30, v60, v61
    v_cvt_pk_bf16_f32 v31, v62, v63
    v_mov_b64 v[62:63], 0
    v_mov_b64 v[64:65], 0
    ds_read_b64 v[92:93], v92
    ds_read_b64 v[94:95], v94
    s_waitcnt lgkmcnt(8)
    v_smfmac_f32_16x16x64_bf16 v[62:65], v[66:69], v[96:103], v70
    v_cvt_pk_bf16_f32 v112, v112, v113
    v_cvt_pk_bf16_f32 v113, v114, v115
    v_lshlrev_b32_sdwa v114, 3, v70 dst_sel:DWORD dst_unused:UNUSED_PAD src0_sel:DWORD src1_sel:WORD_1
    ds_write_b64 v114, v[112:113] offset:33152
    v_lshlrev_b32_sdwa v96, 3, v118 dst_sel:DWORD dst_unused:UNUSED_PAD src0_sel:DWORD src1_sel:WORD_0
    v_lshlrev_b32_sdwa v98, 3, v118 dst_sel:DWORD dst_unused:UNUSED_PAD src0_sel:DWORD src1_sel:WORD_1
    ds_read_b64 v[96:97], v96
    ds_read_b64 v[98:99], v98
    v_lshlrev_b32_sdwa v100, 3, v119 dst_sel:DWORD dst_unused:UNUSED_PAD src0_sel:DWORD src1_sel:WORD_0
    v_lshlrev_b32_sdwa v102, 3, v119 dst_sel:DWORD dst_unused:UNUSED_PAD src0_sel:DWORD src1_sel:WORD_1
    ds_read_b64 v[100:101], v100
    ds_read_b64 v[102:103], v102
    s_add_u32 s20, s20, 0x1000
    buffer_load_dwordx4 v[116:119], v71, s[12:15], s20 offen offset:0 sc1
    s_waitcnt lgkmcnt(9)
    v_smfmac_f32_16x16x64_bf16 v[62:65], v[66:69], v[104:111], v70
    s_waitcnt vmcnt(2)
    v_lshlrev_b32_sdwa v104, 3, v120 dst_sel:DWORD dst_unused:UNUSED_PAD src0_sel:DWORD src1_sel:WORD_0
    v_lshlrev_b32_sdwa v106, 3, v120 dst_sel:DWORD dst_unused:UNUSED_PAD src0_sel:DWORD src1_sel:WORD_1
    ds_read_b64 v[104:105], v104
    ds_read_b64 v[106:107], v106
    v_lshlrev_b32_sdwa v108, 3, v121 dst_sel:DWORD dst_unused:UNUSED_PAD src0_sel:DWORD src1_sel:WORD_0
    v_lshlrev_b32_sdwa v110, 3, v121 dst_sel:DWORD dst_unused:UNUSED_PAD src0_sel:DWORD src1_sel:WORD_1
    s_nop 0
    v_cvt_pk_bf16_f32 v65, v64, v65
    v_cvt_pk_bf16_f32 v64, v62, v63
    v_mov_b64 v[60:61], 0
    v_mov_b64 v[62:63], 0
    ds_read_b64 v[108:109], v108
    ds_read_b64 v[110:111], v110
    s_waitcnt lgkmcnt(9)
    v_smfmac_f32_16x16x64_bf16 v[60:63], v[66:69], v[88:95], v70
    v_lshlrev_b32_sdwa v88, 3, v122 dst_sel:DWORD dst_unused:UNUSED_PAD src0_sel:DWORD src1_sel:WORD_0
    v_lshlrev_b32_sdwa v90, 3, v122 dst_sel:DWORD dst_unused:UNUSED_PAD src0_sel:DWORD src1_sel:WORD_1
    ds_read_b64 v[88:89], v88
    ds_read_b64 v[90:91], v90
    v_lshlrev_b32_sdwa v92, 3, v123 dst_sel:DWORD dst_unused:UNUSED_PAD src0_sel:DWORD src1_sel:WORD_0
    v_lshlrev_b32_sdwa v94, 3, v123 dst_sel:DWORD dst_unused:UNUSED_PAD src0_sel:DWORD src1_sel:WORD_1
    ds_read_b64 v[92:93], v92
    ds_read_b64 v[94:95], v94
    buffer_load_dwordx4 v[120:123], v71, s[12:15], s20 offen offset:1024 sc1
    s_waitcnt lgkmcnt(8)
    v_smfmac_f32_16x16x64_bf16 v[60:63], v[66:69], v[96:103], v70
    v_mfma_f32_16x16x32_bf16 v[112:115], v[72:75], v[192:195], 0
    s_waitcnt vmcnt(2)
    v_lshlrev_b32_sdwa v96, 3, v124 dst_sel:DWORD dst_unused:UNUSED_PAD src0_sel:DWORD src1_sel:WORD_0
    v_lshlrev_b32_sdwa v98, 3, v124 dst_sel:DWORD dst_unused:UNUSED_PAD src0_sel:DWORD src1_sel:WORD_1
    ds_read_b64 v[96:97], v96
    ds_read_b64 v[98:99], v98
    v_mfma_f32_16x16x32_bf16 v[112:115], v[76:79], v[196:199], v[112:115]
    v_lshlrev_b32_sdwa v100, 3, v125 dst_sel:DWORD dst_unused:UNUSED_PAD src0_sel:DWORD src1_sel:WORD_0
    v_lshlrev_b32_sdwa v102, 3, v125 dst_sel:DWORD dst_unused:UNUSED_PAD src0_sel:DWORD src1_sel:WORD_1
    v_cvt_pk_bf16_f32 v63, v62, v63
    v_cvt_pk_bf16_f32 v62, v60, v61
    v_mov_b64 v[58:59], 0
    v_mov_b64 v[60:61], 0
    ds_read_b64 v[100:101], v100
    ds_read_b64 v[102:103], v102
    s_waitcnt lgkmcnt(8)
    v_smfmac_f32_16x16x64_bf16 v[58:61], v[66:69], v[104:111], v70
    v_mfma_f32_16x16x32_bf16 v[112:115], v[80:83], v[200:203], v[112:115]
    v_lshlrev_b32_sdwa v104, 3, v126 dst_sel:DWORD dst_unused:UNUSED_PAD src0_sel:DWORD src1_sel:WORD_0
    v_lshlrev_b32_sdwa v106, 3, v126 dst_sel:DWORD dst_unused:UNUSED_PAD src0_sel:DWORD src1_sel:WORD_1
    ds_read_b64 v[104:105], v104
    ds_read_b64 v[106:107], v106
    v_mfma_f32_16x16x32_bf16 v[112:115], v[84:87], v[204:207], v[112:115]
    v_lshlrev_b32_sdwa v108, 3, v127 dst_sel:DWORD dst_unused:UNUSED_PAD src0_sel:DWORD src1_sel:WORD_0
    v_lshlrev_b32_sdwa v110, 3, v127 dst_sel:DWORD dst_unused:UNUSED_PAD src0_sel:DWORD src1_sel:WORD_1
    ds_read_b64 v[108:109], v108
    ds_read_b64 v[110:111], v110
    buffer_load_dwordx4 v[124:127], v71, s[12:15], s20 offen offset:2048 sc1
    s_waitcnt lgkmcnt(8)
    v_smfmac_f32_16x16x64_bf16 v[58:61], v[66:69], v[88:95], v70
    s_nop 0
    v_cvt_pk_bf16_f32 v112, v112, v113
    v_cvt_pk_bf16_f32 v113, v114, v115
    v_lshlrev_b32_sdwa v114, 3, v70 dst_sel:DWORD dst_unused:UNUSED_PAD src0_sel:DWORD src1_sel:WORD_1
    ds_write_b64 v114, v[112:113] offset:33280
    s_waitcnt vmcnt(2)
    v_lshlrev_b32_sdwa v88, 3, v116 dst_sel:DWORD dst_unused:UNUSED_PAD src0_sel:DWORD src1_sel:WORD_0
    v_lshlrev_b32_sdwa v90, 3, v116 dst_sel:DWORD dst_unused:UNUSED_PAD src0_sel:DWORD src1_sel:WORD_1
    ds_read_b64 v[88:89], v88
    ds_read_b64 v[90:91], v90
    v_lshlrev_b32_sdwa v92, 3, v117 dst_sel:DWORD dst_unused:UNUSED_PAD src0_sel:DWORD src1_sel:WORD_0
    v_lshlrev_b32_sdwa v94, 3, v117 dst_sel:DWORD dst_unused:UNUSED_PAD src0_sel:DWORD src1_sel:WORD_1
    v_cvt_pk_bf16_f32 v61, v60, v61
    v_cvt_pk_bf16_f32 v60, v58, v59
    v_mov_b64 v[56:57], 0
    v_mov_b64 v[58:59], 0
    ds_read_b64 v[92:93], v92
    ds_read_b64 v[94:95], v94
    s_waitcnt lgkmcnt(9)
    v_smfmac_f32_16x16x64_bf16 v[56:59], v[66:69], v[96:103], v70
    v_lshlrev_b32_sdwa v96, 3, v118 dst_sel:DWORD dst_unused:UNUSED_PAD src0_sel:DWORD src1_sel:WORD_0
    v_lshlrev_b32_sdwa v98, 3, v118 dst_sel:DWORD dst_unused:UNUSED_PAD src0_sel:DWORD src1_sel:WORD_1
    ds_read_b64 v[96:97], v96
    ds_read_b64 v[98:99], v98
    v_lshlrev_b32_sdwa v100, 3, v119 dst_sel:DWORD dst_unused:UNUSED_PAD src0_sel:DWORD src1_sel:WORD_0
    v_lshlrev_b32_sdwa v102, 3, v119 dst_sel:DWORD dst_unused:UNUSED_PAD src0_sel:DWORD src1_sel:WORD_1
    ds_read_b64 v[100:101], v100
    ds_read_b64 v[102:103], v102
    buffer_load_dwordx4 v[116:119], v71, s[12:15], s20 offen offset:3072 sc1
    s_waitcnt lgkmcnt(9)
    v_smfmac_f32_16x16x64_bf16 v[56:59], v[66:69], v[104:111], v70
    s_waitcnt vmcnt(2)
    v_lshlrev_b32_sdwa v104, 3, v120 dst_sel:DWORD dst_unused:UNUSED_PAD src0_sel:DWORD src1_sel:WORD_0
    v_lshlrev_b32_sdwa v106, 3, v120 dst_sel:DWORD dst_unused:UNUSED_PAD src0_sel:DWORD src1_sel:WORD_1
    ds_read_b64 v[104:105], v104
    ds_read_b64 v[106:107], v106
    v_lshlrev_b32_sdwa v108, 3, v121 dst_sel:DWORD dst_unused:UNUSED_PAD src0_sel:DWORD src1_sel:WORD_0
    v_lshlrev_b32_sdwa v110, 3, v121 dst_sel:DWORD dst_unused:UNUSED_PAD src0_sel:DWORD src1_sel:WORD_1
    s_nop 0
    v_cvt_pk_bf16_f32 v59, v58, v59
    v_cvt_pk_bf16_f32 v58, v56, v57
    v_mov_b64 v[54:55], 0
    v_mov_b64 v[56:57], 0
    ds_read_b64 v[108:109], v108
    ds_read_b64 v[110:111], v110
    s_waitcnt lgkmcnt(8)
    v_smfmac_f32_16x16x64_bf16 v[54:57], v[66:69], v[88:95], v70
    v_mfma_f32_16x16x32_bf16 v[112:115], v[72:75], v[208:211], 0
    v_lshlrev_b32_sdwa v88, 3, v122 dst_sel:DWORD dst_unused:UNUSED_PAD src0_sel:DWORD src1_sel:WORD_0
    v_lshlrev_b32_sdwa v90, 3, v122 dst_sel:DWORD dst_unused:UNUSED_PAD src0_sel:DWORD src1_sel:WORD_1
    ds_read_b64 v[88:89], v88
    ds_read_b64 v[90:91], v90
    v_mfma_f32_16x16x32_bf16 v[112:115], v[76:79], v[212:215], v[112:115]
    v_lshlrev_b32_sdwa v92, 3, v123 dst_sel:DWORD dst_unused:UNUSED_PAD src0_sel:DWORD src1_sel:WORD_0
    v_lshlrev_b32_sdwa v94, 3, v123 dst_sel:DWORD dst_unused:UNUSED_PAD src0_sel:DWORD src1_sel:WORD_1
    ds_read_b64 v[92:93], v92
    ds_read_b64 v[94:95], v94
    s_add_u32 s20, s20, 0x1000
    buffer_load_dwordx4 v[120:123], v71, s[12:15], s20 offen offset:0 sc1
    s_waitcnt lgkmcnt(8)
    v_smfmac_f32_16x16x64_bf16 v[54:57], v[66:69], v[96:103], v70
    v_mfma_f32_16x16x32_bf16 v[112:115], v[80:83], v[216:219], v[112:115]
    s_waitcnt vmcnt(2)
    v_lshlrev_b32_sdwa v96, 3, v124 dst_sel:DWORD dst_unused:UNUSED_PAD src0_sel:DWORD src1_sel:WORD_0
    v_lshlrev_b32_sdwa v98, 3, v124 dst_sel:DWORD dst_unused:UNUSED_PAD src0_sel:DWORD src1_sel:WORD_1
    ds_read_b64 v[96:97], v96
    ds_read_b64 v[98:99], v98
    v_mfma_f32_16x16x32_bf16 v[112:115], v[84:87], v[220:223], v[112:115]
    v_lshlrev_b32_sdwa v100, 3, v125 dst_sel:DWORD dst_unused:UNUSED_PAD src0_sel:DWORD src1_sel:WORD_0
    v_lshlrev_b32_sdwa v102, 3, v125 dst_sel:DWORD dst_unused:UNUSED_PAD src0_sel:DWORD src1_sel:WORD_1
    v_cvt_pk_bf16_f32 v57, v56, v57
    v_cvt_pk_bf16_f32 v56, v54, v55
    v_mov_b64 v[52:53], 0
    v_mov_b64 v[54:55], 0
    ds_read_b64 v[100:101], v100
    ds_read_b64 v[102:103], v102
    s_waitcnt lgkmcnt(8)
    v_smfmac_f32_16x16x64_bf16 v[52:55], v[66:69], v[104:111], v70
    v_cvt_pk_bf16_f32 v112, v112, v113
    v_cvt_pk_bf16_f32 v113, v114, v115
    v_lshlrev_b32_sdwa v114, 3, v70 dst_sel:DWORD dst_unused:UNUSED_PAD src0_sel:DWORD src1_sel:WORD_1
    ds_write_b64 v114, v[112:113] offset:33408
    v_lshlrev_b32_sdwa v104, 3, v126 dst_sel:DWORD dst_unused:UNUSED_PAD src0_sel:DWORD src1_sel:WORD_0
    v_lshlrev_b32_sdwa v106, 3, v126 dst_sel:DWORD dst_unused:UNUSED_PAD src0_sel:DWORD src1_sel:WORD_1
    ds_read_b64 v[104:105], v104
    ds_read_b64 v[106:107], v106
    v_lshlrev_b32_sdwa v108, 3, v127 dst_sel:DWORD dst_unused:UNUSED_PAD src0_sel:DWORD src1_sel:WORD_0
    v_lshlrev_b32_sdwa v110, 3, v127 dst_sel:DWORD dst_unused:UNUSED_PAD src0_sel:DWORD src1_sel:WORD_1
    ds_read_b64 v[108:109], v108
    ds_read_b64 v[110:111], v110
    buffer_load_dwordx4 v[124:127], v71, s[12:15], s20 offen offset:1024 sc1
    s_waitcnt lgkmcnt(9)
    v_smfmac_f32_16x16x64_bf16 v[52:55], v[66:69], v[88:95], v70
    s_waitcnt vmcnt(2)
    v_lshlrev_b32_sdwa v88, 3, v116 dst_sel:DWORD dst_unused:UNUSED_PAD src0_sel:DWORD src1_sel:WORD_0
    v_lshlrev_b32_sdwa v90, 3, v116 dst_sel:DWORD dst_unused:UNUSED_PAD src0_sel:DWORD src1_sel:WORD_1
    ds_read_b64 v[88:89], v88
    ds_read_b64 v[90:91], v90
    v_lshlrev_b32_sdwa v92, 3, v117 dst_sel:DWORD dst_unused:UNUSED_PAD src0_sel:DWORD src1_sel:WORD_0
    v_lshlrev_b32_sdwa v94, 3, v117 dst_sel:DWORD dst_unused:UNUSED_PAD src0_sel:DWORD src1_sel:WORD_1
    s_nop 0
    v_cvt_pk_bf16_f32 v55, v54, v55
    v_cvt_pk_bf16_f32 v54, v52, v53
    v_mov_b64 v[50:51], 0
    v_mov_b64 v[52:53], 0
    ds_read_b64 v[92:93], v92
    ds_read_b64 v[94:95], v94
    s_waitcnt lgkmcnt(9)
    v_smfmac_f32_16x16x64_bf16 v[50:53], v[66:69], v[96:103], v70
    v_lshlrev_b32_sdwa v96, 3, v118 dst_sel:DWORD dst_unused:UNUSED_PAD src0_sel:DWORD src1_sel:WORD_0
    v_lshlrev_b32_sdwa v98, 3, v118 dst_sel:DWORD dst_unused:UNUSED_PAD src0_sel:DWORD src1_sel:WORD_1
    ds_read_b64 v[96:97], v96
    ds_read_b64 v[98:99], v98
    v_lshlrev_b32_sdwa v100, 3, v119 dst_sel:DWORD dst_unused:UNUSED_PAD src0_sel:DWORD src1_sel:WORD_0
    v_lshlrev_b32_sdwa v102, 3, v119 dst_sel:DWORD dst_unused:UNUSED_PAD src0_sel:DWORD src1_sel:WORD_1
    ds_read_b64 v[100:101], v100
    ds_read_b64 v[102:103], v102
    buffer_load_dwordx4 v[116:119], v71, s[12:15], s20 offen offset:2048 sc1
    s_waitcnt lgkmcnt(8)
    v_smfmac_f32_16x16x64_bf16 v[50:53], v[66:69], v[104:111], v70
    v_mfma_f32_16x16x32_bf16 v[112:115], v[72:75], v[224:227], 0
    s_waitcnt vmcnt(2)
    v_lshlrev_b32_sdwa v104, 3, v120 dst_sel:DWORD dst_unused:UNUSED_PAD src0_sel:DWORD src1_sel:WORD_0
    v_lshlrev_b32_sdwa v106, 3, v120 dst_sel:DWORD dst_unused:UNUSED_PAD src0_sel:DWORD src1_sel:WORD_1
    ds_read_b64 v[104:105], v104
    ds_read_b64 v[106:107], v106
    v_mfma_f32_16x16x32_bf16 v[112:115], v[76:79], v[228:231], v[112:115]
    v_lshlrev_b32_sdwa v108, 3, v121 dst_sel:DWORD dst_unused:UNUSED_PAD src0_sel:DWORD src1_sel:WORD_0
    v_lshlrev_b32_sdwa v110, 3, v121 dst_sel:DWORD dst_unused:UNUSED_PAD src0_sel:DWORD src1_sel:WORD_1
    v_cvt_pk_bf16_f32 v53, v52, v53
    v_cvt_pk_bf16_f32 v52, v50, v51
    v_mov_b64 v[48:49], 0
    v_mov_b64 v[50:51], 0
    ds_read_b64 v[108:109], v108
    ds_read_b64 v[110:111], v110
    s_waitcnt lgkmcnt(8)
    v_smfmac_f32_16x16x64_bf16 v[48:51], v[66:69], v[88:95], v70
    s_setprio 2
    v_mfma_f32_16x16x32_bf16 v[112:115], v[80:83], v[232:235], v[112:115]
    v_lshlrev_b32_sdwa v88, 3, v122 dst_sel:DWORD dst_unused:UNUSED_PAD src0_sel:DWORD src1_sel:WORD_0
    v_lshlrev_b32_sdwa v90, 3, v122 dst_sel:DWORD dst_unused:UNUSED_PAD src0_sel:DWORD src1_sel:WORD_1
    ds_read_b64 v[88:89], v88
    ds_read_b64 v[90:91], v90
    v_mfma_f32_16x16x32_bf16 v[112:115], v[84:87], v[236:239], v[112:115]
    v_lshlrev_b32_sdwa v92, 3, v123 dst_sel:DWORD dst_unused:UNUSED_PAD src0_sel:DWORD src1_sel:WORD_0
    v_lshlrev_b32_sdwa v94, 3, v123 dst_sel:DWORD dst_unused:UNUSED_PAD src0_sel:DWORD src1_sel:WORD_1
    ds_read_b64 v[92:93], v92
    ds_read_b64 v[94:95], v94
    buffer_load_dwordx4 v[120:123], v71, s[12:15], s20 offen offset:3072 sc1
    s_waitcnt lgkmcnt(8)
    v_smfmac_f32_16x16x64_bf16 v[48:51], v[66:69], v[96:103], v70
    s_nop 0
    v_cvt_pk_bf16_f32 v112, v112, v113
    v_cvt_pk_bf16_f32 v113, v114, v115
    v_lshlrev_b32_sdwa v114, 3, v70 dst_sel:DWORD dst_unused:UNUSED_PAD src0_sel:DWORD src1_sel:WORD_1
    ds_write_b64 v114, v[112:113] offset:33536
    s_waitcnt vmcnt(2)
    v_lshlrev_b32_sdwa v96, 3, v124 dst_sel:DWORD dst_unused:UNUSED_PAD src0_sel:DWORD src1_sel:WORD_0
    v_lshlrev_b32_sdwa v98, 3, v124 dst_sel:DWORD dst_unused:UNUSED_PAD src0_sel:DWORD src1_sel:WORD_1
    ds_read_b64 v[96:97], v96
    ds_read_b64 v[98:99], v98
    v_lshlrev_b32_sdwa v100, 3, v125 dst_sel:DWORD dst_unused:UNUSED_PAD src0_sel:DWORD src1_sel:WORD_0
    v_lshlrev_b32_sdwa v102, 3, v125 dst_sel:DWORD dst_unused:UNUSED_PAD src0_sel:DWORD src1_sel:WORD_1
    v_cvt_pk_bf16_f32 v51, v50, v51
    v_cvt_pk_bf16_f32 v50, v48, v49
    v_mov_b64 v[46:47], 0
    v_mov_b64 v[48:49], 0
    ds_read_b64 v[100:101], v100
    ds_read_b64 v[102:103], v102
    s_waitcnt lgkmcnt(9)
    v_smfmac_f32_16x16x64_bf16 v[46:49], v[66:69], v[104:111], v70
    v_lshlrev_b32_sdwa v104, 3, v126 dst_sel:DWORD dst_unused:UNUSED_PAD src0_sel:DWORD src1_sel:WORD_0
    v_lshlrev_b32_sdwa v106, 3, v126 dst_sel:DWORD dst_unused:UNUSED_PAD src0_sel:DWORD src1_sel:WORD_1
    ds_read_b64 v[104:105], v104
    ds_read_b64 v[106:107], v106
    v_lshlrev_b32_sdwa v108, 3, v127 dst_sel:DWORD dst_unused:UNUSED_PAD src0_sel:DWORD src1_sel:WORD_0
    v_lshlrev_b32_sdwa v110, 3, v127 dst_sel:DWORD dst_unused:UNUSED_PAD src0_sel:DWORD src1_sel:WORD_1
    ds_read_b64 v[108:109], v108
    ds_read_b64 v[110:111], v110
    s_add_u32 s20, s20, 0x1000
    buffer_load_dwordx4 v[124:127], v71, s[12:15], s20 offen offset:0 sc1
    s_waitcnt lgkmcnt(9)
    v_smfmac_f32_16x16x64_bf16 v[46:49], v[66:69], v[88:95], v70
    s_waitcnt vmcnt(2)
    v_lshlrev_b32_sdwa v88, 3, v116 dst_sel:DWORD dst_unused:UNUSED_PAD src0_sel:DWORD src1_sel:WORD_0
    v_lshlrev_b32_sdwa v90, 3, v116 dst_sel:DWORD dst_unused:UNUSED_PAD src0_sel:DWORD src1_sel:WORD_1
    ds_read_b64 v[88:89], v88
    ds_read_b64 v[90:91], v90
    v_lshlrev_b32_sdwa v92, 3, v117 dst_sel:DWORD dst_unused:UNUSED_PAD src0_sel:DWORD src1_sel:WORD_0
    v_lshlrev_b32_sdwa v94, 3, v117 dst_sel:DWORD dst_unused:UNUSED_PAD src0_sel:DWORD src1_sel:WORD_1
    s_nop 0
    v_cvt_pk_bf16_f32 v49, v48, v49
    v_cvt_pk_bf16_f32 v48, v46, v47
    v_mov_b64 v[44:45], 0
    v_mov_b64 v[46:47], 0
    ds_read_b64 v[92:93], v92
    ds_read_b64 v[94:95], v94
    s_waitcnt lgkmcnt(8)
    v_smfmac_f32_16x16x64_bf16 v[44:47], v[66:69], v[96:103], v70
    v_mfma_f32_16x16x32_bf16 v[112:115], v[72:75], v[240:243], 0
    buffer_load_dwordx4 v[72:75], v71, s[12:15], s21 offen offset:0
    v_lshlrev_b32_sdwa v96, 3, v118 dst_sel:DWORD dst_unused:UNUSED_PAD src0_sel:DWORD src1_sel:WORD_0
    v_lshlrev_b32_sdwa v98, 3, v118 dst_sel:DWORD dst_unused:UNUSED_PAD src0_sel:DWORD src1_sel:WORD_1
    ds_read_b64 v[96:97], v96
    ds_read_b64 v[98:99], v98
    v_mfma_f32_16x16x32_bf16 v[112:115], v[76:79], v[244:247], v[112:115]
    buffer_load_dwordx4 v[76:79], v71, s[12:15], s21 offen offset:1024
    v_lshlrev_b32_sdwa v100, 3, v119 dst_sel:DWORD dst_unused:UNUSED_PAD src0_sel:DWORD src1_sel:WORD_0
    v_lshlrev_b32_sdwa v102, 3, v119 dst_sel:DWORD dst_unused:UNUSED_PAD src0_sel:DWORD src1_sel:WORD_1
    ds_read_b64 v[100:101], v100
    ds_read_b64 v[102:103], v102
    buffer_load_dwordx4 v[116:119], v71, s[12:15], s20 offen offset:1024 sc1
    s_waitcnt lgkmcnt(8)
    v_smfmac_f32_16x16x64_bf16 v[44:47], v[66:69], v[104:111], v70
    v_mfma_f32_16x16x32_bf16 v[112:115], v[80:83], v[248:251], v[112:115]
    buffer_load_dwordx4 v[80:83], v71, s[12:15], s19 offen offset:0
    s_waitcnt vmcnt(5)
    v_lshlrev_b32_sdwa v104, 3, v120 dst_sel:DWORD dst_unused:UNUSED_PAD src0_sel:DWORD src1_sel:WORD_0
    v_lshlrev_b32_sdwa v106, 3, v120 dst_sel:DWORD dst_unused:UNUSED_PAD src0_sel:DWORD src1_sel:WORD_1
    ds_read_b64 v[104:105], v104
    ds_read_b64 v[106:107], v106
    v_mfma_f32_16x16x32_bf16 v[112:115], v[84:87], v[252:255], v[112:115]
    buffer_load_dwordx4 v[84:87], v71, s[12:15], s19 offen offset:1024
    s_add_u32 s21, s21, 4096
    s_add_u32 s19, s19, 4096
    v_lshlrev_b32_sdwa v108, 3, v121 dst_sel:DWORD dst_unused:UNUSED_PAD src0_sel:DWORD src1_sel:WORD_0
    v_lshlrev_b32_sdwa v110, 3, v121 dst_sel:DWORD dst_unused:UNUSED_PAD src0_sel:DWORD src1_sel:WORD_1
    v_cvt_pk_bf16_f32 v47, v46, v47
    v_cvt_pk_bf16_f32 v46, v44, v45
    v_mov_b64 v[42:43], 0
    v_mov_b64 v[44:45], 0
    ds_read_b64 v[108:109], v108
    ds_read_b64 v[110:111], v110
    s_waitcnt lgkmcnt(8)
    v_smfmac_f32_16x16x64_bf16 v[42:45], v[66:69], v[88:95], v70
    v_cvt_pk_bf16_f32 v112, v112, v113
    v_cvt_pk_bf16_f32 v113, v114, v115
    v_lshlrev_b32_sdwa v114, 3, v70 dst_sel:DWORD dst_unused:UNUSED_PAD src0_sel:DWORD src1_sel:WORD_1
    ds_write_b64 v114, v[112:113] offset:33664
    v_lshlrev_b32_sdwa v88, 3, v122 dst_sel:DWORD dst_unused:UNUSED_PAD src0_sel:DWORD src1_sel:WORD_0
    v_lshlrev_b32_sdwa v90, 3, v122 dst_sel:DWORD dst_unused:UNUSED_PAD src0_sel:DWORD src1_sel:WORD_1
    ds_read_b64 v[88:89], v88
    ds_read_b64 v[90:91], v90
    v_lshlrev_b32_sdwa v92, 3, v123 dst_sel:DWORD dst_unused:UNUSED_PAD src0_sel:DWORD src1_sel:WORD_0
    v_lshlrev_b32_sdwa v94, 3, v123 dst_sel:DWORD dst_unused:UNUSED_PAD src0_sel:DWORD src1_sel:WORD_1
    ds_read_b64 v[92:93], v92
    ds_read_b64 v[94:95], v94
    buffer_load_dwordx4 v[120:123], v71, s[12:15], s20 offen offset:2048 sc1
    s_waitcnt lgkmcnt(9)
    v_smfmac_f32_16x16x64_bf16 v[42:45], v[66:69], v[96:103], v70
    s_waitcnt vmcnt(6)
    v_lshlrev_b32_sdwa v96, 3, v124 dst_sel:DWORD dst_unused:UNUSED_PAD src0_sel:DWORD src1_sel:WORD_0
    v_lshlrev_b32_sdwa v98, 3, v124 dst_sel:DWORD dst_unused:UNUSED_PAD src0_sel:DWORD src1_sel:WORD_1
    ds_read_b64 v[96:97], v96
    ds_read_b64 v[98:99], v98
    v_lshlrev_b32_sdwa v100, 3, v125 dst_sel:DWORD dst_unused:UNUSED_PAD src0_sel:DWORD src1_sel:WORD_0
    v_lshlrev_b32_sdwa v102, 3, v125 dst_sel:DWORD dst_unused:UNUSED_PAD src0_sel:DWORD src1_sel:WORD_1
    s_nop 0
    v_cvt_pk_bf16_f32 v45, v44, v45
    v_cvt_pk_bf16_f32 v44, v42, v43
    v_mov_b64 v[40:41], 0
    v_mov_b64 v[42:43], 0
    ds_read_b64 v[100:101], v100
    ds_read_b64 v[102:103], v102
    s_waitcnt lgkmcnt(9)
    v_smfmac_f32_16x16x64_bf16 v[40:43], v[66:69], v[104:111], v70
    s_setprio 1
    v_lshlrev_b32_sdwa v104, 3, v126 dst_sel:DWORD dst_unused:UNUSED_PAD src0_sel:DWORD src1_sel:WORD_0
    v_lshlrev_b32_sdwa v106, 3, v126 dst_sel:DWORD dst_unused:UNUSED_PAD src0_sel:DWORD src1_sel:WORD_1
    ds_read_b64 v[104:105], v104
    ds_read_b64 v[106:107], v106
    v_lshlrev_b32_sdwa v108, 3, v127 dst_sel:DWORD dst_unused:UNUSED_PAD src0_sel:DWORD src1_sel:WORD_0
    v_lshlrev_b32_sdwa v110, 3, v127 dst_sel:DWORD dst_unused:UNUSED_PAD src0_sel:DWORD src1_sel:WORD_1
    ds_read_b64 v[108:109], v108
    ds_read_b64 v[110:111], v110
    buffer_load_dwordx4 v[124:127], v71, s[12:15], s20 offen offset:3072 sc1
    s_waitcnt lgkmcnt(8)
    v_smfmac_f32_16x16x64_bf16 v[40:43], v[66:69], v[88:95], v70
    s_waitcnt vmcnt(4)
    v_lshlrev_b32_sdwa v88, 3, v116 dst_sel:DWORD dst_unused:UNUSED_PAD src0_sel:DWORD src1_sel:WORD_0
    v_lshlrev_b32_sdwa v90, 3, v116 dst_sel:DWORD dst_unused:UNUSED_PAD src0_sel:DWORD src1_sel:WORD_1
    ds_read_b64 v[88:89], v88
    ds_read_b64 v[90:91], v90
    v_lshlrev_b32_sdwa v92, 3, v117 dst_sel:DWORD dst_unused:UNUSED_PAD src0_sel:DWORD src1_sel:WORD_0
    v_lshlrev_b32_sdwa v94, 3, v117 dst_sel:DWORD dst_unused:UNUSED_PAD src0_sel:DWORD src1_sel:WORD_1
    s_nop 0
    v_cvt_pk_bf16_f32 v43, v42, v43
    v_cvt_pk_bf16_f32 v42, v40, v41
    v_mov_b64 v[38:39], 0
    v_mov_b64 v[40:41], 0
    ds_read_b64 v[92:93], v92
    ds_read_b64 v[94:95], v94
    s_waitcnt lgkmcnt(8)
    v_smfmac_f32_16x16x64_bf16 v[38:41], v[66:69], v[96:103], v70
    v_lshlrev_b32_sdwa v96, 3, v118 dst_sel:DWORD dst_unused:UNUSED_PAD src0_sel:DWORD src1_sel:WORD_0
    v_lshlrev_b32_sdwa v98, 3, v118 dst_sel:DWORD dst_unused:UNUSED_PAD src0_sel:DWORD src1_sel:WORD_1
    ds_read_b64 v[96:97], v96
    ds_read_b64 v[98:99], v98
    v_lshlrev_b32_sdwa v100, 3, v119 dst_sel:DWORD dst_unused:UNUSED_PAD src0_sel:DWORD src1_sel:WORD_0
    v_lshlrev_b32_sdwa v102, 3, v119 dst_sel:DWORD dst_unused:UNUSED_PAD src0_sel:DWORD src1_sel:WORD_1
    ds_read_b64 v[100:101], v100
    ds_read_b64 v[102:103], v102
    s_add_u32 s20, s20, 0x20000
    buffer_load_dwordx4 v[116:119], v71, s[12:15], s20 offen offset:3072 sc1
    s_waitcnt lgkmcnt(8)
    v_smfmac_f32_16x16x64_bf16 v[38:41], v[66:69], v[104:111], v70
    s_waitcnt vmcnt(2)
    v_lshlrev_b32_sdwa v104, 3, v120 dst_sel:DWORD dst_unused:UNUSED_PAD src0_sel:DWORD src1_sel:WORD_0
    v_lshlrev_b32_sdwa v106, 3, v120 dst_sel:DWORD dst_unused:UNUSED_PAD src0_sel:DWORD src1_sel:WORD_1
    ds_read_b64 v[104:105], v104
    ds_read_b64 v[106:107], v106
    v_lshlrev_b32_sdwa v108, 3, v121 dst_sel:DWORD dst_unused:UNUSED_PAD src0_sel:DWORD src1_sel:WORD_0
    v_lshlrev_b32_sdwa v110, 3, v121 dst_sel:DWORD dst_unused:UNUSED_PAD src0_sel:DWORD src1_sel:WORD_1
    s_nop 0
    v_cvt_pk_bf16_f32 v41, v40, v41
    v_cvt_pk_bf16_f32 v40, v38, v39
    v_mov_b64 v[36:37], 0
    v_mov_b64 v[38:39], 0
    ds_read_b64 v[108:109], v108
    ds_read_b64 v[110:111], v110
    s_waitcnt lgkmcnt(8)
    v_smfmac_f32_16x16x64_bf16 v[36:39], v[66:69], v[88:95], v70
    v_lshlrev_b32_sdwa v88, 3, v122 dst_sel:DWORD dst_unused:UNUSED_PAD src0_sel:DWORD src1_sel:WORD_0
    v_lshlrev_b32_sdwa v90, 3, v122 dst_sel:DWORD dst_unused:UNUSED_PAD src0_sel:DWORD src1_sel:WORD_1
    ds_read_b64 v[88:89], v88
    ds_read_b64 v[90:91], v90
    v_lshlrev_b32_sdwa v92, 3, v123 dst_sel:DWORD dst_unused:UNUSED_PAD src0_sel:DWORD src1_sel:WORD_0
    v_lshlrev_b32_sdwa v94, 3, v123 dst_sel:DWORD dst_unused:UNUSED_PAD src0_sel:DWORD src1_sel:WORD_1
    ds_read_b64 v[92:93], v92
    ds_read_b64 v[94:95], v94
    buffer_load_dwordx4 v[120:123], v71, s[12:15], s20 offen offset:2048 sc1
    s_waitcnt lgkmcnt(8)
    v_smfmac_f32_16x16x64_bf16 v[36:39], v[66:69], v[96:103], v70
    s_waitcnt vmcnt(2)
    v_lshlrev_b32_sdwa v96, 3, v124 dst_sel:DWORD dst_unused:UNUSED_PAD src0_sel:DWORD src1_sel:WORD_0
    v_lshlrev_b32_sdwa v98, 3, v124 dst_sel:DWORD dst_unused:UNUSED_PAD src0_sel:DWORD src1_sel:WORD_1
    ds_read_b64 v[96:97], v96
    ds_read_b64 v[98:99], v98
    v_lshlrev_b32_sdwa v100, 3, v125 dst_sel:DWORD dst_unused:UNUSED_PAD src0_sel:DWORD src1_sel:WORD_0
    v_lshlrev_b32_sdwa v102, 3, v125 dst_sel:DWORD dst_unused:UNUSED_PAD src0_sel:DWORD src1_sel:WORD_1
    s_nop 0
    v_cvt_pk_bf16_f32 v39, v38, v39
    v_cvt_pk_bf16_f32 v38, v36, v37
    v_mov_b64 v[34:35], 0
    v_mov_b64 v[36:37], 0
    ds_read_b64 v[100:101], v100
    ds_read_b64 v[102:103], v102
    s_waitcnt lgkmcnt(8)
    v_smfmac_f32_16x16x64_bf16 v[34:37], v[66:69], v[104:111], v70
    s_setprio 0
    v_lshlrev_b32_sdwa v104, 3, v126 dst_sel:DWORD dst_unused:UNUSED_PAD src0_sel:DWORD src1_sel:WORD_0
    v_lshlrev_b32_sdwa v106, 3, v126 dst_sel:DWORD dst_unused:UNUSED_PAD src0_sel:DWORD src1_sel:WORD_1
    ds_read_b64 v[104:105], v104
    ds_read_b64 v[106:107], v106
    v_lshlrev_b32_sdwa v108, 3, v127 dst_sel:DWORD dst_unused:UNUSED_PAD src0_sel:DWORD src1_sel:WORD_0
    v_lshlrev_b32_sdwa v110, 3, v127 dst_sel:DWORD dst_unused:UNUSED_PAD src0_sel:DWORD src1_sel:WORD_1
    ds_read_b64 v[108:109], v108
    ds_read_b64 v[110:111], v110
    buffer_load_dwordx4 v[124:127], v71, s[12:15], s20 offen offset:1024 sc1
    s_waitcnt lgkmcnt(8)
    v_smfmac_f32_16x16x64_bf16 v[34:37], v[66:69], v[88:95], v70
    s_waitcnt vmcnt(2)
    v_lshlrev_b32_sdwa v88, 3, v118 dst_sel:DWORD dst_unused:UNUSED_PAD src0_sel:DWORD src1_sel:WORD_0
    v_lshlrev_b32_sdwa v90, 3, v118 dst_sel:DWORD dst_unused:UNUSED_PAD src0_sel:DWORD src1_sel:WORD_1
    ds_read_b64 v[88:89], v88
    ds_read_b64 v[90:91], v90
    v_lshlrev_b32_sdwa v92, 3, v119 dst_sel:DWORD dst_unused:UNUSED_PAD src0_sel:DWORD src1_sel:WORD_0
    v_lshlrev_b32_sdwa v94, 3, v119 dst_sel:DWORD dst_unused:UNUSED_PAD src0_sel:DWORD src1_sel:WORD_1
    s_nop 0
    v_cvt_pk_bf16_f32 v37, v36, v37
    v_cvt_pk_bf16_f32 v36, v34, v35
    v_mov_b64 v[32:33], 0
    v_mov_b64 v[34:35], 0
    ds_read_b64 v[92:93], v92
    ds_read_b64 v[94:95], v94
    s_waitcnt lgkmcnt(8)
    v_smfmac_f32_16x16x64_bf16 v[32:35], v[66:69], v[96:103], v70
    s_barrier
    s_setprio 3
    v_lshlrev_b32_sdwa v96, 3, v116 dst_sel:DWORD dst_unused:UNUSED_PAD src0_sel:DWORD src1_sel:WORD_0
    v_lshlrev_b32_sdwa v98, 3, v116 dst_sel:DWORD dst_unused:UNUSED_PAD src0_sel:DWORD src1_sel:WORD_1
    ds_read_b64 v[96:97], v96
    ds_read_b64 v[98:99], v98
    v_lshlrev_b32_sdwa v100, 3, v117 dst_sel:DWORD dst_unused:UNUSED_PAD src0_sel:DWORD src1_sel:WORD_0
    v_lshlrev_b32_sdwa v102, 3, v117 dst_sel:DWORD dst_unused:UNUSED_PAD src0_sel:DWORD src1_sel:WORD_1
    ds_read_b64 v[100:101], v100
    ds_read_b64 v[102:103], v102
    buffer_load_dwordx4 v[116:119], v71, s[12:15], s20 offen offset:0 sc1
    s_waitcnt lgkmcnt(8)
    v_smfmac_f32_16x16x64_bf16 v[32:35], v[66:69], v[104:111], v70
    v_mfma_f32_16x16x32_bf16 v[112:115], v[72:75], v[128:131], 0
    s_waitcnt vmcnt(2)
    v_lshlrev_b32_sdwa v104, 3, v122 dst_sel:DWORD dst_unused:UNUSED_PAD src0_sel:DWORD src1_sel:WORD_0
    v_lshlrev_b32_sdwa v106, 3, v122 dst_sel:DWORD dst_unused:UNUSED_PAD src0_sel:DWORD src1_sel:WORD_1
    ds_read_b64 v[104:105], v104
    ds_read_b64 v[106:107], v106
    v_mfma_f32_16x16x32_bf16 v[112:115], v[76:79], v[132:135], v[112:115]
    v_add_u32 v70, 0x20000000, v70
    v_lshlrev_b32_sdwa v108, 3, v123 dst_sel:DWORD dst_unused:UNUSED_PAD src0_sel:DWORD src1_sel:WORD_0
    v_lshlrev_b32_sdwa v110, 3, v123 dst_sel:DWORD dst_unused:UNUSED_PAD src0_sel:DWORD src1_sel:WORD_1
    v_cvt_pk_bf16_f32 v35, v34, v35
    v_cvt_pk_bf16_f32 v34, v32, v33
    v_and_b32 v33, s23, v31
    v_lshlrev_b32 v32, 16, v31
    v_and_b32 v31, s23, v30
    v_lshlrev_b32 v30, 16, v30
    ds_read_b64 v[108:109], v108
    ds_read_b64 v[110:111], v110
    s_waitcnt lgkmcnt(8)
    v_smfmac_f32_16x16x64_bf16 v[30:33], v[66:69], v[88:95], v70
    v_mfma_f32_16x16x32_bf16 v[112:115], v[80:83], v[136:139], v[112:115]
    v_lshlrev_b32_sdwa v88, 3, v120 dst_sel:DWORD dst_unused:UNUSED_PAD src0_sel:DWORD src1_sel:WORD_0
    v_lshlrev_b32_sdwa v90, 3, v120 dst_sel:DWORD dst_unused:UNUSED_PAD src0_sel:DWORD src1_sel:WORD_1
    ds_read_b64 v[88:89], v88
    ds_read_b64 v[90:91], v90
    v_mfma_f32_16x16x32_bf16 v[112:115], v[84:87], v[140:143], v[112:115]
    v_lshlrev_b32_sdwa v92, 3, v121 dst_sel:DWORD dst_unused:UNUSED_PAD src0_sel:DWORD src1_sel:WORD_0
    v_lshlrev_b32_sdwa v94, 3, v121 dst_sel:DWORD dst_unused:UNUSED_PAD src0_sel:DWORD src1_sel:WORD_1
    ds_read_b64 v[92:93], v92
    ds_read_b64 v[94:95], v94
    s_add_u32 s20, s20, 0xfffff000
    buffer_load_dwordx4 v[120:123], v71, s[12:15], s20 offen offset:3072 sc1
    s_waitcnt lgkmcnt(8)
    v_smfmac_f32_16x16x64_bf16 v[30:33], v[66:69], v[96:103], v70
    v_cvt_pk_bf16_f32 v112, v112, v113
    v_cvt_pk_bf16_f32 v113, v114, v115
    v_lshlrev_b32_sdwa v114, 3, v70 dst_sel:DWORD dst_unused:UNUSED_PAD src0_sel:DWORD src1_sel:WORD_1
    ds_write_b64 v114, v[112:113] offset:0
    s_waitcnt vmcnt(2)
    v_lshlrev_b32_sdwa v96, 3, v126 dst_sel:DWORD dst_unused:UNUSED_PAD src0_sel:DWORD src1_sel:WORD_0
    v_lshlrev_b32_sdwa v98, 3, v126 dst_sel:DWORD dst_unused:UNUSED_PAD src0_sel:DWORD src1_sel:WORD_1
    ds_read_b64 v[96:97], v96
    ds_read_b64 v[98:99], v98
    v_lshlrev_b32_sdwa v100, 3, v127 dst_sel:DWORD dst_unused:UNUSED_PAD src0_sel:DWORD src1_sel:WORD_0
    v_lshlrev_b32_sdwa v102, 3, v127 dst_sel:DWORD dst_unused:UNUSED_PAD src0_sel:DWORD src1_sel:WORD_1
    v_cvt_pk_bf16_f32 v33, v32, v33
    v_cvt_pk_bf16_f32 v32, v30, v31
    v_and_b32 v31, s23, v29
    v_lshlrev_b32 v30, 16, v29
    v_and_b32 v29, s23, v28
    v_lshlrev_b32 v28, 16, v28
    ds_read_b64 v[100:101], v100
    ds_read_b64 v[102:103], v102
    s_waitcnt lgkmcnt(9)
    v_smfmac_f32_16x16x64_bf16 v[28:31], v[66:69], v[104:111], v70
    v_mfma_f32_16x16x32_bf16 v[112:115], v[72:75], v[144:147], 0
    v_lshlrev_b32_sdwa v104, 3, v124 dst_sel:DWORD dst_unused:UNUSED_PAD src0_sel:DWORD src1_sel:WORD_0
    v_lshlrev_b32_sdwa v106, 3, v124 dst_sel:DWORD dst_unused:UNUSED_PAD src0_sel:DWORD src1_sel:WORD_1
    ds_read_b64 v[104:105], v104
    ds_read_b64 v[106:107], v106
    v_mfma_f32_16x16x32_bf16 v[112:115], v[76:79], v[148:151], v[112:115]
    v_lshlrev_b32_sdwa v108, 3, v125 dst_sel:DWORD dst_unused:UNUSED_PAD src0_sel:DWORD src1_sel:WORD_0
    v_lshlrev_b32_sdwa v110, 3, v125 dst_sel:DWORD dst_unused:UNUSED_PAD src0_sel:DWORD src1_sel:WORD_1
    ds_read_b64 v[108:109], v108
    ds_read_b64 v[110:111], v110
    buffer_load_dwordx4 v[124:127], v71, s[12:15], s20 offen offset:2048 sc1
    s_waitcnt lgkmcnt(9)
    v_smfmac_f32_16x16x64_bf16 v[28:31], v[66:69], v[88:95], v70
    v_mfma_f32_16x16x32_bf16 v[112:115], v[80:83], v[152:155], v[112:115]
    s_waitcnt vmcnt(2)
    v_lshlrev_b32_sdwa v88, 3, v118 dst_sel:DWORD dst_unused:UNUSED_PAD src0_sel:DWORD src1_sel:WORD_0
    v_lshlrev_b32_sdwa v90, 3, v118 dst_sel:DWORD dst_unused:UNUSED_PAD src0_sel:DWORD src1_sel:WORD_1
    ds_read_b64 v[88:89], v88
    ds_read_b64 v[90:91], v90
    v_mfma_f32_16x16x32_bf16 v[112:115], v[84:87], v[156:159], v[112:115]
    v_lshlrev_b32_sdwa v92, 3, v119 dst_sel:DWORD dst_unused:UNUSED_PAD src0_sel:DWORD src1_sel:WORD_0
    v_lshlrev_b32_sdwa v94, 3, v119 dst_sel:DWORD dst_unused:UNUSED_PAD src0_sel:DWORD src1_sel:WORD_1
    v_cvt_pk_bf16_f32 v31, v30, v31
    v_cvt_pk_bf16_f32 v30, v28, v29
    v_and_b32 v29, s23, v27
    v_lshlrev_b32 v28, 16, v27
    v_and_b32 v27, s23, v26
    v_lshlrev_b32 v26, 16, v26
    ds_read_b64 v[92:93], v92
    ds_read_b64 v[94:95], v94
    s_waitcnt lgkmcnt(8)
    v_smfmac_f32_16x16x64_bf16 v[26:29], v[66:69], v[96:103], v70
    v_cvt_pk_bf16_f32 v112, v112, v113
    v_cvt_pk_bf16_f32 v113, v114, v115
    v_lshlrev_b32_sdwa v114, 3, v70 dst_sel:DWORD dst_unused:UNUSED_PAD src0_sel:DWORD src1_sel:WORD_1
    ds_write_b64 v114, v[112:113] offset:128
    v_lshlrev_b32_sdwa v96, 3, v116 dst_sel:DWORD dst_unused:UNUSED_PAD src0_sel:DWORD src1_sel:WORD_0
    v_lshlrev_b32_sdwa v98, 3, v116 dst_sel:DWORD dst_unused:UNUSED_PAD src0_sel:DWORD src1_sel:WORD_1
    ds_read_b64 v[96:97], v96
    ds_read_b64 v[98:99], v98
    v_lshlrev_b32_sdwa v100, 3, v117 dst_sel:DWORD dst_unused:UNUSED_PAD src0_sel:DWORD src1_sel:WORD_0
    v_lshlrev_b32_sdwa v102, 3, v117 dst_sel:DWORD dst_unused:UNUSED_PAD src0_sel:DWORD src1_sel:WORD_1
    ds_read_b64 v[100:101], v100
    ds_read_b64 v[102:103], v102
    buffer_load_dwordx4 v[116:119], v71, s[12:15], s20 offen offset:1024 sc1
    s_waitcnt lgkmcnt(9)
    v_smfmac_f32_16x16x64_bf16 v[26:29], v[66:69], v[104:111], v70
    v_mfma_f32_16x16x32_bf16 v[112:115], v[72:75], v[160:163], 0
    s_waitcnt vmcnt(2)
    v_lshlrev_b32_sdwa v104, 3, v122 dst_sel:DWORD dst_unused:UNUSED_PAD src0_sel:DWORD src1_sel:WORD_0
    v_lshlrev_b32_sdwa v106, 3, v122 dst_sel:DWORD dst_unused:UNUSED_PAD src0_sel:DWORD src1_sel:WORD_1
    ds_read_b64 v[104:105], v104
    ds_read_b64 v[106:107], v106
    v_mfma_f32_16x16x32_bf16 v[112:115], v[76:79], v[164:167], v[112:115]
    v_lshlrev_b32_sdwa v108, 3, v123 dst_sel:DWORD dst_unused:UNUSED_PAD src0_sel:DWORD src1_sel:WORD_0
    v_lshlrev_b32_sdwa v110, 3, v123 dst_sel:DWORD dst_unused:UNUSED_PAD src0_sel:DWORD src1_sel:WORD_1
    v_cvt_pk_bf16_f32 v29, v28, v29
    v_cvt_pk_bf16_f32 v28, v26, v27
    v_and_b32 v27, s23, v25
    v_lshlrev_b32 v26, 16, v25
    v_and_b32 v25, s23, v24
    v_lshlrev_b32 v24, 16, v24
    ds_read_b64 v[108:109], v108
    ds_read_b64 v[110:111], v110
    s_waitcnt lgkmcnt(9)
    v_smfmac_f32_16x16x64_bf16 v[24:27], v[66:69], v[88:95], v70
    v_mfma_f32_16x16x32_bf16 v[112:115], v[80:83], v[168:171], v[112:115]
    v_lshlrev_b32_sdwa v88, 3, v120 dst_sel:DWORD dst_unused:UNUSED_PAD src0_sel:DWORD src1_sel:WORD_0
    v_lshlrev_b32_sdwa v90, 3, v120 dst_sel:DWORD dst_unused:UNUSED_PAD src0_sel:DWORD src1_sel:WORD_1
    ds_read_b64 v[88:89], v88
    ds_read_b64 v[90:91], v90
    v_mfma_f32_16x16x32_bf16 v[112:115], v[84:87], v[172:175], v[112:115]
    v_lshlrev_b32_sdwa v92, 3, v121 dst_sel:DWORD dst_unused:UNUSED_PAD src0_sel:DWORD src1_sel:WORD_0
    v_lshlrev_b32_sdwa v94, 3, v121 dst_sel:DWORD dst_unused:UNUSED_PAD src0_sel:DWORD src1_sel:WORD_1
    ds_read_b64 v[92:93], v92
    ds_read_b64 v[94:95], v94
    buffer_load_dwordx4 v[120:123], v71, s[12:15], s20 offen offset:0 sc1
    s_waitcnt lgkmcnt(8)
    v_smfmac_f32_16x16x64_bf16 v[24:27], v[66:69], v[96:103], v70
    s_nop 0
    v_cvt_pk_bf16_f32 v112, v112, v113
    v_cvt_pk_bf16_f32 v113, v114, v115
    v_lshlrev_b32_sdwa v114, 3, v70 dst_sel:DWORD dst_unused:UNUSED_PAD src0_sel:DWORD src1_sel:WORD_1
    ds_write_b64 v114, v[112:113] offset:256
    s_waitcnt vmcnt(2)
    v_lshlrev_b32_sdwa v96, 3, v126 dst_sel:DWORD dst_unused:UNUSED_PAD src0_sel:DWORD src1_sel:WORD_0
    v_lshlrev_b32_sdwa v98, 3, v126 dst_sel:DWORD dst_unused:UNUSED_PAD src0_sel:DWORD src1_sel:WORD_1
    ds_read_b64 v[96:97], v96
    ds_read_b64 v[98:99], v98
    v_lshlrev_b32_sdwa v100, 3, v127 dst_sel:DWORD dst_unused:UNUSED_PAD src0_sel:DWORD src1_sel:WORD_0
    v_lshlrev_b32_sdwa v102, 3, v127 dst_sel:DWORD dst_unused:UNUSED_PAD src0_sel:DWORD src1_sel:WORD_1
    v_cvt_pk_bf16_f32 v27, v26, v27
    v_cvt_pk_bf16_f32 v26, v24, v25
    v_and_b32 v25, s23, v23
    v_lshlrev_b32 v24, 16, v23
    v_and_b32 v23, s23, v22
    v_lshlrev_b32 v22, 16, v22
    ds_read_b64 v[100:101], v100
    ds_read_b64 v[102:103], v102
    s_waitcnt lgkmcnt(9)
    v_smfmac_f32_16x16x64_bf16 v[22:25], v[66:69], v[104:111], v70
    v_mfma_f32_16x16x32_bf16 v[112:115], v[72:75], v[176:179], 0
    v_lshlrev_b32_sdwa v104, 3, v124 dst_sel:DWORD dst_unused:UNUSED_PAD src0_sel:DWORD src1_sel:WORD_0
    v_lshlrev_b32_sdwa v106, 3, v124 dst_sel:DWORD dst_unused:UNUSED_PAD src0_sel:DWORD src1_sel:WORD_1
    ds_read_b64 v[104:105], v104
    ds_read_b64 v[106:107], v106
    v_mfma_f32_16x16x32_bf16 v[112:115], v[76:79], v[180:183], v[112:115]
    v_lshlrev_b32_sdwa v108, 3, v125 dst_sel:DWORD dst_unused:UNUSED_PAD src0_sel:DWORD src1_sel:WORD_0
    v_lshlrev_b32_sdwa v110, 3, v125 dst_sel:DWORD dst_unused:UNUSED_PAD src0_sel:DWORD src1_sel:WORD_1
    ds_read_b64 v[108:109], v108
    ds_read_b64 v[110:111], v110
    s_add_u32 s20, s20, 0xfffff000
    buffer_load_dwordx4 v[124:127], v71, s[12:15], s20 offen offset:3072 sc1
    s_waitcnt lgkmcnt(9)
    v_smfmac_f32_16x16x64_bf16 v[22:25], v[66:69], v[88:95], v70
    v_mfma_f32_16x16x32_bf16 v[112:115], v[80:83], v[184:187], v[112:115]
    s_waitcnt vmcnt(2)
    v_lshlrev_b32_sdwa v88, 3, v118 dst_sel:DWORD dst_unused:UNUSED_PAD src0_sel:DWORD src1_sel:WORD_0
    v_lshlrev_b32_sdwa v90, 3, v118 dst_sel:DWORD dst_unused:UNUSED_PAD src0_sel:DWORD src1_sel:WORD_1
    ds_read_b64 v[88:89], v88
    ds_read_b64 v[90:91], v90
    v_mfma_f32_16x16x32_bf16 v[112:115], v[84:87], v[188:191], v[112:115]
    v_lshlrev_b32_sdwa v92, 3, v119 dst_sel:DWORD dst_unused:UNUSED_PAD src0_sel:DWORD src1_sel:WORD_0
    v_lshlrev_b32_sdwa v94, 3, v119 dst_sel:DWORD dst_unused:UNUSED_PAD src0_sel:DWORD src1_sel:WORD_1
    v_cvt_pk_bf16_f32 v25, v24, v25
    v_cvt_pk_bf16_f32 v24, v22, v23
    v_and_b32 v23, s23, v21
    v_lshlrev_b32 v22, 16, v21
    v_and_b32 v21, s23, v20
    v_lshlrev_b32 v20, 16, v20
    ds_read_b64 v[92:93], v92
    ds_read_b64 v[94:95], v94
    s_waitcnt lgkmcnt(8)
    v_smfmac_f32_16x16x64_bf16 v[20:23], v[66:69], v[96:103], v70
    v_cvt_pk_bf16_f32 v112, v112, v113
    v_cvt_pk_bf16_f32 v113, v114, v115
    v_lshlrev_b32_sdwa v114, 3, v70 dst_sel:DWORD dst_unused:UNUSED_PAD src0_sel:DWORD src1_sel:WORD_1
    ds_write_b64 v114, v[112:113] offset:384
    v_lshlrev_b32_sdwa v96, 3, v116 dst_sel:DWORD dst_unused:UNUSED_PAD src0_sel:DWORD src1_sel:WORD_0
    v_lshlrev_b32_sdwa v98, 3, v116 dst_sel:DWORD dst_unused:UNUSED_PAD src0_sel:DWORD src1_sel:WORD_1
    ds_read_b64 v[96:97], v96
    ds_read_b64 v[98:99], v98
    v_lshlrev_b32_sdwa v100, 3, v117 dst_sel:DWORD dst_unused:UNUSED_PAD src0_sel:DWORD src1_sel:WORD_0
    v_lshlrev_b32_sdwa v102, 3, v117 dst_sel:DWORD dst_unused:UNUSED_PAD src0_sel:DWORD src1_sel:WORD_1
    ds_read_b64 v[100:101], v100
    ds_read_b64 v[102:103], v102
    buffer_load_dwordx4 v[116:119], v71, s[12:15], s20 offen offset:2048 sc1
    s_waitcnt lgkmcnt(9)
    v_smfmac_f32_16x16x64_bf16 v[20:23], v[66:69], v[104:111], v70
    v_mfma_f32_16x16x32_bf16 v[112:115], v[72:75], v[192:195], 0
    s_waitcnt vmcnt(2)
    v_lshlrev_b32_sdwa v104, 3, v122 dst_sel:DWORD dst_unused:UNUSED_PAD src0_sel:DWORD src1_sel:WORD_0
    v_lshlrev_b32_sdwa v106, 3, v122 dst_sel:DWORD dst_unused:UNUSED_PAD src0_sel:DWORD src1_sel:WORD_1
    ds_read_b64 v[104:105], v104
    ds_read_b64 v[106:107], v106
    v_mfma_f32_16x16x32_bf16 v[112:115], v[76:79], v[196:199], v[112:115]
    v_lshlrev_b32_sdwa v108, 3, v123 dst_sel:DWORD dst_unused:UNUSED_PAD src0_sel:DWORD src1_sel:WORD_0
    v_lshlrev_b32_sdwa v110, 3, v123 dst_sel:DWORD dst_unused:UNUSED_PAD src0_sel:DWORD src1_sel:WORD_1
    v_cvt_pk_bf16_f32 v23, v22, v23
    v_cvt_pk_bf16_f32 v22, v20, v21
    v_and_b32 v21, s23, v19
    v_lshlrev_b32 v20, 16, v19
    v_and_b32 v19, s23, v18
    v_lshlrev_b32 v18, 16, v18
    ds_read_b64 v[108:109], v108
    ds_read_b64 v[110:111], v110
    s_waitcnt lgkmcnt(9)
    v_smfmac_f32_16x16x64_bf16 v[18:21], v[66:69], v[88:95], v70
    v_mfma_f32_16x16x32_bf16 v[112:115], v[80:83], v[200:203], v[112:115]
    v_lshlrev_b32_sdwa v88, 3, v120 dst_sel:DWORD dst_unused:UNUSED_PAD src0_sel:DWORD src1_sel:WORD_0
    v_lshlrev_b32_sdwa v90, 3, v120 dst_sel:DWORD dst_unused:UNUSED_PAD src0_sel:DWORD src1_sel:WORD_1
    ds_read_b64 v[88:89], v88
    ds_read_b64 v[90:91], v90
    v_mfma_f32_16x16x32_bf16 v[112:115], v[84:87], v[204:207], v[112:115]
    v_lshlrev_b32_sdwa v92, 3, v121 dst_sel:DWORD dst_unused:UNUSED_PAD src0_sel:DWORD src1_sel:WORD_0
    v_lshlrev_b32_sdwa v94, 3, v121 dst_sel:DWORD dst_unused:UNUSED_PAD src0_sel:DWORD src1_sel:WORD_1
    ds_read_b64 v[92:93], v92
    ds_read_b64 v[94:95], v94
    buffer_load_dwordx4 v[120:123], v71, s[12:15], s20 offen offset:1024 sc1
    s_waitcnt lgkmcnt(8)
    v_smfmac_f32_16x16x64_bf16 v[18:21], v[66:69], v[96:103], v70
    s_nop 0
    v_cvt_pk_bf16_f32 v112, v112, v113
    v_cvt_pk_bf16_f32 v113, v114, v115
    v_lshlrev_b32_sdwa v114, 3, v70 dst_sel:DWORD dst_unused:UNUSED_PAD src0_sel:DWORD src1_sel:WORD_1
    ds_write_b64 v114, v[112:113] offset:512
    s_waitcnt vmcnt(2)
    v_lshlrev_b32_sdwa v96, 3, v126 dst_sel:DWORD dst_unused:UNUSED_PAD src0_sel:DWORD src1_sel:WORD_0
    v_lshlrev_b32_sdwa v98, 3, v126 dst_sel:DWORD dst_unused:UNUSED_PAD src0_sel:DWORD src1_sel:WORD_1
    ds_read_b64 v[96:97], v96
    ds_read_b64 v[98:99], v98
    v_lshlrev_b32_sdwa v100, 3, v127 dst_sel:DWORD dst_unused:UNUSED_PAD src0_sel:DWORD src1_sel:WORD_0
    v_lshlrev_b32_sdwa v102, 3, v127 dst_sel:DWORD dst_unused:UNUSED_PAD src0_sel:DWORD src1_sel:WORD_1
    v_cvt_pk_bf16_f32 v21, v20, v21
    v_cvt_pk_bf16_f32 v20, v18, v19
    v_and_b32 v19, s23, v17
    v_lshlrev_b32 v18, 16, v17
    v_and_b32 v17, s23, v16
    v_lshlrev_b32 v16, 16, v16
    ds_read_b64 v[100:101], v100
    ds_read_b64 v[102:103], v102
    s_waitcnt lgkmcnt(9)
    v_smfmac_f32_16x16x64_bf16 v[16:19], v[66:69], v[104:111], v70
    s_setprio 2
    v_mfma_f32_16x16x32_bf16 v[112:115], v[72:75], v[208:211], 0
    v_lshlrev_b32_sdwa v104, 3, v124 dst_sel:DWORD dst_unused:UNUSED_PAD src0_sel:DWORD src1_sel:WORD_0
    v_lshlrev_b32_sdwa v106, 3, v124 dst_sel:DWORD dst_unused:UNUSED_PAD src0_sel:DWORD src1_sel:WORD_1
    ds_read_b64 v[104:105], v104
    ds_read_b64 v[106:107], v106
    v_mfma_f32_16x16x32_bf16 v[112:115], v[76:79], v[212:215], v[112:115]
    v_lshlrev_b32_sdwa v108, 3, v125 dst_sel:DWORD dst_unused:UNUSED_PAD src0_sel:DWORD src1_sel:WORD_0
    v_lshlrev_b32_sdwa v110, 3, v125 dst_sel:DWORD dst_unused:UNUSED_PAD src0_sel:DWORD src1_sel:WORD_1
    ds_read_b64 v[108:109], v108
    ds_read_b64 v[110:111], v110
    buffer_load_dwordx4 v[124:127], v71, s[12:15], s20 offen offset:0 sc1
    s_waitcnt lgkmcnt(9)
    v_smfmac_f32_16x16x64_bf16 v[16:19], v[66:69], v[88:95], v70
    v_mfma_f32_16x16x32_bf16 v[112:115], v[80:83], v[216:219], v[112:115]
    s_waitcnt vmcnt(2)
    v_lshlrev_b32_sdwa v88, 3, v118 dst_sel:DWORD dst_unused:UNUSED_PAD src0_sel:DWORD src1_sel:WORD_0
    v_lshlrev_b32_sdwa v90, 3, v118 dst_sel:DWORD dst_unused:UNUSED_PAD src0_sel:DWORD src1_sel:WORD_1
    ds_read_b64 v[88:89], v88
    ds_read_b64 v[90:91], v90
    v_mfma_f32_16x16x32_bf16 v[112:115], v[84:87], v[220:223], v[112:115]
    v_lshlrev_b32_sdwa v92, 3, v119 dst_sel:DWORD dst_unused:UNUSED_PAD src0_sel:DWORD src1_sel:WORD_0
    v_lshlrev_b32_sdwa v94, 3, v119 dst_sel:DWORD dst_unused:UNUSED_PAD src0_sel:DWORD src1_sel:WORD_1
    v_cvt_pk_bf16_f32 v19, v18, v19
    v_cvt_pk_bf16_f32 v18, v16, v17
    v_and_b32 v17, s23, v15
    v_lshlrev_b32 v16, 16, v15
    v_and_b32 v15, s23, v14
    v_lshlrev_b32 v14, 16, v14
    ds_read_b64 v[92:93], v92
    ds_read_b64 v[94:95], v94
    s_waitcnt lgkmcnt(8)
    v_smfmac_f32_16x16x64_bf16 v[14:17], v[66:69], v[96:103], v70
    v_cvt_pk_bf16_f32 v112, v112, v113
    v_cvt_pk_bf16_f32 v113, v114, v115
    v_lshlrev_b32_sdwa v114, 3, v70 dst_sel:DWORD dst_unused:UNUSED_PAD src0_sel:DWORD src1_sel:WORD_1
    ds_write_b64 v114, v[112:113] offset:640
    v_lshlrev_b32_sdwa v96, 3, v116 dst_sel:DWORD dst_unused:UNUSED_PAD src0_sel:DWORD src1_sel:WORD_0
    v_lshlrev_b32_sdwa v98, 3, v116 dst_sel:DWORD dst_unused:UNUSED_PAD src0_sel:DWORD src1_sel:WORD_1
    ds_read_b64 v[96:97], v96
    ds_read_b64 v[98:99], v98
    v_lshlrev_b32_sdwa v100, 3, v117 dst_sel:DWORD dst_unused:UNUSED_PAD src0_sel:DWORD src1_sel:WORD_0
    v_lshlrev_b32_sdwa v102, 3, v117 dst_sel:DWORD dst_unused:UNUSED_PAD src0_sel:DWORD src1_sel:WORD_1
    ds_read_b64 v[100:101], v100
    ds_read_b64 v[102:103], v102
    s_add_u32 s20, s20, 0xfffff000
    buffer_load_dwordx4 v[116:119], v71, s[12:15], s20 offen offset:3072 sc1
    s_waitcnt lgkmcnt(9)
    v_smfmac_f32_16x16x64_bf16 v[14:17], v[66:69], v[104:111], v70
    v_mfma_f32_16x16x32_bf16 v[112:115], v[72:75], v[224:227], 0
    s_waitcnt vmcnt(2)
    v_lshlrev_b32_sdwa v104, 3, v122 dst_sel:DWORD dst_unused:UNUSED_PAD src0_sel:DWORD src1_sel:WORD_0
    v_lshlrev_b32_sdwa v106, 3, v122 dst_sel:DWORD dst_unused:UNUSED_PAD src0_sel:DWORD src1_sel:WORD_1
    ds_read_b64 v[104:105], v104
    ds_read_b64 v[106:107], v106
    v_mfma_f32_16x16x32_bf16 v[112:115], v[76:79], v[228:231], v[112:115]
    v_lshlrev_b32_sdwa v108, 3, v123 dst_sel:DWORD dst_unused:UNUSED_PAD src0_sel:DWORD src1_sel:WORD_0
    v_lshlrev_b32_sdwa v110, 3, v123 dst_sel:DWORD dst_unused:UNUSED_PAD src0_sel:DWORD src1_sel:WORD_1
    v_cvt_pk_bf16_f32 v17, v16, v17
    v_cvt_pk_bf16_f32 v16, v14, v15
    v_and_b32 v15, s23, v13
    v_lshlrev_b32 v14, 16, v13
    v_and_b32 v13, s23, v12
    v_lshlrev_b32 v12, 16, v12
    ds_read_b64 v[108:109], v108
    ds_read_b64 v[110:111], v110
    s_waitcnt lgkmcnt(9)
    v_smfmac_f32_16x16x64_bf16 v[12:15], v[66:69], v[88:95], v70
    v_mfma_f32_16x16x32_bf16 v[112:115], v[80:83], v[232:235], v[112:115]
    v_lshlrev_b32_sdwa v88, 3, v120 dst_sel:DWORD dst_unused:UNUSED_PAD src0_sel:DWORD src1_sel:WORD_0
    v_lshlrev_b32_sdwa v90, 3, v120 dst_sel:DWORD dst_unused:UNUSED_PAD src0_sel:DWORD src1_sel:WORD_1
    ds_read_b64 v[88:89], v88
    ds_read_b64 v[90:91], v90
    v_mfma_f32_16x16x32_bf16 v[112:115], v[84:87], v[236:239], v[112:115]
    v_lshlrev_b32_sdwa v92, 3, v121 dst_sel:DWORD dst_unused:UNUSED_PAD src0_sel:DWORD src1_sel:WORD_0
    v_lshlrev_b32_sdwa v94, 3, v121 dst_sel:DWORD dst_unused:UNUSED_PAD src0_sel:DWORD src1_sel:WORD_1
    ds_read_b64 v[92:93], v92
    ds_read_b64 v[94:95], v94
    buffer_load_dwordx4 v[120:123], v71, s[12:15], s20 offen offset:2048 sc1
    s_waitcnt lgkmcnt(8)
    v_smfmac_f32_16x16x64_bf16 v[12:15], v[66:69], v[96:103], v70
    s_nop 0
    v_cvt_pk_bf16_f32 v112, v112, v113
    v_cvt_pk_bf16_f32 v113, v114, v115
    v_lshlrev_b32_sdwa v114, 3, v70 dst_sel:DWORD dst_unused:UNUSED_PAD src0_sel:DWORD src1_sel:WORD_1
    ds_write_b64 v114, v[112:113] offset:768
    s_waitcnt vmcnt(2)
    v_lshlrev_b32_sdwa v96, 3, v126 dst_sel:DWORD dst_unused:UNUSED_PAD src0_sel:DWORD src1_sel:WORD_0
    v_lshlrev_b32_sdwa v98, 3, v126 dst_sel:DWORD dst_unused:UNUSED_PAD src0_sel:DWORD src1_sel:WORD_1
    ds_read_b64 v[96:97], v96
    ds_read_b64 v[98:99], v98
    v_lshlrev_b32_sdwa v100, 3, v127 dst_sel:DWORD dst_unused:UNUSED_PAD src0_sel:DWORD src1_sel:WORD_0
    v_lshlrev_b32_sdwa v102, 3, v127 dst_sel:DWORD dst_unused:UNUSED_PAD src0_sel:DWORD src1_sel:WORD_1
    v_cvt_pk_bf16_f32 v15, v14, v15
    v_cvt_pk_bf16_f32 v14, v12, v13
    v_and_b32 v13, s23, v11
    v_lshlrev_b32 v12, 16, v11
    v_and_b32 v11, s23, v10
    v_lshlrev_b32 v10, 16, v10
    ds_read_b64 v[100:101], v100
    ds_read_b64 v[102:103], v102
    s_waitcnt lgkmcnt(9)
    v_smfmac_f32_16x16x64_bf16 v[10:13], v[66:69], v[104:111], v70
    v_mfma_f32_16x16x32_bf16 v[112:115], v[72:75], v[240:243], 0
    buffer_load_dwordx4 v[72:75], v71, s[12:15], s21 offen offset:0
    v_lshlrev_b32_sdwa v104, 3, v124 dst_sel:DWORD dst_unused:UNUSED_PAD src0_sel:DWORD src1_sel:WORD_0
    v_lshlrev_b32_sdwa v106, 3, v124 dst_sel:DWORD dst_unused:UNUSED_PAD src0_sel:DWORD src1_sel:WORD_1
    ds_read_b64 v[104:105], v104
    ds_read_b64 v[106:107], v106
    v_mfma_f32_16x16x32_bf16 v[112:115], v[76:79], v[244:247], v[112:115]
    buffer_load_dwordx4 v[76:79], v71, s[12:15], s21 offen offset:1024
    v_lshlrev_b32_sdwa v108, 3, v125 dst_sel:DWORD dst_unused:UNUSED_PAD src0_sel:DWORD src1_sel:WORD_0
    v_lshlrev_b32_sdwa v110, 3, v125 dst_sel:DWORD dst_unused:UNUSED_PAD src0_sel:DWORD src1_sel:WORD_1
    ds_read_b64 v[108:109], v108
    ds_read_b64 v[110:111], v110
    buffer_load_dwordx4 v[124:127], v71, s[12:15], s20 offen offset:1024 sc1
    s_waitcnt lgkmcnt(9)
    v_smfmac_f32_16x16x64_bf16 v[10:13], v[66:69], v[88:95], v70
    v_mfma_f32_16x16x32_bf16 v[112:115], v[80:83], v[248:251], v[112:115]
    buffer_load_dwordx4 v[80:83], v71, s[12:15], s19 offen offset:0
    s_waitcnt vmcnt(5)
    v_lshlrev_b32_sdwa v88, 3, v118 dst_sel:DWORD dst_unused:UNUSED_PAD src0_sel:DWORD src1_sel:WORD_0
    v_lshlrev_b32_sdwa v90, 3, v118 dst_sel:DWORD dst_unused:UNUSED_PAD src0_sel:DWORD src1_sel:WORD_1
    ds_read_b64 v[88:89], v88
    ds_read_b64 v[90:91], v90
    v_mfma_f32_16x16x32_bf16 v[112:115], v[84:87], v[252:255], v[112:115]
    buffer_load_dwordx4 v[84:87], v71, s[12:15], s19 offen offset:1024
    s_add_u32 s21, s21, 4096
    s_add_u32 s19, s19, 4096
    v_lshlrev_b32_sdwa v92, 3, v119 dst_sel:DWORD dst_unused:UNUSED_PAD src0_sel:DWORD src1_sel:WORD_0
    v_lshlrev_b32_sdwa v94, 3, v119 dst_sel:DWORD dst_unused:UNUSED_PAD src0_sel:DWORD src1_sel:WORD_1
    v_cvt_pk_bf16_f32 v13, v12, v13
    v_cvt_pk_bf16_f32 v12, v10, v11
    v_and_b32 v11, s23, v9
    v_lshlrev_b32 v10, 16, v9
    v_and_b32 v9, s23, v8
    v_lshlrev_b32 v8, 16, v8
    ds_read_b64 v[92:93], v92
    ds_read_b64 v[94:95], v94
    s_waitcnt lgkmcnt(8)
    v_smfmac_f32_16x16x64_bf16 v[8:11], v[66:69], v[96:103], v70
    v_cvt_pk_bf16_f32 v112, v112, v113
    v_cvt_pk_bf16_f32 v113, v114, v115
    v_lshlrev_b32_sdwa v114, 3, v70 dst_sel:DWORD dst_unused:UNUSED_PAD src0_sel:DWORD src1_sel:WORD_1
    ds_write_b64 v114, v[112:113] offset:896
    s_setprio 1
    v_lshlrev_b32_sdwa v96, 3, v116 dst_sel:DWORD dst_unused:UNUSED_PAD src0_sel:DWORD src1_sel:WORD_0
    v_lshlrev_b32_sdwa v98, 3, v116 dst_sel:DWORD dst_unused:UNUSED_PAD src0_sel:DWORD src1_sel:WORD_1
    ds_read_b64 v[96:97], v96
    ds_read_b64 v[98:99], v98
    v_lshlrev_b32_sdwa v100, 3, v117 dst_sel:DWORD dst_unused:UNUSED_PAD src0_sel:DWORD src1_sel:WORD_0
    v_lshlrev_b32_sdwa v102, 3, v117 dst_sel:DWORD dst_unused:UNUSED_PAD src0_sel:DWORD src1_sel:WORD_1
    ds_read_b64 v[100:101], v100
    ds_read_b64 v[102:103], v102
    buffer_load_dwordx4 v[116:119], v71, s[12:15], s20 offen offset:0 sc1
    s_waitcnt lgkmcnt(9)
    v_smfmac_f32_16x16x64_bf16 v[8:11], v[66:69], v[104:111], v70
    s_waitcnt vmcnt(6)
    v_lshlrev_b32_sdwa v104, 3, v122 dst_sel:DWORD dst_unused:UNUSED_PAD src0_sel:DWORD src1_sel:WORD_0
    v_lshlrev_b32_sdwa v106, 3, v122 dst_sel:DWORD dst_unused:UNUSED_PAD src0_sel:DWORD src1_sel:WORD_1
    ds_read_b64 v[104:105], v104
    ds_read_b64 v[106:107], v106
    v_lshlrev_b32_sdwa v108, 3, v123 dst_sel:DWORD dst_unused:UNUSED_PAD src0_sel:DWORD src1_sel:WORD_0
    v_lshlrev_b32_sdwa v110, 3, v123 dst_sel:DWORD dst_unused:UNUSED_PAD src0_sel:DWORD src1_sel:WORD_1
    s_nop 0
    v_cvt_pk_bf16_f32 v11, v10, v11
    v_cvt_pk_bf16_f32 v10, v8, v9
    v_and_b32 v9, s23, v7
    v_lshlrev_b32 v8, 16, v7
    v_and_b32 v7, s23, v6
    v_lshlrev_b32 v6, 16, v6
    ds_read_b64 v[108:109], v108
    ds_read_b64 v[110:111], v110
    s_waitcnt lgkmcnt(9)
    v_smfmac_f32_16x16x64_bf16 v[6:9], v[66:69], v[88:95], v70
    v_lshlrev_b32_sdwa v88, 3, v120 dst_sel:DWORD dst_unused:UNUSED_PAD src0_sel:DWORD src1_sel:WORD_0
    v_lshlrev_b32_sdwa v90, 3, v120 dst_sel:DWORD dst_unused:UNUSED_PAD src0_sel:DWORD src1_sel:WORD_1
    ds_read_b64 v[88:89], v88
    ds_read_b64 v[90:91], v90
    v_lshlrev_b32_sdwa v92, 3, v121 dst_sel:DWORD dst_unused:UNUSED_PAD src0_sel:DWORD src1_sel:WORD_0
    v_lshlrev_b32_sdwa v94, 3, v121 dst_sel:DWORD dst_unused:UNUSED_PAD src0_sel:DWORD src1_sel:WORD_1
    ds_read_b64 v[92:93], v92
    ds_read_b64 v[94:95], v94
    s_add_u32 s20, s20, 0x23000
    buffer_load_dwordx4 v[120:123], v71, s[12:15], s20 offen offset:3072 sc1
    s_waitcnt lgkmcnt(8)
    v_smfmac_f32_16x16x64_bf16 v[6:9], v[66:69], v[96:103], v70
    s_waitcnt vmcnt(4)
    v_lshlrev_b32_sdwa v96, 3, v126 dst_sel:DWORD dst_unused:UNUSED_PAD src0_sel:DWORD src1_sel:WORD_0
    v_lshlrev_b32_sdwa v98, 3, v126 dst_sel:DWORD dst_unused:UNUSED_PAD src0_sel:DWORD src1_sel:WORD_1
    ds_read_b64 v[96:97], v96
    ds_read_b64 v[98:99], v98
    v_lshlrev_b32_sdwa v100, 3, v127 dst_sel:DWORD dst_unused:UNUSED_PAD src0_sel:DWORD src1_sel:WORD_0
    v_lshlrev_b32_sdwa v102, 3, v127 dst_sel:DWORD dst_unused:UNUSED_PAD src0_sel:DWORD src1_sel:WORD_1
    s_nop 0
    v_cvt_pk_bf16_f32 v9, v8, v9
    v_cvt_pk_bf16_f32 v8, v6, v7
    v_and_b32 v7, s23, v5
    v_lshlrev_b32 v6, 16, v5
    v_and_b32 v5, s23, v4
    v_lshlrev_b32 v4, 16, v4
    ds_read_b64 v[100:101], v100
    ds_read_b64 v[102:103], v102
    s_waitcnt lgkmcnt(8)
    v_smfmac_f32_16x16x64_bf16 v[4:7], v[66:69], v[104:111], v70
    v_lshlrev_b32_sdwa v104, 3, v124 dst_sel:DWORD dst_unused:UNUSED_PAD src0_sel:DWORD src1_sel:WORD_0
    v_lshlrev_b32_sdwa v106, 3, v124 dst_sel:DWORD dst_unused:UNUSED_PAD src0_sel:DWORD src1_sel:WORD_1
    ds_read_b64 v[104:105], v104
    ds_read_b64 v[106:107], v106
    v_lshlrev_b32_sdwa v108, 3, v125 dst_sel:DWORD dst_unused:UNUSED_PAD src0_sel:DWORD src1_sel:WORD_0
    v_lshlrev_b32_sdwa v110, 3, v125 dst_sel:DWORD dst_unused:UNUSED_PAD src0_sel:DWORD src1_sel:WORD_1
    ds_read_b64 v[108:109], v108
    ds_read_b64 v[110:111], v110
    buffer_load_dwordx4 v[124:127], v71, s[12:15], s20 offen offset:2048 sc1
    s_waitcnt lgkmcnt(8)
    v_smfmac_f32_16x16x64_bf16 v[4:7], v[66:69], v[88:95], v70
    s_waitcnt vmcnt(2)
    v_lshlrev_b32_sdwa v88, 3, v118 dst_sel:DWORD dst_unused:UNUSED_PAD src0_sel:DWORD src1_sel:WORD_0
    v_lshlrev_b32_sdwa v90, 3, v118 dst_sel:DWORD dst_unused:UNUSED_PAD src0_sel:DWORD src1_sel:WORD_1
    ds_read_b64 v[88:89], v88
    ds_read_b64 v[90:91], v90
    v_lshlrev_b32_sdwa v92, 3, v119 dst_sel:DWORD dst_unused:UNUSED_PAD src0_sel:DWORD src1_sel:WORD_0
    v_lshlrev_b32_sdwa v94, 3, v119 dst_sel:DWORD dst_unused:UNUSED_PAD src0_sel:DWORD src1_sel:WORD_1
    s_nop 0
    v_cvt_pk_bf16_f32 v7, v6, v7
    v_cvt_pk_bf16_f32 v6, v4, v5
    v_and_b32 v5, s23, v3
    v_lshlrev_b32 v4, 16, v3
    v_and_b32 v3, s23, v2
    v_lshlrev_b32 v2, 16, v2
    ds_read_b64 v[92:93], v92
    ds_read_b64 v[94:95], v94
    s_waitcnt lgkmcnt(8)
    v_smfmac_f32_16x16x64_bf16 v[2:5], v[66:69], v[96:103], v70
    s_setprio 0
    v_lshlrev_b32_sdwa v96, 3, v116 dst_sel:DWORD dst_unused:UNUSED_PAD src0_sel:DWORD src1_sel:WORD_0
    v_lshlrev_b32_sdwa v98, 3, v116 dst_sel:DWORD dst_unused:UNUSED_PAD src0_sel:DWORD src1_sel:WORD_1
    ds_read_b64 v[96:97], v96
    ds_read_b64 v[98:99], v98
    v_lshlrev_b32_sdwa v100, 3, v117 dst_sel:DWORD dst_unused:UNUSED_PAD src0_sel:DWORD src1_sel:WORD_0
    v_lshlrev_b32_sdwa v102, 3, v117 dst_sel:DWORD dst_unused:UNUSED_PAD src0_sel:DWORD src1_sel:WORD_1
    ds_read_b64 v[100:101], v100
    ds_read_b64 v[102:103], v102
    buffer_load_dwordx4 v[116:119], v71, s[12:15], s20 offen offset:1024 sc1
    s_waitcnt lgkmcnt(8)
    v_smfmac_f32_16x16x64_bf16 v[2:5], v[66:69], v[104:111], v70
    s_waitcnt vmcnt(2)
    v_lshlrev_b32_sdwa v104, 3, v120 dst_sel:DWORD dst_unused:UNUSED_PAD src0_sel:DWORD src1_sel:WORD_0
    v_lshlrev_b32_sdwa v106, 3, v120 dst_sel:DWORD dst_unused:UNUSED_PAD src0_sel:DWORD src1_sel:WORD_1
    ds_read_b64 v[104:105], v104
    ds_read_b64 v[106:107], v106
    v_lshlrev_b32_sdwa v108, 3, v121 dst_sel:DWORD dst_unused:UNUSED_PAD src0_sel:DWORD src1_sel:WORD_0
    v_lshlrev_b32_sdwa v110, 3, v121 dst_sel:DWORD dst_unused:UNUSED_PAD src0_sel:DWORD src1_sel:WORD_1
    s_nop 0
    v_cvt_pk_bf16_f32 v5, v4, v5
    v_cvt_pk_bf16_f32 v4, v2, v3
    v_and_b32 v3, s23, v1
    v_lshlrev_b32 v2, 16, v1
    v_and_b32 v1, s23, v0
    v_lshlrev_b32 v0, 16, v0
    ds_read_b64 v[108:109], v108
    ds_read_b64 v[110:111], v110
    s_waitcnt lgkmcnt(8)
    v_smfmac_f32_16x16x64_bf16 v[0:3], v[66:69], v[88:95], v70
    s_barrier
    s_setprio 3
    v_lshlrev_b32_sdwa v88, 3, v122 dst_sel:DWORD dst_unused:UNUSED_PAD src0_sel:DWORD src1_sel:WORD_0
    v_lshlrev_b32_sdwa v90, 3, v122 dst_sel:DWORD dst_unused:UNUSED_PAD src0_sel:DWORD src1_sel:WORD_1
    ds_read_b64 v[88:89], v88
    ds_read_b64 v[90:91], v90
    v_lshlrev_b32_sdwa v92, 3, v123 dst_sel:DWORD dst_unused:UNUSED_PAD src0_sel:DWORD src1_sel:WORD_0
    v_lshlrev_b32_sdwa v94, 3, v123 dst_sel:DWORD dst_unused:UNUSED_PAD src0_sel:DWORD src1_sel:WORD_1
    ds_read_b64 v[92:93], v92
    ds_read_b64 v[94:95], v94
    buffer_load_dwordx4 v[120:123], v71, s[12:15], s20 offen offset:0 sc1
    s_waitcnt lgkmcnt(8)
    v_smfmac_f32_16x16x64_bf16 v[0:3], v[66:69], v[96:103], v70
    v_mfma_f32_16x16x32_bf16 v[112:115], v[72:75], v[128:131], 0
    s_waitcnt vmcnt(2)
    v_lshlrev_b32_sdwa v96, 3, v124 dst_sel:DWORD dst_unused:UNUSED_PAD src0_sel:DWORD src1_sel:WORD_0
    v_lshlrev_b32_sdwa v98, 3, v124 dst_sel:DWORD dst_unused:UNUSED_PAD src0_sel:DWORD src1_sel:WORD_1
    ds_read_b64 v[96:97], v96
    ds_read_b64 v[98:99], v98
    v_mfma_f32_16x16x32_bf16 v[112:115], v[76:79], v[132:135], v[112:115]
    v_add_u32 v70, 0xc0000000, v70
    v_lshlrev_b32_sdwa v100, 3, v125 dst_sel:DWORD dst_unused:UNUSED_PAD src0_sel:DWORD src1_sel:WORD_0
    v_lshlrev_b32_sdwa v102, 3, v125 dst_sel:DWORD dst_unused:UNUSED_PAD src0_sel:DWORD src1_sel:WORD_1
    v_cvt_pk_bf16_f32 v3, v2, v3
    v_cvt_pk_bf16_f32 v2, v0, v1
    v_mov_b64 v[0:1], v[32:33]
    v_lshlrev_b32 v32, 16, v34
    v_and_b32 v33, s23, v34
    v_lshlrev_b32 v34, 16, v35
    v_and_b32 v35, s23, v35
    ds_read_b64 v[100:101], v100
    ds_read_b64 v[102:103], v102
    s_waitcnt lgkmcnt(8)
    v_smfmac_f32_16x16x64_bf16 v[32:35], v[66:69], v[104:111], v70
    v_mfma_f32_16x16x32_bf16 v[112:115], v[80:83], v[136:139], v[112:115]
    v_lshlrev_b32_sdwa v104, 3, v126 dst_sel:DWORD dst_unused:UNUSED_PAD src0_sel:DWORD src1_sel:WORD_0
    v_lshlrev_b32_sdwa v106, 3, v126 dst_sel:DWORD dst_unused:UNUSED_PAD src0_sel:DWORD src1_sel:WORD_1
    ds_read_b64 v[104:105], v104
    ds_read_b64 v[106:107], v106
    v_mfma_f32_16x16x32_bf16 v[112:115], v[84:87], v[140:143], v[112:115]
    v_lshlrev_b32_sdwa v108, 3, v127 dst_sel:DWORD dst_unused:UNUSED_PAD src0_sel:DWORD src1_sel:WORD_0
    v_lshlrev_b32_sdwa v110, 3, v127 dst_sel:DWORD dst_unused:UNUSED_PAD src0_sel:DWORD src1_sel:WORD_1
    ds_read_b64 v[108:109], v108
    ds_read_b64 v[110:111], v110
    s_add_u32 s20, s20, 0xfffff000
    buffer_load_dwordx4 v[124:127], v71, s[12:15], s20 offen offset:3072 sc1
    s_waitcnt lgkmcnt(8)
    v_smfmac_f32_16x16x64_bf16 v[32:35], v[66:69], v[88:95], v70
    v_cvt_pk_bf16_f32 v112, v112, v113
    v_cvt_pk_bf16_f32 v113, v114, v115
    v_lshlrev_b32_sdwa v114, 3, v70 dst_sel:DWORD dst_unused:UNUSED_PAD src0_sel:DWORD src1_sel:WORD_1
    ds_write_b64 v114, v[112:113] offset:0
    s_waitcnt vmcnt(2)
    v_lshlrev_b32_sdwa v88, 3, v116 dst_sel:DWORD dst_unused:UNUSED_PAD src0_sel:DWORD src1_sel:WORD_0
    v_lshlrev_b32_sdwa v90, 3, v116 dst_sel:DWORD dst_unused:UNUSED_PAD src0_sel:DWORD src1_sel:WORD_1
    ds_read_b64 v[88:89], v88
    ds_read_b64 v[90:91], v90
    v_lshlrev_b32_sdwa v92, 3, v117 dst_sel:DWORD dst_unused:UNUSED_PAD src0_sel:DWORD src1_sel:WORD_0
    v_lshlrev_b32_sdwa v94, 3, v117 dst_sel:DWORD dst_unused:UNUSED_PAD src0_sel:DWORD src1_sel:WORD_1
    v_cvt_pk_bf16_f32 v32, v32, v33
    v_cvt_pk_bf16_f32 v33, v34, v35
    v_lshlrev_b32 v34, 16, v36
    v_and_b32 v35, s23, v36
    v_lshlrev_b32 v36, 16, v37
    v_and_b32 v37, s23, v37
    ds_read_b64 v[92:93], v92
    ds_read_b64 v[94:95], v94
    s_waitcnt lgkmcnt(9)
    v_smfmac_f32_16x16x64_bf16 v[34:37], v[66:69], v[96:103], v70
    v_mfma_f32_16x16x32_bf16 v[112:115], v[72:75], v[144:147], 0
    v_lshlrev_b32_sdwa v96, 3, v118 dst_sel:DWORD dst_unused:UNUSED_PAD src0_sel:DWORD src1_sel:WORD_0
    v_lshlrev_b32_sdwa v98, 3, v118 dst_sel:DWORD dst_unused:UNUSED_PAD src0_sel:DWORD src1_sel:WORD_1
    ds_read_b64 v[96:97], v96
    ds_read_b64 v[98:99], v98
    v_mfma_f32_16x16x32_bf16 v[112:115], v[76:79], v[148:151], v[112:115]
    v_lshlrev_b32_sdwa v100, 3, v119 dst_sel:DWORD dst_unused:UNUSED_PAD src0_sel:DWORD src1_sel:WORD_0
    v_lshlrev_b32_sdwa v102, 3, v119 dst_sel:DWORD dst_unused:UNUSED_PAD src0_sel:DWORD src1_sel:WORD_1
    ds_read_b64 v[100:101], v100
    ds_read_b64 v[102:103], v102
    buffer_load_dwordx4 v[116:119], v71, s[12:15], s20 offen offset:2048 sc1
    s_waitcnt lgkmcnt(9)
    v_smfmac_f32_16x16x64_bf16 v[34:37], v[66:69], v[104:111], v70
    v_mfma_f32_16x16x32_bf16 v[112:115], v[80:83], v[152:155], v[112:115]
    s_waitcnt vmcnt(2)
    v_lshlrev_b32_sdwa v104, 3, v120 dst_sel:DWORD dst_unused:UNUSED_PAD src0_sel:DWORD src1_sel:WORD_0
    v_lshlrev_b32_sdwa v106, 3, v120 dst_sel:DWORD dst_unused:UNUSED_PAD src0_sel:DWORD src1_sel:WORD_1
    ds_read_b64 v[104:105], v104
    ds_read_b64 v[106:107], v106
    v_mfma_f32_16x16x32_bf16 v[112:115], v[84:87], v[156:159], v[112:115]
    v_lshlrev_b32_sdwa v108, 3, v121 dst_sel:DWORD dst_unused:UNUSED_PAD src0_sel:DWORD src1_sel:WORD_0
    v_lshlrev_b32_sdwa v110, 3, v121 dst_sel:DWORD dst_unused:UNUSED_PAD src0_sel:DWORD src1_sel:WORD_1
    v_cvt_pk_bf16_f32 v34, v34, v35
    v_cvt_pk_bf16_f32 v35, v36, v37
    v_lshlrev_b32 v36, 16, v38
    v_and_b32 v37, s23, v38
    v_lshlrev_b32 v38, 16, v39
    v_and_b32 v39, s23, v39
    ds_read_b64 v[108:109], v108
    ds_read_b64 v[110:111], v110
    s_waitcnt lgkmcnt(8)
    v_smfmac_f32_16x16x64_bf16 v[36:39], v[66:69], v[88:95], v70
    v_cvt_pk_bf16_f32 v112, v112, v113
    v_cvt_pk_bf16_f32 v113, v114, v115
    v_lshlrev_b32_sdwa v114, 3, v70 dst_sel:DWORD dst_unused:UNUSED_PAD src0_sel:DWORD src1_sel:WORD_1
    ds_write_b64 v114, v[112:113] offset:128
    v_lshlrev_b32_sdwa v88, 3, v122 dst_sel:DWORD dst_unused:UNUSED_PAD src0_sel:DWORD src1_sel:WORD_0
    v_lshlrev_b32_sdwa v90, 3, v122 dst_sel:DWORD dst_unused:UNUSED_PAD src0_sel:DWORD src1_sel:WORD_1
    ds_read_b64 v[88:89], v88
    ds_read_b64 v[90:91], v90
    v_lshlrev_b32_sdwa v92, 3, v123 dst_sel:DWORD dst_unused:UNUSED_PAD src0_sel:DWORD src1_sel:WORD_0
    v_lshlrev_b32_sdwa v94, 3, v123 dst_sel:DWORD dst_unused:UNUSED_PAD src0_sel:DWORD src1_sel:WORD_1
    ds_read_b64 v[92:93], v92
    ds_read_b64 v[94:95], v94
    buffer_load_dwordx4 v[120:123], v71, s[12:15], s20 offen offset:1024 sc1
    s_waitcnt lgkmcnt(9)
    v_smfmac_f32_16x16x64_bf16 v[36:39], v[66:69], v[96:103], v70
    v_mfma_f32_16x16x32_bf16 v[112:115], v[72:75], v[160:163], 0
    s_waitcnt vmcnt(2)
    v_lshlrev_b32_sdwa v96, 3, v124 dst_sel:DWORD dst_unused:UNUSED_PAD src0_sel:DWORD src1_sel:WORD_0
    v_lshlrev_b32_sdwa v98, 3, v124 dst_sel:DWORD dst_unused:UNUSED_PAD src0_sel:DWORD src1_sel:WORD_1
    ds_read_b64 v[96:97], v96
    ds_read_b64 v[98:99], v98
    v_mfma_f32_16x16x32_bf16 v[112:115], v[76:79], v[164:167], v[112:115]
    v_lshlrev_b32_sdwa v100, 3, v125 dst_sel:DWORD dst_unused:UNUSED_PAD src0_sel:DWORD src1_sel:WORD_0
    v_lshlrev_b32_sdwa v102, 3, v125 dst_sel:DWORD dst_unused:UNUSED_PAD src0_sel:DWORD src1_sel:WORD_1
    v_cvt_pk_bf16_f32 v36, v36, v37
    v_cvt_pk_bf16_f32 v37, v38, v39
    v_lshlrev_b32 v38, 16, v40
    v_and_b32 v39, s23, v40
    v_lshlrev_b32 v40, 16, v41
    v_and_b32 v41, s23, v41
    ds_read_b64 v[100:101], v100
    ds_read_b64 v[102:103], v102
    s_waitcnt lgkmcnt(9)
    v_smfmac_f32_16x16x64_bf16 v[38:41], v[66:69], v[104:111], v70
    v_mfma_f32_16x16x32_bf16 v[112:115], v[80:83], v[168:171], v[112:115]
    v_lshlrev_b32_sdwa v104, 3, v126 dst_sel:DWORD dst_unused:UNUSED_PAD src0_sel:DWORD src1_sel:WORD_0
    v_lshlrev_b32_sdwa v106, 3, v126 dst_sel:DWORD dst_unused:UNUSED_PAD src0_sel:DWORD src1_sel:WORD_1
    ds_read_b64 v[104:105], v104
    ds_read_b64 v[106:107], v106
    v_mfma_f32_16x16x32_bf16 v[112:115], v[84:87], v[172:175], v[112:115]
    v_lshlrev_b32_sdwa v108, 3, v127 dst_sel:DWORD dst_unused:UNUSED_PAD src0_sel:DWORD src1_sel:WORD_0
    v_lshlrev_b32_sdwa v110, 3, v127 dst_sel:DWORD dst_unused:UNUSED_PAD src0_sel:DWORD src1_sel:WORD_1
    ds_read_b64 v[108:109], v108
    ds_read_b64 v[110:111], v110
    buffer_load_dwordx4 v[124:127], v71, s[12:15], s20 offen offset:0 sc1
    s_waitcnt lgkmcnt(8)
    v_smfmac_f32_16x16x64_bf16 v[38:41], v[66:69], v[88:95], v70
    s_nop 0
    v_cvt_pk_bf16_f32 v112, v112, v113
    v_cvt_pk_bf16_f32 v113, v114, v115
    v_lshlrev_b32_sdwa v114, 3, v70 dst_sel:DWORD dst_unused:UNUSED_PAD src0_sel:DWORD src1_sel:WORD_1
    ds_write_b64 v114, v[112:113] offset:256
    s_waitcnt vmcnt(2)
    v_lshlrev_b32_sdwa v88, 3, v116 dst_sel:DWORD dst_unused:UNUSED_PAD src0_sel:DWORD src1_sel:WORD_0
    v_lshlrev_b32_sdwa v90, 3, v116 dst_sel:DWORD dst_unused:UNUSED_PAD src0_sel:DWORD src1_sel:WORD_1
    ds_read_b64 v[88:89], v88
    ds_read_b64 v[90:91], v90
    v_lshlrev_b32_sdwa v92, 3, v117 dst_sel:DWORD dst_unused:UNUSED_PAD src0_sel:DWORD src1_sel:WORD_0
    v_lshlrev_b32_sdwa v94, 3, v117 dst_sel:DWORD dst_unused:UNUSED_PAD src0_sel:DWORD src1_sel:WORD_1
    v_cvt_pk_bf16_f32 v38, v38, v39
    v_cvt_pk_bf16_f32 v39, v40, v41
    v_lshlrev_b32 v40, 16, v42
    v_and_b32 v41, s23, v42
    v_lshlrev_b32 v42, 16, v43
    v_and_b32 v43, s23, v43
    ds_read_b64 v[92:93], v92
    ds_read_b64 v[94:95], v94
    s_waitcnt lgkmcnt(9)
    v_smfmac_f32_16x16x64_bf16 v[40:43], v[66:69], v[96:103], v70
    v_mfma_f32_16x16x32_bf16 v[112:115], v[72:75], v[176:179], 0
    v_lshlrev_b32_sdwa v96, 3, v118 dst_sel:DWORD dst_unused:UNUSED_PAD src0_sel:DWORD src1_sel:WORD_0
    v_lshlrev_b32_sdwa v98, 3, v118 dst_sel:DWORD dst_unused:UNUSED_PAD src0_sel:DWORD src1_sel:WORD_1
    ds_read_b64 v[96:97], v96
    ds_read_b64 v[98:99], v98
    v_mfma_f32_16x16x32_bf16 v[112:115], v[76:79], v[180:183], v[112:115]
    v_lshlrev_b32_sdwa v100, 3, v119 dst_sel:DWORD dst_unused:UNUSED_PAD src0_sel:DWORD src1_sel:WORD_0
    v_lshlrev_b32_sdwa v102, 3, v119 dst_sel:DWORD dst_unused:UNUSED_PAD src0_sel:DWORD src1_sel:WORD_1
    ds_read_b64 v[100:101], v100
    ds_read_b64 v[102:103], v102
    s_add_u32 s20, s20, 0xfffff000
    buffer_load_dwordx4 v[116:119], v71, s[12:15], s20 offen offset:3072 sc1
    s_waitcnt lgkmcnt(9)
    v_smfmac_f32_16x16x64_bf16 v[40:43], v[66:69], v[104:111], v70
    v_mfma_f32_16x16x32_bf16 v[112:115], v[80:83], v[184:187], v[112:115]
    s_waitcnt vmcnt(2)
    v_lshlrev_b32_sdwa v104, 3, v120 dst_sel:DWORD dst_unused:UNUSED_PAD src0_sel:DWORD src1_sel:WORD_0
    v_lshlrev_b32_sdwa v106, 3, v120 dst_sel:DWORD dst_unused:UNUSED_PAD src0_sel:DWORD src1_sel:WORD_1
    ds_read_b64 v[104:105], v104
    ds_read_b64 v[106:107], v106
    v_mfma_f32_16x16x32_bf16 v[112:115], v[84:87], v[188:191], v[112:115]
    v_lshlrev_b32_sdwa v108, 3, v121 dst_sel:DWORD dst_unused:UNUSED_PAD src0_sel:DWORD src1_sel:WORD_0
    v_lshlrev_b32_sdwa v110, 3, v121 dst_sel:DWORD dst_unused:UNUSED_PAD src0_sel:DWORD src1_sel:WORD_1
    v_cvt_pk_bf16_f32 v40, v40, v41
    v_cvt_pk_bf16_f32 v41, v42, v43
    v_lshlrev_b32 v42, 16, v44
    v_and_b32 v43, s23, v44
    v_lshlrev_b32 v44, 16, v45
    v_and_b32 v45, s23, v45
    ds_read_b64 v[108:109], v108
    ds_read_b64 v[110:111], v110
    s_waitcnt lgkmcnt(8)
    v_smfmac_f32_16x16x64_bf16 v[42:45], v[66:69], v[88:95], v70
    v_cvt_pk_bf16_f32 v112, v112, v113
    v_cvt_pk_bf16_f32 v113, v114, v115
    v_lshlrev_b32_sdwa v114, 3, v70 dst_sel:DWORD dst_unused:UNUSED_PAD src0_sel:DWORD src1_sel:WORD_1
    ds_write_b64 v114, v[112:113] offset:384
    v_lshlrev_b32_sdwa v88, 3, v122 dst_sel:DWORD dst_unused:UNUSED_PAD src0_sel:DWORD src1_sel:WORD_0
    v_lshlrev_b32_sdwa v90, 3, v122 dst_sel:DWORD dst_unused:UNUSED_PAD src0_sel:DWORD src1_sel:WORD_1
    ds_read_b64 v[88:89], v88
    ds_read_b64 v[90:91], v90
    v_lshlrev_b32_sdwa v92, 3, v123 dst_sel:DWORD dst_unused:UNUSED_PAD src0_sel:DWORD src1_sel:WORD_0
    v_lshlrev_b32_sdwa v94, 3, v123 dst_sel:DWORD dst_unused:UNUSED_PAD src0_sel:DWORD src1_sel:WORD_1
    ds_read_b64 v[92:93], v92
    ds_read_b64 v[94:95], v94
    buffer_load_dwordx4 v[120:123], v71, s[12:15], s20 offen offset:2048 sc1
    s_waitcnt lgkmcnt(9)
    v_smfmac_f32_16x16x64_bf16 v[42:45], v[66:69], v[96:103], v70
    v_mfma_f32_16x16x32_bf16 v[112:115], v[72:75], v[192:195], 0
    s_waitcnt vmcnt(2)
    v_lshlrev_b32_sdwa v96, 3, v124 dst_sel:DWORD dst_unused:UNUSED_PAD src0_sel:DWORD src1_sel:WORD_0
    v_lshlrev_b32_sdwa v98, 3, v124 dst_sel:DWORD dst_unused:UNUSED_PAD src0_sel:DWORD src1_sel:WORD_1
    ds_read_b64 v[96:97], v96
    ds_read_b64 v[98:99], v98
    v_mfma_f32_16x16x32_bf16 v[112:115], v[76:79], v[196:199], v[112:115]
    v_lshlrev_b32_sdwa v100, 3, v125 dst_sel:DWORD dst_unused:UNUSED_PAD src0_sel:DWORD src1_sel:WORD_0
    v_lshlrev_b32_sdwa v102, 3, v125 dst_sel:DWORD dst_unused:UNUSED_PAD src0_sel:DWORD src1_sel:WORD_1
    v_cvt_pk_bf16_f32 v42, v42, v43
    v_cvt_pk_bf16_f32 v43, v44, v45
    v_lshlrev_b32 v44, 16, v46
    v_and_b32 v45, s23, v46
    v_lshlrev_b32 v46, 16, v47
    v_and_b32 v47, s23, v47
    ds_read_b64 v[100:101], v100
    ds_read_b64 v[102:103], v102
    s_waitcnt lgkmcnt(9)
    v_smfmac_f32_16x16x64_bf16 v[44:47], v[66:69], v[104:111], v70
    v_mfma_f32_16x16x32_bf16 v[112:115], v[80:83], v[200:203], v[112:115]
    v_lshlrev_b32_sdwa v104, 3, v126 dst_sel:DWORD dst_unused:UNUSED_PAD src0_sel:DWORD src1_sel:WORD_0
    v_lshlrev_b32_sdwa v106, 3, v126 dst_sel:DWORD dst_unused:UNUSED_PAD src0_sel:DWORD src1_sel:WORD_1
    ds_read_b64 v[104:105], v104
    ds_read_b64 v[106:107], v106
    v_mfma_f32_16x16x32_bf16 v[112:115], v[84:87], v[204:207], v[112:115]
    v_lshlrev_b32_sdwa v108, 3, v127 dst_sel:DWORD dst_unused:UNUSED_PAD src0_sel:DWORD src1_sel:WORD_0
    v_lshlrev_b32_sdwa v110, 3, v127 dst_sel:DWORD dst_unused:UNUSED_PAD src0_sel:DWORD src1_sel:WORD_1
    ds_read_b64 v[108:109], v108
    ds_read_b64 v[110:111], v110
    buffer_load_dwordx4 v[124:127], v71, s[12:15], s20 offen offset:1024 sc1
    s_waitcnt lgkmcnt(8)
    v_smfmac_f32_16x16x64_bf16 v[44:47], v[66:69], v[88:95], v70
    s_nop 0
    v_cvt_pk_bf16_f32 v112, v112, v113
    v_cvt_pk_bf16_f32 v113, v114, v115
    v_lshlrev_b32_sdwa v114, 3, v70 dst_sel:DWORD dst_unused:UNUSED_PAD src0_sel:DWORD src1_sel:WORD_1
    ds_write_b64 v114, v[112:113] offset:512
    s_waitcnt vmcnt(2)
    v_lshlrev_b32_sdwa v88, 3, v116 dst_sel:DWORD dst_unused:UNUSED_PAD src0_sel:DWORD src1_sel:WORD_0
    v_lshlrev_b32_sdwa v90, 3, v116 dst_sel:DWORD dst_unused:UNUSED_PAD src0_sel:DWORD src1_sel:WORD_1
    ds_read_b64 v[88:89], v88
    ds_read_b64 v[90:91], v90
    v_lshlrev_b32_sdwa v92, 3, v117 dst_sel:DWORD dst_unused:UNUSED_PAD src0_sel:DWORD src1_sel:WORD_0
    v_lshlrev_b32_sdwa v94, 3, v117 dst_sel:DWORD dst_unused:UNUSED_PAD src0_sel:DWORD src1_sel:WORD_1
    v_cvt_pk_bf16_f32 v44, v44, v45
    v_cvt_pk_bf16_f32 v45, v46, v47
    v_lshlrev_b32 v46, 16, v48
    v_and_b32 v47, s23, v48
    v_lshlrev_b32 v48, 16, v49
    v_and_b32 v49, s23, v49
    ds_read_b64 v[92:93], v92
    ds_read_b64 v[94:95], v94
    s_waitcnt lgkmcnt(9)
    v_smfmac_f32_16x16x64_bf16 v[46:49], v[66:69], v[96:103], v70
    s_setprio 2
    v_mfma_f32_16x16x32_bf16 v[112:115], v[72:75], v[208:211], 0
    v_lshlrev_b32_sdwa v96, 3, v118 dst_sel:DWORD dst_unused:UNUSED_PAD src0_sel:DWORD src1_sel:WORD_0
    v_lshlrev_b32_sdwa v98, 3, v118 dst_sel:DWORD dst_unused:UNUSED_PAD src0_sel:DWORD src1_sel:WORD_1
    ds_read_b64 v[96:97], v96
    ds_read_b64 v[98:99], v98
    v_mfma_f32_16x16x32_bf16 v[112:115], v[76:79], v[212:215], v[112:115]
    v_lshlrev_b32_sdwa v100, 3, v119 dst_sel:DWORD dst_unused:UNUSED_PAD src0_sel:DWORD src1_sel:WORD_0
    v_lshlrev_b32_sdwa v102, 3, v119 dst_sel:DWORD dst_unused:UNUSED_PAD src0_sel:DWORD src1_sel:WORD_1
    ds_read_b64 v[100:101], v100
    ds_read_b64 v[102:103], v102
    buffer_load_dwordx4 v[116:119], v71, s[12:15], s20 offen offset:0 sc1
    s_waitcnt lgkmcnt(9)
    v_smfmac_f32_16x16x64_bf16 v[46:49], v[66:69], v[104:111], v70
    v_mfma_f32_16x16x32_bf16 v[112:115], v[80:83], v[216:219], v[112:115]
    s_waitcnt vmcnt(2)
    v_lshlrev_b32_sdwa v104, 3, v120 dst_sel:DWORD dst_unused:UNUSED_PAD src0_sel:DWORD src1_sel:WORD_0
    v_lshlrev_b32_sdwa v106, 3, v120 dst_sel:DWORD dst_unused:UNUSED_PAD src0_sel:DWORD src1_sel:WORD_1
    ds_read_b64 v[104:105], v104
    ds_read_b64 v[106:107], v106
    v_mfma_f32_16x16x32_bf16 v[112:115], v[84:87], v[220:223], v[112:115]
    v_lshlrev_b32_sdwa v108, 3, v121 dst_sel:DWORD dst_unused:UNUSED_PAD src0_sel:DWORD src1_sel:WORD_0
    v_lshlrev_b32_sdwa v110, 3, v121 dst_sel:DWORD dst_unused:UNUSED_PAD src0_sel:DWORD src1_sel:WORD_1
    v_cvt_pk_bf16_f32 v46, v46, v47
    v_cvt_pk_bf16_f32 v47, v48, v49
    v_lshlrev_b32 v48, 16, v50
    v_and_b32 v49, s23, v50
    v_lshlrev_b32 v50, 16, v51
    v_and_b32 v51, s23, v51
    ds_read_b64 v[108:109], v108
    ds_read_b64 v[110:111], v110
    s_waitcnt lgkmcnt(8)
    v_smfmac_f32_16x16x64_bf16 v[48:51], v[66:69], v[88:95], v70
    v_cvt_pk_bf16_f32 v112, v112, v113
    v_cvt_pk_bf16_f32 v113, v114, v115
    v_lshlrev_b32_sdwa v114, 3, v70 dst_sel:DWORD dst_unused:UNUSED_PAD src0_sel:DWORD src1_sel:WORD_1
    ds_write_b64 v114, v[112:113] offset:640
    v_lshlrev_b32_sdwa v88, 3, v122 dst_sel:DWORD dst_unused:UNUSED_PAD src0_sel:DWORD src1_sel:WORD_0
    v_lshlrev_b32_sdwa v90, 3, v122 dst_sel:DWORD dst_unused:UNUSED_PAD src0_sel:DWORD src1_sel:WORD_1
    ds_read_b64 v[88:89], v88
    ds_read_b64 v[90:91], v90
    v_lshlrev_b32_sdwa v92, 3, v123 dst_sel:DWORD dst_unused:UNUSED_PAD src0_sel:DWORD src1_sel:WORD_0
    v_lshlrev_b32_sdwa v94, 3, v123 dst_sel:DWORD dst_unused:UNUSED_PAD src0_sel:DWORD src1_sel:WORD_1
    ds_read_b64 v[92:93], v92
    ds_read_b64 v[94:95], v94
    s_add_u32 s20, s20, 0xfffff000
    buffer_load_dwordx4 v[120:123], v71, s[12:15], s20 offen offset:3072 sc1
    s_waitcnt lgkmcnt(9)
    v_smfmac_f32_16x16x64_bf16 v[48:51], v[66:69], v[96:103], v70
    v_mfma_f32_16x16x32_bf16 v[112:115], v[72:75], v[224:227], 0
    s_waitcnt vmcnt(2)
    v_lshlrev_b32_sdwa v96, 3, v124 dst_sel:DWORD dst_unused:UNUSED_PAD src0_sel:DWORD src1_sel:WORD_0
    v_lshlrev_b32_sdwa v98, 3, v124 dst_sel:DWORD dst_unused:UNUSED_PAD src0_sel:DWORD src1_sel:WORD_1
    ds_read_b64 v[96:97], v96
    ds_read_b64 v[98:99], v98
    v_mfma_f32_16x16x32_bf16 v[112:115], v[76:79], v[228:231], v[112:115]
    v_lshlrev_b32_sdwa v100, 3, v125 dst_sel:DWORD dst_unused:UNUSED_PAD src0_sel:DWORD src1_sel:WORD_0
    v_lshlrev_b32_sdwa v102, 3, v125 dst_sel:DWORD dst_unused:UNUSED_PAD src0_sel:DWORD src1_sel:WORD_1
    v_cvt_pk_bf16_f32 v48, v48, v49
    v_cvt_pk_bf16_f32 v49, v50, v51
    v_lshlrev_b32 v50, 16, v52
    v_and_b32 v51, s23, v52
    v_lshlrev_b32 v52, 16, v53
    v_and_b32 v53, s23, v53
    ds_read_b64 v[100:101], v100
    ds_read_b64 v[102:103], v102
    s_waitcnt lgkmcnt(9)
    v_smfmac_f32_16x16x64_bf16 v[50:53], v[66:69], v[104:111], v70
    v_mfma_f32_16x16x32_bf16 v[112:115], v[80:83], v[232:235], v[112:115]
    v_lshlrev_b32_sdwa v104, 3, v126 dst_sel:DWORD dst_unused:UNUSED_PAD src0_sel:DWORD src1_sel:WORD_0
    v_lshlrev_b32_sdwa v106, 3, v126 dst_sel:DWORD dst_unused:UNUSED_PAD src0_sel:DWORD src1_sel:WORD_1
    ds_read_b64 v[104:105], v104
    ds_read_b64 v[106:107], v106
    v_mfma_f32_16x16x32_bf16 v[112:115], v[84:87], v[236:239], v[112:115]
    v_lshlrev_b32_sdwa v108, 3, v127 dst_sel:DWORD dst_unused:UNUSED_PAD src0_sel:DWORD src1_sel:WORD_0
    v_lshlrev_b32_sdwa v110, 3, v127 dst_sel:DWORD dst_unused:UNUSED_PAD src0_sel:DWORD src1_sel:WORD_1
    ds_read_b64 v[108:109], v108
    ds_read_b64 v[110:111], v110
    buffer_load_dwordx4 v[124:127], v71, s[12:15], s20 offen offset:2048 sc1
    s_waitcnt lgkmcnt(8)
    v_smfmac_f32_16x16x64_bf16 v[50:53], v[66:69], v[88:95], v70
    s_nop 0
    v_cvt_pk_bf16_f32 v112, v112, v113
    v_cvt_pk_bf16_f32 v113, v114, v115
    v_lshlrev_b32_sdwa v114, 3, v70 dst_sel:DWORD dst_unused:UNUSED_PAD src0_sel:DWORD src1_sel:WORD_1
    ds_write_b64 v114, v[112:113] offset:768
    s_waitcnt vmcnt(2)
    v_lshlrev_b32_sdwa v88, 3, v116 dst_sel:DWORD dst_unused:UNUSED_PAD src0_sel:DWORD src1_sel:WORD_0
    v_lshlrev_b32_sdwa v90, 3, v116 dst_sel:DWORD dst_unused:UNUSED_PAD src0_sel:DWORD src1_sel:WORD_1
    ds_read_b64 v[88:89], v88
    ds_read_b64 v[90:91], v90
    v_lshlrev_b32_sdwa v92, 3, v117 dst_sel:DWORD dst_unused:UNUSED_PAD src0_sel:DWORD src1_sel:WORD_0
    v_lshlrev_b32_sdwa v94, 3, v117 dst_sel:DWORD dst_unused:UNUSED_PAD src0_sel:DWORD src1_sel:WORD_1
    v_cvt_pk_bf16_f32 v50, v50, v51
    v_cvt_pk_bf16_f32 v51, v52, v53
    v_lshlrev_b32 v52, 16, v54
    v_and_b32 v53, s23, v54
    v_lshlrev_b32 v54, 16, v55
    v_and_b32 v55, s23, v55
    ds_read_b64 v[92:93], v92
    ds_read_b64 v[94:95], v94
    s_waitcnt lgkmcnt(9)
    v_smfmac_f32_16x16x64_bf16 v[52:55], v[66:69], v[96:103], v70
    v_mfma_f32_16x16x32_bf16 v[112:115], v[72:75], v[240:243], 0
    buffer_load_dwordx4 v[72:75], v71, s[12:15], s21 offen offset:0
    v_lshlrev_b32_sdwa v96, 3, v118 dst_sel:DWORD dst_unused:UNUSED_PAD src0_sel:DWORD src1_sel:WORD_0
    v_lshlrev_b32_sdwa v98, 3, v118 dst_sel:DWORD dst_unused:UNUSED_PAD src0_sel:DWORD src1_sel:WORD_1
    ds_read_b64 v[96:97], v96
    ds_read_b64 v[98:99], v98
    v_mfma_f32_16x16x32_bf16 v[112:115], v[76:79], v[244:247], v[112:115]
    buffer_load_dwordx4 v[76:79], v71, s[12:15], s21 offen offset:1024
    v_lshlrev_b32_sdwa v100, 3, v119 dst_sel:DWORD dst_unused:UNUSED_PAD src0_sel:DWORD src1_sel:WORD_0
    v_lshlrev_b32_sdwa v102, 3, v119 dst_sel:DWORD dst_unused:UNUSED_PAD src0_sel:DWORD src1_sel:WORD_1
    ds_read_b64 v[100:101], v100
    ds_read_b64 v[102:103], v102
    buffer_load_dwordx4 v[116:119], v71, s[12:15], s20 offen offset:1024 sc1
    s_waitcnt lgkmcnt(9)
    v_smfmac_f32_16x16x64_bf16 v[52:55], v[66:69], v[104:111], v70
    v_mfma_f32_16x16x32_bf16 v[112:115], v[80:83], v[248:251], v[112:115]
    buffer_load_dwordx4 v[80:83], v71, s[12:15], s19 offen offset:0
    s_waitcnt vmcnt(5)
    v_lshlrev_b32_sdwa v104, 3, v120 dst_sel:DWORD dst_unused:UNUSED_PAD src0_sel:DWORD src1_sel:WORD_0
    v_lshlrev_b32_sdwa v106, 3, v120 dst_sel:DWORD dst_unused:UNUSED_PAD src0_sel:DWORD src1_sel:WORD_1
    ds_read_b64 v[104:105], v104
    ds_read_b64 v[106:107], v106
    v_mfma_f32_16x16x32_bf16 v[112:115], v[84:87], v[252:255], v[112:115]
    buffer_load_dwordx4 v[84:87], v71, s[12:15], s19 offen offset:1024
    s_add_u32 s21, s21, 4096
    s_add_u32 s19, s19, 4096
    v_lshlrev_b32_sdwa v108, 3, v121 dst_sel:DWORD dst_unused:UNUSED_PAD src0_sel:DWORD src1_sel:WORD_0
    v_lshlrev_b32_sdwa v110, 3, v121 dst_sel:DWORD dst_unused:UNUSED_PAD src0_sel:DWORD src1_sel:WORD_1
    v_cvt_pk_bf16_f32 v52, v52, v53
    v_cvt_pk_bf16_f32 v53, v54, v55
    v_lshlrev_b32 v54, 16, v56
    v_and_b32 v55, s23, v56
    v_lshlrev_b32 v56, 16, v57
    v_and_b32 v57, s23, v57
    ds_read_b64 v[108:109], v108
    ds_read_b64 v[110:111], v110
    s_waitcnt lgkmcnt(8)
    v_smfmac_f32_16x16x64_bf16 v[54:57], v[66:69], v[88:95], v70
    v_cvt_pk_bf16_f32 v112, v112, v113
    v_cvt_pk_bf16_f32 v113, v114, v115
    v_lshlrev_b32_sdwa v114, 3, v70 dst_sel:DWORD dst_unused:UNUSED_PAD src0_sel:DWORD src1_sel:WORD_1
    ds_write_b64 v114, v[112:113] offset:896
    s_setprio 1
    v_lshlrev_b32_sdwa v88, 3, v122 dst_sel:DWORD dst_unused:UNUSED_PAD src0_sel:DWORD src1_sel:WORD_0
    v_lshlrev_b32_sdwa v90, 3, v122 dst_sel:DWORD dst_unused:UNUSED_PAD src0_sel:DWORD src1_sel:WORD_1
    ds_read_b64 v[88:89], v88
    ds_read_b64 v[90:91], v90
    v_lshlrev_b32_sdwa v92, 3, v123 dst_sel:DWORD dst_unused:UNUSED_PAD src0_sel:DWORD src1_sel:WORD_0
    v_lshlrev_b32_sdwa v94, 3, v123 dst_sel:DWORD dst_unused:UNUSED_PAD src0_sel:DWORD src1_sel:WORD_1
    ds_read_b64 v[92:93], v92
    ds_read_b64 v[94:95], v94
    buffer_load_dwordx4 v[120:123], v71, s[12:15], s20 offen offset:0 sc1
    s_waitcnt lgkmcnt(9)
    v_smfmac_f32_16x16x64_bf16 v[54:57], v[66:69], v[96:103], v70
    s_waitcnt vmcnt(6)
    v_lshlrev_b32_sdwa v96, 3, v124 dst_sel:DWORD dst_unused:UNUSED_PAD src0_sel:DWORD src1_sel:WORD_0
    v_lshlrev_b32_sdwa v98, 3, v124 dst_sel:DWORD dst_unused:UNUSED_PAD src0_sel:DWORD src1_sel:WORD_1
    ds_read_b64 v[96:97], v96
    ds_read_b64 v[98:99], v98
    v_lshlrev_b32_sdwa v100, 3, v125 dst_sel:DWORD dst_unused:UNUSED_PAD src0_sel:DWORD src1_sel:WORD_0
    v_lshlrev_b32_sdwa v102, 3, v125 dst_sel:DWORD dst_unused:UNUSED_PAD src0_sel:DWORD src1_sel:WORD_1
    s_nop 0
    v_cvt_pk_bf16_f32 v54, v54, v55
    v_cvt_pk_bf16_f32 v55, v56, v57
    v_lshlrev_b32 v56, 16, v58
    v_and_b32 v57, s23, v58
    v_lshlrev_b32 v58, 16, v59
    v_and_b32 v59, s23, v59
    ds_read_b64 v[100:101], v100
    ds_read_b64 v[102:103], v102
    s_waitcnt lgkmcnt(9)
    v_smfmac_f32_16x16x64_bf16 v[56:59], v[66:69], v[104:111], v70
    v_lshlrev_b32_sdwa v104, 3, v126 dst_sel:DWORD dst_unused:UNUSED_PAD src0_sel:DWORD src1_sel:WORD_0
    v_lshlrev_b32_sdwa v106, 3, v126 dst_sel:DWORD dst_unused:UNUSED_PAD src0_sel:DWORD src1_sel:WORD_1
    ds_read_b64 v[104:105], v104
    ds_read_b64 v[106:107], v106
    v_lshlrev_b32_sdwa v108, 3, v127 dst_sel:DWORD dst_unused:UNUSED_PAD src0_sel:DWORD src1_sel:WORD_0
    v_lshlrev_b32_sdwa v110, 3, v127 dst_sel:DWORD dst_unused:UNUSED_PAD src0_sel:DWORD src1_sel:WORD_1
    ds_read_b64 v[108:109], v108
    ds_read_b64 v[110:111], v110
    s_add_u32 s20, s20, 0x22c00
    buffer_load_dwordx4 v[124:127], v71, s[12:15], s20 offen offset:3072 sc1
    s_waitcnt lgkmcnt(8)
    v_smfmac_f32_16x16x64_bf16 v[56:59], v[66:69], v[88:95], v70
    s_waitcnt vmcnt(4)
    v_lshlrev_b32_sdwa v88, 3, v116 dst_sel:DWORD dst_unused:UNUSED_PAD src0_sel:DWORD src1_sel:WORD_0
    v_lshlrev_b32_sdwa v90, 3, v116 dst_sel:DWORD dst_unused:UNUSED_PAD src0_sel:DWORD src1_sel:WORD_1
    ds_read_b64 v[88:89], v88
    ds_read_b64 v[90:91], v90
    v_lshlrev_b32_sdwa v92, 3, v117 dst_sel:DWORD dst_unused:UNUSED_PAD src0_sel:DWORD src1_sel:WORD_0
    v_lshlrev_b32_sdwa v94, 3, v117 dst_sel:DWORD dst_unused:UNUSED_PAD src0_sel:DWORD src1_sel:WORD_1
    s_nop 0
    v_cvt_pk_bf16_f32 v56, v56, v57
    v_cvt_pk_bf16_f32 v57, v58, v59
    v_lshlrev_b32 v58, 16, v60
    v_and_b32 v59, s23, v60
    v_lshlrev_b32 v60, 16, v61
    v_and_b32 v61, s23, v61
    ds_read_b64 v[92:93], v92
    ds_read_b64 v[94:95], v94
    s_waitcnt lgkmcnt(8)
    v_smfmac_f32_16x16x64_bf16 v[58:61], v[66:69], v[96:103], v70
    v_lshlrev_b32_sdwa v96, 3, v118 dst_sel:DWORD dst_unused:UNUSED_PAD src0_sel:DWORD src1_sel:WORD_0
    v_lshlrev_b32_sdwa v98, 3, v118 dst_sel:DWORD dst_unused:UNUSED_PAD src0_sel:DWORD src1_sel:WORD_1
    ds_read_b64 v[96:97], v96
    ds_read_b64 v[98:99], v98
    v_lshlrev_b32_sdwa v100, 3, v119 dst_sel:DWORD dst_unused:UNUSED_PAD src0_sel:DWORD src1_sel:WORD_0
    v_lshlrev_b32_sdwa v102, 3, v119 dst_sel:DWORD dst_unused:UNUSED_PAD src0_sel:DWORD src1_sel:WORD_1
    ds_read_b64 v[100:101], v100
    ds_read_b64 v[102:103], v102
    buffer_load_dwordx4 v[116:119], v71, s[12:15], s20 offen offset:2048 sc1
    s_waitcnt lgkmcnt(8)
    v_smfmac_f32_16x16x64_bf16 v[58:61], v[66:69], v[104:111], v70
    s_waitcnt vmcnt(2)
    v_lshlrev_b32_sdwa v104, 3, v120 dst_sel:DWORD dst_unused:UNUSED_PAD src0_sel:DWORD src1_sel:WORD_0
    v_lshlrev_b32_sdwa v106, 3, v120 dst_sel:DWORD dst_unused:UNUSED_PAD src0_sel:DWORD src1_sel:WORD_1
    ds_read_b64 v[104:105], v104
    ds_read_b64 v[106:107], v106
    v_lshlrev_b32_sdwa v108, 3, v121 dst_sel:DWORD dst_unused:UNUSED_PAD src0_sel:DWORD src1_sel:WORD_0
    v_lshlrev_b32_sdwa v110, 3, v121 dst_sel:DWORD dst_unused:UNUSED_PAD src0_sel:DWORD src1_sel:WORD_1
    s_nop 0
    v_cvt_pk_bf16_f32 v58, v58, v59
    v_cvt_pk_bf16_f32 v59, v60, v61
    v_lshlrev_b32 v60, 16, v62
    v_and_b32 v61, s23, v62
    v_lshlrev_b32 v62, 16, v63
    v_and_b32 v63, s23, v63
    ds_read_b64 v[108:109], v108
    ds_read_b64 v[110:111], v110
    s_waitcnt lgkmcnt(8)
    v_smfmac_f32_16x16x64_bf16 v[60:63], v[66:69], v[88:95], v70
    s_setprio 0
    v_lshlrev_b32_sdwa v88, 3, v122 dst_sel:DWORD dst_unused:UNUSED_PAD src0_sel:DWORD src1_sel:WORD_0
    v_lshlrev_b32_sdwa v90, 3, v122 dst_sel:DWORD dst_unused:UNUSED_PAD src0_sel:DWORD src1_sel:WORD_1
    ds_read_b64 v[88:89], v88
    ds_read_b64 v[90:91], v90
    v_lshlrev_b32_sdwa v92, 3, v123 dst_sel:DWORD dst_unused:UNUSED_PAD src0_sel:DWORD src1_sel:WORD_0
    v_lshlrev_b32_sdwa v94, 3, v123 dst_sel:DWORD dst_unused:UNUSED_PAD src0_sel:DWORD src1_sel:WORD_1
    ds_read_b64 v[92:93], v92
    ds_read_b64 v[94:95], v94
    buffer_load_dwordx4 v[120:123], v71, s[12:15], s20 offen offset:1024 sc1
    s_waitcnt lgkmcnt(8)
    v_smfmac_f32_16x16x64_bf16 v[60:63], v[66:69], v[96:103], v70
    s_waitcnt vmcnt(2)
    v_lshlrev_b32_sdwa v96, 3, v126 dst_sel:DWORD dst_unused:UNUSED_PAD src0_sel:DWORD src1_sel:WORD_0
    v_lshlrev_b32_sdwa v98, 3, v126 dst_sel:DWORD dst_unused:UNUSED_PAD src0_sel:DWORD src1_sel:WORD_1
    ds_read_b64 v[96:97], v96
    ds_read_b64 v[98:99], v98
    v_lshlrev_b32_sdwa v100, 3, v127 dst_sel:DWORD dst_unused:UNUSED_PAD src0_sel:DWORD src1_sel:WORD_0
    v_lshlrev_b32_sdwa v102, 3, v127 dst_sel:DWORD dst_unused:UNUSED_PAD src0_sel:DWORD src1_sel:WORD_1
    s_nop 0
    v_cvt_pk_bf16_f32 v60, v60, v61
    v_cvt_pk_bf16_f32 v61, v62, v63
    v_lshlrev_b32 v62, 16, v64
    v_and_b32 v63, s23, v64
    v_lshlrev_b32 v64, 16, v65
    v_and_b32 v65, s23, v65
    ds_read_b64 v[100:101], v100
    ds_read_b64 v[102:103], v102
    s_waitcnt lgkmcnt(8)
    v_smfmac_f32_16x16x64_bf16 v[62:65], v[66:69], v[104:111], v70
    s_barrier
    s_setprio 3
    v_lshlrev_b32_sdwa v104, 3, v124 dst_sel:DWORD dst_unused:UNUSED_PAD src0_sel:DWORD src1_sel:WORD_0
    v_lshlrev_b32_sdwa v106, 3, v124 dst_sel:DWORD dst_unused:UNUSED_PAD src0_sel:DWORD src1_sel:WORD_1
    ds_read_b64 v[104:105], v104
    ds_read_b64 v[106:107], v106
    v_lshlrev_b32_sdwa v108, 3, v125 dst_sel:DWORD dst_unused:UNUSED_PAD src0_sel:DWORD src1_sel:WORD_0
    v_lshlrev_b32_sdwa v110, 3, v125 dst_sel:DWORD dst_unused:UNUSED_PAD src0_sel:DWORD src1_sel:WORD_1
    ds_read_b64 v[108:109], v108
    ds_read_b64 v[110:111], v110
    buffer_load_dwordx4 v[124:127], v71, s[12:15], s20 offen offset:0 sc1
    s_waitcnt lgkmcnt(8)
    v_smfmac_f32_16x16x64_bf16 v[62:65], v[66:69], v[88:95], v70
    v_mfma_f32_16x16x32_bf16 v[112:115], v[72:75], v[128:131], 0
    s_waitcnt vmcnt(2)
    v_lshlrev_b32_sdwa v88, 3, v118 dst_sel:DWORD dst_unused:UNUSED_PAD src0_sel:DWORD src1_sel:WORD_0
    v_lshlrev_b32_sdwa v90, 3, v118 dst_sel:DWORD dst_unused:UNUSED_PAD src0_sel:DWORD src1_sel:WORD_1
    ds_read_b64 v[88:89], v88
    ds_read_b64 v[90:91], v90
    v_mfma_f32_16x16x32_bf16 v[112:115], v[76:79], v[132:135], v[112:115]
    v_lshlrev_b32_sdwa v92, 3, v119 dst_sel:DWORD dst_unused:UNUSED_PAD src0_sel:DWORD src1_sel:WORD_0
    v_lshlrev_b32_sdwa v94, 3, v119 dst_sel:DWORD dst_unused:UNUSED_PAD src0_sel:DWORD src1_sel:WORD_1
    v_cvt_pk_bf16_f32 v62, v62, v63
    v_cvt_pk_bf16_f32 v63, v64, v65
    v_mov_b64 v[64:65], v[32:33]
    v_and_b32 v33, s23, v31
    v_lshlrev_b32 v32, 16, v31
    v_and_b32 v31, s23, v30
    v_lshlrev_b32 v30, 16, v30
    ds_read_b64 v[92:93], v92
    ds_read_b64 v[94:95], v94
    s_waitcnt lgkmcnt(8)
    v_smfmac_f32_16x16x64_bf16 v[30:33], v[66:69], v[96:103], v70
    v_mfma_f32_16x16x32_bf16 v[112:115], v[80:83], v[136:139], v[112:115]
    v_lshlrev_b32_sdwa v96, 3, v116 dst_sel:DWORD dst_unused:UNUSED_PAD src0_sel:DWORD src1_sel:WORD_0
    v_lshlrev_b32_sdwa v98, 3, v116 dst_sel:DWORD dst_unused:UNUSED_PAD src0_sel:DWORD src1_sel:WORD_1
    ds_read_b64 v[96:97], v96
    ds_read_b64 v[98:99], v98
    v_mfma_f32_16x16x32_bf16 v[112:115], v[84:87], v[140:143], v[112:115]
    v_lshlrev_b32_sdwa v100, 3, v117 dst_sel:DWORD dst_unused:UNUSED_PAD src0_sel:DWORD src1_sel:WORD_0
    v_lshlrev_b32_sdwa v102, 3, v117 dst_sel:DWORD dst_unused:UNUSED_PAD src0_sel:DWORD src1_sel:WORD_1
    ds_read_b64 v[100:101], v100
    ds_read_b64 v[102:103], v102
    s_add_u32 s20, s20, 0xfffff000
    buffer_load_dwordx4 v[116:119], v71, s[12:15], s20 offen offset:3072 sc1
    s_waitcnt lgkmcnt(8)
    v_smfmac_f32_16x16x64_bf16 v[30:33], v[66:69], v[104:111], v70
    v_cvt_pk_bf16_f32 v112, v112, v113
    v_cvt_pk_bf16_f32 v113, v114, v115
    v_lshlrev_b32_sdwa v114, 3, v70 dst_sel:DWORD dst_unused:UNUSED_PAD src0_sel:DWORD src1_sel:WORD_1
    ds_write_b64 v114, v[112:113] offset:32768
    s_waitcnt vmcnt(2)
    v_lshlrev_b32_sdwa v104, 3, v122 dst_sel:DWORD dst_unused:UNUSED_PAD src0_sel:DWORD src1_sel:WORD_0
    v_lshlrev_b32_sdwa v106, 3, v122 dst_sel:DWORD dst_unused:UNUSED_PAD src0_sel:DWORD src1_sel:WORD_1
    ds_read_b64 v[104:105], v104
    ds_read_b64 v[106:107], v106
    v_lshlrev_b32_sdwa v108, 3, v123 dst_sel:DWORD dst_unused:UNUSED_PAD src0_sel:DWORD src1_sel:WORD_0
    v_lshlrev_b32_sdwa v110, 3, v123 dst_sel:DWORD dst_unused:UNUSED_PAD src0_sel:DWORD src1_sel:WORD_1
    v_cvt_pk_bf16_f32 v33, v32, v33
    v_cvt_pk_bf16_f32 v32, v30, v31
    v_and_b32 v31, s23, v29
    v_lshlrev_b32 v30, 16, v29
    v_and_b32 v29, s23, v28
    v_lshlrev_b32 v28, 16, v28
    ds_read_b64 v[108:109], v108
    ds_read_b64 v[110:111], v110
    s_waitcnt lgkmcnt(9)
    v_smfmac_f32_16x16x64_bf16 v[28:31], v[66:69], v[88:95], v70
    v_mfma_f32_16x16x32_bf16 v[112:115], v[72:75], v[144:147], 0
    v_lshlrev_b32_sdwa v88, 3, v120 dst_sel:DWORD dst_unused:UNUSED_PAD src0_sel:DWORD src1_sel:WORD_0
    v_lshlrev_b32_sdwa v90, 3, v120 dst_sel:DWORD dst_unused:UNUSED_PAD src0_sel:DWORD src1_sel:WORD_1
    ds_read_b64 v[88:89], v88
    ds_read_b64 v[90:91], v90
    v_mfma_f32_16x16x32_bf16 v[112:115], v[76:79], v[148:151], v[112:115]
    v_lshlrev_b32_sdwa v92, 3, v121 dst_sel:DWORD dst_unused:UNUSED_PAD src0_sel:DWORD src1_sel:WORD_0
    v_lshlrev_b32_sdwa v94, 3, v121 dst_sel:DWORD dst_unused:UNUSED_PAD src0_sel:DWORD src1_sel:WORD_1
    ds_read_b64 v[92:93], v92
    ds_read_b64 v[94:95], v94
    buffer_load_dwordx4 v[120:123], v71, s[12:15], s20 offen offset:2048 sc1
    s_waitcnt lgkmcnt(9)
    v_smfmac_f32_16x16x64_bf16 v[28:31], v[66:69], v[96:103], v70
    v_mfma_f32_16x16x32_bf16 v[112:115], v[80:83], v[152:155], v[112:115]
    s_waitcnt vmcnt(2)
    v_lshlrev_b32_sdwa v96, 3, v126 dst_sel:DWORD dst_unused:UNUSED_PAD src0_sel:DWORD src1_sel:WORD_0
    v_lshlrev_b32_sdwa v98, 3, v126 dst_sel:DWORD dst_unused:UNUSED_PAD src0_sel:DWORD src1_sel:WORD_1
    ds_read_b64 v[96:97], v96
    ds_read_b64 v[98:99], v98
    v_mfma_f32_16x16x32_bf16 v[112:115], v[84:87], v[156:159], v[112:115]
    v_lshlrev_b32_sdwa v100, 3, v127 dst_sel:DWORD dst_unused:UNUSED_PAD src0_sel:DWORD src1_sel:WORD_0
    v_lshlrev_b32_sdwa v102, 3, v127 dst_sel:DWORD dst_unused:UNUSED_PAD src0_sel:DWORD src1_sel:WORD_1
    v_cvt_pk_bf16_f32 v31, v30, v31
    v_cvt_pk_bf16_f32 v30, v28, v29
    v_and_b32 v29, s23, v27
    v_lshlrev_b32 v28, 16, v27
    v_and_b32 v27, s23, v26
    v_lshlrev_b32 v26, 16, v26
    ds_read_b64 v[100:101], v100
    ds_read_b64 v[102:103], v102
    s_waitcnt lgkmcnt(8)
    v_smfmac_f32_16x16x64_bf16 v[26:29], v[66:69], v[104:111], v70
    v_cvt_pk_bf16_f32 v112, v112, v113
    v_cvt_pk_bf16_f32 v113, v114, v115
    v_lshlrev_b32_sdwa v114, 3, v70 dst_sel:DWORD dst_unused:UNUSED_PAD src0_sel:DWORD src1_sel:WORD_1
    ds_write_b64 v114, v[112:113] offset:32896
    v_lshlrev_b32_sdwa v104, 3, v124 dst_sel:DWORD dst_unused:UNUSED_PAD src0_sel:DWORD src1_sel:WORD_0
    v_lshlrev_b32_sdwa v106, 3, v124 dst_sel:DWORD dst_unused:UNUSED_PAD src0_sel:DWORD src1_sel:WORD_1
    ds_read_b64 v[104:105], v104
    ds_read_b64 v[106:107], v106
    v_lshlrev_b32_sdwa v108, 3, v125 dst_sel:DWORD dst_unused:UNUSED_PAD src0_sel:DWORD src1_sel:WORD_0
    v_lshlrev_b32_sdwa v110, 3, v125 dst_sel:DWORD dst_unused:UNUSED_PAD src0_sel:DWORD src1_sel:WORD_1
    ds_read_b64 v[108:109], v108
    ds_read_b64 v[110:111], v110
    buffer_load_dwordx4 v[124:127], v71, s[12:15], s20 offen offset:1024 sc1
    s_waitcnt lgkmcnt(9)
    v_smfmac_f32_16x16x64_bf16 v[26:29], v[66:69], v[88:95], v70
    v_mfma_f32_16x16x32_bf16 v[112:115], v[72:75], v[160:163], 0
    s_waitcnt vmcnt(2)
    v_lshlrev_b32_sdwa v88, 3, v118 dst_sel:DWORD dst_unused:UNUSED_PAD src0_sel:DWORD src1_sel:WORD_0
    v_lshlrev_b32_sdwa v90, 3, v118 dst_sel:DWORD dst_unused:UNUSED_PAD src0_sel:DWORD src1_sel:WORD_1
    ds_read_b64 v[88:89], v88
    ds_read_b64 v[90:91], v90
    v_mfma_f32_16x16x32_bf16 v[112:115], v[76:79], v[164:167], v[112:115]
    v_lshlrev_b32_sdwa v92, 3, v119 dst_sel:DWORD dst_unused:UNUSED_PAD src0_sel:DWORD src1_sel:WORD_0
    v_lshlrev_b32_sdwa v94, 3, v119 dst_sel:DWORD dst_unused:UNUSED_PAD src0_sel:DWORD src1_sel:WORD_1
    v_cvt_pk_bf16_f32 v29, v28, v29
    v_cvt_pk_bf16_f32 v28, v26, v27
    v_and_b32 v27, s23, v25
    v_lshlrev_b32 v26, 16, v25
    v_and_b32 v25, s23, v24
    v_lshlrev_b32 v24, 16, v24
    ds_read_b64 v[92:93], v92
    ds_read_b64 v[94:95], v94
    s_waitcnt lgkmcnt(9)
    v_smfmac_f32_16x16x64_bf16 v[24:27], v[66:69], v[96:103], v70
    v_mfma_f32_16x16x32_bf16 v[112:115], v[80:83], v[168:171], v[112:115]
    v_lshlrev_b32_sdwa v96, 3, v116 dst_sel:DWORD dst_unused:UNUSED_PAD src0_sel:DWORD src1_sel:WORD_0
    v_lshlrev_b32_sdwa v98, 3, v116 dst_sel:DWORD dst_unused:UNUSED_PAD src0_sel:DWORD src1_sel:WORD_1
    ds_read_b64 v[96:97], v96
    ds_read_b64 v[98:99], v98
    v_mfma_f32_16x16x32_bf16 v[112:115], v[84:87], v[172:175], v[112:115]
    v_lshlrev_b32_sdwa v100, 3, v117 dst_sel:DWORD dst_unused:UNUSED_PAD src0_sel:DWORD src1_sel:WORD_0
    v_lshlrev_b32_sdwa v102, 3, v117 dst_sel:DWORD dst_unused:UNUSED_PAD src0_sel:DWORD src1_sel:WORD_1
    ds_read_b64 v[100:101], v100
    ds_read_b64 v[102:103], v102
    buffer_load_dwordx4 v[116:119], v71, s[12:15], s20 offen offset:0 sc1
    s_waitcnt lgkmcnt(8)
    v_smfmac_f32_16x16x64_bf16 v[24:27], v[66:69], v[104:111], v70
    s_nop 0
    v_cvt_pk_bf16_f32 v112, v112, v113
    v_cvt_pk_bf16_f32 v113, v114, v115
    v_lshlrev_b32_sdwa v114, 3, v70 dst_sel:DWORD dst_unused:UNUSED_PAD src0_sel:DWORD src1_sel:WORD_1
    ds_write_b64 v114, v[112:113] offset:33024
    s_waitcnt vmcnt(2)
    v_lshlrev_b32_sdwa v104, 3, v122 dst_sel:DWORD dst_unused:UNUSED_PAD src0_sel:DWORD src1_sel:WORD_0
    v_lshlrev_b32_sdwa v106, 3, v122 dst_sel:DWORD dst_unused:UNUSED_PAD src0_sel:DWORD src1_sel:WORD_1
    ds_read_b64 v[104:105], v104
    ds_read_b64 v[106:107], v106
    v_lshlrev_b32_sdwa v108, 3, v123 dst_sel:DWORD dst_unused:UNUSED_PAD src0_sel:DWORD src1_sel:WORD_0
    v_lshlrev_b32_sdwa v110, 3, v123 dst_sel:DWORD dst_unused:UNUSED_PAD src0_sel:DWORD src1_sel:WORD_1
    v_cvt_pk_bf16_f32 v27, v26, v27
    v_cvt_pk_bf16_f32 v26, v24, v25
    v_and_b32 v25, s23, v23
    v_lshlrev_b32 v24, 16, v23
    v_and_b32 v23, s23, v22
    v_lshlrev_b32 v22, 16, v22
    ds_read_b64 v[108:109], v108
    ds_read_b64 v[110:111], v110
    s_waitcnt lgkmcnt(9)
    v_smfmac_f32_16x16x64_bf16 v[22:25], v[66:69], v[88:95], v70
    v_mfma_f32_16x16x32_bf16 v[112:115], v[72:75], v[176:179], 0
    v_lshlrev_b32_sdwa v88, 3, v120 dst_sel:DWORD dst_unused:UNUSED_PAD src0_sel:DWORD src1_sel:WORD_0
    v_lshlrev_b32_sdwa v90, 3, v120 dst_sel:DWORD dst_unused:UNUSED_PAD src0_sel:DWORD src1_sel:WORD_1
    ds_read_b64 v[88:89], v88
    ds_read_b64 v[90:91], v90
    v_mfma_f32_16x16x32_bf16 v[112:115], v[76:79], v[180:183], v[112:115]
    v_lshlrev_b32_sdwa v92, 3, v121 dst_sel:DWORD dst_unused:UNUSED_PAD src0_sel:DWORD src1_sel:WORD_0
    v_lshlrev_b32_sdwa v94, 3, v121 dst_sel:DWORD dst_unused:UNUSED_PAD src0_sel:DWORD src1_sel:WORD_1
    ds_read_b64 v[92:93], v92
    ds_read_b64 v[94:95], v94
    s_add_u32 s20, s20, 0xfffff000
    buffer_load_dwordx4 v[120:123], v71, s[12:15], s20 offen offset:3072 sc1
    s_waitcnt lgkmcnt(9)
    v_smfmac_f32_16x16x64_bf16 v[22:25], v[66:69], v[96:103], v70
    v_mfma_f32_16x16x32_bf16 v[112:115], v[80:83], v[184:187], v[112:115]
    s_waitcnt vmcnt(2)
    v_lshlrev_b32_sdwa v96, 3, v126 dst_sel:DWORD dst_unused:UNUSED_PAD src0_sel:DWORD src1_sel:WORD_0
    v_lshlrev_b32_sdwa v98, 3, v126 dst_sel:DWORD dst_unused:UNUSED_PAD src0_sel:DWORD src1_sel:WORD_1
    ds_read_b64 v[96:97], v96
    ds_read_b64 v[98:99], v98
    v_mfma_f32_16x16x32_bf16 v[112:115], v[84:87], v[188:191], v[112:115]
    v_lshlrev_b32_sdwa v100, 3, v127 dst_sel:DWORD dst_unused:UNUSED_PAD src0_sel:DWORD src1_sel:WORD_0
    v_lshlrev_b32_sdwa v102, 3, v127 dst_sel:DWORD dst_unused:UNUSED_PAD src0_sel:DWORD src1_sel:WORD_1
    v_cvt_pk_bf16_f32 v25, v24, v25
    v_cvt_pk_bf16_f32 v24, v22, v23
    v_and_b32 v23, s23, v21
    v_lshlrev_b32 v22, 16, v21
    v_and_b32 v21, s23, v20
    v_lshlrev_b32 v20, 16, v20
    ds_read_b64 v[100:101], v100
    ds_read_b64 v[102:103], v102
    s_waitcnt lgkmcnt(8)
    v_smfmac_f32_16x16x64_bf16 v[20:23], v[66:69], v[104:111], v70
    v_cvt_pk_bf16_f32 v112, v112, v113
    v_cvt_pk_bf16_f32 v113, v114, v115
    v_lshlrev_b32_sdwa v114, 3, v70 dst_sel:DWORD dst_unused:UNUSED_PAD src0_sel:DWORD src1_sel:WORD_1
    ds_write_b64 v114, v[112:113] offset:33152
    v_lshlrev_b32_sdwa v104, 3, v124 dst_sel:DWORD dst_unused:UNUSED_PAD src0_sel:DWORD src1_sel:WORD_0
    v_lshlrev_b32_sdwa v106, 3, v124 dst_sel:DWORD dst_unused:UNUSED_PAD src0_sel:DWORD src1_sel:WORD_1
    ds_read_b64 v[104:105], v104
    ds_read_b64 v[106:107], v106
    v_lshlrev_b32_sdwa v108, 3, v125 dst_sel:DWORD dst_unused:UNUSED_PAD src0_sel:DWORD src1_sel:WORD_0
    v_lshlrev_b32_sdwa v110, 3, v125 dst_sel:DWORD dst_unused:UNUSED_PAD src0_sel:DWORD src1_sel:WORD_1
    ds_read_b64 v[108:109], v108
    ds_read_b64 v[110:111], v110
    buffer_load_dwordx4 v[124:127], v71, s[12:15], s20 offen offset:2048 sc1
    s_waitcnt lgkmcnt(9)
    v_smfmac_f32_16x16x64_bf16 v[20:23], v[66:69], v[88:95], v70
    v_mfma_f32_16x16x32_bf16 v[112:115], v[72:75], v[192:195], 0
    s_waitcnt vmcnt(2)
    v_lshlrev_b32_sdwa v88, 3, v118 dst_sel:DWORD dst_unused:UNUSED_PAD src0_sel:DWORD src1_sel:WORD_0
    v_lshlrev_b32_sdwa v90, 3, v118 dst_sel:DWORD dst_unused:UNUSED_PAD src0_sel:DWORD src1_sel:WORD_1
    ds_read_b64 v[88:89], v88
    ds_read_b64 v[90:91], v90
    v_mfma_f32_16x16x32_bf16 v[112:115], v[76:79], v[196:199], v[112:115]
    v_lshlrev_b32_sdwa v92, 3, v119 dst_sel:DWORD dst_unused:UNUSED_PAD src0_sel:DWORD src1_sel:WORD_0
    v_lshlrev_b32_sdwa v94, 3, v119 dst_sel:DWORD dst_unused:UNUSED_PAD src0_sel:DWORD src1_sel:WORD_1
    v_cvt_pk_bf16_f32 v23, v22, v23
    v_cvt_pk_bf16_f32 v22, v20, v21
    v_and_b32 v21, s23, v19
    v_lshlrev_b32 v20, 16, v19
    v_and_b32 v19, s23, v18
    v_lshlrev_b32 v18, 16, v18
    ds_read_b64 v[92:93], v92
    ds_read_b64 v[94:95], v94
    s_waitcnt lgkmcnt(9)
    v_smfmac_f32_16x16x64_bf16 v[18:21], v[66:69], v[96:103], v70
    v_mfma_f32_16x16x32_bf16 v[112:115], v[80:83], v[200:203], v[112:115]
    v_lshlrev_b32_sdwa v96, 3, v116 dst_sel:DWORD dst_unused:UNUSED_PAD src0_sel:DWORD src1_sel:WORD_0
    v_lshlrev_b32_sdwa v98, 3, v116 dst_sel:DWORD dst_unused:UNUSED_PAD src0_sel:DWORD src1_sel:WORD_1
    ds_read_b64 v[96:97], v96
    ds_read_b64 v[98:99], v98
    v_mfma_f32_16x16x32_bf16 v[112:115], v[84:87], v[204:207], v[112:115]
    v_lshlrev_b32_sdwa v100, 3, v117 dst_sel:DWORD dst_unused:UNUSED_PAD src0_sel:DWORD src1_sel:WORD_0
    v_lshlrev_b32_sdwa v102, 3, v117 dst_sel:DWORD dst_unused:UNUSED_PAD src0_sel:DWORD src1_sel:WORD_1
    ds_read_b64 v[100:101], v100
    ds_read_b64 v[102:103], v102
    buffer_load_dwordx4 v[116:119], v71, s[12:15], s20 offen offset:1024 sc1
    s_waitcnt lgkmcnt(8)
    v_smfmac_f32_16x16x64_bf16 v[18:21], v[66:69], v[104:111], v70
    s_nop 0
    v_cvt_pk_bf16_f32 v112, v112, v113
    v_cvt_pk_bf16_f32 v113, v114, v115
    v_lshlrev_b32_sdwa v114, 3, v70 dst_sel:DWORD dst_unused:UNUSED_PAD src0_sel:DWORD src1_sel:WORD_1
    ds_write_b64 v114, v[112:113] offset:33280
    s_waitcnt vmcnt(2)
    v_lshlrev_b32_sdwa v104, 3, v122 dst_sel:DWORD dst_unused:UNUSED_PAD src0_sel:DWORD src1_sel:WORD_0
    v_lshlrev_b32_sdwa v106, 3, v122 dst_sel:DWORD dst_unused:UNUSED_PAD src0_sel:DWORD src1_sel:WORD_1
    ds_read_b64 v[104:105], v104
    ds_read_b64 v[106:107], v106
    v_lshlrev_b32_sdwa v108, 3, v123 dst_sel:DWORD dst_unused:UNUSED_PAD src0_sel:DWORD src1_sel:WORD_0
    v_lshlrev_b32_sdwa v110, 3, v123 dst_sel:DWORD dst_unused:UNUSED_PAD src0_sel:DWORD src1_sel:WORD_1
    v_cvt_pk_bf16_f32 v21, v20, v21
    v_cvt_pk_bf16_f32 v20, v18, v19
    v_and_b32 v19, s23, v17
    v_lshlrev_b32 v18, 16, v17
    v_and_b32 v17, s23, v16
    v_lshlrev_b32 v16, 16, v16
    ds_read_b64 v[108:109], v108
    ds_read_b64 v[110:111], v110
    s_waitcnt lgkmcnt(9)
    v_smfmac_f32_16x16x64_bf16 v[16:19], v[66:69], v[88:95], v70
    s_setprio 2
    v_mfma_f32_16x16x32_bf16 v[112:115], v[72:75], v[208:211], 0
    v_lshlrev_b32_sdwa v88, 3, v120 dst_sel:DWORD dst_unused:UNUSED_PAD src0_sel:DWORD src1_sel:WORD_0
    v_lshlrev_b32_sdwa v90, 3, v120 dst_sel:DWORD dst_unused:UNUSED_PAD src0_sel:DWORD src1_sel:WORD_1
    ds_read_b64 v[88:89], v88
    ds_read_b64 v[90:91], v90
    v_mfma_f32_16x16x32_bf16 v[112:115], v[76:79], v[212:215], v[112:115]
    v_lshlrev_b32_sdwa v92, 3, v121 dst_sel:DWORD dst_unused:UNUSED_PAD src0_sel:DWORD src1_sel:WORD_0
    v_lshlrev_b32_sdwa v94, 3, v121 dst_sel:DWORD dst_unused:UNUSED_PAD src0_sel:DWORD src1_sel:WORD_1
    ds_read_b64 v[92:93], v92
    ds_read_b64 v[94:95], v94
    buffer_load_dwordx4 v[120:123], v71, s[12:15], s20 offen offset:0 sc1
    s_waitcnt lgkmcnt(9)
    v_smfmac_f32_16x16x64_bf16 v[16:19], v[66:69], v[96:103], v70
    v_mfma_f32_16x16x32_bf16 v[112:115], v[80:83], v[216:219], v[112:115]
    s_waitcnt vmcnt(2)
    v_lshlrev_b32_sdwa v96, 3, v126 dst_sel:DWORD dst_unused:UNUSED_PAD src0_sel:DWORD src1_sel:WORD_0
    v_lshlrev_b32_sdwa v98, 3, v126 dst_sel:DWORD dst_unused:UNUSED_PAD src0_sel:DWORD src1_sel:WORD_1
    ds_read_b64 v[96:97], v96
    ds_read_b64 v[98:99], v98
    v_mfma_f32_16x16x32_bf16 v[112:115], v[84:87], v[220:223], v[112:115]
    v_lshlrev_b32_sdwa v100, 3, v127 dst_sel:DWORD dst_unused:UNUSED_PAD src0_sel:DWORD src1_sel:WORD_0
    v_lshlrev_b32_sdwa v102, 3, v127 dst_sel:DWORD dst_unused:UNUSED_PAD src0_sel:DWORD src1_sel:WORD_1
    v_cvt_pk_bf16_f32 v19, v18, v19
    v_cvt_pk_bf16_f32 v18, v16, v17
    v_and_b32 v17, s23, v15
    v_lshlrev_b32 v16, 16, v15
    v_and_b32 v15, s23, v14
    v_lshlrev_b32 v14, 16, v14
    ds_read_b64 v[100:101], v100
    ds_read_b64 v[102:103], v102
    s_waitcnt lgkmcnt(8)
    v_smfmac_f32_16x16x64_bf16 v[14:17], v[66:69], v[104:111], v70
    v_cvt_pk_bf16_f32 v112, v112, v113
    v_cvt_pk_bf16_f32 v113, v114, v115
    v_lshlrev_b32_sdwa v114, 3, v70 dst_sel:DWORD dst_unused:UNUSED_PAD src0_sel:DWORD src1_sel:WORD_1
    ds_write_b64 v114, v[112:113] offset:33408
    v_lshlrev_b32_sdwa v104, 3, v124 dst_sel:DWORD dst_unused:UNUSED_PAD src0_sel:DWORD src1_sel:WORD_0
    v_lshlrev_b32_sdwa v106, 3, v124 dst_sel:DWORD dst_unused:UNUSED_PAD src0_sel:DWORD src1_sel:WORD_1
    ds_read_b64 v[104:105], v104
    ds_read_b64 v[106:107], v106
    v_lshlrev_b32_sdwa v108, 3, v125 dst_sel:DWORD dst_unused:UNUSED_PAD src0_sel:DWORD src1_sel:WORD_0
    v_lshlrev_b32_sdwa v110, 3, v125 dst_sel:DWORD dst_unused:UNUSED_PAD src0_sel:DWORD src1_sel:WORD_1
    ds_read_b64 v[108:109], v108
    ds_read_b64 v[110:111], v110
    s_add_u32 s20, s20, 0xfffff000
    buffer_load_dwordx4 v[124:127], v71, s[12:15], s20 offen offset:3072 sc1
    s_waitcnt lgkmcnt(9)
    v_smfmac_f32_16x16x64_bf16 v[14:17], v[66:69], v[88:95], v70
    v_mfma_f32_16x16x32_bf16 v[112:115], v[72:75], v[224:227], 0
    s_waitcnt vmcnt(2)
    v_lshlrev_b32_sdwa v88, 3, v118 dst_sel:DWORD dst_unused:UNUSED_PAD src0_sel:DWORD src1_sel:WORD_0
    v_lshlrev_b32_sdwa v90, 3, v118 dst_sel:DWORD dst_unused:UNUSED_PAD src0_sel:DWORD src1_sel:WORD_1
    ds_read_b64 v[88:89], v88
    ds_read_b64 v[90:91], v90
    v_mfma_f32_16x16x32_bf16 v[112:115], v[76:79], v[228:231], v[112:115]
    v_lshlrev_b32_sdwa v92, 3, v119 dst_sel:DWORD dst_unused:UNUSED_PAD src0_sel:DWORD src1_sel:WORD_0
    v_lshlrev_b32_sdwa v94, 3, v119 dst_sel:DWORD dst_unused:UNUSED_PAD src0_sel:DWORD src1_sel:WORD_1
    v_cvt_pk_bf16_f32 v17, v16, v17
    v_cvt_pk_bf16_f32 v16, v14, v15
    v_and_b32 v15, s23, v13
    v_lshlrev_b32 v14, 16, v13
    v_and_b32 v13, s23, v12
    v_lshlrev_b32 v12, 16, v12
    ds_read_b64 v[92:93], v92
    ds_read_b64 v[94:95], v94
    s_waitcnt lgkmcnt(9)
    v_smfmac_f32_16x16x64_bf16 v[12:15], v[66:69], v[96:103], v70
    v_mfma_f32_16x16x32_bf16 v[112:115], v[80:83], v[232:235], v[112:115]
    v_lshlrev_b32_sdwa v96, 3, v116 dst_sel:DWORD dst_unused:UNUSED_PAD src0_sel:DWORD src1_sel:WORD_0
    v_lshlrev_b32_sdwa v98, 3, v116 dst_sel:DWORD dst_unused:UNUSED_PAD src0_sel:DWORD src1_sel:WORD_1
    ds_read_b64 v[96:97], v96
    ds_read_b64 v[98:99], v98
    v_mfma_f32_16x16x32_bf16 v[112:115], v[84:87], v[236:239], v[112:115]
    v_lshlrev_b32_sdwa v100, 3, v117 dst_sel:DWORD dst_unused:UNUSED_PAD src0_sel:DWORD src1_sel:WORD_0
    v_lshlrev_b32_sdwa v102, 3, v117 dst_sel:DWORD dst_unused:UNUSED_PAD src0_sel:DWORD src1_sel:WORD_1
    ds_read_b64 v[100:101], v100
    ds_read_b64 v[102:103], v102
    buffer_load_dwordx4 v[116:119], v71, s[12:15], s20 offen offset:2048 sc1
    s_waitcnt lgkmcnt(8)
    v_smfmac_f32_16x16x64_bf16 v[12:15], v[66:69], v[104:111], v70
    s_nop 0
    v_cvt_pk_bf16_f32 v112, v112, v113
    v_cvt_pk_bf16_f32 v113, v114, v115
    v_lshlrev_b32_sdwa v114, 3, v70 dst_sel:DWORD dst_unused:UNUSED_PAD src0_sel:DWORD src1_sel:WORD_1
    ds_write_b64 v114, v[112:113] offset:33536
    s_waitcnt vmcnt(2)
    v_lshlrev_b32_sdwa v104, 3, v122 dst_sel:DWORD dst_unused:UNUSED_PAD src0_sel:DWORD src1_sel:WORD_0
    v_lshlrev_b32_sdwa v106, 3, v122 dst_sel:DWORD dst_unused:UNUSED_PAD src0_sel:DWORD src1_sel:WORD_1
    ds_read_b64 v[104:105], v104
    ds_read_b64 v[106:107], v106
    v_lshlrev_b32_sdwa v108, 3, v123 dst_sel:DWORD dst_unused:UNUSED_PAD src0_sel:DWORD src1_sel:WORD_0
    v_lshlrev_b32_sdwa v110, 3, v123 dst_sel:DWORD dst_unused:UNUSED_PAD src0_sel:DWORD src1_sel:WORD_1
    v_cvt_pk_bf16_f32 v15, v14, v15
    v_cvt_pk_bf16_f32 v14, v12, v13
    v_and_b32 v13, s23, v11
    v_lshlrev_b32 v12, 16, v11
    v_and_b32 v11, s23, v10
    v_lshlrev_b32 v10, 16, v10
    ds_read_b64 v[108:109], v108
    ds_read_b64 v[110:111], v110
    s_waitcnt lgkmcnt(9)
    v_smfmac_f32_16x16x64_bf16 v[10:13], v[66:69], v[88:95], v70
    v_mfma_f32_16x16x32_bf16 v[112:115], v[72:75], v[240:243], 0
    buffer_load_dwordx4 v[72:75], v71, s[12:15], s21 offen offset:0
    v_lshlrev_b32_sdwa v88, 3, v120 dst_sel:DWORD dst_unused:UNUSED_PAD src0_sel:DWORD src1_sel:WORD_0
    v_lshlrev_b32_sdwa v90, 3, v120 dst_sel:DWORD dst_unused:UNUSED_PAD src0_sel:DWORD src1_sel:WORD_1
    ds_read_b64 v[88:89], v88
    ds_read_b64 v[90:91], v90
    v_mfma_f32_16x16x32_bf16 v[112:115], v[76:79], v[244:247], v[112:115]
    buffer_load_dwordx4 v[76:79], v71, s[12:15], s21 offen offset:1024
    v_lshlrev_b32_sdwa v92, 3, v121 dst_sel:DWORD dst_unused:UNUSED_PAD src0_sel:DWORD src1_sel:WORD_0
    v_lshlrev_b32_sdwa v94, 3, v121 dst_sel:DWORD dst_unused:UNUSED_PAD src0_sel:DWORD src1_sel:WORD_1
    ds_read_b64 v[92:93], v92
    ds_read_b64 v[94:95], v94
    buffer_load_dwordx4 v[120:123], v71, s[12:15], s20 offen offset:1024 sc1
    s_waitcnt lgkmcnt(9)
    v_smfmac_f32_16x16x64_bf16 v[10:13], v[66:69], v[96:103], v70
    v_mfma_f32_16x16x32_bf16 v[112:115], v[80:83], v[248:251], v[112:115]
    buffer_load_dwordx4 v[80:83], v71, s[12:15], s19 offen offset:0
    s_waitcnt vmcnt(5)
    v_lshlrev_b32_sdwa v96, 3, v126 dst_sel:DWORD dst_unused:UNUSED_PAD src0_sel:DWORD src1_sel:WORD_0
    v_lshlrev_b32_sdwa v98, 3, v126 dst_sel:DWORD dst_unused:UNUSED_PAD src0_sel:DWORD src1_sel:WORD_1
    ds_read_b64 v[96:97], v96
    ds_read_b64 v[98:99], v98
    v_mfma_f32_16x16x32_bf16 v[112:115], v[84:87], v[252:255], v[112:115]
    buffer_load_dwordx4 v[84:87], v71, s[12:15], s19 offen offset:1024
    s_add_u32 s21, s21, 4096
    s_add_u32 s19, s19, 4096
    v_lshlrev_b32_sdwa v100, 3, v127 dst_sel:DWORD dst_unused:UNUSED_PAD src0_sel:DWORD src1_sel:WORD_0
    v_lshlrev_b32_sdwa v102, 3, v127 dst_sel:DWORD dst_unused:UNUSED_PAD src0_sel:DWORD src1_sel:WORD_1
    v_cvt_pk_bf16_f32 v13, v12, v13
    v_cvt_pk_bf16_f32 v12, v10, v11
    v_and_b32 v11, s23, v9
    v_lshlrev_b32 v10, 16, v9
    v_and_b32 v9, s23, v8
    v_lshlrev_b32 v8, 16, v8
    ds_read_b64 v[100:101], v100
    ds_read_b64 v[102:103], v102
    s_waitcnt lgkmcnt(8)
    v_smfmac_f32_16x16x64_bf16 v[8:11], v[66:69], v[104:111], v70
    v_cvt_pk_bf16_f32 v112, v112, v113
    v_cvt_pk_bf16_f32 v113, v114, v115
    v_lshlrev_b32_sdwa v114, 3, v70 dst_sel:DWORD dst_unused:UNUSED_PAD src0_sel:DWORD src1_sel:WORD_1
    ds_write_b64 v114, v[112:113] offset:33664
    s_setprio 1
    v_lshlrev_b32_sdwa v104, 3, v124 dst_sel:DWORD dst_unused:UNUSED_PAD src0_sel:DWORD src1_sel:WORD_0
    v_lshlrev_b32_sdwa v106, 3, v124 dst_sel:DWORD dst_unused:UNUSED_PAD src0_sel:DWORD src1_sel:WORD_1
    ds_read_b64 v[104:105], v104
    ds_read_b64 v[106:107], v106
    v_lshlrev_b32_sdwa v108, 3, v125 dst_sel:DWORD dst_unused:UNUSED_PAD src0_sel:DWORD src1_sel:WORD_0
    v_lshlrev_b32_sdwa v110, 3, v125 dst_sel:DWORD dst_unused:UNUSED_PAD src0_sel:DWORD src1_sel:WORD_1
    ds_read_b64 v[108:109], v108
    ds_read_b64 v[110:111], v110
    s_add_u32 s20, s20, 0x4000
    buffer_load_dwordx4 v[124:127], v71, s[12:15], s20 offen offset:0 sc1
    s_waitcnt lgkmcnt(9)
    v_smfmac_f32_16x16x64_bf16 v[8:11], v[66:69], v[88:95], v70
    s_waitcnt vmcnt(6)
    v_lshlrev_b32_sdwa v88, 3, v118 dst_sel:DWORD dst_unused:UNUSED_PAD src0_sel:DWORD src1_sel:WORD_0
    v_lshlrev_b32_sdwa v90, 3, v118 dst_sel:DWORD dst_unused:UNUSED_PAD src0_sel:DWORD src1_sel:WORD_1
    ds_read_b64 v[88:89], v88
    ds_read_b64 v[90:91], v90
    v_lshlrev_b32_sdwa v92, 3, v119 dst_sel:DWORD dst_unused:UNUSED_PAD src0_sel:DWORD src1_sel:WORD_0
    v_lshlrev_b32_sdwa v94, 3, v119 dst_sel:DWORD dst_unused:UNUSED_PAD src0_sel:DWORD src1_sel:WORD_1
    s_nop 0
    v_cvt_pk_bf16_f32 v11, v10, v11
    v_cvt_pk_bf16_f32 v10, v8, v9
    v_and_b32 v9, s23, v7
    v_lshlrev_b32 v8, 16, v7
    v_and_b32 v7, s23, v6
    v_lshlrev_b32 v6, 16, v6
    ds_read_b64 v[92:93], v92
    ds_read_b64 v[94:95], v94
    s_waitcnt lgkmcnt(9)
    v_smfmac_f32_16x16x64_bf16 v[6:9], v[66:69], v[96:103], v70
    v_lshlrev_b32_sdwa v96, 3, v116 dst_sel:DWORD dst_unused:UNUSED_PAD src0_sel:DWORD src1_sel:WORD_0
    v_lshlrev_b32_sdwa v98, 3, v116 dst_sel:DWORD dst_unused:UNUSED_PAD src0_sel:DWORD src1_sel:WORD_1
    ds_read_b64 v[96:97], v96
    ds_read_b64 v[98:99], v98
    v_lshlrev_b32_sdwa v100, 3, v117 dst_sel:DWORD dst_unused:UNUSED_PAD src0_sel:DWORD src1_sel:WORD_0
    v_lshlrev_b32_sdwa v102, 3, v117 dst_sel:DWORD dst_unused:UNUSED_PAD src0_sel:DWORD src1_sel:WORD_1
    ds_read_b64 v[100:101], v100
    ds_read_b64 v[102:103], v102
    s_add_u32 s20, s20, 0x1f000
    buffer_load_dwordx4 v[116:119], v71, s[12:15], s20 offen offset:3072 sc1
    s_waitcnt lgkmcnt(8)
    v_smfmac_f32_16x16x64_bf16 v[6:9], v[66:69], v[104:111], v70
    s_waitcnt vmcnt(4)
    v_lshlrev_b32_sdwa v104, 3, v122 dst_sel:DWORD dst_unused:UNUSED_PAD src0_sel:DWORD src1_sel:WORD_0
    v_lshlrev_b32_sdwa v106, 3, v122 dst_sel:DWORD dst_unused:UNUSED_PAD src0_sel:DWORD src1_sel:WORD_1
    ds_read_b64 v[104:105], v104
    ds_read_b64 v[106:107], v106
    v_lshlrev_b32_sdwa v108, 3, v123 dst_sel:DWORD dst_unused:UNUSED_PAD src0_sel:DWORD src1_sel:WORD_0
    v_lshlrev_b32_sdwa v110, 3, v123 dst_sel:DWORD dst_unused:UNUSED_PAD src0_sel:DWORD src1_sel:WORD_1
    s_nop 0
    v_cvt_pk_bf16_f32 v9, v8, v9
    v_cvt_pk_bf16_f32 v8, v6, v7
    v_and_b32 v7, s23, v5
    v_lshlrev_b32 v6, 16, v5
    v_and_b32 v5, s23, v4
    v_lshlrev_b32 v4, 16, v4
    ds_read_b64 v[108:109], v108
    ds_read_b64 v[110:111], v110
    s_waitcnt lgkmcnt(8)
    v_smfmac_f32_16x16x64_bf16 v[4:7], v[66:69], v[88:95], v70
    v_lshlrev_b32_sdwa v88, 3, v120 dst_sel:DWORD dst_unused:UNUSED_PAD src0_sel:DWORD src1_sel:WORD_0
    v_lshlrev_b32_sdwa v90, 3, v120 dst_sel:DWORD dst_unused:UNUSED_PAD src0_sel:DWORD src1_sel:WORD_1
    ds_read_b64 v[88:89], v88
    ds_read_b64 v[90:91], v90
    v_lshlrev_b32_sdwa v92, 3, v121 dst_sel:DWORD dst_unused:UNUSED_PAD src0_sel:DWORD src1_sel:WORD_0
    v_lshlrev_b32_sdwa v94, 3, v121 dst_sel:DWORD dst_unused:UNUSED_PAD src0_sel:DWORD src1_sel:WORD_1
    ds_read_b64 v[92:93], v92
    ds_read_b64 v[94:95], v94
    buffer_load_dwordx4 v[120:123], v71, s[12:15], s20 offen offset:2048 sc1
    s_waitcnt lgkmcnt(8)
    v_smfmac_f32_16x16x64_bf16 v[4:7], v[66:69], v[96:103], v70
    s_waitcnt vmcnt(2)
    v_lshlrev_b32_sdwa v96, 3, v126 dst_sel:DWORD dst_unused:UNUSED_PAD src0_sel:DWORD src1_sel:WORD_0
    v_lshlrev_b32_sdwa v98, 3, v126 dst_sel:DWORD dst_unused:UNUSED_PAD src0_sel:DWORD src1_sel:WORD_1
    ds_read_b64 v[96:97], v96
    ds_read_b64 v[98:99], v98
    v_lshlrev_b32_sdwa v100, 3, v127 dst_sel:DWORD dst_unused:UNUSED_PAD src0_sel:DWORD src1_sel:WORD_0
    v_lshlrev_b32_sdwa v102, 3, v127 dst_sel:DWORD dst_unused:UNUSED_PAD src0_sel:DWORD src1_sel:WORD_1
    s_nop 0
    v_cvt_pk_bf16_f32 v7, v6, v7
    v_cvt_pk_bf16_f32 v6, v4, v5
    v_and_b32 v5, s23, v3
    v_lshlrev_b32 v4, 16, v3
    v_and_b32 v3, s23, v2
    v_lshlrev_b32 v2, 16, v2
    ds_read_b64 v[100:101], v100
    ds_read_b64 v[102:103], v102
    s_waitcnt lgkmcnt(8)
    v_smfmac_f32_16x16x64_bf16 v[2:5], v[66:69], v[104:111], v70
    s_setprio 0
    v_lshlrev_b32_sdwa v104, 3, v124 dst_sel:DWORD dst_unused:UNUSED_PAD src0_sel:DWORD src1_sel:WORD_0
    v_lshlrev_b32_sdwa v106, 3, v124 dst_sel:DWORD dst_unused:UNUSED_PAD src0_sel:DWORD src1_sel:WORD_1
    ds_read_b64 v[104:105], v104
    ds_read_b64 v[106:107], v106
    v_lshlrev_b32_sdwa v108, 3, v125 dst_sel:DWORD dst_unused:UNUSED_PAD src0_sel:DWORD src1_sel:WORD_0
    v_lshlrev_b32_sdwa v110, 3, v125 dst_sel:DWORD dst_unused:UNUSED_PAD src0_sel:DWORD src1_sel:WORD_1
    ds_read_b64 v[108:109], v108
    ds_read_b64 v[110:111], v110
    buffer_load_dwordx4 v[124:127], v71, s[12:15], s20 offen offset:1024 sc1
    s_waitcnt lgkmcnt(8)
    v_smfmac_f32_16x16x64_bf16 v[2:5], v[66:69], v[88:95], v70
    s_waitcnt vmcnt(2)
    v_lshlrev_b32_sdwa v88, 3, v116 dst_sel:DWORD dst_unused:UNUSED_PAD src0_sel:DWORD src1_sel:WORD_0
    v_lshlrev_b32_sdwa v90, 3, v116 dst_sel:DWORD dst_unused:UNUSED_PAD src0_sel:DWORD src1_sel:WORD_1
    ds_read_b64 v[88:89], v88
    ds_read_b64 v[90:91], v90
    v_lshlrev_b32_sdwa v92, 3, v117 dst_sel:DWORD dst_unused:UNUSED_PAD src0_sel:DWORD src1_sel:WORD_0
    v_lshlrev_b32_sdwa v94, 3, v117 dst_sel:DWORD dst_unused:UNUSED_PAD src0_sel:DWORD src1_sel:WORD_1
    s_nop 0
    v_cvt_pk_bf16_f32 v5, v4, v5
    v_cvt_pk_bf16_f32 v4, v2, v3
    v_and_b32 v3, s23, v1
    v_lshlrev_b32 v2, 16, v1
    v_and_b32 v1, s23, v0
    v_lshlrev_b32 v0, 16, v0
    ds_read_b64 v[92:93], v92
    ds_read_b64 v[94:95], v94
    s_waitcnt lgkmcnt(8)
    v_smfmac_f32_16x16x64_bf16 v[0:3], v[66:69], v[96:103], v70
    s_barrier
    s_setprio 3
    v_lshlrev_b32_sdwa v96, 3, v118 dst_sel:DWORD dst_unused:UNUSED_PAD src0_sel:DWORD src1_sel:WORD_0
    v_lshlrev_b32_sdwa v98, 3, v118 dst_sel:DWORD dst_unused:UNUSED_PAD src0_sel:DWORD src1_sel:WORD_1
    ds_read_b64 v[96:97], v96
    ds_read_b64 v[98:99], v98
    v_lshlrev_b32_sdwa v100, 3, v119 dst_sel:DWORD dst_unused:UNUSED_PAD src0_sel:DWORD src1_sel:WORD_0
    v_lshlrev_b32_sdwa v102, 3, v119 dst_sel:DWORD dst_unused:UNUSED_PAD src0_sel:DWORD src1_sel:WORD_1
    ds_read_b64 v[100:101], v100
    ds_read_b64 v[102:103], v102
    buffer_load_dwordx4 v[116:119], v71, s[12:15], s20 offen offset:0 sc1
    s_waitcnt lgkmcnt(8)
    v_smfmac_f32_16x16x64_bf16 v[0:3], v[66:69], v[104:111], v70
    v_mfma_f32_16x16x32_bf16 v[112:115], v[72:75], v[128:131], 0
    s_waitcnt vmcnt(2)
    v_lshlrev_b32_sdwa v104, 3, v120 dst_sel:DWORD dst_unused:UNUSED_PAD src0_sel:DWORD src1_sel:WORD_0
    v_lshlrev_b32_sdwa v106, 3, v120 dst_sel:DWORD dst_unused:UNUSED_PAD src0_sel:DWORD src1_sel:WORD_1
    ds_read_b64 v[104:105], v104
    ds_read_b64 v[106:107], v106
    v_mfma_f32_16x16x32_bf16 v[112:115], v[76:79], v[132:135], v[112:115]
    v_add_u32 v70, 0x20000000, v70
    v_lshlrev_b32_sdwa v108, 3, v121 dst_sel:DWORD dst_unused:UNUSED_PAD src0_sel:DWORD src1_sel:WORD_0
    v_lshlrev_b32_sdwa v110, 3, v121 dst_sel:DWORD dst_unused:UNUSED_PAD src0_sel:DWORD src1_sel:WORD_1
    v_cvt_pk_bf16_f32 v3, v2, v3
    v_cvt_pk_bf16_f32 v2, v0, v1
    v_mov_b64 v[0:1], v[32:33]
    v_lshlrev_b32 v32, 16, v34
    v_and_b32 v33, s23, v34
    v_lshlrev_b32 v34, 16, v35
    v_and_b32 v35, s23, v35
    ds_read_b64 v[108:109], v108
    ds_read_b64 v[110:111], v110
    s_waitcnt lgkmcnt(8)
    v_smfmac_f32_16x16x64_bf16 v[32:35], v[66:69], v[88:95], v70
    v_mfma_f32_16x16x32_bf16 v[112:115], v[80:83], v[136:139], v[112:115]
    v_lshlrev_b32_sdwa v88, 3, v122 dst_sel:DWORD dst_unused:UNUSED_PAD src0_sel:DWORD src1_sel:WORD_0
    v_lshlrev_b32_sdwa v90, 3, v122 dst_sel:DWORD dst_unused:UNUSED_PAD src0_sel:DWORD src1_sel:WORD_1
    ds_read_b64 v[88:89], v88
    ds_read_b64 v[90:91], v90
    v_mfma_f32_16x16x32_bf16 v[112:115], v[84:87], v[140:143], v[112:115]
    v_lshlrev_b32_sdwa v92, 3, v123 dst_sel:DWORD dst_unused:UNUSED_PAD src0_sel:DWORD src1_sel:WORD_0
    v_lshlrev_b32_sdwa v94, 3, v123 dst_sel:DWORD dst_unused:UNUSED_PAD src0_sel:DWORD src1_sel:WORD_1
    ds_read_b64 v[92:93], v92
    ds_read_b64 v[94:95], v94
    s_add_u32 s20, s20, 0xfffff000
    buffer_load_dwordx4 v[120:123], v71, s[12:15], s20 offen offset:3072 sc1
    s_waitcnt lgkmcnt(8)
    v_smfmac_f32_16x16x64_bf16 v[32:35], v[66:69], v[96:103], v70
    v_cvt_pk_bf16_f32 v112, v112, v113
    v_cvt_pk_bf16_f32 v113, v114, v115
    v_lshlrev_b32_sdwa v114, 3, v70 dst_sel:DWORD dst_unused:UNUSED_PAD src0_sel:DWORD src1_sel:WORD_1
    ds_write_b64 v114, v[112:113] offset:0
    s_waitcnt vmcnt(2)
    v_lshlrev_b32_sdwa v96, 3, v124 dst_sel:DWORD dst_unused:UNUSED_PAD src0_sel:DWORD src1_sel:WORD_0
    v_lshlrev_b32_sdwa v98, 3, v124 dst_sel:DWORD dst_unused:UNUSED_PAD src0_sel:DWORD src1_sel:WORD_1
    ds_read_b64 v[96:97], v96
    ds_read_b64 v[98:99], v98
    v_lshlrev_b32_sdwa v100, 3, v125 dst_sel:DWORD dst_unused:UNUSED_PAD src0_sel:DWORD src1_sel:WORD_0
    v_lshlrev_b32_sdwa v102, 3, v125 dst_sel:DWORD dst_unused:UNUSED_PAD src0_sel:DWORD src1_sel:WORD_1
    v_cvt_pk_bf16_f32 v32, v32, v33
    v_cvt_pk_bf16_f32 v33, v34, v35
    v_lshlrev_b32 v34, 16, v36
    v_and_b32 v35, s23, v36
    v_lshlrev_b32 v36, 16, v37
    v_and_b32 v37, s23, v37
    ds_read_b64 v[100:101], v100
    ds_read_b64 v[102:103], v102
    s_waitcnt lgkmcnt(9)
    v_smfmac_f32_16x16x64_bf16 v[34:37], v[66:69], v[104:111], v70
    v_mfma_f32_16x16x32_bf16 v[112:115], v[72:75], v[144:147], 0
    v_lshlrev_b32_sdwa v104, 3, v126 dst_sel:DWORD dst_unused:UNUSED_PAD src0_sel:DWORD src1_sel:WORD_0
    v_lshlrev_b32_sdwa v106, 3, v126 dst_sel:DWORD dst_unused:UNUSED_PAD src0_sel:DWORD src1_sel:WORD_1
    ds_read_b64 v[104:105], v104
    ds_read_b64 v[106:107], v106
    v_mfma_f32_16x16x32_bf16 v[112:115], v[76:79], v[148:151], v[112:115]
    v_lshlrev_b32_sdwa v108, 3, v127 dst_sel:DWORD dst_unused:UNUSED_PAD src0_sel:DWORD src1_sel:WORD_0
    v_lshlrev_b32_sdwa v110, 3, v127 dst_sel:DWORD dst_unused:UNUSED_PAD src0_sel:DWORD src1_sel:WORD_1
    ds_read_b64 v[108:109], v108
    ds_read_b64 v[110:111], v110
    buffer_load_dwordx4 v[124:127], v71, s[12:15], s20 offen offset:2048 sc1
    s_waitcnt lgkmcnt(9)
    v_smfmac_f32_16x16x64_bf16 v[34:37], v[66:69], v[88:95], v70
    v_mfma_f32_16x16x32_bf16 v[112:115], v[80:83], v[152:155], v[112:115]
    s_waitcnt vmcnt(2)
    v_lshlrev_b32_sdwa v88, 3, v116 dst_sel:DWORD dst_unused:UNUSED_PAD src0_sel:DWORD src1_sel:WORD_0
    v_lshlrev_b32_sdwa v90, 3, v116 dst_sel:DWORD dst_unused:UNUSED_PAD src0_sel:DWORD src1_sel:WORD_1
    ds_read_b64 v[88:89], v88
    ds_read_b64 v[90:91], v90
    v_mfma_f32_16x16x32_bf16 v[112:115], v[84:87], v[156:159], v[112:115]
    v_lshlrev_b32_sdwa v92, 3, v117 dst_sel:DWORD dst_unused:UNUSED_PAD src0_sel:DWORD src1_sel:WORD_0
    v_lshlrev_b32_sdwa v94, 3, v117 dst_sel:DWORD dst_unused:UNUSED_PAD src0_sel:DWORD src1_sel:WORD_1
    v_cvt_pk_bf16_f32 v34, v34, v35
    v_cvt_pk_bf16_f32 v35, v36, v37
    v_lshlrev_b32 v36, 16, v38
    v_and_b32 v37, s23, v38
    v_lshlrev_b32 v38, 16, v39
    v_and_b32 v39, s23, v39
    ds_read_b64 v[92:93], v92
    ds_read_b64 v[94:95], v94
    s_waitcnt lgkmcnt(8)
    v_smfmac_f32_16x16x64_bf16 v[36:39], v[66:69], v[96:103], v70
    v_cvt_pk_bf16_f32 v112, v112, v113
    v_cvt_pk_bf16_f32 v113, v114, v115
    v_lshlrev_b32_sdwa v114, 3, v70 dst_sel:DWORD dst_unused:UNUSED_PAD src0_sel:DWORD src1_sel:WORD_1
    ds_write_b64 v114, v[112:113] offset:128
    v_lshlrev_b32_sdwa v96, 3, v118 dst_sel:DWORD dst_unused:UNUSED_PAD src0_sel:DWORD src1_sel:WORD_0
    v_lshlrev_b32_sdwa v98, 3, v118 dst_sel:DWORD dst_unused:UNUSED_PAD src0_sel:DWORD src1_sel:WORD_1
    ds_read_b64 v[96:97], v96
    ds_read_b64 v[98:99], v98
    v_lshlrev_b32_sdwa v100, 3, v119 dst_sel:DWORD dst_unused:UNUSED_PAD src0_sel:DWORD src1_sel:WORD_0
    v_lshlrev_b32_sdwa v102, 3, v119 dst_sel:DWORD dst_unused:UNUSED_PAD src0_sel:DWORD src1_sel:WORD_1
    ds_read_b64 v[100:101], v100
    ds_read_b64 v[102:103], v102
    buffer_load_dwordx4 v[116:119], v71, s[12:15], s20 offen offset:1024 sc1
    s_waitcnt lgkmcnt(9)
    v_smfmac_f32_16x16x64_bf16 v[36:39], v[66:69], v[104:111], v70
    v_mfma_f32_16x16x32_bf16 v[112:115], v[72:75], v[160:163], 0
    s_waitcnt vmcnt(2)
    v_lshlrev_b32_sdwa v104, 3, v120 dst_sel:DWORD dst_unused:UNUSED_PAD src0_sel:DWORD src1_sel:WORD_0
    v_lshlrev_b32_sdwa v106, 3, v120 dst_sel:DWORD dst_unused:UNUSED_PAD src0_sel:DWORD src1_sel:WORD_1
    ds_read_b64 v[104:105], v104
    ds_read_b64 v[106:107], v106
    v_mfma_f32_16x16x32_bf16 v[112:115], v[76:79], v[164:167], v[112:115]
    v_lshlrev_b32_sdwa v108, 3, v121 dst_sel:DWORD dst_unused:UNUSED_PAD src0_sel:DWORD src1_sel:WORD_0
    v_lshlrev_b32_sdwa v110, 3, v121 dst_sel:DWORD dst_unused:UNUSED_PAD src0_sel:DWORD src1_sel:WORD_1
    v_cvt_pk_bf16_f32 v36, v36, v37
    v_cvt_pk_bf16_f32 v37, v38, v39
    v_lshlrev_b32 v38, 16, v40
    v_and_b32 v39, s23, v40
    v_lshlrev_b32 v40, 16, v41
    v_and_b32 v41, s23, v41
    ds_read_b64 v[108:109], v108
    ds_read_b64 v[110:111], v110
    s_waitcnt lgkmcnt(9)
    v_smfmac_f32_16x16x64_bf16 v[38:41], v[66:69], v[88:95], v70
    v_mfma_f32_16x16x32_bf16 v[112:115], v[80:83], v[168:171], v[112:115]
    v_lshlrev_b32_sdwa v88, 3, v122 dst_sel:DWORD dst_unused:UNUSED_PAD src0_sel:DWORD src1_sel:WORD_0
    v_lshlrev_b32_sdwa v90, 3, v122 dst_sel:DWORD dst_unused:UNUSED_PAD src0_sel:DWORD src1_sel:WORD_1
    ds_read_b64 v[88:89], v88
    ds_read_b64 v[90:91], v90
    v_mfma_f32_16x16x32_bf16 v[112:115], v[84:87], v[172:175], v[112:115]
    v_lshlrev_b32_sdwa v92, 3, v123 dst_sel:DWORD dst_unused:UNUSED_PAD src0_sel:DWORD src1_sel:WORD_0
    v_lshlrev_b32_sdwa v94, 3, v123 dst_sel:DWORD dst_unused:UNUSED_PAD src0_sel:DWORD src1_sel:WORD_1
    ds_read_b64 v[92:93], v92
    ds_read_b64 v[94:95], v94
    buffer_load_dwordx4 v[120:123], v71, s[12:15], s20 offen offset:0 sc1
    s_waitcnt lgkmcnt(8)
    v_smfmac_f32_16x16x64_bf16 v[38:41], v[66:69], v[96:103], v70
    s_nop 0
    v_cvt_pk_bf16_f32 v112, v112, v113
    v_cvt_pk_bf16_f32 v113, v114, v115
    v_lshlrev_b32_sdwa v114, 3, v70 dst_sel:DWORD dst_unused:UNUSED_PAD src0_sel:DWORD src1_sel:WORD_1
    ds_write_b64 v114, v[112:113] offset:256
    s_waitcnt vmcnt(2)
    v_lshlrev_b32_sdwa v96, 3, v124 dst_sel:DWORD dst_unused:UNUSED_PAD src0_sel:DWORD src1_sel:WORD_0
    v_lshlrev_b32_sdwa v98, 3, v124 dst_sel:DWORD dst_unused:UNUSED_PAD src0_sel:DWORD src1_sel:WORD_1
    ds_read_b64 v[96:97], v96
    ds_read_b64 v[98:99], v98
    v_lshlrev_b32_sdwa v100, 3, v125 dst_sel:DWORD dst_unused:UNUSED_PAD src0_sel:DWORD src1_sel:WORD_0
    v_lshlrev_b32_sdwa v102, 3, v125 dst_sel:DWORD dst_unused:UNUSED_PAD src0_sel:DWORD src1_sel:WORD_1
    v_cvt_pk_bf16_f32 v38, v38, v39
    v_cvt_pk_bf16_f32 v39, v40, v41
    v_lshlrev_b32 v40, 16, v42
    v_and_b32 v41, s23, v42
    v_lshlrev_b32 v42, 16, v43
    v_and_b32 v43, s23, v43
    ds_read_b64 v[100:101], v100
    ds_read_b64 v[102:103], v102
    s_waitcnt lgkmcnt(9)
    v_smfmac_f32_16x16x64_bf16 v[40:43], v[66:69], v[104:111], v70
    v_mfma_f32_16x16x32_bf16 v[112:115], v[72:75], v[176:179], 0
    v_lshlrev_b32_sdwa v104, 3, v126 dst_sel:DWORD dst_unused:UNUSED_PAD src0_sel:DWORD src1_sel:WORD_0
    v_lshlrev_b32_sdwa v106, 3, v126 dst_sel:DWORD dst_unused:UNUSED_PAD src0_sel:DWORD src1_sel:WORD_1
    ds_read_b64 v[104:105], v104
    ds_read_b64 v[106:107], v106
    v_mfma_f32_16x16x32_bf16 v[112:115], v[76:79], v[180:183], v[112:115]
    v_lshlrev_b32_sdwa v108, 3, v127 dst_sel:DWORD dst_unused:UNUSED_PAD src0_sel:DWORD src1_sel:WORD_0
    v_lshlrev_b32_sdwa v110, 3, v127 dst_sel:DWORD dst_unused:UNUSED_PAD src0_sel:DWORD src1_sel:WORD_1
    ds_read_b64 v[108:109], v108
    ds_read_b64 v[110:111], v110
    s_add_u32 s20, s20, 0xfffff000
    buffer_load_dwordx4 v[124:127], v71, s[12:15], s20 offen offset:3072 sc1
    s_waitcnt lgkmcnt(9)
    v_smfmac_f32_16x16x64_bf16 v[40:43], v[66:69], v[88:95], v70
    v_mfma_f32_16x16x32_bf16 v[112:115], v[80:83], v[184:187], v[112:115]
    s_waitcnt vmcnt(2)
    v_lshlrev_b32_sdwa v88, 3, v116 dst_sel:DWORD dst_unused:UNUSED_PAD src0_sel:DWORD src1_sel:WORD_0
    v_lshlrev_b32_sdwa v90, 3, v116 dst_sel:DWORD dst_unused:UNUSED_PAD src0_sel:DWORD src1_sel:WORD_1
    ds_read_b64 v[88:89], v88
    ds_read_b64 v[90:91], v90
    v_mfma_f32_16x16x32_bf16 v[112:115], v[84:87], v[188:191], v[112:115]
    v_lshlrev_b32_sdwa v92, 3, v117 dst_sel:DWORD dst_unused:UNUSED_PAD src0_sel:DWORD src1_sel:WORD_0
    v_lshlrev_b32_sdwa v94, 3, v117 dst_sel:DWORD dst_unused:UNUSED_PAD src0_sel:DWORD src1_sel:WORD_1
    v_cvt_pk_bf16_f32 v40, v40, v41
    v_cvt_pk_bf16_f32 v41, v42, v43
    v_lshlrev_b32 v42, 16, v44
    v_and_b32 v43, s23, v44
    v_lshlrev_b32 v44, 16, v45
    v_and_b32 v45, s23, v45
    ds_read_b64 v[92:93], v92
    ds_read_b64 v[94:95], v94
    s_waitcnt lgkmcnt(8)
    v_smfmac_f32_16x16x64_bf16 v[42:45], v[66:69], v[96:103], v70
    v_cvt_pk_bf16_f32 v112, v112, v113
    v_cvt_pk_bf16_f32 v113, v114, v115
    v_lshlrev_b32_sdwa v114, 3, v70 dst_sel:DWORD dst_unused:UNUSED_PAD src0_sel:DWORD src1_sel:WORD_1
    ds_write_b64 v114, v[112:113] offset:384
    v_lshlrev_b32_sdwa v96, 3, v118 dst_sel:DWORD dst_unused:UNUSED_PAD src0_sel:DWORD src1_sel:WORD_0
    v_lshlrev_b32_sdwa v98, 3, v118 dst_sel:DWORD dst_unused:UNUSED_PAD src0_sel:DWORD src1_sel:WORD_1
    ds_read_b64 v[96:97], v96
    ds_read_b64 v[98:99], v98
    v_lshlrev_b32_sdwa v100, 3, v119 dst_sel:DWORD dst_unused:UNUSED_PAD src0_sel:DWORD src1_sel:WORD_0
    v_lshlrev_b32_sdwa v102, 3, v119 dst_sel:DWORD dst_unused:UNUSED_PAD src0_sel:DWORD src1_sel:WORD_1
    ds_read_b64 v[100:101], v100
    ds_read_b64 v[102:103], v102
    buffer_load_dwordx4 v[116:119], v71, s[12:15], s20 offen offset:2048 sc1
    s_waitcnt lgkmcnt(9)
    v_smfmac_f32_16x16x64_bf16 v[42:45], v[66:69], v[104:111], v70
    v_mfma_f32_16x16x32_bf16 v[112:115], v[72:75], v[192:195], 0
    s_waitcnt vmcnt(2)
    v_lshlrev_b32_sdwa v104, 3, v120 dst_sel:DWORD dst_unused:UNUSED_PAD src0_sel:DWORD src1_sel:WORD_0
    v_lshlrev_b32_sdwa v106, 3, v120 dst_sel:DWORD dst_unused:UNUSED_PAD src0_sel:DWORD src1_sel:WORD_1
    ds_read_b64 v[104:105], v104
    ds_read_b64 v[106:107], v106
    v_mfma_f32_16x16x32_bf16 v[112:115], v[76:79], v[196:199], v[112:115]
    v_lshlrev_b32_sdwa v108, 3, v121 dst_sel:DWORD dst_unused:UNUSED_PAD src0_sel:DWORD src1_sel:WORD_0
    v_lshlrev_b32_sdwa v110, 3, v121 dst_sel:DWORD dst_unused:UNUSED_PAD src0_sel:DWORD src1_sel:WORD_1
    v_cvt_pk_bf16_f32 v42, v42, v43
    v_cvt_pk_bf16_f32 v43, v44, v45
    v_lshlrev_b32 v44, 16, v46
    v_and_b32 v45, s23, v46
    v_lshlrev_b32 v46, 16, v47
    v_and_b32 v47, s23, v47
    ds_read_b64 v[108:109], v108
    ds_read_b64 v[110:111], v110
    s_waitcnt lgkmcnt(9)
    v_smfmac_f32_16x16x64_bf16 v[44:47], v[66:69], v[88:95], v70
    v_mfma_f32_16x16x32_bf16 v[112:115], v[80:83], v[200:203], v[112:115]
    v_lshlrev_b32_sdwa v88, 3, v122 dst_sel:DWORD dst_unused:UNUSED_PAD src0_sel:DWORD src1_sel:WORD_0
    v_lshlrev_b32_sdwa v90, 3, v122 dst_sel:DWORD dst_unused:UNUSED_PAD src0_sel:DWORD src1_sel:WORD_1
    ds_read_b64 v[88:89], v88
    ds_read_b64 v[90:91], v90
    v_mfma_f32_16x16x32_bf16 v[112:115], v[84:87], v[204:207], v[112:115]
    v_lshlrev_b32_sdwa v92, 3, v123 dst_sel:DWORD dst_unused:UNUSED_PAD src0_sel:DWORD src1_sel:WORD_0
    v_lshlrev_b32_sdwa v94, 3, v123 dst_sel:DWORD dst_unused:UNUSED_PAD src0_sel:DWORD src1_sel:WORD_1
    ds_read_b64 v[92:93], v92
    ds_read_b64 v[94:95], v94
    buffer_load_dwordx4 v[120:123], v71, s[12:15], s20 offen offset:1024 sc1
    s_waitcnt lgkmcnt(8)
    v_smfmac_f32_16x16x64_bf16 v[44:47], v[66:69], v[96:103], v70
    s_nop 0
    v_cvt_pk_bf16_f32 v112, v112, v113
    v_cvt_pk_bf16_f32 v113, v114, v115
    v_lshlrev_b32_sdwa v114, 3, v70 dst_sel:DWORD dst_unused:UNUSED_PAD src0_sel:DWORD src1_sel:WORD_1
    ds_write_b64 v114, v[112:113] offset:512
    s_waitcnt vmcnt(2)
    v_lshlrev_b32_sdwa v96, 3, v124 dst_sel:DWORD dst_unused:UNUSED_PAD src0_sel:DWORD src1_sel:WORD_0
    v_lshlrev_b32_sdwa v98, 3, v124 dst_sel:DWORD dst_unused:UNUSED_PAD src0_sel:DWORD src1_sel:WORD_1
    ds_read_b64 v[96:97], v96
    ds_read_b64 v[98:99], v98
    v_lshlrev_b32_sdwa v100, 3, v125 dst_sel:DWORD dst_unused:UNUSED_PAD src0_sel:DWORD src1_sel:WORD_0
    v_lshlrev_b32_sdwa v102, 3, v125 dst_sel:DWORD dst_unused:UNUSED_PAD src0_sel:DWORD src1_sel:WORD_1
    v_cvt_pk_bf16_f32 v44, v44, v45
    v_cvt_pk_bf16_f32 v45, v46, v47
    v_lshlrev_b32 v46, 16, v48
    v_and_b32 v47, s23, v48
    v_lshlrev_b32 v48, 16, v49
    v_and_b32 v49, s23, v49
    ds_read_b64 v[100:101], v100
    ds_read_b64 v[102:103], v102
    s_waitcnt lgkmcnt(9)
    v_smfmac_f32_16x16x64_bf16 v[46:49], v[66:69], v[104:111], v70
    s_setprio 2
    v_mfma_f32_16x16x32_bf16 v[112:115], v[72:75], v[208:211], 0
    v_lshlrev_b32_sdwa v104, 3, v126 dst_sel:DWORD dst_unused:UNUSED_PAD src0_sel:DWORD src1_sel:WORD_0
    v_lshlrev_b32_sdwa v106, 3, v126 dst_sel:DWORD dst_unused:UNUSED_PAD src0_sel:DWORD src1_sel:WORD_1
    ds_read_b64 v[104:105], v104
    ds_read_b64 v[106:107], v106
    v_mfma_f32_16x16x32_bf16 v[112:115], v[76:79], v[212:215], v[112:115]
    v_lshlrev_b32_sdwa v108, 3, v127 dst_sel:DWORD dst_unused:UNUSED_PAD src0_sel:DWORD src1_sel:WORD_0
    v_lshlrev_b32_sdwa v110, 3, v127 dst_sel:DWORD dst_unused:UNUSED_PAD src0_sel:DWORD src1_sel:WORD_1
    ds_read_b64 v[108:109], v108
    ds_read_b64 v[110:111], v110
    buffer_load_dwordx4 v[124:127], v71, s[12:15], s20 offen offset:0 sc1
    s_waitcnt lgkmcnt(9)
    v_smfmac_f32_16x16x64_bf16 v[46:49], v[66:69], v[88:95], v70
    v_mfma_f32_16x16x32_bf16 v[112:115], v[80:83], v[216:219], v[112:115]
    s_waitcnt vmcnt(2)
    v_lshlrev_b32_sdwa v88, 3, v116 dst_sel:DWORD dst_unused:UNUSED_PAD src0_sel:DWORD src1_sel:WORD_0
    v_lshlrev_b32_sdwa v90, 3, v116 dst_sel:DWORD dst_unused:UNUSED_PAD src0_sel:DWORD src1_sel:WORD_1
    ds_read_b64 v[88:89], v88
    ds_read_b64 v[90:91], v90
    v_mfma_f32_16x16x32_bf16 v[112:115], v[84:87], v[220:223], v[112:115]
    v_lshlrev_b32_sdwa v92, 3, v117 dst_sel:DWORD dst_unused:UNUSED_PAD src0_sel:DWORD src1_sel:WORD_0
    v_lshlrev_b32_sdwa v94, 3, v117 dst_sel:DWORD dst_unused:UNUSED_PAD src0_sel:DWORD src1_sel:WORD_1
    v_cvt_pk_bf16_f32 v46, v46, v47
    v_cvt_pk_bf16_f32 v47, v48, v49
    v_lshlrev_b32 v48, 16, v50
    v_and_b32 v49, s23, v50
    v_lshlrev_b32 v50, 16, v51
    v_and_b32 v51, s23, v51
    ds_read_b64 v[92:93], v92
    ds_read_b64 v[94:95], v94
    s_waitcnt lgkmcnt(8)
    v_smfmac_f32_16x16x64_bf16 v[48:51], v[66:69], v[96:103], v70
    v_cvt_pk_bf16_f32 v112, v112, v113
    v_cvt_pk_bf16_f32 v113, v114, v115
    v_lshlrev_b32_sdwa v114, 3, v70 dst_sel:DWORD dst_unused:UNUSED_PAD src0_sel:DWORD src1_sel:WORD_1
    ds_write_b64 v114, v[112:113] offset:640
    v_lshlrev_b32_sdwa v96, 3, v118 dst_sel:DWORD dst_unused:UNUSED_PAD src0_sel:DWORD src1_sel:WORD_0
    v_lshlrev_b32_sdwa v98, 3, v118 dst_sel:DWORD dst_unused:UNUSED_PAD src0_sel:DWORD src1_sel:WORD_1
    ds_read_b64 v[96:97], v96
    ds_read_b64 v[98:99], v98
    v_lshlrev_b32_sdwa v100, 3, v119 dst_sel:DWORD dst_unused:UNUSED_PAD src0_sel:DWORD src1_sel:WORD_0
    v_lshlrev_b32_sdwa v102, 3, v119 dst_sel:DWORD dst_unused:UNUSED_PAD src0_sel:DWORD src1_sel:WORD_1
    ds_read_b64 v[100:101], v100
    ds_read_b64 v[102:103], v102
    s_add_u32 s20, s20, 0xfffff000
    buffer_load_dwordx4 v[116:119], v71, s[12:15], s20 offen offset:3072 sc1
    s_waitcnt lgkmcnt(9)
    v_smfmac_f32_16x16x64_bf16 v[48:51], v[66:69], v[104:111], v70
    v_mfma_f32_16x16x32_bf16 v[112:115], v[72:75], v[224:227], 0
    s_waitcnt vmcnt(2)
    v_lshlrev_b32_sdwa v104, 3, v120 dst_sel:DWORD dst_unused:UNUSED_PAD src0_sel:DWORD src1_sel:WORD_0
    v_lshlrev_b32_sdwa v106, 3, v120 dst_sel:DWORD dst_unused:UNUSED_PAD src0_sel:DWORD src1_sel:WORD_1
    ds_read_b64 v[104:105], v104
    ds_read_b64 v[106:107], v106
    v_mfma_f32_16x16x32_bf16 v[112:115], v[76:79], v[228:231], v[112:115]
    v_lshlrev_b32_sdwa v108, 3, v121 dst_sel:DWORD dst_unused:UNUSED_PAD src0_sel:DWORD src1_sel:WORD_0
    v_lshlrev_b32_sdwa v110, 3, v121 dst_sel:DWORD dst_unused:UNUSED_PAD src0_sel:DWORD src1_sel:WORD_1
    v_cvt_pk_bf16_f32 v48, v48, v49
    v_cvt_pk_bf16_f32 v49, v50, v51
    v_lshlrev_b32 v50, 16, v52
    v_and_b32 v51, s23, v52
    v_lshlrev_b32 v52, 16, v53
    v_and_b32 v53, s23, v53
    ds_read_b64 v[108:109], v108
    ds_read_b64 v[110:111], v110
    s_waitcnt lgkmcnt(9)
    v_smfmac_f32_16x16x64_bf16 v[50:53], v[66:69], v[88:95], v70
    v_mfma_f32_16x16x32_bf16 v[112:115], v[80:83], v[232:235], v[112:115]
    v_lshlrev_b32_sdwa v88, 3, v122 dst_sel:DWORD dst_unused:UNUSED_PAD src0_sel:DWORD src1_sel:WORD_0
    v_lshlrev_b32_sdwa v90, 3, v122 dst_sel:DWORD dst_unused:UNUSED_PAD src0_sel:DWORD src1_sel:WORD_1
    ds_read_b64 v[88:89], v88
    ds_read_b64 v[90:91], v90
    v_mfma_f32_16x16x32_bf16 v[112:115], v[84:87], v[236:239], v[112:115]
    v_lshlrev_b32_sdwa v92, 3, v123 dst_sel:DWORD dst_unused:UNUSED_PAD src0_sel:DWORD src1_sel:WORD_0
    v_lshlrev_b32_sdwa v94, 3, v123 dst_sel:DWORD dst_unused:UNUSED_PAD src0_sel:DWORD src1_sel:WORD_1
    ds_read_b64 v[92:93], v92
    ds_read_b64 v[94:95], v94
    buffer_load_dwordx4 v[120:123], v71, s[12:15], s20 offen offset:2048 sc1
    s_waitcnt lgkmcnt(8)
    v_smfmac_f32_16x16x64_bf16 v[50:53], v[66:69], v[96:103], v70
    s_nop 0
    v_cvt_pk_bf16_f32 v112, v112, v113
    v_cvt_pk_bf16_f32 v113, v114, v115
    v_lshlrev_b32_sdwa v114, 3, v70 dst_sel:DWORD dst_unused:UNUSED_PAD src0_sel:DWORD src1_sel:WORD_1
    ds_write_b64 v114, v[112:113] offset:768
    s_waitcnt vmcnt(2)
    v_lshlrev_b32_sdwa v96, 3, v124 dst_sel:DWORD dst_unused:UNUSED_PAD src0_sel:DWORD src1_sel:WORD_0
    v_lshlrev_b32_sdwa v98, 3, v124 dst_sel:DWORD dst_unused:UNUSED_PAD src0_sel:DWORD src1_sel:WORD_1
    ds_read_b64 v[96:97], v96
    ds_read_b64 v[98:99], v98
    v_lshlrev_b32_sdwa v100, 3, v125 dst_sel:DWORD dst_unused:UNUSED_PAD src0_sel:DWORD src1_sel:WORD_0
    v_lshlrev_b32_sdwa v102, 3, v125 dst_sel:DWORD dst_unused:UNUSED_PAD src0_sel:DWORD src1_sel:WORD_1
    v_cvt_pk_bf16_f32 v50, v50, v51
    v_cvt_pk_bf16_f32 v51, v52, v53
    v_lshlrev_b32 v52, 16, v54
    v_and_b32 v53, s23, v54
    v_lshlrev_b32 v54, 16, v55
    v_and_b32 v55, s23, v55
    ds_read_b64 v[100:101], v100
    ds_read_b64 v[102:103], v102
    s_waitcnt lgkmcnt(9)
    v_smfmac_f32_16x16x64_bf16 v[52:55], v[66:69], v[104:111], v70
    v_mfma_f32_16x16x32_bf16 v[112:115], v[72:75], v[240:243], 0
    buffer_load_dwordx4 v[72:75], v71, s[12:15], s21 offen offset:0
    v_lshlrev_b32_sdwa v104, 3, v126 dst_sel:DWORD dst_unused:UNUSED_PAD src0_sel:DWORD src1_sel:WORD_0
    v_lshlrev_b32_sdwa v106, 3, v126 dst_sel:DWORD dst_unused:UNUSED_PAD src0_sel:DWORD src1_sel:WORD_1
    ds_read_b64 v[104:105], v104
    ds_read_b64 v[106:107], v106
    v_mfma_f32_16x16x32_bf16 v[112:115], v[76:79], v[244:247], v[112:115]
    buffer_load_dwordx4 v[76:79], v71, s[12:15], s21 offen offset:1024
    v_lshlrev_b32_sdwa v108, 3, v127 dst_sel:DWORD dst_unused:UNUSED_PAD src0_sel:DWORD src1_sel:WORD_0
    v_lshlrev_b32_sdwa v110, 3, v127 dst_sel:DWORD dst_unused:UNUSED_PAD src0_sel:DWORD src1_sel:WORD_1
    ds_read_b64 v[108:109], v108
    ds_read_b64 v[110:111], v110
    buffer_load_dwordx4 v[124:127], v71, s[12:15], s20 offen offset:1024 sc1
    s_waitcnt lgkmcnt(9)
    v_smfmac_f32_16x16x64_bf16 v[52:55], v[66:69], v[88:95], v70
    v_mfma_f32_16x16x32_bf16 v[112:115], v[80:83], v[248:251], v[112:115]
    buffer_load_dwordx4 v[80:83], v71, s[12:15], s19 offen offset:0
    s_waitcnt vmcnt(5)
    v_lshlrev_b32_sdwa v88, 3, v116 dst_sel:DWORD dst_unused:UNUSED_PAD src0_sel:DWORD src1_sel:WORD_0
    v_lshlrev_b32_sdwa v90, 3, v116 dst_sel:DWORD dst_unused:UNUSED_PAD src0_sel:DWORD src1_sel:WORD_1
    ds_read_b64 v[88:89], v88
    ds_read_b64 v[90:91], v90
    v_mfma_f32_16x16x32_bf16 v[112:115], v[84:87], v[252:255], v[112:115]
    buffer_load_dwordx4 v[84:87], v71, s[12:15], s19 offen offset:1024
    s_add_u32 s21, s21, 4096
    s_add_u32 s19, s19, 4096
    v_lshlrev_b32_sdwa v92, 3, v117 dst_sel:DWORD dst_unused:UNUSED_PAD src0_sel:DWORD src1_sel:WORD_0
    v_lshlrev_b32_sdwa v94, 3, v117 dst_sel:DWORD dst_unused:UNUSED_PAD src0_sel:DWORD src1_sel:WORD_1
    v_cvt_pk_bf16_f32 v52, v52, v53
    v_cvt_pk_bf16_f32 v53, v54, v55
    v_lshlrev_b32 v54, 16, v56
    v_and_b32 v55, s23, v56
    v_lshlrev_b32 v56, 16, v57
    v_and_b32 v57, s23, v57
    ds_read_b64 v[92:93], v92
    ds_read_b64 v[94:95], v94
    s_waitcnt lgkmcnt(8)
    v_smfmac_f32_16x16x64_bf16 v[54:57], v[66:69], v[96:103], v70
    v_cvt_pk_bf16_f32 v112, v112, v113
    v_cvt_pk_bf16_f32 v113, v114, v115
    v_lshlrev_b32_sdwa v114, 3, v70 dst_sel:DWORD dst_unused:UNUSED_PAD src0_sel:DWORD src1_sel:WORD_1
    ds_write_b64 v114, v[112:113] offset:896
    s_setprio 1
    v_lshlrev_b32_sdwa v96, 3, v118 dst_sel:DWORD dst_unused:UNUSED_PAD src0_sel:DWORD src1_sel:WORD_0
    v_lshlrev_b32_sdwa v98, 3, v118 dst_sel:DWORD dst_unused:UNUSED_PAD src0_sel:DWORD src1_sel:WORD_1
    ds_read_b64 v[96:97], v96
    ds_read_b64 v[98:99], v98
    v_lshlrev_b32_sdwa v100, 3, v119 dst_sel:DWORD dst_unused:UNUSED_PAD src0_sel:DWORD src1_sel:WORD_0
    v_lshlrev_b32_sdwa v102, 3, v119 dst_sel:DWORD dst_unused:UNUSED_PAD src0_sel:DWORD src1_sel:WORD_1
    ds_read_b64 v[100:101], v100
    ds_read_b64 v[102:103], v102
    s_add_u32 s20, s20, 0x4000
    buffer_load_dwordx4 v[116:119], v71, s[12:15], s20 offen offset:0 sc1
    s_waitcnt lgkmcnt(9)
    v_smfmac_f32_16x16x64_bf16 v[54:57], v[66:69], v[104:111], v70
    s_waitcnt vmcnt(6)
    v_lshlrev_b32_sdwa v104, 3, v120 dst_sel:DWORD dst_unused:UNUSED_PAD src0_sel:DWORD src1_sel:WORD_0
    v_lshlrev_b32_sdwa v106, 3, v120 dst_sel:DWORD dst_unused:UNUSED_PAD src0_sel:DWORD src1_sel:WORD_1
    ds_read_b64 v[104:105], v104
    ds_read_b64 v[106:107], v106
    v_lshlrev_b32_sdwa v108, 3, v121 dst_sel:DWORD dst_unused:UNUSED_PAD src0_sel:DWORD src1_sel:WORD_0
    v_lshlrev_b32_sdwa v110, 3, v121 dst_sel:DWORD dst_unused:UNUSED_PAD src0_sel:DWORD src1_sel:WORD_1
    s_nop 0
    v_cvt_pk_bf16_f32 v54, v54, v55
    v_cvt_pk_bf16_f32 v55, v56, v57
    v_lshlrev_b32 v56, 16, v58
    v_and_b32 v57, s23, v58
    v_lshlrev_b32 v58, 16, v59
    v_and_b32 v59, s23, v59
    ds_read_b64 v[108:109], v108
    ds_read_b64 v[110:111], v110
    s_waitcnt lgkmcnt(9)
    v_smfmac_f32_16x16x64_bf16 v[56:59], v[66:69], v[88:95], v70
    v_lshlrev_b32_sdwa v88, 3, v122 dst_sel:DWORD dst_unused:UNUSED_PAD src0_sel:DWORD src1_sel:WORD_0
    v_lshlrev_b32_sdwa v90, 3, v122 dst_sel:DWORD dst_unused:UNUSED_PAD src0_sel:DWORD src1_sel:WORD_1
    ds_read_b64 v[88:89], v88
    ds_read_b64 v[90:91], v90
    v_lshlrev_b32_sdwa v92, 3, v123 dst_sel:DWORD dst_unused:UNUSED_PAD src0_sel:DWORD src1_sel:WORD_0
    v_lshlrev_b32_sdwa v94, 3, v123 dst_sel:DWORD dst_unused:UNUSED_PAD src0_sel:DWORD src1_sel:WORD_1
    ds_read_b64 v[92:93], v92
    ds_read_b64 v[94:95], v94
    s_add_u32 s20, s20, 0x1ec00
    buffer_load_dwordx4 v[120:123], v71, s[12:15], s20 offen offset:3072 sc1
    s_waitcnt lgkmcnt(8)
    v_smfmac_f32_16x16x64_bf16 v[56:59], v[66:69], v[96:103], v70
    s_waitcnt vmcnt(4)
    v_lshlrev_b32_sdwa v96, 3, v124 dst_sel:DWORD dst_unused:UNUSED_PAD src0_sel:DWORD src1_sel:WORD_0
    v_lshlrev_b32_sdwa v98, 3, v124 dst_sel:DWORD dst_unused:UNUSED_PAD src0_sel:DWORD src1_sel:WORD_1
    ds_read_b64 v[96:97], v96
    ds_read_b64 v[98:99], v98
    v_lshlrev_b32_sdwa v100, 3, v125 dst_sel:DWORD dst_unused:UNUSED_PAD src0_sel:DWORD src1_sel:WORD_0
    v_lshlrev_b32_sdwa v102, 3, v125 dst_sel:DWORD dst_unused:UNUSED_PAD src0_sel:DWORD src1_sel:WORD_1
    s_nop 0
    v_cvt_pk_bf16_f32 v56, v56, v57
    v_cvt_pk_bf16_f32 v57, v58, v59
    v_lshlrev_b32 v58, 16, v60
    v_and_b32 v59, s23, v60
    v_lshlrev_b32 v60, 16, v61
    v_and_b32 v61, s23, v61
    ds_read_b64 v[100:101], v100
    ds_read_b64 v[102:103], v102
    s_waitcnt lgkmcnt(8)
    v_smfmac_f32_16x16x64_bf16 v[58:61], v[66:69], v[104:111], v70
    v_lshlrev_b32_sdwa v104, 3, v126 dst_sel:DWORD dst_unused:UNUSED_PAD src0_sel:DWORD src1_sel:WORD_0
    v_lshlrev_b32_sdwa v106, 3, v126 dst_sel:DWORD dst_unused:UNUSED_PAD src0_sel:DWORD src1_sel:WORD_1
    ds_read_b64 v[104:105], v104
    ds_read_b64 v[106:107], v106
    v_lshlrev_b32_sdwa v108, 3, v127 dst_sel:DWORD dst_unused:UNUSED_PAD src0_sel:DWORD src1_sel:WORD_0
    v_lshlrev_b32_sdwa v110, 3, v127 dst_sel:DWORD dst_unused:UNUSED_PAD src0_sel:DWORD src1_sel:WORD_1
    ds_read_b64 v[108:109], v108
    ds_read_b64 v[110:111], v110
    buffer_load_dwordx4 v[124:127], v71, s[12:15], s20 offen offset:2048 sc1
    s_waitcnt lgkmcnt(8)
    v_smfmac_f32_16x16x64_bf16 v[58:61], v[66:69], v[88:95], v70
    s_waitcnt vmcnt(2)
    v_lshlrev_b32_sdwa v88, 3, v116 dst_sel:DWORD dst_unused:UNUSED_PAD src0_sel:DWORD src1_sel:WORD_0
    v_lshlrev_b32_sdwa v90, 3, v116 dst_sel:DWORD dst_unused:UNUSED_PAD src0_sel:DWORD src1_sel:WORD_1
    ds_read_b64 v[88:89], v88
    ds_read_b64 v[90:91], v90
    v_lshlrev_b32_sdwa v92, 3, v117 dst_sel:DWORD dst_unused:UNUSED_PAD src0_sel:DWORD src1_sel:WORD_0
    v_lshlrev_b32_sdwa v94, 3, v117 dst_sel:DWORD dst_unused:UNUSED_PAD src0_sel:DWORD src1_sel:WORD_1
    s_nop 0
    v_cvt_pk_bf16_f32 v58, v58, v59
    v_cvt_pk_bf16_f32 v59, v60, v61
    v_lshlrev_b32 v60, 16, v62
    v_and_b32 v61, s23, v62
    v_lshlrev_b32 v62, 16, v63
    v_and_b32 v63, s23, v63
    ds_read_b64 v[92:93], v92
    ds_read_b64 v[94:95], v94
    s_waitcnt lgkmcnt(8)
    v_smfmac_f32_16x16x64_bf16 v[60:63], v[66:69], v[96:103], v70
    s_setprio 0
    v_lshlrev_b32_sdwa v96, 3, v118 dst_sel:DWORD dst_unused:UNUSED_PAD src0_sel:DWORD src1_sel:WORD_0
    v_lshlrev_b32_sdwa v98, 3, v118 dst_sel:DWORD dst_unused:UNUSED_PAD src0_sel:DWORD src1_sel:WORD_1
    ds_read_b64 v[96:97], v96
    ds_read_b64 v[98:99], v98
    v_lshlrev_b32_sdwa v100, 3, v119 dst_sel:DWORD dst_unused:UNUSED_PAD src0_sel:DWORD src1_sel:WORD_0
    v_lshlrev_b32_sdwa v102, 3, v119 dst_sel:DWORD dst_unused:UNUSED_PAD src0_sel:DWORD src1_sel:WORD_1
    ds_read_b64 v[100:101], v100
    ds_read_b64 v[102:103], v102
    buffer_load_dwordx4 v[116:119], v71, s[12:15], s20 offen offset:1024 sc1
    s_waitcnt lgkmcnt(8)
    v_smfmac_f32_16x16x64_bf16 v[60:63], v[66:69], v[104:111], v70
    s_waitcnt vmcnt(2)
    v_lshlrev_b32_sdwa v104, 3, v122 dst_sel:DWORD dst_unused:UNUSED_PAD src0_sel:DWORD src1_sel:WORD_0
    v_lshlrev_b32_sdwa v106, 3, v122 dst_sel:DWORD dst_unused:UNUSED_PAD src0_sel:DWORD src1_sel:WORD_1
    ds_read_b64 v[104:105], v104
    ds_read_b64 v[106:107], v106
    v_lshlrev_b32_sdwa v108, 3, v123 dst_sel:DWORD dst_unused:UNUSED_PAD src0_sel:DWORD src1_sel:WORD_0
    v_lshlrev_b32_sdwa v110, 3, v123 dst_sel:DWORD dst_unused:UNUSED_PAD src0_sel:DWORD src1_sel:WORD_1
    s_nop 0
    v_cvt_pk_bf16_f32 v60, v60, v61
    v_cvt_pk_bf16_f32 v61, v62, v63
    v_lshlrev_b32 v62, 16, v64
    v_and_b32 v63, s23, v64
    v_lshlrev_b32 v64, 16, v65
    v_and_b32 v65, s23, v65
    ds_read_b64 v[108:109], v108
    ds_read_b64 v[110:111], v110
    s_waitcnt lgkmcnt(8)
    v_smfmac_f32_16x16x64_bf16 v[62:65], v[66:69], v[88:95], v70
    s_barrier
    s_setprio 3
    v_lshlrev_b32_sdwa v88, 3, v120 dst_sel:DWORD dst_unused:UNUSED_PAD src0_sel:DWORD src1_sel:WORD_0
    v_lshlrev_b32_sdwa v90, 3, v120 dst_sel:DWORD dst_unused:UNUSED_PAD src0_sel:DWORD src1_sel:WORD_1
    ds_read_b64 v[88:89], v88
    ds_read_b64 v[90:91], v90
    v_lshlrev_b32_sdwa v92, 3, v121 dst_sel:DWORD dst_unused:UNUSED_PAD src0_sel:DWORD src1_sel:WORD_0
    v_lshlrev_b32_sdwa v94, 3, v121 dst_sel:DWORD dst_unused:UNUSED_PAD src0_sel:DWORD src1_sel:WORD_1
    ds_read_b64 v[92:93], v92
    ds_read_b64 v[94:95], v94
    buffer_load_dwordx4 v[120:123], v71, s[12:15], s20 offen offset:0 sc1
    s_waitcnt lgkmcnt(8)
    v_smfmac_f32_16x16x64_bf16 v[62:65], v[66:69], v[96:103], v70
    v_mfma_f32_16x16x32_bf16 v[112:115], v[72:75], v[128:131], 0
    s_waitcnt vmcnt(2)
    v_lshlrev_b32_sdwa v96, 3, v126 dst_sel:DWORD dst_unused:UNUSED_PAD src0_sel:DWORD src1_sel:WORD_0
    v_lshlrev_b32_sdwa v98, 3, v126 dst_sel:DWORD dst_unused:UNUSED_PAD src0_sel:DWORD src1_sel:WORD_1
    ds_read_b64 v[96:97], v96
    ds_read_b64 v[98:99], v98
    v_mfma_f32_16x16x32_bf16 v[112:115], v[76:79], v[132:135], v[112:115]
    v_lshlrev_b32_sdwa v100, 3, v127 dst_sel:DWORD dst_unused:UNUSED_PAD src0_sel:DWORD src1_sel:WORD_0
    v_lshlrev_b32_sdwa v102, 3, v127 dst_sel:DWORD dst_unused:UNUSED_PAD src0_sel:DWORD src1_sel:WORD_1
    v_cvt_pk_bf16_f32 v62, v62, v63
    v_cvt_pk_bf16_f32 v63, v64, v65
    v_mov_b64 v[64:65], v[32:33]
    v_and_b32 v33, s23, v31
    v_lshlrev_b32 v32, 16, v31
    v_and_b32 v31, s23, v30
    v_lshlrev_b32 v30, 16, v30
    ds_read_b64 v[100:101], v100
    ds_read_b64 v[102:103], v102
    s_waitcnt lgkmcnt(8)
    v_smfmac_f32_16x16x64_bf16 v[30:33], v[66:69], v[104:111], v70
    v_mfma_f32_16x16x32_bf16 v[112:115], v[80:83], v[136:139], v[112:115]
    v_lshlrev_b32_sdwa v104, 3, v124 dst_sel:DWORD dst_unused:UNUSED_PAD src0_sel:DWORD src1_sel:WORD_0
    v_lshlrev_b32_sdwa v106, 3, v124 dst_sel:DWORD dst_unused:UNUSED_PAD src0_sel:DWORD src1_sel:WORD_1
    ds_read_b64 v[104:105], v104
    ds_read_b64 v[106:107], v106
    v_mfma_f32_16x16x32_bf16 v[112:115], v[84:87], v[140:143], v[112:115]
    v_lshlrev_b32_sdwa v108, 3, v125 dst_sel:DWORD dst_unused:UNUSED_PAD src0_sel:DWORD src1_sel:WORD_0
    v_lshlrev_b32_sdwa v110, 3, v125 dst_sel:DWORD dst_unused:UNUSED_PAD src0_sel:DWORD src1_sel:WORD_1
    ds_read_b64 v[108:109], v108
    ds_read_b64 v[110:111], v110
    s_add_u32 s20, s20, 0xfffff000
    buffer_load_dwordx4 v[124:127], v71, s[12:15], s20 offen offset:3072 sc1
    s_waitcnt lgkmcnt(8)
    v_smfmac_f32_16x16x64_bf16 v[30:33], v[66:69], v[88:95], v70
    v_cvt_pk_bf16_f32 v112, v112, v113
    v_cvt_pk_bf16_f32 v113, v114, v115
    v_lshlrev_b32_sdwa v114, 3, v70 dst_sel:DWORD dst_unused:UNUSED_PAD src0_sel:DWORD src1_sel:WORD_1
    ds_write_b64 v114, v[112:113] offset:32768
    s_waitcnt vmcnt(2)
    v_lshlrev_b32_sdwa v88, 3, v118 dst_sel:DWORD dst_unused:UNUSED_PAD src0_sel:DWORD src1_sel:WORD_0
    v_lshlrev_b32_sdwa v90, 3, v118 dst_sel:DWORD dst_unused:UNUSED_PAD src0_sel:DWORD src1_sel:WORD_1
    ds_read_b64 v[88:89], v88
    ds_read_b64 v[90:91], v90
    v_lshlrev_b32_sdwa v92, 3, v119 dst_sel:DWORD dst_unused:UNUSED_PAD src0_sel:DWORD src1_sel:WORD_0
    v_lshlrev_b32_sdwa v94, 3, v119 dst_sel:DWORD dst_unused:UNUSED_PAD src0_sel:DWORD src1_sel:WORD_1
    v_cvt_pk_bf16_f32 v33, v32, v33
    v_cvt_pk_bf16_f32 v32, v30, v31
    v_and_b32 v31, s23, v29
    v_lshlrev_b32 v30, 16, v29
    v_and_b32 v29, s23, v28
    v_lshlrev_b32 v28, 16, v28
    ds_read_b64 v[92:93], v92
    ds_read_b64 v[94:95], v94
    s_waitcnt lgkmcnt(9)
    v_smfmac_f32_16x16x64_bf16 v[28:31], v[66:69], v[96:103], v70
    v_mfma_f32_16x16x32_bf16 v[112:115], v[72:75], v[144:147], 0
    v_lshlrev_b32_sdwa v96, 3, v116 dst_sel:DWORD dst_unused:UNUSED_PAD src0_sel:DWORD src1_sel:WORD_0
    v_lshlrev_b32_sdwa v98, 3, v116 dst_sel:DWORD dst_unused:UNUSED_PAD src0_sel:DWORD src1_sel:WORD_1
    ds_read_b64 v[96:97], v96
    ds_read_b64 v[98:99], v98
    v_mfma_f32_16x16x32_bf16 v[112:115], v[76:79], v[148:151], v[112:115]
    v_lshlrev_b32_sdwa v100, 3, v117 dst_sel:DWORD dst_unused:UNUSED_PAD src0_sel:DWORD src1_sel:WORD_0
    v_lshlrev_b32_sdwa v102, 3, v117 dst_sel:DWORD dst_unused:UNUSED_PAD src0_sel:DWORD src1_sel:WORD_1
    ds_read_b64 v[100:101], v100
    ds_read_b64 v[102:103], v102
    buffer_load_dwordx4 v[116:119], v71, s[12:15], s20 offen offset:2048 sc1
    s_waitcnt lgkmcnt(9)
    v_smfmac_f32_16x16x64_bf16 v[28:31], v[66:69], v[104:111], v70
    v_mfma_f32_16x16x32_bf16 v[112:115], v[80:83], v[152:155], v[112:115]
    s_waitcnt vmcnt(2)
    v_lshlrev_b32_sdwa v104, 3, v122 dst_sel:DWORD dst_unused:UNUSED_PAD src0_sel:DWORD src1_sel:WORD_0
    v_lshlrev_b32_sdwa v106, 3, v122 dst_sel:DWORD dst_unused:UNUSED_PAD src0_sel:DWORD src1_sel:WORD_1
    ds_read_b64 v[104:105], v104
    ds_read_b64 v[106:107], v106
    v_mfma_f32_16x16x32_bf16 v[112:115], v[84:87], v[156:159], v[112:115]
    v_lshlrev_b32_sdwa v108, 3, v123 dst_sel:DWORD dst_unused:UNUSED_PAD src0_sel:DWORD src1_sel:WORD_0
    v_lshlrev_b32_sdwa v110, 3, v123 dst_sel:DWORD dst_unused:UNUSED_PAD src0_sel:DWORD src1_sel:WORD_1
    v_cvt_pk_bf16_f32 v31, v30, v31
    v_cvt_pk_bf16_f32 v30, v28, v29
    v_and_b32 v29, s23, v27
    v_lshlrev_b32 v28, 16, v27
    v_and_b32 v27, s23, v26
    v_lshlrev_b32 v26, 16, v26
    ds_read_b64 v[108:109], v108
    ds_read_b64 v[110:111], v110
    s_waitcnt lgkmcnt(8)
    v_smfmac_f32_16x16x64_bf16 v[26:29], v[66:69], v[88:95], v70
    v_cvt_pk_bf16_f32 v112, v112, v113
    v_cvt_pk_bf16_f32 v113, v114, v115
    v_lshlrev_b32_sdwa v114, 3, v70 dst_sel:DWORD dst_unused:UNUSED_PAD src0_sel:DWORD src1_sel:WORD_1
    ds_write_b64 v114, v[112:113] offset:32896
    v_lshlrev_b32_sdwa v88, 3, v120 dst_sel:DWORD dst_unused:UNUSED_PAD src0_sel:DWORD src1_sel:WORD_0
    v_lshlrev_b32_sdwa v90, 3, v120 dst_sel:DWORD dst_unused:UNUSED_PAD src0_sel:DWORD src1_sel:WORD_1
    ds_read_b64 v[88:89], v88
    ds_read_b64 v[90:91], v90
    v_lshlrev_b32_sdwa v92, 3, v121 dst_sel:DWORD dst_unused:UNUSED_PAD src0_sel:DWORD src1_sel:WORD_0
    v_lshlrev_b32_sdwa v94, 3, v121 dst_sel:DWORD dst_unused:UNUSED_PAD src0_sel:DWORD src1_sel:WORD_1
    ds_read_b64 v[92:93], v92
    ds_read_b64 v[94:95], v94
    buffer_load_dwordx4 v[120:123], v71, s[12:15], s20 offen offset:1024 sc1
    s_waitcnt lgkmcnt(9)
    v_smfmac_f32_16x16x64_bf16 v[26:29], v[66:69], v[96:103], v70
    v_mfma_f32_16x16x32_bf16 v[112:115], v[72:75], v[160:163], 0
    s_waitcnt vmcnt(2)
    v_lshlrev_b32_sdwa v96, 3, v126 dst_sel:DWORD dst_unused:UNUSED_PAD src0_sel:DWORD src1_sel:WORD_0
    v_lshlrev_b32_sdwa v98, 3, v126 dst_sel:DWORD dst_unused:UNUSED_PAD src0_sel:DWORD src1_sel:WORD_1
    ds_read_b64 v[96:97], v96
    ds_read_b64 v[98:99], v98
    v_mfma_f32_16x16x32_bf16 v[112:115], v[76:79], v[164:167], v[112:115]
    v_lshlrev_b32_sdwa v100, 3, v127 dst_sel:DWORD dst_unused:UNUSED_PAD src0_sel:DWORD src1_sel:WORD_0
    v_lshlrev_b32_sdwa v102, 3, v127 dst_sel:DWORD dst_unused:UNUSED_PAD src0_sel:DWORD src1_sel:WORD_1
    v_cvt_pk_bf16_f32 v29, v28, v29
    v_cvt_pk_bf16_f32 v28, v26, v27
    v_and_b32 v27, s23, v25
    v_lshlrev_b32 v26, 16, v25
    v_and_b32 v25, s23, v24
    v_lshlrev_b32 v24, 16, v24
    ds_read_b64 v[100:101], v100
    ds_read_b64 v[102:103], v102
    s_waitcnt lgkmcnt(9)
    v_smfmac_f32_16x16x64_bf16 v[24:27], v[66:69], v[104:111], v70
    v_mfma_f32_16x16x32_bf16 v[112:115], v[80:83], v[168:171], v[112:115]
    v_lshlrev_b32_sdwa v104, 3, v124 dst_sel:DWORD dst_unused:UNUSED_PAD src0_sel:DWORD src1_sel:WORD_0
    v_lshlrev_b32_sdwa v106, 3, v124 dst_sel:DWORD dst_unused:UNUSED_PAD src0_sel:DWORD src1_sel:WORD_1
    ds_read_b64 v[104:105], v104
    ds_read_b64 v[106:107], v106
    v_mfma_f32_16x16x32_bf16 v[112:115], v[84:87], v[172:175], v[112:115]
    v_lshlrev_b32_sdwa v108, 3, v125 dst_sel:DWORD dst_unused:UNUSED_PAD src0_sel:DWORD src1_sel:WORD_0
    v_lshlrev_b32_sdwa v110, 3, v125 dst_sel:DWORD dst_unused:UNUSED_PAD src0_sel:DWORD src1_sel:WORD_1
    ds_read_b64 v[108:109], v108
    ds_read_b64 v[110:111], v110
    buffer_load_dwordx4 v[124:127], v71, s[12:15], s20 offen offset:0 sc1
    s_waitcnt lgkmcnt(8)
    v_smfmac_f32_16x16x64_bf16 v[24:27], v[66:69], v[88:95], v70
    s_nop 0
    v_cvt_pk_bf16_f32 v112, v112, v113
    v_cvt_pk_bf16_f32 v113, v114, v115
    v_lshlrev_b32_sdwa v114, 3, v70 dst_sel:DWORD dst_unused:UNUSED_PAD src0_sel:DWORD src1_sel:WORD_1
    ds_write_b64 v114, v[112:113] offset:33024
    s_waitcnt vmcnt(2)
    v_lshlrev_b32_sdwa v88, 3, v118 dst_sel:DWORD dst_unused:UNUSED_PAD src0_sel:DWORD src1_sel:WORD_0
    v_lshlrev_b32_sdwa v90, 3, v118 dst_sel:DWORD dst_unused:UNUSED_PAD src0_sel:DWORD src1_sel:WORD_1
    ds_read_b64 v[88:89], v88
    ds_read_b64 v[90:91], v90
    v_lshlrev_b32_sdwa v92, 3, v119 dst_sel:DWORD dst_unused:UNUSED_PAD src0_sel:DWORD src1_sel:WORD_0
    v_lshlrev_b32_sdwa v94, 3, v119 dst_sel:DWORD dst_unused:UNUSED_PAD src0_sel:DWORD src1_sel:WORD_1
    v_cvt_pk_bf16_f32 v27, v26, v27
    v_cvt_pk_bf16_f32 v26, v24, v25
    v_and_b32 v25, s23, v23
    v_lshlrev_b32 v24, 16, v23
    v_and_b32 v23, s23, v22
    v_lshlrev_b32 v22, 16, v22
    ds_read_b64 v[92:93], v92
    ds_read_b64 v[94:95], v94
    s_waitcnt lgkmcnt(9)
    v_smfmac_f32_16x16x64_bf16 v[22:25], v[66:69], v[96:103], v70
    v_mfma_f32_16x16x32_bf16 v[112:115], v[72:75], v[176:179], 0
    v_lshlrev_b32_sdwa v96, 3, v116 dst_sel:DWORD dst_unused:UNUSED_PAD src0_sel:DWORD src1_sel:WORD_0
    v_lshlrev_b32_sdwa v98, 3, v116 dst_sel:DWORD dst_unused:UNUSED_PAD src0_sel:DWORD src1_sel:WORD_1
    ds_read_b64 v[96:97], v96
    ds_read_b64 v[98:99], v98
    v_mfma_f32_16x16x32_bf16 v[112:115], v[76:79], v[180:183], v[112:115]
    v_lshlrev_b32_sdwa v100, 3, v117 dst_sel:DWORD dst_unused:UNUSED_PAD src0_sel:DWORD src1_sel:WORD_0
    v_lshlrev_b32_sdwa v102, 3, v117 dst_sel:DWORD dst_unused:UNUSED_PAD src0_sel:DWORD src1_sel:WORD_1
    ds_read_b64 v[100:101], v100
    ds_read_b64 v[102:103], v102
    s_add_u32 s20, s20, 0xfffff000
    buffer_load_dwordx4 v[116:119], v71, s[12:15], s20 offen offset:3072 sc1
    s_waitcnt lgkmcnt(9)
    v_smfmac_f32_16x16x64_bf16 v[22:25], v[66:69], v[104:111], v70
    v_mfma_f32_16x16x32_bf16 v[112:115], v[80:83], v[184:187], v[112:115]
    s_waitcnt vmcnt(2)
    v_lshlrev_b32_sdwa v104, 3, v122 dst_sel:DWORD dst_unused:UNUSED_PAD src0_sel:DWORD src1_sel:WORD_0
    v_lshlrev_b32_sdwa v106, 3, v122 dst_sel:DWORD dst_unused:UNUSED_PAD src0_sel:DWORD src1_sel:WORD_1
    ds_read_b64 v[104:105], v104
    ds_read_b64 v[106:107], v106
    v_mfma_f32_16x16x32_bf16 v[112:115], v[84:87], v[188:191], v[112:115]
    v_lshlrev_b32_sdwa v108, 3, v123 dst_sel:DWORD dst_unused:UNUSED_PAD src0_sel:DWORD src1_sel:WORD_0
    v_lshlrev_b32_sdwa v110, 3, v123 dst_sel:DWORD dst_unused:UNUSED_PAD src0_sel:DWORD src1_sel:WORD_1
    v_cvt_pk_bf16_f32 v25, v24, v25
    v_cvt_pk_bf16_f32 v24, v22, v23
    v_and_b32 v23, s23, v21
    v_lshlrev_b32 v22, 16, v21
    v_and_b32 v21, s23, v20
    v_lshlrev_b32 v20, 16, v20
    ds_read_b64 v[108:109], v108
    ds_read_b64 v[110:111], v110
    s_waitcnt lgkmcnt(8)
    v_smfmac_f32_16x16x64_bf16 v[20:23], v[66:69], v[88:95], v70
    v_cvt_pk_bf16_f32 v112, v112, v113
    v_cvt_pk_bf16_f32 v113, v114, v115
    v_lshlrev_b32_sdwa v114, 3, v70 dst_sel:DWORD dst_unused:UNUSED_PAD src0_sel:DWORD src1_sel:WORD_1
    ds_write_b64 v114, v[112:113] offset:33152
    v_lshlrev_b32_sdwa v88, 3, v120 dst_sel:DWORD dst_unused:UNUSED_PAD src0_sel:DWORD src1_sel:WORD_0
    v_lshlrev_b32_sdwa v90, 3, v120 dst_sel:DWORD dst_unused:UNUSED_PAD src0_sel:DWORD src1_sel:WORD_1
    ds_read_b64 v[88:89], v88
    ds_read_b64 v[90:91], v90
    v_lshlrev_b32_sdwa v92, 3, v121 dst_sel:DWORD dst_unused:UNUSED_PAD src0_sel:DWORD src1_sel:WORD_0
    v_lshlrev_b32_sdwa v94, 3, v121 dst_sel:DWORD dst_unused:UNUSED_PAD src0_sel:DWORD src1_sel:WORD_1
    ds_read_b64 v[92:93], v92
    ds_read_b64 v[94:95], v94
    buffer_load_dwordx4 v[120:123], v71, s[12:15], s20 offen offset:2048 sc1
    s_waitcnt lgkmcnt(9)
    v_smfmac_f32_16x16x64_bf16 v[20:23], v[66:69], v[96:103], v70
    v_mfma_f32_16x16x32_bf16 v[112:115], v[72:75], v[192:195], 0
    s_waitcnt vmcnt(2)
    v_lshlrev_b32_sdwa v96, 3, v126 dst_sel:DWORD dst_unused:UNUSED_PAD src0_sel:DWORD src1_sel:WORD_0
    v_lshlrev_b32_sdwa v98, 3, v126 dst_sel:DWORD dst_unused:UNUSED_PAD src0_sel:DWORD src1_sel:WORD_1
    ds_read_b64 v[96:97], v96
    ds_read_b64 v[98:99], v98
    v_mfma_f32_16x16x32_bf16 v[112:115], v[76:79], v[196:199], v[112:115]
    v_lshlrev_b32_sdwa v100, 3, v127 dst_sel:DWORD dst_unused:UNUSED_PAD src0_sel:DWORD src1_sel:WORD_0
    v_lshlrev_b32_sdwa v102, 3, v127 dst_sel:DWORD dst_unused:UNUSED_PAD src0_sel:DWORD src1_sel:WORD_1
    v_cvt_pk_bf16_f32 v23, v22, v23
    v_cvt_pk_bf16_f32 v22, v20, v21
    v_and_b32 v21, s23, v19
    v_lshlrev_b32 v20, 16, v19
    v_and_b32 v19, s23, v18
    v_lshlrev_b32 v18, 16, v18
    ds_read_b64 v[100:101], v100
    ds_read_b64 v[102:103], v102
    s_waitcnt lgkmcnt(9)
    v_smfmac_f32_16x16x64_bf16 v[18:21], v[66:69], v[104:111], v70
    v_mfma_f32_16x16x32_bf16 v[112:115], v[80:83], v[200:203], v[112:115]
    v_lshlrev_b32_sdwa v104, 3, v124 dst_sel:DWORD dst_unused:UNUSED_PAD src0_sel:DWORD src1_sel:WORD_0
    v_lshlrev_b32_sdwa v106, 3, v124 dst_sel:DWORD dst_unused:UNUSED_PAD src0_sel:DWORD src1_sel:WORD_1
    ds_read_b64 v[104:105], v104
    ds_read_b64 v[106:107], v106
    v_mfma_f32_16x16x32_bf16 v[112:115], v[84:87], v[204:207], v[112:115]
    v_lshlrev_b32_sdwa v108, 3, v125 dst_sel:DWORD dst_unused:UNUSED_PAD src0_sel:DWORD src1_sel:WORD_0
    v_lshlrev_b32_sdwa v110, 3, v125 dst_sel:DWORD dst_unused:UNUSED_PAD src0_sel:DWORD src1_sel:WORD_1
    ds_read_b64 v[108:109], v108
    ds_read_b64 v[110:111], v110
    buffer_load_dwordx4 v[124:127], v71, s[12:15], s20 offen offset:1024 sc1
    s_waitcnt lgkmcnt(8)
    v_smfmac_f32_16x16x64_bf16 v[18:21], v[66:69], v[88:95], v70
    s_nop 0
    v_cvt_pk_bf16_f32 v112, v112, v113
    v_cvt_pk_bf16_f32 v113, v114, v115
    v_lshlrev_b32_sdwa v114, 3, v70 dst_sel:DWORD dst_unused:UNUSED_PAD src0_sel:DWORD src1_sel:WORD_1
    ds_write_b64 v114, v[112:113] offset:33280
    s_waitcnt vmcnt(2)
    v_lshlrev_b32_sdwa v88, 3, v118 dst_sel:DWORD dst_unused:UNUSED_PAD src0_sel:DWORD src1_sel:WORD_0
    v_lshlrev_b32_sdwa v90, 3, v118 dst_sel:DWORD dst_unused:UNUSED_PAD src0_sel:DWORD src1_sel:WORD_1
    ds_read_b64 v[88:89], v88
    ds_read_b64 v[90:91], v90
    v_lshlrev_b32_sdwa v92, 3, v119 dst_sel:DWORD dst_unused:UNUSED_PAD src0_sel:DWORD src1_sel:WORD_0
    v_lshlrev_b32_sdwa v94, 3, v119 dst_sel:DWORD dst_unused:UNUSED_PAD src0_sel:DWORD src1_sel:WORD_1
    v_cvt_pk_bf16_f32 v21, v20, v21
    v_cvt_pk_bf16_f32 v20, v18, v19
    v_and_b32 v19, s23, v17
    v_lshlrev_b32 v18, 16, v17
    v_and_b32 v17, s23, v16
    v_lshlrev_b32 v16, 16, v16
    ds_read_b64 v[92:93], v92
    ds_read_b64 v[94:95], v94
    s_waitcnt lgkmcnt(9)
    v_smfmac_f32_16x16x64_bf16 v[16:19], v[66:69], v[96:103], v70
    s_setprio 2
    v_mfma_f32_16x16x32_bf16 v[112:115], v[72:75], v[208:211], 0
    v_lshlrev_b32_sdwa v96, 3, v116 dst_sel:DWORD dst_unused:UNUSED_PAD src0_sel:DWORD src1_sel:WORD_0
    v_lshlrev_b32_sdwa v98, 3, v116 dst_sel:DWORD dst_unused:UNUSED_PAD src0_sel:DWORD src1_sel:WORD_1
    ds_read_b64 v[96:97], v96
    ds_read_b64 v[98:99], v98
    v_mfma_f32_16x16x32_bf16 v[112:115], v[76:79], v[212:215], v[112:115]
    v_lshlrev_b32_sdwa v100, 3, v117 dst_sel:DWORD dst_unused:UNUSED_PAD src0_sel:DWORD src1_sel:WORD_0
    v_lshlrev_b32_sdwa v102, 3, v117 dst_sel:DWORD dst_unused:UNUSED_PAD src0_sel:DWORD src1_sel:WORD_1
    ds_read_b64 v[100:101], v100
    ds_read_b64 v[102:103], v102
    buffer_load_dwordx4 v[116:119], v71, s[12:15], s20 offen offset:0 sc1
    s_waitcnt lgkmcnt(9)
    v_smfmac_f32_16x16x64_bf16 v[16:19], v[66:69], v[104:111], v70
    v_mfma_f32_16x16x32_bf16 v[112:115], v[80:83], v[216:219], v[112:115]
    s_waitcnt vmcnt(2)
    v_lshlrev_b32_sdwa v104, 3, v122 dst_sel:DWORD dst_unused:UNUSED_PAD src0_sel:DWORD src1_sel:WORD_0
    v_lshlrev_b32_sdwa v106, 3, v122 dst_sel:DWORD dst_unused:UNUSED_PAD src0_sel:DWORD src1_sel:WORD_1
    ds_read_b64 v[104:105], v104
    ds_read_b64 v[106:107], v106
    v_mfma_f32_16x16x32_bf16 v[112:115], v[84:87], v[220:223], v[112:115]
    v_lshlrev_b32_sdwa v108, 3, v123 dst_sel:DWORD dst_unused:UNUSED_PAD src0_sel:DWORD src1_sel:WORD_0
    v_lshlrev_b32_sdwa v110, 3, v123 dst_sel:DWORD dst_unused:UNUSED_PAD src0_sel:DWORD src1_sel:WORD_1
    v_cvt_pk_bf16_f32 v19, v18, v19
    v_cvt_pk_bf16_f32 v18, v16, v17
    v_and_b32 v17, s23, v15
    v_lshlrev_b32 v16, 16, v15
    v_and_b32 v15, s23, v14
    v_lshlrev_b32 v14, 16, v14
    ds_read_b64 v[108:109], v108
    ds_read_b64 v[110:111], v110
    s_waitcnt lgkmcnt(8)
    v_smfmac_f32_16x16x64_bf16 v[14:17], v[66:69], v[88:95], v70
    v_cvt_pk_bf16_f32 v112, v112, v113
    v_cvt_pk_bf16_f32 v113, v114, v115
    v_lshlrev_b32_sdwa v114, 3, v70 dst_sel:DWORD dst_unused:UNUSED_PAD src0_sel:DWORD src1_sel:WORD_1
    ds_write_b64 v114, v[112:113] offset:33408
    v_lshlrev_b32_sdwa v88, 3, v120 dst_sel:DWORD dst_unused:UNUSED_PAD src0_sel:DWORD src1_sel:WORD_0
    v_lshlrev_b32_sdwa v90, 3, v120 dst_sel:DWORD dst_unused:UNUSED_PAD src0_sel:DWORD src1_sel:WORD_1
    ds_read_b64 v[88:89], v88
    ds_read_b64 v[90:91], v90
    v_lshlrev_b32_sdwa v92, 3, v121 dst_sel:DWORD dst_unused:UNUSED_PAD src0_sel:DWORD src1_sel:WORD_0
    v_lshlrev_b32_sdwa v94, 3, v121 dst_sel:DWORD dst_unused:UNUSED_PAD src0_sel:DWORD src1_sel:WORD_1
    ds_read_b64 v[92:93], v92
    ds_read_b64 v[94:95], v94
    s_add_u32 s20, s20, 0xfffffc00
    buffer_load_dwordx4 v[120:123], v71, s[12:15], s20 offen offset:0 sc1
    s_waitcnt lgkmcnt(9)
    v_smfmac_f32_16x16x64_bf16 v[14:17], v[66:69], v[96:103], v70
    v_mfma_f32_16x16x32_bf16 v[112:115], v[72:75], v[224:227], 0
    s_waitcnt vmcnt(2)
    v_lshlrev_b32_sdwa v96, 3, v126 dst_sel:DWORD dst_unused:UNUSED_PAD src0_sel:DWORD src1_sel:WORD_0
    v_lshlrev_b32_sdwa v98, 3, v126 dst_sel:DWORD dst_unused:UNUSED_PAD src0_sel:DWORD src1_sel:WORD_1
    ds_read_b64 v[96:97], v96
    ds_read_b64 v[98:99], v98
    v_mfma_f32_16x16x32_bf16 v[112:115], v[76:79], v[228:231], v[112:115]
    v_lshlrev_b32_sdwa v100, 3, v127 dst_sel:DWORD dst_unused:UNUSED_PAD src0_sel:DWORD src1_sel:WORD_0
    v_lshlrev_b32_sdwa v102, 3, v127 dst_sel:DWORD dst_unused:UNUSED_PAD src0_sel:DWORD src1_sel:WORD_1
    v_cvt_pk_bf16_f32 v17, v16, v17
    v_cvt_pk_bf16_f32 v16, v14, v15
    v_and_b32 v15, s23, v13
    v_lshlrev_b32 v14, 16, v13
    v_and_b32 v13, s23, v12
    v_lshlrev_b32 v12, 16, v12
    ds_read_b64 v[100:101], v100
    ds_read_b64 v[102:103], v102
    s_waitcnt lgkmcnt(9)
    v_smfmac_f32_16x16x64_bf16 v[12:15], v[66:69], v[104:111], v70
    v_mfma_f32_16x16x32_bf16 v[112:115], v[80:83], v[232:235], v[112:115]
    v_lshlrev_b32_sdwa v104, 3, v124 dst_sel:DWORD dst_unused:UNUSED_PAD src0_sel:DWORD src1_sel:WORD_0
    v_lshlrev_b32_sdwa v106, 3, v124 dst_sel:DWORD dst_unused:UNUSED_PAD src0_sel:DWORD src1_sel:WORD_1
    ds_read_b64 v[104:105], v104
    ds_read_b64 v[106:107], v106
    v_mfma_f32_16x16x32_bf16 v[112:115], v[84:87], v[236:239], v[112:115]
    v_lshlrev_b32_sdwa v108, 3, v125 dst_sel:DWORD dst_unused:UNUSED_PAD src0_sel:DWORD src1_sel:WORD_0
    v_lshlrev_b32_sdwa v110, 3, v125 dst_sel:DWORD dst_unused:UNUSED_PAD src0_sel:DWORD src1_sel:WORD_1
    ds_read_b64 v[108:109], v108
    ds_read_b64 v[110:111], v110
    s_add_u32 s20, s20, 0xfffffc00
    buffer_load_dwordx4 v[124:127], v71, s[12:15], s20 offen offset:0 sc1
    s_waitcnt lgkmcnt(8)
    v_smfmac_f32_16x16x64_bf16 v[12:15], v[66:69], v[88:95], v70
    v_cvt_pk_bf16_f32 v112, v112, v113
    v_cvt_pk_bf16_f32 v113, v114, v115
    v_lshlrev_b32_sdwa v114, 3, v70 dst_sel:DWORD dst_unused:UNUSED_PAD src0_sel:DWORD src1_sel:WORD_1
    ds_write_b64 v114, v[112:113] offset:33536
    s_waitcnt vmcnt(2)
    v_lshlrev_b32_sdwa v88, 3, v118 dst_sel:DWORD dst_unused:UNUSED_PAD src0_sel:DWORD src1_sel:WORD_0
    v_lshlrev_b32_sdwa v90, 3, v118 dst_sel:DWORD dst_unused:UNUSED_PAD src0_sel:DWORD src1_sel:WORD_1
    ds_read_b64 v[88:89], v88
    ds_read_b64 v[90:91], v90
    v_lshlrev_b32_sdwa v92, 3, v119 dst_sel:DWORD dst_unused:UNUSED_PAD src0_sel:DWORD src1_sel:WORD_0
    v_lshlrev_b32_sdwa v94, 3, v119 dst_sel:DWORD dst_unused:UNUSED_PAD src0_sel:DWORD src1_sel:WORD_1
    v_cvt_pk_bf16_f32 v15, v14, v15
    v_cvt_pk_bf16_f32 v14, v12, v13
    v_and_b32 v13, s23, v11
    v_lshlrev_b32 v12, 16, v11
    v_and_b32 v11, s23, v10
    v_lshlrev_b32 v10, 16, v10
    ds_read_b64 v[92:93], v92
    ds_read_b64 v[94:95], v94
    s_waitcnt lgkmcnt(9)
    v_smfmac_f32_16x16x64_bf16 v[10:13], v[66:69], v[96:103], v70
    v_mfma_f32_16x16x32_bf16 v[112:115], v[72:75], v[240:243], 0
    buffer_load_dwordx4 v[72:75], v71, s[12:15], s21 offen offset:0
    v_lshlrev_b32_sdwa v96, 3, v116 dst_sel:DWORD dst_unused:UNUSED_PAD src0_sel:DWORD src1_sel:WORD_0
    v_lshlrev_b32_sdwa v98, 3, v116 dst_sel:DWORD dst_unused:UNUSED_PAD src0_sel:DWORD src1_sel:WORD_1
    ds_read_b64 v[96:97], v96
    ds_read_b64 v[98:99], v98
    v_mfma_f32_16x16x32_bf16 v[112:115], v[76:79], v[244:247], v[112:115]
    buffer_load_dwordx4 v[76:79], v71, s[12:15], s21 offen offset:1024
    v_lshlrev_b32_sdwa v100, 3, v117 dst_sel:DWORD dst_unused:UNUSED_PAD src0_sel:DWORD src1_sel:WORD_0
    v_lshlrev_b32_sdwa v102, 3, v117 dst_sel:DWORD dst_unused:UNUSED_PAD src0_sel:DWORD src1_sel:WORD_1
    ds_read_b64 v[100:101], v100
    ds_read_b64 v[102:103], v102
    s_add_u32 s20, s20, 0x3c00
    buffer_load_dwordx4 v[116:119], v71, s[12:15], s20 offen offset:0 sc1
    s_waitcnt lgkmcnt(9)
    v_smfmac_f32_16x16x64_bf16 v[10:13], v[66:69], v[104:111], v70
    v_mfma_f32_16x16x32_bf16 v[112:115], v[80:83], v[248:251], v[112:115]
    buffer_load_dwordx4 v[80:83], v71, s[12:15], s19 offen offset:0
    s_waitcnt vmcnt(5)
    v_lshlrev_b32_sdwa v104, 3, v122 dst_sel:DWORD dst_unused:UNUSED_PAD src0_sel:DWORD src1_sel:WORD_0
    v_lshlrev_b32_sdwa v106, 3, v122 dst_sel:DWORD dst_unused:UNUSED_PAD src0_sel:DWORD src1_sel:WORD_1
    ds_read_b64 v[104:105], v104
    ds_read_b64 v[106:107], v106
    v_mfma_f32_16x16x32_bf16 v[112:115], v[84:87], v[252:255], v[112:115]
    buffer_load_dwordx4 v[84:87], v71, s[12:15], s19 offen offset:1024
    s_add_u32 s21, s21, 4096
    s_add_u32 s19, s19, 4096
    v_lshlrev_b32_sdwa v108, 3, v123 dst_sel:DWORD dst_unused:UNUSED_PAD src0_sel:DWORD src1_sel:WORD_0
    v_lshlrev_b32_sdwa v110, 3, v123 dst_sel:DWORD dst_unused:UNUSED_PAD src0_sel:DWORD src1_sel:WORD_1
    v_cvt_pk_bf16_f32 v13, v12, v13
    v_cvt_pk_bf16_f32 v12, v10, v11
    v_and_b32 v11, s23, v9
    v_lshlrev_b32 v10, 16, v9
    v_and_b32 v9, s23, v8
    v_lshlrev_b32 v8, 16, v8
    ds_read_b64 v[108:109], v108
    ds_read_b64 v[110:111], v110
    s_waitcnt lgkmcnt(8)
    v_smfmac_f32_16x16x64_bf16 v[8:11], v[66:69], v[88:95], v70
    v_cvt_pk_bf16_f32 v112, v112, v113
    v_cvt_pk_bf16_f32 v113, v114, v115
    v_lshlrev_b32_sdwa v114, 3, v70 dst_sel:DWORD dst_unused:UNUSED_PAD src0_sel:DWORD src1_sel:WORD_1
    ds_write_b64 v114, v[112:113] offset:33664
    s_setprio 1
    v_lshlrev_b32_sdwa v88, 3, v120 dst_sel:DWORD dst_unused:UNUSED_PAD src0_sel:DWORD src1_sel:WORD_0
    v_lshlrev_b32_sdwa v90, 3, v120 dst_sel:DWORD dst_unused:UNUSED_PAD src0_sel:DWORD src1_sel:WORD_1
    ds_read_b64 v[88:89], v88
    ds_read_b64 v[90:91], v90
    v_lshlrev_b32_sdwa v92, 3, v121 dst_sel:DWORD dst_unused:UNUSED_PAD src0_sel:DWORD src1_sel:WORD_0
    v_lshlrev_b32_sdwa v94, 3, v121 dst_sel:DWORD dst_unused:UNUSED_PAD src0_sel:DWORD src1_sel:WORD_1
    ds_read_b64 v[92:93], v92
    ds_read_b64 v[94:95], v94
    s_add_u32 s20, s20, 0xfffffc00
    buffer_load_dwordx4 v[120:123], v71, s[12:15], s20 offen offset:0 sc1
    s_waitcnt lgkmcnt(9)
    v_smfmac_f32_16x16x64_bf16 v[8:11], v[66:69], v[96:103], v70
    s_waitcnt vmcnt(6)
    v_lshlrev_b32_sdwa v96, 3, v126 dst_sel:DWORD dst_unused:UNUSED_PAD src0_sel:DWORD src1_sel:WORD_0
    v_lshlrev_b32_sdwa v98, 3, v126 dst_sel:DWORD dst_unused:UNUSED_PAD src0_sel:DWORD src1_sel:WORD_1
    ds_read_b64 v[96:97], v96
    ds_read_b64 v[98:99], v98
    v_lshlrev_b32_sdwa v100, 3, v127 dst_sel:DWORD dst_unused:UNUSED_PAD src0_sel:DWORD src1_sel:WORD_0
    v_lshlrev_b32_sdwa v102, 3, v127 dst_sel:DWORD dst_unused:UNUSED_PAD src0_sel:DWORD src1_sel:WORD_1
    s_nop 0
    v_cvt_pk_bf16_f32 v11, v10, v11
    v_cvt_pk_bf16_f32 v10, v8, v9
    v_and_b32 v9, s23, v7
    v_lshlrev_b32 v8, 16, v7
    v_and_b32 v7, s23, v6
    v_lshlrev_b32 v6, 16, v6
    ds_read_b64 v[100:101], v100
    ds_read_b64 v[102:103], v102
    s_waitcnt lgkmcnt(9)
    v_smfmac_f32_16x16x64_bf16 v[6:9], v[66:69], v[104:111], v70
    v_lshlrev_b32_sdwa v104, 3, v124 dst_sel:DWORD dst_unused:UNUSED_PAD src0_sel:DWORD src1_sel:WORD_0
    v_lshlrev_b32_sdwa v106, 3, v124 dst_sel:DWORD dst_unused:UNUSED_PAD src0_sel:DWORD src1_sel:WORD_1
    ds_read_b64 v[104:105], v104
    ds_read_b64 v[106:107], v106
    v_lshlrev_b32_sdwa v108, 3, v125 dst_sel:DWORD dst_unused:UNUSED_PAD src0_sel:DWORD src1_sel:WORD_0
    v_lshlrev_b32_sdwa v110, 3, v125 dst_sel:DWORD dst_unused:UNUSED_PAD src0_sel:DWORD src1_sel:WORD_1
    ds_read_b64 v[108:109], v108
    ds_read_b64 v[110:111], v110
    s_add_u32 s20, s20, 0x1f000
    buffer_load_dwordx4 v[124:127], v71, s[12:15], s20 offen offset:3072 sc1
    s_waitcnt lgkmcnt(8)
    v_smfmac_f32_16x16x64_bf16 v[6:9], v[66:69], v[88:95], v70
    s_waitcnt vmcnt(4)
    v_lshlrev_b32_sdwa v88, 3, v118 dst_sel:DWORD dst_unused:UNUSED_PAD src0_sel:DWORD src1_sel:WORD_0
    v_lshlrev_b32_sdwa v90, 3, v118 dst_sel:DWORD dst_unused:UNUSED_PAD src0_sel:DWORD src1_sel:WORD_1
    ds_read_b64 v[88:89], v88
    ds_read_b64 v[90:91], v90
    v_lshlrev_b32_sdwa v92, 3, v119 dst_sel:DWORD dst_unused:UNUSED_PAD src0_sel:DWORD src1_sel:WORD_0
    v_lshlrev_b32_sdwa v94, 3, v119 dst_sel:DWORD dst_unused:UNUSED_PAD src0_sel:DWORD src1_sel:WORD_1
    s_nop 0
    v_cvt_pk_bf16_f32 v9, v8, v9
    v_cvt_pk_bf16_f32 v8, v6, v7
    v_and_b32 v7, s23, v5
    v_lshlrev_b32 v6, 16, v5
    v_and_b32 v5, s23, v4
    v_lshlrev_b32 v4, 16, v4
    ds_read_b64 v[92:93], v92
    ds_read_b64 v[94:95], v94
    s_waitcnt lgkmcnt(8)
    v_smfmac_f32_16x16x64_bf16 v[4:7], v[66:69], v[96:103], v70
    v_lshlrev_b32_sdwa v96, 3, v116 dst_sel:DWORD dst_unused:UNUSED_PAD src0_sel:DWORD src1_sel:WORD_0
    v_lshlrev_b32_sdwa v98, 3, v116 dst_sel:DWORD dst_unused:UNUSED_PAD src0_sel:DWORD src1_sel:WORD_1
    ds_read_b64 v[96:97], v96
    ds_read_b64 v[98:99], v98
    v_lshlrev_b32_sdwa v100, 3, v117 dst_sel:DWORD dst_unused:UNUSED_PAD src0_sel:DWORD src1_sel:WORD_0
    v_lshlrev_b32_sdwa v102, 3, v117 dst_sel:DWORD dst_unused:UNUSED_PAD src0_sel:DWORD src1_sel:WORD_1
    ds_read_b64 v[100:101], v100
    ds_read_b64 v[102:103], v102
    buffer_load_dwordx4 v[116:119], v71, s[12:15], s20 offen offset:2048 sc1
    s_waitcnt lgkmcnt(8)
    v_smfmac_f32_16x16x64_bf16 v[4:7], v[66:69], v[104:111], v70
    s_waitcnt vmcnt(2)
    v_lshlrev_b32_sdwa v104, 3, v122 dst_sel:DWORD dst_unused:UNUSED_PAD src0_sel:DWORD src1_sel:WORD_0
    v_lshlrev_b32_sdwa v106, 3, v122 dst_sel:DWORD dst_unused:UNUSED_PAD src0_sel:DWORD src1_sel:WORD_1
    ds_read_b64 v[104:105], v104
    ds_read_b64 v[106:107], v106
    v_lshlrev_b32_sdwa v108, 3, v123 dst_sel:DWORD dst_unused:UNUSED_PAD src0_sel:DWORD src1_sel:WORD_0
    v_lshlrev_b32_sdwa v110, 3, v123 dst_sel:DWORD dst_unused:UNUSED_PAD src0_sel:DWORD src1_sel:WORD_1
    s_nop 0
    v_cvt_pk_bf16_f32 v7, v6, v7
    v_cvt_pk_bf16_f32 v6, v4, v5
    v_and_b32 v5, s23, v3
    v_lshlrev_b32 v4, 16, v3
    v_and_b32 v3, s23, v2
    v_lshlrev_b32 v2, 16, v2
    ds_read_b64 v[108:109], v108
    ds_read_b64 v[110:111], v110
    s_waitcnt lgkmcnt(8)
    v_smfmac_f32_16x16x64_bf16 v[2:5], v[66:69], v[88:95], v70
    s_setprio 0
    v_lshlrev_b32_sdwa v88, 3, v120 dst_sel:DWORD dst_unused:UNUSED_PAD src0_sel:DWORD src1_sel:WORD_0
    v_lshlrev_b32_sdwa v90, 3, v120 dst_sel:DWORD dst_unused:UNUSED_PAD src0_sel:DWORD src1_sel:WORD_1
    ds_read_b64 v[88:89], v88
    ds_read_b64 v[90:91], v90
    v_lshlrev_b32_sdwa v92, 3, v121 dst_sel:DWORD dst_unused:UNUSED_PAD src0_sel:DWORD src1_sel:WORD_0
    v_lshlrev_b32_sdwa v94, 3, v121 dst_sel:DWORD dst_unused:UNUSED_PAD src0_sel:DWORD src1_sel:WORD_1
    ds_read_b64 v[92:93], v92
    ds_read_b64 v[94:95], v94
    buffer_load_dwordx4 v[120:123], v71, s[12:15], s20 offen offset:1024 sc1
    s_waitcnt lgkmcnt(8)
    v_smfmac_f32_16x16x64_bf16 v[2:5], v[66:69], v[96:103], v70
    s_waitcnt vmcnt(2)
    v_lshlrev_b32_sdwa v96, 3, v124 dst_sel:DWORD dst_unused:UNUSED_PAD src0_sel:DWORD src1_sel:WORD_0
    v_lshlrev_b32_sdwa v98, 3, v124 dst_sel:DWORD dst_unused:UNUSED_PAD src0_sel:DWORD src1_sel:WORD_1
    ds_read_b64 v[96:97], v96
    ds_read_b64 v[98:99], v98
    v_lshlrev_b32_sdwa v100, 3, v125 dst_sel:DWORD dst_unused:UNUSED_PAD src0_sel:DWORD src1_sel:WORD_0
    v_lshlrev_b32_sdwa v102, 3, v125 dst_sel:DWORD dst_unused:UNUSED_PAD src0_sel:DWORD src1_sel:WORD_1
    s_nop 0
    v_cvt_pk_bf16_f32 v5, v4, v5
    v_cvt_pk_bf16_f32 v4, v2, v3
    v_and_b32 v3, s23, v1
    v_lshlrev_b32 v2, 16, v1
    v_and_b32 v1, s23, v0
    v_lshlrev_b32 v0, 16, v0
    ds_read_b64 v[100:101], v100
    ds_read_b64 v[102:103], v102
    s_waitcnt lgkmcnt(8)
    v_smfmac_f32_16x16x64_bf16 v[0:3], v[66:69], v[104:111], v70
    s_barrier
    s_setprio 3
    v_lshlrev_b32_sdwa v104, 3, v126 dst_sel:DWORD dst_unused:UNUSED_PAD src0_sel:DWORD src1_sel:WORD_0
    v_lshlrev_b32_sdwa v106, 3, v126 dst_sel:DWORD dst_unused:UNUSED_PAD src0_sel:DWORD src1_sel:WORD_1
    ds_read_b64 v[104:105], v104
    ds_read_b64 v[106:107], v106
    v_lshlrev_b32_sdwa v108, 3, v127 dst_sel:DWORD dst_unused:UNUSED_PAD src0_sel:DWORD src1_sel:WORD_0
    v_lshlrev_b32_sdwa v110, 3, v127 dst_sel:DWORD dst_unused:UNUSED_PAD src0_sel:DWORD src1_sel:WORD_1
    ds_read_b64 v[108:109], v108
    ds_read_b64 v[110:111], v110
    buffer_load_dwordx4 v[124:127], v71, s[12:15], s20 offen offset:0 sc1
    s_waitcnt lgkmcnt(8)
    v_smfmac_f32_16x16x64_bf16 v[0:3], v[66:69], v[88:95], v70
    v_mfma_f32_16x16x32_bf16 v[112:115], v[72:75], v[128:131], 0
    s_waitcnt vmcnt(2)
    v_lshlrev_b32_sdwa v88, 3, v116 dst_sel:DWORD dst_unused:UNUSED_PAD src0_sel:DWORD src1_sel:WORD_0
    v_lshlrev_b32_sdwa v90, 3, v116 dst_sel:DWORD dst_unused:UNUSED_PAD src0_sel:DWORD src1_sel:WORD_1
    ds_read_b64 v[88:89], v88
    ds_read_b64 v[90:91], v90
    v_mfma_f32_16x16x32_bf16 v[112:115], v[76:79], v[132:135], v[112:115]
    v_add_u32 v70, 0x20000000, v70
    v_lshlrev_b32_sdwa v92, 3, v117 dst_sel:DWORD dst_unused:UNUSED_PAD src0_sel:DWORD src1_sel:WORD_0
    v_lshlrev_b32_sdwa v94, 3, v117 dst_sel:DWORD dst_unused:UNUSED_PAD src0_sel:DWORD src1_sel:WORD_1
    v_cvt_pk_bf16_f32 v3, v2, v3
    v_cvt_pk_bf16_f32 v2, v0, v1
    v_mov_b64 v[0:1], v[32:33]
    v_lshlrev_b32 v32, 16, v34
    v_and_b32 v33, s23, v34
    v_lshlrev_b32 v34, 16, v35
    v_and_b32 v35, s23, v35
    ds_read_b64 v[92:93], v92
    ds_read_b64 v[94:95], v94
    s_waitcnt lgkmcnt(8)
    v_smfmac_f32_16x16x64_bf16 v[32:35], v[66:69], v[96:103], v70
    v_mfma_f32_16x16x32_bf16 v[112:115], v[80:83], v[136:139], v[112:115]
    v_lshlrev_b32_sdwa v96, 3, v118 dst_sel:DWORD dst_unused:UNUSED_PAD src0_sel:DWORD src1_sel:WORD_0
    v_lshlrev_b32_sdwa v98, 3, v118 dst_sel:DWORD dst_unused:UNUSED_PAD src0_sel:DWORD src1_sel:WORD_1
    ds_read_b64 v[96:97], v96
    ds_read_b64 v[98:99], v98
    v_mfma_f32_16x16x32_bf16 v[112:115], v[84:87], v[140:143], v[112:115]
    v_lshlrev_b32_sdwa v100, 3, v119 dst_sel:DWORD dst_unused:UNUSED_PAD src0_sel:DWORD src1_sel:WORD_0
    v_lshlrev_b32_sdwa v102, 3, v119 dst_sel:DWORD dst_unused:UNUSED_PAD src0_sel:DWORD src1_sel:WORD_1
    ds_read_b64 v[100:101], v100
    ds_read_b64 v[102:103], v102
    s_add_u32 s20, s20, 0xfffff000
    buffer_load_dwordx4 v[116:119], v71, s[12:15], s20 offen offset:3072 sc1
    s_waitcnt lgkmcnt(8)
    v_smfmac_f32_16x16x64_bf16 v[32:35], v[66:69], v[104:111], v70
    v_cvt_pk_bf16_f32 v112, v112, v113
    v_cvt_pk_bf16_f32 v113, v114, v115
    v_lshlrev_b32_sdwa v114, 3, v70 dst_sel:DWORD dst_unused:UNUSED_PAD src0_sel:DWORD src1_sel:WORD_1
    ds_write_b64 v114, v[112:113] offset:0
    s_waitcnt vmcnt(2)
    v_lshlrev_b32_sdwa v104, 3, v120 dst_sel:DWORD dst_unused:UNUSED_PAD src0_sel:DWORD src1_sel:WORD_0
    v_lshlrev_b32_sdwa v106, 3, v120 dst_sel:DWORD dst_unused:UNUSED_PAD src0_sel:DWORD src1_sel:WORD_1
    ds_read_b64 v[104:105], v104
    ds_read_b64 v[106:107], v106
    v_lshlrev_b32_sdwa v108, 3, v121 dst_sel:DWORD dst_unused:UNUSED_PAD src0_sel:DWORD src1_sel:WORD_0
    v_lshlrev_b32_sdwa v110, 3, v121 dst_sel:DWORD dst_unused:UNUSED_PAD src0_sel:DWORD src1_sel:WORD_1
    v_cvt_pk_bf16_f32 v32, v32, v33
    v_cvt_pk_bf16_f32 v33, v34, v35
    v_lshlrev_b32 v34, 16, v36
    v_and_b32 v35, s23, v36
    v_lshlrev_b32 v36, 16, v37
    v_and_b32 v37, s23, v37
    ds_read_b64 v[108:109], v108
    ds_read_b64 v[110:111], v110
    s_waitcnt lgkmcnt(9)
    v_smfmac_f32_16x16x64_bf16 v[34:37], v[66:69], v[88:95], v70
    v_mfma_f32_16x16x32_bf16 v[112:115], v[72:75], v[144:147], 0
    v_lshlrev_b32_sdwa v88, 3, v122 dst_sel:DWORD dst_unused:UNUSED_PAD src0_sel:DWORD src1_sel:WORD_0
    v_lshlrev_b32_sdwa v90, 3, v122 dst_sel:DWORD dst_unused:UNUSED_PAD src0_sel:DWORD src1_sel:WORD_1
    ds_read_b64 v[88:89], v88
    ds_read_b64 v[90:91], v90
    v_mfma_f32_16x16x32_bf16 v[112:115], v[76:79], v[148:151], v[112:115]
    v_lshlrev_b32_sdwa v92, 3, v123 dst_sel:DWORD dst_unused:UNUSED_PAD src0_sel:DWORD src1_sel:WORD_0
    v_lshlrev_b32_sdwa v94, 3, v123 dst_sel:DWORD dst_unused:UNUSED_PAD src0_sel:DWORD src1_sel:WORD_1
    ds_read_b64 v[92:93], v92
    ds_read_b64 v[94:95], v94
    buffer_load_dwordx4 v[120:123], v71, s[12:15], s20 offen offset:2048 sc1
    s_waitcnt lgkmcnt(9)
    v_smfmac_f32_16x16x64_bf16 v[34:37], v[66:69], v[96:103], v70
    v_mfma_f32_16x16x32_bf16 v[112:115], v[80:83], v[152:155], v[112:115]
    s_waitcnt vmcnt(2)
    v_lshlrev_b32_sdwa v96, 3, v124 dst_sel:DWORD dst_unused:UNUSED_PAD src0_sel:DWORD src1_sel:WORD_0
    v_lshlrev_b32_sdwa v98, 3, v124 dst_sel:DWORD dst_unused:UNUSED_PAD src0_sel:DWORD src1_sel:WORD_1
    ds_read_b64 v[96:97], v96
    ds_read_b64 v[98:99], v98
    v_mfma_f32_16x16x32_bf16 v[112:115], v[84:87], v[156:159], v[112:115]
    v_lshlrev_b32_sdwa v100, 3, v125 dst_sel:DWORD dst_unused:UNUSED_PAD src0_sel:DWORD src1_sel:WORD_0
    v_lshlrev_b32_sdwa v102, 3, v125 dst_sel:DWORD dst_unused:UNUSED_PAD src0_sel:DWORD src1_sel:WORD_1
    v_cvt_pk_bf16_f32 v34, v34, v35
    v_cvt_pk_bf16_f32 v35, v36, v37
    v_lshlrev_b32 v36, 16, v38
    v_and_b32 v37, s23, v38
    v_lshlrev_b32 v38, 16, v39
    v_and_b32 v39, s23, v39
    ds_read_b64 v[100:101], v100
    ds_read_b64 v[102:103], v102
    s_waitcnt lgkmcnt(8)
    v_smfmac_f32_16x16x64_bf16 v[36:39], v[66:69], v[104:111], v70
    v_cvt_pk_bf16_f32 v112, v112, v113
    v_cvt_pk_bf16_f32 v113, v114, v115
    v_lshlrev_b32_sdwa v114, 3, v70 dst_sel:DWORD dst_unused:UNUSED_PAD src0_sel:DWORD src1_sel:WORD_1
    ds_write_b64 v114, v[112:113] offset:128
    v_lshlrev_b32_sdwa v104, 3, v126 dst_sel:DWORD dst_unused:UNUSED_PAD src0_sel:DWORD src1_sel:WORD_0
    v_lshlrev_b32_sdwa v106, 3, v126 dst_sel:DWORD dst_unused:UNUSED_PAD src0_sel:DWORD src1_sel:WORD_1
    ds_read_b64 v[104:105], v104
    ds_read_b64 v[106:107], v106
    v_lshlrev_b32_sdwa v108, 3, v127 dst_sel:DWORD dst_unused:UNUSED_PAD src0_sel:DWORD src1_sel:WORD_0
    v_lshlrev_b32_sdwa v110, 3, v127 dst_sel:DWORD dst_unused:UNUSED_PAD src0_sel:DWORD src1_sel:WORD_1
    ds_read_b64 v[108:109], v108
    ds_read_b64 v[110:111], v110
    buffer_load_dwordx4 v[124:127], v71, s[12:15], s20 offen offset:1024 sc1
    s_waitcnt lgkmcnt(9)
    v_smfmac_f32_16x16x64_bf16 v[36:39], v[66:69], v[88:95], v70
    v_mfma_f32_16x16x32_bf16 v[112:115], v[72:75], v[160:163], 0
    s_waitcnt vmcnt(2)
    v_lshlrev_b32_sdwa v88, 3, v116 dst_sel:DWORD dst_unused:UNUSED_PAD src0_sel:DWORD src1_sel:WORD_0
    v_lshlrev_b32_sdwa v90, 3, v116 dst_sel:DWORD dst_unused:UNUSED_PAD src0_sel:DWORD src1_sel:WORD_1
    ds_read_b64 v[88:89], v88
    ds_read_b64 v[90:91], v90
    v_mfma_f32_16x16x32_bf16 v[112:115], v[76:79], v[164:167], v[112:115]
    v_lshlrev_b32_sdwa v92, 3, v117 dst_sel:DWORD dst_unused:UNUSED_PAD src0_sel:DWORD src1_sel:WORD_0
    v_lshlrev_b32_sdwa v94, 3, v117 dst_sel:DWORD dst_unused:UNUSED_PAD src0_sel:DWORD src1_sel:WORD_1
    v_cvt_pk_bf16_f32 v36, v36, v37
    v_cvt_pk_bf16_f32 v37, v38, v39
    v_lshlrev_b32 v38, 16, v40
    v_and_b32 v39, s23, v40
    v_lshlrev_b32 v40, 16, v41
    v_and_b32 v41, s23, v41
    ds_read_b64 v[92:93], v92
    ds_read_b64 v[94:95], v94
    s_waitcnt lgkmcnt(9)
    v_smfmac_f32_16x16x64_bf16 v[38:41], v[66:69], v[96:103], v70
    v_mfma_f32_16x16x32_bf16 v[112:115], v[80:83], v[168:171], v[112:115]
    v_lshlrev_b32_sdwa v96, 3, v118 dst_sel:DWORD dst_unused:UNUSED_PAD src0_sel:DWORD src1_sel:WORD_0
    v_lshlrev_b32_sdwa v98, 3, v118 dst_sel:DWORD dst_unused:UNUSED_PAD src0_sel:DWORD src1_sel:WORD_1
    ds_read_b64 v[96:97], v96
    ds_read_b64 v[98:99], v98
    v_mfma_f32_16x16x32_bf16 v[112:115], v[84:87], v[172:175], v[112:115]
    v_lshlrev_b32_sdwa v100, 3, v119 dst_sel:DWORD dst_unused:UNUSED_PAD src0_sel:DWORD src1_sel:WORD_0
    v_lshlrev_b32_sdwa v102, 3, v119 dst_sel:DWORD dst_unused:UNUSED_PAD src0_sel:DWORD src1_sel:WORD_1
    ds_read_b64 v[100:101], v100
    ds_read_b64 v[102:103], v102
    buffer_load_dwordx4 v[116:119], v71, s[12:15], s20 offen offset:0 sc1
    s_waitcnt lgkmcnt(8)
    v_smfmac_f32_16x16x64_bf16 v[38:41], v[66:69], v[104:111], v70
    s_nop 0
    v_cvt_pk_bf16_f32 v112, v112, v113
    v_cvt_pk_bf16_f32 v113, v114, v115
    v_lshlrev_b32_sdwa v114, 3, v70 dst_sel:DWORD dst_unused:UNUSED_PAD src0_sel:DWORD src1_sel:WORD_1
    ds_write_b64 v114, v[112:113] offset:256
    s_waitcnt vmcnt(2)
    v_lshlrev_b32_sdwa v104, 3, v120 dst_sel:DWORD dst_unused:UNUSED_PAD src0_sel:DWORD src1_sel:WORD_0
    v_lshlrev_b32_sdwa v106, 3, v120 dst_sel:DWORD dst_unused:UNUSED_PAD src0_sel:DWORD src1_sel:WORD_1
    ds_read_b64 v[104:105], v104
    ds_read_b64 v[106:107], v106
    v_lshlrev_b32_sdwa v108, 3, v121 dst_sel:DWORD dst_unused:UNUSED_PAD src0_sel:DWORD src1_sel:WORD_0
    v_lshlrev_b32_sdwa v110, 3, v121 dst_sel:DWORD dst_unused:UNUSED_PAD src0_sel:DWORD src1_sel:WORD_1
    v_cvt_pk_bf16_f32 v38, v38, v39
    v_cvt_pk_bf16_f32 v39, v40, v41
    v_lshlrev_b32 v40, 16, v42
    v_and_b32 v41, s23, v42
    v_lshlrev_b32 v42, 16, v43
    v_and_b32 v43, s23, v43
    ds_read_b64 v[108:109], v108
    ds_read_b64 v[110:111], v110
    s_waitcnt lgkmcnt(9)
    v_smfmac_f32_16x16x64_bf16 v[40:43], v[66:69], v[88:95], v70
    v_mfma_f32_16x16x32_bf16 v[112:115], v[72:75], v[176:179], 0
    v_lshlrev_b32_sdwa v88, 3, v122 dst_sel:DWORD dst_unused:UNUSED_PAD src0_sel:DWORD src1_sel:WORD_0
    v_lshlrev_b32_sdwa v90, 3, v122 dst_sel:DWORD dst_unused:UNUSED_PAD src0_sel:DWORD src1_sel:WORD_1
    ds_read_b64 v[88:89], v88
    ds_read_b64 v[90:91], v90
    v_mfma_f32_16x16x32_bf16 v[112:115], v[76:79], v[180:183], v[112:115]
    v_lshlrev_b32_sdwa v92, 3, v123 dst_sel:DWORD dst_unused:UNUSED_PAD src0_sel:DWORD src1_sel:WORD_0
    v_lshlrev_b32_sdwa v94, 3, v123 dst_sel:DWORD dst_unused:UNUSED_PAD src0_sel:DWORD src1_sel:WORD_1
    ds_read_b64 v[92:93], v92
    ds_read_b64 v[94:95], v94
    s_add_u32 s20, s20, 0xfffff000
    buffer_load_dwordx4 v[120:123], v71, s[12:15], s20 offen offset:3072 sc1
    s_waitcnt lgkmcnt(9)
    v_smfmac_f32_16x16x64_bf16 v[40:43], v[66:69], v[96:103], v70
    v_mfma_f32_16x16x32_bf16 v[112:115], v[80:83], v[184:187], v[112:115]
    s_waitcnt vmcnt(2)
    v_lshlrev_b32_sdwa v96, 3, v124 dst_sel:DWORD dst_unused:UNUSED_PAD src0_sel:DWORD src1_sel:WORD_0
    v_lshlrev_b32_sdwa v98, 3, v124 dst_sel:DWORD dst_unused:UNUSED_PAD src0_sel:DWORD src1_sel:WORD_1
    ds_read_b64 v[96:97], v96
    ds_read_b64 v[98:99], v98
    v_mfma_f32_16x16x32_bf16 v[112:115], v[84:87], v[188:191], v[112:115]
    v_lshlrev_b32_sdwa v100, 3, v125 dst_sel:DWORD dst_unused:UNUSED_PAD src0_sel:DWORD src1_sel:WORD_0
    v_lshlrev_b32_sdwa v102, 3, v125 dst_sel:DWORD dst_unused:UNUSED_PAD src0_sel:DWORD src1_sel:WORD_1
    v_cvt_pk_bf16_f32 v40, v40, v41
    v_cvt_pk_bf16_f32 v41, v42, v43
    v_lshlrev_b32 v42, 16, v44
    v_and_b32 v43, s23, v44
    v_lshlrev_b32 v44, 16, v45
    v_and_b32 v45, s23, v45
    ds_read_b64 v[100:101], v100
    ds_read_b64 v[102:103], v102
    s_waitcnt lgkmcnt(8)
    v_smfmac_f32_16x16x64_bf16 v[42:45], v[66:69], v[104:111], v70
    v_cvt_pk_bf16_f32 v112, v112, v113
    v_cvt_pk_bf16_f32 v113, v114, v115
    v_lshlrev_b32_sdwa v114, 3, v70 dst_sel:DWORD dst_unused:UNUSED_PAD src0_sel:DWORD src1_sel:WORD_1
    ds_write_b64 v114, v[112:113] offset:384
    v_lshlrev_b32_sdwa v104, 3, v126 dst_sel:DWORD dst_unused:UNUSED_PAD src0_sel:DWORD src1_sel:WORD_0
    v_lshlrev_b32_sdwa v106, 3, v126 dst_sel:DWORD dst_unused:UNUSED_PAD src0_sel:DWORD src1_sel:WORD_1
    ds_read_b64 v[104:105], v104
    ds_read_b64 v[106:107], v106
    v_lshlrev_b32_sdwa v108, 3, v127 dst_sel:DWORD dst_unused:UNUSED_PAD src0_sel:DWORD src1_sel:WORD_0
    v_lshlrev_b32_sdwa v110, 3, v127 dst_sel:DWORD dst_unused:UNUSED_PAD src0_sel:DWORD src1_sel:WORD_1
    ds_read_b64 v[108:109], v108
    ds_read_b64 v[110:111], v110
    buffer_load_dwordx4 v[124:127], v71, s[12:15], s20 offen offset:2048 sc1
    s_waitcnt lgkmcnt(9)
    v_smfmac_f32_16x16x64_bf16 v[42:45], v[66:69], v[88:95], v70
    v_mfma_f32_16x16x32_bf16 v[112:115], v[72:75], v[192:195], 0
    s_waitcnt vmcnt(2)
    v_lshlrev_b32_sdwa v88, 3, v116 dst_sel:DWORD dst_unused:UNUSED_PAD src0_sel:DWORD src1_sel:WORD_0
    v_lshlrev_b32_sdwa v90, 3, v116 dst_sel:DWORD dst_unused:UNUSED_PAD src0_sel:DWORD src1_sel:WORD_1
    ds_read_b64 v[88:89], v88
    ds_read_b64 v[90:91], v90
    v_mfma_f32_16x16x32_bf16 v[112:115], v[76:79], v[196:199], v[112:115]
    v_lshlrev_b32_sdwa v92, 3, v117 dst_sel:DWORD dst_unused:UNUSED_PAD src0_sel:DWORD src1_sel:WORD_0
    v_lshlrev_b32_sdwa v94, 3, v117 dst_sel:DWORD dst_unused:UNUSED_PAD src0_sel:DWORD src1_sel:WORD_1
    v_cvt_pk_bf16_f32 v42, v42, v43
    v_cvt_pk_bf16_f32 v43, v44, v45
    v_lshlrev_b32 v44, 16, v46
    v_and_b32 v45, s23, v46
    v_lshlrev_b32 v46, 16, v47
    v_and_b32 v47, s23, v47
    ds_read_b64 v[92:93], v92
    ds_read_b64 v[94:95], v94
    s_waitcnt lgkmcnt(9)
    v_smfmac_f32_16x16x64_bf16 v[44:47], v[66:69], v[96:103], v70
    v_mfma_f32_16x16x32_bf16 v[112:115], v[80:83], v[200:203], v[112:115]
    v_lshlrev_b32_sdwa v96, 3, v118 dst_sel:DWORD dst_unused:UNUSED_PAD src0_sel:DWORD src1_sel:WORD_0
    v_lshlrev_b32_sdwa v98, 3, v118 dst_sel:DWORD dst_unused:UNUSED_PAD src0_sel:DWORD src1_sel:WORD_1
    ds_read_b64 v[96:97], v96
    ds_read_b64 v[98:99], v98
    v_mfma_f32_16x16x32_bf16 v[112:115], v[84:87], v[204:207], v[112:115]
    v_lshlrev_b32_sdwa v100, 3, v119 dst_sel:DWORD dst_unused:UNUSED_PAD src0_sel:DWORD src1_sel:WORD_0
    v_lshlrev_b32_sdwa v102, 3, v119 dst_sel:DWORD dst_unused:UNUSED_PAD src0_sel:DWORD src1_sel:WORD_1
    ds_read_b64 v[100:101], v100
    ds_read_b64 v[102:103], v102
    buffer_load_dwordx4 v[116:119], v71, s[12:15], s20 offen offset:1024 sc1
    s_waitcnt lgkmcnt(8)
    v_smfmac_f32_16x16x64_bf16 v[44:47], v[66:69], v[104:111], v70
    s_nop 0
    v_cvt_pk_bf16_f32 v112, v112, v113
    v_cvt_pk_bf16_f32 v113, v114, v115
    v_lshlrev_b32_sdwa v114, 3, v70 dst_sel:DWORD dst_unused:UNUSED_PAD src0_sel:DWORD src1_sel:WORD_1
    ds_write_b64 v114, v[112:113] offset:512
    s_waitcnt vmcnt(2)
    v_lshlrev_b32_sdwa v104, 3, v120 dst_sel:DWORD dst_unused:UNUSED_PAD src0_sel:DWORD src1_sel:WORD_0
    v_lshlrev_b32_sdwa v106, 3, v120 dst_sel:DWORD dst_unused:UNUSED_PAD src0_sel:DWORD src1_sel:WORD_1
    ds_read_b64 v[104:105], v104
    ds_read_b64 v[106:107], v106
    v_lshlrev_b32_sdwa v108, 3, v121 dst_sel:DWORD dst_unused:UNUSED_PAD src0_sel:DWORD src1_sel:WORD_0
    v_lshlrev_b32_sdwa v110, 3, v121 dst_sel:DWORD dst_unused:UNUSED_PAD src0_sel:DWORD src1_sel:WORD_1
    v_cvt_pk_bf16_f32 v44, v44, v45
    v_cvt_pk_bf16_f32 v45, v46, v47
    v_lshlrev_b32 v46, 16, v48
    v_and_b32 v47, s23, v48
    v_lshlrev_b32 v48, 16, v49
    v_and_b32 v49, s23, v49
    ds_read_b64 v[108:109], v108
    ds_read_b64 v[110:111], v110
    s_waitcnt lgkmcnt(9)
    v_smfmac_f32_16x16x64_bf16 v[46:49], v[66:69], v[88:95], v70
    s_setprio 2
    v_mfma_f32_16x16x32_bf16 v[112:115], v[72:75], v[208:211], 0
    v_lshlrev_b32_sdwa v88, 3, v122 dst_sel:DWORD dst_unused:UNUSED_PAD src0_sel:DWORD src1_sel:WORD_0
    v_lshlrev_b32_sdwa v90, 3, v122 dst_sel:DWORD dst_unused:UNUSED_PAD src0_sel:DWORD src1_sel:WORD_1
    ds_read_b64 v[88:89], v88
    ds_read_b64 v[90:91], v90
    v_mfma_f32_16x16x32_bf16 v[112:115], v[76:79], v[212:215], v[112:115]
    v_lshlrev_b32_sdwa v92, 3, v123 dst_sel:DWORD dst_unused:UNUSED_PAD src0_sel:DWORD src1_sel:WORD_0
    v_lshlrev_b32_sdwa v94, 3, v123 dst_sel:DWORD dst_unused:UNUSED_PAD src0_sel:DWORD src1_sel:WORD_1
    ds_read_b64 v[92:93], v92
    ds_read_b64 v[94:95], v94
    buffer_load_dwordx4 v[120:123], v71, s[12:15], s20 offen offset:0 sc1
    s_waitcnt lgkmcnt(9)
    v_smfmac_f32_16x16x64_bf16 v[46:49], v[66:69], v[96:103], v70
    v_mfma_f32_16x16x32_bf16 v[112:115], v[80:83], v[216:219], v[112:115]
    s_waitcnt vmcnt(2)
    v_lshlrev_b32_sdwa v96, 3, v124 dst_sel:DWORD dst_unused:UNUSED_PAD src0_sel:DWORD src1_sel:WORD_0
    v_lshlrev_b32_sdwa v98, 3, v124 dst_sel:DWORD dst_unused:UNUSED_PAD src0_sel:DWORD src1_sel:WORD_1
    ds_read_b64 v[96:97], v96
    ds_read_b64 v[98:99], v98
    v_mfma_f32_16x16x32_bf16 v[112:115], v[84:87], v[220:223], v[112:115]
    v_lshlrev_b32_sdwa v100, 3, v125 dst_sel:DWORD dst_unused:UNUSED_PAD src0_sel:DWORD src1_sel:WORD_0
    v_lshlrev_b32_sdwa v102, 3, v125 dst_sel:DWORD dst_unused:UNUSED_PAD src0_sel:DWORD src1_sel:WORD_1
    v_cvt_pk_bf16_f32 v46, v46, v47
    v_cvt_pk_bf16_f32 v47, v48, v49
    v_lshlrev_b32 v48, 16, v50
    v_and_b32 v49, s23, v50
    v_lshlrev_b32 v50, 16, v51
    v_and_b32 v51, s23, v51
    ds_read_b64 v[100:101], v100
    ds_read_b64 v[102:103], v102
    s_waitcnt lgkmcnt(8)
    v_smfmac_f32_16x16x64_bf16 v[48:51], v[66:69], v[104:111], v70
    v_cvt_pk_bf16_f32 v112, v112, v113
    v_cvt_pk_bf16_f32 v113, v114, v115
    v_lshlrev_b32_sdwa v114, 3, v70 dst_sel:DWORD dst_unused:UNUSED_PAD src0_sel:DWORD src1_sel:WORD_1
    ds_write_b64 v114, v[112:113] offset:640
    v_lshlrev_b32_sdwa v104, 3, v126 dst_sel:DWORD dst_unused:UNUSED_PAD src0_sel:DWORD src1_sel:WORD_0
    v_lshlrev_b32_sdwa v106, 3, v126 dst_sel:DWORD dst_unused:UNUSED_PAD src0_sel:DWORD src1_sel:WORD_1
    ds_read_b64 v[104:105], v104
    ds_read_b64 v[106:107], v106
    v_lshlrev_b32_sdwa v108, 3, v127 dst_sel:DWORD dst_unused:UNUSED_PAD src0_sel:DWORD src1_sel:WORD_0
    v_lshlrev_b32_sdwa v110, 3, v127 dst_sel:DWORD dst_unused:UNUSED_PAD src0_sel:DWORD src1_sel:WORD_1
    ds_read_b64 v[108:109], v108
    ds_read_b64 v[110:111], v110
    s_add_u32 s20, s20, 0xfffffc00
    buffer_load_dwordx4 v[124:127], v71, s[12:15], s20 offen offset:0 sc1
    s_waitcnt lgkmcnt(9)
    v_smfmac_f32_16x16x64_bf16 v[48:51], v[66:69], v[88:95], v70
    v_mfma_f32_16x16x32_bf16 v[112:115], v[72:75], v[224:227], 0
    s_waitcnt vmcnt(2)
    v_lshlrev_b32_sdwa v88, 3, v116 dst_sel:DWORD dst_unused:UNUSED_PAD src0_sel:DWORD src1_sel:WORD_0
    v_lshlrev_b32_sdwa v90, 3, v116 dst_sel:DWORD dst_unused:UNUSED_PAD src0_sel:DWORD src1_sel:WORD_1
    ds_read_b64 v[88:89], v88
    ds_read_b64 v[90:91], v90
    v_mfma_f32_16x16x32_bf16 v[112:115], v[76:79], v[228:231], v[112:115]
    v_lshlrev_b32_sdwa v92, 3, v117 dst_sel:DWORD dst_unused:UNUSED_PAD src0_sel:DWORD src1_sel:WORD_0
    v_lshlrev_b32_sdwa v94, 3, v117 dst_sel:DWORD dst_unused:UNUSED_PAD src0_sel:DWORD src1_sel:WORD_1
    v_cvt_pk_bf16_f32 v48, v48, v49
    v_cvt_pk_bf16_f32 v49, v50, v51
    v_lshlrev_b32 v50, 16, v52
    v_and_b32 v51, s23, v52
    v_lshlrev_b32 v52, 16, v53
    v_and_b32 v53, s23, v53
    ds_read_b64 v[92:93], v92
    ds_read_b64 v[94:95], v94
    s_waitcnt lgkmcnt(9)
    v_smfmac_f32_16x16x64_bf16 v[50:53], v[66:69], v[96:103], v70
    v_mfma_f32_16x16x32_bf16 v[112:115], v[80:83], v[232:235], v[112:115]
    v_lshlrev_b32_sdwa v96, 3, v118 dst_sel:DWORD dst_unused:UNUSED_PAD src0_sel:DWORD src1_sel:WORD_0
    v_lshlrev_b32_sdwa v98, 3, v118 dst_sel:DWORD dst_unused:UNUSED_PAD src0_sel:DWORD src1_sel:WORD_1
    ds_read_b64 v[96:97], v96
    ds_read_b64 v[98:99], v98
    v_mfma_f32_16x16x32_bf16 v[112:115], v[84:87], v[236:239], v[112:115]
    v_lshlrev_b32_sdwa v100, 3, v119 dst_sel:DWORD dst_unused:UNUSED_PAD src0_sel:DWORD src1_sel:WORD_0
    v_lshlrev_b32_sdwa v102, 3, v119 dst_sel:DWORD dst_unused:UNUSED_PAD src0_sel:DWORD src1_sel:WORD_1
    ds_read_b64 v[100:101], v100
    ds_read_b64 v[102:103], v102
    s_add_u32 s20, s20, 0xfffffc00
    buffer_load_dwordx4 v[116:119], v71, s[12:15], s20 offen offset:0 sc1
    s_waitcnt lgkmcnt(8)
    v_smfmac_f32_16x16x64_bf16 v[50:53], v[66:69], v[104:111], v70
    v_cvt_pk_bf16_f32 v112, v112, v113
    v_cvt_pk_bf16_f32 v113, v114, v115
    v_lshlrev_b32_sdwa v114, 3, v70 dst_sel:DWORD dst_unused:UNUSED_PAD src0_sel:DWORD src1_sel:WORD_1
    ds_write_b64 v114, v[112:113] offset:768
    s_waitcnt vmcnt(2)
    v_lshlrev_b32_sdwa v104, 3, v120 dst_sel:DWORD dst_unused:UNUSED_PAD src0_sel:DWORD src1_sel:WORD_0
    v_lshlrev_b32_sdwa v106, 3, v120 dst_sel:DWORD dst_unused:UNUSED_PAD src0_sel:DWORD src1_sel:WORD_1
    ds_read_b64 v[104:105], v104
    ds_read_b64 v[106:107], v106
    v_lshlrev_b32_sdwa v108, 3, v121 dst_sel:DWORD dst_unused:UNUSED_PAD src0_sel:DWORD src1_sel:WORD_0
    v_lshlrev_b32_sdwa v110, 3, v121 dst_sel:DWORD dst_unused:UNUSED_PAD src0_sel:DWORD src1_sel:WORD_1
    v_cvt_pk_bf16_f32 v50, v50, v51
    v_cvt_pk_bf16_f32 v51, v52, v53
    v_lshlrev_b32 v52, 16, v54
    v_and_b32 v53, s23, v54
    v_lshlrev_b32 v54, 16, v55
    v_and_b32 v55, s23, v55
    ds_read_b64 v[108:109], v108
    ds_read_b64 v[110:111], v110
    s_waitcnt lgkmcnt(9)
    v_smfmac_f32_16x16x64_bf16 v[52:55], v[66:69], v[88:95], v70
    v_mfma_f32_16x16x32_bf16 v[112:115], v[72:75], v[240:243], 0
    buffer_load_dwordx4 v[72:75], v71, s[12:15], s21 offen offset:0
    v_lshlrev_b32_sdwa v88, 3, v122 dst_sel:DWORD dst_unused:UNUSED_PAD src0_sel:DWORD src1_sel:WORD_0
    v_lshlrev_b32_sdwa v90, 3, v122 dst_sel:DWORD dst_unused:UNUSED_PAD src0_sel:DWORD src1_sel:WORD_1
    ds_read_b64 v[88:89], v88
    ds_read_b64 v[90:91], v90
    v_mfma_f32_16x16x32_bf16 v[112:115], v[76:79], v[244:247], v[112:115]
    buffer_load_dwordx4 v[76:79], v71, s[12:15], s21 offen offset:1024
    v_lshlrev_b32_sdwa v92, 3, v123 dst_sel:DWORD dst_unused:UNUSED_PAD src0_sel:DWORD src1_sel:WORD_0
    v_lshlrev_b32_sdwa v94, 3, v123 dst_sel:DWORD dst_unused:UNUSED_PAD src0_sel:DWORD src1_sel:WORD_1
    ds_read_b64 v[92:93], v92
    ds_read_b64 v[94:95], v94
    s_add_u32 s20, s20, 0x3c00
    buffer_load_dwordx4 v[120:123], v71, s[12:15], s20 offen offset:0 sc1
    s_waitcnt lgkmcnt(9)
    v_smfmac_f32_16x16x64_bf16 v[52:55], v[66:69], v[96:103], v70
    v_mfma_f32_16x16x32_bf16 v[112:115], v[80:83], v[248:251], v[112:115]
    buffer_load_dwordx4 v[80:83], v71, s[12:15], s19 offen offset:0
    s_waitcnt vmcnt(5)
    v_lshlrev_b32_sdwa v96, 3, v124 dst_sel:DWORD dst_unused:UNUSED_PAD src0_sel:DWORD src1_sel:WORD_0
    v_lshlrev_b32_sdwa v98, 3, v124 dst_sel:DWORD dst_unused:UNUSED_PAD src0_sel:DWORD src1_sel:WORD_1
    ds_read_b64 v[96:97], v96
    ds_read_b64 v[98:99], v98
    v_mfma_f32_16x16x32_bf16 v[112:115], v[84:87], v[252:255], v[112:115]
    buffer_load_dwordx4 v[84:87], v71, s[12:15], s19 offen offset:1024
    s_add_u32 s21, s21, 4096
    s_add_u32 s19, s19, 4096
    v_lshlrev_b32_sdwa v100, 3, v125 dst_sel:DWORD dst_unused:UNUSED_PAD src0_sel:DWORD src1_sel:WORD_0
    v_lshlrev_b32_sdwa v102, 3, v125 dst_sel:DWORD dst_unused:UNUSED_PAD src0_sel:DWORD src1_sel:WORD_1
    v_cvt_pk_bf16_f32 v52, v52, v53
    v_cvt_pk_bf16_f32 v53, v54, v55
    v_lshlrev_b32 v54, 16, v56
    v_and_b32 v55, s23, v56
    v_lshlrev_b32 v56, 16, v57
    v_and_b32 v57, s23, v57
    ds_read_b64 v[100:101], v100
    ds_read_b64 v[102:103], v102
    s_waitcnt lgkmcnt(8)
    v_smfmac_f32_16x16x64_bf16 v[54:57], v[66:69], v[104:111], v70
    v_cvt_pk_bf16_f32 v112, v112, v113
    v_cvt_pk_bf16_f32 v113, v114, v115
    v_lshlrev_b32_sdwa v114, 3, v70 dst_sel:DWORD dst_unused:UNUSED_PAD src0_sel:DWORD src1_sel:WORD_1
    ds_write_b64 v114, v[112:113] offset:896
    s_setprio 1
    v_lshlrev_b32_sdwa v104, 3, v126 dst_sel:DWORD dst_unused:UNUSED_PAD src0_sel:DWORD src1_sel:WORD_0
    v_lshlrev_b32_sdwa v106, 3, v126 dst_sel:DWORD dst_unused:UNUSED_PAD src0_sel:DWORD src1_sel:WORD_1
    ds_read_b64 v[104:105], v104
    ds_read_b64 v[106:107], v106
    v_lshlrev_b32_sdwa v108, 3, v127 dst_sel:DWORD dst_unused:UNUSED_PAD src0_sel:DWORD src1_sel:WORD_0
    v_lshlrev_b32_sdwa v110, 3, v127 dst_sel:DWORD dst_unused:UNUSED_PAD src0_sel:DWORD src1_sel:WORD_1
    ds_read_b64 v[108:109], v108
    ds_read_b64 v[110:111], v110
    s_add_u32 s20, s20, 0xfffffc00
    buffer_load_dwordx4 v[124:127], v71, s[12:15], s20 offen offset:0 sc1
    s_waitcnt lgkmcnt(9)
    v_smfmac_f32_16x16x64_bf16 v[54:57], v[66:69], v[88:95], v70
    s_waitcnt vmcnt(6)
    v_lshlrev_b32_sdwa v88, 3, v116 dst_sel:DWORD dst_unused:UNUSED_PAD src0_sel:DWORD src1_sel:WORD_0
    v_lshlrev_b32_sdwa v90, 3, v116 dst_sel:DWORD dst_unused:UNUSED_PAD src0_sel:DWORD src1_sel:WORD_1
    ds_read_b64 v[88:89], v88
    ds_read_b64 v[90:91], v90
    v_lshlrev_b32_sdwa v92, 3, v117 dst_sel:DWORD dst_unused:UNUSED_PAD src0_sel:DWORD src1_sel:WORD_0
    v_lshlrev_b32_sdwa v94, 3, v117 dst_sel:DWORD dst_unused:UNUSED_PAD src0_sel:DWORD src1_sel:WORD_1
    s_nop 0
    v_cvt_pk_bf16_f32 v54, v54, v55
    v_cvt_pk_bf16_f32 v55, v56, v57
    v_lshlrev_b32 v56, 16, v58
    v_and_b32 v57, s23, v58
    v_lshlrev_b32 v58, 16, v59
    v_and_b32 v59, s23, v59
    ds_read_b64 v[92:93], v92
    ds_read_b64 v[94:95], v94
    s_waitcnt lgkmcnt(9)
    v_smfmac_f32_16x16x64_bf16 v[56:59], v[66:69], v[96:103], v70
    v_lshlrev_b32_sdwa v96, 3, v118 dst_sel:DWORD dst_unused:UNUSED_PAD src0_sel:DWORD src1_sel:WORD_0
    v_lshlrev_b32_sdwa v98, 3, v118 dst_sel:DWORD dst_unused:UNUSED_PAD src0_sel:DWORD src1_sel:WORD_1
    ds_read_b64 v[96:97], v96
    ds_read_b64 v[98:99], v98
    v_lshlrev_b32_sdwa v100, 3, v119 dst_sel:DWORD dst_unused:UNUSED_PAD src0_sel:DWORD src1_sel:WORD_0
    v_lshlrev_b32_sdwa v102, 3, v119 dst_sel:DWORD dst_unused:UNUSED_PAD src0_sel:DWORD src1_sel:WORD_1
    ds_read_b64 v[100:101], v100
    ds_read_b64 v[102:103], v102
    s_add_u32 s20, s20, 0x1ec00
    buffer_load_dwordx4 v[116:119], v71, s[12:15], s20 offen offset:3072 sc1
    s_waitcnt lgkmcnt(8)
    v_smfmac_f32_16x16x64_bf16 v[56:59], v[66:69], v[104:111], v70
    s_waitcnt vmcnt(4)
    v_lshlrev_b32_sdwa v104, 3, v120 dst_sel:DWORD dst_unused:UNUSED_PAD src0_sel:DWORD src1_sel:WORD_0
    v_lshlrev_b32_sdwa v106, 3, v120 dst_sel:DWORD dst_unused:UNUSED_PAD src0_sel:DWORD src1_sel:WORD_1
    ds_read_b64 v[104:105], v104
    ds_read_b64 v[106:107], v106
    v_lshlrev_b32_sdwa v108, 3, v121 dst_sel:DWORD dst_unused:UNUSED_PAD src0_sel:DWORD src1_sel:WORD_0
    v_lshlrev_b32_sdwa v110, 3, v121 dst_sel:DWORD dst_unused:UNUSED_PAD src0_sel:DWORD src1_sel:WORD_1
    s_nop 0
    v_cvt_pk_bf16_f32 v56, v56, v57
    v_cvt_pk_bf16_f32 v57, v58, v59
    v_lshlrev_b32 v58, 16, v60
    v_and_b32 v59, s23, v60
    v_lshlrev_b32 v60, 16, v61
    v_and_b32 v61, s23, v61
    ds_read_b64 v[108:109], v108
    ds_read_b64 v[110:111], v110
    s_waitcnt lgkmcnt(8)
    v_smfmac_f32_16x16x64_bf16 v[58:61], v[66:69], v[88:95], v70
    v_lshlrev_b32_sdwa v88, 3, v122 dst_sel:DWORD dst_unused:UNUSED_PAD src0_sel:DWORD src1_sel:WORD_0
    v_lshlrev_b32_sdwa v90, 3, v122 dst_sel:DWORD dst_unused:UNUSED_PAD src0_sel:DWORD src1_sel:WORD_1
    ds_read_b64 v[88:89], v88
    ds_read_b64 v[90:91], v90
    v_lshlrev_b32_sdwa v92, 3, v123 dst_sel:DWORD dst_unused:UNUSED_PAD src0_sel:DWORD src1_sel:WORD_0
    v_lshlrev_b32_sdwa v94, 3, v123 dst_sel:DWORD dst_unused:UNUSED_PAD src0_sel:DWORD src1_sel:WORD_1
    ds_read_b64 v[92:93], v92
    ds_read_b64 v[94:95], v94
    buffer_load_dwordx4 v[120:123], v71, s[12:15], s20 offen offset:2048 sc1
    s_waitcnt lgkmcnt(8)
    v_smfmac_f32_16x16x64_bf16 v[58:61], v[66:69], v[96:103], v70
    s_waitcnt vmcnt(2)
    v_lshlrev_b32_sdwa v96, 3, v124 dst_sel:DWORD dst_unused:UNUSED_PAD src0_sel:DWORD src1_sel:WORD_0
    v_lshlrev_b32_sdwa v98, 3, v124 dst_sel:DWORD dst_unused:UNUSED_PAD src0_sel:DWORD src1_sel:WORD_1
    ds_read_b64 v[96:97], v96
    ds_read_b64 v[98:99], v98
    v_lshlrev_b32_sdwa v100, 3, v125 dst_sel:DWORD dst_unused:UNUSED_PAD src0_sel:DWORD src1_sel:WORD_0
    v_lshlrev_b32_sdwa v102, 3, v125 dst_sel:DWORD dst_unused:UNUSED_PAD src0_sel:DWORD src1_sel:WORD_1
    s_nop 0
    v_cvt_pk_bf16_f32 v58, v58, v59
    v_cvt_pk_bf16_f32 v59, v60, v61
    v_lshlrev_b32 v60, 16, v62
    v_and_b32 v61, s23, v62
    v_lshlrev_b32 v62, 16, v63
    v_and_b32 v63, s23, v63
    ds_read_b64 v[100:101], v100
    ds_read_b64 v[102:103], v102
    s_waitcnt lgkmcnt(8)
    v_smfmac_f32_16x16x64_bf16 v[60:63], v[66:69], v[104:111], v70
    s_setprio 0
    v_lshlrev_b32_sdwa v104, 3, v126 dst_sel:DWORD dst_unused:UNUSED_PAD src0_sel:DWORD src1_sel:WORD_0
    v_lshlrev_b32_sdwa v106, 3, v126 dst_sel:DWORD dst_unused:UNUSED_PAD src0_sel:DWORD src1_sel:WORD_1
    ds_read_b64 v[104:105], v104
    ds_read_b64 v[106:107], v106
    v_lshlrev_b32_sdwa v108, 3, v127 dst_sel:DWORD dst_unused:UNUSED_PAD src0_sel:DWORD src1_sel:WORD_0
    v_lshlrev_b32_sdwa v110, 3, v127 dst_sel:DWORD dst_unused:UNUSED_PAD src0_sel:DWORD src1_sel:WORD_1
    ds_read_b64 v[108:109], v108
    ds_read_b64 v[110:111], v110
    buffer_load_dwordx4 v[124:127], v71, s[12:15], s20 offen offset:1024 sc1
    s_waitcnt lgkmcnt(8)
    v_smfmac_f32_16x16x64_bf16 v[60:63], v[66:69], v[88:95], v70
    s_waitcnt vmcnt(2)
    v_lshlrev_b32_sdwa v88, 3, v116 dst_sel:DWORD dst_unused:UNUSED_PAD src0_sel:DWORD src1_sel:WORD_0
    v_lshlrev_b32_sdwa v90, 3, v116 dst_sel:DWORD dst_unused:UNUSED_PAD src0_sel:DWORD src1_sel:WORD_1
    ds_read_b64 v[88:89], v88
    ds_read_b64 v[90:91], v90
    v_lshlrev_b32_sdwa v92, 3, v117 dst_sel:DWORD dst_unused:UNUSED_PAD src0_sel:DWORD src1_sel:WORD_0
    v_lshlrev_b32_sdwa v94, 3, v117 dst_sel:DWORD dst_unused:UNUSED_PAD src0_sel:DWORD src1_sel:WORD_1
    s_nop 0
    v_cvt_pk_bf16_f32 v60, v60, v61
    v_cvt_pk_bf16_f32 v61, v62, v63
    v_lshlrev_b32 v62, 16, v64
    v_and_b32 v63, s23, v64
    v_lshlrev_b32 v64, 16, v65
    v_and_b32 v65, s23, v65
    ds_read_b64 v[92:93], v92
    ds_read_b64 v[94:95], v94
    s_waitcnt lgkmcnt(8)
    v_smfmac_f32_16x16x64_bf16 v[62:65], v[66:69], v[96:103], v70
    s_barrier
    s_setprio 3
    v_lshlrev_b32_sdwa v96, 3, v118 dst_sel:DWORD dst_unused:UNUSED_PAD src0_sel:DWORD src1_sel:WORD_0
    v_lshlrev_b32_sdwa v98, 3, v118 dst_sel:DWORD dst_unused:UNUSED_PAD src0_sel:DWORD src1_sel:WORD_1
    ds_read_b64 v[96:97], v96
    ds_read_b64 v[98:99], v98
    v_lshlrev_b32_sdwa v100, 3, v119 dst_sel:DWORD dst_unused:UNUSED_PAD src0_sel:DWORD src1_sel:WORD_0
    v_lshlrev_b32_sdwa v102, 3, v119 dst_sel:DWORD dst_unused:UNUSED_PAD src0_sel:DWORD src1_sel:WORD_1
    ds_read_b64 v[100:101], v100
    ds_read_b64 v[102:103], v102
    buffer_load_dwordx4 v[116:119], v71, s[12:15], s20 offen offset:0 sc1
    s_waitcnt lgkmcnt(8)
    v_smfmac_f32_16x16x64_bf16 v[62:65], v[66:69], v[104:111], v70
    v_mfma_f32_16x16x32_bf16 v[112:115], v[72:75], v[128:131], 0
    s_waitcnt vmcnt(2)
    v_lshlrev_b32_sdwa v104, 3, v120 dst_sel:DWORD dst_unused:UNUSED_PAD src0_sel:DWORD src1_sel:WORD_0
    v_lshlrev_b32_sdwa v106, 3, v120 dst_sel:DWORD dst_unused:UNUSED_PAD src0_sel:DWORD src1_sel:WORD_1
    ds_read_b64 v[104:105], v104
    ds_read_b64 v[106:107], v106
    v_mfma_f32_16x16x32_bf16 v[112:115], v[76:79], v[132:135], v[112:115]
    v_add_u32 v70, 0xc0000000, v70
    v_lshlrev_b32_sdwa v108, 3, v121 dst_sel:DWORD dst_unused:UNUSED_PAD src0_sel:DWORD src1_sel:WORD_0
    v_lshlrev_b32_sdwa v110, 3, v121 dst_sel:DWORD dst_unused:UNUSED_PAD src0_sel:DWORD src1_sel:WORD_1
    v_cvt_pk_bf16_f32 v62, v62, v63
    v_cvt_pk_bf16_f32 v63, v64, v65
    v_mov_b64 v[64:65], v[32:33]
    v_and_b32 v33, s23, v31
    v_lshlrev_b32 v32, 16, v31
    v_and_b32 v31, s23, v30
    v_lshlrev_b32 v30, 16, v30
    ds_read_b64 v[108:109], v108
    ds_read_b64 v[110:111], v110
    s_waitcnt lgkmcnt(8)
    v_smfmac_f32_16x16x64_bf16 v[30:33], v[66:69], v[88:95], v70
    v_mfma_f32_16x16x32_bf16 v[112:115], v[80:83], v[136:139], v[112:115]
    v_lshlrev_b32_sdwa v88, 3, v122 dst_sel:DWORD dst_unused:UNUSED_PAD src0_sel:DWORD src1_sel:WORD_0
    v_lshlrev_b32_sdwa v90, 3, v122 dst_sel:DWORD dst_unused:UNUSED_PAD src0_sel:DWORD src1_sel:WORD_1
    ds_read_b64 v[88:89], v88
    ds_read_b64 v[90:91], v90
    v_mfma_f32_16x16x32_bf16 v[112:115], v[84:87], v[140:143], v[112:115]
    v_lshlrev_b32_sdwa v92, 3, v123 dst_sel:DWORD dst_unused:UNUSED_PAD src0_sel:DWORD src1_sel:WORD_0
    v_lshlrev_b32_sdwa v94, 3, v123 dst_sel:DWORD dst_unused:UNUSED_PAD src0_sel:DWORD src1_sel:WORD_1
    ds_read_b64 v[92:93], v92
    ds_read_b64 v[94:95], v94
    s_add_u32 s20, s20, 0xfffff000
    buffer_load_dwordx4 v[120:123], v71, s[12:15], s20 offen offset:3072 sc1
    s_waitcnt lgkmcnt(8)
    v_smfmac_f32_16x16x64_bf16 v[30:33], v[66:69], v[96:103], v70
    v_cvt_pk_bf16_f32 v112, v112, v113
    v_cvt_pk_bf16_f32 v113, v114, v115
    v_lshlrev_b32_sdwa v114, 3, v70 dst_sel:DWORD dst_unused:UNUSED_PAD src0_sel:DWORD src1_sel:WORD_1
    ds_write_b64 v114, v[112:113] offset:0
    s_waitcnt vmcnt(2)
    v_lshlrev_b32_sdwa v96, 3, v124 dst_sel:DWORD dst_unused:UNUSED_PAD src0_sel:DWORD src1_sel:WORD_0
    v_lshlrev_b32_sdwa v98, 3, v124 dst_sel:DWORD dst_unused:UNUSED_PAD src0_sel:DWORD src1_sel:WORD_1
    ds_read_b64 v[96:97], v96
    ds_read_b64 v[98:99], v98
    v_lshlrev_b32_sdwa v100, 3, v125 dst_sel:DWORD dst_unused:UNUSED_PAD src0_sel:DWORD src1_sel:WORD_0
    v_lshlrev_b32_sdwa v102, 3, v125 dst_sel:DWORD dst_unused:UNUSED_PAD src0_sel:DWORD src1_sel:WORD_1
    v_cvt_pk_bf16_f32 v33, v32, v33
    v_cvt_pk_bf16_f32 v32, v30, v31
    v_and_b32 v31, s23, v29
    v_lshlrev_b32 v30, 16, v29
    v_and_b32 v29, s23, v28
    v_lshlrev_b32 v28, 16, v28
    ds_read_b64 v[100:101], v100
    ds_read_b64 v[102:103], v102
    s_waitcnt lgkmcnt(9)
    v_smfmac_f32_16x16x64_bf16 v[28:31], v[66:69], v[104:111], v70
    v_mfma_f32_16x16x32_bf16 v[112:115], v[72:75], v[144:147], 0
    v_lshlrev_b32_sdwa v104, 3, v126 dst_sel:DWORD dst_unused:UNUSED_PAD src0_sel:DWORD src1_sel:WORD_0
    v_lshlrev_b32_sdwa v106, 3, v126 dst_sel:DWORD dst_unused:UNUSED_PAD src0_sel:DWORD src1_sel:WORD_1
    ds_read_b64 v[104:105], v104
    ds_read_b64 v[106:107], v106
    v_mfma_f32_16x16x32_bf16 v[112:115], v[76:79], v[148:151], v[112:115]
    v_lshlrev_b32_sdwa v108, 3, v127 dst_sel:DWORD dst_unused:UNUSED_PAD src0_sel:DWORD src1_sel:WORD_0
    v_lshlrev_b32_sdwa v110, 3, v127 dst_sel:DWORD dst_unused:UNUSED_PAD src0_sel:DWORD src1_sel:WORD_1
    ds_read_b64 v[108:109], v108
    ds_read_b64 v[110:111], v110
    buffer_load_dwordx4 v[124:127], v71, s[12:15], s20 offen offset:2048 sc1
    s_waitcnt lgkmcnt(9)
    v_smfmac_f32_16x16x64_bf16 v[28:31], v[66:69], v[88:95], v70
    v_mfma_f32_16x16x32_bf16 v[112:115], v[80:83], v[152:155], v[112:115]
    s_waitcnt vmcnt(2)
    v_lshlrev_b32_sdwa v88, 3, v116 dst_sel:DWORD dst_unused:UNUSED_PAD src0_sel:DWORD src1_sel:WORD_0
    v_lshlrev_b32_sdwa v90, 3, v116 dst_sel:DWORD dst_unused:UNUSED_PAD src0_sel:DWORD src1_sel:WORD_1
    ds_read_b64 v[88:89], v88
    ds_read_b64 v[90:91], v90
    v_mfma_f32_16x16x32_bf16 v[112:115], v[84:87], v[156:159], v[112:115]
    v_lshlrev_b32_sdwa v92, 3, v117 dst_sel:DWORD dst_unused:UNUSED_PAD src0_sel:DWORD src1_sel:WORD_0
    v_lshlrev_b32_sdwa v94, 3, v117 dst_sel:DWORD dst_unused:UNUSED_PAD src0_sel:DWORD src1_sel:WORD_1
    v_cvt_pk_bf16_f32 v31, v30, v31
    v_cvt_pk_bf16_f32 v30, v28, v29
    v_and_b32 v29, s23, v27
    v_lshlrev_b32 v28, 16, v27
    v_and_b32 v27, s23, v26
    v_lshlrev_b32 v26, 16, v26
    ds_read_b64 v[92:93], v92
    ds_read_b64 v[94:95], v94
    s_waitcnt lgkmcnt(8)
    v_smfmac_f32_16x16x64_bf16 v[26:29], v[66:69], v[96:103], v70
    v_cvt_pk_bf16_f32 v112, v112, v113
    v_cvt_pk_bf16_f32 v113, v114, v115
    v_lshlrev_b32_sdwa v114, 3, v70 dst_sel:DWORD dst_unused:UNUSED_PAD src0_sel:DWORD src1_sel:WORD_1
    ds_write_b64 v114, v[112:113] offset:128
    v_lshlrev_b32_sdwa v96, 3, v118 dst_sel:DWORD dst_unused:UNUSED_PAD src0_sel:DWORD src1_sel:WORD_0
    v_lshlrev_b32_sdwa v98, 3, v118 dst_sel:DWORD dst_unused:UNUSED_PAD src0_sel:DWORD src1_sel:WORD_1
    ds_read_b64 v[96:97], v96
    ds_read_b64 v[98:99], v98
    v_lshlrev_b32_sdwa v100, 3, v119 dst_sel:DWORD dst_unused:UNUSED_PAD src0_sel:DWORD src1_sel:WORD_0
    v_lshlrev_b32_sdwa v102, 3, v119 dst_sel:DWORD dst_unused:UNUSED_PAD src0_sel:DWORD src1_sel:WORD_1
    ds_read_b64 v[100:101], v100
    ds_read_b64 v[102:103], v102
    buffer_load_dwordx4 v[116:119], v71, s[12:15], s20 offen offset:1024 sc1
    s_waitcnt lgkmcnt(9)
    v_smfmac_f32_16x16x64_bf16 v[26:29], v[66:69], v[104:111], v70
    v_mfma_f32_16x16x32_bf16 v[112:115], v[72:75], v[160:163], 0
    s_waitcnt vmcnt(2)
    v_lshlrev_b32_sdwa v104, 3, v120 dst_sel:DWORD dst_unused:UNUSED_PAD src0_sel:DWORD src1_sel:WORD_0
    v_lshlrev_b32_sdwa v106, 3, v120 dst_sel:DWORD dst_unused:UNUSED_PAD src0_sel:DWORD src1_sel:WORD_1
    ds_read_b64 v[104:105], v104
    ds_read_b64 v[106:107], v106
    v_mfma_f32_16x16x32_bf16 v[112:115], v[76:79], v[164:167], v[112:115]
    v_lshlrev_b32_sdwa v108, 3, v121 dst_sel:DWORD dst_unused:UNUSED_PAD src0_sel:DWORD src1_sel:WORD_0
    v_lshlrev_b32_sdwa v110, 3, v121 dst_sel:DWORD dst_unused:UNUSED_PAD src0_sel:DWORD src1_sel:WORD_1
    v_cvt_pk_bf16_f32 v29, v28, v29
    v_cvt_pk_bf16_f32 v28, v26, v27
    v_and_b32 v27, s23, v25
    v_lshlrev_b32 v26, 16, v25
    v_and_b32 v25, s23, v24
    v_lshlrev_b32 v24, 16, v24
    ds_read_b64 v[108:109], v108
    ds_read_b64 v[110:111], v110
    s_waitcnt lgkmcnt(9)
    v_smfmac_f32_16x16x64_bf16 v[24:27], v[66:69], v[88:95], v70
    v_mfma_f32_16x16x32_bf16 v[112:115], v[80:83], v[168:171], v[112:115]
    v_lshlrev_b32_sdwa v88, 3, v122 dst_sel:DWORD dst_unused:UNUSED_PAD src0_sel:DWORD src1_sel:WORD_0
    v_lshlrev_b32_sdwa v90, 3, v122 dst_sel:DWORD dst_unused:UNUSED_PAD src0_sel:DWORD src1_sel:WORD_1
    ds_read_b64 v[88:89], v88
    ds_read_b64 v[90:91], v90
    v_mfma_f32_16x16x32_bf16 v[112:115], v[84:87], v[172:175], v[112:115]
    v_lshlrev_b32_sdwa v92, 3, v123 dst_sel:DWORD dst_unused:UNUSED_PAD src0_sel:DWORD src1_sel:WORD_0
    v_lshlrev_b32_sdwa v94, 3, v123 dst_sel:DWORD dst_unused:UNUSED_PAD src0_sel:DWORD src1_sel:WORD_1
    ds_read_b64 v[92:93], v92
    ds_read_b64 v[94:95], v94
    buffer_load_dwordx4 v[120:123], v71, s[12:15], s20 offen offset:0 sc1
    s_waitcnt lgkmcnt(8)
    v_smfmac_f32_16x16x64_bf16 v[24:27], v[66:69], v[96:103], v70
    s_nop 0
    v_cvt_pk_bf16_f32 v112, v112, v113
    v_cvt_pk_bf16_f32 v113, v114, v115
    v_lshlrev_b32_sdwa v114, 3, v70 dst_sel:DWORD dst_unused:UNUSED_PAD src0_sel:DWORD src1_sel:WORD_1
    ds_write_b64 v114, v[112:113] offset:256
    s_waitcnt vmcnt(2)
    v_lshlrev_b32_sdwa v96, 3, v124 dst_sel:DWORD dst_unused:UNUSED_PAD src0_sel:DWORD src1_sel:WORD_0
    v_lshlrev_b32_sdwa v98, 3, v124 dst_sel:DWORD dst_unused:UNUSED_PAD src0_sel:DWORD src1_sel:WORD_1
    ds_read_b64 v[96:97], v96
    ds_read_b64 v[98:99], v98
    v_lshlrev_b32_sdwa v100, 3, v125 dst_sel:DWORD dst_unused:UNUSED_PAD src0_sel:DWORD src1_sel:WORD_0
    v_lshlrev_b32_sdwa v102, 3, v125 dst_sel:DWORD dst_unused:UNUSED_PAD src0_sel:DWORD src1_sel:WORD_1
    v_cvt_pk_bf16_f32 v27, v26, v27
    v_cvt_pk_bf16_f32 v26, v24, v25
    v_and_b32 v25, s23, v23
    v_lshlrev_b32 v24, 16, v23
    v_and_b32 v23, s23, v22
    v_lshlrev_b32 v22, 16, v22
    ds_read_b64 v[100:101], v100
    ds_read_b64 v[102:103], v102
    s_waitcnt lgkmcnt(9)
    v_smfmac_f32_16x16x64_bf16 v[22:25], v[66:69], v[104:111], v70
    v_mfma_f32_16x16x32_bf16 v[112:115], v[72:75], v[176:179], 0
    v_lshlrev_b32_sdwa v104, 3, v126 dst_sel:DWORD dst_unused:UNUSED_PAD src0_sel:DWORD src1_sel:WORD_0
    v_lshlrev_b32_sdwa v106, 3, v126 dst_sel:DWORD dst_unused:UNUSED_PAD src0_sel:DWORD src1_sel:WORD_1
    ds_read_b64 v[104:105], v104
    ds_read_b64 v[106:107], v106
    v_mfma_f32_16x16x32_bf16 v[112:115], v[76:79], v[180:183], v[112:115]
    v_lshlrev_b32_sdwa v108, 3, v127 dst_sel:DWORD dst_unused:UNUSED_PAD src0_sel:DWORD src1_sel:WORD_0
    v_lshlrev_b32_sdwa v110, 3, v127 dst_sel:DWORD dst_unused:UNUSED_PAD src0_sel:DWORD src1_sel:WORD_1
    ds_read_b64 v[108:109], v108
    ds_read_b64 v[110:111], v110
    s_add_u32 s20, s20, 0xfffff000
    buffer_load_dwordx4 v[124:127], v71, s[12:15], s20 offen offset:3072 sc1
    s_waitcnt lgkmcnt(9)
    v_smfmac_f32_16x16x64_bf16 v[22:25], v[66:69], v[88:95], v70
    v_mfma_f32_16x16x32_bf16 v[112:115], v[80:83], v[184:187], v[112:115]
    s_waitcnt vmcnt(2)
    v_lshlrev_b32_sdwa v88, 3, v116 dst_sel:DWORD dst_unused:UNUSED_PAD src0_sel:DWORD src1_sel:WORD_0
    v_lshlrev_b32_sdwa v90, 3, v116 dst_sel:DWORD dst_unused:UNUSED_PAD src0_sel:DWORD src1_sel:WORD_1
    ds_read_b64 v[88:89], v88
    ds_read_b64 v[90:91], v90
    v_mfma_f32_16x16x32_bf16 v[112:115], v[84:87], v[188:191], v[112:115]
    v_lshlrev_b32_sdwa v92, 3, v117 dst_sel:DWORD dst_unused:UNUSED_PAD src0_sel:DWORD src1_sel:WORD_0
    v_lshlrev_b32_sdwa v94, 3, v117 dst_sel:DWORD dst_unused:UNUSED_PAD src0_sel:DWORD src1_sel:WORD_1
    v_cvt_pk_bf16_f32 v25, v24, v25
    v_cvt_pk_bf16_f32 v24, v22, v23
    v_and_b32 v23, s23, v21
    v_lshlrev_b32 v22, 16, v21
    v_and_b32 v21, s23, v20
    v_lshlrev_b32 v20, 16, v20
    ds_read_b64 v[92:93], v92
    ds_read_b64 v[94:95], v94
    s_waitcnt lgkmcnt(8)
    v_smfmac_f32_16x16x64_bf16 v[20:23], v[66:69], v[96:103], v70
    v_cvt_pk_bf16_f32 v112, v112, v113
    v_cvt_pk_bf16_f32 v113, v114, v115
    v_lshlrev_b32_sdwa v114, 3, v70 dst_sel:DWORD dst_unused:UNUSED_PAD src0_sel:DWORD src1_sel:WORD_1
    ds_write_b64 v114, v[112:113] offset:384
    v_lshlrev_b32_sdwa v96, 3, v118 dst_sel:DWORD dst_unused:UNUSED_PAD src0_sel:DWORD src1_sel:WORD_0
    v_lshlrev_b32_sdwa v98, 3, v118 dst_sel:DWORD dst_unused:UNUSED_PAD src0_sel:DWORD src1_sel:WORD_1
    ds_read_b64 v[96:97], v96
    ds_read_b64 v[98:99], v98
    v_lshlrev_b32_sdwa v100, 3, v119 dst_sel:DWORD dst_unused:UNUSED_PAD src0_sel:DWORD src1_sel:WORD_0
    v_lshlrev_b32_sdwa v102, 3, v119 dst_sel:DWORD dst_unused:UNUSED_PAD src0_sel:DWORD src1_sel:WORD_1
    ds_read_b64 v[100:101], v100
    ds_read_b64 v[102:103], v102
    buffer_load_dwordx4 v[116:119], v71, s[12:15], s20 offen offset:2048 sc1
    s_waitcnt lgkmcnt(9)
    v_smfmac_f32_16x16x64_bf16 v[20:23], v[66:69], v[104:111], v70
    v_mfma_f32_16x16x32_bf16 v[112:115], v[72:75], v[192:195], 0
    s_waitcnt vmcnt(2)
    v_lshlrev_b32_sdwa v104, 3, v120 dst_sel:DWORD dst_unused:UNUSED_PAD src0_sel:DWORD src1_sel:WORD_0
    v_lshlrev_b32_sdwa v106, 3, v120 dst_sel:DWORD dst_unused:UNUSED_PAD src0_sel:DWORD src1_sel:WORD_1
    ds_read_b64 v[104:105], v104
    ds_read_b64 v[106:107], v106
    v_mfma_f32_16x16x32_bf16 v[112:115], v[76:79], v[196:199], v[112:115]
    v_lshlrev_b32_sdwa v108, 3, v121 dst_sel:DWORD dst_unused:UNUSED_PAD src0_sel:DWORD src1_sel:WORD_0
    v_lshlrev_b32_sdwa v110, 3, v121 dst_sel:DWORD dst_unused:UNUSED_PAD src0_sel:DWORD src1_sel:WORD_1
    v_cvt_pk_bf16_f32 v23, v22, v23
    v_cvt_pk_bf16_f32 v22, v20, v21
    v_and_b32 v21, s23, v19
    v_lshlrev_b32 v20, 16, v19
    v_and_b32 v19, s23, v18
    v_lshlrev_b32 v18, 16, v18
    ds_read_b64 v[108:109], v108
    ds_read_b64 v[110:111], v110
    s_waitcnt lgkmcnt(9)
    v_smfmac_f32_16x16x64_bf16 v[18:21], v[66:69], v[88:95], v70
    v_mfma_f32_16x16x32_bf16 v[112:115], v[80:83], v[200:203], v[112:115]
    v_lshlrev_b32_sdwa v88, 3, v122 dst_sel:DWORD dst_unused:UNUSED_PAD src0_sel:DWORD src1_sel:WORD_0
    v_lshlrev_b32_sdwa v90, 3, v122 dst_sel:DWORD dst_unused:UNUSED_PAD src0_sel:DWORD src1_sel:WORD_1
    ds_read_b64 v[88:89], v88
    ds_read_b64 v[90:91], v90
    v_mfma_f32_16x16x32_bf16 v[112:115], v[84:87], v[204:207], v[112:115]
    v_lshlrev_b32_sdwa v92, 3, v123 dst_sel:DWORD dst_unused:UNUSED_PAD src0_sel:DWORD src1_sel:WORD_0
    v_lshlrev_b32_sdwa v94, 3, v123 dst_sel:DWORD dst_unused:UNUSED_PAD src0_sel:DWORD src1_sel:WORD_1
    ds_read_b64 v[92:93], v92
    ds_read_b64 v[94:95], v94
    buffer_load_dwordx4 v[120:123], v71, s[12:15], s20 offen offset:1024 sc1
    s_waitcnt lgkmcnt(8)
    v_smfmac_f32_16x16x64_bf16 v[18:21], v[66:69], v[96:103], v70
    s_nop 0
    v_cvt_pk_bf16_f32 v112, v112, v113
    v_cvt_pk_bf16_f32 v113, v114, v115
    v_lshlrev_b32_sdwa v114, 3, v70 dst_sel:DWORD dst_unused:UNUSED_PAD src0_sel:DWORD src1_sel:WORD_1
    ds_write_b64 v114, v[112:113] offset:512
    s_waitcnt vmcnt(2)
    v_lshlrev_b32_sdwa v96, 3, v124 dst_sel:DWORD dst_unused:UNUSED_PAD src0_sel:DWORD src1_sel:WORD_0
    v_lshlrev_b32_sdwa v98, 3, v124 dst_sel:DWORD dst_unused:UNUSED_PAD src0_sel:DWORD src1_sel:WORD_1
    ds_read_b64 v[96:97], v96
    ds_read_b64 v[98:99], v98
    v_lshlrev_b32_sdwa v100, 3, v125 dst_sel:DWORD dst_unused:UNUSED_PAD src0_sel:DWORD src1_sel:WORD_0
    v_lshlrev_b32_sdwa v102, 3, v125 dst_sel:DWORD dst_unused:UNUSED_PAD src0_sel:DWORD src1_sel:WORD_1
    v_cvt_pk_bf16_f32 v21, v20, v21
    v_cvt_pk_bf16_f32 v20, v18, v19
    v_and_b32 v19, s23, v17
    v_lshlrev_b32 v18, 16, v17
    v_and_b32 v17, s23, v16
    v_lshlrev_b32 v16, 16, v16
    ds_read_b64 v[100:101], v100
    ds_read_b64 v[102:103], v102
    s_waitcnt lgkmcnt(9)
    v_smfmac_f32_16x16x64_bf16 v[16:19], v[66:69], v[104:111], v70
    s_setprio 2
    v_mfma_f32_16x16x32_bf16 v[112:115], v[72:75], v[208:211], 0
    v_lshlrev_b32_sdwa v104, 3, v126 dst_sel:DWORD dst_unused:UNUSED_PAD src0_sel:DWORD src1_sel:WORD_0
    v_lshlrev_b32_sdwa v106, 3, v126 dst_sel:DWORD dst_unused:UNUSED_PAD src0_sel:DWORD src1_sel:WORD_1
    ds_read_b64 v[104:105], v104
    ds_read_b64 v[106:107], v106
    v_mfma_f32_16x16x32_bf16 v[112:115], v[76:79], v[212:215], v[112:115]
    v_lshlrev_b32_sdwa v108, 3, v127 dst_sel:DWORD dst_unused:UNUSED_PAD src0_sel:DWORD src1_sel:WORD_0
    v_lshlrev_b32_sdwa v110, 3, v127 dst_sel:DWORD dst_unused:UNUSED_PAD src0_sel:DWORD src1_sel:WORD_1
    ds_read_b64 v[108:109], v108
    ds_read_b64 v[110:111], v110
    buffer_load_dwordx4 v[124:127], v71, s[12:15], s20 offen offset:0 sc1
    s_waitcnt lgkmcnt(9)
    v_smfmac_f32_16x16x64_bf16 v[16:19], v[66:69], v[88:95], v70
    v_mfma_f32_16x16x32_bf16 v[112:115], v[80:83], v[216:219], v[112:115]
    s_waitcnt vmcnt(2)
    v_lshlrev_b32_sdwa v88, 3, v116 dst_sel:DWORD dst_unused:UNUSED_PAD src0_sel:DWORD src1_sel:WORD_0
    v_lshlrev_b32_sdwa v90, 3, v116 dst_sel:DWORD dst_unused:UNUSED_PAD src0_sel:DWORD src1_sel:WORD_1
    ds_read_b64 v[88:89], v88
    ds_read_b64 v[90:91], v90
    v_mfma_f32_16x16x32_bf16 v[112:115], v[84:87], v[220:223], v[112:115]
    v_lshlrev_b32_sdwa v92, 3, v117 dst_sel:DWORD dst_unused:UNUSED_PAD src0_sel:DWORD src1_sel:WORD_0
    v_lshlrev_b32_sdwa v94, 3, v117 dst_sel:DWORD dst_unused:UNUSED_PAD src0_sel:DWORD src1_sel:WORD_1
    v_cvt_pk_bf16_f32 v19, v18, v19
    v_cvt_pk_bf16_f32 v18, v16, v17
    v_and_b32 v17, s23, v15
    v_lshlrev_b32 v16, 16, v15
    v_and_b32 v15, s23, v14
    v_lshlrev_b32 v14, 16, v14
    ds_read_b64 v[92:93], v92
    ds_read_b64 v[94:95], v94
    s_waitcnt lgkmcnt(8)
    v_smfmac_f32_16x16x64_bf16 v[14:17], v[66:69], v[96:103], v70
    v_cvt_pk_bf16_f32 v112, v112, v113
    v_cvt_pk_bf16_f32 v113, v114, v115
    v_lshlrev_b32_sdwa v114, 3, v70 dst_sel:DWORD dst_unused:UNUSED_PAD src0_sel:DWORD src1_sel:WORD_1
    ds_write_b64 v114, v[112:113] offset:640
    v_lshlrev_b32_sdwa v96, 3, v118 dst_sel:DWORD dst_unused:UNUSED_PAD src0_sel:DWORD src1_sel:WORD_0
    v_lshlrev_b32_sdwa v98, 3, v118 dst_sel:DWORD dst_unused:UNUSED_PAD src0_sel:DWORD src1_sel:WORD_1
    ds_read_b64 v[96:97], v96
    ds_read_b64 v[98:99], v98
    v_lshlrev_b32_sdwa v100, 3, v119 dst_sel:DWORD dst_unused:UNUSED_PAD src0_sel:DWORD src1_sel:WORD_0
    v_lshlrev_b32_sdwa v102, 3, v119 dst_sel:DWORD dst_unused:UNUSED_PAD src0_sel:DWORD src1_sel:WORD_1
    ds_read_b64 v[100:101], v100
    ds_read_b64 v[102:103], v102
    s_add_u32 s20, s20, 0xfffffc00
    buffer_load_dwordx4 v[116:119], v71, s[12:15], s20 offen offset:0 sc1
    s_waitcnt lgkmcnt(9)
    v_smfmac_f32_16x16x64_bf16 v[14:17], v[66:69], v[104:111], v70
    v_mfma_f32_16x16x32_bf16 v[112:115], v[72:75], v[224:227], 0
    s_waitcnt vmcnt(2)
    v_lshlrev_b32_sdwa v104, 3, v120 dst_sel:DWORD dst_unused:UNUSED_PAD src0_sel:DWORD src1_sel:WORD_0
    v_lshlrev_b32_sdwa v106, 3, v120 dst_sel:DWORD dst_unused:UNUSED_PAD src0_sel:DWORD src1_sel:WORD_1
    ds_read_b64 v[104:105], v104
    ds_read_b64 v[106:107], v106
    v_mfma_f32_16x16x32_bf16 v[112:115], v[76:79], v[228:231], v[112:115]
    v_lshlrev_b32_sdwa v108, 3, v121 dst_sel:DWORD dst_unused:UNUSED_PAD src0_sel:DWORD src1_sel:WORD_0
    v_lshlrev_b32_sdwa v110, 3, v121 dst_sel:DWORD dst_unused:UNUSED_PAD src0_sel:DWORD src1_sel:WORD_1
    v_cvt_pk_bf16_f32 v17, v16, v17
    v_cvt_pk_bf16_f32 v16, v14, v15
    v_and_b32 v15, s23, v13
    v_lshlrev_b32 v14, 16, v13
    v_and_b32 v13, s23, v12
    v_lshlrev_b32 v12, 16, v12
    ds_read_b64 v[108:109], v108
    ds_read_b64 v[110:111], v110
    s_waitcnt lgkmcnt(9)
    v_smfmac_f32_16x16x64_bf16 v[12:15], v[66:69], v[88:95], v70
    v_mfma_f32_16x16x32_bf16 v[112:115], v[80:83], v[232:235], v[112:115]
    v_lshlrev_b32_sdwa v88, 3, v122 dst_sel:DWORD dst_unused:UNUSED_PAD src0_sel:DWORD src1_sel:WORD_0
    v_lshlrev_b32_sdwa v90, 3, v122 dst_sel:DWORD dst_unused:UNUSED_PAD src0_sel:DWORD src1_sel:WORD_1
    ds_read_b64 v[88:89], v88
    ds_read_b64 v[90:91], v90
    v_mfma_f32_16x16x32_bf16 v[112:115], v[84:87], v[236:239], v[112:115]
    v_lshlrev_b32_sdwa v92, 3, v123 dst_sel:DWORD dst_unused:UNUSED_PAD src0_sel:DWORD src1_sel:WORD_0
    v_lshlrev_b32_sdwa v94, 3, v123 dst_sel:DWORD dst_unused:UNUSED_PAD src0_sel:DWORD src1_sel:WORD_1
    ds_read_b64 v[92:93], v92
    ds_read_b64 v[94:95], v94
    s_add_u32 s20, s20, 0x3000
    buffer_load_dwordx4 v[120:123], v71, s[12:15], s20 offen offset:3072 sc1
    s_waitcnt lgkmcnt(8)
    v_smfmac_f32_16x16x64_bf16 v[12:15], v[66:69], v[96:103], v70
    v_cvt_pk_bf16_f32 v112, v112, v113
    v_cvt_pk_bf16_f32 v113, v114, v115
    v_lshlrev_b32_sdwa v114, 3, v70 dst_sel:DWORD dst_unused:UNUSED_PAD src0_sel:DWORD src1_sel:WORD_1
    ds_write_b64 v114, v[112:113] offset:768
    s_waitcnt vmcnt(2)
    v_lshlrev_b32_sdwa v96, 3, v124 dst_sel:DWORD dst_unused:UNUSED_PAD src0_sel:DWORD src1_sel:WORD_0
    v_lshlrev_b32_sdwa v98, 3, v124 dst_sel:DWORD dst_unused:UNUSED_PAD src0_sel:DWORD src1_sel:WORD_1
    ds_read_b64 v[96:97], v96
    ds_read_b64 v[98:99], v98
    v_lshlrev_b32_sdwa v100, 3, v125 dst_sel:DWORD dst_unused:UNUSED_PAD src0_sel:DWORD src1_sel:WORD_0
    v_lshlrev_b32_sdwa v102, 3, v125 dst_sel:DWORD dst_unused:UNUSED_PAD src0_sel:DWORD src1_sel:WORD_1
    v_cvt_pk_bf16_f32 v15, v14, v15
    v_cvt_pk_bf16_f32 v14, v12, v13
    v_and_b32 v13, s23, v11
    v_lshlrev_b32 v12, 16, v11
    v_and_b32 v11, s23, v10
    v_lshlrev_b32 v10, 16, v10
    ds_read_b64 v[100:101], v100
    ds_read_b64 v[102:103], v102
    s_waitcnt lgkmcnt(9)
    v_smfmac_f32_16x16x64_bf16 v[10:13], v[66:69], v[104:111], v70
    v_mfma_f32_16x16x32_bf16 v[112:115], v[72:75], v[240:243], 0
    buffer_load_dwordx4 v[72:75], v71, s[12:15], s21 offen offset:0
    v_lshlrev_b32_sdwa v104, 3, v126 dst_sel:DWORD dst_unused:UNUSED_PAD src0_sel:DWORD src1_sel:WORD_0
    v_lshlrev_b32_sdwa v106, 3, v126 dst_sel:DWORD dst_unused:UNUSED_PAD src0_sel:DWORD src1_sel:WORD_1
    ds_read_b64 v[104:105], v104
    ds_read_b64 v[106:107], v106
    v_mfma_f32_16x16x32_bf16 v[112:115], v[76:79], v[244:247], v[112:115]
    buffer_load_dwordx4 v[76:79], v71, s[12:15], s21 offen offset:1024
    v_lshlrev_b32_sdwa v108, 3, v127 dst_sel:DWORD dst_unused:UNUSED_PAD src0_sel:DWORD src1_sel:WORD_0
    v_lshlrev_b32_sdwa v110, 3, v127 dst_sel:DWORD dst_unused:UNUSED_PAD src0_sel:DWORD src1_sel:WORD_1
    ds_read_b64 v[108:109], v108
    ds_read_b64 v[110:111], v110
    buffer_load_dwordx4 v[124:127], v71, s[12:15], s20 offen offset:2048 sc1
    s_waitcnt lgkmcnt(9)
    v_smfmac_f32_16x16x64_bf16 v[10:13], v[66:69], v[88:95], v70
    v_mfma_f32_16x16x32_bf16 v[112:115], v[80:83], v[248:251], v[112:115]
    buffer_load_dwordx4 v[80:83], v71, s[12:15], s19 offen offset:0
    s_waitcnt vmcnt(5)
    v_lshlrev_b32_sdwa v88, 3, v116 dst_sel:DWORD dst_unused:UNUSED_PAD src0_sel:DWORD src1_sel:WORD_0
    v_lshlrev_b32_sdwa v90, 3, v116 dst_sel:DWORD dst_unused:UNUSED_PAD src0_sel:DWORD src1_sel:WORD_1
    ds_read_b64 v[88:89], v88
    ds_read_b64 v[90:91], v90
    v_mfma_f32_16x16x32_bf16 v[112:115], v[84:87], v[252:255], v[112:115]
    buffer_load_dwordx4 v[84:87], v71, s[12:15], s19 offen offset:1024
    s_add_u32 s21, s21, s22
    s_add_u32 s19, s19, s22
    v_lshlrev_b32_sdwa v92, 3, v117 dst_sel:DWORD dst_unused:UNUSED_PAD src0_sel:DWORD src1_sel:WORD_0
    v_lshlrev_b32_sdwa v94, 3, v117 dst_sel:DWORD dst_unused:UNUSED_PAD src0_sel:DWORD src1_sel:WORD_1
    v_cvt_pk_bf16_f32 v13, v12, v13
    v_cvt_pk_bf16_f32 v12, v10, v11
    v_and_b32 v11, s23, v9
    v_lshlrev_b32 v10, 16, v9
    v_and_b32 v9, s23, v8
    v_lshlrev_b32 v8, 16, v8
    ds_read_b64 v[92:93], v92
    ds_read_b64 v[94:95], v94
    s_waitcnt lgkmcnt(8)
    v_smfmac_f32_16x16x64_bf16 v[8:11], v[66:69], v[96:103], v70
    v_cvt_pk_bf16_f32 v112, v112, v113
    v_cvt_pk_bf16_f32 v113, v114, v115
    v_lshlrev_b32_sdwa v114, 3, v70 dst_sel:DWORD dst_unused:UNUSED_PAD src0_sel:DWORD src1_sel:WORD_1
    ds_write_b64 v114, v[112:113] offset:896
    s_setprio 1
    v_lshlrev_b32_sdwa v96, 3, v118 dst_sel:DWORD dst_unused:UNUSED_PAD src0_sel:DWORD src1_sel:WORD_0
    v_lshlrev_b32_sdwa v98, 3, v118 dst_sel:DWORD dst_unused:UNUSED_PAD src0_sel:DWORD src1_sel:WORD_1
    ds_read_b64 v[96:97], v96
    ds_read_b64 v[98:99], v98
    v_lshlrev_b32_sdwa v100, 3, v119 dst_sel:DWORD dst_unused:UNUSED_PAD src0_sel:DWORD src1_sel:WORD_0
    v_lshlrev_b32_sdwa v102, 3, v119 dst_sel:DWORD dst_unused:UNUSED_PAD src0_sel:DWORD src1_sel:WORD_1
    ds_read_b64 v[100:101], v100
    ds_read_b64 v[102:103], v102
    buffer_load_dwordx4 v[116:119], v71, s[12:15], s20 offen offset:1024 sc1
    s_waitcnt lgkmcnt(9)
    v_smfmac_f32_16x16x64_bf16 v[8:11], v[66:69], v[104:111], v70
    s_waitcnt vmcnt(6)
    v_lshlrev_b32_sdwa v104, 3, v120 dst_sel:DWORD dst_unused:UNUSED_PAD src0_sel:DWORD src1_sel:WORD_0
    v_lshlrev_b32_sdwa v106, 3, v120 dst_sel:DWORD dst_unused:UNUSED_PAD src0_sel:DWORD src1_sel:WORD_1
    ds_read_b64 v[104:105], v104
    ds_read_b64 v[106:107], v106
    v_lshlrev_b32_sdwa v108, 3, v121 dst_sel:DWORD dst_unused:UNUSED_PAD src0_sel:DWORD src1_sel:WORD_0
    v_lshlrev_b32_sdwa v110, 3, v121 dst_sel:DWORD dst_unused:UNUSED_PAD src0_sel:DWORD src1_sel:WORD_1
    s_nop 0
    v_cvt_pk_bf16_f32 v11, v10, v11
    v_cvt_pk_bf16_f32 v10, v8, v9
    v_and_b32 v9, s23, v7
    v_lshlrev_b32 v8, 16, v7
    v_and_b32 v7, s23, v6
    v_lshlrev_b32 v6, 16, v6
    ds_read_b64 v[108:109], v108
    ds_read_b64 v[110:111], v110
    s_waitcnt lgkmcnt(9)
    v_smfmac_f32_16x16x64_bf16 v[6:9], v[66:69], v[88:95], v70
    v_lshlrev_b32_sdwa v88, 3, v122 dst_sel:DWORD dst_unused:UNUSED_PAD src0_sel:DWORD src1_sel:WORD_0
    v_lshlrev_b32_sdwa v90, 3, v122 dst_sel:DWORD dst_unused:UNUSED_PAD src0_sel:DWORD src1_sel:WORD_1
    ds_read_b64 v[88:89], v88
    ds_read_b64 v[90:91], v90
    v_lshlrev_b32_sdwa v92, 3, v123 dst_sel:DWORD dst_unused:UNUSED_PAD src0_sel:DWORD src1_sel:WORD_0
    v_lshlrev_b32_sdwa v94, 3, v123 dst_sel:DWORD dst_unused:UNUSED_PAD src0_sel:DWORD src1_sel:WORD_1
    ds_read_b64 v[92:93], v92
    ds_read_b64 v[94:95], v94
    s_add_u32 s20, s20, 0x1f400
    buffer_load_dwordx4 v[120:123], v71, s[12:15], s20 offen offset:3072 sc1
    s_waitcnt lgkmcnt(8)
    v_smfmac_f32_16x16x64_bf16 v[6:9], v[66:69], v[96:103], v70
    s_waitcnt vmcnt(4)
    v_lshlrev_b32_sdwa v96, 3, v124 dst_sel:DWORD dst_unused:UNUSED_PAD src0_sel:DWORD src1_sel:WORD_0
    v_lshlrev_b32_sdwa v98, 3, v124 dst_sel:DWORD dst_unused:UNUSED_PAD src0_sel:DWORD src1_sel:WORD_1
    ds_read_b64 v[96:97], v96
    ds_read_b64 v[98:99], v98
    v_lshlrev_b32_sdwa v100, 3, v125 dst_sel:DWORD dst_unused:UNUSED_PAD src0_sel:DWORD src1_sel:WORD_0
    v_lshlrev_b32_sdwa v102, 3, v125 dst_sel:DWORD dst_unused:UNUSED_PAD src0_sel:DWORD src1_sel:WORD_1
    s_nop 0
    v_cvt_pk_bf16_f32 v9, v8, v9
    v_cvt_pk_bf16_f32 v8, v6, v7
    v_and_b32 v7, s23, v5
    v_lshlrev_b32 v6, 16, v5
    v_and_b32 v5, s23, v4
    v_lshlrev_b32 v4, 16, v4
    ds_read_b64 v[100:101], v100
    ds_read_b64 v[102:103], v102
    s_waitcnt lgkmcnt(8)
    v_smfmac_f32_16x16x64_bf16 v[4:7], v[66:69], v[104:111], v70
    v_lshlrev_b32_sdwa v104, 3, v126 dst_sel:DWORD dst_unused:UNUSED_PAD src0_sel:DWORD src1_sel:WORD_0
    v_lshlrev_b32_sdwa v106, 3, v126 dst_sel:DWORD dst_unused:UNUSED_PAD src0_sel:DWORD src1_sel:WORD_1
    ds_read_b64 v[104:105], v104
    ds_read_b64 v[106:107], v106
    v_lshlrev_b32_sdwa v108, 3, v127 dst_sel:DWORD dst_unused:UNUSED_PAD src0_sel:DWORD src1_sel:WORD_0
    v_lshlrev_b32_sdwa v110, 3, v127 dst_sel:DWORD dst_unused:UNUSED_PAD src0_sel:DWORD src1_sel:WORD_1
    ds_read_b64 v[108:109], v108
    ds_read_b64 v[110:111], v110
    buffer_load_dwordx4 v[124:127], v71, s[12:15], s20 offen offset:2048 sc1
    s_waitcnt lgkmcnt(8)
    v_smfmac_f32_16x16x64_bf16 v[4:7], v[66:69], v[88:95], v70
    s_waitcnt vmcnt(2)
    v_lshlrev_b32_sdwa v88, 3, v116 dst_sel:DWORD dst_unused:UNUSED_PAD src0_sel:DWORD src1_sel:WORD_0
    v_lshlrev_b32_sdwa v90, 3, v116 dst_sel:DWORD dst_unused:UNUSED_PAD src0_sel:DWORD src1_sel:WORD_1
    ds_read_b64 v[88:89], v88
    ds_read_b64 v[90:91], v90
    v_lshlrev_b32_sdwa v92, 3, v117 dst_sel:DWORD dst_unused:UNUSED_PAD src0_sel:DWORD src1_sel:WORD_0
    v_lshlrev_b32_sdwa v94, 3, v117 dst_sel:DWORD dst_unused:UNUSED_PAD src0_sel:DWORD src1_sel:WORD_1
    s_nop 0
    v_cvt_pk_bf16_f32 v7, v6, v7
    v_cvt_pk_bf16_f32 v6, v4, v5
    v_and_b32 v5, s23, v3
    v_lshlrev_b32 v4, 16, v3
    v_and_b32 v3, s23, v2
    v_lshlrev_b32 v2, 16, v2
    ds_read_b64 v[92:93], v92
    ds_read_b64 v[94:95], v94
    s_waitcnt lgkmcnt(8)
    v_smfmac_f32_16x16x64_bf16 v[2:5], v[66:69], v[96:103], v70
    s_setprio 0
    v_lshlrev_b32_sdwa v96, 3, v118 dst_sel:DWORD dst_unused:UNUSED_PAD src0_sel:DWORD src1_sel:WORD_0
    v_lshlrev_b32_sdwa v98, 3, v118 dst_sel:DWORD dst_unused:UNUSED_PAD src0_sel:DWORD src1_sel:WORD_1
    ds_read_b64 v[96:97], v96
    ds_read_b64 v[98:99], v98
    v_lshlrev_b32_sdwa v100, 3, v119 dst_sel:DWORD dst_unused:UNUSED_PAD src0_sel:DWORD src1_sel:WORD_0
    v_lshlrev_b32_sdwa v102, 3, v119 dst_sel:DWORD dst_unused:UNUSED_PAD src0_sel:DWORD src1_sel:WORD_1
    ds_read_b64 v[100:101], v100
    ds_read_b64 v[102:103], v102
    buffer_load_dwordx4 v[116:119], v71, s[12:15], s20 offen offset:1024 sc1
    s_waitcnt lgkmcnt(8)
    v_smfmac_f32_16x16x64_bf16 v[2:5], v[66:69], v[104:111], v70
    s_waitcnt vmcnt(2)
    v_lshlrev_b32_sdwa v104, 3, v120 dst_sel:DWORD dst_unused:UNUSED_PAD src0_sel:DWORD src1_sel:WORD_0
    v_lshlrev_b32_sdwa v106, 3, v120 dst_sel:DWORD dst_unused:UNUSED_PAD src0_sel:DWORD src1_sel:WORD_1
    ds_read_b64 v[104:105], v104
    ds_read_b64 v[106:107], v106
    v_lshlrev_b32_sdwa v108, 3, v121 dst_sel:DWORD dst_unused:UNUSED_PAD src0_sel:DWORD src1_sel:WORD_0
    v_lshlrev_b32_sdwa v110, 3, v121 dst_sel:DWORD dst_unused:UNUSED_PAD src0_sel:DWORD src1_sel:WORD_1
    s_nop 0
    v_cvt_pk_bf16_f32 v5, v4, v5
    v_cvt_pk_bf16_f32 v4, v2, v3
    v_and_b32 v3, s23, v1
    v_lshlrev_b32 v2, 16, v1
    v_and_b32 v1, s23, v0
    v_lshlrev_b32 v0, 16, v0
    ds_read_b64 v[108:109], v108
    ds_read_b64 v[110:111], v110
    s_waitcnt lgkmcnt(8)
    v_smfmac_f32_16x16x64_bf16 v[0:3], v[66:69], v[88:95], v70
    s_barrier
    s_setprio 3
    v_lshlrev_b32_sdwa v88, 3, v122 dst_sel:DWORD dst_unused:UNUSED_PAD src0_sel:DWORD src1_sel:WORD_0
    v_lshlrev_b32_sdwa v90, 3, v122 dst_sel:DWORD dst_unused:UNUSED_PAD src0_sel:DWORD src1_sel:WORD_1
    ds_read_b64 v[88:89], v88
    ds_read_b64 v[90:91], v90
    v_lshlrev_b32_sdwa v92, 3, v123 dst_sel:DWORD dst_unused:UNUSED_PAD src0_sel:DWORD src1_sel:WORD_0
    v_lshlrev_b32_sdwa v94, 3, v123 dst_sel:DWORD dst_unused:UNUSED_PAD src0_sel:DWORD src1_sel:WORD_1
    ds_read_b64 v[92:93], v92
    ds_read_b64 v[94:95], v94
    buffer_load_dwordx4 v[120:123], v71, s[12:15], s20 offen offset:0 sc1
    s_waitcnt lgkmcnt(8)
    v_smfmac_f32_16x16x64_bf16 v[0:3], v[66:69], v[96:103], v70
    v_mfma_f32_16x16x32_bf16 v[112:115], v[72:75], v[128:131], 0
    s_waitcnt vmcnt(2)
    v_lshlrev_b32_sdwa v96, 3, v124 dst_sel:DWORD dst_unused:UNUSED_PAD src0_sel:DWORD src1_sel:WORD_0
    v_lshlrev_b32_sdwa v98, 3, v124 dst_sel:DWORD dst_unused:UNUSED_PAD src0_sel:DWORD src1_sel:WORD_1
    ds_read_b64 v[96:97], v96
    ds_read_b64 v[98:99], v98
    v_mfma_f32_16x16x32_bf16 v[112:115], v[76:79], v[132:135], v[112:115]
    v_lshlrev_b32_sdwa v100, 3, v125 dst_sel:DWORD dst_unused:UNUSED_PAD src0_sel:DWORD src1_sel:WORD_0
    v_lshlrev_b32_sdwa v102, 3, v125 dst_sel:DWORD dst_unused:UNUSED_PAD src0_sel:DWORD src1_sel:WORD_1
    v_cvt_pk_bf16_f32 v3, v2, v3
    v_cvt_pk_bf16_f32 v2, v0, v1
    v_mov_b64 v[0:1], v[32:33]
    v_lshlrev_b32 v32, 16, v34
    v_and_b32 v33, s23, v34
    v_lshlrev_b32 v34, 16, v35
    v_and_b32 v35, s23, v35
    ds_read_b64 v[100:101], v100
    ds_read_b64 v[102:103], v102
    s_waitcnt lgkmcnt(8)
    v_smfmac_f32_16x16x64_bf16 v[32:35], v[66:69], v[104:111], v70
    v_mfma_f32_16x16x32_bf16 v[112:115], v[80:83], v[136:139], v[112:115]
    v_lshlrev_b32_sdwa v104, 3, v126 dst_sel:DWORD dst_unused:UNUSED_PAD src0_sel:DWORD src1_sel:WORD_0
    v_lshlrev_b32_sdwa v106, 3, v126 dst_sel:DWORD dst_unused:UNUSED_PAD src0_sel:DWORD src1_sel:WORD_1
    ds_read_b64 v[104:105], v104
    ds_read_b64 v[106:107], v106
    v_mfma_f32_16x16x32_bf16 v[112:115], v[84:87], v[140:143], v[112:115]
    v_lshlrev_b32_sdwa v108, 3, v127 dst_sel:DWORD dst_unused:UNUSED_PAD src0_sel:DWORD src1_sel:WORD_0
    v_lshlrev_b32_sdwa v110, 3, v127 dst_sel:DWORD dst_unused:UNUSED_PAD src0_sel:DWORD src1_sel:WORD_1
    ds_read_b64 v[108:109], v108
    ds_read_b64 v[110:111], v110
    s_add_u32 s20, s20, 0xfffff000
    buffer_load_dwordx4 v[124:127], v71, s[12:15], s20 offen offset:3072 sc1
    s_waitcnt lgkmcnt(8)
    v_smfmac_f32_16x16x64_bf16 v[32:35], v[66:69], v[88:95], v70
    v_cvt_pk_bf16_f32 v112, v112, v113
    v_cvt_pk_bf16_f32 v113, v114, v115
    v_lshlrev_b32_sdwa v114, 3, v70 dst_sel:DWORD dst_unused:UNUSED_PAD src0_sel:DWORD src1_sel:WORD_1
    ds_write_b64 v114, v[112:113] offset:32768
    s_waitcnt vmcnt(2)
    v_lshlrev_b32_sdwa v88, 3, v116 dst_sel:DWORD dst_unused:UNUSED_PAD src0_sel:DWORD src1_sel:WORD_0
    v_lshlrev_b32_sdwa v90, 3, v116 dst_sel:DWORD dst_unused:UNUSED_PAD src0_sel:DWORD src1_sel:WORD_1
    ds_read_b64 v[88:89], v88
    ds_read_b64 v[90:91], v90
    v_lshlrev_b32_sdwa v92, 3, v117 dst_sel:DWORD dst_unused:UNUSED_PAD src0_sel:DWORD src1_sel:WORD_0
    v_lshlrev_b32_sdwa v94, 3, v117 dst_sel:DWORD dst_unused:UNUSED_PAD src0_sel:DWORD src1_sel:WORD_1
    v_cvt_pk_bf16_f32 v32, v32, v33
    v_cvt_pk_bf16_f32 v33, v34, v35
    v_lshlrev_b32 v34, 16, v36
    v_and_b32 v35, s23, v36
    v_lshlrev_b32 v36, 16, v37
    v_and_b32 v37, s23, v37
    ds_read_b64 v[92:93], v92
    ds_read_b64 v[94:95], v94
    s_waitcnt lgkmcnt(9)
    v_smfmac_f32_16x16x64_bf16 v[34:37], v[66:69], v[96:103], v70
    v_mfma_f32_16x16x32_bf16 v[112:115], v[72:75], v[144:147], 0
    v_lshlrev_b32_sdwa v96, 3, v118 dst_sel:DWORD dst_unused:UNUSED_PAD src0_sel:DWORD src1_sel:WORD_0
    v_lshlrev_b32_sdwa v98, 3, v118 dst_sel:DWORD dst_unused:UNUSED_PAD src0_sel:DWORD src1_sel:WORD_1
    ds_read_b64 v[96:97], v96
    ds_read_b64 v[98:99], v98
    v_mfma_f32_16x16x32_bf16 v[112:115], v[76:79], v[148:151], v[112:115]
    v_lshlrev_b32_sdwa v100, 3, v119 dst_sel:DWORD dst_unused:UNUSED_PAD src0_sel:DWORD src1_sel:WORD_0
    v_lshlrev_b32_sdwa v102, 3, v119 dst_sel:DWORD dst_unused:UNUSED_PAD src0_sel:DWORD src1_sel:WORD_1
    ds_read_b64 v[100:101], v100
    ds_read_b64 v[102:103], v102
    buffer_load_dwordx4 v[116:119], v71, s[12:15], s20 offen offset:2048 sc1
    s_waitcnt lgkmcnt(9)
    v_smfmac_f32_16x16x64_bf16 v[34:37], v[66:69], v[104:111], v70
    v_mfma_f32_16x16x32_bf16 v[112:115], v[80:83], v[152:155], v[112:115]
    s_waitcnt vmcnt(2)
    v_lshlrev_b32_sdwa v104, 3, v120 dst_sel:DWORD dst_unused:UNUSED_PAD src0_sel:DWORD src1_sel:WORD_0
    v_lshlrev_b32_sdwa v106, 3, v120 dst_sel:DWORD dst_unused:UNUSED_PAD src0_sel:DWORD src1_sel:WORD_1
    ds_read_b64 v[104:105], v104
    ds_read_b64 v[106:107], v106
    v_mfma_f32_16x16x32_bf16 v[112:115], v[84:87], v[156:159], v[112:115]
    v_lshlrev_b32_sdwa v108, 3, v121 dst_sel:DWORD dst_unused:UNUSED_PAD src0_sel:DWORD src1_sel:WORD_0
    v_lshlrev_b32_sdwa v110, 3, v121 dst_sel:DWORD dst_unused:UNUSED_PAD src0_sel:DWORD src1_sel:WORD_1
    v_cvt_pk_bf16_f32 v34, v34, v35
    v_cvt_pk_bf16_f32 v35, v36, v37
    v_lshlrev_b32 v36, 16, v38
    v_and_b32 v37, s23, v38
    v_lshlrev_b32 v38, 16, v39
    v_and_b32 v39, s23, v39
    ds_read_b64 v[108:109], v108
    ds_read_b64 v[110:111], v110
    s_waitcnt lgkmcnt(8)
    v_smfmac_f32_16x16x64_bf16 v[36:39], v[66:69], v[88:95], v70
    v_cvt_pk_bf16_f32 v112, v112, v113
    v_cvt_pk_bf16_f32 v113, v114, v115
    v_lshlrev_b32_sdwa v114, 3, v70 dst_sel:DWORD dst_unused:UNUSED_PAD src0_sel:DWORD src1_sel:WORD_1
    ds_write_b64 v114, v[112:113] offset:32896
    v_lshlrev_b32_sdwa v88, 3, v122 dst_sel:DWORD dst_unused:UNUSED_PAD src0_sel:DWORD src1_sel:WORD_0
    v_lshlrev_b32_sdwa v90, 3, v122 dst_sel:DWORD dst_unused:UNUSED_PAD src0_sel:DWORD src1_sel:WORD_1
    ds_read_b64 v[88:89], v88
    ds_read_b64 v[90:91], v90
    v_lshlrev_b32_sdwa v92, 3, v123 dst_sel:DWORD dst_unused:UNUSED_PAD src0_sel:DWORD src1_sel:WORD_0
    v_lshlrev_b32_sdwa v94, 3, v123 dst_sel:DWORD dst_unused:UNUSED_PAD src0_sel:DWORD src1_sel:WORD_1
    ds_read_b64 v[92:93], v92
    ds_read_b64 v[94:95], v94
    buffer_load_dwordx4 v[120:123], v71, s[12:15], s20 offen offset:1024 sc1
    s_waitcnt lgkmcnt(9)
    v_smfmac_f32_16x16x64_bf16 v[36:39], v[66:69], v[96:103], v70
    v_mfma_f32_16x16x32_bf16 v[112:115], v[72:75], v[160:163], 0
    s_waitcnt vmcnt(2)
    v_lshlrev_b32_sdwa v96, 3, v124 dst_sel:DWORD dst_unused:UNUSED_PAD src0_sel:DWORD src1_sel:WORD_0
    v_lshlrev_b32_sdwa v98, 3, v124 dst_sel:DWORD dst_unused:UNUSED_PAD src0_sel:DWORD src1_sel:WORD_1
    ds_read_b64 v[96:97], v96
    ds_read_b64 v[98:99], v98
    v_mfma_f32_16x16x32_bf16 v[112:115], v[76:79], v[164:167], v[112:115]
    v_lshlrev_b32_sdwa v100, 3, v125 dst_sel:DWORD dst_unused:UNUSED_PAD src0_sel:DWORD src1_sel:WORD_0
    v_lshlrev_b32_sdwa v102, 3, v125 dst_sel:DWORD dst_unused:UNUSED_PAD src0_sel:DWORD src1_sel:WORD_1
    v_cvt_pk_bf16_f32 v36, v36, v37
    v_cvt_pk_bf16_f32 v37, v38, v39
    v_lshlrev_b32 v38, 16, v40
    v_and_b32 v39, s23, v40
    v_lshlrev_b32 v40, 16, v41
    v_and_b32 v41, s23, v41
    ds_read_b64 v[100:101], v100
    ds_read_b64 v[102:103], v102
    s_waitcnt lgkmcnt(9)
    v_smfmac_f32_16x16x64_bf16 v[38:41], v[66:69], v[104:111], v70
    v_mfma_f32_16x16x32_bf16 v[112:115], v[80:83], v[168:171], v[112:115]
    v_lshlrev_b32_sdwa v104, 3, v126 dst_sel:DWORD dst_unused:UNUSED_PAD src0_sel:DWORD src1_sel:WORD_0
    v_lshlrev_b32_sdwa v106, 3, v126 dst_sel:DWORD dst_unused:UNUSED_PAD src0_sel:DWORD src1_sel:WORD_1
    ds_read_b64 v[104:105], v104
    ds_read_b64 v[106:107], v106
    v_mfma_f32_16x16x32_bf16 v[112:115], v[84:87], v[172:175], v[112:115]
    v_lshlrev_b32_sdwa v108, 3, v127 dst_sel:DWORD dst_unused:UNUSED_PAD src0_sel:DWORD src1_sel:WORD_0
    v_lshlrev_b32_sdwa v110, 3, v127 dst_sel:DWORD dst_unused:UNUSED_PAD src0_sel:DWORD src1_sel:WORD_1
    ds_read_b64 v[108:109], v108
    ds_read_b64 v[110:111], v110
    buffer_load_dwordx4 v[124:127], v71, s[12:15], s20 offen offset:0 sc1
    s_waitcnt lgkmcnt(8)
    v_smfmac_f32_16x16x64_bf16 v[38:41], v[66:69], v[88:95], v70
    s_nop 0
    v_cvt_pk_bf16_f32 v112, v112, v113
    v_cvt_pk_bf16_f32 v113, v114, v115
    v_lshlrev_b32_sdwa v114, 3, v70 dst_sel:DWORD dst_unused:UNUSED_PAD src0_sel:DWORD src1_sel:WORD_1
    ds_write_b64 v114, v[112:113] offset:33024
    s_waitcnt vmcnt(2)
    v_lshlrev_b32_sdwa v88, 3, v116 dst_sel:DWORD dst_unused:UNUSED_PAD src0_sel:DWORD src1_sel:WORD_0
    v_lshlrev_b32_sdwa v90, 3, v116 dst_sel:DWORD dst_unused:UNUSED_PAD src0_sel:DWORD src1_sel:WORD_1
    ds_read_b64 v[88:89], v88
    ds_read_b64 v[90:91], v90
    v_lshlrev_b32_sdwa v92, 3, v117 dst_sel:DWORD dst_unused:UNUSED_PAD src0_sel:DWORD src1_sel:WORD_0
    v_lshlrev_b32_sdwa v94, 3, v117 dst_sel:DWORD dst_unused:UNUSED_PAD src0_sel:DWORD src1_sel:WORD_1
    v_cvt_pk_bf16_f32 v38, v38, v39
    v_cvt_pk_bf16_f32 v39, v40, v41
    v_lshlrev_b32 v40, 16, v42
    v_and_b32 v41, s23, v42
    v_lshlrev_b32 v42, 16, v43
    v_and_b32 v43, s23, v43
    ds_read_b64 v[92:93], v92
    ds_read_b64 v[94:95], v94
    s_waitcnt lgkmcnt(9)
    v_smfmac_f32_16x16x64_bf16 v[40:43], v[66:69], v[96:103], v70
    v_mfma_f32_16x16x32_bf16 v[112:115], v[72:75], v[176:179], 0
    v_lshlrev_b32_sdwa v96, 3, v118 dst_sel:DWORD dst_unused:UNUSED_PAD src0_sel:DWORD src1_sel:WORD_0
    v_lshlrev_b32_sdwa v98, 3, v118 dst_sel:DWORD dst_unused:UNUSED_PAD src0_sel:DWORD src1_sel:WORD_1
    ds_read_b64 v[96:97], v96
    ds_read_b64 v[98:99], v98
    v_mfma_f32_16x16x32_bf16 v[112:115], v[76:79], v[180:183], v[112:115]
    v_lshlrev_b32_sdwa v100, 3, v119 dst_sel:DWORD dst_unused:UNUSED_PAD src0_sel:DWORD src1_sel:WORD_0
    v_lshlrev_b32_sdwa v102, 3, v119 dst_sel:DWORD dst_unused:UNUSED_PAD src0_sel:DWORD src1_sel:WORD_1
    ds_read_b64 v[100:101], v100
    ds_read_b64 v[102:103], v102
    s_add_u32 s20, s20, 0xfffff000
    buffer_load_dwordx4 v[116:119], v71, s[12:15], s20 offen offset:3072 sc1
    s_waitcnt lgkmcnt(9)
    v_smfmac_f32_16x16x64_bf16 v[40:43], v[66:69], v[104:111], v70
    v_mfma_f32_16x16x32_bf16 v[112:115], v[80:83], v[184:187], v[112:115]
    s_waitcnt vmcnt(2)
    v_lshlrev_b32_sdwa v104, 3, v120 dst_sel:DWORD dst_unused:UNUSED_PAD src0_sel:DWORD src1_sel:WORD_0
    v_lshlrev_b32_sdwa v106, 3, v120 dst_sel:DWORD dst_unused:UNUSED_PAD src0_sel:DWORD src1_sel:WORD_1
    ds_read_b64 v[104:105], v104
    ds_read_b64 v[106:107], v106
    v_mfma_f32_16x16x32_bf16 v[112:115], v[84:87], v[188:191], v[112:115]
    v_lshlrev_b32_sdwa v108, 3, v121 dst_sel:DWORD dst_unused:UNUSED_PAD src0_sel:DWORD src1_sel:WORD_0
    v_lshlrev_b32_sdwa v110, 3, v121 dst_sel:DWORD dst_unused:UNUSED_PAD src0_sel:DWORD src1_sel:WORD_1
    v_cvt_pk_bf16_f32 v40, v40, v41
    v_cvt_pk_bf16_f32 v41, v42, v43
    v_lshlrev_b32 v42, 16, v44
    v_and_b32 v43, s23, v44
    v_lshlrev_b32 v44, 16, v45
    v_and_b32 v45, s23, v45
    ds_read_b64 v[108:109], v108
    ds_read_b64 v[110:111], v110
    s_waitcnt lgkmcnt(8)
    v_smfmac_f32_16x16x64_bf16 v[42:45], v[66:69], v[88:95], v70
    v_cvt_pk_bf16_f32 v112, v112, v113
    v_cvt_pk_bf16_f32 v113, v114, v115
    v_lshlrev_b32_sdwa v114, 3, v70 dst_sel:DWORD dst_unused:UNUSED_PAD src0_sel:DWORD src1_sel:WORD_1
    ds_write_b64 v114, v[112:113] offset:33152
    v_lshlrev_b32_sdwa v88, 3, v122 dst_sel:DWORD dst_unused:UNUSED_PAD src0_sel:DWORD src1_sel:WORD_0
    v_lshlrev_b32_sdwa v90, 3, v122 dst_sel:DWORD dst_unused:UNUSED_PAD src0_sel:DWORD src1_sel:WORD_1
    ds_read_b64 v[88:89], v88
    ds_read_b64 v[90:91], v90
    v_lshlrev_b32_sdwa v92, 3, v123 dst_sel:DWORD dst_unused:UNUSED_PAD src0_sel:DWORD src1_sel:WORD_0
    v_lshlrev_b32_sdwa v94, 3, v123 dst_sel:DWORD dst_unused:UNUSED_PAD src0_sel:DWORD src1_sel:WORD_1
    ds_read_b64 v[92:93], v92
    ds_read_b64 v[94:95], v94
    buffer_load_dwordx4 v[120:123], v71, s[12:15], s20 offen offset:2048 sc1
    s_waitcnt lgkmcnt(9)
    v_smfmac_f32_16x16x64_bf16 v[42:45], v[66:69], v[96:103], v70
    v_mfma_f32_16x16x32_bf16 v[112:115], v[72:75], v[192:195], 0
    s_waitcnt vmcnt(2)
    v_lshlrev_b32_sdwa v96, 3, v124 dst_sel:DWORD dst_unused:UNUSED_PAD src0_sel:DWORD src1_sel:WORD_0
    v_lshlrev_b32_sdwa v98, 3, v124 dst_sel:DWORD dst_unused:UNUSED_PAD src0_sel:DWORD src1_sel:WORD_1
    ds_read_b64 v[96:97], v96
    ds_read_b64 v[98:99], v98
    v_mfma_f32_16x16x32_bf16 v[112:115], v[76:79], v[196:199], v[112:115]
    v_lshlrev_b32_sdwa v100, 3, v125 dst_sel:DWORD dst_unused:UNUSED_PAD src0_sel:DWORD src1_sel:WORD_0
    v_lshlrev_b32_sdwa v102, 3, v125 dst_sel:DWORD dst_unused:UNUSED_PAD src0_sel:DWORD src1_sel:WORD_1
    v_cvt_pk_bf16_f32 v42, v42, v43
    v_cvt_pk_bf16_f32 v43, v44, v45
    v_lshlrev_b32 v44, 16, v46
    v_and_b32 v45, s23, v46
    v_lshlrev_b32 v46, 16, v47
    v_and_b32 v47, s23, v47
    ds_read_b64 v[100:101], v100
    ds_read_b64 v[102:103], v102
    s_waitcnt lgkmcnt(9)
    v_smfmac_f32_16x16x64_bf16 v[44:47], v[66:69], v[104:111], v70
    v_mfma_f32_16x16x32_bf16 v[112:115], v[80:83], v[200:203], v[112:115]
    v_lshlrev_b32_sdwa v104, 3, v126 dst_sel:DWORD dst_unused:UNUSED_PAD src0_sel:DWORD src1_sel:WORD_0
    v_lshlrev_b32_sdwa v106, 3, v126 dst_sel:DWORD dst_unused:UNUSED_PAD src0_sel:DWORD src1_sel:WORD_1
    ds_read_b64 v[104:105], v104
    ds_read_b64 v[106:107], v106
    v_mfma_f32_16x16x32_bf16 v[112:115], v[84:87], v[204:207], v[112:115]
    v_lshlrev_b32_sdwa v108, 3, v127 dst_sel:DWORD dst_unused:UNUSED_PAD src0_sel:DWORD src1_sel:WORD_0
    v_lshlrev_b32_sdwa v110, 3, v127 dst_sel:DWORD dst_unused:UNUSED_PAD src0_sel:DWORD src1_sel:WORD_1
    ds_read_b64 v[108:109], v108
    ds_read_b64 v[110:111], v110
    buffer_load_dwordx4 v[124:127], v71, s[12:15], s20 offen offset:1024 sc1
    s_waitcnt lgkmcnt(8)
    v_smfmac_f32_16x16x64_bf16 v[44:47], v[66:69], v[88:95], v70
    s_nop 0
    v_cvt_pk_bf16_f32 v112, v112, v113
    v_cvt_pk_bf16_f32 v113, v114, v115
    v_lshlrev_b32_sdwa v114, 3, v70 dst_sel:DWORD dst_unused:UNUSED_PAD src0_sel:DWORD src1_sel:WORD_1
    ds_write_b64 v114, v[112:113] offset:33280
    s_setprio 2
    s_waitcnt vmcnt(2)
    v_lshlrev_b32_sdwa v88, 3, v116 dst_sel:DWORD dst_unused:UNUSED_PAD src0_sel:DWORD src1_sel:WORD_0
    v_lshlrev_b32_sdwa v90, 3, v116 dst_sel:DWORD dst_unused:UNUSED_PAD src0_sel:DWORD src1_sel:WORD_1
    ds_read_b64 v[88:89], v88
    ds_read_b64 v[90:91], v90
    v_lshlrev_b32_sdwa v92, 3, v117 dst_sel:DWORD dst_unused:UNUSED_PAD src0_sel:DWORD src1_sel:WORD_0
    v_lshlrev_b32_sdwa v94, 3, v117 dst_sel:DWORD dst_unused:UNUSED_PAD src0_sel:DWORD src1_sel:WORD_1
    v_cvt_pk_bf16_f32 v44, v44, v45
    v_cvt_pk_bf16_f32 v45, v46, v47
    v_lshlrev_b32 v46, 16, v48
    v_and_b32 v47, s23, v48
    v_lshlrev_b32 v48, 16, v49
    v_and_b32 v49, s23, v49
    ds_read_b64 v[92:93], v92
    ds_read_b64 v[94:95], v94
    s_waitcnt lgkmcnt(9)
    v_smfmac_f32_16x16x64_bf16 v[46:49], v[66:69], v[96:103], v70
    s_lshl_b32 s28, s38, 16
    s_and_b32 s29, s38, 0xffff0000
    v_mfma_f32_16x16x32_bf16 v[112:115], v[72:75], v[208:211], 0
    v_lshlrev_b32_sdwa v96, 3, v118 dst_sel:DWORD dst_unused:UNUSED_PAD src0_sel:DWORD src1_sel:WORD_0
    v_lshlrev_b32_sdwa v98, 3, v118 dst_sel:DWORD dst_unused:UNUSED_PAD src0_sel:DWORD src1_sel:WORD_1
    ds_read_b64 v[96:97], v96
    ds_read_b64 v[98:99], v98
    v_mfma_f32_16x16x32_bf16 v[112:115], v[76:79], v[212:215], v[112:115]
    v_lshlrev_b32_sdwa v100, 3, v119 dst_sel:DWORD dst_unused:UNUSED_PAD src0_sel:DWORD src1_sel:WORD_0
    v_lshlrev_b32_sdwa v102, 3, v119 dst_sel:DWORD dst_unused:UNUSED_PAD src0_sel:DWORD src1_sel:WORD_1
    ds_read_b64 v[100:101], v100
    ds_read_b64 v[102:103], v102
    buffer_load_dwordx4 v[116:119], v71, s[12:15], s20 offen offset:0 sc1
    s_waitcnt lgkmcnt(9)
    v_smfmac_f32_16x16x64_bf16 v[46:49], v[66:69], v[104:111], v70
    s_lshl_b32 s30, s39, 16
    s_and_b32 s31, s39, 0xffff0000
    v_mfma_f32_16x16x32_bf16 v[112:115], v[80:83], v[216:219], v[112:115]
    s_waitcnt vmcnt(2)
    v_lshlrev_b32_sdwa v104, 3, v120 dst_sel:DWORD dst_unused:UNUSED_PAD src0_sel:DWORD src1_sel:WORD_0
    v_lshlrev_b32_sdwa v106, 3, v120 dst_sel:DWORD dst_unused:UNUSED_PAD src0_sel:DWORD src1_sel:WORD_1
    ds_read_b64 v[104:105], v104
    ds_read_b64 v[106:107], v106
    v_mfma_f32_16x16x32_bf16 v[112:115], v[84:87], v[220:223], v[112:115]
    v_lshlrev_b32_sdwa v108, 3, v121 dst_sel:DWORD dst_unused:UNUSED_PAD src0_sel:DWORD src1_sel:WORD_0
    v_lshlrev_b32_sdwa v110, 3, v121 dst_sel:DWORD dst_unused:UNUSED_PAD src0_sel:DWORD src1_sel:WORD_1
    v_cvt_pk_bf16_f32 v46, v46, v47
    v_cvt_pk_bf16_f32 v47, v48, v49
    v_lshlrev_b32 v48, 16, v50
    v_and_b32 v49, s23, v50
    v_lshlrev_b32 v50, 16, v51
    v_and_b32 v51, s23, v51
    ds_read_b64 v[108:109], v108
    ds_read_b64 v[110:111], v110
    s_waitcnt lgkmcnt(8)
    v_smfmac_f32_16x16x64_bf16 v[48:51], v[66:69], v[88:95], v70
    v_cvt_pk_bf16_f32 v112, v112, v113
    v_cvt_pk_bf16_f32 v113, v114, v115
    v_lshlrev_b32_sdwa v114, 3, v70 dst_sel:DWORD dst_unused:UNUSED_PAD src0_sel:DWORD src1_sel:WORD_1
    ds_write_b64 v114, v[112:113] offset:33408
    s_lshl1_add_u32 s35, s33, s34
    s_lshl3_add_u32 s35, s35, s3
    v_lshlrev_b32_sdwa v88, 3, v122 dst_sel:DWORD dst_unused:UNUSED_PAD src0_sel:DWORD src1_sel:WORD_0
    v_lshlrev_b32_sdwa v90, 3, v122 dst_sel:DWORD dst_unused:UNUSED_PAD src0_sel:DWORD src1_sel:WORD_1
    ds_read_b64 v[88:89], v88
    ds_read_b64 v[90:91], v90
    v_lshlrev_b32_sdwa v92, 3, v123 dst_sel:DWORD dst_unused:UNUSED_PAD src0_sel:DWORD src1_sel:WORD_0
    v_lshlrev_b32_sdwa v94, 3, v123 dst_sel:DWORD dst_unused:UNUSED_PAD src0_sel:DWORD src1_sel:WORD_1
    ds_read_b64 v[92:93], v92
    ds_read_b64 v[94:95], v94
    s_add_u32 s20, s20, 0xfffffc00
    buffer_load_dwordx4 v[120:123], v71, s[12:15], s20 offen offset:0 sc1
    s_waitcnt lgkmcnt(9)
    v_smfmac_f32_16x16x64_bf16 v[48:51], v[66:69], v[96:103], v70
    s_lshl_b32 s35, s35, 12
    s_add_u32 s35, s35, 20971520
    v_mfma_f32_16x16x32_bf16 v[112:115], v[72:75], v[224:227], 0
    s_waitcnt vmcnt(2)
    v_lshlrev_b32_sdwa v96, 3, v124 dst_sel:DWORD dst_unused:UNUSED_PAD src0_sel:DWORD src1_sel:WORD_0
    v_lshlrev_b32_sdwa v98, 3, v124 dst_sel:DWORD dst_unused:UNUSED_PAD src0_sel:DWORD src1_sel:WORD_1
    ds_read_b64 v[96:97], v96
    ds_read_b64 v[98:99], v98
    v_mfma_f32_16x16x32_bf16 v[112:115], v[76:79], v[228:231], v[112:115]
    v_lshlrev_b32_sdwa v100, 3, v125 dst_sel:DWORD dst_unused:UNUSED_PAD src0_sel:DWORD src1_sel:WORD_0
    v_lshlrev_b32_sdwa v102, 3, v125 dst_sel:DWORD dst_unused:UNUSED_PAD src0_sel:DWORD src1_sel:WORD_1
    v_cvt_pk_bf16_f32 v48, v48, v49
    v_cvt_pk_bf16_f32 v49, v50, v51
    v_lshlrev_b32 v50, 16, v52
    v_and_b32 v51, s23, v52
    v_lshlrev_b32 v52, 16, v53
    v_and_b32 v53, s23, v53
    ds_read_b64 v[100:101], v100
    ds_read_b64 v[102:103], v102
    s_waitcnt lgkmcnt(9)
    v_smfmac_f32_16x16x64_bf16 v[50:53], v[66:69], v[104:111], v70
    s_and_b32 s57, s57, 0xffff
    s_mov_b32 s58, 2
    v_mfma_f32_16x16x32_bf16 v[112:115], v[80:83], v[232:235], v[112:115]
    v_lshlrev_b32_sdwa v104, 3, v126 dst_sel:DWORD dst_unused:UNUSED_PAD src0_sel:DWORD src1_sel:WORD_0
    v_lshlrev_b32_sdwa v106, 3, v126 dst_sel:DWORD dst_unused:UNUSED_PAD src0_sel:DWORD src1_sel:WORD_1
    ds_read_b64 v[104:105], v104
    ds_read_b64 v[106:107], v106
    v_mfma_f32_16x16x32_bf16 v[112:115], v[84:87], v[236:239], v[112:115]
    v_lshlrev_b32_sdwa v108, 3, v127 dst_sel:DWORD dst_unused:UNUSED_PAD src0_sel:DWORD src1_sel:WORD_0
    v_lshlrev_b32_sdwa v110, 3, v127 dst_sel:DWORD dst_unused:UNUSED_PAD src0_sel:DWORD src1_sel:WORD_1
    ds_read_b64 v[108:109], v108
    ds_read_b64 v[110:111], v110
    s_add_u32 s20, s20, 0x3000
    buffer_load_dwordx4 v[124:127], v71, s[12:15], s20 offen offset:3072 sc1
    s_waitcnt lgkmcnt(8)
    v_smfmac_f32_16x16x64_bf16 v[50:53], v[66:69], v[88:95], v70
    v_cvt_pk_bf16_f32 v112, v112, v113
    v_cvt_pk_bf16_f32 v113, v114, v115
    v_lshlrev_b32_sdwa v114, 3, v70 dst_sel:DWORD dst_unused:UNUSED_PAD src0_sel:DWORD src1_sel:WORD_1
    ds_write_b64 v114, v[112:113] offset:33536
    s_mov_b32 s59, 0x00020000
    s_and_b32 s61, s61, 0xffff
    s_waitcnt vmcnt(2)
    v_lshlrev_b32_sdwa v88, 3, v116 dst_sel:DWORD dst_unused:UNUSED_PAD src0_sel:DWORD src1_sel:WORD_0
    v_lshlrev_b32_sdwa v90, 3, v116 dst_sel:DWORD dst_unused:UNUSED_PAD src0_sel:DWORD src1_sel:WORD_1
    ds_read_b64 v[88:89], v88
    ds_read_b64 v[90:91], v90
    v_lshlrev_b32_sdwa v92, 3, v117 dst_sel:DWORD dst_unused:UNUSED_PAD src0_sel:DWORD src1_sel:WORD_0
    v_lshlrev_b32_sdwa v94, 3, v117 dst_sel:DWORD dst_unused:UNUSED_PAD src0_sel:DWORD src1_sel:WORD_1
    v_cvt_pk_bf16_f32 v50, v50, v51
    v_cvt_pk_bf16_f32 v51, v52, v53
    v_lshlrev_b32 v52, 16, v54
    v_and_b32 v53, s23, v54
    v_lshlrev_b32 v54, 16, v55
    v_and_b32 v55, s23, v55
    ds_read_b64 v[92:93], v92
    ds_read_b64 v[94:95], v94
    s_waitcnt lgkmcnt(9)
    v_smfmac_f32_16x16x64_bf16 v[52:55], v[66:69], v[96:103], v70
    s_mov_b32 s62, 32768
    s_mov_b32 s63, 0x00020000
    v_mfma_f32_16x16x32_bf16 v[112:115], v[72:75], v[240:243], 0
    buffer_load_dwordx4 v[72:75], v71, s[12:15], s21 offen offset:0
    v_lshlrev_b32_sdwa v96, 3, v118 dst_sel:DWORD dst_unused:UNUSED_PAD src0_sel:DWORD src1_sel:WORD_0
    v_lshlrev_b32_sdwa v98, 3, v118 dst_sel:DWORD dst_unused:UNUSED_PAD src0_sel:DWORD src1_sel:WORD_1
    ds_read_b64 v[96:97], v96
    ds_read_b64 v[98:99], v98
    v_mfma_f32_16x16x32_bf16 v[112:115], v[76:79], v[244:247], v[112:115]
    buffer_load_dwordx4 v[76:79], v71, s[12:15], s21 offen offset:1024
    v_lshlrev_b32_sdwa v100, 3, v119 dst_sel:DWORD dst_unused:UNUSED_PAD src0_sel:DWORD src1_sel:WORD_0
    v_lshlrev_b32_sdwa v102, 3, v119 dst_sel:DWORD dst_unused:UNUSED_PAD src0_sel:DWORD src1_sel:WORD_1
    ds_read_b64 v[100:101], v100
    ds_read_b64 v[102:103], v102
    buffer_load_dwordx4 v[116:119], v71, s[12:15], s20 offen offset:2048 sc1
    s_waitcnt lgkmcnt(9)
    v_smfmac_f32_16x16x64_bf16 v[52:55], v[66:69], v[104:111], v70
    s_setprio 1
    s_xor_b32 s64, s34, 1
    s_lshl_b32 s64, s64, 7
    v_mfma_f32_16x16x32_bf16 v[112:115], v[80:83], v[248:251], v[112:115]
    buffer_load_dwordx4 v[80:83], v71, s[12:15], s19 offen offset:0
    s_waitcnt vmcnt(5)
    v_lshlrev_b32_sdwa v104, 3, v120 dst_sel:DWORD dst_unused:UNUSED_PAD src0_sel:DWORD src1_sel:WORD_0
    v_lshlrev_b32_sdwa v106, 3, v120 dst_sel:DWORD dst_unused:UNUSED_PAD src0_sel:DWORD src1_sel:WORD_1
    ds_read_b64 v[104:105], v104
    ds_read_b64 v[106:107], v106
    v_mfma_f32_16x16x32_bf16 v[112:115], v[84:87], v[252:255], v[112:115]
    buffer_load_dwordx4 v[84:87], v71, s[12:15], s19 offen offset:1024
    v_lshlrev_b32_sdwa v108, 3, v121 dst_sel:DWORD dst_unused:UNUSED_PAD src0_sel:DWORD src1_sel:WORD_0
    v_lshlrev_b32_sdwa v110, 3, v121 dst_sel:DWORD dst_unused:UNUSED_PAD src0_sel:DWORD src1_sel:WORD_1
    v_cvt_pk_bf16_f32 v52, v52, v53
    v_cvt_pk_bf16_f32 v53, v54, v55
    v_lshlrev_b32 v54, 16, v56
    v_and_b32 v55, s23, v56
    v_lshlrev_b32 v56, 16, v57
    v_and_b32 v57, s23, v57
    ds_read_b64 v[108:109], v108
    ds_read_b64 v[110:111], v110
    s_waitcnt lgkmcnt(8)
    v_smfmac_f32_16x16x64_bf16 v[54:57], v[66:69], v[88:95], v70
    v_cvt_pk_bf16_f32 v112, v112, v113
    v_cvt_pk_bf16_f32 v113, v114, v115
    v_lshlrev_b32_sdwa v114, 3, v70 dst_sel:DWORD dst_unused:UNUSED_PAD src0_sel:DWORD src1_sel:WORD_1
    ds_write_b64 v114, v[112:113] offset:33664
    s_add_u32 s64, s64, s33
    s_lshl_b32 s65, s3, 20
    v_lshlrev_b32_sdwa v88, 3, v122 dst_sel:DWORD dst_unused:UNUSED_PAD src0_sel:DWORD src1_sel:WORD_0
    v_lshlrev_b32_sdwa v90, 3, v122 dst_sel:DWORD dst_unused:UNUSED_PAD src0_sel:DWORD src1_sel:WORD_1
    ds_read_b64 v[88:89], v88
    ds_read_b64 v[90:91], v90
    v_lshlrev_b32_sdwa v92, 3, v123 dst_sel:DWORD dst_unused:UNUSED_PAD src0_sel:DWORD src1_sel:WORD_0
    v_lshlrev_b32_sdwa v94, 3, v123 dst_sel:DWORD dst_unused:UNUSED_PAD src0_sel:DWORD src1_sel:WORD_1
    ds_read_b64 v[92:93], v92
    ds_read_b64 v[94:95], v94
    buffer_load_dwordx4 v[120:123], v71, s[12:15], s20 offen offset:1024 sc1
    s_waitcnt lgkmcnt(9)
    v_smfmac_f32_16x16x64_bf16 v[54:57], v[66:69], v[96:103], v70
    s_add_u32 s66, s65, 1048576
    s_lshl_b32 s67, s3, 14
    s_waitcnt vmcnt(6)
    v_lshlrev_b32_sdwa v96, 3, v124 dst_sel:DWORD dst_unused:UNUSED_PAD src0_sel:DWORD src1_sel:WORD_0
    v_lshlrev_b32_sdwa v98, 3, v124 dst_sel:DWORD dst_unused:UNUSED_PAD src0_sel:DWORD src1_sel:WORD_1
    ds_read_b64 v[96:97], v96
    ds_read_b64 v[98:99], v98
    v_lshlrev_b32_sdwa v100, 3, v125 dst_sel:DWORD dst_unused:UNUSED_PAD src0_sel:DWORD src1_sel:WORD_0
    v_lshlrev_b32_sdwa v102, 3, v125 dst_sel:DWORD dst_unused:UNUSED_PAD src0_sel:DWORD src1_sel:WORD_1
    v_cvt_pk_bf16_f32 v54, v54, v55
    v_cvt_pk_bf16_f32 v55, v56, v57
    v_lshlrev_b32 v56, 16, v58
    v_and_b32 v57, s23, v58
    v_lshlrev_b32 v58, 16, v59
    v_and_b32 v59, s23, v59
    ds_read_b64 v[100:101], v100
    ds_read_b64 v[102:103], v102
    s_waitcnt lgkmcnt(9)
    v_smfmac_f32_16x16x64_bf16 v[56:59], v[66:69], v[104:111], v70
    s_add_u32 s67, s67, 8000
    s_lshl_b32 s68, s64, 7
    v_lshlrev_b32_sdwa v104, 3, v126 dst_sel:DWORD dst_unused:UNUSED_PAD src0_sel:DWORD src1_sel:WORD_0
    v_lshlrev_b32_sdwa v106, 3, v126 dst_sel:DWORD dst_unused:UNUSED_PAD src0_sel:DWORD src1_sel:WORD_1
    ds_read_b64 v[104:105], v104
    ds_read_b64 v[106:107], v106
    v_lshlrev_b32_sdwa v108, 3, v127 dst_sel:DWORD dst_unused:UNUSED_PAD src0_sel:DWORD src1_sel:WORD_0
    v_lshlrev_b32_sdwa v110, 3, v127 dst_sel:DWORD dst_unused:UNUSED_PAD src0_sel:DWORD src1_sel:WORD_1
    ds_read_b64 v[108:109], v108
    ds_read_b64 v[110:111], v110
    s_add_u32 s20, s20, 0x40400
    buffer_load_dwordx4 v[124:127], v71, s[12:15], s20 offen offset:0 sc1
    s_waitcnt lgkmcnt(8)
    v_smfmac_f32_16x16x64_bf16 v[56:59], v[66:69], v[88:95], v70
    s_lshl_b32 s69, s64, 8
    s_add_u32 s69, s69, s65
    s_waitcnt vmcnt(4)
    v_lshlrev_b32_sdwa v88, 3, v116 dst_sel:DWORD dst_unused:UNUSED_PAD src0_sel:DWORD src1_sel:WORD_0
    v_lshlrev_b32_sdwa v90, 3, v116 dst_sel:DWORD dst_unused:UNUSED_PAD src0_sel:DWORD src1_sel:WORD_1
    ds_read_b64 v[88:89], v88
    ds_read_b64 v[90:91], v90
    v_lshlrev_b32_sdwa v92, 3, v117 dst_sel:DWORD dst_unused:UNUSED_PAD src0_sel:DWORD src1_sel:WORD_0
    v_lshlrev_b32_sdwa v94, 3, v117 dst_sel:DWORD dst_unused:UNUSED_PAD src0_sel:DWORD src1_sel:WORD_1
    v_cvt_pk_bf16_f32 v56, v56, v57
    v_cvt_pk_bf16_f32 v57, v58, v59
    v_lshlrev_b32 v58, 16, v60
    v_and_b32 v59, s23, v60
    v_lshlrev_b32 v60, 16, v61
    v_and_b32 v61, s23, v61
    ds_read_b64 v[92:93], v92
    ds_read_b64 v[94:95], v94
    s_waitcnt lgkmcnt(8)
    v_smfmac_f32_16x16x64_bf16 v[58:61], v[66:69], v[96:103], v70
    s_add_u32 s69, s69, 20971520
    s_mov_b32 s42, 0
    v_lshlrev_b32_sdwa v96, 3, v118 dst_sel:DWORD dst_unused:UNUSED_PAD src0_sel:DWORD src1_sel:WORD_0
    v_lshlrev_b32_sdwa v98, 3, v118 dst_sel:DWORD dst_unused:UNUSED_PAD src0_sel:DWORD src1_sel:WORD_1
    ds_read_b64 v[96:97], v96
    ds_read_b64 v[98:99], v98
    v_lshlrev_b32_sdwa v100, 3, v119 dst_sel:DWORD dst_unused:UNUSED_PAD src0_sel:DWORD src1_sel:WORD_0
    v_lshlrev_b32_sdwa v102, 3, v119 dst_sel:DWORD dst_unused:UNUSED_PAD src0_sel:DWORD src1_sel:WORD_1
    ds_read_b64 v[100:101], v100
    ds_read_b64 v[102:103], v102
    buffer_load_dwordx4 v[116:119], v71, s[12:15], s20 offen offset:1024 sc1
    s_waitcnt lgkmcnt(8)
    v_smfmac_f32_16x16x64_bf16 v[58:61], v[66:69], v[104:111], v70
    s_setprio 0
    s_mov_b32 s43, 0
    s_add_u32 s17, s16, 4096
    s_waitcnt vmcnt(2)
    v_lshlrev_b32_sdwa v104, 3, v120 dst_sel:DWORD dst_unused:UNUSED_PAD src0_sel:DWORD src1_sel:WORD_0
    v_lshlrev_b32_sdwa v106, 3, v120 dst_sel:DWORD dst_unused:UNUSED_PAD src0_sel:DWORD src1_sel:WORD_1
    ds_read_b64 v[104:105], v104
    ds_read_b64 v[106:107], v106
    v_lshlrev_b32_sdwa v108, 3, v121 dst_sel:DWORD dst_unused:UNUSED_PAD src0_sel:DWORD src1_sel:WORD_0
    v_lshlrev_b32_sdwa v110, 3, v121 dst_sel:DWORD dst_unused:UNUSED_PAD src0_sel:DWORD src1_sel:WORD_1
    v_cvt_pk_bf16_f32 v58, v58, v59
    v_cvt_pk_bf16_f32 v59, v60, v61
    v_lshlrev_b32 v60, 16, v62
    v_and_b32 v61, s23, v62
    v_lshlrev_b32 v62, 16, v63
    v_and_b32 v63, s23, v63
    ds_read_b64 v[108:109], v108
    ds_read_b64 v[110:111], v110
    s_waitcnt lgkmcnt(8)
    v_smfmac_f32_16x16x64_bf16 v[60:63], v[66:69], v[88:95], v70
    s_add_u32 s32, s18, 4096
    v_lshlrev_b32_sdwa v88, 3, v122 dst_sel:DWORD dst_unused:UNUSED_PAD src0_sel:DWORD src1_sel:WORD_0
    v_lshlrev_b32_sdwa v90, 3, v122 dst_sel:DWORD dst_unused:UNUSED_PAD src0_sel:DWORD src1_sel:WORD_1
    ds_read_b64 v[88:89], v88
    ds_read_b64 v[90:91], v90
    v_lshlrev_b32_sdwa v92, 3, v123 dst_sel:DWORD dst_unused:UNUSED_PAD src0_sel:DWORD src1_sel:WORD_0
    v_lshlrev_b32_sdwa v94, 3, v123 dst_sel:DWORD dst_unused:UNUSED_PAD src0_sel:DWORD src1_sel:WORD_1
    ds_read_b64 v[92:93], v92
    ds_read_b64 v[94:95], v94
    buffer_load_dwordx4 v[120:123], v71, s[12:15], s20 offen offset:2048 sc1
    s_waitcnt lgkmcnt(8)
    v_smfmac_f32_16x16x64_bf16 v[60:63], v[66:69], v[96:103], v70
    s_waitcnt lgkmcnt(4)
    s_barrier
    s_setprio 3
    s_waitcnt vmcnt(2)
    v_lshlrev_b32_sdwa v96, 3, v124 dst_sel:DWORD dst_unused:UNUSED_PAD src0_sel:DWORD src1_sel:WORD_0
    v_lshlrev_b32_sdwa v98, 3, v124 dst_sel:DWORD dst_unused:UNUSED_PAD src0_sel:DWORD src1_sel:WORD_1
    ds_read_b64 v[96:97], v96
    ds_read_b64 v[98:99], v98
    v_lshlrev_b32_sdwa v100, 3, v125 dst_sel:DWORD dst_unused:UNUSED_PAD src0_sel:DWORD src1_sel:WORD_0
    v_lshlrev_b32_sdwa v102, 3, v125 dst_sel:DWORD dst_unused:UNUSED_PAD src0_sel:DWORD src1_sel:WORD_1
    v_cvt_pk_bf16_f32 v60, v60, v61
    v_cvt_pk_bf16_f32 v61, v62, v63
    v_lshlrev_b32 v62, 16, v64
    v_and_b32 v63, s23, v64
    v_lshlrev_b32 v64, 16, v65
    v_and_b32 v65, s23, v65
    ds_read_b64 v[100:101], v100
    ds_read_b64 v[102:103], v102
    v_smfmac_f32_16x16x64_bf16 v[62:65], v[66:69], v[104:111], v70
    v_lshlrev_b32_sdwa v104, 3, v126 dst_sel:DWORD dst_unused:UNUSED_PAD src0_sel:DWORD src1_sel:WORD_0
    v_lshlrev_b32_sdwa v106, 3, v126 dst_sel:DWORD dst_unused:UNUSED_PAD src0_sel:DWORD src1_sel:WORD_1
    ds_read_b64 v[104:105], v104
    ds_read_b64 v[106:107], v106
    v_lshlrev_b32_sdwa v108, 3, v127 dst_sel:DWORD dst_unused:UNUSED_PAD src0_sel:DWORD src1_sel:WORD_0
    v_lshlrev_b32_sdwa v110, 3, v127 dst_sel:DWORD dst_unused:UNUSED_PAD src0_sel:DWORD src1_sel:WORD_1
    ds_read_b64 v[108:109], v108
    ds_read_b64 v[110:111], v110
    s_add_u32 s20, s20, 0xffffcc00
    buffer_load_dwordx4 v[124:127], v71, s[12:15], s20 offen offset:0 sc1
    s_waitcnt lgkmcnt(8)
    v_smfmac_f32_16x16x64_bf16 v[62:65], v[66:69], v[88:95], v70
    v_mfma_f32_16x16x32_bf16 v[112:115], v[72:75], v[128:131], 0
    s_waitcnt vmcnt(2)
    v_lshlrev_b32_sdwa v88, 3, v116 dst_sel:DWORD dst_unused:UNUSED_PAD src0_sel:DWORD src1_sel:WORD_0
    v_lshlrev_b32_sdwa v90, 3, v116 dst_sel:DWORD dst_unused:UNUSED_PAD src0_sel:DWORD src1_sel:WORD_1
    ds_read_b64 v[88:89], v88
    ds_read_b64 v[90:91], v90
    v_mfma_f32_16x16x32_bf16 v[112:115], v[76:79], v[132:135], v[112:115]
    v_add_u32 v70, 0x20000000, v70
    v_lshlrev_b32_sdwa v92, 3, v117 dst_sel:DWORD dst_unused:UNUSED_PAD src0_sel:DWORD src1_sel:WORD_0
    v_lshlrev_b32_sdwa v94, 3, v117 dst_sel:DWORD dst_unused:UNUSED_PAD src0_sel:DWORD src1_sel:WORD_1
    v_cvt_pk_bf16_f32 v62, v62, v63
    v_cvt_pk_bf16_f32 v63, v64, v65
    v_and_b32 v65, s23, v63
    v_lshlrev_b32 v64, 16, v63
    v_and_b32 v63, s23, v62
    v_lshlrev_b32 v62, 16, v62
    ds_read_b64 v[92:93], v92
    ds_read_b64 v[94:95], v94
    s_waitcnt lgkmcnt(8)
    v_smfmac_f32_16x16x64_bf16 v[62:65], v[66:69], v[96:103], v70
    v_mfma_f32_16x16x32_bf16 v[112:115], v[80:83], v[136:139], v[112:115]
    v_lshlrev_b32_sdwa v96, 3, v118 dst_sel:DWORD dst_unused:UNUSED_PAD src0_sel:DWORD src1_sel:WORD_0
    v_lshlrev_b32_sdwa v98, 3, v118 dst_sel:DWORD dst_unused:UNUSED_PAD src0_sel:DWORD src1_sel:WORD_1
    ds_read_b64 v[96:97], v96
    ds_read_b64 v[98:99], v98
    v_mfma_f32_16x16x32_bf16 v[112:115], v[84:87], v[140:143], v[112:115]
    v_lshlrev_b32_sdwa v100, 3, v119 dst_sel:DWORD dst_unused:UNUSED_PAD src0_sel:DWORD src1_sel:WORD_0
    v_lshlrev_b32_sdwa v102, 3, v119 dst_sel:DWORD dst_unused:UNUSED_PAD src0_sel:DWORD src1_sel:WORD_1
    ds_read_b64 v[100:101], v100
    ds_read_b64 v[102:103], v102
    buffer_load_dwordx4 v[128:131], v71, s[12:15], s20 offen offset:1024 sc1
    s_waitcnt lgkmcnt(8)
    v_smfmac_f32_16x16x64_bf16 v[62:65], v[66:69], v[104:111], v70
    s_nop 0
    v_cvt_pk_bf16_f32 v112, v112, v113
    v_cvt_pk_bf16_f32 v113, v114, v115
    v_lshlrev_b32_sdwa v114, 3, v70 dst_sel:DWORD dst_unused:UNUSED_PAD src0_sel:DWORD src1_sel:WORD_1
    ds_write_b64 v114, v[112:113] offset:0
    s_waitcnt vmcnt(2)
    v_lshlrev_b32_sdwa v104, 3, v120 dst_sel:DWORD dst_unused:UNUSED_PAD src0_sel:DWORD src1_sel:WORD_0
    v_lshlrev_b32_sdwa v106, 3, v120 dst_sel:DWORD dst_unused:UNUSED_PAD src0_sel:DWORD src1_sel:WORD_1
    ds_read_b64 v[104:105], v104
    ds_read_b64 v[106:107], v106
    v_lshlrev_b32_sdwa v108, 3, v121 dst_sel:DWORD dst_unused:UNUSED_PAD src0_sel:DWORD src1_sel:WORD_0
    v_lshlrev_b32_sdwa v110, 3, v121 dst_sel:DWORD dst_unused:UNUSED_PAD src0_sel:DWORD src1_sel:WORD_1
    v_cvt_pk_bf16_f32 v65, v64, v65
    v_cvt_pk_bf16_f32 v64, v62, v63
    v_and_b32 v63, s23, v61
    v_lshlrev_b32 v62, 16, v61
    v_and_b32 v61, s23, v60
    v_lshlrev_b32 v60, 16, v60
    ds_read_b64 v[108:109], v108
    ds_read_b64 v[110:111], v110
    buffer_load_dwordx4 v[132:135], v71, s[12:15], s20 offen offset:2048 sc1
    s_waitcnt lgkmcnt(9)
    v_smfmac_f32_16x16x64_bf16 v[60:63], v[66:69], v[88:95], v70
    v_mfma_f32_16x16x32_bf16 v[112:115], v[72:75], v[144:147], 0
    v_lshlrev_b32_sdwa v88, 3, v122 dst_sel:DWORD dst_unused:UNUSED_PAD src0_sel:DWORD src1_sel:WORD_0
    v_lshlrev_b32_sdwa v90, 3, v122 dst_sel:DWORD dst_unused:UNUSED_PAD src0_sel:DWORD src1_sel:WORD_1
    ds_read_b64 v[88:89], v88
    ds_read_b64 v[90:91], v90
    v_mfma_f32_16x16x32_bf16 v[112:115], v[76:79], v[148:151], v[112:115]
    v_lshlrev_b32_sdwa v92, 3, v123 dst_sel:DWORD dst_unused:UNUSED_PAD src0_sel:DWORD src1_sel:WORD_0
    v_lshlrev_b32_sdwa v94, 3, v123 dst_sel:DWORD dst_unused:UNUSED_PAD src0_sel:DWORD src1_sel:WORD_1
    ds_read_b64 v[92:93], v92
    ds_read_b64 v[94:95], v94
    buffer_load_dwordx4 v[136:139], v71, s[12:15], s20 offen offset:3072 sc1
    s_waitcnt lgkmcnt(9)
    v_smfmac_f32_16x16x64_bf16 v[60:63], v[66:69], v[96:103], v70
    v_mfma_f32_16x16x32_bf16 v[112:115], v[80:83], v[152:155], v[112:115]
    s_waitcnt vmcnt(3)
    v_lshlrev_b32_sdwa v96, 3, v124 dst_sel:DWORD dst_unused:UNUSED_PAD src0_sel:DWORD src1_sel:WORD_0
    v_lshlrev_b32_sdwa v98, 3, v124 dst_sel:DWORD dst_unused:UNUSED_PAD src0_sel:DWORD src1_sel:WORD_1
    ds_read_b64 v[96:97], v96
    ds_read_b64 v[98:99], v98
    v_mfma_f32_16x16x32_bf16 v[112:115], v[84:87], v[156:159], v[112:115]
    v_lshlrev_b32_sdwa v100, 3, v125 dst_sel:DWORD dst_unused:UNUSED_PAD src0_sel:DWORD src1_sel:WORD_0
    v_lshlrev_b32_sdwa v102, 3, v125 dst_sel:DWORD dst_unused:UNUSED_PAD src0_sel:DWORD src1_sel:WORD_1
    v_cvt_pk_bf16_f32 v63, v62, v63
    v_cvt_pk_bf16_f32 v62, v60, v61
    v_and_b32 v61, s23, v59
    v_lshlrev_b32 v60, 16, v59
    v_and_b32 v59, s23, v58
    v_lshlrev_b32 v58, 16, v58
    ds_read_b64 v[100:101], v100
    ds_read_b64 v[102:103], v102
    s_add_u32 s20, s20, 0x1000
    buffer_load_dwordx4 v[140:143], v71, s[12:15], s20 offen offset:0 sc1
    buffer_store_dwordx4 v[62:65], v71, s[12:15], s16 offen offset:0 sc1
    s_waitcnt lgkmcnt(8)
    v_smfmac_f32_16x16x64_bf16 v[58:61], v[66:69], v[104:111], v70
    v_cvt_pk_bf16_f32 v112, v112, v113
    v_cvt_pk_bf16_f32 v113, v114, v115
    v_lshlrev_b32_sdwa v114, 3, v70 dst_sel:DWORD dst_unused:UNUSED_PAD src0_sel:DWORD src1_sel:WORD_1
    ds_write_b64 v114, v[112:113] offset:128
    v_lshlrev_b32_sdwa v104, 3, v126 dst_sel:DWORD dst_unused:UNUSED_PAD src0_sel:DWORD src1_sel:WORD_0
    v_lshlrev_b32_sdwa v106, 3, v126 dst_sel:DWORD dst_unused:UNUSED_PAD src0_sel:DWORD src1_sel:WORD_1
    ds_read_b64 v[104:105], v104
    ds_read_b64 v[106:107], v106
    v_lshlrev_b32_sdwa v108, 3, v127 dst_sel:DWORD dst_unused:UNUSED_PAD src0_sel:DWORD src1_sel:WORD_0
    v_lshlrev_b32_sdwa v110, 3, v127 dst_sel:DWORD dst_unused:UNUSED_PAD src0_sel:DWORD src1_sel:WORD_1
    ds_read_b64 v[108:109], v108
    ds_read_b64 v[110:111], v110
    buffer_load_dwordx4 v[116:119], v71, s[12:15], s20 offen offset:1024 sc1
    s_waitcnt lgkmcnt(9)
    v_smfmac_f32_16x16x64_bf16 v[58:61], v[66:69], v[88:95], v70
    v_mfma_f32_16x16x32_bf16 v[112:115], v[72:75], v[160:163], 0
    s_waitcnt vmcnt(5)
    v_lshlrev_b32_sdwa v88, 3, v128 dst_sel:DWORD dst_unused:UNUSED_PAD src0_sel:DWORD src1_sel:WORD_0
    v_lshlrev_b32_sdwa v90, 3, v128 dst_sel:DWORD dst_unused:UNUSED_PAD src0_sel:DWORD src1_sel:WORD_1
    ds_read_b64 v[88:89], v88
    ds_read_b64 v[90:91], v90
    v_mfma_f32_16x16x32_bf16 v[112:115], v[76:79], v[164:167], v[112:115]
    v_lshlrev_b32_sdwa v92, 3, v129 dst_sel:DWORD dst_unused:UNUSED_PAD src0_sel:DWORD src1_sel:WORD_0
    v_lshlrev_b32_sdwa v94, 3, v129 dst_sel:DWORD dst_unused:UNUSED_PAD src0_sel:DWORD src1_sel:WORD_1
    v_cvt_pk_bf16_f32 v61, v60, v61
    v_cvt_pk_bf16_f32 v60, v58, v59
    v_and_b32 v59, s23, v57
    v_lshlrev_b32 v58, 16, v57
    v_and_b32 v57, s23, v56
    v_lshlrev_b32 v56, 16, v56
    ds_read_b64 v[92:93], v92
    ds_read_b64 v[94:95], v94
    buffer_load_dwordx4 v[120:123], v71, s[12:15], s20 offen offset:2048 sc1
    s_waitcnt lgkmcnt(9)
    v_smfmac_f32_16x16x64_bf16 v[56:59], v[66:69], v[96:103], v70
    v_mfma_f32_16x16x32_bf16 v[112:115], v[80:83], v[168:171], v[112:115]
    v_lshlrev_b32_sdwa v96, 3, v130 dst_sel:DWORD dst_unused:UNUSED_PAD src0_sel:DWORD src1_sel:WORD_0
    v_lshlrev_b32_sdwa v98, 3, v130 dst_sel:DWORD dst_unused:UNUSED_PAD src0_sel:DWORD src1_sel:WORD_1
    ds_read_b64 v[96:97], v96
    ds_read_b64 v[98:99], v98
    v_mfma_f32_16x16x32_bf16 v[112:115], v[84:87], v[172:175], v[112:115]
    v_lshlrev_b32_sdwa v100, 3, v131 dst_sel:DWORD dst_unused:UNUSED_PAD src0_sel:DWORD src1_sel:WORD_0
    v_lshlrev_b32_sdwa v102, 3, v131 dst_sel:DWORD dst_unused:UNUSED_PAD src0_sel:DWORD src1_sel:WORD_1
    ds_read_b64 v[100:101], v100
    ds_read_b64 v[102:103], v102
    buffer_load_dwordx4 v[124:127], v71, s[12:15], s20 offen offset:3072 sc1
    s_waitcnt lgkmcnt(8)
    v_smfmac_f32_16x16x64_bf16 v[56:59], v[66:69], v[104:111], v70
    s_nop 0
    v_cvt_pk_bf16_f32 v112, v112, v113
    v_cvt_pk_bf16_f32 v113, v114, v115
    v_lshlrev_b32_sdwa v114, 3, v70 dst_sel:DWORD dst_unused:UNUSED_PAD src0_sel:DWORD src1_sel:WORD_1
    ds_write_b64 v114, v[112:113] offset:256
    s_waitcnt vmcnt(6)
    v_lshlrev_b32_sdwa v104, 3, v132 dst_sel:DWORD dst_unused:UNUSED_PAD src0_sel:DWORD src1_sel:WORD_0
    v_lshlrev_b32_sdwa v106, 3, v132 dst_sel:DWORD dst_unused:UNUSED_PAD src0_sel:DWORD src1_sel:WORD_1
    ds_read_b64 v[104:105], v104
    ds_read_b64 v[106:107], v106
    v_lshlrev_b32_sdwa v108, 3, v133 dst_sel:DWORD dst_unused:UNUSED_PAD src0_sel:DWORD src1_sel:WORD_0
    v_lshlrev_b32_sdwa v110, 3, v133 dst_sel:DWORD dst_unused:UNUSED_PAD src0_sel:DWORD src1_sel:WORD_1
    v_cvt_pk_bf16_f32 v59, v58, v59
    v_cvt_pk_bf16_f32 v58, v56, v57
    v_and_b32 v57, s23, v55
    v_lshlrev_b32 v56, 16, v55
    v_and_b32 v55, s23, v54
    v_lshlrev_b32 v54, 16, v54
    ds_read_b64 v[108:109], v108
    ds_read_b64 v[110:111], v110
    s_add_u32 s20, s20, 0x1000
    buffer_load_dwordx4 v[128:131], v71, s[12:15], s20 offen offset:0 sc1
    s_waitcnt lgkmcnt(9)
    v_smfmac_f32_16x16x64_bf16 v[54:57], v[66:69], v[88:95], v70
    v_mfma_f32_16x16x32_bf16 v[112:115], v[72:75], v[176:179], 0
    v_lshlrev_b32_sdwa v88, 3, v134 dst_sel:DWORD dst_unused:UNUSED_PAD src0_sel:DWORD src1_sel:WORD_0
    v_lshlrev_b32_sdwa v90, 3, v134 dst_sel:DWORD dst_unused:UNUSED_PAD src0_sel:DWORD src1_sel:WORD_1
    ds_read_b64 v[88:89], v88
    ds_read_b64 v[90:91], v90
    v_mfma_f32_16x16x32_bf16 v[112:115], v[76:79], v[180:183], v[112:115]
    v_lshlrev_b32_sdwa v92, 3, v135 dst_sel:DWORD dst_unused:UNUSED_PAD src0_sel:DWORD src1_sel:WORD_0
    v_lshlrev_b32_sdwa v94, 3, v135 dst_sel:DWORD dst_unused:UNUSED_PAD src0_sel:DWORD src1_sel:WORD_1
    ds_read_b64 v[92:93], v92
    ds_read_b64 v[94:95], v94
    buffer_load_dwordx4 v[132:135], v71, s[12:15], s20 offen offset:1024 sc1
    s_waitcnt lgkmcnt(9)
    v_smfmac_f32_16x16x64_bf16 v[54:57], v[66:69], v[96:103], v70
    v_mfma_f32_16x16x32_bf16 v[112:115], v[80:83], v[184:187], v[112:115]
    s_waitcnt vmcnt(7)
    v_lshlrev_b32_sdwa v96, 3, v136 dst_sel:DWORD dst_unused:UNUSED_PAD src0_sel:DWORD src1_sel:WORD_0
    v_lshlrev_b32_sdwa v98, 3, v136 dst_sel:DWORD dst_unused:UNUSED_PAD src0_sel:DWORD src1_sel:WORD_1
    ds_read_b64 v[96:97], v96
    ds_read_b64 v[98:99], v98
    v_mfma_f32_16x16x32_bf16 v[112:115], v[84:87], v[188:191], v[112:115]
    v_lshlrev_b32_sdwa v100, 3, v137 dst_sel:DWORD dst_unused:UNUSED_PAD src0_sel:DWORD src1_sel:WORD_0
    v_lshlrev_b32_sdwa v102, 3, v137 dst_sel:DWORD dst_unused:UNUSED_PAD src0_sel:DWORD src1_sel:WORD_1
    v_cvt_pk_bf16_f32 v57, v56, v57
    v_cvt_pk_bf16_f32 v56, v54, v55
    v_and_b32 v55, s23, v53
    v_lshlrev_b32 v54, 16, v53
    v_and_b32 v53, s23, v52
    v_lshlrev_b32 v52, 16, v52
    ds_read_b64 v[100:101], v100
    ds_read_b64 v[102:103], v102
    buffer_store_dwordx4 v[58:61], v71, s[12:15], s16 offen offset:1024 sc1
    s_waitcnt lgkmcnt(8)
    v_smfmac_f32_16x16x64_bf16 v[52:55], v[66:69], v[104:111], v70
    v_cvt_pk_bf16_f32 v112, v112, v113
    v_cvt_pk_bf16_f32 v113, v114, v115
    v_lshlrev_b32_sdwa v114, 3, v70 dst_sel:DWORD dst_unused:UNUSED_PAD src0_sel:DWORD src1_sel:WORD_1
    ds_write_b64 v114, v[112:113] offset:384
    v_lshlrev_b32_sdwa v104, 3, v138 dst_sel:DWORD dst_unused:UNUSED_PAD src0_sel:DWORD src1_sel:WORD_0
    v_lshlrev_b32_sdwa v106, 3, v138 dst_sel:DWORD dst_unused:UNUSED_PAD src0_sel:DWORD src1_sel:WORD_1
    ds_read_b64 v[104:105], v104
    ds_read_b64 v[106:107], v106
    v_lshlrev_b32_sdwa v108, 3, v139 dst_sel:DWORD dst_unused:UNUSED_PAD src0_sel:DWORD src1_sel:WORD_0
    v_lshlrev_b32_sdwa v110, 3, v139 dst_sel:DWORD dst_unused:UNUSED_PAD src0_sel:DWORD src1_sel:WORD_1
    ds_read_b64 v[108:109], v108
    ds_read_b64 v[110:111], v110
    buffer_load_dwordx4 v[136:139], v71, s[12:15], s20 offen offset:2048 sc1
    s_waitcnt lgkmcnt(9)
    v_smfmac_f32_16x16x64_bf16 v[52:55], v[66:69], v[88:95], v70
    v_mfma_f32_16x16x32_bf16 v[112:115], v[72:75], v[192:195], 0
    s_waitcnt vmcnt(8)
    v_lshlrev_b32_sdwa v88, 3, v140 dst_sel:DWORD dst_unused:UNUSED_PAD src0_sel:DWORD src1_sel:WORD_0
    v_lshlrev_b32_sdwa v90, 3, v140 dst_sel:DWORD dst_unused:UNUSED_PAD src0_sel:DWORD src1_sel:WORD_1
    ds_read_b64 v[88:89], v88
    ds_read_b64 v[90:91], v90
    v_mfma_f32_16x16x32_bf16 v[112:115], v[76:79], v[196:199], v[112:115]
    v_lshlrev_b32_sdwa v92, 3, v141 dst_sel:DWORD dst_unused:UNUSED_PAD src0_sel:DWORD src1_sel:WORD_0
    v_lshlrev_b32_sdwa v94, 3, v141 dst_sel:DWORD dst_unused:UNUSED_PAD src0_sel:DWORD src1_sel:WORD_1
    v_cvt_pk_bf16_f32 v55, v54, v55
    v_cvt_pk_bf16_f32 v54, v52, v53
    v_and_b32 v53, s23, v51
    v_lshlrev_b32 v52, 16, v51
    v_and_b32 v51, s23, v50
    v_lshlrev_b32 v50, 16, v50
    ds_read_b64 v[92:93], v92
    ds_read_b64 v[94:95], v94
    s_waitcnt lgkmcnt(9)
    v_smfmac_f32_16x16x64_bf16 v[50:53], v[66:69], v[96:103], v70
    v_mfma_f32_16x16x32_bf16 v[112:115], v[80:83], v[200:203], v[112:115]
    v_lshlrev_b32_sdwa v96, 3, v142 dst_sel:DWORD dst_unused:UNUSED_PAD src0_sel:DWORD src1_sel:WORD_0
    v_lshlrev_b32_sdwa v98, 3, v142 dst_sel:DWORD dst_unused:UNUSED_PAD src0_sel:DWORD src1_sel:WORD_1
    ds_read_b64 v[96:97], v96
    ds_read_b64 v[98:99], v98
    v_mfma_f32_16x16x32_bf16 v[112:115], v[84:87], v[204:207], v[112:115]
    v_lshlrev_b32_sdwa v100, 3, v143 dst_sel:DWORD dst_unused:UNUSED_PAD src0_sel:DWORD src1_sel:WORD_0
    v_lshlrev_b32_sdwa v102, 3, v143 dst_sel:DWORD dst_unused:UNUSED_PAD src0_sel:DWORD src1_sel:WORD_1
    ds_read_b64 v[100:101], v100
    ds_read_b64 v[102:103], v102
    buffer_load_dwordx4 v[140:143], v71, s[12:15], s20 offen offset:3072 sc1
    s_waitcnt lgkmcnt(8)
    v_smfmac_f32_16x16x64_bf16 v[50:53], v[66:69], v[104:111], v70
    s_nop 0
    v_cvt_pk_bf16_f32 v112, v112, v113
    v_cvt_pk_bf16_f32 v113, v114, v115
    v_lshlrev_b32_sdwa v114, 3, v70 dst_sel:DWORD dst_unused:UNUSED_PAD src0_sel:DWORD src1_sel:WORD_1
    ds_write_b64 v114, v[112:113] offset:512
    s_waitcnt vmcnt(7)
    v_lshlrev_b32_sdwa v104, 3, v116 dst_sel:DWORD dst_unused:UNUSED_PAD src0_sel:DWORD src1_sel:WORD_0
    v_lshlrev_b32_sdwa v106, 3, v116 dst_sel:DWORD dst_unused:UNUSED_PAD src0_sel:DWORD src1_sel:WORD_1
    ds_read_b64 v[104:105], v104
    ds_read_b64 v[106:107], v106
    v_lshlrev_b32_sdwa v108, 3, v117 dst_sel:DWORD dst_unused:UNUSED_PAD src0_sel:DWORD src1_sel:WORD_0
    v_lshlrev_b32_sdwa v110, 3, v117 dst_sel:DWORD dst_unused:UNUSED_PAD src0_sel:DWORD src1_sel:WORD_1
    v_cvt_pk_bf16_f32 v53, v52, v53
    v_cvt_pk_bf16_f32 v52, v50, v51
    v_and_b32 v51, s23, v49
    v_lshlrev_b32 v50, 16, v49
    v_and_b32 v49, s23, v48
    v_lshlrev_b32 v48, 16, v48
    ds_read_b64 v[108:109], v108
    ds_read_b64 v[110:111], v110
    s_waitcnt lgkmcnt(9)
    v_smfmac_f32_16x16x64_bf16 v[48:51], v[66:69], v[88:95], v70
    v_mfma_f32_16x16x32_bf16 v[112:115], v[72:75], v[208:211], 0
    v_lshlrev_b32_sdwa v88, 3, v118 dst_sel:DWORD dst_unused:UNUSED_PAD src0_sel:DWORD src1_sel:WORD_0
    v_lshlrev_b32_sdwa v90, 3, v118 dst_sel:DWORD dst_unused:UNUSED_PAD src0_sel:DWORD src1_sel:WORD_1
    ds_read_b64 v[88:89], v88
    ds_read_b64 v[90:91], v90
    v_mfma_f32_16x16x32_bf16 v[112:115], v[76:79], v[212:215], v[112:115]
    v_lshlrev_b32_sdwa v92, 3, v119 dst_sel:DWORD dst_unused:UNUSED_PAD src0_sel:DWORD src1_sel:WORD_0
    v_lshlrev_b32_sdwa v94, 3, v119 dst_sel:DWORD dst_unused:UNUSED_PAD src0_sel:DWORD src1_sel:WORD_1
    ds_read_b64 v[92:93], v92
    ds_read_b64 v[94:95], v94
    s_add_u32 s20, s20, 0x1000
    buffer_load_dwordx4 v[116:119], v71, s[12:15], s20 offen offset:0 sc1
    s_waitcnt lgkmcnt(9)
    v_smfmac_f32_16x16x64_bf16 v[48:51], v[66:69], v[96:103], v70
    s_setprio 2
    v_mfma_f32_16x16x32_bf16 v[112:115], v[80:83], v[216:219], v[112:115]
    s_waitcnt vmcnt(7)
    v_lshlrev_b32_sdwa v96, 3, v120 dst_sel:DWORD dst_unused:UNUSED_PAD src0_sel:DWORD src1_sel:WORD_0
    v_lshlrev_b32_sdwa v98, 3, v120 dst_sel:DWORD dst_unused:UNUSED_PAD src0_sel:DWORD src1_sel:WORD_1
    ds_read_b64 v[96:97], v96
    ds_read_b64 v[98:99], v98
    v_mfma_f32_16x16x32_bf16 v[112:115], v[84:87], v[220:223], v[112:115]
    v_lshlrev_b32_sdwa v100, 3, v121 dst_sel:DWORD dst_unused:UNUSED_PAD src0_sel:DWORD src1_sel:WORD_0
    v_lshlrev_b32_sdwa v102, 3, v121 dst_sel:DWORD dst_unused:UNUSED_PAD src0_sel:DWORD src1_sel:WORD_1
    v_cvt_pk_bf16_f32 v51, v50, v51
    v_cvt_pk_bf16_f32 v50, v48, v49
    v_and_b32 v49, s23, v47
    v_lshlrev_b32 v48, 16, v47
    v_and_b32 v47, s23, v46
    v_lshlrev_b32 v46, 16, v46
    ds_read_b64 v[100:101], v100
    ds_read_b64 v[102:103], v102
    buffer_store_dwordx4 v[54:57], v71, s[12:15], s16 offen offset:2048 sc1
    s_waitcnt lgkmcnt(8)
    v_smfmac_f32_16x16x64_bf16 v[46:49], v[66:69], v[104:111], v70
    v_cvt_pk_bf16_f32 v112, v112, v113
    v_cvt_pk_bf16_f32 v113, v114, v115
    v_lshlrev_b32_sdwa v114, 3, v70 dst_sel:DWORD dst_unused:UNUSED_PAD src0_sel:DWORD src1_sel:WORD_1
    ds_write_b64 v114, v[112:113] offset:640
    v_lshlrev_b32_sdwa v104, 3, v122 dst_sel:DWORD dst_unused:UNUSED_PAD src0_sel:DWORD src1_sel:WORD_0
    v_lshlrev_b32_sdwa v106, 3, v122 dst_sel:DWORD dst_unused:UNUSED_PAD src0_sel:DWORD src1_sel:WORD_1
    ds_read_b64 v[104:105], v104
    ds_read_b64 v[106:107], v106
    v_lshlrev_b32_sdwa v108, 3, v123 dst_sel:DWORD dst_unused:UNUSED_PAD src0_sel:DWORD src1_sel:WORD_0
    v_lshlrev_b32_sdwa v110, 3, v123 dst_sel:DWORD dst_unused:UNUSED_PAD src0_sel:DWORD src1_sel:WORD_1
    ds_read_b64 v[108:109], v108
    ds_read_b64 v[110:111], v110
    s_add_u32 s20, s20, 0xfffe0400
    buffer_load_dwordx4 v[120:123], v71, s[12:15], s20 offen offset:0 sc1
    s_waitcnt lgkmcnt(9)
    v_smfmac_f32_16x16x64_bf16 v[46:49], v[66:69], v[88:95], v70
    v_mfma_f32_16x16x32_bf16 v[112:115], v[72:75], v[224:227], 0
    s_waitcnt vmcnt(8)
    v_lshlrev_b32_sdwa v88, 3, v124 dst_sel:DWORD dst_unused:UNUSED_PAD src0_sel:DWORD src1_sel:WORD_0
    v_lshlrev_b32_sdwa v90, 3, v124 dst_sel:DWORD dst_unused:UNUSED_PAD src0_sel:DWORD src1_sel:WORD_1
    ds_read_b64 v[88:89], v88
    ds_read_b64 v[90:91], v90
    v_mfma_f32_16x16x32_bf16 v[112:115], v[76:79], v[228:231], v[112:115]
    v_lshlrev_b32_sdwa v92, 3, v125 dst_sel:DWORD dst_unused:UNUSED_PAD src0_sel:DWORD src1_sel:WORD_0
    v_lshlrev_b32_sdwa v94, 3, v125 dst_sel:DWORD dst_unused:UNUSED_PAD src0_sel:DWORD src1_sel:WORD_1
    v_cvt_pk_bf16_f32 v49, v48, v49
    v_cvt_pk_bf16_f32 v48, v46, v47
    v_and_b32 v47, s23, v45
    v_lshlrev_b32 v46, 16, v45
    v_and_b32 v45, s23, v44
    v_lshlrev_b32 v44, 16, v44
    ds_read_b64 v[92:93], v92
    ds_read_b64 v[94:95], v94
    s_waitcnt lgkmcnt(9)
    v_smfmac_f32_16x16x64_bf16 v[44:47], v[66:69], v[96:103], v70
    v_mfma_f32_16x16x32_bf16 v[112:115], v[80:83], v[232:235], v[112:115]
    v_lshlrev_b32_sdwa v96, 3, v126 dst_sel:DWORD dst_unused:UNUSED_PAD src0_sel:DWORD src1_sel:WORD_0
    v_lshlrev_b32_sdwa v98, 3, v126 dst_sel:DWORD dst_unused:UNUSED_PAD src0_sel:DWORD src1_sel:WORD_1
    ds_read_b64 v[96:97], v96
    ds_read_b64 v[98:99], v98
    v_mfma_f32_16x16x32_bf16 v[112:115], v[84:87], v[236:239], v[112:115]
    v_lshlrev_b32_sdwa v100, 3, v127 dst_sel:DWORD dst_unused:UNUSED_PAD src0_sel:DWORD src1_sel:WORD_0
    v_lshlrev_b32_sdwa v102, 3, v127 dst_sel:DWORD dst_unused:UNUSED_PAD src0_sel:DWORD src1_sel:WORD_1
    ds_read_b64 v[100:101], v100
    ds_read_b64 v[102:103], v102
    s_add_u32 s20, s20, 0x40000
    buffer_load_dwordx4 v[124:127], v71, s[12:15], s20 offen offset:0 sc1
    s_waitcnt lgkmcnt(8)
    v_smfmac_f32_16x16x64_bf16 v[44:47], v[66:69], v[104:111], v70
    v_cvt_pk_bf16_f32 v112, v112, v113
    v_cvt_pk_bf16_f32 v113, v114, v115
    v_lshlrev_b32_sdwa v114, 3, v70 dst_sel:DWORD dst_unused:UNUSED_PAD src0_sel:DWORD src1_sel:WORD_1
    ds_write_b64 v114, v[112:113] offset:768
    s_waitcnt vmcnt(8)
    v_lshlrev_b32_sdwa v104, 3, v128 dst_sel:DWORD dst_unused:UNUSED_PAD src0_sel:DWORD src1_sel:WORD_0
    v_lshlrev_b32_sdwa v106, 3, v128 dst_sel:DWORD dst_unused:UNUSED_PAD src0_sel:DWORD src1_sel:WORD_1
    ds_read_b64 v[104:105], v104
    ds_read_b64 v[106:107], v106
    v_lshlrev_b32_sdwa v108, 3, v129 dst_sel:DWORD dst_unused:UNUSED_PAD src0_sel:DWORD src1_sel:WORD_0
    v_lshlrev_b32_sdwa v110, 3, v129 dst_sel:DWORD dst_unused:UNUSED_PAD src0_sel:DWORD src1_sel:WORD_1
    v_cvt_pk_bf16_f32 v47, v46, v47
    v_cvt_pk_bf16_f32 v46, v44, v45
    v_and_b32 v45, s23, v43
    v_lshlrev_b32 v44, 16, v43
    v_and_b32 v43, s23, v42
    v_lshlrev_b32 v42, 16, v42
    ds_read_b64 v[108:109], v108
    ds_read_b64 v[110:111], v110
    s_waitcnt lgkmcnt(9)
    v_smfmac_f32_16x16x64_bf16 v[42:45], v[66:69], v[88:95], v70
    v_mfma_f32_16x16x32_bf16 v[112:115], v[72:75], v[240:243], 0
    v_lshlrev_b32_sdwa v88, 3, v130 dst_sel:DWORD dst_unused:UNUSED_PAD src0_sel:DWORD src1_sel:WORD_0
    v_lshlrev_b32_sdwa v90, 3, v130 dst_sel:DWORD dst_unused:UNUSED_PAD src0_sel:DWORD src1_sel:WORD_1
    ds_read_b64 v[88:89], v88
    ds_read_b64 v[90:91], v90
    v_mfma_f32_16x16x32_bf16 v[112:115], v[76:79], v[244:247], v[112:115]
    v_lshlrev_b32_sdwa v92, 3, v131 dst_sel:DWORD dst_unused:UNUSED_PAD src0_sel:DWORD src1_sel:WORD_0
    v_lshlrev_b32_sdwa v94, 3, v131 dst_sel:DWORD dst_unused:UNUSED_PAD src0_sel:DWORD src1_sel:WORD_1
    ds_read_b64 v[92:93], v92
    ds_read_b64 v[94:95], v94
    s_add_u32 s20, s20, 0xfffc0400
    buffer_load_dwordx4 v[128:131], v71, s[12:15], s20 offen offset:0 sc1
    s_waitcnt lgkmcnt(9)
    v_smfmac_f32_16x16x64_bf16 v[42:45], v[66:69], v[96:103], v70
    v_mfma_f32_16x16x32_bf16 v[112:115], v[80:83], v[248:251], v[112:115]
    s_waitcnt vmcnt(8)
    v_lshlrev_b32_sdwa v96, 3, v132 dst_sel:DWORD dst_unused:UNUSED_PAD src0_sel:DWORD src1_sel:WORD_0
    v_lshlrev_b32_sdwa v98, 3, v132 dst_sel:DWORD dst_unused:UNUSED_PAD src0_sel:DWORD src1_sel:WORD_1
    ds_read_b64 v[96:97], v96
    ds_read_b64 v[98:99], v98
    v_mfma_f32_16x16x32_bf16 v[112:115], v[84:87], v[252:255], v[112:115]
    v_lshlrev_b32_sdwa v100, 3, v133 dst_sel:DWORD dst_unused:UNUSED_PAD src0_sel:DWORD src1_sel:WORD_0
    v_lshlrev_b32_sdwa v102, 3, v133 dst_sel:DWORD dst_unused:UNUSED_PAD src0_sel:DWORD src1_sel:WORD_1
    v_cvt_pk_bf16_f32 v45, v44, v45
    v_cvt_pk_bf16_f32 v44, v42, v43
    v_and_b32 v43, s23, v41
    v_lshlrev_b32 v42, 16, v41
    v_and_b32 v41, s23, v40
    v_lshlrev_b32 v40, 16, v40
    ds_read_b64 v[100:101], v100
    ds_read_b64 v[102:103], v102
    buffer_store_dwordx4 v[50:53], v71, s[12:15], s16 offen offset:3072 sc1
    s_waitcnt lgkmcnt(8)
    v_smfmac_f32_16x16x64_bf16 v[40:43], v[66:69], v[104:111], v70
    v_cvt_pk_bf16_f32 v112, v112, v113
    v_cvt_pk_bf16_f32 v113, v114, v115
    v_lshlrev_b32_sdwa v114, 3, v70 dst_sel:DWORD dst_unused:UNUSED_PAD src0_sel:DWORD src1_sel:WORD_1
    ds_write_b64 v114, v[112:113] offset:896
    v_mov_b32 v144, 0xbdd2d3e8
    v_mov_b32 v145, 0xbdd2d3e8
    v_mov_b32 v146, 0xc0135761
    v_mov_b32 v147, 0xc0135761
    v_bfe_u32 v148, v71, 4, 2
    v_mov_b32 v154, 0x3f80
    v_lshlrev_b32 v148, 4, v148
    v_lshlrev_b32_sdwa v104, 3, v134 dst_sel:DWORD dst_unused:UNUSED_PAD src0_sel:DWORD src1_sel:WORD_0
    v_lshlrev_b32_sdwa v106, 3, v134 dst_sel:DWORD dst_unused:UNUSED_PAD src0_sel:DWORD src1_sel:WORD_1
    ds_read_b64 v[104:105], v104
    ds_read_b64 v[106:107], v106
    v_lshlrev_b32_sdwa v108, 3, v135 dst_sel:DWORD dst_unused:UNUSED_PAD src0_sel:DWORD src1_sel:WORD_0
    v_lshlrev_b32_sdwa v110, 3, v135 dst_sel:DWORD dst_unused:UNUSED_PAD src0_sel:DWORD src1_sel:WORD_1
    ds_read_b64 v[108:109], v108
    ds_read_b64 v[110:111], v110
    s_add_u32 s20, s20, 0x40000
    buffer_load_dwordx4 v[132:135], v71, s[12:15], s20 offen offset:0 sc1
    s_waitcnt lgkmcnt(9)
    v_smfmac_f32_16x16x64_bf16 v[40:43], v[66:69], v[88:95], v70
    s_setprio 1
    v_mov_b32 v155, 0
    v_lshlrev_b64 v[154:155], v148, v[154:155]
    v_mov_b32 v150, s28
    v_mov_b32 v151, s29
    v_mov_b32 v152, s30
    v_mov_b32 v153, s31
    v_rcp_f32 v150, v150
    s_waitcnt vmcnt(8)
    v_lshlrev_b32_sdwa v88, 3, v136 dst_sel:DWORD dst_unused:UNUSED_PAD src0_sel:DWORD src1_sel:WORD_0
    v_lshlrev_b32_sdwa v90, 3, v136 dst_sel:DWORD dst_unused:UNUSED_PAD src0_sel:DWORD src1_sel:WORD_1
    ds_read_b64 v[88:89], v88
    ds_read_b64 v[90:91], v90
    v_lshlrev_b32_sdwa v92, 3, v137 dst_sel:DWORD dst_unused:UNUSED_PAD src0_sel:DWORD src1_sel:WORD_0
    v_lshlrev_b32_sdwa v94, 3, v137 dst_sel:DWORD dst_unused:UNUSED_PAD src0_sel:DWORD src1_sel:WORD_1
    v_cvt_pk_bf16_f32 v43, v42, v43
    v_cvt_pk_bf16_f32 v42, v40, v41
    v_and_b32 v41, s23, v39
    v_lshlrev_b32 v40, 16, v39
    v_and_b32 v39, s23, v38
    v_lshlrev_b32 v38, 16, v38
    ds_read_b64 v[92:93], v92
    ds_read_b64 v[94:95], v94
    v_mov_b32 v84, 1
    s_mov_b64 exec, 1
    buffer_store_dword v84, off, s[12:15], s46 sc1
    s_mov_b64 exec, -1
    s_waitcnt lgkmcnt(9)
    v_smfmac_f32_16x16x64_bf16 v[38:41], v[66:69], v[96:103], v70
    v_rcp_f32 v151, v151
    v_rcp_f32 v152, v152
    v_rcp_f32 v153, v153
    v_mov_b32 v148, 0x7f7fffff
    v_mov_b32 v149, 0xff7fffff
    v_med3_f32 v150, v150, v148, v149
    v_med3_f32 v151, v151, v148, v149
    v_lshlrev_b32_sdwa v96, 3, v138 dst_sel:DWORD dst_unused:UNUSED_PAD src0_sel:DWORD src1_sel:WORD_0
    v_lshlrev_b32_sdwa v98, 3, v138 dst_sel:DWORD dst_unused:UNUSED_PAD src0_sel:DWORD src1_sel:WORD_1
    ds_read_b64 v[96:97], v96
    ds_read_b64 v[98:99], v98
    v_lshlrev_b32_sdwa v100, 3, v139 dst_sel:DWORD dst_unused:UNUSED_PAD src0_sel:DWORD src1_sel:WORD_0
    v_lshlrev_b32_sdwa v102, 3, v139 dst_sel:DWORD dst_unused:UNUSED_PAD src0_sel:DWORD src1_sel:WORD_1
    ds_read_b64 v[100:101], v100
    ds_read_b64 v[102:103], v102
    s_add_u32 s20, s20, 0xfffbf800
    buffer_load_dwordx4 v[136:139], v71, s[12:15], s20 offen offset:3072 sc1
    s_waitcnt lgkmcnt(8)
    v_smfmac_f32_16x16x64_bf16 v[38:41], v[66:69], v[104:111], v70
    v_med3_f32 v152, v152, v148, v149
    v_med3_f32 v153, v153, v148, v149
    v_mov_b32 v73, 0
    v_lshrrev_b32 v76, 2, v71
    v_mov_b32 v79, 0
    v_and_b32 v75, 0xf0, v71
    v_lshrrev_b32 v80, 8, v71
    s_waitcnt vmcnt(9)
    v_lshlrev_b32_sdwa v104, 3, v140 dst_sel:DWORD dst_unused:UNUSED_PAD src0_sel:DWORD src1_sel:WORD_0
    v_lshlrev_b32_sdwa v106, 3, v140 dst_sel:DWORD dst_unused:UNUSED_PAD src0_sel:DWORD src1_sel:WORD_1
    ds_read_b64 v[104:105], v104
    ds_read_b64 v[106:107], v106
    v_lshlrev_b32_sdwa v108, 3, v141 dst_sel:DWORD dst_unused:UNUSED_PAD src0_sel:DWORD src1_sel:WORD_0
    v_lshlrev_b32_sdwa v110, 3, v141 dst_sel:DWORD dst_unused:UNUSED_PAD src0_sel:DWORD src1_sel:WORD_1
    v_cvt_pk_bf16_f32 v41, v40, v41
    v_cvt_pk_bf16_f32 v40, v38, v39
    v_and_b32 v39, s23, v37
    v_lshlrev_b32 v38, 16, v37
    v_and_b32 v37, s23, v36
    v_lshlrev_b32 v36, 16, v36
    ds_read_b64 v[108:109], v108
    ds_read_b64 v[110:111], v110
    s_waitcnt lgkmcnt(8)
    v_smfmac_f32_16x16x64_bf16 v[36:39], v[66:69], v[88:95], v70
    v_lshl_add_u32 v74, v80, 16, v75
    v_lshl_add_u32 v75, v80, 2, v75
    v_lshrrev_b32 v77, 9, v71
    v_mul_u32_u24 v77, 8064, v77
    v_add3_u32 v77, v77, v76, s67
    v_lshrrev_b32 v78, 1, v75
    v_lshlrev_b32_sdwa v88, 3, v142 dst_sel:DWORD dst_unused:UNUSED_PAD src0_sel:DWORD src1_sel:WORD_0
    v_lshlrev_b32_sdwa v90, 3, v142 dst_sel:DWORD dst_unused:UNUSED_PAD src0_sel:DWORD src1_sel:WORD_1
    ds_read_b64 v[88:89], v88
    ds_read_b64 v[90:91], v90
    v_lshlrev_b32_sdwa v92, 3, v143 dst_sel:DWORD dst_unused:UNUSED_PAD src0_sel:DWORD src1_sel:WORD_0
    v_lshlrev_b32_sdwa v94, 3, v143 dst_sel:DWORD dst_unused:UNUSED_PAD src0_sel:DWORD src1_sel:WORD_1
    ds_read_b64 v[92:93], v92
    ds_read_b64 v[94:95], v94
    s_add_u32 s20, s20, 0x40000
    buffer_load_dwordx4 v[140:143], v71, s[12:15], s20 offen offset:3072 sc1
    s_waitcnt lgkmcnt(8)
    v_smfmac_f32_16x16x64_bf16 v[36:39], v[66:69], v[96:103], v70
    s_waitcnt vmcnt(9)
    v_lshlrev_b32_sdwa v96, 3, v116 dst_sel:DWORD dst_unused:UNUSED_PAD src0_sel:DWORD src1_sel:WORD_0
    v_lshlrev_b32_sdwa v98, 3, v116 dst_sel:DWORD dst_unused:UNUSED_PAD src0_sel:DWORD src1_sel:WORD_1
    ds_read_b64 v[96:97], v96
    ds_read_b64 v[98:99], v98
    v_lshlrev_b32_sdwa v100, 3, v117 dst_sel:DWORD dst_unused:UNUSED_PAD src0_sel:DWORD src1_sel:WORD_0
    v_lshlrev_b32_sdwa v102, 3, v117 dst_sel:DWORD dst_unused:UNUSED_PAD src0_sel:DWORD src1_sel:WORD_1
    s_nop 0
    v_cvt_pk_bf16_f32 v39, v38, v39
    v_cvt_pk_bf16_f32 v38, v36, v37
    v_and_b32 v37, s23, v35
    v_lshlrev_b32 v36, 16, v35
    v_and_b32 v35, s23, v34
    v_lshlrev_b32 v34, 16, v34
    ds_read_b64 v[100:101], v100
    ds_read_b64 v[102:103], v102
    buffer_store_dwordx4 v[46:49], v71, s[12:15], s17 offen offset:0 sc1
    s_waitcnt lgkmcnt(8)
    v_smfmac_f32_16x16x64_bf16 v[34:37], v[66:69], v[104:111], v70
    v_lshlrev_b32_sdwa v104, 3, v118 dst_sel:DWORD dst_unused:UNUSED_PAD src0_sel:DWORD src1_sel:WORD_0
    v_lshlrev_b32_sdwa v106, 3, v118 dst_sel:DWORD dst_unused:UNUSED_PAD src0_sel:DWORD src1_sel:WORD_1
    ds_read_b64 v[104:105], v104
    ds_read_b64 v[106:107], v106
    v_lshlrev_b32_sdwa v108, 3, v119 dst_sel:DWORD dst_unused:UNUSED_PAD src0_sel:DWORD src1_sel:WORD_0
    v_lshlrev_b32_sdwa v110, 3, v119 dst_sel:DWORD dst_unused:UNUSED_PAD src0_sel:DWORD src1_sel:WORD_1
    ds_read_b64 v[108:109], v108
    ds_read_b64 v[110:111], v110
    s_add_u32 s20, s20, 0xfffbd000
    buffer_load_dwordx4 v[116:119], v71, s[12:15], s20 offen offset:0 sc1
    s_waitcnt lgkmcnt(8)
    v_smfmac_f32_16x16x64_bf16 v[34:37], v[66:69], v[88:95], v70
    s_setprio 0
    s_waitcnt vmcnt(9)
    v_lshlrev_b32_sdwa v88, 3, v120 dst_sel:DWORD dst_unused:UNUSED_PAD src0_sel:DWORD src1_sel:WORD_0
    v_lshlrev_b32_sdwa v90, 3, v120 dst_sel:DWORD dst_unused:UNUSED_PAD src0_sel:DWORD src1_sel:WORD_1
    ds_read_b64 v[88:89], v88
    ds_read_b64 v[90:91], v90
    v_lshlrev_b32_sdwa v92, 3, v121 dst_sel:DWORD dst_unused:UNUSED_PAD src0_sel:DWORD src1_sel:WORD_0
    v_lshlrev_b32_sdwa v94, 3, v121 dst_sel:DWORD dst_unused:UNUSED_PAD src0_sel:DWORD src1_sel:WORD_1
    v_cvt_pk_bf16_f32 v37, v36, v37
    v_cvt_pk_bf16_f32 v36, v34, v35
    v_and_b32 v35, s23, v33
    v_lshlrev_b32 v34, 16, v33
    v_and_b32 v33, s23, v32
    v_lshlrev_b32 v32, 16, v32
    ds_read_b64 v[92:93], v92
    ds_read_b64 v[94:95], v94
    s_waitcnt lgkmcnt(8)
    v_smfmac_f32_16x16x64_bf16 v[32:35], v[66:69], v[96:103], v70
    v_lshlrev_b32_sdwa v96, 3, v122 dst_sel:DWORD dst_unused:UNUSED_PAD src0_sel:DWORD src1_sel:WORD_0
    v_lshlrev_b32_sdwa v98, 3, v122 dst_sel:DWORD dst_unused:UNUSED_PAD src0_sel:DWORD src1_sel:WORD_1
    ds_read_b64 v[96:97], v96
    ds_read_b64 v[98:99], v98
    v_lshlrev_b32_sdwa v100, 3, v123 dst_sel:DWORD dst_unused:UNUSED_PAD src0_sel:DWORD src1_sel:WORD_0
    v_lshlrev_b32_sdwa v102, 3, v123 dst_sel:DWORD dst_unused:UNUSED_PAD src0_sel:DWORD src1_sel:WORD_1
    ds_read_b64 v[100:101], v100
    ds_read_b64 v[102:103], v102
    s_add_u32 s20, s20, 0x40000
    buffer_load_dwordx4 v[120:123], v71, s[12:15], s20 offen offset:0 sc1
    s_waitcnt lgkmcnt(8)
    v_smfmac_f32_16x16x64_bf16 v[32:35], v[66:69], v[104:111], v70
    s_barrier
    s_setprio 3
    s_waitcnt vmcnt(9)
    v_lshlrev_b32_sdwa v104, 3, v124 dst_sel:DWORD dst_unused:UNUSED_PAD src0_sel:DWORD src1_sel:WORD_0
    v_lshlrev_b32_sdwa v106, 3, v124 dst_sel:DWORD dst_unused:UNUSED_PAD src0_sel:DWORD src1_sel:WORD_1
    ds_read_b64 v[104:105], v104
    ds_read_b64 v[106:107], v106
    v_lshlrev_b32_sdwa v108, 3, v125 dst_sel:DWORD dst_unused:UNUSED_PAD src0_sel:DWORD src1_sel:WORD_0
    v_lshlrev_b32_sdwa v110, 3, v125 dst_sel:DWORD dst_unused:UNUSED_PAD src0_sel:DWORD src1_sel:WORD_1
    v_cvt_pk_bf16_f32 v35, v34, v35
    v_cvt_pk_bf16_f32 v34, v32, v33
    v_lshlrev_b32 v192, 16, v2
    v_and_b32 v193, s23, v2
    v_lshlrev_b32 v194, 16, v3
    v_and_b32 v195, s23, v3
    ds_read_b64 v[108:109], v108
    ds_read_b64 v[110:111], v110
    s_mov_b64 exec, 1
    buffer_load_dword v85, off, s[12:15], s47 sc1
    s_mov_b64 exec, -1
    s_waitcnt lgkmcnt(8)
    v_smfmac_f32_16x16x64_bf16 v[192:195], v[66:69], v[88:95], v70
    v_lshlrev_b32_sdwa v88, 3, v126 dst_sel:DWORD dst_unused:UNUSED_PAD src0_sel:DWORD src1_sel:WORD_0
    v_lshlrev_b32_sdwa v90, 3, v126 dst_sel:DWORD dst_unused:UNUSED_PAD src0_sel:DWORD src1_sel:WORD_1
    ds_read_b64 v[88:89], v88
    ds_read_b64 v[90:91], v90
    v_lshlrev_b32_sdwa v92, 3, v127 dst_sel:DWORD dst_unused:UNUSED_PAD src0_sel:DWORD src1_sel:WORD_0
    v_lshlrev_b32_sdwa v94, 3, v127 dst_sel:DWORD dst_unused:UNUSED_PAD src0_sel:DWORD src1_sel:WORD_1
    ds_read_b64 v[92:93], v92
    ds_read_b64 v[94:95], v94
    s_add_u32 s20, s20, 0xfffc0400
    buffer_load_dwordx4 v[124:127], v71, s[12:15], s20 offen offset:0 sc1
    s_waitcnt lgkmcnt(8)
    v_smfmac_f32_16x16x64_bf16 v[192:195], v[66:69], v[96:103], v70
    s_waitcnt vmcnt(10)
    v_lshlrev_b32_sdwa v96, 3, v128 dst_sel:DWORD dst_unused:UNUSED_PAD src0_sel:DWORD src1_sel:WORD_0
    v_lshlrev_b32_sdwa v98, 3, v128 dst_sel:DWORD dst_unused:UNUSED_PAD src0_sel:DWORD src1_sel:WORD_1
    ds_read_b64 v[96:97], v96
    ds_read_b64 v[98:99], v98
    v_lshlrev_b32_sdwa v100, 3, v129 dst_sel:DWORD dst_unused:UNUSED_PAD src0_sel:DWORD src1_sel:WORD_0
    v_lshlrev_b32_sdwa v102, 3, v129 dst_sel:DWORD dst_unused:UNUSED_PAD src0_sel:DWORD src1_sel:WORD_1
    ds_read_b64 v[100:101], v100
    ds_read_b64 v[102:103], v102
    buffer_store_dwordx4 v[42:45], v71, s[12:15], s17 offen offset:1024 sc1
    s_waitcnt lgkmcnt(8)
    v_smfmac_f32_16x16x64_bf16 v[192:195], v[66:69], v[104:111], v70
    v_lshlrev_b32_sdwa v104, 3, v130 dst_sel:DWORD dst_unused:UNUSED_PAD src0_sel:DWORD src1_sel:WORD_0
    v_lshlrev_b32_sdwa v106, 3, v130 dst_sel:DWORD dst_unused:UNUSED_PAD src0_sel:DWORD src1_sel:WORD_1
    ds_read_b64 v[104:105], v104
    ds_read_b64 v[106:107], v106
    v_lshlrev_b32_sdwa v108, 3, v131 dst_sel:DWORD dst_unused:UNUSED_PAD src0_sel:DWORD src1_sel:WORD_0
    v_lshlrev_b32_sdwa v110, 3, v131 dst_sel:DWORD dst_unused:UNUSED_PAD src0_sel:DWORD src1_sel:WORD_1
    ds_read_b64 v[108:109], v108
    ds_read_b64 v[110:111], v110
    s_add_u32 s20, s20, 0x40000
    buffer_load_dwordx4 v[128:131], v71, s[12:15], s20 offen offset:0 sc1
    s_waitcnt lgkmcnt(8)
    v_smfmac_f32_16x16x64_bf16 v[192:195], v[66:69], v[88:95], v70
    s_waitcnt vmcnt(10)
    v_lshlrev_b32_sdwa v88, 3, v132 dst_sel:DWORD dst_unused:UNUSED_PAD src0_sel:DWORD src1_sel:WORD_0
    v_lshlrev_b32_sdwa v90, 3, v132 dst_sel:DWORD dst_unused:UNUSED_PAD src0_sel:DWORD src1_sel:WORD_1
    ds_read_b64 v[88:89], v88
    ds_read_b64 v[90:91], v90
    v_lshlrev_b32_sdwa v92, 3, v133 dst_sel:DWORD dst_unused:UNUSED_PAD src0_sel:DWORD src1_sel:WORD_0
    v_lshlrev_b32_sdwa v94, 3, v133 dst_sel:DWORD dst_unused:UNUSED_PAD src0_sel:DWORD src1_sel:WORD_1
    v_lshlrev_b32 v196, 16, v4
    v_and_b32 v197, s23, v4
    v_lshlrev_b32 v198, 16, v5
    v_and_b32 v199, s23, v5
    ds_read_b64 v[92:93], v92
    ds_read_b64 v[94:95], v94
    v_mov_b32 v84, 2
    s_mov_b64 exec, 1
    buffer_store_dword v84, off, s[12:15], s46 sc1
    s_mov_b64 exec, -1
    s_waitcnt lgkmcnt(8)
    v_smfmac_f32_16x16x64_bf16 v[196:199], v[66:69], v[96:103], v70
    v_lshlrev_b32_sdwa v96, 3, v134 dst_sel:DWORD dst_unused:UNUSED_PAD src0_sel:DWORD src1_sel:WORD_0
    v_lshlrev_b32_sdwa v98, 3, v134 dst_sel:DWORD dst_unused:UNUSED_PAD src0_sel:DWORD src1_sel:WORD_1
    ds_read_b64 v[96:97], v96
    ds_read_b64 v[98:99], v98
    v_lshlrev_b32_sdwa v100, 3, v135 dst_sel:DWORD dst_unused:UNUSED_PAD src0_sel:DWORD src1_sel:WORD_0
    v_lshlrev_b32_sdwa v102, 3, v135 dst_sel:DWORD dst_unused:UNUSED_PAD src0_sel:DWORD src1_sel:WORD_1
    ds_read_b64 v[100:101], v100
    ds_read_b64 v[102:103], v102
    s_add_u32 s20, s20, 0xfffc0400
    buffer_load_dwordx4 v[132:135], v71, s[12:15], s20 offen offset:0 sc1
    s_waitcnt lgkmcnt(8)
    v_smfmac_f32_16x16x64_bf16 v[196:199], v[66:69], v[104:111], v70
    s_waitcnt vmcnt(10)
    v_lshlrev_b32_sdwa v104, 3, v136 dst_sel:DWORD dst_unused:UNUSED_PAD src0_sel:DWORD src1_sel:WORD_0
    v_lshlrev_b32_sdwa v106, 3, v136 dst_sel:DWORD dst_unused:UNUSED_PAD src0_sel:DWORD src1_sel:WORD_1
    ds_read_b64 v[104:105], v104
    ds_read_b64 v[106:107], v106
    v_lshlrev_b32_sdwa v108, 3, v137 dst_sel:DWORD dst_unused:UNUSED_PAD src0_sel:DWORD src1_sel:WORD_0
    v_lshlrev_b32_sdwa v110, 3, v137 dst_sel:DWORD dst_unused:UNUSED_PAD src0_sel:DWORD src1_sel:WORD_1
    ds_read_b64 v[108:109], v108
    ds_read_b64 v[110:111], v110
    s_waitcnt lgkmcnt(8)
    v_smfmac_f32_16x16x64_bf16 v[196:199], v[66:69], v[88:95], v70
    v_lshlrev_b32_sdwa v88, 3, v138 dst_sel:DWORD dst_unused:UNUSED_PAD src0_sel:DWORD src1_sel:WORD_0
    v_lshlrev_b32_sdwa v90, 3, v138 dst_sel:DWORD dst_unused:UNUSED_PAD src0_sel:DWORD src1_sel:WORD_1
    ds_read_b64 v[88:89], v88
    ds_read_b64 v[90:91], v90
    v_lshlrev_b32_sdwa v92, 3, v139 dst_sel:DWORD dst_unused:UNUSED_PAD src0_sel:DWORD src1_sel:WORD_0
    v_lshlrev_b32_sdwa v94, 3, v139 dst_sel:DWORD dst_unused:UNUSED_PAD src0_sel:DWORD src1_sel:WORD_1
    ds_read_b64 v[92:93], v92
    ds_read_b64 v[94:95], v94
    s_add_u32 s20, s20, 0x40000
    buffer_load_dwordx4 v[136:139], v71, s[12:15], s20 offen offset:0 sc1
    s_waitcnt lgkmcnt(8)
    v_smfmac_f32_16x16x64_bf16 v[196:199], v[66:69], v[96:103], v70
    s_waitcnt vmcnt(10)
    v_lshlrev_b32_sdwa v96, 3, v140 dst_sel:DWORD dst_unused:UNUSED_PAD src0_sel:DWORD src1_sel:WORD_0
    v_lshlrev_b32_sdwa v98, 3, v140 dst_sel:DWORD dst_unused:UNUSED_PAD src0_sel:DWORD src1_sel:WORD_1
    ds_read_b64 v[96:97], v96
    ds_read_b64 v[98:99], v98
    v_lshlrev_b32_sdwa v100, 3, v141 dst_sel:DWORD dst_unused:UNUSED_PAD src0_sel:DWORD src1_sel:WORD_0
    v_lshlrev_b32_sdwa v102, 3, v141 dst_sel:DWORD dst_unused:UNUSED_PAD src0_sel:DWORD src1_sel:WORD_1
    v_lshlrev_b32 v200, 16, v6
    v_and_b32 v201, s23, v6
    v_lshlrev_b32 v202, 16, v7
    v_and_b32 v203, s23, v7
    ds_read_b64 v[100:101], v100
    ds_read_b64 v[102:103], v102
    s_waitcnt vmcnt(6)
    v_readfirstlane_b32 s44, v85
    s_cmp_le_u32 s44, 0
    s_cbranch_scc1 k1_kernel_xw0
k1_kernel_xb0:
    buffer_load_dwordx4 v[62:65], v71, s[12:15], s18 offen offset:0 sc1
    buffer_load_dwordx4 v[58:61], v71, s[12:15], s18 offen offset:1024 sc1
    buffer_store_dwordx4 v[38:41], v71, s[12:15], s17 offen offset:2048 sc1
    s_waitcnt lgkmcnt(8)
    v_smfmac_f32_16x16x64_bf16 v[200:203], v[66:69], v[104:111], v70
    v_lshlrev_b32_sdwa v104, 3, v142 dst_sel:DWORD dst_unused:UNUSED_PAD src0_sel:DWORD src1_sel:WORD_0
    v_lshlrev_b32_sdwa v106, 3, v142 dst_sel:DWORD dst_unused:UNUSED_PAD src0_sel:DWORD src1_sel:WORD_1
    ds_read_b64 v[104:105], v104
    ds_read_b64 v[106:107], v106
    v_lshlrev_b32_sdwa v108, 3, v143 dst_sel:DWORD dst_unused:UNUSED_PAD src0_sel:DWORD src1_sel:WORD_0
    v_lshlrev_b32_sdwa v110, 3, v143 dst_sel:DWORD dst_unused:UNUSED_PAD src0_sel:DWORD src1_sel:WORD_1
    ds_read_b64 v[108:109], v108
    ds_read_b64 v[110:111], v110
    s_add_u32 s20, s20, 0xfffc0400
    buffer_load_dwordx4 v[140:143], v71, s[12:15], s20 offen offset:0 sc1
    s_waitcnt lgkmcnt(8)
    v_smfmac_f32_16x16x64_bf16 v[200:203], v[66:69], v[88:95], v70
    v_lshlrev_b32_sdwa v88, 3, v116 dst_sel:DWORD dst_unused:UNUSED_PAD src0_sel:DWORD src1_sel:WORD_0
    v_lshlrev_b32_sdwa v90, 3, v116 dst_sel:DWORD dst_unused:UNUSED_PAD src0_sel:DWORD src1_sel:WORD_1
    ds_read_b64 v[88:89], v88
    ds_read_b64 v[90:91], v90
    v_lshlrev_b32_sdwa v92, 3, v117 dst_sel:DWORD dst_unused:UNUSED_PAD src0_sel:DWORD src1_sel:WORD_0
    v_lshlrev_b32_sdwa v94, 3, v117 dst_sel:DWORD dst_unused:UNUSED_PAD src0_sel:DWORD src1_sel:WORD_1
    ds_read_b64 v[92:93], v92
    ds_read_b64 v[94:95], v94
    s_waitcnt lgkmcnt(8)
    v_smfmac_f32_16x16x64_bf16 v[200:203], v[66:69], v[96:103], v70
    v_lshlrev_b32_sdwa v96, 3, v118 dst_sel:DWORD dst_unused:UNUSED_PAD src0_sel:DWORD src1_sel:WORD_0
    v_lshlrev_b32_sdwa v98, 3, v118 dst_sel:DWORD dst_unused:UNUSED_PAD src0_sel:DWORD src1_sel:WORD_1
    ds_read_b64 v[96:97], v96
    ds_read_b64 v[98:99], v98
    v_lshlrev_b32_sdwa v100, 3, v119 dst_sel:DWORD dst_unused:UNUSED_PAD src0_sel:DWORD src1_sel:WORD_0
    v_lshlrev_b32_sdwa v102, 3, v119 dst_sel:DWORD dst_unused:UNUSED_PAD src0_sel:DWORD src1_sel:WORD_1
    ds_read_b64 v[100:101], v100
    ds_read_b64 v[102:103], v102
    s_add_u32 s20, s20, 0x40000
    buffer_load_dwordx4 v[116:119], v71, s[12:15], s20 offen offset:0 sc1
    s_waitcnt lgkmcnt(8)
    v_smfmac_f32_16x16x64_bf16 v[200:203], v[66:69], v[104:111], v70
    v_lshlrev_b32_sdwa v104, 3, v120 dst_sel:DWORD dst_unused:UNUSED_PAD src0_sel:DWORD src1_sel:WORD_0
    v_lshlrev_b32_sdwa v106, 3, v120 dst_sel:DWORD dst_unused:UNUSED_PAD src0_sel:DWORD src1_sel:WORD_1
    ds_read_b64 v[104:105], v104
    ds_read_b64 v[106:107], v106
    v_lshlrev_b32_sdwa v108, 3, v121 dst_sel:DWORD dst_unused:UNUSED_PAD src0_sel:DWORD src1_sel:WORD_0
    v_lshlrev_b32_sdwa v110, 3, v121 dst_sel:DWORD dst_unused:UNUSED_PAD src0_sel:DWORD src1_sel:WORD_1
    v_lshlrev_b32 v204, 16, v8
    v_and_b32 v205, s23, v8
    v_lshlrev_b32 v206, 16, v9
    v_and_b32 v207, s23, v9
    ds_read_b64 v[108:109], v108
    ds_read_b64 v[110:111], v110
    s_mov_b64 exec, 1
    buffer_load_dword v85, off, s[12:15], s47 sc1
    s_mov_b64 exec, -1
    s_waitcnt lgkmcnt(8)
    v_smfmac_f32_16x16x64_bf16 v[204:207], v[66:69], v[88:95], v70
    v_lshlrev_b32_sdwa v88, 3, v122 dst_sel:DWORD dst_unused:UNUSED_PAD src0_sel:DWORD src1_sel:WORD_0
    v_lshlrev_b32_sdwa v90, 3, v122 dst_sel:DWORD dst_unused:UNUSED_PAD src0_sel:DWORD src1_sel:WORD_1
    ds_read_b64 v[88:89], v88
    ds_read_b64 v[90:91], v90
    v_lshlrev_b32_sdwa v92, 3, v123 dst_sel:DWORD dst_unused:UNUSED_PAD src0_sel:DWORD src1_sel:WORD_0
    v_lshlrev_b32_sdwa v94, 3, v123 dst_sel:DWORD dst_unused:UNUSED_PAD src0_sel:DWORD src1_sel:WORD_1
    ds_read_b64 v[92:93], v92
    ds_read_b64 v[94:95], v94
    s_add_u32 s20, s20, 0xfffc0400
    buffer_load_dwordx4 v[120:123], v71, s[12:15], s20 offen offset:0 sc1
    s_waitcnt lgkmcnt(8)
    v_smfmac_f32_16x16x64_bf16 v[204:207], v[66:69], v[96:103], v70
    s_waitcnt vmcnt(12)
    v_lshlrev_b32_sdwa v96, 3, v124 dst_sel:DWORD dst_unused:UNUSED_PAD src0_sel:DWORD src1_sel:WORD_0
    v_lshlrev_b32_sdwa v98, 3, v124 dst_sel:DWORD dst_unused:UNUSED_PAD src0_sel:DWORD src1_sel:WORD_1
    ds_read_b64 v[96:97], v96
    ds_read_b64 v[98:99], v98
    v_lshlrev_b32_sdwa v100, 3, v125 dst_sel:DWORD dst_unused:UNUSED_PAD src0_sel:DWORD src1_sel:WORD_0
    v_lshlrev_b32_sdwa v102, 3, v125 dst_sel:DWORD dst_unused:UNUSED_PAD src0_sel:DWORD src1_sel:WORD_1
    ds_read_b64 v[100:101], v100
    ds_read_b64 v[102:103], v102
    buffer_store_dwordx4 v[34:37], v71, s[12:15], s17 offen offset:3072 sc1
    s_cmp_eq_u32 s48, 1
    s_cbranch_scc1 k1_kernel_solo2
    s_waitcnt lgkmcnt(8)
    v_smfmac_f32_16x16x64_bf16 v[204:207], v[66:69], v[104:111], v70
    v_lshlrev_b32_sdwa v104, 3, v126 dst_sel:DWORD dst_unused:UNUSED_PAD src0_sel:DWORD src1_sel:WORD_0
    v_lshlrev_b32_sdwa v106, 3, v126 dst_sel:DWORD dst_unused:UNUSED_PAD src0_sel:DWORD src1_sel:WORD_1
    ds_read_b64 v[104:105], v104
    ds_read_b64 v[106:107], v106
    v_lshlrev_b32_sdwa v108, 3, v127 dst_sel:DWORD dst_unused:UNUSED_PAD src0_sel:DWORD src1_sel:WORD_0
    v_lshlrev_b32_sdwa v110, 3, v127 dst_sel:DWORD dst_unused:UNUSED_PAD src0_sel:DWORD src1_sel:WORD_1
    ds_read_b64 v[108:109], v108
    ds_read_b64 v[110:111], v110
    s_add_u32 s20, s20, 0x40000
    buffer_load_dwordx4 v[124:127], v71, s[12:15], s20 offen offset:0 sc1
    s_waitcnt lgkmcnt(8)
    v_smfmac_f32_16x16x64_bf16 v[204:207], v[66:69], v[88:95], v70
    s_waitcnt vmcnt(12)
    v_lshlrev_b32_sdwa v88, 3, v128 dst_sel:DWORD dst_unused:UNUSED_PAD src0_sel:DWORD src1_sel:WORD_0
    v_lshlrev_b32_sdwa v90, 3, v128 dst_sel:DWORD dst_unused:UNUSED_PAD src0_sel:DWORD src1_sel:WORD_1
    ds_read_b64 v[88:89], v88
    ds_read_b64 v[90:91], v90
    v_lshlrev_b32_sdwa v92, 3, v129 dst_sel:DWORD dst_unused:UNUSED_PAD src0_sel:DWORD src1_sel:WORD_0
    v_lshlrev_b32_sdwa v94, 3, v129 dst_sel:DWORD dst_unused:UNUSED_PAD src0_sel:DWORD src1_sel:WORD_1
    v_lshlrev_b32 v208, 16, v10
    v_and_b32 v209, s23, v10
    v_lshlrev_b32 v210, 16, v11
    v_and_b32 v211, s23, v11
    ds_read_b64 v[92:93], v92
    ds_read_b64 v[94:95], v94
    v_mov_b32 v84, 3
    s_mov_b64 exec, 1
    buffer_store_dword v84, off, s[12:15], s46 sc1
    s_mov_b64 exec, -1
    s_waitcnt lgkmcnt(8)
    v_smfmac_f32_16x16x64_bf16 v[208:211], v[66:69], v[96:103], v70
    v_lshlrev_b32_sdwa v96, 3, v130 dst_sel:DWORD dst_unused:UNUSED_PAD src0_sel:DWORD src1_sel:WORD_0
    v_lshlrev_b32_sdwa v98, 3, v130 dst_sel:DWORD dst_unused:UNUSED_PAD src0_sel:DWORD src1_sel:WORD_1
    ds_read_b64 v[96:97], v96
    ds_read_b64 v[98:99], v98
    v_lshlrev_b32_sdwa v100, 3, v131 dst_sel:DWORD dst_unused:UNUSED_PAD src0_sel:DWORD src1_sel:WORD_0
    v_lshlrev_b32_sdwa v102, 3, v131 dst_sel:DWORD dst_unused:UNUSED_PAD src0_sel:DWORD src1_sel:WORD_1
    ds_read_b64 v[100:101], v100
    ds_read_b64 v[102:103], v102
    s_add_u32 s20, s20, 0xfffc0400
    buffer_load_dwordx4 v[128:131], v71, s[12:15], s20 offen offset:0 sc1
    s_waitcnt lgkmcnt(8)
    v_smfmac_f32_16x16x64_bf16 v[208:211], v[66:69], v[104:111], v70
    s_waitcnt vmcnt(10)
    v_mfma_f32_4x4x4_16b_bf16 v[192:195], v[154:155], v[64:65], v[192:195]
    v_mfma_f32_4x4x4_16b_bf16 v[196:199], v[154:155], v[62:63], v[196:199]
    s_waitcnt vmcnt(9)
    v_mfma_f32_4x4x4_16b_bf16 v[200:203], v[154:155], v[60:61], v[200:203]
    v_mfma_f32_4x4x4_16b_bf16 v[204:207], v[154:155], v[58:59], v[204:207]
    v_lshlrev_b32_sdwa v104, 3, v132 dst_sel:DWORD dst_unused:UNUSED_PAD src0_sel:DWORD src1_sel:WORD_0
    v_lshlrev_b32_sdwa v106, 3, v132 dst_sel:DWORD dst_unused:UNUSED_PAD src0_sel:DWORD src1_sel:WORD_1
    ds_read_b64 v[104:105], v104
    ds_read_b64 v[106:107], v106
    v_lshlrev_b32_sdwa v108, 3, v133 dst_sel:DWORD dst_unused:UNUSED_PAD src0_sel:DWORD src1_sel:WORD_0
    v_lshlrev_b32_sdwa v110, 3, v133 dst_sel:DWORD dst_unused:UNUSED_PAD src0_sel:DWORD src1_sel:WORD_1
    ds_read_b64 v[108:109], v108
    ds_read_b64 v[110:111], v110
    s_waitcnt lgkmcnt(8)
    v_smfmac_f32_16x16x64_bf16 v[208:211], v[66:69], v[88:95], v70
    v_pk_mul_f32 v[156:157], v[192:193], v[192:193]
    v_pk_mul_f32 v[158:159], v[194:195], v[194:195]
    v_pk_fma_f32 v[156:157], v[156:157], v[144:145], v[146:147]
    v_pk_fma_f32 v[158:159], v[158:159], v[144:145], v[146:147]
    v_pk_mul_f32 v[156:157], v[156:157], v[192:193]
    v_pk_mul_f32 v[158:159], v[158:159], v[194:195]
    v_exp_f32 v156, v156
    v_lshlrev_b32_sdwa v88, 3, v134 dst_sel:DWORD dst_unused:UNUSED_PAD src0_sel:DWORD src1_sel:WORD_0
    v_lshlrev_b32_sdwa v90, 3, v134 dst_sel:DWORD dst_unused:UNUSED_PAD src0_sel:DWORD src1_sel:WORD_1
    ds_read_b64 v[88:89], v88
    ds_read_b64 v[90:91], v90
    v_lshlrev_b32_sdwa v92, 3, v135 dst_sel:DWORD dst_unused:UNUSED_PAD src0_sel:DWORD src1_sel:WORD_0
    v_lshlrev_b32_sdwa v94, 3, v135 dst_sel:DWORD dst_unused:UNUSED_PAD src0_sel:DWORD src1_sel:WORD_1
    ds_read_b64 v[92:93], v92
    ds_read_b64 v[94:95], v94
    s_add_u32 s20, s20, 0x40000
    buffer_load_dwordx4 v[132:135], v71, s[12:15], s20 offen offset:0 sc1
    s_waitcnt lgkmcnt(8)
    v_smfmac_f32_16x16x64_bf16 v[208:211], v[66:69], v[96:103], v70
    v_exp_f32 v157, v157
    v_pk_mul_f32 v[162:163], v[196:197], v[196:197]
    v_pk_mul_f32 v[164:165], v[198:199], v[198:199]
    v_exp_f32 v158, v158
    v_pk_fma_f32 v[156:157], v[156:157], v[150:151], v[150:151]
    v_pk_fma_f32 v[162:163], v[162:163], v[144:145], v[146:147]
    v_rcp_f32 v156, v156
    v_lshlrev_b32_sdwa v96, 3, v136 dst_sel:DWORD dst_unused:UNUSED_PAD src0_sel:DWORD src1_sel:WORD_0
    v_lshlrev_b32_sdwa v98, 3, v136 dst_sel:DWORD dst_unused:UNUSED_PAD src0_sel:DWORD src1_sel:WORD_1
    ds_read_b64 v[96:97], v96
    ds_read_b64 v[98:99], v98
    v_lshlrev_b32_sdwa v100, 3, v137 dst_sel:DWORD dst_unused:UNUSED_PAD src0_sel:DWORD src1_sel:WORD_0
    v_lshlrev_b32_sdwa v102, 3, v137 dst_sel:DWORD dst_unused:UNUSED_PAD src0_sel:DWORD src1_sel:WORD_1
    v_lshlrev_b32 v212, 16, v12
    v_and_b32 v213, s23, v12
    v_lshlrev_b32 v214, 16, v13
    v_and_b32 v215, s23, v13
    ds_read_b64 v[100:101], v100
    ds_read_b64 v[102:103], v102
    s_waitcnt vmcnt(6)
    v_readfirstlane_b32 s44, v85
    s_cmp_le_u32 s44, 1
    s_cbranch_scc1 k1_kernel_xw1
k1_kernel_xb1:
    buffer_load_dwordx4 v[54:57], v71, s[12:15], s18 offen offset:2048 sc1
    buffer_load_dwordx4 v[50:53], v71, s[12:15], s18 offen offset:3072 sc1
    s_waitcnt lgkmcnt(8)
    v_smfmac_f32_16x16x64_bf16 v[212:215], v[66:69], v[104:111], v70
    v_rcp_f32 v157, v157
    v_pk_mul_f32 v[162:163], v[162:163], v[196:197]
    v_pk_fma_f32 v[164:165], v[164:165], v[144:145], v[146:147]
    v_exp_f32 v159, v159
    v_pk_mul_f32 v[160:161], v[192:193], v[156:157]
    v_pk_mul_f32 v[164:165], v[164:165], v[198:199]
    v_exp_f32 v162, v162
    v_lshlrev_b32_sdwa v104, 3, v138 dst_sel:DWORD dst_unused:UNUSED_PAD src0_sel:DWORD src1_sel:WORD_0
    v_lshlrev_b32_sdwa v106, 3, v138 dst_sel:DWORD dst_unused:UNUSED_PAD src0_sel:DWORD src1_sel:WORD_1
    ds_read_b64 v[104:105], v104
    ds_read_b64 v[106:107], v106
    v_lshlrev_b32_sdwa v108, 3, v139 dst_sel:DWORD dst_unused:UNUSED_PAD src0_sel:DWORD src1_sel:WORD_0
    v_lshlrev_b32_sdwa v110, 3, v139 dst_sel:DWORD dst_unused:UNUSED_PAD src0_sel:DWORD src1_sel:WORD_1
    ds_read_b64 v[108:109], v108
    ds_read_b64 v[110:111], v110
    s_add_u32 s20, s20, 0xfffc0400
    buffer_load_dwordx4 v[136:139], v71, s[12:15], s20 offen offset:0 sc1
    s_waitcnt lgkmcnt(8)
    v_smfmac_f32_16x16x64_bf16 v[212:215], v[66:69], v[88:95], v70
    v_exp_f32 v163, v163
    v_pk_fma_f32 v[158:159], v[158:159], v[152:153], v[152:153]
    v_pk_mul_f32 v[168:169], v[200:201], v[200:201]
    v_rcp_f32 v158, v158
    v_pk_fma_f32 v[162:163], v[162:163], v[150:151], v[150:151]
    v_pk_fma_f32 v[168:169], v[168:169], v[144:145], v[146:147]
    v_rcp_f32 v159, v159
    v_lshlrev_b32_sdwa v88, 3, v140 dst_sel:DWORD dst_unused:UNUSED_PAD src0_sel:DWORD src1_sel:WORD_0
    v_lshlrev_b32_sdwa v90, 3, v140 dst_sel:DWORD dst_unused:UNUSED_PAD src0_sel:DWORD src1_sel:WORD_1
    ds_read_b64 v[88:89], v88
    ds_read_b64 v[90:91], v90
    v_lshlrev_b32_sdwa v92, 3, v141 dst_sel:DWORD dst_unused:UNUSED_PAD src0_sel:DWORD src1_sel:WORD_0
    v_lshlrev_b32_sdwa v94, 3, v141 dst_sel:DWORD dst_unused:UNUSED_PAD src0_sel:DWORD src1_sel:WORD_1
    ds_read_b64 v[92:93], v92
    ds_read_b64 v[94:95], v94
    s_waitcnt lgkmcnt(8)
    v_smfmac_f32_16x16x64_bf16 v[212:215], v[66:69], v[96:103], v70
    v_rcp_f32 v162, v162
    v_pk_fma_f32 v[160:161], v[194:195], v[158:159], v[160:161]
    v_pk_mul_f32 v[168:169], v[168:169], v[200:201]
    v_rcp_f32 v163, v163
    v_add_f32 v160, v160, v161
    v_pk_mul_f32 v[170:171], v[202:203], v[202:203]
    v_exp_f32 v164, v164
    v_lshlrev_b32_sdwa v96, 3, v142 dst_sel:DWORD dst_unused:UNUSED_PAD src0_sel:DWORD src1_sel:WORD_0
    v_lshlrev_b32_sdwa v98, 3, v142 dst_sel:DWORD dst_unused:UNUSED_PAD src0_sel:DWORD src1_sel:WORD_1
    ds_read_b64 v[96:97], v96
    ds_read_b64 v[98:99], v98
    v_lshlrev_b32_sdwa v100, 3, v143 dst_sel:DWORD dst_unused:UNUSED_PAD src0_sel:DWORD src1_sel:WORD_0
    v_lshlrev_b32_sdwa v102, 3, v143 dst_sel:DWORD dst_unused:UNUSED_PAD src0_sel:DWORD src1_sel:WORD_1
    ds_read_b64 v[100:101], v100
    ds_read_b64 v[102:103], v102
    s_add_u32 s20, s20, 0x40000
    buffer_load_dwordx4 v[140:143], v71, s[12:15], s20 offen offset:0 sc1
    s_waitcnt lgkmcnt(8)
    v_smfmac_f32_16x16x64_bf16 v[212:215], v[66:69], v[104:111], v70
    v_exp_f32 v165, v165
    v_min_u32 v160, -2, v160
    v_pk_mul_f32 v[166:167], v[196:197], v[162:163]
    v_exp_f32 v168, v168
    buffer_store_dword v160, v76, s[12:15], s35 offen offset:3328 sc1
    v_pk_fma_f32 v[164:165], v[164:165], v[152:153], v[152:153]
    v_exp_f32 v169, v169
    v_lshlrev_b32_sdwa v104, 3, v116 dst_sel:DWORD dst_unused:UNUSED_PAD src0_sel:DWORD src1_sel:WORD_0
    v_lshlrev_b32_sdwa v106, 3, v116 dst_sel:DWORD dst_unused:UNUSED_PAD src0_sel:DWORD src1_sel:WORD_1
    ds_read_b64 v[104:105], v104
    ds_read_b64 v[106:107], v106
    v_lshlrev_b32_sdwa v108, 3, v117 dst_sel:DWORD dst_unused:UNUSED_PAD src0_sel:DWORD src1_sel:WORD_0
    v_lshlrev_b32_sdwa v110, 3, v117 dst_sel:DWORD dst_unused:UNUSED_PAD src0_sel:DWORD src1_sel:WORD_1
    v_lshlrev_b32 v216, 16, v14
    v_and_b32 v217, s23, v14
    v_lshlrev_b32 v218, 16, v15
    v_and_b32 v219, s23, v15
    ds_read_b64 v[108:109], v108
    ds_read_b64 v[110:111], v110
    s_mov_b64 exec, 1
    buffer_load_dword v85, off, s[12:15], s47 sc1
    s_mov_b64 exec, -1
    s_waitcnt lgkmcnt(8)
    v_smfmac_f32_16x16x64_bf16 v[216:219], v[66:69], v[88:95], v70
    v_rcp_f32 v164, v164
    v_pk_fma_f32 v[168:169], v[168:169], v[150:151], v[150:151]
    v_pk_fma_f32 v[170:171], v[170:171], v[144:145], v[146:147]
    v_rcp_f32 v165, v165
    v_pk_mul_f32 v[170:171], v[170:171], v[202:203]
    v_pk_mul_f32 v[174:175], v[204:205], v[204:205]
    v_rcp_f32 v168, v168
    v_lshlrev_b32_sdwa v88, 3, v118 dst_sel:DWORD dst_unused:UNUSED_PAD src0_sel:DWORD src1_sel:WORD_0
    v_lshlrev_b32_sdwa v90, 3, v118 dst_sel:DWORD dst_unused:UNUSED_PAD src0_sel:DWORD src1_sel:WORD_1
    ds_read_b64 v[88:89], v88
    ds_read_b64 v[90:91], v90
    v_lshlrev_b32_sdwa v92, 3, v119 dst_sel:DWORD dst_unused:UNUSED_PAD src0_sel:DWORD src1_sel:WORD_0
    v_lshlrev_b32_sdwa v94, 3, v119 dst_sel:DWORD dst_unused:UNUSED_PAD src0_sel:DWORD src1_sel:WORD_1
    ds_read_b64 v[92:93], v92
    ds_read_b64 v[94:95], v94
    s_add_u32 s20, s20, 0xfffc0400
    buffer_load_dwordx4 v[116:119], v71, s[12:15], s20 offen offset:0 sc1
    s_waitcnt lgkmcnt(8)
    v_smfmac_f32_16x16x64_bf16 v[216:219], v[66:69], v[96:103], v70
    v_rcp_f32 v169, v169
    v_pk_fma_f32 v[166:167], v[198:199], v[164:165], v[166:167]
    v_pk_fma_f32 v[174:175], v[174:175], v[144:145], v[146:147]
    v_exp_f32 v170, v170
    v_add_f32 v166, v166, v167
    v_pk_mul_f32 v[172:173], v[200:201], v[168:169]
    v_exp_f32 v171, v171
    s_waitcnt vmcnt(12)
    v_lshlrev_b32_sdwa v96, 3, v120 dst_sel:DWORD dst_unused:UNUSED_PAD src0_sel:DWORD src1_sel:WORD_0
    v_lshlrev_b32_sdwa v98, 3, v120 dst_sel:DWORD dst_unused:UNUSED_PAD src0_sel:DWORD src1_sel:WORD_1
    ds_read_b64 v[96:97], v96
    ds_read_b64 v[98:99], v98
    v_lshlrev_b32_sdwa v100, 3, v121 dst_sel:DWORD dst_unused:UNUSED_PAD src0_sel:DWORD src1_sel:WORD_0
    v_lshlrev_b32_sdwa v102, 3, v121 dst_sel:DWORD dst_unused:UNUSED_PAD src0_sel:DWORD src1_sel:WORD_1
    ds_read_b64 v[100:101], v100
    ds_read_b64 v[102:103], v102
    s_waitcnt lgkmcnt(8)
    v_smfmac_f32_16x16x64_bf16 v[216:219], v[66:69], v[104:111], v70
    v_min_u32 v166, -2, v166
    v_pk_fma_f32 v[170:171], v[170:171], v[152:153], v[152:153]
    buffer_store_dword v166, v76, s[12:15], s35 offen offset:3584 sc1
    v_rcp_f32 v170, v170
    v_pk_mul_f32 v[174:175], v[174:175], v[204:205]
    v_pk_mul_f32 v[176:177], v[206:207], v[206:207]
    v_rcp_f32 v171, v171
    v_lshlrev_b32_sdwa v104, 3, v122 dst_sel:DWORD dst_unused:UNUSED_PAD src0_sel:DWORD src1_sel:WORD_0
    v_lshlrev_b32_sdwa v106, 3, v122 dst_sel:DWORD dst_unused:UNUSED_PAD src0_sel:DWORD src1_sel:WORD_1
    ds_read_b64 v[104:105], v104
    ds_read_b64 v[106:107], v106
    v_lshlrev_b32_sdwa v108, 3, v123 dst_sel:DWORD dst_unused:UNUSED_PAD src0_sel:DWORD src1_sel:WORD_0
    v_lshlrev_b32_sdwa v110, 3, v123 dst_sel:DWORD dst_unused:UNUSED_PAD src0_sel:DWORD src1_sel:WORD_1
    ds_read_b64 v[108:109], v108
    ds_read_b64 v[110:111], v110
    s_add_u32 s20, s20, 0x40000
    buffer_load_dwordx4 v[120:123], v71, s[12:15], s20 offen offset:0 sc1
    s_waitcnt lgkmcnt(8)
    v_smfmac_f32_16x16x64_bf16 v[216:219], v[66:69], v[88:95], v70
    v_exp_f32 v174, v174
    v_pk_fma_f32 v[172:173], v[202:203], v[170:171], v[172:173]
    v_pk_fma_f32 v[176:177], v[176:177], v[144:145], v[146:147]
    v_exp_f32 v175, v175
    v_add_f32 v172, v172, v173
    v_pk_mul_f32 v[176:177], v[176:177], v[206:207]
    v_min_u32 v172, -2, v172
    s_waitcnt vmcnt(12)
    v_lshlrev_b32_sdwa v88, 3, v124 dst_sel:DWORD dst_unused:UNUSED_PAD src0_sel:DWORD src1_sel:WORD_0
    v_lshlrev_b32_sdwa v90, 3, v124 dst_sel:DWORD dst_unused:UNUSED_PAD src0_sel:DWORD src1_sel:WORD_1
    ds_read_b64 v[88:89], v88
    ds_read_b64 v[90:91], v90
    v_lshlrev_b32_sdwa v92, 3, v125 dst_sel:DWORD dst_unused:UNUSED_PAD src0_sel:DWORD src1_sel:WORD_0
    v_lshlrev_b32_sdwa v94, 3, v125 dst_sel:DWORD dst_unused:UNUSED_PAD src0_sel:DWORD src1_sel:WORD_1
    v_lshlrev_b32 v220, 16, v16
    v_and_b32 v221, s23, v16
    v_lshlrev_b32 v222, 16, v17
    v_and_b32 v223, s23, v17
    ds_read_b64 v[92:93], v92
    ds_read_b64 v[94:95], v94
    v_mov_b32 v84, 4
    s_mov_b64 exec, 1
    buffer_store_dword v84, off, s[12:15], s46 sc1
    s_mov_b64 exec, -1
    s_waitcnt lgkmcnt(8)
    v_smfmac_f32_16x16x64_bf16 v[220:223], v[66:69], v[96:103], v70
    v_exp_f32 v176, v176
    buffer_store_dword v172, v76, s[12:15], s35 offen offset:3840 sc1
    v_pk_fma_f32 v[174:175], v[174:175], v[150:151], v[150:151]
    v_exp_f32 v177, v177
    v_rcp_f32 v174, v174
    v_rcp_f32 v175, v175
    v_pk_fma_f32 v[176:177], v[176:177], v[152:153], v[152:153]
    v_lshlrev_b32_sdwa v96, 3, v126 dst_sel:DWORD dst_unused:UNUSED_PAD src0_sel:DWORD src1_sel:WORD_0
    v_lshlrev_b32_sdwa v98, 3, v126 dst_sel:DWORD dst_unused:UNUSED_PAD src0_sel:DWORD src1_sel:WORD_1
    ds_read_b64 v[96:97], v96
    ds_read_b64 v[98:99], v98
    v_lshlrev_b32_sdwa v100, 3, v127 dst_sel:DWORD dst_unused:UNUSED_PAD src0_sel:DWORD src1_sel:WORD_0
    v_lshlrev_b32_sdwa v102, 3, v127 dst_sel:DWORD dst_unused:UNUSED_PAD src0_sel:DWORD src1_sel:WORD_1
    ds_read_b64 v[100:101], v100
    ds_read_b64 v[102:103], v102
    s_add_u32 s20, s20, 0xfffc0400
    buffer_load_dwordx4 v[124:127], v71, s[12:15], s20 offen offset:0 sc1
    s_waitcnt lgkmcnt(8)
    v_smfmac_f32_16x16x64_bf16 v[220:223], v[66:69], v[104:111], v70
    v_rcp_f32 v176, v176
    v_pk_mul_f32 v[178:179], v[204:205], v[174:175]
    s_waitcnt vmcnt(11)
    v_mfma_f32_4x4x4_16b_bf16 v[208:211], v[154:155], v[56:57], v[208:211]
    v_rcp_f32 v177, v177
    v_mfma_f32_4x4x4_16b_bf16 v[212:215], v[154:155], v[54:55], v[212:215]
    s_waitcnt vmcnt(10)
    v_mfma_f32_4x4x4_16b_bf16 v[216:219], v[154:155], v[52:53], v[216:219]
    v_pk_fma_f32 v[178:179], v[206:207], v[176:177], v[178:179]
    v_lshlrev_b32_sdwa v104, 3, v128 dst_sel:DWORD dst_unused:UNUSED_PAD src0_sel:DWORD src1_sel:WORD_0
    v_lshlrev_b32_sdwa v106, 3, v128 dst_sel:DWORD dst_unused:UNUSED_PAD src0_sel:DWORD src1_sel:WORD_1
    ds_read_b64 v[104:105], v104
    ds_read_b64 v[106:107], v106
    v_lshlrev_b32_sdwa v108, 3, v129 dst_sel:DWORD dst_unused:UNUSED_PAD src0_sel:DWORD src1_sel:WORD_0
    v_lshlrev_b32_sdwa v110, 3, v129 dst_sel:DWORD dst_unused:UNUSED_PAD src0_sel:DWORD src1_sel:WORD_1
    ds_read_b64 v[108:109], v108
    ds_read_b64 v[110:111], v110
    s_waitcnt lgkmcnt(8)
    v_smfmac_f32_16x16x64_bf16 v[220:223], v[66:69], v[88:95], v70
    v_add_f32 v178, v178, v179
    v_pk_mul_f32 v[180:181], v[208:209], v[208:209]
    v_min_u32 v178, -2, v178
    v_pk_fma_f32 v[180:181], v[180:181], v[144:145], v[146:147]
    buffer_store_dword v178, v76, s[12:15], s35 offen offset:0 sc1
    v_pk_mul_f32 v[180:181], v[180:181], v[208:209]
    v_pk_mul_f32 v[182:183], v[210:211], v[210:211]
    v_lshlrev_b32_sdwa v88, 3, v130 dst_sel:DWORD dst_unused:UNUSED_PAD src0_sel:DWORD src1_sel:WORD_0
    v_lshlrev_b32_sdwa v90, 3, v130 dst_sel:DWORD dst_unused:UNUSED_PAD src0_sel:DWORD src1_sel:WORD_1
    ds_read_b64 v[88:89], v88
    ds_read_b64 v[90:91], v90
    v_lshlrev_b32_sdwa v92, 3, v131 dst_sel:DWORD dst_unused:UNUSED_PAD src0_sel:DWORD src1_sel:WORD_0
    v_lshlrev_b32_sdwa v94, 3, v131 dst_sel:DWORD dst_unused:UNUSED_PAD src0_sel:DWORD src1_sel:WORD_1
    ds_read_b64 v[92:93], v92
    ds_read_b64 v[94:95], v94
    s_add_u32 s20, s20, 0x40000
    buffer_load_dwordx4 v[128:131], v71, s[12:15], s20 offen offset:0 sc1
    s_waitcnt lgkmcnt(8)
    v_smfmac_f32_16x16x64_bf16 v[220:223], v[66:69], v[96:103], v70
    v_exp_f32 v180, v180
    v_pk_fma_f32 v[182:183], v[182:183], v[144:145], v[146:147]
    v_pk_mul_f32 v[186:187], v[212:213], v[212:213]
    v_exp_f32 v181, v181
    v_pk_mul_f32 v[182:183], v[182:183], v[210:211]
    v_pk_fma_f32 v[186:187], v[186:187], v[144:145], v[146:147]
    v_exp_f32 v182, v182
    v_lshlrev_b32_sdwa v96, 3, v132 dst_sel:DWORD dst_unused:UNUSED_PAD src0_sel:DWORD src1_sel:WORD_0
    v_lshlrev_b32_sdwa v98, 3, v132 dst_sel:DWORD dst_unused:UNUSED_PAD src0_sel:DWORD src1_sel:WORD_1
    ds_read_b64 v[96:97], v96
    ds_read_b64 v[98:99], v98
    v_lshlrev_b32_sdwa v100, 3, v133 dst_sel:DWORD dst_unused:UNUSED_PAD src0_sel:DWORD src1_sel:WORD_0
    v_lshlrev_b32_sdwa v102, 3, v133 dst_sel:DWORD dst_unused:UNUSED_PAD src0_sel:DWORD src1_sel:WORD_1
    v_lshlrev_b32 v224, 16, v18
    v_and_b32 v225, s23, v18
    v_lshlrev_b32 v226, 16, v19
    v_and_b32 v227, s23, v19
    ds_read_b64 v[100:101], v100
    ds_read_b64 v[102:103], v102
    s_waitcnt vmcnt(8)
    v_readfirstlane_b32 s44, v85
    s_cmp_le_u32 s44, 2
    s_cbranch_scc1 k1_kernel_xw2
k1_kernel_xb2:
    buffer_load_dwordx4 v[46:49], v71, s[12:15], s32 offen offset:0 sc1
    buffer_load_dwordx4 v[42:45], v71, s[12:15], s32 offen offset:1024 sc1
    s_waitcnt lgkmcnt(8)
    v_smfmac_f32_16x16x64_bf16 v[224:227], v[66:69], v[104:111], v70
    v_exp_f32 v183, v183
    v_pk_fma_f32 v[180:181], v[180:181], v[150:151], v[150:151]
    v_pk_mul_f32 v[186:187], v[186:187], v[212:213]
    v_rcp_f32 v180, v180
    v_pk_fma_f32 v[182:183], v[182:183], v[152:153], v[152:153]
    v_pk_mul_f32 v[188:189], v[214:215], v[214:215]
    v_rcp_f32 v181, v181
    v_lshlrev_b32_sdwa v104, 3, v134 dst_sel:DWORD dst_unused:UNUSED_PAD src0_sel:DWORD src1_sel:WORD_0
    v_lshlrev_b32_sdwa v106, 3, v134 dst_sel:DWORD dst_unused:UNUSED_PAD src0_sel:DWORD src1_sel:WORD_1
    ds_read_b64 v[104:105], v104
    ds_read_b64 v[106:107], v106
    v_lshlrev_b32_sdwa v108, 3, v135 dst_sel:DWORD dst_unused:UNUSED_PAD src0_sel:DWORD src1_sel:WORD_0
    v_lshlrev_b32_sdwa v110, 3, v135 dst_sel:DWORD dst_unused:UNUSED_PAD src0_sel:DWORD src1_sel:WORD_1
    ds_read_b64 v[108:109], v108
    ds_read_b64 v[110:111], v110
    s_add_u32 s20, s20, 0xfffc0400
    buffer_load_dwordx4 v[132:135], v71, s[12:15], s20 offen offset:0 sc1
    s_waitcnt lgkmcnt(8)
    v_smfmac_f32_16x16x64_bf16 v[224:227], v[66:69], v[88:95], v70
    v_rcp_f32 v182, v182
    v_pk_mul_f32 v[184:185], v[208:209], v[180:181]
    v_pk_fma_f32 v[188:189], v[188:189], v[144:145], v[146:147]
    v_rcp_f32 v183, v183
    v_pk_mul_f32 v[188:189], v[188:189], v[214:215]
    v_pk_mul_f32 v[156:157], v[216:217], v[216:217]
    v_exp_f32 v186, v186
    v_lshlrev_b32_sdwa v88, 3, v136 dst_sel:DWORD dst_unused:UNUSED_PAD src0_sel:DWORD src1_sel:WORD_0
    v_lshlrev_b32_sdwa v90, 3, v136 dst_sel:DWORD dst_unused:UNUSED_PAD src0_sel:DWORD src1_sel:WORD_1
    ds_read_b64 v[88:89], v88
    ds_read_b64 v[90:91], v90
    v_lshlrev_b32_sdwa v92, 3, v137 dst_sel:DWORD dst_unused:UNUSED_PAD src0_sel:DWORD src1_sel:WORD_0
    v_lshlrev_b32_sdwa v94, 3, v137 dst_sel:DWORD dst_unused:UNUSED_PAD src0_sel:DWORD src1_sel:WORD_1
    ds_read_b64 v[92:93], v92
    ds_read_b64 v[94:95], v94
    s_waitcnt lgkmcnt(8)
    v_smfmac_f32_16x16x64_bf16 v[224:227], v[66:69], v[96:103], v70
    v_exp_f32 v187, v187
    v_pk_fma_f32 v[184:185], v[210:211], v[182:183], v[184:185]
    v_pk_fma_f32 v[156:157], v[156:157], v[144:145], v[146:147]
    v_exp_f32 v188, v188
    v_add_f32 v184, v184, v185
    v_pk_fma_f32 v[186:187], v[186:187], v[150:151], v[150:151]
    v_exp_f32 v189, v189
    v_lshlrev_b32_sdwa v96, 3, v138 dst_sel:DWORD dst_unused:UNUSED_PAD src0_sel:DWORD src1_sel:WORD_0
    v_lshlrev_b32_sdwa v98, 3, v138 dst_sel:DWORD dst_unused:UNUSED_PAD src0_sel:DWORD src1_sel:WORD_1
    ds_read_b64 v[96:97], v96
    ds_read_b64 v[98:99], v98
    v_lshlrev_b32_sdwa v100, 3, v139 dst_sel:DWORD dst_unused:UNUSED_PAD src0_sel:DWORD src1_sel:WORD_0
    v_lshlrev_b32_sdwa v102, 3, v139 dst_sel:DWORD dst_unused:UNUSED_PAD src0_sel:DWORD src1_sel:WORD_1
    ds_read_b64 v[100:101], v100
    ds_read_b64 v[102:103], v102
    s_add_u32 s20, s20, 0x40000
    buffer_load_dwordx4 v[136:139], v71, s[12:15], s20 offen offset:0 sc1
    s_waitcnt lgkmcnt(8)
    v_smfmac_f32_16x16x64_bf16 v[224:227], v[66:69], v[104:111], v70
    v_rcp_f32 v186, v186
    v_min_u32 v184, -2, v184
    v_pk_fma_f32 v[188:189], v[188:189], v[152:153], v[152:153]
    v_rcp_f32 v187, v187
    buffer_store_dword v184, v76, s[12:15], s35 offen offset:256 sc1
    v_pk_mul_f32 v[156:157], v[156:157], v[216:217]
    v_rcp_f32 v188, v188
    v_lshlrev_b32_sdwa v104, 3, v140 dst_sel:DWORD dst_unused:UNUSED_PAD src0_sel:DWORD src1_sel:WORD_0
    v_lshlrev_b32_sdwa v106, 3, v140 dst_sel:DWORD dst_unused:UNUSED_PAD src0_sel:DWORD src1_sel:WORD_1
    ds_read_b64 v[104:105], v104
    ds_read_b64 v[106:107], v106
    v_lshlrev_b32_sdwa v108, 3, v141 dst_sel:DWORD dst_unused:UNUSED_PAD src0_sel:DWORD src1_sel:WORD_0
    v_lshlrev_b32_sdwa v110, 3, v141 dst_sel:DWORD dst_unused:UNUSED_PAD src0_sel:DWORD src1_sel:WORD_1
    v_lshlrev_b32 v228, 16, v20
    v_and_b32 v229, s23, v20
    v_lshlrev_b32 v230, 16, v21
    v_and_b32 v231, s23, v21
    ds_read_b64 v[108:109], v108
    ds_read_b64 v[110:111], v110
    s_mov_b64 exec, 1
    buffer_load_dword v85, off, s[12:15], s47 sc1
    s_mov_b64 exec, -1
    s_waitcnt lgkmcnt(8)
    v_smfmac_f32_16x16x64_bf16 v[228:231], v[66:69], v[88:95], v70
    s_setprio 2
    v_rcp_f32 v189, v189
    v_pk_mul_f32 v[190:191], v[212:213], v[186:187]
    v_pk_mul_f32 v[158:159], v[218:219], v[218:219]
    v_exp_f32 v156, v156
    v_pk_fma_f32 v[190:191], v[214:215], v[188:189], v[190:191]
    v_pk_fma_f32 v[158:159], v[158:159], v[144:145], v[146:147]
    v_exp_f32 v157, v157
    v_lshlrev_b32_sdwa v88, 3, v142 dst_sel:DWORD dst_unused:UNUSED_PAD src0_sel:DWORD src1_sel:WORD_0
    v_lshlrev_b32_sdwa v90, 3, v142 dst_sel:DWORD dst_unused:UNUSED_PAD src0_sel:DWORD src1_sel:WORD_1
    ds_read_b64 v[88:89], v88
    ds_read_b64 v[90:91], v90
    v_lshlrev_b32_sdwa v92, 3, v143 dst_sel:DWORD dst_unused:UNUSED_PAD src0_sel:DWORD src1_sel:WORD_0
    v_lshlrev_b32_sdwa v94, 3, v143 dst_sel:DWORD dst_unused:UNUSED_PAD src0_sel:DWORD src1_sel:WORD_1
    ds_read_b64 v[92:93], v92
    ds_read_b64 v[94:95], v94
    s_add_u32 s20, s20, 0xfffc0400
    buffer_load_dwordx4 v[140:143], v71, s[12:15], s20 offen offset:0 sc1
    s_waitcnt lgkmcnt(8)
    v_smfmac_f32_16x16x64_bf16 v[228:231], v[66:69], v[96:103], v70
    v_add_f32 v190, v190, v191
    v_pk_fma_f32 v[156:157], v[156:157], v[150:151], v[150:151]
    v_min_u32 v190, -2, v190
    v_rcp_f32 v156, v156
    buffer_store_dword v190, v76, s[12:15], s35 offen offset:512 sc1
    v_pk_mul_f32 v[158:159], v[158:159], v[218:219]
    v_rcp_f32 v157, v157
    s_waitcnt vmcnt(15)
    v_lshlrev_b32_sdwa v96, 3, v116 dst_sel:DWORD dst_unused:UNUSED_PAD src0_sel:DWORD src1_sel:WORD_0
    v_lshlrev_b32_sdwa v98, 3, v116 dst_sel:DWORD dst_unused:UNUSED_PAD src0_sel:DWORD src1_sel:WORD_1
    ds_read_b64 v[96:97], v96
    ds_read_b64 v[98:99], v98
    v_lshlrev_b32_sdwa v100, 3, v117 dst_sel:DWORD dst_unused:UNUSED_PAD src0_sel:DWORD src1_sel:WORD_0
    v_lshlrev_b32_sdwa v102, 3, v117 dst_sel:DWORD dst_unused:UNUSED_PAD src0_sel:DWORD src1_sel:WORD_1
    ds_read_b64 v[100:101], v100
    ds_read_b64 v[102:103], v102
    s_waitcnt lgkmcnt(8)
    v_smfmac_f32_16x16x64_bf16 v[228:231], v[66:69], v[104:111], v70
    v_exp_f32 v158, v158
    v_pk_mul_f32 v[160:161], v[216:217], v[156:157]
    v_mfma_f32_4x4x4_16b_bf16 v[220:223], v[154:155], v[50:51], v[220:223]
    v_exp_f32 v159, v159
    v_lshlrev_b32_sdwa v104, 3, v118 dst_sel:DWORD dst_unused:UNUSED_PAD src0_sel:DWORD src1_sel:WORD_0
    v_lshlrev_b32_sdwa v106, 3, v118 dst_sel:DWORD dst_unused:UNUSED_PAD src0_sel:DWORD src1_sel:WORD_1
    ds_read_b64 v[104:105], v104
    ds_read_b64 v[106:107], v106
    v_lshlrev_b32_sdwa v108, 3, v119 dst_sel:DWORD dst_unused:UNUSED_PAD src0_sel:DWORD src1_sel:WORD_0
    v_lshlrev_b32_sdwa v110, 3, v119 dst_sel:DWORD dst_unused:UNUSED_PAD src0_sel:DWORD src1_sel:WORD_1
    ds_read_b64 v[108:109], v108
    ds_read_b64 v[110:111], v110
    s_add_u32 s20, s20, 0x40000
    buffer_load_dwordx4 v[116:119], v71, s[12:15], s20 offen offset:0 sc1
    s_waitcnt lgkmcnt(8)
    v_smfmac_f32_16x16x64_bf16 v[228:231], v[66:69], v[88:95], v70
    v_pk_fma_f32 v[158:159], v[158:159], v[152:153], v[152:153]
    v_pk_mul_f32 v[162:163], v[220:221], v[220:221]
    v_rcp_f32 v158, v158
    v_pk_fma_f32 v[162:163], v[162:163], v[144:145], v[146:147]
    v_pk_mul_f32 v[164:165], v[222:223], v[222:223]
    v_rcp_f32 v159, v159
    v_pk_mul_f32 v[162:163], v[162:163], v[220:221]
    s_waitcnt vmcnt(14)
    v_lshlrev_b32_sdwa v88, 3, v120 dst_sel:DWORD dst_unused:UNUSED_PAD src0_sel:DWORD src1_sel:WORD_0
    v_lshlrev_b32_sdwa v90, 3, v120 dst_sel:DWORD dst_unused:UNUSED_PAD src0_sel:DWORD src1_sel:WORD_1
    ds_read_b64 v[88:89], v88
    ds_read_b64 v[90:91], v90
    v_lshlrev_b32_sdwa v92, 3, v121 dst_sel:DWORD dst_unused:UNUSED_PAD src0_sel:DWORD src1_sel:WORD_0
    v_lshlrev_b32_sdwa v94, 3, v121 dst_sel:DWORD dst_unused:UNUSED_PAD src0_sel:DWORD src1_sel:WORD_1
    v_lshlrev_b32 v232, 16, v22
    v_and_b32 v233, s23, v22
    v_lshlrev_b32 v234, 16, v23
    v_and_b32 v235, s23, v23
    ds_read_b64 v[92:93], v92
    ds_read_b64 v[94:95], v94
    s_waitcnt lgkmcnt(8)
    v_smfmac_f32_16x16x64_bf16 v[232:235], v[66:69], v[96:103], v70
    v_exp_f32 v162, v162
    v_pk_fma_f32 v[160:161], v[218:219], v[158:159], v[160:161]
    v_pk_fma_f32 v[164:165], v[164:165], v[144:145], v[146:147]
    v_exp_f32 v163, v163
    v_add_f32 v160, v160, v161
    v_pk_mul_f32 v[164:165], v[164:165], v[222:223]
    v_min_u32 v160, -2, v160
    v_lshlrev_b32_sdwa v96, 3, v122 dst_sel:DWORD dst_unused:UNUSED_PAD src0_sel:DWORD src1_sel:WORD_0
    v_lshlrev_b32_sdwa v98, 3, v122 dst_sel:DWORD dst_unused:UNUSED_PAD src0_sel:DWORD src1_sel:WORD_1
    ds_read_b64 v[96:97], v96
    ds_read_b64 v[98:99], v98
    v_lshlrev_b32_sdwa v100, 3, v123 dst_sel:DWORD dst_unused:UNUSED_PAD src0_sel:DWORD src1_sel:WORD_0
    v_lshlrev_b32_sdwa v102, 3, v123 dst_sel:DWORD dst_unused:UNUSED_PAD src0_sel:DWORD src1_sel:WORD_1
    ds_read_b64 v[100:101], v100
    ds_read_b64 v[102:103], v102
    s_add_u32 s20, s20, 0xfffc0400
    buffer_load_dwordx4 v[120:123], v71, s[12:15], s20 offen offset:0 sc1
    s_waitcnt lgkmcnt(8)
    v_smfmac_f32_16x16x64_bf16 v[232:235], v[66:69], v[104:111], v70
    v_exp_f32 v164, v164
    buffer_store_dword v160, v76, s[12:15], s35 offen offset:768 sc1
    v_pk_fma_f32 v[162:163], v[162:163], v[150:151], v[150:151]
    v_exp_f32 v165, v165
    s_waitcnt vmcnt(10)
    v_mfma_f32_4x4x4_16b_bf16 v[224:227], v[154:155], v[48:49], v[224:227]
    v_rcp_f32 v162, v162
    v_pk_fma_f32 v[164:165], v[164:165], v[152:153], v[152:153]
    v_lshlrev_b32_sdwa v104, 3, v124 dst_sel:DWORD dst_unused:UNUSED_PAD src0_sel:DWORD src1_sel:WORD_0
    v_lshlrev_b32_sdwa v106, 3, v124 dst_sel:DWORD dst_unused:UNUSED_PAD src0_sel:DWORD src1_sel:WORD_1
    ds_read_b64 v[104:105], v104
    ds_read_b64 v[106:107], v106
    v_lshlrev_b32_sdwa v108, 3, v125 dst_sel:DWORD dst_unused:UNUSED_PAD src0_sel:DWORD src1_sel:WORD_0
    v_lshlrev_b32_sdwa v110, 3, v125 dst_sel:DWORD dst_unused:UNUSED_PAD src0_sel:DWORD src1_sel:WORD_1
    ds_read_b64 v[108:109], v108
    ds_read_b64 v[110:111], v110
    s_waitcnt lgkmcnt(8)
    v_smfmac_f32_16x16x64_bf16 v[232:235], v[66:69], v[88:95], v70
    v_rcp_f32 v163, v163
    v_pk_mul_f32 v[168:169], v[224:225], v[224:225]
    v_pk_mul_f32 v[170:171], v[226:227], v[226:227]
    v_rcp_f32 v164, v164
    v_pk_mul_f32 v[166:167], v[220:221], v[162:163]
    v_pk_fma_f32 v[168:169], v[168:169], v[144:145], v[146:147]
    v_rcp_f32 v165, v165
    v_lshlrev_b32_sdwa v88, 3, v126 dst_sel:DWORD dst_unused:UNUSED_PAD src0_sel:DWORD src1_sel:WORD_0
    v_lshlrev_b32_sdwa v90, 3, v126 dst_sel:DWORD dst_unused:UNUSED_PAD src0_sel:DWORD src1_sel:WORD_1
    ds_read_b64 v[88:89], v88
    ds_read_b64 v[90:91], v90
    v_lshlrev_b32_sdwa v92, 3, v127 dst_sel:DWORD dst_unused:UNUSED_PAD src0_sel:DWORD src1_sel:WORD_0
    v_lshlrev_b32_sdwa v94, 3, v127 dst_sel:DWORD dst_unused:UNUSED_PAD src0_sel:DWORD src1_sel:WORD_1
    ds_read_b64 v[92:93], v92
    ds_read_b64 v[94:95], v94
    s_add_u32 s20, s20, 0x40000
    buffer_load_dwordx4 v[124:127], v71, s[12:15], s20 offen offset:0 sc1
    s_waitcnt lgkmcnt(8)
    v_smfmac_f32_16x16x64_bf16 v[232:235], v[66:69], v[96:103], v70
    v_pk_fma_f32 v[166:167], v[222:223], v[164:165], v[166:167]
    v_pk_mul_f32 v[168:169], v[168:169], v[224:225]
    v_add_f32 v166, v166, v167
    v_exp_f32 v168, v168
    v_min_u32 v166, -2, v166
    v_pk_fma_f32 v[170:171], v[170:171], v[144:145], v[146:147]
    v_exp_f32 v169, v169
    v_lshlrev_b32_sdwa v96, 3, v128 dst_sel:DWORD dst_unused:UNUSED_PAD src0_sel:DWORD src1_sel:WORD_0
    v_lshlrev_b32_sdwa v98, 3, v128 dst_sel:DWORD dst_unused:UNUSED_PAD src0_sel:DWORD src1_sel:WORD_1
    ds_read_b64 v[96:97], v96
    ds_read_b64 v[98:99], v98
    v_lshlrev_b32_sdwa v100, 3, v129 dst_sel:DWORD dst_unused:UNUSED_PAD src0_sel:DWORD src1_sel:WORD_0
    v_lshlrev_b32_sdwa v102, 3, v129 dst_sel:DWORD dst_unused:UNUSED_PAD src0_sel:DWORD src1_sel:WORD_1
    v_lshlrev_b32 v236, 16, v24
    v_and_b32 v237, s23, v24
    v_lshlrev_b32 v238, 16, v25
    v_and_b32 v239, s23, v25
    ds_read_b64 v[100:101], v100
    ds_read_b64 v[102:103], v102
    s_waitcnt vmcnt(6)
    v_readfirstlane_b32 s44, v85
    s_cmp_le_u32 s44, 3
    s_cbranch_scc1 k1_kernel_xw3
k1_kernel_xb3:
    buffer_load_dwordx4 v[38:41], v71, s[12:15], s32 offen offset:2048 sc1
    buffer_load_dwordx4 v[34:37], v71, s[12:15], s32 offen offset:3072 sc1
    s_waitcnt lgkmcnt(8)
    v_smfmac_f32_16x16x64_bf16 v[236:239], v[66:69], v[104:111], v70
    buffer_store_dword v166, v76, s[12:15], s35 offen offset:1024 sc1
    v_pk_fma_f32 v[168:169], v[168:169], v[150:151], v[150:151]
    v_pk_mul_f32 v[170:171], v[170:171], v[226:227]
    v_rcp_f32 v168, v168
    v_mfma_f32_4x4x4_16b_bf16 v[228:231], v[154:155], v[46:47], v[228:231]
    v_mfma_f32_4x4x4_16b_bf16 v[232:235], v[154:155], v[44:45], v[232:235]
    v_rcp_f32 v169, v169
    v_lshlrev_b32_sdwa v104, 3, v130 dst_sel:DWORD dst_unused:UNUSED_PAD src0_sel:DWORD src1_sel:WORD_0
    v_lshlrev_b32_sdwa v106, 3, v130 dst_sel:DWORD dst_unused:UNUSED_PAD src0_sel:DWORD src1_sel:WORD_1
    ds_read_b64 v[104:105], v104
    ds_read_b64 v[106:107], v106
    v_lshlrev_b32_sdwa v108, 3, v131 dst_sel:DWORD dst_unused:UNUSED_PAD src0_sel:DWORD src1_sel:WORD_0
    v_lshlrev_b32_sdwa v110, 3, v131 dst_sel:DWORD dst_unused:UNUSED_PAD src0_sel:DWORD src1_sel:WORD_1
    ds_read_b64 v[108:109], v108
    ds_read_b64 v[110:111], v110
    s_add_u32 s20, s20, 0xfffc0400
    buffer_load_dwordx4 v[128:131], v71, s[12:15], s20 offen offset:0 sc1
    s_waitcnt lgkmcnt(8)
    v_smfmac_f32_16x16x64_bf16 v[236:239], v[66:69], v[88:95], v70
    v_exp_f32 v170, v170
    v_pk_mul_f32 v[172:173], v[224:225], v[168:169]
    v_pk_mul_f32 v[174:175], v[228:229], v[228:229]
    v_exp_f32 v171, v171
    v_pk_fma_f32 v[174:175], v[174:175], v[144:145], v[146:147]
    v_pk_mul_f32 v[176:177], v[230:231], v[230:231]
    v_pk_fma_f32 v[170:171], v[170:171], v[152:153], v[152:153]
    v_lshlrev_b32_sdwa v88, 3, v132 dst_sel:DWORD dst_unused:UNUSED_PAD src0_sel:DWORD src1_sel:WORD_0
    v_lshlrev_b32_sdwa v90, 3, v132 dst_sel:DWORD dst_unused:UNUSED_PAD src0_sel:DWORD src1_sel:WORD_1
    ds_read_b64 v[88:89], v88
    ds_read_b64 v[90:91], v90
    v_lshlrev_b32_sdwa v92, 3, v133 dst_sel:DWORD dst_unused:UNUSED_PAD src0_sel:DWORD src1_sel:WORD_0
    v_lshlrev_b32_sdwa v94, 3, v133 dst_sel:DWORD dst_unused:UNUSED_PAD src0_sel:DWORD src1_sel:WORD_1
    ds_read_b64 v[92:93], v92
    ds_read_b64 v[94:95], v94
    s_waitcnt lgkmcnt(8)
    v_smfmac_f32_16x16x64_bf16 v[236:239], v[66:69], v[96:103], v70
    v_rcp_f32 v170, v170
    v_pk_mul_f32 v[174:175], v[174:175], v[228:229]
    v_pk_fma_f32 v[176:177], v[176:177], v[144:145], v[146:147]
    v_rcp_f32 v171, v171
    v_pk_mul_f32 v[176:177], v[176:177], v[230:231]
    v_pk_mul_f32 v[180:181], v[232:233], v[232:233]
    v_exp_f32 v174, v174
    v_lshlrev_b32_sdwa v96, 3, v134 dst_sel:DWORD dst_unused:UNUSED_PAD src0_sel:DWORD src1_sel:WORD_0
    v_lshlrev_b32_sdwa v98, 3, v134 dst_sel:DWORD dst_unused:UNUSED_PAD src0_sel:DWORD src1_sel:WORD_1
    ds_read_b64 v[96:97], v96
    ds_read_b64 v[98:99], v98
    v_lshlrev_b32_sdwa v100, 3, v135 dst_sel:DWORD dst_unused:UNUSED_PAD src0_sel:DWORD src1_sel:WORD_0
    v_lshlrev_b32_sdwa v102, 3, v135 dst_sel:DWORD dst_unused:UNUSED_PAD src0_sel:DWORD src1_sel:WORD_1
    ds_read_b64 v[100:101], v100
    ds_read_b64 v[102:103], v102
    s_add_u32 s20, s20, 0x40000
    buffer_load_dwordx4 v[132:135], v71, s[12:15], s20 offen offset:0 sc1
    s_waitcnt lgkmcnt(8)
    v_smfmac_f32_16x16x64_bf16 v[236:239], v[66:69], v[104:111], v70
    v_exp_f32 v175, v175
    v_pk_fma_f32 v[172:173], v[226:227], v[170:171], v[172:173]
    v_pk_fma_f32 v[180:181], v[180:181], v[144:145], v[146:147]
    v_exp_f32 v176, v176
    v_add_f32 v172, v172, v173
    v_pk_fma_f32 v[174:175], v[174:175], v[150:151], v[150:151]
    v_exp_f32 v177, v177
    v_lshlrev_b32_sdwa v104, 3, v136 dst_sel:DWORD dst_unused:UNUSED_PAD src0_sel:DWORD src1_sel:WORD_0
    v_lshlrev_b32_sdwa v106, 3, v136 dst_sel:DWORD dst_unused:UNUSED_PAD src0_sel:DWORD src1_sel:WORD_1
    ds_read_b64 v[104:105], v104
    ds_read_b64 v[106:107], v106
    v_lshlrev_b32_sdwa v108, 3, v137 dst_sel:DWORD dst_unused:UNUSED_PAD src0_sel:DWORD src1_sel:WORD_0
    v_lshlrev_b32_sdwa v110, 3, v137 dst_sel:DWORD dst_unused:UNUSED_PAD src0_sel:DWORD src1_sel:WORD_1
    v_lshlrev_b32 v240, 16, v26
    v_and_b32 v241, s23, v26
    v_lshlrev_b32 v242, 16, v27
    v_and_b32 v243, s23, v27
    ds_read_b64 v[108:109], v108
    ds_read_b64 v[110:111], v110
    s_waitcnt lgkmcnt(8)
    v_smfmac_f32_16x16x64_bf16 v[240:243], v[66:69], v[88:95], v70
    v_rcp_f32 v174, v174
    v_min_u32 v172, -2, v172
    v_pk_fma_f32 v[176:177], v[176:177], v[152:153], v[152:153]
    v_rcp_f32 v175, v175
    buffer_store_dword v172, v76, s[12:15], s35 offen offset:1280 sc1
    v_pk_mul_f32 v[180:181], v[180:181], v[232:233]
    v_rcp_f32 v176, v176
    v_lshlrev_b32_sdwa v88, 3, v138 dst_sel:DWORD dst_unused:UNUSED_PAD src0_sel:DWORD src1_sel:WORD_0
    v_lshlrev_b32_sdwa v90, 3, v138 dst_sel:DWORD dst_unused:UNUSED_PAD src0_sel:DWORD src1_sel:WORD_1
    ds_read_b64 v[88:89], v88
    ds_read_b64 v[90:91], v90
    v_lshlrev_b32_sdwa v92, 3, v139 dst_sel:DWORD dst_unused:UNUSED_PAD src0_sel:DWORD src1_sel:WORD_0
    v_lshlrev_b32_sdwa v94, 3, v139 dst_sel:DWORD dst_unused:UNUSED_PAD src0_sel:DWORD src1_sel:WORD_1
    ds_read_b64 v[92:93], v92
    ds_read_b64 v[94:95], v94
    s_waitcnt lgkmcnt(8)
    v_smfmac_f32_16x16x64_bf16 v[240:243], v[66:69], v[96:103], v70
    v_rcp_f32 v177, v177
    v_pk_mul_f32 v[178:179], v[228:229], v[174:175]
    v_pk_mul_f32 v[182:183], v[234:235], v[234:235]
    v_exp_f32 v180, v180
    v_pk_fma_f32 v[178:179], v[230:231], v[176:177], v[178:179]
    v_pk_fma_f32 v[182:183], v[182:183], v[144:145], v[146:147]
    v_exp_f32 v181, v181
    s_waitcnt vmcnt(11)
    v_lshlrev_b32_sdwa v96, 3, v140 dst_sel:DWORD dst_unused:UNUSED_PAD src0_sel:DWORD src1_sel:WORD_0
    v_lshlrev_b32_sdwa v98, 3, v140 dst_sel:DWORD dst_unused:UNUSED_PAD src0_sel:DWORD src1_sel:WORD_1
    ds_read_b64 v[96:97], v96
    ds_read_b64 v[98:99], v98
    v_lshlrev_b32_sdwa v100, 3, v141 dst_sel:DWORD dst_unused:UNUSED_PAD src0_sel:DWORD src1_sel:WORD_0
    v_lshlrev_b32_sdwa v102, 3, v141 dst_sel:DWORD dst_unused:UNUSED_PAD src0_sel:DWORD src1_sel:WORD_1
    ds_read_b64 v[100:101], v100
    ds_read_b64 v[102:103], v102
    s_waitcnt lgkmcnt(8)
    v_smfmac_f32_16x16x64_bf16 v[240:243], v[66:69], v[104:111], v70
    v_add_f32 v178, v178, v179
    v_pk_fma_f32 v[180:181], v[180:181], v[150:151], v[150:151]
    v_min_u32 v178, -2, v178
    v_rcp_f32 v180, v180
    buffer_store_dword v178, v76, s[12:15], s35 offen offset:1536 sc1
    v_pk_mul_f32 v[182:183], v[182:183], v[234:235]
    v_rcp_f32 v181, v181
    v_lshlrev_b32_sdwa v104, 3, v142 dst_sel:DWORD dst_unused:UNUSED_PAD src0_sel:DWORD src1_sel:WORD_0
    v_lshlrev_b32_sdwa v106, 3, v142 dst_sel:DWORD dst_unused:UNUSED_PAD src0_sel:DWORD src1_sel:WORD_1
    ds_read_b64 v[104:105], v104
    ds_read_b64 v[106:107], v106
    v_lshlrev_b32_sdwa v108, 3, v143 dst_sel:DWORD dst_unused:UNUSED_PAD src0_sel:DWORD src1_sel:WORD_0
    v_lshlrev_b32_sdwa v110, 3, v143 dst_sel:DWORD dst_unused:UNUSED_PAD src0_sel:DWORD src1_sel:WORD_1
    ds_read_b64 v[108:109], v108
    ds_read_b64 v[110:111], v110
    s_waitcnt lgkmcnt(8)
    v_smfmac_f32_16x16x64_bf16 v[240:243], v[66:69], v[88:95], v70
    v_exp_f32 v182, v182
    v_pk_mul_f32 v[184:185], v[232:233], v[180:181]
    v_mfma_f32_4x4x4_16b_bf16 v[236:239], v[154:155], v[42:43], v[236:239]
    v_exp_f32 v183, v183
    s_waitcnt vmcnt(10)
    v_lshlrev_b32_sdwa v88, 3, v116 dst_sel:DWORD dst_unused:UNUSED_PAD src0_sel:DWORD src1_sel:WORD_0
    v_lshlrev_b32_sdwa v90, 3, v116 dst_sel:DWORD dst_unused:UNUSED_PAD src0_sel:DWORD src1_sel:WORD_1
    ds_read_b64 v[88:89], v88
    ds_read_b64 v[90:91], v90
    v_lshlrev_b32_sdwa v92, 3, v117 dst_sel:DWORD dst_unused:UNUSED_PAD src0_sel:DWORD src1_sel:WORD_0
    v_lshlrev_b32_sdwa v94, 3, v117 dst_sel:DWORD dst_unused:UNUSED_PAD src0_sel:DWORD src1_sel:WORD_1
    v_lshlrev_b32 v244, 16, v28
    v_and_b32 v245, s23, v28
    v_lshlrev_b32 v246, 16, v29
    v_and_b32 v247, s23, v29
    ds_read_b64 v[92:93], v92
    ds_read_b64 v[94:95], v94
    s_waitcnt lgkmcnt(8)
    v_smfmac_f32_16x16x64_bf16 v[244:247], v[66:69], v[96:103], v70
    s_setprio 1
    v_pk_fma_f32 v[182:183], v[182:183], v[152:153], v[152:153]
    v_pk_mul_f32 v[186:187], v[236:237], v[236:237]
    v_rcp_f32 v182, v182
    v_pk_fma_f32 v[186:187], v[186:187], v[144:145], v[146:147]
    v_pk_mul_f32 v[188:189], v[238:239], v[238:239]
    v_rcp_f32 v183, v183
    v_pk_mul_f32 v[186:187], v[186:187], v[236:237]
    v_lshlrev_b32_sdwa v96, 3, v118 dst_sel:DWORD dst_unused:UNUSED_PAD src0_sel:DWORD src1_sel:WORD_0
    v_lshlrev_b32_sdwa v98, 3, v118 dst_sel:DWORD dst_unused:UNUSED_PAD src0_sel:DWORD src1_sel:WORD_1
    ds_read_b64 v[96:97], v96
    ds_read_b64 v[98:99], v98
    v_lshlrev_b32_sdwa v100, 3, v119 dst_sel:DWORD dst_unused:UNUSED_PAD src0_sel:DWORD src1_sel:WORD_0
    v_lshlrev_b32_sdwa v102, 3, v119 dst_sel:DWORD dst_unused:UNUSED_PAD src0_sel:DWORD src1_sel:WORD_1
    ds_read_b64 v[100:101], v100
    ds_read_b64 v[102:103], v102
    s_waitcnt lgkmcnt(8)
    v_smfmac_f32_16x16x64_bf16 v[244:247], v[66:69], v[104:111], v70
    v_exp_f32 v186, v186
    v_pk_fma_f32 v[184:185], v[234:235], v[182:183], v[184:185]
    v_pk_fma_f32 v[188:189], v[188:189], v[144:145], v[146:147]
    v_exp_f32 v187, v187
    v_add_f32 v184, v184, v185
    v_pk_mul_f32 v[188:189], v[188:189], v[238:239]
    v_min_u32 v184, -2, v184
    s_waitcnt vmcnt(9)
    v_lshlrev_b32_sdwa v104, 3, v120 dst_sel:DWORD dst_unused:UNUSED_PAD src0_sel:DWORD src1_sel:WORD_0
    v_lshlrev_b32_sdwa v106, 3, v120 dst_sel:DWORD dst_unused:UNUSED_PAD src0_sel:DWORD src1_sel:WORD_1
    ds_read_b64 v[104:105], v104
    ds_read_b64 v[106:107], v106
    v_lshlrev_b32_sdwa v108, 3, v121 dst_sel:DWORD dst_unused:UNUSED_PAD src0_sel:DWORD src1_sel:WORD_0
    v_lshlrev_b32_sdwa v110, 3, v121 dst_sel:DWORD dst_unused:UNUSED_PAD src0_sel:DWORD src1_sel:WORD_1
    ds_read_b64 v[108:109], v108
    ds_read_b64 v[110:111], v110
    s_waitcnt lgkmcnt(8)
    v_smfmac_f32_16x16x64_bf16 v[244:247], v[66:69], v[88:95], v70
    v_exp_f32 v188, v188
    buffer_store_dword v184, v76, s[12:15], s35 offen offset:1792 sc1
    v_pk_fma_f32 v[186:187], v[186:187], v[150:151], v[150:151]
    v_exp_f32 v189, v189
    s_waitcnt vmcnt(7)
    v_mfma_f32_4x4x4_16b_bf16 v[240:243], v[154:155], v[40:41], v[240:243]
    v_rcp_f32 v186, v186
    v_pk_fma_f32 v[188:189], v[188:189], v[152:153], v[152:153]
    v_lshlrev_b32_sdwa v88, 3, v122 dst_sel:DWORD dst_unused:UNUSED_PAD src0_sel:DWORD src1_sel:WORD_0
    v_lshlrev_b32_sdwa v90, 3, v122 dst_sel:DWORD dst_unused:UNUSED_PAD src0_sel:DWORD src1_sel:WORD_1
    ds_read_b64 v[88:89], v88
    ds_read_b64 v[90:91], v90
    v_lshlrev_b32_sdwa v92, 3, v123 dst_sel:DWORD dst_unused:UNUSED_PAD src0_sel:DWORD src1_sel:WORD_0
    v_lshlrev_b32_sdwa v94, 3, v123 dst_sel:DWORD dst_unused:UNUSED_PAD src0_sel:DWORD src1_sel:WORD_1
    ds_read_b64 v[92:93], v92
    ds_read_b64 v[94:95], v94
    s_waitcnt lgkmcnt(8)
    v_smfmac_f32_16x16x64_bf16 v[244:247], v[66:69], v[96:103], v70
    v_rcp_f32 v187, v187
    v_pk_mul_f32 v[156:157], v[240:241], v[240:241]
    v_pk_mul_f32 v[158:159], v[242:243], v[242:243]
    v_rcp_f32 v188, v188
    v_pk_mul_f32 v[190:191], v[236:237], v[186:187]
    v_pk_fma_f32 v[156:157], v[156:157], v[144:145], v[146:147]
    v_rcp_f32 v189, v189
    v_lshlrev_b32_sdwa v96, 3, v124 dst_sel:DWORD dst_unused:UNUSED_PAD src0_sel:DWORD src1_sel:WORD_0
    v_lshlrev_b32_sdwa v98, 3, v124 dst_sel:DWORD dst_unused:UNUSED_PAD src0_sel:DWORD src1_sel:WORD_1
    ds_read_b64 v[96:97], v96
    ds_read_b64 v[98:99], v98
    v_lshlrev_b32_sdwa v100, 3, v125 dst_sel:DWORD dst_unused:UNUSED_PAD src0_sel:DWORD src1_sel:WORD_0
    v_lshlrev_b32_sdwa v102, 3, v125 dst_sel:DWORD dst_unused:UNUSED_PAD src0_sel:DWORD src1_sel:WORD_1
    v_lshlrev_b32 v248, 16, v30
    v_and_b32 v249, s23, v30
    v_lshlrev_b32 v250, 16, v31
    v_and_b32 v251, s23, v31
    ds_read_b64 v[100:101], v100
    ds_read_b64 v[102:103], v102
    s_waitcnt lgkmcnt(8)
    v_smfmac_f32_16x16x64_bf16 v[248:251], v[66:69], v[104:111], v70
    buffer_load_dword v72, v76, s[52:55], 0 offen offset:32 sc1
    buffer_load_short_d16_hi v73, v79, s[56:59], 0 offen
    buffer_load_ushort v81, v78, s[60:63], s68 offen
    buffer_load_dword v82, v79, s[12:15], s69 offen sc1
    v_pk_fma_f32 v[190:191], v[238:239], v[188:189], v[190:191]
    v_pk_mul_f32 v[156:157], v[156:157], v[240:241]
    v_add_f32 v190, v190, v191
    v_lshlrev_b32_sdwa v104, 3, v126 dst_sel:DWORD dst_unused:UNUSED_PAD src0_sel:DWORD src1_sel:WORD_0
    v_lshlrev_b32_sdwa v106, 3, v126 dst_sel:DWORD dst_unused:UNUSED_PAD src0_sel:DWORD src1_sel:WORD_1
    ds_read_b64 v[104:105], v104
    ds_read_b64 v[106:107], v106
    v_lshlrev_b32_sdwa v108, 3, v127 dst_sel:DWORD dst_unused:UNUSED_PAD src0_sel:DWORD src1_sel:WORD_0
    v_lshlrev_b32_sdwa v110, 3, v127 dst_sel:DWORD dst_unused:UNUSED_PAD src0_sel:DWORD src1_sel:WORD_1
    ds_read_b64 v[108:109], v108
    ds_read_b64 v[110:111], v110
    s_waitcnt lgkmcnt(8)
    v_smfmac_f32_16x16x64_bf16 v[248:251], v[66:69], v[88:95], v70
    v_exp_f32 v156, v156
    v_min_u32 v190, -2, v190
    v_pk_fma_f32 v[158:159], v[158:159], v[144:145], v[146:147]
    v_exp_f32 v157, v157
    buffer_store_dword v190, v76, s[12:15], s35 offen offset:2048 sc1
    v_pk_mul_f32 v[158:159], v[158:159], v[242:243]
    v_pk_fma_f32 v[156:157], v[156:157], v[150:151], v[150:151]
    s_waitcnt vmcnt(9)
    v_lshlrev_b32_sdwa v88, 3, v128 dst_sel:DWORD dst_unused:UNUSED_PAD src0_sel:DWORD src1_sel:WORD_0
    v_lshlrev_b32_sdwa v90, 3, v128 dst_sel:DWORD dst_unused:UNUSED_PAD src0_sel:DWORD src1_sel:WORD_1
    ds_read_b64 v[88:89], v88
    ds_read_b64 v[90:91], v90
    v_lshlrev_b32_sdwa v92, 3, v129 dst_sel:DWORD dst_unused:UNUSED_PAD src0_sel:DWORD src1_sel:WORD_0
    v_lshlrev_b32_sdwa v94, 3, v129 dst_sel:DWORD dst_unused:UNUSED_PAD src0_sel:DWORD src1_sel:WORD_1
    ds_read_b64 v[92:93], v92
    ds_read_b64 v[94:95], v94
    s_waitcnt lgkmcnt(8)
    v_smfmac_f32_16x16x64_bf16 v[248:251], v[66:69], v[96:103], v70
    v_rcp_f32 v156, v156
    v_mfma_f32_4x4x4_16b_bf16 v[244:247], v[154:155], v[38:39], v[244:247]
    v_rcp_f32 v157, v157
    v_exp_f32 v158, v158
    v_exp_f32 v159, v159
    v_pk_mul_f32 v[160:161], v[240:241], v[156:157]
    v_lshlrev_b32_sdwa v96, 3, v130 dst_sel:DWORD dst_unused:UNUSED_PAD src0_sel:DWORD src1_sel:WORD_0
    v_lshlrev_b32_sdwa v98, 3, v130 dst_sel:DWORD dst_unused:UNUSED_PAD src0_sel:DWORD src1_sel:WORD_1
    ds_read_b64 v[96:97], v96
    ds_read_b64 v[98:99], v98
    v_lshlrev_b32_sdwa v100, 3, v131 dst_sel:DWORD dst_unused:UNUSED_PAD src0_sel:DWORD src1_sel:WORD_0
    v_lshlrev_b32_sdwa v102, 3, v131 dst_sel:DWORD dst_unused:UNUSED_PAD src0_sel:DWORD src1_sel:WORD_1
    ds_read_b64 v[100:101], v100
    ds_read_b64 v[102:103], v102
    s_waitcnt lgkmcnt(8)
    v_smfmac_f32_16x16x64_bf16 v[248:251], v[66:69], v[104:111], v70
    v_pk_fma_f32 v[158:159], v[158:159], v[152:153], v[152:153]
    v_pk_mul_f32 v[162:163], v[244:245], v[244:245]
    v_rcp_f32 v158, v158
    v_pk_fma_f32 v[162:163], v[162:163], v[144:145], v[146:147]
    v_pk_mul_f32 v[164:165], v[246:247], v[246:247]
    v_rcp_f32 v159, v159
    v_pk_mul_f32 v[162:163], v[162:163], v[244:245]
    s_waitcnt vmcnt(8)
    v_lshlrev_b32_sdwa v104, 3, v132 dst_sel:DWORD dst_unused:UNUSED_PAD src0_sel:DWORD src1_sel:WORD_0
    v_lshlrev_b32_sdwa v106, 3, v132 dst_sel:DWORD dst_unused:UNUSED_PAD src0_sel:DWORD src1_sel:WORD_1
    ds_read_b64 v[104:105], v104
    ds_read_b64 v[106:107], v106
    v_lshlrev_b32_sdwa v108, 3, v133 dst_sel:DWORD dst_unused:UNUSED_PAD src0_sel:DWORD src1_sel:WORD_0
    v_lshlrev_b32_sdwa v110, 3, v133 dst_sel:DWORD dst_unused:UNUSED_PAD src0_sel:DWORD src1_sel:WORD_1
    v_lshlrev_b32 v252, 16, v0
    v_and_b32 v253, s23, v0
    v_lshlrev_b32 v254, 16, v1
    v_and_b32 v255, s23, v1
    ds_read_b64 v[108:109], v108
    ds_read_b64 v[110:111], v110
    s_waitcnt lgkmcnt(8)
    v_smfmac_f32_16x16x64_bf16 v[252:255], v[66:69], v[88:95], v70
    s_setprio 0
    v_exp_f32 v162, v162
    v_pk_fma_f32 v[160:161], v[242:243], v[158:159], v[160:161]
    v_pk_fma_f32 v[164:165], v[164:165], v[144:145], v[146:147]
    v_exp_f32 v163, v163
    v_add_f32 v160, v160, v161
    v_pk_mul_f32 v[164:165], v[164:165], v[246:247]
    v_min_u32 v160, -2, v160
    v_lshlrev_b32_sdwa v88, 3, v134 dst_sel:DWORD dst_unused:UNUSED_PAD src0_sel:DWORD src1_sel:WORD_0
    v_lshlrev_b32_sdwa v90, 3, v134 dst_sel:DWORD dst_unused:UNUSED_PAD src0_sel:DWORD src1_sel:WORD_1
    ds_read_b64 v[88:89], v88
    ds_read_b64 v[90:91], v90
    v_lshlrev_b32_sdwa v92, 3, v135 dst_sel:DWORD dst_unused:UNUSED_PAD src0_sel:DWORD src1_sel:WORD_0
    v_lshlrev_b32_sdwa v94, 3, v135 dst_sel:DWORD dst_unused:UNUSED_PAD src0_sel:DWORD src1_sel:WORD_1
    ds_read_b64 v[92:93], v92
    ds_read_b64 v[94:95], v94
    s_waitcnt lgkmcnt(8)
    v_smfmac_f32_16x16x64_bf16 v[252:255], v[66:69], v[96:103], v70
    v_exp_f32 v164, v164
    buffer_store_dword v160, v76, s[12:15], s35 offen offset:2304 sc1
    v_pk_fma_f32 v[162:163], v[162:163], v[150:151], v[150:151]
    v_exp_f32 v165, v165
    v_mfma_f32_4x4x4_16b_bf16 v[248:251], v[154:155], v[36:37], v[248:251]
    v_rcp_f32 v162, v162
    v_pk_fma_f32 v[164:165], v[164:165], v[152:153], v[152:153]
    s_waitcnt lgkmcnt(4)
    v_smfmac_f32_16x16x64_bf16 v[252:255], v[66:69], v[104:111], v70
    v_rcp_f32 v163, v163
    v_rcp_f32 v164, v164
    v_pk_mul_f32 v[168:169], v[248:249], v[248:249]
    v_pk_mul_f32 v[166:167], v[244:245], v[162:163]
    v_rcp_f32 v165, v165
    v_pk_fma_f32 v[168:169], v[168:169], v[144:145], v[146:147]
    v_pk_mul_f32 v[170:171], v[250:251], v[250:251]
    s_waitcnt lgkmcnt(0)
    v_smfmac_f32_16x16x64_bf16 v[252:255], v[66:69], v[88:95], v70
    v_pk_fma_f32 v[166:167], v[246:247], v[164:165], v[166:167]
    v_pk_mul_f32 v[168:169], v[168:169], v[248:249]
    v_add_f32 v166, v166, v167
    v_exp_f32 v168, v168
    v_min_u32 v166, -2, v166
    v_pk_fma_f32 v[170:171], v[170:171], v[144:145], v[146:147]
    v_exp_f32 v169, v169
    buffer_store_dword v166, v76, s[12:15], s35 offen offset:2560 sc1
    v_pk_mul_f32 v[170:171], v[170:171], v[250:251]
    v_pk_fma_f32 v[168:169], v[168:169], v[150:151], v[150:151]
    v_exp_f32 v170, v170
    v_mfma_f32_4x4x4_16b_bf16 v[252:255], v[154:155], v[34:35], v[252:255]
    v_rcp_f32 v168, v168
    v_rcp_f32 v169, v169
    v_exp_f32 v171, v171
    s_nop 0
    v_pk_mul_f32 v[172:173], v[248:249], v[168:169]
    v_pk_fma_f32 v[170:171], v[170:171], v[152:153], v[152:153]
    v_pk_mul_f32 v[174:175], v[252:253], v[252:253]
    v_rcp_f32 v170, v170
    v_pk_fma_f32 v[174:175], v[174:175], v[144:145], v[146:147]
    v_pk_mul_f32 v[176:177], v[254:255], v[254:255]
    v_rcp_f32 v171, v171
    v_pk_mul_f32 v[174:175], v[174:175], v[252:253]
    v_pk_fma_f32 v[176:177], v[176:177], v[144:145], v[146:147]
    v_exp_f32 v174, v174
    v_pk_fma_f32 v[172:173], v[250:251], v[170:171], v[172:173]
    v_pk_mul_f32 v[176:177], v[176:177], v[254:255]
    v_exp_f32 v175, v175
    v_add_f32 v172, v172, v173
    v_exp_f32 v176, v176
    v_min_u32 v172, -2, v172
    v_pk_fma_f32 v[174:175], v[174:175], v[150:151], v[150:151]
    v_exp_f32 v177, v177
    buffer_store_dword v172, v76, s[12:15], s35 offen offset:2816 sc1
    v_rcp_f32 v174, v174
    v_pk_fma_f32 v[176:177], v[176:177], v[152:153], v[152:153]
    v_rcp_f32 v175, v175
    v_rcp_f32 v176, v176
    v_rcp_f32 v177, v177
    v_pk_mul_f32 v[178:179], v[252:253], v[174:175]
    s_nop 0
    v_pk_fma_f32 v[178:179], v[254:255], v[176:177], v[178:179]
    s_nop 0
    v_add_f32 v178, v178, v179
    s_nop 0
    v_min_u32 v178, -2, v178
    s_nop 0
    buffer_store_dword v178, v76, s[12:15], s35 offen offset:3072 sc1
    s_waitcnt vmcnt(5)

    v_cmp_ne_u32 vcc, 128, v72
    s_and_b32 s44, vcc_hi, 0x1
    s_and_b32 s45, vcc_lo, 0x1
    s_or_b32 s45, s45, s44
    s_cbranch_scc1 k1_kernel_rslow

k1_kernel_rjob:

    s_lshl_b32 s67, s64, 8
    s_add_u32 s68, s67, 29360128
    s_add_u32 s69, s68, 65536
    s_add_u32 s67, s67, 20971520

k1_kernel_rgrp:

    s_add_u32 s70, s67, s65
    s_add_u32 s71, s70, 262144
    s_add_u32 s72, s70, 524288
    s_add_u32 s73, s70, 786432
    s_add_u32 s65, s65, 1048576

    buffer_load_dwordx4 v[0:3], v74, s[12:15], s70 offen sc1
    buffer_load_dwordx4 v[4:7], v74, s[12:15], s71 offen sc1
    buffer_load_dwordx4 v[8:11], v74, s[12:15], s72 offen sc1
    buffer_load_dwordx4 v[12:15], v74, s[12:15], s73 offen sc1
    buffer_load_dword v16, v75, s[12:15], s68 offen sc1
    buffer_load_dword v17, v75, s[12:15], s69 offen sc1
    s_branch k1_kernel_rchk
k1_kernel_rpoll:
    s_mov_b64 exec, s[74:75]
    s_cbranch_execz k1_kernel_rsk0
    buffer_load_dwordx4 v[0:3], v74, s[12:15], s70 offen sc1
k1_kernel_rsk0:
    s_mov_b64 exec, s[76:77]
    s_cbranch_execz k1_kernel_rsk1
    buffer_load_dwordx4 v[4:7], v74, s[12:15], s71 offen sc1
k1_kernel_rsk1:
    s_mov_b64 exec, s[78:79]
    s_cbranch_execz k1_kernel_rsk2
    buffer_load_dwordx4 v[8:11], v74, s[12:15], s72 offen sc1
k1_kernel_rsk2:
    s_mov_b64 exec, s[80:81]
    s_cbranch_execz k1_kernel_rsk3
    buffer_load_dwordx4 v[12:15], v74, s[12:15], s73 offen sc1
k1_kernel_rsk3:
    s_mov_b64 exec, -1
k1_kernel_rchk:
    s_waitcnt vmcnt(0)
k1_kernel_rchk0:
    v_max3_u32 v20, v0, v1, v2
    v_max3_u32 v21, v4, v5, v6
    v_max3_u32 v22, v8, v9, v10
    v_max3_u32 v23, v12, v13, v14
    v_max_u32 v20, v20, v3
    v_max_u32 v21, v21, v7
    v_max_u32 v22, v22, v11
    v_max_u32 v23, v23, v15
    v_cmp_eq_u32 s[74:75], -1, v20
    v_cmp_eq_u32 s[76:77], -1, v21
    v_cmp_eq_u32 s[78:79], -1, v22
    v_cmp_eq_u32 s[80:81], -1, v23

    v_pk_add_f32 v[26:27], v[0:1], v[4:5]
    v_pk_add_f32 v[28:29], v[2:3], v[6:7]
    v_pk_add_f32 v[30:31], v[8:9], v[12:13]
    v_pk_add_f32 v[32:33], v[10:11], v[14:15]
    s_or_b64 s[82:83], s[74:75], s[76:77]
    s_or_b64 s[84:85], s[78:79], s[80:81]
    v_pk_add_f32 v[26:27], v[26:27], v[30:31]
    v_pk_add_f32 v[28:29], v[28:29], v[32:33]
    s_or_b64 s[82:83], s[82:83], s[84:85]
    s_cbranch_scc1 k1_kernel_rpoll
    v_permlane32_swap_b32 v26, v28
    v_permlane32_swap_b32 v27, v29
    s_cmp_lt_u32 s65, s66
    s_nop 0
    v_pk_add_f32 v[26:27], v[26:27], v[28:29]
    s_nop 1
    v_permlane16_swap_b32 v26, v27
    s_nop 1
    v_add_f32 v26, v26, v27
    v_add_f32 v79, v79, v26
    s_cbranch_scc1 k1_kernel_rgrp
    s_cmp_lg_u32 s43, 0
    s_cbranch_scc1 k1_kernel_rpn
    ds_write_b32 v77, v79
    v_add_u32 v21, 0x10000, v77
    s_cmp_lg_u32 s3, 0
    s_waitcnt lgkmcnt(0)
    s_barrier
    s_cbranch_scc1 k1_kernel_rend

    ds_read2st64_b32 v[40:41], v77 offset0:0 offset1:64
    ds_read2st64_b32 v[42:43], v77 offset0:128 offset1:192
    ds_read2st64_b32 v[44:45], v21 offset0:0 offset1:64
    ds_read2st64_b32 v[46:47], v21 offset0:128 offset1:192

    s_waitcnt lgkmcnt(2)
    v_pk_add_f32 v[26:27], v[40:41], v[42:43]
    v_max3_u32 v20, v41, v42, v43
    s_waitcnt lgkmcnt(0)
    v_pk_add_f32 v[28:29], v[44:45], v[46:47]
    v_max3_u32 v20, v20, v44, v45
    v_pk_add_f32 v[26:27], v[26:27], v[28:29]
    v_max3_u32 v20, v20, v46, v47
    v_add_f32 v79, v26, v27
    v_cmp_eq_u32 vcc, -1, v20
    s_cbranch_vccnz k1_kernel_rnext

k1_kernel_rpn:

    v_max_u32 v20, v16, v17
    v_add_f32 v21, v16, v17
    v_cmp_eq_u32 vcc, -1, v20
    v_cvt_pk_bf16_f32 v21, v79, v21
    s_cbranch_vccnz k1_kernel_rpn2
    v_lshlrev_b32 v22, 16, v21
    v_and_b32 v21, 0xffff0000, v21
    v_add_f32 v22, v22, v73
    v_cvt_pk_bf16_f32 v22, v22, v22
    v_lshlrev_b32 v22, 16, v22
    v_add_f32 v22, v22, v21
    s_lshl_b32 s45, s64, 7
    v_cvt_pk_bf16_f32 v22, v22, v22
    buffer_store_short v22, v78, s[60:63], s45 offen

k1_kernel_rnext:

    v_cmp_ne_u32 vcc, 0, v72
    s_and_b32 s45, vcc_lo, 0xff00
    s_cbranch_scc1 k1_kernel_rmore

k1_kernel_rend:
    s_endpgm
k1_kernel_rpn2:
    buffer_load_dword v16, v75, s[12:15], s68 offen sc1
    buffer_load_dword v17, v75, s[12:15], s69 offen sc1
    s_waitcnt vmcnt(0)
    s_branch k1_kernel_rpn
k1_kernel_rmore:

    s_ff1_i32_b32 s45, s45
    s_mov_b32 s43, 1
    s_mov_b32 s65, 0
    s_mov_b32 s66, 8388608
    v_readlane_b32 s44, v72, s45
    v_mov_b32 v79, 0
    s_mov_b32 m0, s45
    s_ff1_i32_b32 s64, s44
    s_bitset0_b32 s44, s64
    s_sub_u32 s45, s45, 8
    s_lshl_b32 s45, s45, 5
    s_add_u32 s64, s64, s45
    v_writelane_b32 v72, s44, m0
    s_branch k1_kernel_rjob

k1_kernel_rslow:
    s_lshl_b32 s65, s3, 20
    buffer_load_dword v72, v76, s[52:55], 0 offen offset:32 sc1
    s_waitcnt vmcnt(0)

    v_cmp_ne_u32 vcc, 128, v72
    s_and_b32 s44, vcc_hi, 0x1
    s_and_b32 s45, vcc_lo, 0x1
    s_or_b32 s45, s45, s44
    s_cbranch_scc0 k1_kernel_rjob

    s_add_u32 s42, s42, 1
    s_cmp_lt_u32 s42, 200
    s_cbranch_scc1 k1_kernel_rslow
    s_lshl_b32 s44, 1, s64
    s_lshr_b32 s45, s64, 5
    s_lshl_b32 s45, s45, 2
    v_mov_b32 v20, s44
    s_mov_b64 exec, 1
    buffer_atomic_or v20, v76, s[52:55], s45 offen offset:64 sc0
    s_mov_b64 exec, -1
    s_waitcnt vmcnt(0)
    buffer_load_dword v72, v76, s[52:55], 0 offen offset:32 sc1
    s_waitcnt vmcnt(0)

    v_cmp_ne_u32 vcc, 128, v72
    s_and_b32 s44, vcc_hi, 0x1
    s_and_b32 s45, vcc_lo, 0x1
    s_or_b32 s45, s45, s44
    s_cbranch_scc0 k1_kernel_rjob

    v_mov_b32 v20, -1
    ds_write_b32 v77, v20
    s_waitcnt lgkmcnt(0)
    s_endpgm

k1_kernel_xw0:

    buffer_load_dword v85, off, s[12:15], s47 sc1
    s_waitcnt vmcnt(0)
    v_readfirstlane_b32 s44, v85
    s_cmp_le_u32 s44, 0
    s_cbranch_scc1 k1_kernel_xw0
    s_branch k1_kernel_xb0

k1_kernel_xw1:

    buffer_load_dword v85, off, s[12:15], s47 sc1
    s_waitcnt vmcnt(0)
    v_readfirstlane_b32 s44, v85
    s_cmp_le_u32 s44, 1
    s_cbranch_scc1 k1_kernel_xw1
    s_branch k1_kernel_xb1

k1_kernel_xw2:

    buffer_load_dword v85, off, s[12:15], s47 sc1
    s_waitcnt vmcnt(0)
    v_readfirstlane_b32 s44, v85
    s_cmp_le_u32 s44, 2
    s_cbranch_scc1 k1_kernel_xw2
    s_branch k1_kernel_xb2

k1_kernel_xw3:

    buffer_load_dword v85, off, s[12:15], s47 sc1
    s_waitcnt vmcnt(0)
    v_readfirstlane_b32 s44, v85
    s_cmp_le_u32 s44, 3
    s_cbranch_scc1 k1_kernel_xw3
    s_branch k1_kernel_xb3

k1_kernel_solo1:
    s_mov_b32 s48, 1
    s_add_u32 s16, s16, 33554432
    s_add_u32 s46, s46, 33554432
    s_mov_b32 s18, s16
    s_mov_b32 s47, s46
    s_xor_b32 s49, s34, 1
    s_branch k1_kernel_solo3
k1_kernel_solo2:
    s_mov_b32 s48, 2
    s_waitcnt vmcnt(0)
    v_mov_b32 v0, 4
    buffer_store_dword v0, off, s[12:15], s46 sc1

    s_lshl_b32 s16, s2, 3
    s_add_u32 s16, s16, s3
    s_lshl_b32 s46, s16, 7
    s_lshl_b32 s16, s16, 13
    s_add_u32 s46, s46, 30408704
    s_add_u32 s16, s16, 33554432

    s_mov_b32 s49, s34
k1_kernel_solo3:
    s_load_dwordx2 s[4:5], s[0:1], 8
    s_mov_b32 s6, 256000
    s_mov_b32 s7, 0x00020000

    s_mul_i32 s21, s33, 102656
    s_mul_i32 s35, s49, 49152
    s_sub_u32 s22, 53248, s35
    s_add_u32 s21, s21, s35
    s_lshl_b32 s35, s50, 11
    s_xor_b32 s19, s35, 2048
    s_add_u32 s19, s19, s21
    s_add_u32 s21, s21, s35
    s_mul_i32 s20, s49, 1703936
    s_add_u32 s20, s20, 16777216
    s_lshl_b32 s35, s3, 14
    s_add_u32 s20, s20, s35

    s_waitcnt vmcnt(0) lgkmcnt(0)
    s_and_b32 s5, s5, 0xffff
    s_barrier
    v_bfe_u32 v1, v71, 4, 4
    v_lshrrev_b32 v2, 8, v71
    v_lshlrev_b32 v65, 8, v1
    v_lshl_add_u32 v65, v2, 4, v65
    v_and_b32 v70, 0x0fffffff, v70
    v_lshrrev_b32 v64, 16, v70
    v_lshlrev_b32 v64, 3, v64
    s_lshl_b32 s44, s3, 15
    s_lshl_b32 s45, s50, 7
    s_add_u32 s44, s44, s45
    s_xor_b32 s45, s44, 128

    buffer_load_dwordx4 v[128:131], v65, s[4:7], s44 offen offset:0
    buffer_load_dwordx4 v[132:135], v65, s[4:7], s44 offen offset:64
    buffer_load_dwordx4 v[136:139], v65, s[4:7], s45 offen offset:0
    buffer_load_dwordx4 v[140:143], v65, s[4:7], s45 offen offset:64
    s_add_u32 s44, s44, 4096
    s_add_u32 s45, s45, 4096
    buffer_load_dwordx4 v[144:147], v65, s[4:7], s44 offen offset:0
    buffer_load_dwordx4 v[148:151], v65, s[4:7], s44 offen offset:64
    buffer_load_dwordx4 v[152:155], v65, s[4:7], s45 offen offset:0
    buffer_load_dwordx4 v[156:159], v65, s[4:7], s45 offen offset:64
    s_add_u32 s44, s44, 4096
    s_add_u32 s45, s45, 4096
    buffer_load_dwordx4 v[160:163], v65, s[4:7], s44 offen offset:0
    buffer_load_dwordx4 v[164:167], v65, s[4:7], s44 offen offset:64
    buffer_load_dwordx4 v[168:171], v65, s[4:7], s45 offen offset:0
    buffer_load_dwordx4 v[172:175], v65, s[4:7], s45 offen offset:64
    s_add_u32 s44, s44, 4096
    s_add_u32 s45, s45, 4096
    buffer_load_dwordx4 v[176:179], v65, s[4:7], s44 offen offset:0
    buffer_load_dwordx4 v[180:183], v65, s[4:7], s44 offen offset:64
    buffer_load_dwordx4 v[184:187], v65, s[4:7], s45 offen offset:0
    buffer_load_dwordx4 v[188:191], v65, s[4:7], s45 offen offset:64
    s_add_u32 s44, s44, 4096
    s_add_u32 s45, s45, 4096
    buffer_load_dwordx4 v[192:195], v65, s[4:7], s44 offen offset:0
    buffer_load_dwordx4 v[196:199], v65, s[4:7], s44 offen offset:64
    buffer_load_dwordx4 v[200:203], v65, s[4:7], s45 offen offset:0
    buffer_load_dwordx4 v[204:207], v65, s[4:7], s45 offen offset:64
    s_add_u32 s44, s44, 4096
    s_add_u32 s45, s45, 4096
    buffer_load_dwordx4 v[208:211], v65, s[4:7], s44 offen offset:0
    buffer_load_dwordx4 v[212:215], v65, s[4:7], s44 offen offset:64
    buffer_load_dwordx4 v[216:219], v65, s[4:7], s45 offen offset:0
    buffer_load_dwordx4 v[220:223], v65, s[4:7], s45 offen offset:64
    s_add_u32 s44, s44, 4096
    s_add_u32 s45, s45, 4096
    buffer_load_dwordx4 v[224:227], v65, s[4:7], s44 offen offset:0
    buffer_load_dwordx4 v[228:231], v65, s[4:7], s44 offen offset:64
    buffer_load_dwordx4 v[232:235], v65, s[4:7], s45 offen offset:0
    buffer_load_dwordx4 v[236:239], v65, s[4:7], s45 offen offset:64
    s_add_u32 s44, s44, 4096
    s_add_u32 s45, s45, 4096
    buffer_load_dwordx4 v[240:243], v65, s[4:7], s44 offen offset:0
    buffer_load_dwordx4 v[244:247], v65, s[4:7], s44 offen offset:64
    buffer_load_dwordx4 v[248:251], v65, s[4:7], s45 offen offset:0
    buffer_load_dwordx4 v[252:255], v65, s[4:7], s45 offen offset:64
    s_add_u32 s44, s44, 4096
    s_add_u32 s45, s45, 4096
    buffer_load_dwordx4 v[0:3], v71, s[12:15], s21 offen offset:0
    buffer_load_dwordx4 v[4:7], v71, s[12:15], s21 offen offset:1024
    buffer_load_dwordx4 v[8:11], v71, s[12:15], s19 offen offset:0
    buffer_load_dwordx4 v[12:15], v71, s[12:15], s19 offen offset:1024
    s_add_u32 s21, s21, 4096
    s_add_u32 s19, s19, 4096
    buffer_load_dwordx4 v[16:19], v71, s[12:15], s21 offen offset:0
    buffer_load_dwordx4 v[20:23], v71, s[12:15], s21 offen offset:1024
    buffer_load_dwordx4 v[24:27], v71, s[12:15], s19 offen offset:0
    buffer_load_dwordx4 v[28:31], v71, s[12:15], s19 offen offset:1024
    s_add_u32 s21, s21, 4096
    s_add_u32 s19, s19, 4096
    buffer_load_dwordx4 v[32:35], v71, s[12:15], s21 offen offset:0
    buffer_load_dwordx4 v[36:39], v71, s[12:15], s21 offen offset:1024
    buffer_load_dwordx4 v[40:43], v71, s[12:15], s19 offen offset:0
    buffer_load_dwordx4 v[44:47], v71, s[12:15], s19 offen offset:1024
    s_add_u32 s21, s21, 4096
    s_add_u32 s19, s19, 4096
    buffer_load_dwordx4 v[72:75], v71, s[12:15], s21 offen offset:0
    buffer_load_dwordx4 v[76:79], v71, s[12:15], s21 offen offset:1024
    buffer_load_dwordx4 v[80:83], v71, s[12:15], s19 offen offset:0
    buffer_load_dwordx4 v[84:87], v71, s[12:15], s19 offen offset:1024
    s_add_u32 s21, s21, 4096
    s_add_u32 s19, s19, 4096
    buffer_load_dwordx2 v[116:117], v71, s[12:15], s20 offen offset:0 sc1
    buffer_load_dwordx2 v[118:119], v71, s[12:15], s20 offen offset:1024 sc1
    buffer_load_dwordx2 v[120:121], v71, s[12:15], s20 offen offset:2048 sc1
    buffer_load_dwordx2 v[122:123], v71, s[12:15], s20 offen offset:3072 sc1
    s_add_u32 s20, s20, 4096
    buffer_load_dwordx2 v[124:125], v71, s[12:15], s20 offen offset:0 sc1
    buffer_load_dwordx2 v[126:127], v71, s[12:15], s20 offen offset:1024 sc1
    s_waitcnt vmcnt(0)
    v_mfma_f32_16x16x32_bf16 v[96:99], v[0:3], v[128:131], 0
    v_mfma_f32_16x16x32_bf16 v[100:103], v[0:3], v[144:147], 0
    v_mfma_f32_16x16x32_bf16 v[96:99], v[4:7], v[132:135], v[96:99]
    v_mfma_f32_16x16x32_bf16 v[100:103], v[4:7], v[148:151], v[100:103]
    v_mfma_f32_16x16x32_bf16 v[96:99], v[8:11], v[136:139], v[96:99]
    v_mfma_f32_16x16x32_bf16 v[100:103], v[8:11], v[152:155], v[100:103]
    v_mfma_f32_16x16x32_bf16 v[96:99], v[12:15], v[140:143], v[96:99]
    v_mfma_f32_16x16x32_bf16 v[100:103], v[12:15], v[156:159], v[100:103]
    v_mfma_f32_16x16x32_bf16 v[104:107], v[0:3], v[160:163], 0
    v_mfma_f32_16x16x32_bf16 v[108:111], v[0:3], v[176:179], 0
    v_mfma_f32_16x16x32_bf16 v[104:107], v[4:7], v[164:167], v[104:107]
    v_cvt_pk_bf16_f32 v96, v96, v97
    v_mfma_f32_16x16x32_bf16 v[108:111], v[4:7], v[180:183], v[108:111]
    v_cvt_pk_bf16_f32 v97, v98, v99
    v_mfma_f32_16x16x32_bf16 v[104:107], v[8:11], v[168:171], v[104:107]
    ds_write_b64 v64, v[96:97] offset:0
    v_mfma_f32_16x16x32_bf16 v[108:111], v[8:11], v[184:187], v[108:111]
    v_cvt_pk_bf16_f32 v100, v100, v101
    v_mfma_f32_16x16x32_bf16 v[104:107], v[12:15], v[172:175], v[104:107]
    v_cvt_pk_bf16_f32 v101, v102, v103
    v_mfma_f32_16x16x32_bf16 v[108:111], v[12:15], v[188:191], v[108:111]
    ds_write_b64 v64, v[100:101] offset:128
    v_mfma_f32_16x16x32_bf16 v[88:91], v[0:3], v[192:195], 0
    v_mfma_f32_16x16x32_bf16 v[92:95], v[0:3], v[208:211], 0
    v_mfma_f32_16x16x32_bf16 v[88:91], v[4:7], v[196:199], v[88:91]
    v_cvt_pk_bf16_f32 v104, v104, v105
    v_mfma_f32_16x16x32_bf16 v[92:95], v[4:7], v[212:215], v[92:95]
    v_cvt_pk_bf16_f32 v105, v106, v107
    v_mfma_f32_16x16x32_bf16 v[88:91], v[8:11], v[200:203], v[88:91]
    ds_write_b64 v64, v[104:105] offset:256
    v_mfma_f32_16x16x32_bf16 v[92:95], v[8:11], v[216:219], v[92:95]
    v_cvt_pk_bf16_f32 v108, v108, v109
    v_mfma_f32_16x16x32_bf16 v[88:91], v[12:15], v[204:207], v[88:91]
    v_cvt_pk_bf16_f32 v109, v110, v111
    v_mfma_f32_16x16x32_bf16 v[92:95], v[12:15], v[220:223], v[92:95]
    ds_write_b64 v64, v[108:109] offset:384
    v_mfma_f32_16x16x32_bf16 v[96:99], v[0:3], v[224:227], 0
    v_mfma_f32_16x16x32_bf16 v[100:103], v[0:3], v[240:243], 0
    v_mfma_f32_16x16x32_bf16 v[96:99], v[4:7], v[228:231], v[96:99]
    v_cvt_pk_bf16_f32 v88, v88, v89
    v_mfma_f32_16x16x32_bf16 v[100:103], v[4:7], v[244:247], v[100:103]
    v_cvt_pk_bf16_f32 v89, v90, v91
    v_mfma_f32_16x16x32_bf16 v[96:99], v[8:11], v[232:235], v[96:99]
    ds_write_b64 v64, v[88:89] offset:512
    v_mfma_f32_16x16x32_bf16 v[100:103], v[8:11], v[248:251], v[100:103]
    v_cvt_pk_bf16_f32 v92, v92, v93
    v_mfma_f32_16x16x32_bf16 v[96:99], v[12:15], v[236:239], v[96:99]
    v_cvt_pk_bf16_f32 v93, v94, v95
    v_mfma_f32_16x16x32_bf16 v[100:103], v[12:15], v[252:255], v[100:103]
    ds_write_b64 v64, v[92:93] offset:640
    s_nop 7
    v_cvt_pk_bf16_f32 v96, v96, v97
    v_cvt_pk_bf16_f32 v97, v98, v99
    ds_write_b64 v64, v[96:97] offset:768
    v_cvt_pk_bf16_f32 v100, v100, v101
    v_cvt_pk_bf16_f32 v101, v102, v103
    ds_write_b64 v64, v[100:101] offset:896
    v_add_u32 v64, 0x8000, v64
    v_mfma_f32_16x16x32_bf16 v[104:107], v[16:19], v[128:131], 0
    v_mfma_f32_16x16x32_bf16 v[108:111], v[16:19], v[144:147], 0
    v_mfma_f32_16x16x32_bf16 v[104:107], v[20:23], v[132:135], v[104:107]
    v_mfma_f32_16x16x32_bf16 v[108:111], v[20:23], v[148:151], v[108:111]
    v_mfma_f32_16x16x32_bf16 v[104:107], v[24:27], v[136:139], v[104:107]
    v_mfma_f32_16x16x32_bf16 v[108:111], v[24:27], v[152:155], v[108:111]
    v_mfma_f32_16x16x32_bf16 v[104:107], v[28:31], v[140:143], v[104:107]
    v_mfma_f32_16x16x32_bf16 v[108:111], v[28:31], v[156:159], v[108:111]
    v_mfma_f32_16x16x32_bf16 v[88:91], v[16:19], v[160:163], 0
    v_mfma_f32_16x16x32_bf16 v[92:95], v[16:19], v[176:179], 0
    v_mfma_f32_16x16x32_bf16 v[88:91], v[20:23], v[164:167], v[88:91]
    v_cvt_pk_bf16_f32 v104, v104, v105
    v_mfma_f32_16x16x32_bf16 v[92:95], v[20:23], v[180:183], v[92:95]
    v_cvt_pk_bf16_f32 v105, v106, v107
    v_mfma_f32_16x16x32_bf16 v[88:91], v[24:27], v[168:171], v[88:91]
    ds_write_b64 v64, v[104:105] offset:0
    v_mfma_f32_16x16x32_bf16 v[92:95], v[24:27], v[184:187], v[92:95]
    v_cvt_pk_bf16_f32 v108, v108, v109
    v_mfma_f32_16x16x32_bf16 v[88:91], v[28:31], v[172:175], v[88:91]
    v_cvt_pk_bf16_f32 v109, v110, v111
    v_mfma_f32_16x16x32_bf16 v[92:95], v[28:31], v[188:191], v[92:95]
    ds_write_b64 v64, v[108:109] offset:128
    v_mfma_f32_16x16x32_bf16 v[96:99], v[16:19], v[192:195], 0
    v_mfma_f32_16x16x32_bf16 v[100:103], v[16:19], v[208:211], 0
    v_mfma_f32_16x16x32_bf16 v[96:99], v[20:23], v[196:199], v[96:99]
    v_cvt_pk_bf16_f32 v88, v88, v89
    v_mfma_f32_16x16x32_bf16 v[100:103], v[20:23], v[212:215], v[100:103]
    v_cvt_pk_bf16_f32 v89, v90, v91
    v_mfma_f32_16x16x32_bf16 v[96:99], v[24:27], v[200:203], v[96:99]
    ds_write_b64 v64, v[88:89] offset:256
    v_mfma_f32_16x16x32_bf16 v[100:103], v[24:27], v[216:219], v[100:103]
    v_cvt_pk_bf16_f32 v92, v92, v93
    v_mfma_f32_16x16x32_bf16 v[96:99], v[28:31], v[204:207], v[96:99]
    v_cvt_pk_bf16_f32 v93, v94, v95
    v_mfma_f32_16x16x32_bf16 v[100:103], v[28:31], v[220:223], v[100:103]
    ds_write_b64 v64, v[92:93] offset:384
    v_mfma_f32_16x16x32_bf16 v[104:107], v[16:19], v[224:227], 0
    v_mfma_f32_16x16x32_bf16 v[108:111], v[16:19], v[240:243], 0
    v_mfma_f32_16x16x32_bf16 v[104:107], v[20:23], v[228:231], v[104:107]
    v_cvt_pk_bf16_f32 v96, v96, v97
    v_mfma_f32_16x16x32_bf16 v[108:111], v[20:23], v[244:247], v[108:111]
    v_cvt_pk_bf16_f32 v97, v98, v99
    v_mfma_f32_16x16x32_bf16 v[104:107], v[24:27], v[232:235], v[104:107]
    ds_write_b64 v64, v[96:97] offset:512
    v_mfma_f32_16x16x32_bf16 v[108:111], v[24:27], v[248:251], v[108:111]
    v_cvt_pk_bf16_f32 v100, v100, v101
    v_mfma_f32_16x16x32_bf16 v[104:107], v[28:31], v[236:239], v[104:107]
    v_cvt_pk_bf16_f32 v101, v102, v103
    v_mfma_f32_16x16x32_bf16 v[108:111], v[28:31], v[252:255], v[108:111]
    ds_write_b64 v64, v[100:101] offset:640
    s_nop 7
    v_cvt_pk_bf16_f32 v104, v104, v105
    v_cvt_pk_bf16_f32 v105, v106, v107
    ds_write_b64 v64, v[104:105] offset:768
    v_cvt_pk_bf16_f32 v108, v108, v109
    v_cvt_pk_bf16_f32 v109, v110, v111
    ds_write_b64 v64, v[108:109] offset:896
    v_add_u32 v64, 0x8000, v64
    v_mfma_f32_16x16x32_bf16 v[88:91], v[32:35], v[128:131], 0
    v_mfma_f32_16x16x32_bf16 v[92:95], v[32:35], v[144:147], 0
    v_mfma_f32_16x16x32_bf16 v[88:91], v[36:39], v[132:135], v[88:91]
    v_mfma_f32_16x16x32_bf16 v[92:95], v[36:39], v[148:151], v[92:95]
    v_mfma_f32_16x16x32_bf16 v[88:91], v[40:43], v[136:139], v[88:91]
    v_mfma_f32_16x16x32_bf16 v[92:95], v[40:43], v[152:155], v[92:95]
    v_mfma_f32_16x16x32_bf16 v[88:91], v[44:47], v[140:143], v[88:91]
    v_mfma_f32_16x16x32_bf16 v[92:95], v[44:47], v[156:159], v[92:95]
    v_mfma_f32_16x16x32_bf16 v[96:99], v[32:35], v[160:163], 0
    v_mfma_f32_16x16x32_bf16 v[100:103], v[32:35], v[176:179], 0
    v_mfma_f32_16x16x32_bf16 v[96:99], v[36:39], v[164:167], v[96:99]
    v_cvt_pk_bf16_f32 v88, v88, v89
    v_mfma_f32_16x16x32_bf16 v[100:103], v[36:39], v[180:183], v[100:103]
    v_cvt_pk_bf16_f32 v89, v90, v91
    v_mfma_f32_16x16x32_bf16 v[96:99], v[40:43], v[168:171], v[96:99]
    ds_write_b64 v64, v[88:89] offset:0
    v_mfma_f32_16x16x32_bf16 v[100:103], v[40:43], v[184:187], v[100:103]
    v_cvt_pk_bf16_f32 v92, v92, v93
    v_mfma_f32_16x16x32_bf16 v[96:99], v[44:47], v[172:175], v[96:99]
    v_cvt_pk_bf16_f32 v93, v94, v95
    v_mfma_f32_16x16x32_bf16 v[100:103], v[44:47], v[188:191], v[100:103]
    ds_write_b64 v64, v[92:93] offset:128
    v_mfma_f32_16x16x32_bf16 v[104:107], v[32:35], v[192:195], 0
    v_mfma_f32_16x16x32_bf16 v[108:111], v[32:35], v[208:211], 0
    v_mfma_f32_16x16x32_bf16 v[104:107], v[36:39], v[196:199], v[104:107]
    v_cvt_pk_bf16_f32 v96, v96, v97
    v_mfma_f32_16x16x32_bf16 v[108:111], v[36:39], v[212:215], v[108:111]
    v_cvt_pk_bf16_f32 v97, v98, v99
    v_mfma_f32_16x16x32_bf16 v[104:107], v[40:43], v[200:203], v[104:107]
    ds_write_b64 v64, v[96:97] offset:256
    v_mfma_f32_16x16x32_bf16 v[108:111], v[40:43], v[216:219], v[108:111]
    v_cvt_pk_bf16_f32 v100, v100, v101
    v_mfma_f32_16x16x32_bf16 v[104:107], v[44:47], v[204:207], v[104:107]
    v_cvt_pk_bf16_f32 v101, v102, v103
    v_mfma_f32_16x16x32_bf16 v[108:111], v[44:47], v[220:223], v[108:111]
    ds_write_b64 v64, v[100:101] offset:384
    v_mfma_f32_16x16x32_bf16 v[88:91], v[32:35], v[224:227], 0
    v_mfma_f32_16x16x32_bf16 v[92:95], v[32:35], v[240:243], 0
    v_mfma_f32_16x16x32_bf16 v[88:91], v[36:39], v[228:231], v[88:91]
    v_cvt_pk_bf16_f32 v104, v104, v105
    v_mfma_f32_16x16x32_bf16 v[92:95], v[36:39], v[244:247], v[92:95]
    v_cvt_pk_bf16_f32 v105, v106, v107
    v_mfma_f32_16x16x32_bf16 v[88:91], v[40:43], v[232:235], v[88:91]
    ds_write_b64 v64, v[104:105] offset:512
    v_mfma_f32_16x16x32_bf16 v[92:95], v[40:43], v[248:251], v[92:95]
    v_cvt_pk_bf16_f32 v108, v108, v109
    v_mfma_f32_16x16x32_bf16 v[88:91], v[44:47], v[236:239], v[88:91]
    v_cvt_pk_bf16_f32 v109, v110, v111
    v_mfma_f32_16x16x32_bf16 v[92:95], v[44:47], v[252:255], v[92:95]
    ds_write_b64 v64, v[108:109] offset:640
    s_nop 7
    v_cvt_pk_bf16_f32 v88, v88, v89
    v_cvt_pk_bf16_f32 v89, v90, v91
    ds_write_b64 v64, v[88:89] offset:768
    v_cvt_pk_bf16_f32 v92, v92, v93
    v_cvt_pk_bf16_f32 v93, v94, v95
    ds_write_b64 v64, v[92:93] offset:896
    v_add_u32 v64, 0x8000, v64
    v_mov_b32 v0, s24
    v_mov_b32 v1, s25
    v_mov_b32 v2, s26
    v_mov_b32 v3, s27
    v_mov_b32 v4, s24
    v_mov_b32 v5, s25
    v_mov_b32 v6, s26
    v_mov_b32 v7, s27
    v_mov_b32 v8, s24
    v_mov_b32 v9, s25
    v_mov_b32 v10, s26
    v_mov_b32 v11, s27
    v_mov_b32 v12, s24
    v_mov_b32 v13, s25
    v_mov_b32 v14, s26
    v_mov_b32 v15, s27
    v_mov_b32 v16, s24
    v_mov_b32 v17, s25
    v_mov_b32 v18, s26
    v_mov_b32 v19, s27
    v_mov_b32 v20, s24
    v_mov_b32 v21, s25
    v_mov_b32 v22, s26
    v_mov_b32 v23, s27
    v_mov_b32 v24, s24
    v_mov_b32 v25, s25
    v_mov_b32 v26, s26
    v_mov_b32 v27, s27
    v_mov_b32 v28, s24
    v_mov_b32 v29, s25
    v_mov_b32 v30, s26
    v_mov_b32 v31, s27
    v_mov_b32 v32, s24
    v_mov_b32 v33, s25
    v_mov_b32 v34, s26
    v_mov_b32 v35, s27
    v_mov_b32 v36, s24
    v_mov_b32 v37, s25
    v_mov_b32 v38, s26
    v_mov_b32 v39, s27
    v_mov_b32 v40, s24
    v_mov_b32 v41, s25
    v_mov_b32 v42, s26
    v_mov_b32 v43, s27
    v_mov_b32 v44, s24
    v_mov_b32 v45, s25
    v_mov_b32 v46, s26
    v_mov_b32 v47, s27
    v_mov_b32 v48, s24
    v_mov_b32 v49, s25
    v_mov_b32 v50, s26
    v_mov_b32 v51, s27
    v_mov_b32 v52, s24
    v_mov_b32 v53, s25
    v_mov_b32 v54, s26
    v_mov_b32 v55, s27
    v_mov_b32 v56, s24
    v_mov_b32 v57, s25
    v_mov_b32 v58, s26
    v_mov_b32 v59, s27
    v_mov_b32 v60, s24
    v_mov_b32 v61, s25
    v_mov_b32 v62, s26
    v_mov_b32 v63, s27

    s_mov_b32 s64, 0
    s_cmp_eq_u32 s3, 7
    s_cbranch_scc1 k1_kernel_k2w
    s_branch k1_kernel_k2j

k1_kernel_end:
    s_endpgm
k1_kernel_main:
    s_setprio 3
    s_mov_b32 s16, s4
    s_and_b32 s17, s5, 0xffff
    s_mov_b32 s20, s6
    s_and_b32 s21, s7, 0xffff
    s_mov_b32 s28, s10
    s_and_b32 s29, s11, 0xffff
    s_mov_b32 s32, s12
    s_and_b32 s33, s13, 0xffff
    s_and_b32 s13, s13, 0xffff
    s_and_b32 s53, s53, 0xffff

    v_and_b32 v5, 15, v255
    v_lshrrev_b32 v6, 4, v255
    v_and_b32 v7, 3, v255
    v_bfe_u32 v8, v255, 2, 2
    v_lshl_add_u32 v9, v7, 2, v8
    v_cmp_eq_u32 s[46:47], 0, v7
    s_movk_i32 s45, 200
    v_mov_b32 v10, 144384
    v_mad_u32_u24 v11, v9, s45, v10
    v_and_b32 v213, 48, v255
    v_add_u32 v128, v11, v213
    v_mul_u32_u24 v12, 6400, v6
    v_add_u32 v132, v11, v12
    v_and_b32 v12, 16, v255
    v_add_u32 v10, v10, v12
    v_add_u32 v11, v11, v12
    v_and_b32 v12, 32, v255
    v_mul_u32_u24 v12, 100, v12
    v_add_u32 v131, v11, v12
    v_and_b32 v12, 8, v255
    v_lshl_add_u32 v13, v7, 1, v12
    v_and_b32 v14, 1, v8
    v_add_u32 v13, v13, v14
    v_lshrrev_b32 v14, 5, v255
    v_lshl_add_u32 v14, v13, 1, v14
    v_mad_u32_u24 v129, v14, s45, v10
    v_lshl_add_u32 v130, v12, 2, v129
    v_lshlrev_b32 v15, 2, v6
    v_sub_u32 v13, v13, v15
    v_lshrrev_b32 v14, 1, v9
    v_sub_u32 v14, v14, v15
    v_sub_u32 v15, v5, v15
    v_and_b32 v12, 1, v9
    v_lshlrev_b32 v12, 4, v12
    v_mov_b32 v16, 0x3f80
    v_lshlrev_b32 v12, v12, v16
    v_mov_b32 v17, 0x3f800000

    v_cmp_eq_u32 vcc, 0, v13
    v_cndmask_b32 v120, 0, v16, vcc
    v_cmp_eq_u32 vcc, 0, v14
    v_cndmask_b32 v112, 0, v12, vcc
    v_cmp_eq_u32 vcc, -8, v14
    v_cndmask_b32 v116, 0, v12, vcc
    v_cmp_eq_u32 vcc, 0, v15
    v_cndmask_b32 v200, 0, v17, vcc
    v_lshlrev_b32 v124, 16, v120

    v_cmp_eq_u32 vcc, 1, v13
    v_cndmask_b32 v121, 0, v16, vcc
    v_cmp_eq_u32 vcc, 1, v14
    v_cndmask_b32 v113, 0, v12, vcc
    v_cmp_eq_u32 vcc, -7, v14
    v_cndmask_b32 v117, 0, v12, vcc
    v_cmp_eq_u32 vcc, 1, v15
    v_cndmask_b32 v201, 0, v17, vcc
    v_lshlrev_b32 v125, 16, v121

    v_cmp_eq_u32 vcc, 2, v13
    v_cndmask_b32 v122, 0, v16, vcc
    v_cmp_eq_u32 vcc, 2, v14
    v_cndmask_b32 v114, 0, v12, vcc
    v_cmp_eq_u32 vcc, -6, v14
    v_cndmask_b32 v118, 0, v12, vcc
    v_cmp_eq_u32 vcc, 2, v15
    v_cndmask_b32 v202, 0, v17, vcc
    v_lshlrev_b32 v126, 16, v122

    v_cmp_eq_u32 vcc, 3, v13
    v_cndmask_b32 v123, 0, v16, vcc
    v_cmp_eq_u32 vcc, 3, v14
    v_cndmask_b32 v115, 0, v12, vcc
    v_cmp_eq_u32 vcc, -5, v14
    v_cndmask_b32 v119, 0, v12, vcc
    v_cmp_eq_u32 vcc, 3, v15
    v_cndmask_b32 v203, 0, v17, vcc
    v_lshlrev_b32 v127, 16, v123

    s_mul_i32 s45, s3, 36864
    s_add_u32 s45, s45, 128
    s_movk_i32 s57, 144
    v_mov_b32 v10, s45
    v_mad_u32_u24 v214, v5, s57, v10
    v_mad_u32_u24 v218, v255, s57, v10
    v_add_u32 v218, 12, v218
    v_cmp_lt_u32 vcc, 25, v255
    v_subrev_u32 v11, 26, v255
    v_cndmask_b32 v11, v255, v11, vcc
    v_add_u32 v12, 2304, v10
    v_cndmask_b32 v10, v10, v12, vcc
    v_and_b32 v12, 3, v11
    v_mad_u32_u24 v10, v12, s57, v10
    v_lshrrev_b32 v11, 2, v11
    v_lshl_add_u32 v215, v11, 1, v10
    v_cmp_gt_u32 vcc, 52, v255
    v_add_u32 v11, 2304, v218
    v_cndmask_b32 v215, v11, v215, vcc
    v_mov_b32 v216, 0xdddddddd
    v_mov_b32 v219, 1000
    s_mov_b32 s60, 0xff00ff00
    s_mov_b32 s61, 0xff00ff00
    s_mov_b32 s62, -1
    s_mov_b32 s63, 0xffff

    s_waitcnt vmcnt(3)

    s_mov_b64 exec, 1
    ds_add_u32 v252, v253 offset:0
    s_mov_b64 exec, -1

k1_kernel_wf1:

    ds_read_b32 v251, v252 offset:0
    s_waitcnt lgkmcnt(0)
    v_readfirstlane_b32 s45, v251
    s_cmp_lt_u32 s45, 4
    s_cbranch_scc1 k1_kernel_wf1

    v_mov_b32 v72, 0
    v_mov_b32 v73, 0
    v_mov_b32 v74, 0
    v_mov_b32 v75, 0
    s_mov_b64 exec, s[62:63]
    ds_read_b64 v[72:73], v132 offset:192
    ds_read_b64 v[74:75], v132 offset:3392
    s_mov_b64 exec, -1
    ds_read_b64 v[76:77], v128 offset:16160
    ds_read_b64 v[78:79], v128 offset:16168
    ds_read_b64 v[80:81], v128 offset:0
    ds_read_b64 v[82:83], v128 offset:8
    ds_read_b64 v[84:85], v131 offset:0
    ds_read_b64 v[86:87], v131 offset:8
    s_waitcnt vmcnt(2)
    s_waitcnt lgkmcnt(4)
    v_mfma_f32_16x16x32_bf16 v[64:67], v[112:115], v[72:75], 0
    ds_read_b64 v[88:89], v128 offset:3232
    ds_read_b64 v[90:91], v128 offset:3240
    v_mfma_f32_16x16x32_bf16 v[68:71], v[116:119], v[72:75], 0
    v_mfma_f32_16x16x32_bf16 v[60:63], v[112:115], v[76:79], 0
    v_mfma_f32_16x16x32_bf16 v[64:67], v[232:235], v[112:115], v[64:67]
    v_mov_b32 v92, 0
    v_mov_b32 v93, 0
    v_mov_b32 v94, 0
    v_mov_b32 v95, 0
    s_mov_b64 exec, s[60:61]
    ds_read_b64 v[92:93], v129 offset:3232
    ds_read_b64 v[94:95], v129 offset:3240
    s_mov_b64 exec, -1
    v_mfma_f32_16x16x32_bf16 v[68:71], v[232:235], v[116:119], v[68:71]
    s_waitcnt lgkmcnt(4)
    v_mfma_f32_16x16x32_bf16 v[0:3], v[112:115], v[80:83], 0
    ds_read_b64 v[72:73], v128 offset:64
    ds_read_b64 v[74:75], v128 offset:72
    v_mfma_f32_16x16x32_bf16 v[4:7], v[116:119], v[80:83], 0
    v_mfma_f32_16x16x32_bf16 v[4:7], v[84:87], v[116:119], v[4:7]
    v_cndmask_b32 v70, 0, v70, s[46:47]
    ds_read_b64 v[76:77], v131 offset:6400
    ds_read_b64 v[78:79], v131 offset:6408
    s_waitcnt lgkmcnt(4)
    v_mfma_f32_16x16x32_bf16 v[96:99], v[120:123], v[88:91], 0
    ds_read_b64 v[80:81], v128 offset:9632
    ds_read_b64 v[82:83], v128 offset:9640
    v_mfma_f32_16x16x32_bf16 v[100:103], v[124:127], v[88:91], 0
    v_mfma_f32_16x16x32_bf16 v[96:99], v[92:95], v[112:115], v[96:99]
    v_mfma_f32_16x16x32_bf16 v[100:103], v[92:95], v[116:119], v[100:103]
    ds_read_b64 v[84:85], v129 offset:3296
    ds_read_b64 v[86:87], v129 offset:3304
    s_waitcnt lgkmcnt(4)
    v_mfma_f32_16x16x32_bf16 v[12:15], v[112:115], v[72:75], 0
    ds_read_b64 v[88:89], v128 offset:6464
    ds_read_b64 v[90:91], v128 offset:6472
    v_mfma_f32_16x16x32_bf16 v[16:19], v[116:119], v[72:75], 0
    v_cvt_pk_bf16_f32 v8, v96, v97
    v_cvt_pk_bf16_f32 v9, v98, v99
    v_mfma_f32_16x16x32_bf16 v[12:15], v[76:79], v[112:115], v[12:15]
    v_cvt_pk_bf16_f32 v10, v100, v101
    v_cvt_pk_bf16_f32 v11, v102, v103
    v_mfma_f32_16x16x32_bf16 v[16:19], v[76:79], v[116:119], v[16:19]
    ds_read_b64 v[92:93], v128 offset:9696
    ds_read_b64 v[94:95], v128 offset:9704
    s_waitcnt lgkmcnt(4)
    v_mfma_f32_16x16x32_bf16 v[96:99], v[120:123], v[80:83], 0
    ds_read_b64 v[72:73], v128 offset:128
    ds_read_b64 v[74:75], v128 offset:136
    v_mfma_f32_16x16x32_bf16 v[100:103], v[124:127], v[80:83], 0
    v_mfma_f32_16x16x32_bf16 v[96:99], v[84:87], v[112:115], v[96:99]
    v_mfma_f32_16x16x32_bf16 v[100:103], v[84:87], v[116:119], v[100:103]
    ds_read_b64 v[76:77], v129 offset:12800
    ds_read_b64 v[78:79], v129 offset:12808
    s_waitcnt lgkmcnt(4)
    v_mfma_f32_16x16x32_bf16 v[24:27], v[112:115], v[88:91], 0
    ds_read_b64 v[80:81], v128 offset:3328
    ds_read_b64 v[82:83], v128 offset:3336
    v_mfma_f32_16x16x32_bf16 v[28:31], v[112:115], v[92:95], 0
    v_cvt_pk_bf16_f32 v20, v96, v97
    v_cvt_pk_bf16_f32 v21, v98, v99
    s_nop 3
    v_cvt_pk_bf16_f32 v22, v100, v101
    v_cvt_pk_bf16_f32 v23, v102, v103
    ds_read_b64 v[84:85], v131 offset:12832
    ds_read_b64 v[86:87], v131 offset:12840
    s_waitcnt lgkmcnt(4)
    v_mfma_f32_16x16x32_bf16 v[96:99], v[120:123], v[72:75], 0
    ds_read_b64 v[88:89], v128 offset:6528
    ds_read_b64 v[90:91], v128 offset:6536
    v_mfma_f32_16x16x32_bf16 v[100:103], v[124:127], v[72:75], 0
    v_mfma_f32_16x16x32_bf16 v[96:99], v[76:79], v[112:115], v[96:99]
    v_mfma_f32_16x16x32_bf16 v[100:103], v[76:79], v[116:119], v[100:103]
    ds_read_b64 v[92:93], v129 offset:12864
    ds_read_b64 v[94:95], v129 offset:12872
    s_waitcnt lgkmcnt(4)
    v_mfma_f32_16x16x32_bf16 v[36:39], v[112:115], v[80:83], 0
    ds_read_b64 v[72:73], v128 offset:9728
    ds_read_b64 v[74:75], v128 offset:9736
    v_mfma_f32_16x16x32_bf16 v[40:43], v[116:119], v[80:83], 0
    v_cvt_pk_bf16_f32 v32, v96, v97
    v_cvt_pk_bf16_f32 v33, v98, v99
    v_mfma_f32_16x16x32_bf16 v[36:39], v[84:87], v[112:115], v[36:39]
    v_cvt_pk_bf16_f32 v34, v100, v101
    v_cvt_pk_bf16_f32 v35, v102, v103
    v_mfma_f32_16x16x32_bf16 v[40:43], v[84:87], v[116:119], v[40:43]
    ds_read_b64 v[76:77], v131 offset:12896
    ds_read_b64 v[78:79], v131 offset:12904
    s_waitcnt lgkmcnt(4)
    v_mfma_f32_16x16x32_bf16 v[96:99], v[120:123], v[88:91], 0
    ds_read_b64 v[80:81], v128 offset:12928
    ds_read_b64 v[82:83], v128 offset:12936
    v_mfma_f32_16x16x32_bf16 v[100:103], v[124:127], v[88:91], 0
    v_mfma_f32_16x16x32_bf16 v[96:99], v[92:95], v[112:115], v[96:99]
    v_mfma_f32_16x16x32_bf16 v[100:103], v[92:95], v[116:119], v[100:103]
    v_mov_b32 v84, 0
    v_mov_b32 v85, 0
    v_mov_b32 v86, 0
    v_mov_b32 v87, 0
    s_mov_b64 exec, s[60:61]
    ds_read_b64 v[84:85], v129 offset:12928
    ds_read_b64 v[86:87], v129 offset:12936
    s_mov_b64 exec, -1
    s_waitcnt lgkmcnt(4)
    v_mfma_f32_16x16x32_bf16 v[48:51], v[112:115], v[72:75], 0
    v_mfma_f32_16x16x32_bf16 v[52:55], v[116:119], v[72:75], 0
    v_cvt_pk_bf16_f32 v44, v96, v97
    v_cvt_pk_bf16_f32 v45, v98, v99
    v_mfma_f32_16x16x32_bf16 v[48:51], v[76:79], v[112:115], v[48:51]
    v_cvt_pk_bf16_f32 v46, v100, v101
    v_cvt_pk_bf16_f32 v47, v102, v103
    v_mfma_f32_16x16x32_bf16 v[52:55], v[76:79], v[116:119], v[52:55]
    s_waitcnt lgkmcnt(0)

    s_mov_b64 exec, 1
    ds_add_u32 v252, v253 offset:12
    s_mov_b64 exec, -1

    v_mfma_f32_16x16x32_bf16 v[96:99], v[120:123], v[80:83], 0
    v_mfma_f32_16x16x32_bf16 v[100:103], v[124:127], v[80:83], 0
    v_mfma_f32_16x16x32_bf16 v[96:99], v[84:87], v[112:115], v[96:99]
    v_mfma_f32_16x16x32_bf16 v[100:103], v[84:87], v[116:119], v[100:103]
    s_nop 7
    v_cvt_pk_bf16_f32 v56, v96, v97
    v_cvt_pk_bf16_f32 v57, v98, v99
    v_cvt_pk_bf16_f32 v58, v100, v101
    v_cvt_pk_bf16_f32 v59, v102, v103

    v_mov_b32_dpp v71, v70 row_shr:1 row_mask:0xf bank_mask:0xf bound_ctrl:0
    ds_write_b32 v218, v219
    v_and_b32 v217, 1, v255
    v_lshlrev_b32 v248, 1, v213
    v_lshl_add_u32 v248, v217, 2, v248
    v_mul_u32_u24 v208, 0xaaaa, v217
    v_mov_b32 v217, 0
    s_mov_b32 vcc_lo, 0x01010101
    s_mov_b32 vcc_hi, 0x01010101
    s_movk_i32 s58, 7

    v_mov_b64 v[172:173], 0
    v_mov_b64 v[176:177], 0
    v_mov_b64 v[180:181], 0
    v_mov_b64 v[184:185], 0
    v_mov_b64 v[188:189], 0
    v_mov_b64 v[192:193], 0
    v_mov_b64 v[196:197], 0
    v_mov_b64 v[198:199], 0
    s_waitcnt vmcnt(1)
    ds_write_b16 v215, v240 offset:0
    ds_write_b16 v215, v241 offset:576
    ds_write_b16 v215, v242 offset:1152
    ds_write_b16 v215, v243 offset:1728
    v_add_u32 v250, 0x4444, v208
    ds_read_b128 v[204:207], v214 offset:0
k1_kernel_wf2:

    ds_read_b32 v251, v252 offset:16
    s_waitcnt lgkmcnt(0)
    v_readfirstlane_b32 s45, v251
    s_cmp_lt_u32 s45, 4
    s_cbranch_scc1 k1_kernel_wf2

    s_setprio 2
    v_mad_u32_u16 v76, v204, s57, v213 op_sel:[0,0,0,0]
    ds_read_b128 v[72:75], v76 offset:0
    ds_read_b128 v[76:79], v76 offset:64
    v_mad_u32_u16 v84, v204, s57, v213 op_sel:[1,0,0,0]
    ds_read_b128 v[80:83], v84 offset:0
    ds_read_b128 v[84:87], v84 offset:64
    v_mad_u32_u16 v92, v205, s57, v213 op_sel:[0,0,0,0]
    ds_read_b128 v[88:91], v92 offset:0
    ds_read_b128 v[92:95], v92 offset:64
    v_mad_u32_u16 v100, v205, s57, v213 op_sel:[1,0,0,0]
    ds_read_b128 v[96:99], v100 offset:0
    ds_read_b128 v[100:103], v100 offset:64
    v_mad_u32_u16 v108, v206, s57, v213 op_sel:[0,0,0,0]
    ds_read_b128 v[104:107], v108 offset:0
    ds_read_b128 v[108:111], v108 offset:64
    buffer_load_dwordx4 v[240:243], v249, s[16:19], s74 offen offset:0
    s_waitcnt lgkmcnt(4)
    v_mad_u32_u16 v116, v206, s57, v213 op_sel:[1,0,0,0]
    ds_read_b128 v[112:115], v116 offset:0
k1_kernel_loop:
    v_mfma_f32_16x16x32_bf16 v[124:127], v[72:75], v[72:75], 0
    ds_read_b128 v[116:119], v116 offset:64
    v_mad_u32_u16 v122, v207, s57, v248 op_sel:[0,0,0,0]
    ds_read2_b32 v[120:121], v122 offset0:0 offset1:2
    v_mfma_f32_16x16x32_bf16 v[124:127], v[76:79], v[76:79], v[124:127]
    ds_read2_b32 v[122:123], v122 offset0:4 offset1:6
    ds_read_b128 v[204:207], v214 offset:2304
    v_mfma_f32_16x16x32_bf16 v[128:131], v[80:83], v[72:75], 0
    v_fmac_f32 v217, v189, v68
    v_fmac_f32 v217, v196, v200
    v_mfma_f32_16x16x32_bf16 v[128:131], v[84:87], v[76:79], v[128:131]
    v_fmac_f32 v217, v192, v69
    v_fmac_f32 v217, v197, v201
    v_mfma_f32_16x16x32_bf16 v[132:135], v[80:83], v[80:83], 0
    v_fmac_f32 v217, v193, v69
    v_fmac_f32 v217, v198, v202
    v_mfma_f32_16x16x32_bf16 v[132:135], v[84:87], v[84:87], v[132:135]
    v_fmac_f32 v217, v199, v203
    v_fmac_f32 v209, v153, v53
    v_mfma_f32_16x16x32_bf16 v[136:139], v[88:91], v[80:83], 0
    v_fmac_f32 v208, v154, v54
    v_fmac_f32 v209, v155, v55
    v_mfma_f32_16x16x32_bf16 v[136:139], v[92:95], v[84:87], v[136:139]
    v_fmac_f32 v208, v164, v60
    v_fmac_f32 v209, v165, v61
    v_mfma_f32_16x16x32_bf16 v[140:143], v[88:91], v[72:75], 0
    v_fmac_f32 v208, v166, v62
    v_fmac_f32 v209, v167, v63
    v_mfma_f32_16x16x32_bf16 v[140:143], v[92:95], v[76:79], v[140:143]
    s_waitcnt lgkmcnt(7)
    v_add_f32 v209, v209, v217
    v_smfmac_f32_16x16x64_bf16 v[196:199], v[8:11], v[132:139], v216
    v_fmac_f32 v208, v168, v70
    v_mfma_f32_16x16x32_bf16 v[144:147], v[96:99], v[72:75], 0
    v_fmac_f32 v208, v169, v71
    v_add_f32 v211, v208, v209
    v_mfma_f32_16x16x32_bf16 v[144:147], v[100:103], v[76:79], v[144:147]
    v_fma_f32 v208, v124, v0, -v217
    v_mul_f32 v209, v125, v1
    v_mfma_f32_16x16x32_bf16 v[148:151], v[80:83], v[96:99], 0
    v_fmac_f32 v208, v126, v2
    v_fmac_f32 v209, v127, v3
    v_mfma_f32_16x16x32_bf16 v[148:151], v[84:87], v[100:103], v[148:151]
    v_fmac_f32 v208, v128, v4
    v_fmac_f32 v209, v129, v5
    v_mfma_f32_16x16x32_bf16 v[152:155], v[88:91], v[96:99], 0
    v_fmac_f32 v208, v130, v6
    v_fmac_f32 v209, v131, v7
    v_mfma_f32_16x16x32_bf16 v[152:155], v[92:95], v[100:103], v[152:155]
    v_fmac_f32 v208, v140, v12
    v_fmac_f32 v209, v141, v13
    v_mfma_f32_16x16x32_bf16 v[156:159], v[88:91], v[88:91], 0
    v_fmac_f32 v208, v142, v14
    v_fmac_f32 v209, v143, v15
    v_mfma_f32_16x16x32_bf16 v[156:159], v[92:95], v[92:95], v[156:159]
    v_fmac_f32 v208, v144, v16
    v_fmac_f32 v209, v145, v17
    v_smfmac_f32_16x16x64_bf16 v[196:199], v[20:23], v[148:155], v216
    v_fmac_f32 v208, v146, v18
    v_mfma_f32_16x16x32_bf16 v[160:163], v[96:99], v[96:99], 0
    s_waitcnt lgkmcnt(0)
    v_fmac_f32 v209, v147, v19
    v_mfma_f32_16x16x32_bf16 v[160:163], v[100:103], v[100:103], v[160:163]
    v_fmac_f32 v208, v156, v24
    v_fmac_f32 v209, v157, v25
    v_mfma_f32_16x16x32_bf16 v[124:127], v[104:107], v[72:75], 0
    v_fmac_f32 v208, v158, v26
    v_fmac_f32 v209, v159, v27
    v_mfma_f32_16x16x32_bf16 v[124:127], v[108:111], v[76:79], v[124:127]
    v_permlane32_swap_b32 v210, v211
    s_waitcnt vmcnt(1)
    v_mfma_f32_16x16x32_bf16 v[128:131], v[112:115], v[72:75], 0
    v_fmac_f32 v208, v160, v28
    v_fmac_f32 v209, v161, v29
    v_mfma_f32_16x16x32_bf16 v[128:131], v[116:119], v[76:79], v[128:131]
    v_fmac_f32 v208, v162, v30
    v_fmac_f32 v209, v163, v31
    v_smfmac_f32_16x16x64_bf16 v[172:175], v[120:123], v[72:79], v250
    v_mad_u32_u16 v76, v204, s57, v213 op_sel:[0,0,0,0]
    v_mfma_f32_16x16x32_bf16 v[132:135], v[104:107], v[80:83], 0
    ds_read_b128 v[72:75], v76 offset:0
    ds_read_b128 v[76:79], v76 offset:64
    v_smfmac_f32_16x16x64_bf16 v[196:199], v[32:35], v[124:131], v216
    v_add_f32 v219, v210, v211
    v_mfma_f32_16x16x32_bf16 v[132:135], v[108:111], v[84:87], v[132:135]
    v_mul_f32 v217, v172, v64
    ds_write_b16 v215, v244 offset:4608
    v_mfma_f32_16x16x32_bf16 v[136:139], v[112:115], v[80:83], 0
    v_fmac_f32 v217, v173, v64
    ds_write_b16 v215, v245 offset:5184
    v_mfma_f32_16x16x32_bf16 v[136:139], v[116:119], v[84:87], v[136:139]
    ds_write_b16 v215, v246 offset:5760
    ds_write_b16 v215, v247 offset:6336
    v_smfmac_f32_16x16x64_bf16 v[176:179], v[120:123], v[80:87], v250
    v_mad_u32_u16 v84, v204, s57, v213 op_sel:[1,0,0,0]
    v_mfma_f32_16x16x32_bf16 v[140:143], v[104:107], v[88:91], 0
    ds_read_b128 v[80:83], v84 offset:0
    ds_read_b128 v[84:87], v84 offset:64
    v_mfma_f32_16x16x32_bf16 v[140:143], v[108:111], v[92:95], v[140:143]
    v_fmac_f32 v208, v132, v36
    v_fmac_f32 v209, v133, v37
    v_mfma_f32_16x16x32_bf16 v[144:147], v[112:115], v[88:91], 0
    v_fmac_f32 v217, v176, v65
    v_fmac_f32 v208, v134, v38
    v_mfma_f32_16x16x32_bf16 v[144:147], v[116:119], v[92:95], v[144:147]
    v_fmac_f32 v217, v177, v65
    v_fmac_f32 v209, v135, v39
    v_smfmac_f32_16x16x64_bf16 v[180:183], v[120:123], v[88:95], v250
    v_mad_u32_u16 v92, v205, s57, v213 op_sel:[0,0,0,0]
    v_mfma_f32_16x16x32_bf16 v[148:151], v[104:107], v[96:99], 0
    ds_read_b128 v[88:91], v92 offset:0
    ds_read_b128 v[92:95], v92 offset:64
    v_smfmac_f32_16x16x64_bf16 v[196:199], v[44:47], v[140:147], v216
    v_fmac_f32 v208, v136, v40
    v_mfma_f32_16x16x32_bf16 v[148:151], v[108:111], v[100:103], v[148:151]
    v_fmac_f32 v217, v180, v66
    v_fmac_f32 v209, v137, v41
    v_mfma_f32_16x16x32_bf16 v[152:155], v[112:115], v[96:99], 0
    v_fmac_f32 v217, v181, v66
    v_fmac_f32 v208, v138, v42
    v_mfma_f32_16x16x32_bf16 v[152:155], v[116:119], v[100:103], v[152:155]
    v_fmac_f32 v209, v139, v43
    buffer_load_dwordx4 v[244:247], v249, s[16:19], s74 offen offset:800
    v_smfmac_f32_16x16x64_bf16 v[184:187], v[120:123], v[96:103], v250
    v_mad_u32_u16 v100, v205, s57, v213 op_sel:[1,0,0,0]
    v_mfma_f32_16x16x32_bf16 v[156:159], v[104:107], v[104:107], 0
    ds_read_b128 v[96:99], v100 offset:0
    ds_read_b128 v[100:103], v100 offset:64
    v_mfma_f32_16x16x32_bf16 v[156:159], v[108:111], v[108:111], v[156:159]
    v_fmac_f32 v208, v148, v48
    v_fmac_f32 v209, v149, v49
    v_mfma_f32_16x16x32_bf16 v[160:163], v[112:115], v[104:107], 0
    v_fmac_f32 v217, v184, v67
    v_fmac_f32 v208, v150, v50
    v_mfma_f32_16x16x32_bf16 v[160:163], v[116:119], v[108:111], v[160:163]
    v_fmac_f32 v217, v185, v67
    v_fmac_f32 v209, v151, v51
    v_smfmac_f32_16x16x64_bf16 v[188:191], v[120:123], v[104:111], v250
    v_mad_u32_u16 v108, v206, s57, v213 op_sel:[0,0,0,0]
    v_mfma_f32_16x16x32_bf16 v[164:167], v[112:115], v[112:115], 0
    ds_read_b128 v[104:107], v108 offset:0
    ds_read_b128 v[108:111], v108 offset:64
    v_smfmac_f32_16x16x64_bf16 v[196:199], v[56:59], v[156:163], v216
    s_waitcnt lgkmcnt(4)
    v_mfma_f32_16x16x32_bf16 v[164:167], v[116:119], v[116:119], v[164:167]
    v_fmac_f32 v217, v188, v68
    v_fmac_f32 v208, v152, v52
    v_smfmac_f32_16x16x64_bf16 v[192:195], v[120:123], v[112:119], v250
    v_mad_u32_u16 v116, v206, s57, v213 op_sel:[1,0,0,0]
    v_mfma_f32_16x16x32_bf16 v[168:171], v[120:123], v[120:123], 0
    ds_read_b128 v[112:115], v116 offset:0
    v_mfma_f32_16x16x32_bf16 v[124:127], v[72:75], v[72:75], 0
    ds_read_b128 v[116:119], v116 offset:64
    v_mad_u32_u16 v122, v207, s57, v248 op_sel:[0,0,0,0]
    ds_read2_b32 v[120:121], v122 offset0:0 offset1:2
    v_mfma_f32_16x16x32_bf16 v[124:127], v[76:79], v[76:79], v[124:127]
    ds_read2_b32 v[122:123], v122 offset0:4 offset1:6
    ds_read_b128 v[204:207], v214 offset:4608
    v_mfma_f32_16x16x32_bf16 v[128:131], v[80:83], v[72:75], 0
    v_fmac_f32 v217, v189, v68
    v_fmac_f32 v217, v196, v200
    v_mfma_f32_16x16x32_bf16 v[128:131], v[84:87], v[76:79], v[128:131]
    v_fmac_f32 v217, v192, v69
    v_fmac_f32 v217, v197, v201
    v_mfma_f32_16x16x32_bf16 v[132:135], v[80:83], v[80:83], 0
    v_fmac_f32 v217, v193, v69
    v_fmac_f32 v217, v198, v202
    v_mfma_f32_16x16x32_bf16 v[132:135], v[84:87], v[84:87], v[132:135]
    v_fmac_f32 v217, v199, v203
    v_fmac_f32 v209, v153, v53
    v_mfma_f32_16x16x32_bf16 v[136:139], v[88:91], v[80:83], 0
    v_fmac_f32 v208, v154, v54
    v_fmac_f32 v209, v155, v55
    v_mfma_f32_16x16x32_bf16 v[136:139], v[92:95], v[84:87], v[136:139]
    v_fmac_f32 v208, v164, v60
    v_fmac_f32 v209, v165, v61
    v_mfma_f32_16x16x32_bf16 v[140:143], v[88:91], v[72:75], 0
    v_fmac_f32 v208, v166, v62
    v_fmac_f32 v209, v167, v63
    v_mfma_f32_16x16x32_bf16 v[140:143], v[92:95], v[76:79], v[140:143]
    s_waitcnt lgkmcnt(7)
    v_add_f32 v209, v209, v217
    v_smfmac_f32_16x16x64_bf16 v[196:199], v[8:11], v[132:139], v216
    v_fmac_f32 v208, v168, v70
    v_mfma_f32_16x16x32_bf16 v[144:147], v[96:99], v[72:75], 0
    v_fmac_f32 v208, v169, v71
    v_add_f32 v210, v208, v209
    v_mfma_f32_16x16x32_bf16 v[144:147], v[100:103], v[76:79], v[144:147]
    v_fma_f32 v208, v124, v0, -v217
    v_mul_f32 v209, v125, v1
    v_mfma_f32_16x16x32_bf16 v[148:151], v[80:83], v[96:99], 0
    v_fmac_f32 v208, v126, v2
    v_fmac_f32 v209, v127, v3
    v_mfma_f32_16x16x32_bf16 v[148:151], v[84:87], v[100:103], v[148:151]
    v_fmac_f32 v208, v128, v4
    v_fmac_f32 v209, v129, v5
    v_mfma_f32_16x16x32_bf16 v[152:155], v[88:91], v[96:99], 0
    v_fmac_f32 v208, v130, v6
    v_fmac_f32 v209, v131, v7
    v_mfma_f32_16x16x32_bf16 v[152:155], v[92:95], v[100:103], v[152:155]
    v_fmac_f32 v208, v140, v12
    v_fmac_f32 v209, v141, v13
    v_mfma_f32_16x16x32_bf16 v[156:159], v[88:91], v[88:91], 0
    v_fmac_f32 v208, v142, v14
    v_fmac_f32 v209, v143, v15
    v_mfma_f32_16x16x32_bf16 v[156:159], v[92:95], v[92:95], v[156:159]
    v_fmac_f32 v208, v144, v16
    v_fmac_f32 v209, v145, v17
    v_smfmac_f32_16x16x64_bf16 v[196:199], v[20:23], v[148:155], v216
    v_fmac_f32 v208, v146, v18
    v_mfma_f32_16x16x32_bf16 v[160:163], v[96:99], v[96:99], 0
    s_waitcnt lgkmcnt(0)
    v_fmac_f32 v209, v147, v19
    v_mfma_f32_16x16x32_bf16 v[160:163], v[100:103], v[100:103], v[160:163]
    v_fmac_f32 v208, v156, v24
    v_fmac_f32 v209, v157, v25
    v_mfma_f32_16x16x32_bf16 v[124:127], v[104:107], v[72:75], 0
    v_fmac_f32 v208, v158, v26
    v_fmac_f32 v209, v159, v27
    v_mfma_f32_16x16x32_bf16 v[124:127], v[108:111], v[76:79], v[124:127]
    v_permlane16_swap_b32 v218, v219
    s_add_u32 s74, s74, s77
    v_mfma_f32_16x16x32_bf16 v[128:131], v[112:115], v[72:75], 0
    v_fmac_f32 v208, v160, v28
    v_fmac_f32 v209, v161, v29
    v_mfma_f32_16x16x32_bf16 v[128:131], v[116:119], v[76:79], v[128:131]
    v_fmac_f32 v208, v162, v30
    v_fmac_f32 v209, v163, v31
    v_smfmac_f32_16x16x64_bf16 v[172:175], v[120:123], v[72:79], v250
    v_mad_u32_u16 v76, v204, s57, v213 op_sel:[0,0,0,0]
    v_mfma_f32_16x16x32_bf16 v[132:135], v[104:107], v[80:83], 0
    ds_read_b128 v[72:75], v76 offset:0
    ds_read_b128 v[76:79], v76 offset:64
    v_smfmac_f32_16x16x64_bf16 v[196:199], v[32:35], v[124:131], v216
    v_add_f32 v220, v218, v219
    v_mfma_f32_16x16x32_bf16 v[132:135], v[108:111], v[84:87], v[132:135]
    v_mul_f32 v217, v172, v64
    s_min_i32 s74, s74, s79
    v_mfma_f32_16x16x32_bf16 v[136:139], v[112:115], v[80:83], 0
    v_fmac_f32 v217, v173, v64
    s_max_i32 s74, s74, s78
    v_mfma_f32_16x16x32_bf16 v[136:139], v[116:119], v[84:87], v[136:139]
    v_smfmac_f32_16x16x64_bf16 v[176:179], v[120:123], v[80:87], v250
    v_mad_u32_u16 v84, v204, s57, v213 op_sel:[1,0,0,0]
    v_mfma_f32_16x16x32_bf16 v[140:143], v[104:107], v[88:91], 0
    ds_read_b128 v[80:83], v84 offset:0
    ds_read_b128 v[84:87], v84 offset:64
    v_mfma_f32_16x16x32_bf16 v[140:143], v[108:111], v[92:95], v[140:143]
    v_fmac_f32 v208, v132, v36
    v_fmac_f32 v209, v133, v37
    v_mfma_f32_16x16x32_bf16 v[144:147], v[112:115], v[88:91], 0
    v_fmac_f32 v217, v176, v65
    v_fmac_f32 v208, v134, v38
    v_mfma_f32_16x16x32_bf16 v[144:147], v[116:119], v[92:95], v[144:147]
    v_fmac_f32 v217, v177, v65
    v_fmac_f32 v209, v135, v39
    v_smfmac_f32_16x16x64_bf16 v[180:183], v[120:123], v[88:95], v250
    v_mad_u32_u16 v92, v205, s57, v213 op_sel:[0,0,0,0]
    v_mfma_f32_16x16x32_bf16 v[148:151], v[104:107], v[96:99], 0
    ds_read_b128 v[88:91], v92 offset:0
    ds_read_b128 v[92:95], v92 offset:64
    v_smfmac_f32_16x16x64_bf16 v[196:199], v[44:47], v[140:147], v216
    v_fmac_f32 v208, v136, v40
    v_mfma_f32_16x16x32_bf16 v[148:151], v[108:111], v[100:103], v[148:151]
    v_fmac_f32 v217, v180, v66
    v_fmac_f32 v209, v137, v41
    v_mfma_f32_16x16x32_bf16 v[152:155], v[112:115], v[96:99], 0
    v_fmac_f32 v217, v181, v66
    v_fmac_f32 v208, v138, v42
    v_mfma_f32_16x16x32_bf16 v[152:155], v[116:119], v[100:103], v[152:155]
    v_fmac_f32 v209, v139, v43
    v_smfmac_f32_16x16x64_bf16 v[184:187], v[120:123], v[96:103], v250
    v_mad_u32_u16 v100, v205, s57, v213 op_sel:[1,0,0,0]
    v_mfma_f32_16x16x32_bf16 v[156:159], v[104:107], v[104:107], 0
    ds_read_b128 v[96:99], v100 offset:0
    ds_read_b128 v[100:103], v100 offset:64
    v_mfma_f32_16x16x32_bf16 v[156:159], v[108:111], v[108:111], v[156:159]
    v_fmac_f32 v208, v148, v48
    v_fmac_f32 v209, v149, v49
    v_mfma_f32_16x16x32_bf16 v[160:163], v[112:115], v[104:107], 0
    v_fmac_f32 v217, v184, v67
    v_fmac_f32 v208, v150, v50
    v_mfma_f32_16x16x32_bf16 v[160:163], v[116:119], v[108:111], v[160:163]
    v_fmac_f32 v217, v185, v67
    v_fmac_f32 v209, v151, v51
    v_smfmac_f32_16x16x64_bf16 v[188:191], v[120:123], v[104:111], v250
    v_mad_u32_u16 v108, v206, s57, v213 op_sel:[0,0,0,0]
    v_mfma_f32_16x16x32_bf16 v[164:167], v[112:115], v[112:115], 0
    ds_read_b128 v[104:107], v108 offset:0
    ds_read_b128 v[108:111], v108 offset:64
    v_smfmac_f32_16x16x64_bf16 v[196:199], v[56:59], v[156:163], v216
    s_waitcnt lgkmcnt(4)
    v_mfma_f32_16x16x32_bf16 v[164:167], v[116:119], v[116:119], v[164:167]
    v_fmac_f32 v217, v188, v68
    v_fmac_f32 v208, v152, v52
    v_smfmac_f32_16x16x64_bf16 v[192:195], v[120:123], v[112:119], v250
    v_mad_u32_u16 v116, v206, s57, v213 op_sel:[1,0,0,0]
    v_mfma_f32_16x16x32_bf16 v[168:171], v[120:123], v[120:123], 0
    ds_read_b128 v[112:115], v116 offset:0
    v_mfma_f32_16x16x32_bf16 v[124:127], v[72:75], v[72:75], 0
    ds_read_b128 v[116:119], v116 offset:64
    v_mad_u32_u16 v122, v207, s57, v248 op_sel:[0,0,0,0]
    ds_read2_b32 v[120:121], v122 offset0:0 offset1:2
    v_mfma_f32_16x16x32_bf16 v[124:127], v[76:79], v[76:79], v[124:127]
    ds_read2_b32 v[122:123], v122 offset0:4 offset1:6
    ds_read_b128 v[204:207], v214 offset:6912
    v_mfma_f32_16x16x32_bf16 v[128:131], v[80:83], v[72:75], 0
    v_fmac_f32 v217, v189, v68
    v_fmac_f32 v217, v196, v200
    v_mfma_f32_16x16x32_bf16 v[128:131], v[84:87], v[76:79], v[128:131]
    v_fmac_f32 v217, v192, v69
    v_fmac_f32 v217, v197, v201
    v_mfma_f32_16x16x32_bf16 v[132:135], v[80:83], v[80:83], 0
    v_fmac_f32 v217, v193, v69
    v_fmac_f32 v217, v198, v202
    v_mfma_f32_16x16x32_bf16 v[132:135], v[84:87], v[84:87], v[132:135]
    v_fmac_f32 v217, v199, v203
    v_fmac_f32 v209, v153, v53
    v_mfma_f32_16x16x32_bf16 v[136:139], v[88:91], v[80:83], 0
    v_fmac_f32 v208, v154, v54
    v_fmac_f32 v209, v155, v55
    v_mfma_f32_16x16x32_bf16 v[136:139], v[92:95], v[84:87], v[136:139]
    v_fmac_f32 v208, v164, v60
    v_fmac_f32 v209, v165, v61
    v_mfma_f32_16x16x32_bf16 v[140:143], v[88:91], v[72:75], 0
    v_fmac_f32 v208, v166, v62
    v_fmac_f32 v209, v167, v63
    v_mfma_f32_16x16x32_bf16 v[140:143], v[92:95], v[76:79], v[140:143]
    s_waitcnt lgkmcnt(7)
    v_add_f32 v209, v209, v217
    v_smfmac_f32_16x16x64_bf16 v[196:199], v[8:11], v[132:139], v216
    v_fmac_f32 v208, v168, v70
    v_mfma_f32_16x16x32_bf16 v[144:147], v[96:99], v[72:75], 0
    v_fmac_f32 v208, v169, v71
    v_add_f32 v211, v208, v209
    v_mfma_f32_16x16x32_bf16 v[144:147], v[100:103], v[76:79], v[144:147]
    v_fma_f32 v208, v124, v0, -v217
    v_mul_f32 v209, v125, v1
    v_mfma_f32_16x16x32_bf16 v[148:151], v[80:83], v[96:99], 0
    v_fmac_f32 v208, v126, v2
    v_fmac_f32 v209, v127, v3
    v_mfma_f32_16x16x32_bf16 v[148:151], v[84:87], v[100:103], v[148:151]
    v_fmac_f32 v208, v128, v4
    v_fmac_f32 v209, v129, v5
    v_mfma_f32_16x16x32_bf16 v[152:155], v[88:91], v[96:99], 0
    v_fmac_f32 v208, v130, v6
    v_fmac_f32 v209, v131, v7
    v_mfma_f32_16x16x32_bf16 v[152:155], v[92:95], v[100:103], v[152:155]
    v_fmac_f32 v208, v140, v12
    v_fmac_f32 v209, v141, v13
    v_mfma_f32_16x16x32_bf16 v[156:159], v[88:91], v[88:91], 0
    v_fmac_f32 v208, v142, v14
    v_fmac_f32 v209, v143, v15
    v_mfma_f32_16x16x32_bf16 v[156:159], v[92:95], v[92:95], v[156:159]
    v_fmac_f32 v208, v144, v16
    v_fmac_f32 v209, v145, v17
    v_smfmac_f32_16x16x64_bf16 v[196:199], v[20:23], v[148:155], v216
    v_fmac_f32 v208, v146, v18
    v_mfma_f32_16x16x32_bf16 v[160:163], v[96:99], v[96:99], 0
    s_waitcnt lgkmcnt(0)
    v_fmac_f32 v209, v147, v19
    v_mfma_f32_16x16x32_bf16 v[160:163], v[100:103], v[100:103], v[160:163]
    v_fmac_f32 v208, v156, v24
    v_fmac_f32 v209, v157, v25
    v_mfma_f32_16x16x32_bf16 v[124:127], v[104:107], v[72:75], 0
    v_fmac_f32 v208, v158, v26
    v_fmac_f32 v209, v159, v27
    v_mfma_f32_16x16x32_bf16 v[124:127], v[108:111], v[76:79], v[124:127]
    v_permlane32_swap_b32 v210, v211
    s_waitcnt vmcnt(1)
    v_mfma_f32_16x16x32_bf16 v[128:131], v[112:115], v[72:75], 0
    v_fmac_f32 v208, v160, v28
    v_fmac_f32 v209, v161, v29
    v_mfma_f32_16x16x32_bf16 v[128:131], v[116:119], v[76:79], v[128:131]
    v_fmac_f32 v208, v162, v30
    v_fmac_f32 v209, v163, v31
    v_smfmac_f32_16x16x64_bf16 v[172:175], v[120:123], v[72:79], v250
    v_mad_u32_u16 v76, v204, s57, v213 op_sel:[0,0,0,0]
    v_mfma_f32_16x16x32_bf16 v[132:135], v[104:107], v[80:83], 0
    ds_read_b128 v[72:75], v76 offset:0
    ds_read_b128 v[76:79], v76 offset:64
    v_smfmac_f32_16x16x64_bf16 v[196:199], v[32:35], v[124:131], v216
    v_add_f32 v218, v210, v211
    v_mfma_f32_16x16x32_bf16 v[132:135], v[108:111], v[84:87], v[132:135]
    v_mul_f32 v217, v172, v64
    ds_write_b16 v215, v240 offset:0
    v_mfma_f32_16x16x32_bf16 v[136:139], v[112:115], v[80:83], 0
    v_fmac_f32 v217, v173, v64
    ds_write_b16 v215, v241 offset:576
    v_mfma_f32_16x16x32_bf16 v[136:139], v[116:119], v[84:87], v[136:139]
    ds_write_b16 v215, v242 offset:1152
    ds_write_b16 v215, v243 offset:1728
    v_smfmac_f32_16x16x64_bf16 v[176:179], v[120:123], v[80:87], v250
    v_mad_u32_u16 v84, v204, s57, v213 op_sel:[1,0,0,0]
    v_mfma_f32_16x16x32_bf16 v[140:143], v[104:107], v[88:91], 0
    ds_read_b128 v[80:83], v84 offset:0
    ds_read_b128 v[84:87], v84 offset:64
    v_mfma_f32_16x16x32_bf16 v[140:143], v[108:111], v[92:95], v[140:143]
    v_fmac_f32 v208, v132, v36
    v_fmac_f32 v209, v133, v37
    v_mfma_f32_16x16x32_bf16 v[144:147], v[112:115], v[88:91], 0
    v_fmac_f32 v217, v176, v65
    v_fmac_f32 v208, v134, v38
    v_mfma_f32_16x16x32_bf16 v[144:147], v[116:119], v[92:95], v[144:147]
    v_fmac_f32 v217, v177, v65
    v_fmac_f32 v209, v135, v39
    v_smfmac_f32_16x16x64_bf16 v[180:183], v[120:123], v[88:95], v250
    v_mad_u32_u16 v92, v205, s57, v213 op_sel:[0,0,0,0]
    v_mfma_f32_16x16x32_bf16 v[148:151], v[104:107], v[96:99], 0
    ds_read_b128 v[88:91], v92 offset:0
    ds_read_b128 v[92:95], v92 offset:64
    v_smfmac_f32_16x16x64_bf16 v[196:199], v[44:47], v[140:147], v216
    v_fmac_f32 v208, v136, v40
    v_mfma_f32_16x16x32_bf16 v[148:151], v[108:111], v[100:103], v[148:151]
    v_fmac_f32 v217, v180, v66
    v_fmac_f32 v209, v137, v41
    v_mfma_f32_16x16x32_bf16 v[152:155], v[112:115], v[96:99], 0
    v_fmac_f32 v217, v181, v66
    v_fmac_f32 v208, v138, v42
    v_mfma_f32_16x16x32_bf16 v[152:155], v[116:119], v[100:103], v[152:155]
    v_fmac_f32 v209, v139, v43
    buffer_load_dwordx4 v[240:243], v249, s[16:19], s74 offen offset:0
    v_smfmac_f32_16x16x64_bf16 v[184:187], v[120:123], v[96:103], v250
    v_mad_u32_u16 v100, v205, s57, v213 op_sel:[1,0,0,0]
    v_mfma_f32_16x16x32_bf16 v[156:159], v[104:107], v[104:107], 0
    ds_read_b128 v[96:99], v100 offset:0
    ds_read_b128 v[100:103], v100 offset:64
    v_mfma_f32_16x16x32_bf16 v[156:159], v[108:111], v[108:111], v[156:159]
    v_fmac_f32 v208, v148, v48
    v_fmac_f32 v209, v149, v49
    v_mfma_f32_16x16x32_bf16 v[160:163], v[112:115], v[104:107], 0
    v_fmac_f32 v217, v184, v67
    v_fmac_f32 v208, v150, v50
    v_mfma_f32_16x16x32_bf16 v[160:163], v[116:119], v[108:111], v[160:163]
    v_fmac_f32 v217, v185, v67
    v_fmac_f32 v209, v151, v51
    v_smfmac_f32_16x16x64_bf16 v[188:191], v[120:123], v[104:111], v250
    v_mad_u32_u16 v108, v206, s57, v213 op_sel:[0,0,0,0]
    v_mfma_f32_16x16x32_bf16 v[164:167], v[112:115], v[112:115], 0
    ds_read_b128 v[104:107], v108 offset:0
    ds_read_b128 v[108:111], v108 offset:64
    v_smfmac_f32_16x16x64_bf16 v[196:199], v[56:59], v[156:163], v216
    s_waitcnt lgkmcnt(4)
    v_mfma_f32_16x16x32_bf16 v[164:167], v[116:119], v[116:119], v[164:167]
    v_fmac_f32 v217, v188, v68
    v_fmac_f32 v208, v152, v52
    v_smfmac_f32_16x16x64_bf16 v[192:195], v[120:123], v[112:119], v250
    v_mad_u32_u16 v116, v206, s57, v213 op_sel:[1,0,0,0]
    v_mfma_f32_16x16x32_bf16 v[168:171], v[120:123], v[120:123], 0
    ds_read_b128 v[112:115], v116 offset:0
    v_mfma_f32_16x16x32_bf16 v[124:127], v[72:75], v[72:75], 0
    ds_read_b128 v[116:119], v116 offset:64
    v_mad_u32_u16 v122, v207, s57, v248 op_sel:[0,0,0,0]
    ds_read2_b32 v[120:121], v122 offset0:0 offset1:2
    v_mfma_f32_16x16x32_bf16 v[124:127], v[76:79], v[76:79], v[124:127]
    ds_read2_b32 v[122:123], v122 offset0:4 offset1:6
    ds_read_b128 v[204:207], v214 offset:0
    v_mfma_f32_16x16x32_bf16 v[128:131], v[80:83], v[72:75], 0
    v_fmac_f32 v217, v189, v68
    v_fmac_f32 v217, v196, v200
    v_mfma_f32_16x16x32_bf16 v[128:131], v[84:87], v[76:79], v[128:131]
    v_fmac_f32 v217, v192, v69
    v_fmac_f32 v217, v197, v201
    v_mfma_f32_16x16x32_bf16 v[132:135], v[80:83], v[80:83], 0
    v_fmac_f32 v217, v193, v69
    v_fmac_f32 v217, v198, v202
    v_mfma_f32_16x16x32_bf16 v[132:135], v[84:87], v[84:87], v[132:135]
    v_fmac_f32 v217, v199, v203
    v_fmac_f32 v209, v153, v53
    v_mfma_f32_16x16x32_bf16 v[136:139], v[88:91], v[80:83], 0
    v_fmac_f32 v208, v154, v54
    v_fmac_f32 v209, v155, v55
    v_mfma_f32_16x16x32_bf16 v[136:139], v[92:95], v[84:87], v[136:139]
    v_fmac_f32 v208, v164, v60
    v_fmac_f32 v209, v165, v61
    v_mfma_f32_16x16x32_bf16 v[140:143], v[88:91], v[72:75], 0
    v_fmac_f32 v208, v166, v62
    v_fmac_f32 v209, v167, v63
    v_mfma_f32_16x16x32_bf16 v[140:143], v[92:95], v[76:79], v[140:143]
    s_waitcnt lgkmcnt(7)
    v_add_f32 v209, v209, v217
    v_smfmac_f32_16x16x64_bf16 v[196:199], v[8:11], v[132:139], v216
    v_fmac_f32 v208, v168, v70
    v_mfma_f32_16x16x32_bf16 v[144:147], v[96:99], v[72:75], 0
    v_fmac_f32 v208, v169, v71
    v_add_f32 v210, v208, v209
    v_mfma_f32_16x16x32_bf16 v[144:147], v[100:103], v[76:79], v[144:147]
    v_fma_f32 v208, v124, v0, -v217
    v_mul_f32 v209, v125, v1
    v_mfma_f32_16x16x32_bf16 v[148:151], v[80:83], v[96:99], 0
    v_fmac_f32 v208, v126, v2
    v_fmac_f32 v209, v127, v3
    v_mfma_f32_16x16x32_bf16 v[148:151], v[84:87], v[100:103], v[148:151]
    v_fmac_f32 v208, v128, v4
    v_fmac_f32 v209, v129, v5
    v_mfma_f32_16x16x32_bf16 v[152:155], v[88:91], v[96:99], 0
    v_fmac_f32 v208, v130, v6
    v_fmac_f32 v209, v131, v7
    v_mfma_f32_16x16x32_bf16 v[152:155], v[92:95], v[100:103], v[152:155]
    v_fmac_f32 v208, v140, v12
    v_fmac_f32 v209, v141, v13
    v_mfma_f32_16x16x32_bf16 v[156:159], v[88:91], v[88:91], 0
    v_fmac_f32 v208, v142, v14
    v_fmac_f32 v209, v143, v15
    v_mfma_f32_16x16x32_bf16 v[156:159], v[92:95], v[92:95], v[156:159]
    v_fmac_f32 v208, v144, v16
    v_fmac_f32 v209, v145, v17
    v_smfmac_f32_16x16x64_bf16 v[196:199], v[20:23], v[148:155], v216
    v_fmac_f32 v208, v146, v18
    v_mfma_f32_16x16x32_bf16 v[160:163], v[96:99], v[96:99], 0
    s_waitcnt lgkmcnt(0)
    v_fmac_f32 v209, v147, v19
    v_mfma_f32_16x16x32_bf16 v[160:163], v[100:103], v[100:103], v[160:163]
    v_fmac_f32 v208, v156, v24
    v_fmac_f32 v209, v157, v25
    v_mfma_f32_16x16x32_bf16 v[124:127], v[104:107], v[72:75], 0
    v_fmac_f32 v208, v158, v26
    v_fmac_f32 v209, v159, v27
    v_mfma_f32_16x16x32_bf16 v[124:127], v[108:111], v[76:79], v[124:127]
    v_add_f32_dpp v220, v220, v220 quad_perm:[1,0,3,2] row_mask:0xf bank_mask:0xf
    s_sub_u32 s58, s58, 1
    v_mfma_f32_16x16x32_bf16 v[128:131], v[112:115], v[72:75], 0
    v_fmac_f32 v208, v160, v28
    v_fmac_f32 v209, v161, v29
    v_mfma_f32_16x16x32_bf16 v[128:131], v[116:119], v[76:79], v[128:131]
    v_fmac_f32 v208, v162, v30
    v_fmac_f32 v209, v163, v31
    v_smfmac_f32_16x16x64_bf16 v[172:175], v[120:123], v[72:79], v250
    v_mad_u32_u16 v76, v204, s57, v213 op_sel:[0,0,0,0]
    v_mfma_f32_16x16x32_bf16 v[132:135], v[104:107], v[80:83], 0
    ds_read_b128 v[72:75], v76 offset:0
    ds_read_b128 v[76:79], v76 offset:64
    v_smfmac_f32_16x16x64_bf16 v[196:199], v[32:35], v[124:131], v216
    v_add_f32_dpp v220, v220, v220 quad_perm:[2,3,0,1] row_mask:0xf bank_mask:0xf
    v_mfma_f32_16x16x32_bf16 v[132:135], v[108:111], v[84:87], v[132:135]
    v_mul_f32 v217, v172, v64
    v_mfma_f32_16x16x32_bf16 v[136:139], v[112:115], v[80:83], 0
    v_fmac_f32 v217, v173, v64
    v_add_f32_dpp v220, v220, v220 row_half_mirror row_mask:0xf bank_mask:0xf
    v_mfma_f32_16x16x32_bf16 v[136:139], v[116:119], v[84:87], v[136:139]
    v_smfmac_f32_16x16x64_bf16 v[176:179], v[120:123], v[80:87], v250
    v_mad_u32_u16 v84, v204, s57, v213 op_sel:[1,0,0,0]
    v_mfma_f32_16x16x32_bf16 v[140:143], v[104:107], v[88:91], 0
    ds_read_b128 v[80:83], v84 offset:0
    ds_read_b128 v[84:87], v84 offset:64
    v_mfma_f32_16x16x32_bf16 v[140:143], v[108:111], v[92:95], v[140:143]
    v_fmac_f32 v208, v132, v36
    v_fmac_f32 v209, v133, v37
    v_mfma_f32_16x16x32_bf16 v[144:147], v[112:115], v[88:91], 0
    v_fmac_f32 v217, v176, v65
    v_fmac_f32 v208, v134, v38
    v_mfma_f32_16x16x32_bf16 v[144:147], v[116:119], v[92:95], v[144:147]
    v_fmac_f32 v217, v177, v65
    v_fmac_f32 v209, v135, v39
    v_smfmac_f32_16x16x64_bf16 v[180:183], v[120:123], v[88:95], v250
    v_mad_u32_u16 v92, v205, s57, v213 op_sel:[0,0,0,0]
    v_mfma_f32_16x16x32_bf16 v[148:151], v[104:107], v[96:99], 0
    ds_read_b128 v[88:91], v92 offset:0
    ds_read_b128 v[92:95], v92 offset:64
    v_smfmac_f32_16x16x64_bf16 v[196:199], v[44:47], v[140:147], v216
    v_fmac_f32 v208, v136, v40
    v_mfma_f32_16x16x32_bf16 v[148:151], v[108:111], v[100:103], v[148:151]
    v_fmac_f32 v217, v180, v66
    v_fmac_f32 v209, v137, v41
    v_mfma_f32_16x16x32_bf16 v[152:155], v[112:115], v[96:99], 0
    v_fmac_f32 v217, v181, v66
    v_fmac_f32 v208, v138, v42
    v_mfma_f32_16x16x32_bf16 v[152:155], v[116:119], v[100:103], v[152:155]
    v_fmac_f32 v209, v139, v43
    v_cndmask_b32_dpp v212, v212, v220, vcc row_shr:1 row_mask:0xf bank_mask:0xf bound_ctrl:0
    v_smfmac_f32_16x16x64_bf16 v[184:187], v[120:123], v[96:103], v250
    v_mad_u32_u16 v100, v205, s57, v213 op_sel:[1,0,0,0]
    v_mfma_f32_16x16x32_bf16 v[156:159], v[104:107], v[104:107], 0
    ds_read_b128 v[96:99], v100 offset:0
    ds_read_b128 v[100:103], v100 offset:64
    v_mfma_f32_16x16x32_bf16 v[156:159], v[108:111], v[108:111], v[156:159]
    v_fmac_f32 v208, v148, v48
    v_fmac_f32 v209, v149, v49
    v_mfma_f32_16x16x32_bf16 v[160:163], v[112:115], v[104:107], 0
    v_fmac_f32 v217, v184, v67
    v_fmac_f32 v208, v150, v50
    v_mfma_f32_16x16x32_bf16 v[160:163], v[116:119], v[108:111], v[160:163]
    v_fmac_f32 v217, v185, v67
    v_fmac_f32 v209, v151, v51
    v_smfmac_f32_16x16x64_bf16 v[188:191], v[120:123], v[104:111], v250
    v_mad_u32_u16 v108, v206, s57, v213 op_sel:[0,0,0,0]
    v_mfma_f32_16x16x32_bf16 v[164:167], v[112:115], v[112:115], 0
    ds_read_b128 v[104:107], v108 offset:0
    ds_read_b128 v[108:111], v108 offset:64
    v_smfmac_f32_16x16x64_bf16 v[196:199], v[56:59], v[156:163], v216
    s_waitcnt lgkmcnt(4)
    v_mfma_f32_16x16x32_bf16 v[164:167], v[116:119], v[116:119], v[164:167]
    v_fmac_f32 v217, v188, v68
    v_fmac_f32 v208, v152, v52
    v_smfmac_f32_16x16x64_bf16 v[192:195], v[120:123], v[112:119], v250
    v_mad_u32_u16 v116, v206, s57, v213 op_sel:[1,0,0,0]
    v_mfma_f32_16x16x32_bf16 v[168:171], v[120:123], v[120:123], 0
    ds_read_b128 v[112:115], v116 offset:0
    s_cbranch_scc0 k1_kernel_loop
    s_nop 7
    v_fmac_f32 v217, v189, v68
    v_fmac_f32 v217, v196, v200
    v_fmac_f32 v217, v192, v69
    v_fmac_f32 v217, v197, v201
    v_fmac_f32 v217, v193, v69
    v_fmac_f32 v217, v198, v202
    v_fmac_f32 v217, v199, v203
    v_fmac_f32 v209, v153, v53
    v_fmac_f32 v208, v154, v54
    v_fmac_f32 v209, v155, v55
    v_fmac_f32 v208, v164, v60
    v_fmac_f32 v209, v165, v61
    v_fmac_f32 v208, v166, v62
    v_fmac_f32 v209, v167, v63
    v_add_f32 v209, v209, v217
    v_fmac_f32 v208, v168, v70
    v_fmac_f32 v208, v169, v71
    v_add_f32 v211, v208, v209
    v_and_b32 v40, 7, v255
    s_mul_i32 s76, s36, 7
    v_permlane32_swap_b32 v210, v211
    v_add_f32 v219, v210, v211
    s_waitcnt lgkmcnt(0)
    v_lshrrev_b32 v41, 5, v255
    v_permlane16_swap_b32 v218, v219
    v_add_f32 v220, v218, v219
    s_xor_b32 s76, s76, 7
    v_bfe_u32 v42, v255, 4, 1
    v_add_f32_dpp v220, v220, v220 quad_perm:[1,0,3,2] row_mask:0xf bank_mask:0xf
    v_xor_b32 v40, s76, v40
    v_lshl_add_u32 v41, v42, 1, v41
    v_add_f32_dpp v220, v220, v220 quad_perm:[2,3,0,1] row_mask:0xf bank_mask:0xf
    s_lshl_b32 s74, s72, 2
    v_lshl_add_u32 v40, v40, 2, v41
    v_add_f32_dpp v220, v220, v220 row_half_mirror row_mask:0xf bank_mask:0xf
    v_cndmask_b32_dpp v212, v212, v220, vcc row_shr:1 row_mask:0xf bank_mask:0xf bound_ctrl:0
    s_lshl_b32 s76, s36, 16
    v_lshlrev_b32 v113, 2, v40
    v_add_f32_dpp v112, v212, v212 row_ror:8 row_mask:0xf bank_mask:0xf
    s_add_u32 s74, s74, s76
    s_add_u32 s74, s74, 29360128
    s_waitcnt vmcnt(0)
    v_min_u32 v112, -2, v112
    s_branch k1_kernel_k2
k1_kernel_last:
    s_endpgm
.section .rodata,"a"
.p2align 6
.amdhsa_kernel standalone__deep_cross_pnn__recsys_kernel
  .amdhsa_next_free_vgpr 256
  .amdhsa_next_free_sgpr 102
  .amdhsa_accum_offset 256
  .amdhsa_group_segment_fixed_size 0
  .amdhsa_kernarg_size 80
  .amdhsa_user_sgpr_count 2
  .amdhsa_user_sgpr_kernarg_segment_ptr 1
  .amdhsa_system_sgpr_workgroup_id_x 1
.end_amdhsa_kernel
```

```asm
; @launch grid=(256,1,1) block=(512,1,1) lds=163840
.amdgcn_target "amdgcn-amd-amdhsa--gfx950"
.text
.globl standalone__deep_cross_pnn__recsys_kernel
.p2align 8
.type standalone__deep_cross_pnn__recsys_kernel,@function
standalone__deep_cross_pnn__recsys_kernel:

    s_cmp_ge_u32 s2, 256
    s_cbranch_scc1 k1_kernel_end

    s_load_dwordx8 s[4:11], s[0:1], 0
    s_load_dwordx2 s[12:13], s[0:1], 72
    s_load_dwordx2 s[52:53], s[0:1], 64

    v_cmp_gt_u32 vcc, 40, v0
    s_and_saveexec_b64 s[48:49], vcc
    s_cbranch_execz k1_kernel_ncp
    s_getpc_b64 s[46:47]
k1_kernel_pc:
    s_bfe_u32 s38, s2, 0x40003
    s_lshl_b32 s38, s38, 7
    v_lshl_add_u32 v2, v0, 11, s38
    v_min_u32 v2, k1_kernel_last-k1_kernel_pc, v2
    global_load_dword v250, v2, s[46:47]
k1_kernel_ncp:
    s_mov_b64 exec, s[48:49]

    v_lshrrev_b32 v1, 6, v0
    v_and_b32 v255, 63, v0
    s_bfe_u32 s36, s2, 0x10003
    v_readfirstlane_b32 s3, v1
    s_lshr_b32 s37, s2, 4
    s_lshl_b32 s37, s37, 3
    s_and_b32 s38, s2, 7
    s_or_b32 s37, s37, s38
    v_lshlrev_b32 v254, 4, v255
    v_mov_b32 v252, 144144
    v_mov_b32 v253, 1
    v_mov_b32 v40, 0
    v_lshl_add_u32 v41, v0, 2, v252
    v_cmp_gt_u32 vcc, 8, v0
    s_and_saveexec_b64 s[46:47], vcc
    ds_write_b32 v41, v40
    s_mov_b64 exec, s[46:47]
    v_mul_u32_u24 v6, 57, v255
    v_lshrrev_b32 v6, 9, v6
    v_mul_u32_u24 v5, 9, v6
    v_sub_u32 v5, v255, v5
    v_cmp_gt_u32 s[40:41], 8, v5
    s_lshl_b32 s38, s36, 7
    v_lshl_add_u32 v5, v5, 4, s38
    v_lshl_add_u32 v83, v6, 8, v5
    s_and_b32 s56, s3, 3
    s_bitset0_b32 s41, 31
    s_lshr_b32 s42, s2, 3
    s_mul_i32 s42, s42, 36
    s_lshr_b32 s42, s42, 5
    s_lshl_b32 s42, s42, 2
    s_add_u32 s42, s42, s56
    s_mov_b32 s43, s42
    s_mov_b32 s50, s36
    s_lshl_b32 s72, s37, 7
    s_lshl_b32 s73, s3, 5
    s_add_u32 s72, s72, s73
    s_mul_i32 s74, s72, 400
    s_mul_i32 s45, s36, 11200
    s_add_u32 s74, s74, s45
    s_lshl_b32 s38, s3, 10
    s_add_u32 m0, s38, 144384

    s_mov_b32 s18, 6553600
    s_mov_b32 s19, 0x00020000
    s_mov_b32 s22, 256000
    s_mov_b32 s23, 0x00020000
    s_mov_b32 s26, 20000
    s_mov_b32 s27, 0x00020000
    s_mov_b32 s30, 13107200
    s_mov_b32 s31, 0x00020000
    s_mov_b32 s34, 268435456
    s_mov_b32 s35, 0x00020000
    s_mov_b32 s14, 268435456
    s_mov_b32 s15, 0x00020000
    s_mov_b32 s54, 256
    s_mov_b32 s55, 0x00020000

    v_bfe_u32 v5, v255, 2, 2
    v_mul_u32_u24 v5, 200, v5
    v_and_b32 v6, 3, v255
    v_lshl_add_u32 v5, v6, 5, v5
    v_and_b32 v6, 32, v255
    v_lshl_add_u32 v5, v6, 2, v5
    v_and_b32 v6, 16, v255
    v_add_u32 v5, v5, v6
    s_movk_i32 s39, 19200
    s_cmp_ge_u32 s3, 4
    s_waitcnt lgkmcnt(0)
    s_barrier
    s_cbranch_scc1 k1_kernel_dma

    s_mov_b32 s24, s8
    s_and_b32 s25, s9, 0xffff
    buffer_load_dwordx4 v254, s[24:27], s38 offen lds
    s_add_u32 s38, s38, 4096
    s_add_u32 m0, s38, 144384
    s_mov_b32 s16, s4
    s_and_b32 s17, s5, 0xffff
    buffer_load_dwordx4 v254, s[24:27], s38 offen lds
    s_add_u32 s38, s38, 4096
    s_add_u32 m0, s38, 144384
    v_cmp_lt_u32 vcc, 24, v255
    buffer_load_dwordx4 v254, s[24:27], s38 offen lds
    s_add_u32 s38, s38, 4096
    s_add_u32 m0, s38, 144384
    v_subbrev_co_u32 v249, vcc, 0, v255, vcc
    buffer_load_dwordx4 v254, s[24:27], s38 offen lds
    s_add_u32 s38, s38, 4096
    s_min_u32 s38, s38, 18432
    s_add_u32 m0, s38, 144384
    v_min_u32 v249, 49, v249
    v_lshlrev_b32 v249, 4, v249
    buffer_load_dwordx4 v254, s[24:27], s38 offen lds
    buffer_load_dwordx4 v[232:235], v5, s[24:27], s39 offen
    buffer_load_dwordx4 v[240:243], v249, s[16:19], s74 offen offset:0
    buffer_load_dwordx4 v[244:247], v249, s[16:19], s74 offen offset:800

    s_mul_i32 s77, s36, -3200
    s_mul_i32 s78, s72, 400
    s_addk_i32 s77, 1600
    s_add_u32 s79, s78, 11200
    s_add_u32 s74, s74, s77

    s_branch k1_kernel_main
k1_kernel_dma:
    s_mov_b32 s20, s6
    s_and_b32 s21, s7, 0xffff
    s_mov_b64 exec, s[40:41]
k1_kernel_dml:

    s_min_u32 s38, s42, 142
    s_mul_i32 m0, s38, 1008
    s_mul_i32 s39, s38, 1792
    s_add_u32 s42, s42, 4
    buffer_load_dwordx4 v83, s[20:23], s39 offen lds
    s_cmp_ge_u32 s42, 144
    s_cselect_b32 s38, 144, 0
    s_sub_u32 s42, s42, s38
    s_cmp_lg_u32 s42, s43
    s_cbranch_scc1 k1_kernel_dml
    s_mov_b64 exec, -1

    s_mov_b32 s16, s4
    s_and_b32 s17, s5, 0xffff
    s_mov_b32 s20, s6
    s_and_b32 s21, s7, 0xffff
    s_mov_b32 s28, s10
    s_and_b32 s29, s11, 0xffff
    s_mov_b32 s32, s12
    s_and_b32 s33, s13, 0xffff
    s_and_b32 s13, s13, 0xffff
    s_and_b32 s53, s53, 0xffff
k1_kernel_aux:

    s_setprio 0
    v_mov_b32 v8, v255
    v_mov_b32 v9, v254
    v_mov_b32 v10, v253
    v_mov_b32 v11, v252
    s_mov_b32 s51, s2
    s_mov_b32 s64, 0
    s_mov_b32 s65, 0

k1_kernel_unit:

    s_bfe_u32 s60, s51, 0x10003
    s_lshr_b32 s38, s51, 7
    s_xnor_b32 s36, s60, s38
    s_and_b32 s36, s36, 1

    s_lshr_b32 s38, s51, 4
    s_and_b32 s39, s51, 7
    s_sub_u32 s57, 2, s36
    s_lshl_b32 s57, s39, s57
    s_lshl_b32 s37, s36, 5
    s_add_u32 s57, s57, s37
    s_add_u32 s57, s57, s56
    s_mul_i32 s37, s38, 48
    s_add_u32 s37, s37, s57
    s_lshl_b32 s38, s38, 1
    s_lshr_b32 s39, s39, 2
    s_add_u32 s38, s38, s39
    s_add_u32 s38, s38, 768
    s_and_b32 s57, s57, 7
    s_cmp_eq_u32 s57, 2
    s_cselect_b32 s38, s38, 1000
    s_lshl_b32 s39, s36, 1
    s_and_b32 s39, s39, s56
    s_cselect_b32 s57, s38, s37

    s_mov_b32 s63, s36
    s_mov_b32 s36, s60
    s_lshr_b32 s37, s51, 4
    s_lshl_b32 s37, s37, 3
    s_and_b32 s38, s51, 7
    s_or_b32 s37, s37, s38
    s_and_b32 s58, s56, 1
    s_lshl_b32 s59, s37, 1
    s_add_u32 s58, s58, s59
    s_lshr_b32 s59, s56, 1
    s_xor_b32 s62, s59, 1
    s_and_b32 s59, s59, s63
    s_add_u32 s61, s63, 6
    s_mul_i32 s61, s61, s62
    s_mul_i32 s60, s36, 12
    s_add_u32 s61, s61, s60
    s_mul_i32 s60, s58, 25600
    s_lshl4_add_u32 s60, s61, s60
    s_cmp_eq_u32 s61, 7
    s_cselect_b32 s38, 5, 99
    s_movk_i32 s61, 400
    v_lshrrev_b32 v1, 3, v8
    v_and_b32 v2, 7, v8
    v_cmp_ne_u32 vcc, s38, v2
    v_mul_u32_u24 v0, s61, v1
    v_cmp_gt_u32 s[48:49], 7, v2
    v_cndmask_b32 v5, 17, v2, vcc
    v_lshl_add_u32 v0, v5, 4, v0
    v_and_b32 v5, 15, v8
    v_and_b32 v6, 48, v8
    v_lshl_add_u32 v7, v5, 8, v6
    s_lshl_b32 s44, s56, 15
    s_xor_b32 s38, s50, 1
    s_lshl_b32 s38, s38, 7
    s_add_u32 s44, s44, s38

    s_mov_b64 exec, s[48:49]
    buffer_load_dwordx4 v[224:227], v0, s[16:19], s60 offen
    s_add_u32 s60, s60, 3200
    buffer_load_dwordx4 v[228:231], v0, s[16:19], s60 offen
    s_add_u32 s60, s60, 3200
    buffer_load_dwordx4 v[232:235], v0, s[16:19], s60 offen
    s_add_u32 s60, s60, 3200
    buffer_load_dwordx4 v[236:239], v0, s[16:19], s60 offen
    s_add_u32 s60, s60, 3200
    buffer_load_dwordx4 v[240:243], v0, s[16:19], s60 offen
    s_add_u32 s60, s60, 3200
    buffer_load_dwordx4 v[244:247], v0, s[16:19], s60 offen
    s_add_u32 s60, s60, 3200
    buffer_load_dwordx4 v[248:251], v0, s[16:19], s60 offen
    s_add_u32 s60, s60, 3200
    buffer_load_dwordx4 v[252:255], v0, s[16:19], s60 offen
    s_add_u32 s60, s60, 3200
    s_mov_b64 exec, -1

    s_lshr_b32 s78, s57, 5
    s_bfe_u32 s79, s57, 0x20003
    s_bfe_u32 s80, s57, 0x20001
    s_and_b32 s81, s57, 1
    s_lshl_b32 s77, s78, 2
    s_lshl_b32 s83, s81, 1
    s_add_u32 s77, s77, s83
    s_lshl_b32 s77, s77, 7
    s_lshl_b32 s83, s79, 5
    s_add_u32 s77, s77, s83
    s_lshl_b32 s83, s80, 3
    s_add_u32 s77, s77, s83
    s_lshl_b32 s77, s77, 10
    s_lshl_b32 s82, s78, 12
    s_lshl_b32 s83, s79, 10
    s_add_u32 s82, s82, s83
    s_lshl_b32 s83, s80, 8
    s_add_u32 s82, s82, s83
    s_lshl_b32 s83, s81, 7
    s_add_u32 s82, s82, s83
    s_mov_b32 s84, 205312
    v_lshrrev_b32 v3, 2, v8
    v_and_b32 v4, 3, v8
    v_mul_lo_u32 v14, v3, s84
    v_lshl_add_u32 v14, v4, 4, v14
    s_lshl_b32 s61, s56, 12
    s_add_u32 s61, s61, 147456
    v_and_b32 v3, 3, v3
    v_lshlrev_b32 v36, 6, v8
    v_lshl_add_u32 v36, v3, 4, v36
    v_add_u32 v36, s61, v36
    v_xor_b32 v37, 16, v36
    v_xor_b32 v38, 32, v36
    v_xor_b32 v39, 48, v36
    v_and_b32 v3, 48, v8
    v_xor_b32 v15, v3, v9
    v_add_u32 v15, s61, v15
    s_mov_b32 s84, 0x05040100
    s_mov_b32 s85, 0x07060302
    s_cmp_eq_u32 s64, 0
    s_cbranch_scc1 k1_kernel_nsig0
    s_waitcnt vmcnt(0)

k1_kernel_nsig0:

    s_waitcnt vmcnt(8)
    s_cmp_lg_u32 s64, 0
    s_cbranch_scc1 k1_kernel_nsig

    s_mov_b64 exec, 1
    ds_add_u32 v11, v10 offset:16
    s_mov_b64 exec, -1

k1_kernel_nsig:
    s_setprio 3

    s_lshl_b32 s61, s56, 12
    s_add_u32 s61, s61, 147456
    v_lshlrev_b32 v86, 2, v8
    v_add_u32 v86, s61, v86
    v_and_b32 v85, 0xffffff80, v86
    v_and_b32 v123, 32, v8
    s_add_u32 s61, s61, 256
    v_mul_u32_u24 v31, 56, v8
    v_add_u32 v31, s61, v31
    v_mul_u32_u24 v34, 56, v1
    v_lshl_add_u32 v34, v2, 3, v34
    v_add_u32 v34, s61, v34
    s_lshl_b32 s61, s62, s63
    v_add_u32 v2, s61, v2
    v_subrev_u32 v3, 5, v2
    v_min_u32 v2, v2, v3
    v_mov_b32 v13, 0
    v_mul_u32_u24 v2, 0x10001, v2
    v_lshlrev_b32 v2, 12, v2
    v_add_u32 v32, 67108864, v2
    v_add_u32 v33, 201328640, v2
    v_mov_b32 v71, 0xf00
    s_add_u32 s61, s63, 7
    s_xor_b32 s63, s63, 1
    s_cmp_eq_u32 s62, 1
    s_cselect_b32 s62, s61, s63
    s_mul_i32 s63, s36, 13
    s_add_u32 s62, s62, s63
    s_lshl_b32 s62, s62, 7
    s_and_b32 s63, s58, 127
    s_add_u32 s62, s62, s63
    s_lshl_b32 s62, s62, 10
    s_add_u32 s62, s62, 16777216
    s_cmp_eq_u32 s59, 1
    s_cselect_b32 s63, -16, 0x0ffffff0
    s_movk_i32 s66, 0x7c
    s_mov_b32 s67, 0x001f001f
    s_mov_b32 s75, 0x06040200
    v_mov_b32 v54, 0x08040201
    v_mov_b32 v55, 0x80402010

    s_lshl_b32 s72, s2, 15
    s_lshl_b32 s73, s56, 13
    s_add_u32 s72, s72, s73
    s_add_u32 s72, s72, 20971520
    s_lshl_b32 s73, s36, 9
    s_lshl2_add_u32 s73, s37, s73
    s_add_u32 s73, s73, s56
    s_lshl_b32 s73, s73, 7
    s_add_u32 s73, s73, 29360128

k1_kernel_wf3:

    ds_read_b32 v12, v11 offset:12
    s_waitcnt lgkmcnt(0)
    v_readfirstlane_b32 s45, v12
    s_cmp_lt_u32 s45, 4
    s_cbranch_scc1 k1_kernel_wf3

    s_mov_b64 exec, s[48:49]

    s_waitcnt vmcnt(7)
    v_lshl_or_b32 v224, v225, 16, v224
    v_lshl_or_b32 v225, v227, 16, v226
    v_add_u32 v224, v32, v224
    v_add_u32 v225, v33, v225
    ds_write_b64 v34, v[224:225] offset:0

    s_waitcnt vmcnt(6)
    v_lshl_or_b32 v228, v229, 16, v228
    v_lshl_or_b32 v229, v231, 16, v230
    v_add_u32 v228, v32, v228
    v_add_u32 v229, v33, v229
    ds_write_b64 v34, v[228:229] offset:448

    s_waitcnt vmcnt(5)
    v_lshl_or_b32 v232, v233, 16, v232
    v_lshl_or_b32 v233, v235, 16, v234
    v_add_u32 v232, v32, v232
    v_add_u32 v233, v33, v233
    ds_write_b64 v34, v[232:233] offset:896

    s_waitcnt vmcnt(4)
    v_lshl_or_b32 v236, v237, 16, v236
    v_lshl_or_b32 v237, v239, 16, v238
    v_add_u32 v236, v32, v236
    v_add_u32 v237, v33, v237
    ds_write_b64 v34, v[236:237] offset:1344

    s_waitcnt vmcnt(3)
    v_lshl_or_b32 v240, v241, 16, v240
    v_lshl_or_b32 v241, v243, 16, v242
    v_add_u32 v240, v32, v240
    v_add_u32 v241, v33, v241
    ds_write_b64 v34, v[240:241] offset:1792

    s_waitcnt vmcnt(2)
    v_lshl_or_b32 v244, v245, 16, v244
    v_lshl_or_b32 v245, v247, 16, v246
    v_add_u32 v244, v32, v244
    v_add_u32 v245, v33, v245
    ds_write_b64 v34, v[244:245] offset:2240

    s_waitcnt vmcnt(1)
    v_lshl_or_b32 v248, v249, 16, v248
    v_lshl_or_b32 v249, v251, 16, v250
    v_add_u32 v248, v32, v248
    v_add_u32 v249, v33, v249
    ds_write_b64 v34, v[248:249] offset:2688

    s_waitcnt vmcnt(0)
    v_lshl_or_b32 v252, v253, 16, v252
    v_lshl_or_b32 v253, v255, 16, v254
    v_add_u32 v252, v32, v252
    v_add_u32 v253, v33, v253
    ds_write_b64 v34, v[252:253] offset:3136

    s_mov_b64 exec, -1
    ds_read_b64 v[40:41], v31 offset:0
    ds_read_b64 v[42:43], v31 offset:8
    ds_read_b64 v[44:45], v31 offset:16
    ds_read_b64 v[46:47], v31 offset:24
    ds_read_b64 v[48:49], v31 offset:32
    ds_read_b64 v[50:51], v31 offset:40
    ds_read_b64 v[52:53], v31 offset:48

    s_waitcnt lgkmcnt(6)
    v_perm_b32 v72, v41, v40, s75
    v_lshrrev_b32 v73, 3, v72
    v_lshlrev_b32 v64, 2, v72
    v_and_b32 v72, 0x07070707, v72
    v_and_b32 v0, 0x03030303, v73
    v_perm_b32 v16, v55, v54, v72
    v_xor_b32 v23, v55, v16

    s_waitcnt lgkmcnt(5)
    v_perm_b32 v72, v43, v42, s75
    v_lshrrev_b32 v73, 3, v72
    v_lshlrev_b32 v65, 2, v72
    v_and_b32 v72, 0x07070707, v72
    v_and_b32 v1, 0x03030303, v73
    v_perm_b32 v17, v55, v54, v72
    v_xor_b32 v24, v55, v17

    s_waitcnt lgkmcnt(4)
    v_perm_b32 v72, v45, v44, s75
    v_lshrrev_b32 v73, 3, v72
    v_lshlrev_b32 v66, 2, v72
    v_and_b32 v72, 0x07070707, v72
    v_and_b32 v2, 0x03030303, v73
    v_perm_b32 v18, v55, v54, v72
    v_xor_b32 v25, v55, v18

    s_waitcnt lgkmcnt(3)
    v_perm_b32 v72, v47, v46, s75
    v_lshrrev_b32 v73, 3, v72
    v_lshlrev_b32 v67, 2, v72
    v_and_b32 v72, 0x07070707, v72
    v_and_b32 v3, 0x03030303, v73
    v_perm_b32 v19, v55, v54, v72
    v_xor_b32 v26, v55, v19

    s_waitcnt lgkmcnt(2)
    v_perm_b32 v72, v49, v48, s75
    v_lshrrev_b32 v73, 3, v72
    v_lshlrev_b32 v68, 2, v72
    v_and_b32 v72, 0x07070707, v72
    v_and_b32 v4, 0x03030303, v73
    v_perm_b32 v20, v55, v54, v72
    v_xor_b32 v27, v55, v20

    s_waitcnt lgkmcnt(1)
    v_perm_b32 v72, v51, v50, s75
    v_lshrrev_b32 v73, 3, v72
    v_lshlrev_b32 v69, 2, v72
    v_and_b32 v72, 0x07070707, v72
    v_and_b32 v5, 0x03030303, v73
    v_perm_b32 v21, v55, v54, v72
    v_xor_b32 v28, v55, v21

    s_waitcnt lgkmcnt(0)
    v_perm_b32 v72, v53, v52, s75
    v_lshrrev_b32 v73, 3, v72
    v_lshlrev_b32 v70, 2, v72
    v_and_b32 v72, 0x07070707, v72
    v_and_b32 v6, 0x03030303, v73
    v_perm_b32 v22, v55, v54, v72
    v_xor_b32 v29, v55, v22

    ds_write_b32 v86, v13
    v_mov_b32 v71, s63
    v_subrev_u32 v30, 8, v31
    s_setprio 0
    v_ffbl_b32 v84, v71

    v_perm_b32 v72, v64, v64, v84
    v_and_or_b32 v72, v72, s66, v85
    ds_add_rtn_u32 v87, v72, v10
    ds_wrxchg_rtn_b32 v116, v86, v13

    s_waitcnt lgkmcnt(0)
    v_cmp_gt_u32 s[68:69], 2, v116

    v_cmpx_lt_u32 vcc, 1, v87
    s_nop 0
    v_lshrrev_b64 v[74:75], v123, s[68:69]
    v_perm_b32 v121, v74, v74, v1
    v_perm_b32 v122, v74, v74, v0
    v_and_b32 v121, v121, v17
    v_and_b32 v122, v122, v16
    v_msad_u8 v120, v24, v121, 0
    v_lshlrev_b32 v120, 4, v120
    v_msad_u8 v120, v23, v122, v120
    v_and_b32 v120, v120, v71

    v_ffbl_b32 v120, v120
    v_max_i32 v84, v120, v84
    s_mov_b64 exec, -1

    v_lshl_add_u32 v73, v84, 1, v30
    v_lshl_add_u32 v71, -1, v84, v71
    ds_read_u16 v80, v73 offset:0
    v_ffbl_b32 v84, v71

    v_perm_b32 v72, v64, v64, v84
    v_and_or_b32 v72, v72, s66, v85
    ds_add_rtn_u32 v87, v72, v10
    ds_wrxchg_rtn_b32 v116, v86, v13

    s_lshl_b32 s45, s2, 8
    s_add_u32 s45, s45, 14680064
    s_mov_b64 exec, 3
    buffer_store_dword v13, v9, s[12:15], s45 offen sc1
    s_mov_b64 exec, -1
    buffer_load_dwordx4 v[128:131], v9, s[28:31], s77 offen offset:0

    s_waitcnt lgkmcnt(0)
    v_cmp_gt_u32 s[68:69], 2, v116

    v_cmpx_lt_u32 vcc, 1, v87
    s_nop 0
    v_lshrrev_b64 v[74:75], v123, s[68:69]
    v_perm_b32 v121, v74, v74, v1
    v_perm_b32 v122, v74, v74, v0
    v_and_b32 v121, v121, v17
    v_and_b32 v122, v122, v16
    v_msad_u8 v120, v24, v121, 0
    v_lshlrev_b32 v120, 4, v120
    v_msad_u8 v120, v23, v122, v120
    v_and_b32 v120, v120, v71

    v_ffbl_b32 v120, v120
    v_max_i32 v84, v120, v84
    s_mov_b64 exec, -1

    v_lshl_add_u32 v73, v84, 1, v30
    v_lshl_add_u32 v71, -1, v84, v71
    ds_read_u16 v81, v73 offset:0
    v_ffbl_b32 v84, v71

    v_perm_b32 v72, v64, v64, v84
    v_and_or_b32 v72, v72, s66, v85
    ds_add_rtn_u32 v87, v72, v10
    ds_wrxchg_rtn_b32 v116, v86, v13

    s_lshl_b32 s45, s2, 10
    s_add_u32 s45, s45, 30408704
    s_mov_b32 exec_lo, 0x01010101
    s_mov_b32 exec_hi, 0x01010101
    buffer_store_dword v13, v9, s[12:15], s45 offen sc1
    s_mul_i32 s45, s2, 67584
    s_add_u32 s45, s45, 67108864
    s_mov_b64 exec, 1
    buffer_load_dword v117, v13, s[12:15], s45 offen
    s_mov_b64 exec, -1
    buffer_load_dwordx4 v[132:135], v9, s[28:31], s77 offen offset:1024

    s_waitcnt lgkmcnt(0)
    v_cmp_gt_u32 s[68:69], 2, v116

    v_cmpx_lt_u32 vcc, 1, v87
    s_nop 0
    v_lshrrev_b64 v[74:75], v123, s[68:69]
    v_perm_b32 v121, v74, v74, v1
    v_perm_b32 v122, v74, v74, v0
    v_and_b32 v121, v121, v17
    v_and_b32 v122, v122, v16
    v_msad_u8 v120, v24, v121, 0
    v_lshlrev_b32 v120, 4, v120
    v_msad_u8 v120, v23, v122, v120
    v_and_b32 v120, v120, v71

    v_ffbl_b32 v120, v120
    v_max_i32 v84, v120, v84
    s_mov_b64 exec, -1

    v_lshl_add_u32 v73, v84, 1, v30
    v_lshl_add_u32 v71, -1, v84, v71
    ds_read_u16 v82, v73 offset:0
    v_ffbl_b32 v84, v71

    v_perm_b32 v72, v64, v64, v84
    v_and_or_b32 v72, v72, s66, v85
    ds_add_rtn_u32 v87, v72, v10
    ds_wrxchg_rtn_b32 v116, v86, v13

    buffer_load_dwordx4 v[144:147], v9, s[28:31], s77 offen offset:2048

    s_waitcnt lgkmcnt(0)
    v_cmp_gt_u32 s[68:69], 2, v116

    v_cmpx_lt_u32 vcc, 1, v87
    s_nop 0
    v_lshrrev_b64 v[74:75], v123, s[68:69]
    v_perm_b32 v121, v74, v74, v1
    v_and_b32 v121, v121, v17
    v_msad_u8 v120, v24, v121, 0
    v_lshlrev_b32 v120, 4, v120
    v_and_b32 v120, v120, v71

    v_ffbl_b32 v120, v120
    v_max_i32 v84, v120, v84
    s_mov_b64 exec, -1

    v_lshl_add_u32 v73, v84, 1, v30
    v_lshl_add_u32 v71, -1, v84, v71
    ds_read_u16 v83, v73 offset:0
    v_lshrrev_b32 v71, 4, v71
    v_ffbl_b32 v84, v71

    v_perm_b32 v72, v65, v64, v84
    v_and_or_b32 v72, v72, s66, v85
    ds_add_rtn_u32 v87, v72, v10
    ds_wrxchg_rtn_b32 v116, v86, v13

    buffer_load_dwordx4 v[148:151], v9, s[28:31], s77 offen offset:3072
    s_add_u32 s77, s77, 4096
    s_mov_b32 s70, 0x7fff7fff

    s_waitcnt lgkmcnt(0)
    v_cmp_gt_u32 s[68:69], 2, v116

    s_cmp_eq_u32 s59, 0
    v_lshl_or_b32 v76, v81, 16, v80
    v_lshl_or_b32 v77, v83, 16, v82
    s_cbranch_scc1 k1_kernel_nf0
    buffer_store_dwordx4 v[76:79], v9, s[32:35], s62 offen sc1
    s_add_u32 s62, s62, 262144
k1_kernel_nf0:
    v_cmpx_lt_u32 vcc, 1, v87
    v_bfe_i32 v119, s70, v71, 1
    v_lshrrev_b64 v[74:75], v123, s[68:69]
    v_perm_b32 v121, v74, v74, v2
    v_perm_b32 v122, v74, v74, v1
    v_and_b32 v121, v121, v18
    v_and_b32 v122, v122, v17
    v_msad_u8 v120, v25, v121, 0
    v_lshlrev_b32 v120, 4, v120
    v_msad_u8 v120, v24, v122, v120
    v_bitop3_b32 v120, v120, v71, v119 bitop3:0x80

    v_ffbl_b32 v120, v120
    v_max_i32 v84, v120, v84
    s_mov_b64 exec, -1

    v_lshl_add_u32 v73, v84, 1, v30
    v_lshl_add_u32 v71, -1, v84, v71
    ds_read_u16 v80, v73 offset:8
    v_ffbl_b32 v84, v71

    v_perm_b32 v72, v65, v64, v84
    v_and_or_b32 v72, v72, s66, v85
    ds_add_rtn_u32 v87, v72, v10
    ds_wrxchg_rtn_b32 v116, v86, v13

    buffer_load_dwordx4 v[160:163], v9, s[28:31], s77 offen offset:0
    s_mov_b32 s70, 0x977f977f

    s_waitcnt lgkmcnt(0)
    v_cmp_gt_u32 s[68:69], 2, v116

    v_cmpx_lt_u32 vcc, 1, v87
    v_bfe_i32 v119, s70, v71, 1
    v_lshrrev_b64 v[74:75], v123, s[68:69]
    v_perm_b32 v121, v74, v74, v2
    v_perm_b32 v122, v74, v74, v1
    v_and_b32 v121, v121, v18
    v_and_b32 v122, v122, v17
    v_msad_u8 v120, v25, v121, 0
    v_lshlrev_b32 v120, 4, v120
    v_msad_u8 v120, v24, v122, v120
    v_bitop3_b32 v120, v120, v71, v119 bitop3:0x80

    v_ffbl_b32 v120, v120
    v_max_i32 v84, v120, v84
    s_mov_b64 exec, -1

    v_lshl_add_u32 v73, v84, 1, v30
    v_lshl_add_u32 v71, -1, v84, v71
    ds_read_u16 v81, v73 offset:8
    v_ffbl_b32 v84, v71

    v_perm_b32 v72, v65, v64, v84
    v_and_or_b32 v72, v72, s66, v85
    ds_add_rtn_u32 v87, v72, v10
    ds_wrxchg_rtn_b32 v116, v86, v13

    buffer_load_dwordx4 v[164:167], v9, s[28:31], s77 offen offset:1024
    s_mov_b32 s70, 0xe997e997

    s_waitcnt lgkmcnt(0)
    v_cmp_gt_u32 s[68:69], 2, v116

    v_cmpx_lt_u32 vcc, 1, v87
    v_bfe_i32 v119, s70, v71, 1
    v_lshrrev_b64 v[74:75], v123, s[68:69]
    v_perm_b32 v121, v74, v74, v2
    v_perm_b32 v122, v74, v74, v1
    v_and_b32 v121, v121, v18
    v_and_b32 v122, v122, v17
    v_msad_u8 v120, v25, v121, 0
    v_lshlrev_b32 v120, 4, v120
    v_msad_u8 v120, v24, v122, v120
    v_bitop3_b32 v120, v120, v71, v119 bitop3:0x80

    v_ffbl_b32 v120, v120
    v_max_i32 v84, v120, v84
    s_mov_b64 exec, -1

    v_lshl_add_u32 v73, v84, 1, v30
    v_lshl_add_u32 v71, -1, v84, v71
    ds_read_u16 v82, v73 offset:8
    v_ffbl_b32 v84, v71

    v_perm_b32 v72, v65, v64, v84
    v_and_or_b32 v72, v72, s66, v85
    ds_add_rtn_u32 v87, v72, v10
    ds_wrxchg_rtn_b32 v116, v86, v13

    buffer_load_dwordx4 v[176:179], v9, s[28:31], s77 offen offset:2048
    s_add_u32 s47, s44, 12288
    buffer_load_dwordx4 v[56:59], v7, s[20:23], s47 offen offset:0
    buffer_load_dwordx4 v[60:63], v7, s[20:23], s47 offen offset:64
    s_mov_b32 s70, 0xfee9fee9

    s_waitcnt lgkmcnt(0)
    v_cmp_gt_u32 s[68:69], 2, v116

    v_cmpx_lt_u32 vcc, 1, v87
    v_bfe_i32 v119, s70, v71, 1
    v_lshrrev_b64 v[74:75], v123, s[68:69]
    v_perm_b32 v121, v74, v74, v2
    v_and_b32 v121, v121, v18
    v_msad_u8 v120, v25, v121, 0
    v_lshlrev_b32 v120, 4, v120
    v_bitop3_b32 v120, v120, v71, v119 bitop3:0x80

    v_ffbl_b32 v120, v120
    v_max_i32 v84, v120, v84
    s_mov_b64 exec, -1

    v_lshl_add_u32 v73, v84, 1, v30
    v_lshl_add_u32 v71, -1, v84, v71
    ds_read_u16 v83, v73 offset:8
    v_lshrrev_b32 v71, 4, v71
    v_ffbl_b32 v84, v71

    v_perm_b32 v72, v66, v65, v84
    v_and_or_b32 v72, v72, s66, v85
    ds_add_rtn_u32 v87, v72, v10
    ds_wrxchg_rtn_b32 v116, v86, v13

    buffer_load_dwordx4 v[180:183], v9, s[28:31], s77 offen offset:3072
    s_add_u32 s77, s77, 126976
    s_cmp_lg_u32 s64, 0
    s_cbranch_scc1 k1_kernel_nc8
    v_mov_b32 v121, -1
    v_lshlrev_b32 v122, 1, v8
    buffer_store_short v121, v122, s[12:15], s73 offen sc1
k1_kernel_nc8:
    s_add_u32 s47, s44, 16384
    buffer_load_dwordx4 v[88:91], v7, s[20:23], s47 offen offset:0
    buffer_load_dwordx4 v[92:95], v7, s[20:23], s47 offen offset:64
    s_mov_b32 s70, 0x7fff7fff

    s_waitcnt lgkmcnt(0)
    v_cmp_gt_u32 s[68:69], 2, v116

    s_cmp_eq_u32 s59, 1
    v_lshl_or_b32 v78, v81, 16, v80
    v_lshl_or_b32 v79, v83, 16, v82
    s_cbranch_scc1 k1_kernel_nf1
    buffer_store_dwordx4 v[76:79], v9, s[32:35], s62 offen sc1
    s_add_u32 s62, s62, 262144
k1_kernel_nf1:
    v_cmpx_lt_u32 vcc, 1, v87
    v_bfe_i32 v119, s70, v71, 1
    v_lshrrev_b64 v[74:75], v123, s[68:69]
    v_perm_b32 v121, v74, v74, v3
    v_perm_b32 v122, v74, v74, v2
    v_and_b32 v121, v121, v19
    v_and_b32 v122, v122, v18
    v_msad_u8 v120, v26, v121, 0
    v_lshlrev_b32 v120, 4, v120
    v_msad_u8 v120, v25, v122, v120
    v_bitop3_b32 v120, v120, v71, v119 bitop3:0x80

    v_ffbl_b32 v120, v120
    v_max_i32 v84, v120, v84
    s_mov_b64 exec, -1

    v_lshl_add_u32 v73, v84, 1, v30
    v_lshl_add_u32 v71, -1, v84, v71
    ds_read_u16 v80, v73 offset:16
    v_ffbl_b32 v84, v71

    v_perm_b32 v72, v66, v65, v84
    v_and_or_b32 v72, v72, s66, v85
    ds_add_rtn_u32 v87, v72, v10
    ds_wrxchg_rtn_b32 v116, v86, v13

    buffer_load_dwordx4 v[192:195], v9, s[28:31], s77 offen offset:0
    s_add_u32 s47, s44, 20480
    buffer_load_dwordx4 v[96:99], v7, s[20:23], s47 offen offset:0
    buffer_load_dwordx4 v[100:103], v7, s[20:23], s47 offen offset:64
    s_mov_b32 s70, 0x977f977f

    s_waitcnt lgkmcnt(0)
    v_cmp_gt_u32 s[68:69], 2, v116

    v_cmpx_lt_u32 vcc, 1, v87
    v_bfe_i32 v119, s70, v71, 1
    v_lshrrev_b64 v[74:75], v123, s[68:69]
    v_perm_b32 v121, v74, v74, v3
    v_perm_b32 v122, v74, v74, v2
    v_and_b32 v121, v121, v19
    v_and_b32 v122, v122, v18
    v_msad_u8 v120, v26, v121, 0
    v_lshlrev_b32 v120, 4, v120
    v_msad_u8 v120, v25, v122, v120
    v_bitop3_b32 v120, v120, v71, v119 bitop3:0x80

    v_ffbl_b32 v120, v120
    v_max_i32 v84, v120, v84
    s_mov_b64 exec, -1

    v_lshl_add_u32 v73, v84, 1, v30
    v_lshl_add_u32 v71, -1, v84, v71
    ds_read_u16 v81, v73 offset:16
    v_ffbl_b32 v84, v71

    v_perm_b32 v72, v66, v65, v84
    v_and_or_b32 v72, v72, s66, v85
    ds_add_rtn_u32 v87, v72, v10
    ds_wrxchg_rtn_b32 v116, v86, v13

    buffer_load_dwordx4 v[196:199], v9, s[28:31], s77 offen offset:1024
    s_add_u32 s47, s44, 24576
    buffer_load_dwordx4 v[104:107], v7, s[20:23], s47 offen offset:0
    buffer_load_dwordx4 v[108:111], v7, s[20:23], s47 offen offset:64
    s_mov_b32 s70, 0xe997e997

    s_waitcnt lgkmcnt(0)
    v_cmp_gt_u32 s[68:69], 2, v116

    v_cmpx_lt_u32 vcc, 1, v87
    v_bfe_i32 v119, s70, v71, 1
    v_lshrrev_b64 v[74:75], v123, s[68:69]
    v_perm_b32 v121, v74, v74, v3
    v_perm_b32 v122, v74, v74, v2
    v_and_b32 v121, v121, v19
    v_and_b32 v122, v122, v18
    v_msad_u8 v120, v26, v121, 0
    v_lshlrev_b32 v120, 4, v120
    v_msad_u8 v120, v25, v122, v120
    v_bitop3_b32 v120, v120, v71, v119 bitop3:0x80

    v_ffbl_b32 v120, v120
    v_max_i32 v84, v120, v84
    s_mov_b64 exec, -1

    v_lshl_add_u32 v73, v84, 1, v30
    v_lshl_add_u32 v71, -1, v84, v71
    ds_read_u16 v82, v73 offset:16
    v_ffbl_b32 v84, v71

    v_perm_b32 v72, v66, v65, v84
    v_and_or_b32 v72, v72, s66, v85
    ds_add_rtn_u32 v87, v72, v10
    ds_wrxchg_rtn_b32 v116, v86, v13

    buffer_load_dwordx4 v[208:211], v9, s[28:31], s77 offen offset:2048
    s_add_u32 s47, s44, 28672
    buffer_load_dwordx4 v[112:115], v7, s[20:23], s47 offen offset:0
    buffer_load_dwordx4 v[124:127], v7, s[20:23], s47 offen offset:64
    s_mov_b32 s70, 0xfee9fee9

    s_waitcnt lgkmcnt(0)
    v_cmp_gt_u32 s[68:69], 2, v116

    v_cmpx_lt_u32 vcc, 1, v87
    v_bfe_i32 v119, s70, v71, 1
    v_lshrrev_b64 v[74:75], v123, s[68:69]
    v_perm_b32 v121, v74, v74, v3
    v_and_b32 v121, v121, v19
    v_msad_u8 v120, v26, v121, 0
    v_lshlrev_b32 v120, 4, v120
    v_bitop3_b32 v120, v120, v71, v119 bitop3:0x80

    v_ffbl_b32 v120, v120
    v_max_i32 v84, v120, v84
    s_mov_b64 exec, -1

    v_lshl_add_u32 v73, v84, 1, v30
    v_lshl_add_u32 v71, -1, v84, v71
    ds_read_u16 v83, v73 offset:16
    v_lshrrev_b32 v71, 4, v71
    v_ffbl_b32 v84, v71

    v_perm_b32 v72, v67, v66, v84
    v_and_or_b32 v72, v72, s66, v85
    ds_add_rtn_u32 v87, v72, v10
    ds_wrxchg_rtn_b32 v116, v86, v13

    buffer_load_dwordx4 v[212:215], v9, s[28:31], s77 offen offset:3072
    s_add_u32 s77, s77, 4096
    s_add_u32 s47, s44, 131072
    buffer_load_dwordx4 v[136:139], v7, s[20:23], s47 offen offset:0
    buffer_load_dwordx4 v[140:143], v7, s[20:23], s47 offen offset:64
    s_mov_b32 s70, 0x7fff7fff

    s_waitcnt lgkmcnt(0)
    v_cmp_gt_u32 s[68:69], 2, v116

    s_cmp_eq_u32 s59, 0
    v_lshl_or_b32 v76, v81, 16, v80
    v_lshl_or_b32 v77, v83, 16, v82
    s_cbranch_scc1 k1_kernel_nf2
    buffer_store_dwordx4 v[76:79], v9, s[32:35], s62 offen sc1
    s_add_u32 s62, s62, 262144
k1_kernel_nf2:
    v_cmpx_lt_u32 vcc, 1, v87
    v_bfe_i32 v119, s70, v71, 1
    v_lshrrev_b64 v[74:75], v123, s[68:69]
    v_perm_b32 v121, v74, v74, v4
    v_perm_b32 v122, v74, v74, v3
    v_and_b32 v121, v121, v20
    v_and_b32 v122, v122, v19
    v_msad_u8 v120, v27, v121, 0
    v_lshlrev_b32 v120, 4, v120
    v_msad_u8 v120, v26, v122, v120
    v_bitop3_b32 v120, v120, v71, v119 bitop3:0x80

    v_ffbl_b32 v120, v120
    v_max_i32 v84, v120, v84
    s_mov_b64 exec, -1

    v_lshl_add_u32 v73, v84, 1, v30
    v_lshl_add_u32 v71, -1, v84, v71
    ds_read_u16 v80, v73 offset:24
    v_ffbl_b32 v84, v71

    v_perm_b32 v72, v67, v66, v84
    v_and_or_b32 v72, v72, s66, v85
    ds_add_rtn_u32 v87, v72, v10
    ds_wrxchg_rtn_b32 v116, v86, v13

    buffer_load_dwordx4 v[224:227], v9, s[28:31], s77 offen offset:0
    s_add_u32 s47, s44, 135168
    buffer_load_dwordx4 v[152:155], v7, s[20:23], s47 offen offset:0
    buffer_load_dwordx4 v[156:159], v7, s[20:23], s47 offen offset:64
    s_mov_b32 s70, 0x977f977f

    s_waitcnt lgkmcnt(0)
    v_cmp_gt_u32 s[68:69], 2, v116

    v_cmpx_lt_u32 vcc, 1, v87
    v_bfe_i32 v119, s70, v71, 1
    v_lshrrev_b64 v[74:75], v123, s[68:69]
    v_perm_b32 v121, v74, v74, v4
    v_perm_b32 v122, v74, v74, v3
    v_and_b32 v121, v121, v20
    v_and_b32 v122, v122, v19
    v_msad_u8 v120, v27, v121, 0
    v_lshlrev_b32 v120, 4, v120
    v_msad_u8 v120, v26, v122, v120
    v_bitop3_b32 v120, v120, v71, v119 bitop3:0x80

    v_ffbl_b32 v120, v120
    v_max_i32 v84, v120, v84
    s_mov_b64 exec, -1

    v_lshl_add_u32 v73, v84, 1, v30
    v_lshl_add_u32 v71, -1, v84, v71
    ds_read_u16 v81, v73 offset:24
    v_ffbl_b32 v84, v71

    v_perm_b32 v72, v67, v66, v84
    v_and_or_b32 v72, v72, s66, v85
    ds_add_rtn_u32 v87, v72, v10
    ds_wrxchg_rtn_b32 v116, v86, v13

    buffer_load_dwordx4 v[228:231], v9, s[28:31], s77 offen offset:1024
    s_add_u32 s47, s44, 139264
    buffer_load_dwordx4 v[168:171], v7, s[20:23], s47 offen offset:0
    buffer_load_dwordx4 v[172:175], v7, s[20:23], s47 offen offset:64
    s_mov_b32 s70, 0xe997e997

    s_waitcnt lgkmcnt(0)
    v_cmp_gt_u32 s[68:69], 2, v116

    v_cmpx_lt_u32 vcc, 1, v87
    v_bfe_i32 v119, s70, v71, 1
    v_lshrrev_b64 v[74:75], v123, s[68:69]
    v_perm_b32 v121, v74, v74, v4
    v_perm_b32 v122, v74, v74, v3
    v_and_b32 v121, v121, v20
    v_and_b32 v122, v122, v19
    v_msad_u8 v120, v27, v121, 0
    v_lshlrev_b32 v120, 4, v120
    v_msad_u8 v120, v26, v122, v120
    v_bitop3_b32 v120, v120, v71, v119 bitop3:0x80

    v_ffbl_b32 v120, v120
    v_max_i32 v84, v120, v84
    s_mov_b64 exec, -1

    v_lshl_add_u32 v73, v84, 1, v30
    v_lshl_add_u32 v71, -1, v84, v71
    ds_read_u16 v82, v73 offset:24
    v_ffbl_b32 v84, v71

    v_perm_b32 v72, v67, v66, v84
    v_and_or_b32 v72, v72, s66, v85
    ds_add_rtn_u32 v87, v72, v10
    ds_wrxchg_rtn_b32 v116, v86, v13

    buffer_load_dwordx4 v[240:243], v9, s[28:31], s77 offen offset:2048
    s_add_u32 s47, s44, 143360
    buffer_load_dwordx4 v[184:187], v7, s[20:23], s47 offen offset:0
    buffer_load_dwordx4 v[188:191], v7, s[20:23], s47 offen offset:64
    s_mov_b32 s70, 0xfee9fee9

    s_waitcnt lgkmcnt(0)
    v_cmp_gt_u32 s[68:69], 2, v116

    v_cmpx_lt_u32 vcc, 1, v87
    v_bfe_i32 v119, s70, v71, 1
    v_lshrrev_b64 v[74:75], v123, s[68:69]
    v_perm_b32 v121, v74, v74, v4
    v_and_b32 v121, v121, v20
    v_msad_u8 v120, v27, v121, 0
    v_lshlrev_b32 v120, 4, v120
    v_bitop3_b32 v120, v120, v71, v119 bitop3:0x80

    v_ffbl_b32 v120, v120
    v_max_i32 v84, v120, v84
    s_mov_b64 exec, -1

    v_lshl_add_u32 v73, v84, 1, v30
    v_lshl_add_u32 v71, -1, v84, v71
    ds_read_u16 v83, v73 offset:24
    v_lshrrev_b32 v71, 4, v71
    v_ffbl_b32 v84, v71

    v_perm_b32 v72, v68, v67, v84
    v_and_or_b32 v72, v72, s66, v85
    ds_add_rtn_u32 v87, v72, v10
    ds_wrxchg_rtn_b32 v116, v86, v13

    buffer_load_dwordx4 v[244:247], v9, s[28:31], s77 offen offset:3072
    s_add_u32 s47, s44, 147456
    buffer_load_dwordx4 v[200:203], v7, s[20:23], s47 offen offset:0
    buffer_load_dwordx4 v[204:207], v7, s[20:23], s47 offen offset:64
    s_mov_b32 s70, 0x7fff7fff

    s_waitcnt lgkmcnt(0)
    v_cmp_gt_u32 s[68:69], 2, v116

    s_cmp_eq_u32 s59, 1
    v_lshl_or_b32 v78, v81, 16, v80
    v_lshl_or_b32 v79, v83, 16, v82
    s_cbranch_scc1 k1_kernel_nf3
    buffer_store_dwordx4 v[76:79], v9, s[32:35], s62 offen sc1
    s_add_u32 s62, s62, 262144
k1_kernel_nf3:
    v_cmpx_lt_u32 vcc, 1, v87
    v_bfe_i32 v119, s70, v71, 1
    v_lshrrev_b64 v[74:75], v123, s[68:69]
    v_perm_b32 v121, v74, v74, v5
    v_perm_b32 v122, v74, v74, v4
    v_and_b32 v121, v121, v21
    v_and_b32 v122, v122, v20
    v_msad_u8 v120, v28, v121, 0
    v_lshlrev_b32 v120, 4, v120
    v_msad_u8 v120, v27, v122, v120
    v_bitop3_b32 v120, v120, v71, v119 bitop3:0x80

    v_ffbl_b32 v120, v120
    v_max_i32 v84, v120, v84
    s_mov_b64 exec, -1

    v_lshl_add_u32 v73, v84, 1, v30
    v_lshl_add_u32 v71, -1, v84, v71
    ds_read_u16 v80, v73 offset:32
    v_ffbl_b32 v84, v71

    v_perm_b32 v72, v68, v67, v84
    v_and_or_b32 v72, v72, s66, v85
    ds_add_rtn_u32 v87, v72, v10
    ds_wrxchg_rtn_b32 v116, v86, v13

    s_add_u32 s47, s44, 151552
    buffer_load_dwordx4 v[216:219], v7, s[20:23], s47 offen offset:0
    buffer_load_dwordx4 v[220:223], v7, s[20:23], s47 offen offset:64
    s_mov_b32 s70, 0x977f977f

    s_waitcnt lgkmcnt(0)
    v_cmp_gt_u32 s[68:69], 2, v116

    v_cmpx_lt_u32 vcc, 1, v87
    v_bfe_i32 v119, s70, v71, 1
    v_lshrrev_b64 v[74:75], v123, s[68:69]
    v_perm_b32 v121, v74, v74, v5
    v_perm_b32 v122, v74, v74, v4
    v_and_b32 v121, v121, v21
    v_and_b32 v122, v122, v20
    v_msad_u8 v120, v28, v121, 0
    v_lshlrev_b32 v120, 4, v120
    v_msad_u8 v120, v27, v122, v120
    v_bitop3_b32 v120, v120, v71, v119 bitop3:0x80

    v_ffbl_b32 v120, v120
    v_max_i32 v84, v120, v84
    s_mov_b64 exec, -1

    v_lshl_add_u32 v73, v84, 1, v30
    v_lshl_add_u32 v71, -1, v84, v71
    ds_read_u16 v81, v73 offset:32
    v_ffbl_b32 v84, v71

    v_perm_b32 v72, v68, v67, v84
    v_and_or_b32 v72, v72, s66, v85
    ds_add_rtn_u32 v87, v72, v10
    ds_wrxchg_rtn_b32 v116, v86, v13

    s_add_u32 s47, s44, 155648
    buffer_load_dwordx4 v[232:235], v7, s[20:23], s47 offen offset:0
    buffer_load_dwordx4 v[236:239], v7, s[20:23], s47 offen offset:64
    s_mov_b32 s70, 0xe997e997

    s_waitcnt lgkmcnt(0)
    v_cmp_gt_u32 s[68:69], 2, v116

    v_cmpx_lt_u32 vcc, 1, v87
    v_bfe_i32 v119, s70, v71, 1
    v_lshrrev_b64 v[74:75], v123, s[68:69]
    v_perm_b32 v121, v74, v74, v5
    v_perm_b32 v122, v74, v74, v4
    v_and_b32 v121, v121, v21
    v_and_b32 v122, v122, v20
    v_msad_u8 v120, v28, v121, 0
    v_lshlrev_b32 v120, 4, v120
    v_msad_u8 v120, v27, v122, v120
    v_bitop3_b32 v120, v120, v71, v119 bitop3:0x80

    v_ffbl_b32 v120, v120
    v_max_i32 v84, v120, v84
    s_mov_b64 exec, -1

    v_lshl_add_u32 v73, v84, 1, v30
    v_lshl_add_u32 v71, -1, v84, v71
    ds_read_u16 v82, v73 offset:32
    v_ffbl_b32 v84, v71

    v_perm_b32 v72, v68, v67, v84
    v_and_or_b32 v72, v72, s66, v85
    ds_add_rtn_u32 v87, v72, v10
    ds_wrxchg_rtn_b32 v116, v86, v13

    s_add_u32 s47, s44, 159744
    buffer_load_dwordx4 v[248:251], v7, s[20:23], s47 offen offset:0
    buffer_load_dwordx4 v[252:255], v7, s[20:23], s47 offen offset:64
    s_mov_b32 s70, 0xfee9fee9

    s_waitcnt lgkmcnt(0)
    v_cmp_gt_u32 s[68:69], 2, v116

    v_cmpx_lt_u32 vcc, 1, v87
    v_bfe_i32 v119, s70, v71, 1
    v_lshrrev_b64 v[74:75], v123, s[68:69]
    v_perm_b32 v121, v74, v74, v5
    v_and_b32 v121, v121, v21
    v_msad_u8 v120, v28, v121, 0
    v_lshlrev_b32 v120, 4, v120
    v_bitop3_b32 v120, v120, v71, v119 bitop3:0x80

    v_ffbl_b32 v120, v120
    v_max_i32 v84, v120, v84
    s_mov_b64 exec, -1

    v_lshl_add_u32 v73, v84, 1, v30
    v_lshl_add_u32 v71, -1, v84, v71
    ds_read_u16 v83, v73 offset:32
    v_lshrrev_b32 v71, 4, v71

    s_cmp_ge_u32 s57, 800
    s_cbranch_scc1 k1_kernel_norl
    s_waitcnt vmcnt(0)

    v_perm_b32 v0, v132, v128, s84
    v_perm_b32 v1, v148, v144, s84
    v_perm_b32 v2, v164, v160, s84
    v_perm_b32 v3, v180, v176, s84
    v_perm_b32 v16, v132, v128, s85
    v_perm_b32 v17, v148, v144, s85
    v_perm_b32 v18, v164, v160, s85
    v_perm_b32 v19, v180, v176, s85
    v_perm_b32 v32, v133, v129, s84
    v_perm_b32 v33, v149, v145, s84
    v_perm_b32 v34, v165, v161, s84
    v_perm_b32 v35, v181, v177, s84
    v_perm_b32 v64, v133, v129, s85
    v_perm_b32 v65, v149, v145, s85
    v_perm_b32 v66, v165, v161, s85
    v_perm_b32 v67, v181, v177, s85
    ds_write_b128 v36, v[0:3]
    ds_write_b128 v37, v[16:19]
    ds_write_b128 v38, v[32:35]
    ds_write_b128 v39, v[64:67]
    ds_read_b128 v[40:43], v15 offset:0
    ds_read_b128 v[44:47], v15 offset:1024
    ds_read_b128 v[72:75], v15 offset:2048
    ds_read_b128 v[116:119], v15 offset:3072
    v_perm_b32 v0, v196, v192, s84
    v_perm_b32 v1, v212, v208, s84
    v_perm_b32 v2, v228, v224, s84
    v_perm_b32 v3, v244, v240, s84
    v_perm_b32 v16, v196, v192, s85
    v_perm_b32 v17, v212, v208, s85
    v_perm_b32 v18, v228, v224, s85
    v_perm_b32 v19, v244, v240, s85
    v_perm_b32 v32, v197, v193, s84
    v_perm_b32 v33, v213, v209, s84
    v_perm_b32 v34, v229, v225, s84
    v_perm_b32 v35, v245, v241, s84
    v_perm_b32 v64, v197, v193, s85
    v_perm_b32 v65, v213, v209, s85
    v_perm_b32 v66, v229, v225, s85
    v_perm_b32 v67, v245, v241, s85
    s_waitcnt lgkmcnt(0)
    s_add_u32 s83, s82, 0
    buffer_store_dwordx4 v[40:43], v14, s[32:35], s83 offen sc1
    s_add_u32 s83, s82, 3284992
    buffer_store_dwordx4 v[44:47], v14, s[32:35], s83 offen sc1
    s_add_u32 s83, s82, 6569984
    buffer_store_dwordx4 v[72:75], v14, s[32:35], s83 offen sc1
    s_add_u32 s83, s82, 9854976
    buffer_store_dwordx4 v[116:119], v14, s[32:35], s83 offen sc1
    ds_write_b128 v36, v[0:3]
    ds_write_b128 v37, v[16:19]
    ds_write_b128 v38, v[32:35]
    ds_write_b128 v39, v[64:67]
    ds_read_b128 v[40:43], v15 offset:0
    ds_read_b128 v[44:47], v15 offset:1024
    ds_read_b128 v[72:75], v15 offset:2048
    ds_read_b128 v[116:119], v15 offset:3072
    v_perm_b32 v0, v134, v130, s84
    v_perm_b32 v1, v150, v146, s84
    v_perm_b32 v2, v166, v162, s84
    v_perm_b32 v3, v182, v178, s84
    v_perm_b32 v16, v134, v130, s85
    v_perm_b32 v17, v150, v146, s85
    v_perm_b32 v18, v166, v162, s85
    v_perm_b32 v19, v182, v178, s85
    v_perm_b32 v32, v135, v131, s84
    v_perm_b32 v33, v151, v147, s84
    v_perm_b32 v34, v167, v163, s84
    v_perm_b32 v35, v183, v179, s84
    v_perm_b32 v64, v135, v131, s85
    v_perm_b32 v65, v151, v147, s85
    v_perm_b32 v66, v167, v163, s85
    v_perm_b32 v67, v183, v179, s85
    s_waitcnt lgkmcnt(0)
    s_add_u32 s83, s82, 64
    buffer_store_dwordx4 v[40:43], v14, s[32:35], s83 offen sc1
    s_add_u32 s83, s82, 3285056
    buffer_store_dwordx4 v[44:47], v14, s[32:35], s83 offen sc1
    s_add_u32 s83, s82, 6570048
    buffer_store_dwordx4 v[72:75], v14, s[32:35], s83 offen sc1
    s_add_u32 s83, s82, 9855040
    buffer_store_dwordx4 v[116:119], v14, s[32:35], s83 offen sc1
    ds_write_b128 v36, v[0:3]
    ds_write_b128 v37, v[16:19]
    ds_write_b128 v38, v[32:35]
    ds_write_b128 v39, v[64:67]
    ds_read_b128 v[40:43], v15 offset:0
    ds_read_b128 v[44:47], v15 offset:1024
    ds_read_b128 v[72:75], v15 offset:2048
    ds_read_b128 v[116:119], v15 offset:3072
    v_perm_b32 v0, v198, v194, s84
    v_perm_b32 v1, v214, v210, s84
    v_perm_b32 v2, v230, v226, s84
    v_perm_b32 v3, v246, v242, s84
    v_perm_b32 v16, v198, v194, s85
    v_perm_b32 v17, v214, v210, s85
    v_perm_b32 v18, v230, v226, s85
    v_perm_b32 v19, v246, v242, s85
    v_perm_b32 v32, v199, v195, s84
    v_perm_b32 v33, v215, v211, s84
    v_perm_b32 v34, v231, v227, s84
    v_perm_b32 v35, v247, v243, s84
    v_perm_b32 v64, v199, v195, s85
    v_perm_b32 v65, v215, v211, s85
    v_perm_b32 v66, v231, v227, s85
    v_perm_b32 v67, v247, v243, s85
    s_waitcnt lgkmcnt(0)
    s_add_u32 s83, s82, 102656
    buffer_store_dwordx4 v[40:43], v14, s[32:35], s83 offen sc1
    s_add_u32 s83, s82, 3387648
    buffer_store_dwordx4 v[44:47], v14, s[32:35], s83 offen sc1
    s_add_u32 s83, s82, 6672640
    buffer_store_dwordx4 v[72:75], v14, s[32:35], s83 offen sc1
    s_add_u32 s83, s82, 9957632
    buffer_store_dwordx4 v[116:119], v14, s[32:35], s83 offen sc1
    ds_write_b128 v36, v[0:3]
    ds_write_b128 v37, v[16:19]
    ds_write_b128 v38, v[32:35]
    ds_write_b128 v39, v[64:67]
    ds_read_b128 v[40:43], v15 offset:0
    ds_read_b128 v[44:47], v15 offset:1024
    ds_read_b128 v[72:75], v15 offset:2048
    ds_read_b128 v[116:119], v15 offset:3072
    ds_write_b64 v31, v[48:49] offset:32
    ds_write_b64 v31, v[50:51] offset:40
    ds_write_b64 v31, v[52:53] offset:48
    s_waitcnt lgkmcnt(3)
    s_add_u32 s83, s82, 102720
    buffer_store_dwordx4 v[40:43], v14, s[32:35], s83 offen sc1
    s_add_u32 s83, s82, 3387712
    buffer_store_dwordx4 v[44:47], v14, s[32:35], s83 offen sc1
    s_add_u32 s83, s82, 6672704
    buffer_store_dwordx4 v[72:75], v14, s[32:35], s83 offen sc1
    s_add_u32 s83, s82, 9957696
    buffer_store_dwordx4 v[116:119], v14, s[32:35], s83 offen sc1
k1_kernel_norl:
k1_kernel_rld:
    ds_write_b32 v86, v13
    v_ffbl_b32 v84, v71

    v_perm_b32 v72, v69, v68, v84
    v_and_or_b32 v72, v72, s66, v85
    ds_add_rtn_u32 v87, v72, v10
    ds_wrxchg_rtn_b32 v116, v86, v13

    s_mov_b32 s70, 0x7fff7fff

    s_waitcnt lgkmcnt(0)
    v_cmp_gt_u32 s[68:69], 2, v116

    s_cmp_eq_u32 s59, 0
    v_lshl_or_b32 v76, v81, 16, v80
    v_lshl_or_b32 v77, v83, 16, v82
    s_cbranch_scc1 k1_kernel_nf4
    buffer_store_dwordx4 v[76:79], v9, s[32:35], s62 offen sc1
    s_add_u32 s62, s62, 262144
k1_kernel_nf4:
    v_cmpx_lt_u32 vcc, 1, v87
    v_bfe_i32 v119, s70, v71, 1
    v_lshrrev_b64 v[74:75], v123, s[68:69]
    v_perm_b32 v121, v74, v74, v6
    v_perm_b32 v122, v74, v74, v5
    v_and_b32 v121, v121, v22
    v_and_b32 v122, v122, v21
    v_msad_u8 v120, v29, v121, 0
    v_lshlrev_b32 v120, 4, v120
    v_msad_u8 v120, v28, v122, v120
    v_bitop3_b32 v120, v120, v71, v119 bitop3:0x80

    v_ffbl_b32 v120, v120
    v_max_i32 v84, v120, v84
    s_mov_b64 exec, -1

    v_lshl_add_u32 v73, v84, 1, v30
    v_lshl_add_u32 v71, -1, v84, v71
    ds_read_u16 v80, v73 offset:40
    v_ffbl_b32 v84, v71

    v_perm_b32 v72, v69, v68, v84
    v_and_or_b32 v72, v72, s66, v85
    ds_add_rtn_u32 v87, v72, v10
    ds_wrxchg_rtn_b32 v116, v86, v13

    s_mov_b32 s70, 0x977f977f

    s_waitcnt lgkmcnt(0)
    v_cmp_gt_u32 s[68:69], 2, v116

    v_cmpx_lt_u32 vcc, 1, v87
    v_bfe_i32 v119, s70, v71, 1
    v_lshrrev_b64 v[74:75], v123, s[68:69]
    v_perm_b32 v121, v74, v74, v6
    v_perm_b32 v122, v74, v74, v5
    v_and_b32 v121, v121, v22
    v_and_b32 v122, v122, v21
    v_msad_u8 v120, v29, v121, 0
    v_lshlrev_b32 v120, 4, v120
    v_msad_u8 v120, v28, v122, v120
    v_bitop3_b32 v120, v120, v71, v119 bitop3:0x80

    v_ffbl_b32 v120, v120
    v_max_i32 v84, v120, v84
    s_mov_b64 exec, -1

    v_lshl_add_u32 v73, v84, 1, v30
    v_lshl_add_u32 v71, -1, v84, v71
    ds_read_u16 v81, v73 offset:40
    v_ffbl_b32 v84, v71

    v_perm_b32 v72, v69, v68, v84
    v_and_or_b32 v72, v72, s66, v85
    ds_add_rtn_u32 v87, v72, v10
    ds_wrxchg_rtn_b32 v116, v86, v13

    s_mov_b32 s70, 0xe997e997

    s_waitcnt lgkmcnt(0)
    v_cmp_gt_u32 s[68:69], 2, v116

    v_cmpx_lt_u32 vcc, 1, v87
    v_bfe_i32 v119, s70, v71, 1
    v_lshrrev_b64 v[74:75], v123, s[68:69]
    v_perm_b32 v121, v74, v74, v6
    v_perm_b32 v122, v74, v74, v5
    v_and_b32 v121, v121, v22
    v_and_b32 v122, v122, v21
    v_msad_u8 v120, v29, v121, 0
    v_lshlrev_b32 v120, 4, v120
    v_msad_u8 v120, v28, v122, v120
    v_bitop3_b32 v120, v120, v71, v119 bitop3:0x80

    v_ffbl_b32 v120, v120
    v_max_i32 v84, v120, v84
    s_mov_b64 exec, -1

    v_lshl_add_u32 v73, v84, 1, v30
    v_lshl_add_u32 v71, -1, v84, v71
    ds_read_u16 v82, v73 offset:40
    v_ffbl_b32 v84, v71

    v_perm_b32 v72, v69, v68, v84
    v_and_or_b32 v72, v72, s66, v85
    ds_add_rtn_u32 v87, v72, v10
    ds_wrxchg_rtn_b32 v116, v86, v13

    s_mov_b32 s70, 0xfee9fee9

    s_waitcnt lgkmcnt(0)
    v_cmp_gt_u32 s[68:69], 2, v116

    v_cmpx_lt_u32 vcc, 1, v87
    v_bfe_i32 v119, s70, v71, 1
    v_lshrrev_b64 v[74:75], v123, s[68:69]
    v_perm_b32 v121, v74, v74, v6
    v_and_b32 v121, v121, v22
    v_msad_u8 v120, v29, v121, 0
    v_lshlrev_b32 v120, 4, v120
    v_bitop3_b32 v120, v120, v71, v119 bitop3:0x80

    v_ffbl_b32 v120, v120
    v_max_i32 v84, v120, v84
    s_mov_b64 exec, -1

    v_lshl_add_u32 v73, v84, 1, v30
    v_lshl_add_u32 v71, -1, v84, v71
    ds_read_u16 v83, v73 offset:40
    s_cmp_lg_u32 s59, 1
    s_cbranch_scc1 k1_kernel_sdone
    v_lshrrev_b32 v71, 4, v71
    v_ffbl_b32 v84, v71

    v_perm_b32 v72, v70, v69, v84
    v_and_or_b32 v72, v72, s66, v85
    ds_add_rtn_u32 v87, v72, v10
    ds_wrxchg_rtn_b32 v116, v86, v13

    s_waitcnt lgkmcnt(0)
    v_cmp_gt_u32 s[68:69], 2, v116

    v_lshl_or_b32 v78, v81, 16, v80
    v_lshl_or_b32 v79, v83, 16, v82
    v_cmpx_lt_u32 vcc, 1, v87
    v_lshrrev_b64 v[74:75], v123, s[68:69]
    v_perm_b32 v121, v74, v74, v6
    v_and_b32 v121, v121, v22
    v_msad_u8 v120, v29, v121, 0
    v_and_b32 v120, v120, v71

    v_ffbl_b32 v120, v120
    v_max_i32 v84, v120, v84
    s_mov_b64 exec, -1

    v_lshl_add_u32 v73, v84, 1, v30
    v_lshl_add_u32 v71, -1, v84, v71
    ds_read_u16 v80, v73 offset:48
    v_ffbl_b32 v84, v71

    v_perm_b32 v72, v70, v69, v84
    v_and_or_b32 v72, v72, s66, v85
    ds_add_rtn_u32 v87, v72, v10
    ds_wrxchg_rtn_b32 v116, v86, v13

    s_waitcnt lgkmcnt(0)
    v_cmp_gt_u32 s[68:69], 2, v116

    v_cmpx_lt_u32 vcc, 1, v87
    s_nop 0
    v_lshrrev_b64 v[74:75], v123, s[68:69]
    v_perm_b32 v121, v74, v74, v6
    v_and_b32 v121, v121, v22
    v_msad_u8 v120, v29, v121, 0
    v_and_b32 v120, v120, v71

    v_ffbl_b32 v120, v120
    v_max_i32 v84, v120, v84
    s_mov_b64 exec, -1

    v_lshl_add_u32 v73, v84, 1, v30
    v_lshl_add_u32 v71, -1, v84, v71
    ds_read_u16 v81, v73 offset:48
    v_ffbl_b32 v84, v71

    v_perm_b32 v72, v70, v69, v84
    v_and_or_b32 v72, v72, s66, v85
    ds_add_rtn_u32 v87, v72, v10
    ds_wrxchg_rtn_b32 v116, v86, v13

    s_waitcnt lgkmcnt(0)
    v_cmp_gt_u32 s[68:69], 2, v116

    v_cmpx_lt_u32 vcc, 1, v87
    s_nop 0
    v_lshrrev_b64 v[74:75], v123, s[68:69]
    v_perm_b32 v121, v74, v74, v6
    v_and_b32 v121, v121, v22
    v_msad_u8 v120, v29, v121, 0
    v_and_b32 v120, v120, v71

    v_ffbl_b32 v120, v120
    v_max_i32 v84, v120, v84
    s_mov_b64 exec, -1

    v_lshl_add_u32 v73, v84, 1, v30
    v_lshl_add_u32 v71, -1, v84, v71
    ds_read_u16 v82, v73 offset:48
    v_ffbl_b32 v84, v71
    v_lshl_add_u32 v73, v84, 1, v30
    ds_read_u16 v83, v73 offset:48
    s_waitcnt lgkmcnt(0)
    v_lshl_or_b32 v76, v81, 16, v80
    v_lshl_or_b32 v77, v83, 16, v82
    s_branch k1_kernel_sst
k1_kernel_sdone:
    s_waitcnt lgkmcnt(0)
    v_lshl_or_b32 v78, v81, 16, v80
    v_lshl_or_b32 v79, v83, 16, v82
k1_kernel_sst:
    buffer_store_dwordx4 v[76:79], v9, s[32:35], s62 offen sc1
    s_add_u32 s62, s62, 262144
k1_kernel_udone:
    s_setprio 3

    s_mov_b64 exec, 1
    ds_add_rtn_u32 v12, v11, v10 offset:28
    s_waitcnt lgkmcnt(0)
    v_readfirstlane_b32 s45, v12
    s_cmp_ge_u32 s45, 2
    s_cbranch_scc1 k1_kernel_ncl
    s_mov_b64 exec, -1
    s_mul_i32 s45, s45, 16384
    s_min_u32 s45, s45, 16384
    s_lshl_b32 s72, s2, 15
    s_add_u32 s72, s72, s45
    s_add_u32 s72, s72, 20971520
    v_mov_b32 v192, -1
    v_mov_b32 v193, -1
    v_mov_b32 v194, -1
    v_mov_b32 v195, -1
    buffer_store_dwordx4 v[192:195], v9, s[12:15], s72 offen offset:0 sc1
    buffer_store_dwordx4 v[192:195], v9, s[12:15], s72 offen offset:1024 sc1
    buffer_store_dwordx4 v[192:195], v9, s[12:15], s72 offen offset:2048 sc1
    buffer_store_dwordx4 v[192:195], v9, s[12:15], s72 offen offset:3072 sc1
    s_add_u32 s72, s72, 4096
    buffer_store_dwordx4 v[192:195], v9, s[12:15], s72 offen offset:0 sc1
    buffer_store_dwordx4 v[192:195], v9, s[12:15], s72 offen offset:1024 sc1
    buffer_store_dwordx4 v[192:195], v9, s[12:15], s72 offen offset:2048 sc1
    buffer_store_dwordx4 v[192:195], v9, s[12:15], s72 offen offset:3072 sc1
    s_add_u32 s72, s72, 4096
    buffer_store_dwordx4 v[192:195], v9, s[12:15], s72 offen offset:0 sc1
    buffer_store_dwordx4 v[192:195], v9, s[12:15], s72 offen offset:1024 sc1
    buffer_store_dwordx4 v[192:195], v9, s[12:15], s72 offen offset:2048 sc1
    buffer_store_dwordx4 v[192:195], v9, s[12:15], s72 offen offset:3072 sc1
    s_add_u32 s72, s72, 4096
    buffer_store_dwordx4 v[192:195], v9, s[12:15], s72 offen offset:0 sc1
    buffer_store_dwordx4 v[192:195], v9, s[12:15], s72 offen offset:1024 sc1
    buffer_store_dwordx4 v[192:195], v9, s[12:15], s72 offen offset:2048 sc1
    buffer_store_dwordx4 v[192:195], v9, s[12:15], s72 offen offset:3072 sc1
    s_add_u32 s72, s72, 4096
k1_kernel_ncl:

    s_waitcnt vmcnt(0)

    s_mov_b64 exec, 1
    ds_add_rtn_u32 v12, v11, v10 offset:20
    v_mov_b32 v3, 1
    s_bfe_u32 s39, s2, 0x10004
    s_mul_i32 s38, s39, 128
    s_waitcnt lgkmcnt(0)
    v_readfirstlane_b32 s45, v12
    s_cmp_eq_u32 s45, 3
    s_cbranch_scc0 k1_kernel_tld0
    buffer_atomic_add v3, v13, s[52:55], s38 offen offset:32 sc0
k1_kernel_tld0:
    s_and_b32 s45, s45, 3
k1_kernel_tld:
    s_mov_b64 exec, -1
    s_add_u32 s47, s44, 0
    buffer_load_dwordx4 v[32:35], v7, s[20:23], s47 offen offset:0
    buffer_load_dwordx4 v[36:39], v7, s[20:23], s47 offen offset:64
    s_add_u32 s47, s44, 4096
    buffer_load_dwordx4 v[40:43], v7, s[20:23], s47 offen offset:0
    buffer_load_dwordx4 v[44:47], v7, s[20:23], s47 offen offset:64
    s_add_u32 s47, s44, 8192
    buffer_load_dwordx4 v[48:51], v7, s[20:23], s47 offen offset:0
    buffer_load_dwordx4 v[52:55], v7, s[20:23], s47 offen offset:64
    s_cmp_eq_u32 s45, 3
    s_cbranch_scc0 k1_kernel_wdec
    s_lshl_b32 s45, s2, 8
    s_add_u32 s45, s45, 14680064
    v_lshlrev_b32 v0, 8, v8
    v_mov_b32 v116, 0
    s_lshl4_add_u32 s38, s39, 14680064
    s_cmp_lg_u32 s64, 0
    s_cbranch_scc1 k1_kernel_bits
    s_waitcnt vmcnt(6)
    v_readfirstlane_b32 s39, v3

    s_cmp_eq_u32 s39, 127
    s_cbranch_scc0 k1_kernel_poll0

    buffer_store_dword v10, v0, s[12:15], s38 offen sc1
    s_add_u32 s38, s38, 16384
    buffer_store_dword v10, v0, s[12:15], s38 offen sc1
    s_add_u32 s38, s38, 16384
    buffer_store_dword v10, v0, s[12:15], s38 offen sc1
    s_add_u32 s38, s38, 16384
    buffer_store_dword v10, v0, s[12:15], s38 offen sc1

k1_kernel_poll0:
    s_mov_b64 exec, 3
k1_kernel_poll:
    buffer_load_dword v116, v9, s[12:15], s45 offen sc1
    s_add_u32 s65, s65, 1
    s_waitcnt vmcnt(0)
    v_cmp_ne_u32 vcc, 1, v116
    s_cbranch_vccz k1_kernel_go

    s_cmp_lt_u32 s65, 200
    s_cbranch_scc1 k1_kernel_poll
k1_kernel_bits:
    s_mov_b64 exec, -1
    s_lshr_b32 s38, s51, 5
    s_lshl_b32 s39, 1, s51
    v_cmp_eq_u32 vcc, s38, v8
    v_mov_b32 v2, s39
    v_lshlrev_b32 v0, 2, v8
    v_cndmask_b32 v2, 0, v2, vcc
    v_mov_b32 v1, v2
    buffer_atomic_or v1, v0, s[52:55], 0 offen sc0
    s_waitcnt vmcnt(0)
    v_cmp_ne_u32 vcc, 128, v1
    v_or_b32 v1, v1, v2
    s_and_b32 s38, vcc_lo, 0x100
    s_and_b32 s39, vcc_hi, 0x100
    v_cmp_ne_u32 vcc, -1, v1
    s_or_b32 s38, s38, s39
    s_cbranch_scc0 k1_kernel_go
    s_and_b32 s39, vcc_lo, 0xff
    s_mov_b32 s38, 0xc0000000
    s_cbranch_scc0 k1_kernel_dec
    s_ff1_i32_b32 s38, s39
    s_nop 3
    v_readlane_b32 s39, v1, s38
    s_ff0_i32_b32 s39, s39
    s_lshl_b32 s38, s38, 5
    s_add_u32 s38, s38, s39
    s_andn2_b32 s39, s64, 255
    s_add_u32 s39, s39, 256
    s_or_b32 s38, s38, s39
    s_branch k1_kernel_dec

k1_kernel_go:

    s_mov_b32 s38, 0x80000000

k1_kernel_dec:

    v_mov_b32 v1, s38
    s_mov_b64 exec, 1
    ds_write_b32 v11, v1 offset:24

k1_kernel_wdec:

    s_mov_b64 exec, -1
    ds_read_b32 v12, v11 offset:24
    s_waitcnt lgkmcnt(0)
    v_readfirstlane_b32 s45, v12
    s_cmp_lg_u32 s45, s64
    s_cbranch_scc1 k1_kernel_gotd
    s_sleep 2
    s_branch k1_kernel_wdec
k1_kernel_redo:
    s_waitcnt vmcnt(0) lgkmcnt(0)
    s_branch k1_kernel_unit

k1_kernel_gotd:

    s_mov_b32 s64, s45
    s_and_b32 s51, s45, 255
    s_mov_b32 s65, 0x10000
    s_bitcmp0_b32 s45, 31
    s_cbranch_scc1 k1_kernel_redo

k1_kernel_k2:

    s_setprio 0
    s_load_dwordx4 s[8:11], s[0:1], 32
    s_load_dwordx2 s[56:57], s[0:1], 48
    s_load_dwordx2 s[60:61], s[0:1], 56
    v_mbcnt_lo_u32_b32 v0, -1, 0
    v_mbcnt_hi_u32_b32 v0, -1, v0
    s_mul_i32 s35, s3, 18432
    v_and_b32 v1, 15, v0
    v_lshrrev_b32 v2, 4, v0
    v_mul_u32_u24 v65, 144, v1
    v_lshl_add_u32 v65, v2, 4, v65
    v_add_u32 v65, s35, v65

    ds_read_b128 v[128:131], v65 offset:0
    ds_read_b128 v[132:135], v65 offset:64
    ds_read_b128 v[144:147], v65 offset:2304
    ds_read_b128 v[148:151], v65 offset:2368
    ds_read_b128 v[160:163], v65 offset:4608
    ds_read_b128 v[164:167], v65 offset:4672
    ds_read_b128 v[176:179], v65 offset:6912
    ds_read_b128 v[180:183], v65 offset:6976
    ds_read_b128 v[192:195], v65 offset:9216
    ds_read_b128 v[196:199], v65 offset:9280
    ds_read_b128 v[208:211], v65 offset:11520
    ds_read_b128 v[212:215], v65 offset:11584
    ds_read_b128 v[224:227], v65 offset:13824
    ds_read_b128 v[228:231], v65 offset:13888
    ds_read_b128 v[240:243], v65 offset:16128
    ds_read_b128 v[244:247], v65 offset:16192

    s_lshr_b32 s33, s2, 1
    s_and_b32 s34, s2, 1
    v_lshlrev_b32 v71, 4, v0

    s_mul_i32 s21, s33, 102656
    s_mul_i32 s35, s34, 49152
    s_sub_u32 s22, 53248, s35
    s_add_u32 s21, s21, s35
    s_lshl_b32 s35, s50, 11
    s_xor_b32 s19, s35, 2048
    s_add_u32 s19, s19, s21
    s_add_u32 s21, s21, s35
    s_mul_i32 s20, s34, 1703936
    s_add_u32 s20, s20, 16777216
    s_lshl_b32 s35, s3, 14
    s_add_u32 s20, s20, s35

    v_lshlrev_b32 v64, 13, v2
    v_lshl_add_u32 v64, v1, 3, v64
    s_lshl_b32 s35, s3, 10
    v_add_u32 v64, s35, v64
    v_lshrrev_b32 v4, 3, v0
    v_xor_b32 v4, v4, v2
    v_and_b32 v4, 1, v4
    v_bfe_u32 v5, v0, 2, 1
    v_lshl_or_b32 v4, v4, 1, v5
    v_mov_b32 v6, 0x3f80
    v_cmp_eq_u32 vcc, 0, v4
    v_and_b32 v5, 3, v0
    v_mul_u32_u24 v70, 0x5555, v5
    v_cndmask_b32 v66, 0, v6, vcc
    v_cndmask_b32 v67, 0, v6, vcc
    v_cmp_eq_u32 vcc, 1, v4
    v_lshl_add_u32 v70, v64, 13, v70
    s_mov_b32 s23, 0xffff0000
    v_cndmask_b32 v68, 0, v6, vcc
    v_cndmask_b32 v69, 0, v6, vcc

    s_cmp_lt_u32 s3, 4
    s_cbranch_scc1 k1_kernel_k2n
    buffer_load_dwordx4 v[0:3], v71, s[12:15], s21 offen offset:0
    buffer_load_dwordx4 v[4:7], v71, s[12:15], s21 offen offset:1024
    buffer_load_dwordx4 v[8:11], v71, s[12:15], s19 offen offset:0
    buffer_load_dwordx4 v[12:15], v71, s[12:15], s19 offen offset:1024
    s_add_u32 s21, s21, 4096
    s_add_u32 s19, s19, 4096
    buffer_load_dwordx4 v[16:19], v71, s[12:15], s21 offen offset:0
    buffer_load_dwordx4 v[20:23], v71, s[12:15], s21 offen offset:1024
    buffer_load_dwordx4 v[24:27], v71, s[12:15], s19 offen offset:0
    buffer_load_dwordx4 v[28:31], v71, s[12:15], s19 offen offset:1024
    s_add_u32 s21, s21, 4096
    s_add_u32 s19, s19, 4096
    s_mov_b32 s44, s21
    s_mov_b32 s45, s19
    s_add_u32 s21, s21, 4096
    s_add_u32 s19, s19, 4096
    buffer_load_dwordx4 v[72:75], v71, s[12:15], s21 offen offset:0
    buffer_load_dwordx4 v[76:79], v71, s[12:15], s21 offen offset:1024
    buffer_load_dwordx4 v[80:83], v71, s[12:15], s19 offen offset:0
    buffer_load_dwordx4 v[84:87], v71, s[12:15], s19 offen offset:1024
    s_add_u32 s21, s21, 4096
    s_add_u32 s19, s19, 4096
    buffer_load_dwordx2 v[116:117], v71, s[12:15], s20 offen offset:0 sc1
    buffer_load_dwordx2 v[118:119], v71, s[12:15], s20 offen offset:1024 sc1
    buffer_load_dwordx2 v[120:121], v71, s[12:15], s20 offen offset:2048 sc1
    buffer_load_dwordx2 v[122:123], v71, s[12:15], s20 offen offset:3072 sc1
k1_kernel_k2n:

    s_and_b32 s35, s3, 3
    s_lshl_b32 s35, s35, 14
    s_add_u32 s35, s35, 98304
    v_add_u32 v65, s35, v71

    s_lshl_b32 s16, s2, 3
    s_add_u32 s16, s16, s3
    s_lshl_b32 s46, s16, 7
    s_mul_i32 s16, s16, 8448
    s_add_u32 s46, s46, 30408704
    s_add_u32 s16, s16, 67108864

    s_xor_b32 s47, s46, 1024
    s_mul_i32 s35, s34, 135168
    s_add_u32 s18, s16, 67584
    s_sub_u32 s18, s18, s35
    s_mov_b32 s48, 0
    s_lshl_b32 s35, s33, 3
    s_waitcnt lgkmcnt(0)
    s_add_u32 s8, s8, s35
    s_addc_u32 s9, s9, 0
    s_add_u32 s10, s10, s35
    s_addc_u32 s11, s11, 0
    s_barrier

    s_load_dwordx2 s[36:37], s[8:9], 0
    s_load_dwordx2 s[38:39], s[10:11], 0
    s_cmp_lt_u32 s3, 4
    s_cbranch_scc1 k1_kernel_k2m

    s_waitcnt vmcnt(12)
    ds_write_b128 v65, v[32:35] offset:0
    ds_write_b128 v65, v[36:39] offset:1024
    ds_write_b128 v65, v[40:43] offset:2048
    ds_write_b128 v65, v[44:47] offset:3072
    v_mfma_f32_16x16x32_bf16 v[32:35], v[0:3], v[128:131], 0
    v_mfma_f32_16x16x32_bf16 v[36:39], v[0:3], v[144:147], 0
    ds_write_b128 v65, v[48:51] offset:4096
    v_mfma_f32_16x16x32_bf16 v[40:43], v[0:3], v[160:163], 0
    v_mfma_f32_16x16x32_bf16 v[44:47], v[0:3], v[176:179], 0
    ds_write_b128 v65, v[52:55] offset:5120
    v_mfma_f32_16x16x32_bf16 v[32:35], v[4:7], v[132:135], v[32:35]
    v_mfma_f32_16x16x32_bf16 v[36:39], v[4:7], v[148:151], v[36:39]
    ds_write_b128 v65, v[56:59] offset:6144
    v_mfma_f32_16x16x32_bf16 v[40:43], v[4:7], v[164:167], v[40:43]
    v_mfma_f32_16x16x32_bf16 v[44:47], v[4:7], v[180:183], v[44:47]
    ds_write_b128 v65, v[60:63] offset:7168
    v_mfma_f32_16x16x32_bf16 v[32:35], v[8:11], v[136:139], v[32:35]
    v_mfma_f32_16x16x32_bf16 v[36:39], v[8:11], v[152:155], v[36:39]
    ds_write_b128 v65, v[88:91] offset:8192
    v_mfma_f32_16x16x32_bf16 v[40:43], v[8:11], v[168:171], v[40:43]
    v_mfma_f32_16x16x32_bf16 v[44:47], v[8:11], v[184:187], v[44:47]
    ds_write_b128 v65, v[92:95] offset:9216
    v_mfma_f32_16x16x32_bf16 v[32:35], v[12:15], v[140:143], v[32:35]
    v_mfma_f32_16x16x32_bf16 v[36:39], v[12:15], v[156:159], v[36:39]
    ds_write_b128 v65, v[96:99] offset:10240
    v_mfma_f32_16x16x32_bf16 v[40:43], v[12:15], v[172:175], v[40:43]
    v_mfma_f32_16x16x32_bf16 v[44:47], v[12:15], v[188:191], v[44:47]
    ds_write_b128 v65, v[100:103] offset:11264
    v_mfma_f32_16x16x32_bf16 v[48:51], v[0:3], v[192:195], 0
    v_mfma_f32_16x16x32_bf16 v[52:55], v[0:3], v[208:211], 0
    ds_write_b128 v65, v[104:107] offset:12288
    v_mfma_f32_16x16x32_bf16 v[56:59], v[0:3], v[224:227], 0
    v_mfma_f32_16x16x32_bf16 v[60:63], v[0:3], v[240:243], 0
    ds_write_b128 v65, v[108:111] offset:13312
    v_mfma_f32_16x16x32_bf16 v[48:51], v[4:7], v[196:199], v[48:51]
    v_mfma_f32_16x16x32_bf16 v[52:55], v[4:7], v[212:215], v[52:55]
    ds_write_b128 v65, v[112:115] offset:14336
    v_mfma_f32_16x16x32_bf16 v[56:59], v[4:7], v[228:231], v[56:59]
    v_mfma_f32_16x16x32_bf16 v[60:63], v[4:7], v[244:247], v[60:63]
    ds_write_b128 v65, v[124:127] offset:15360
    v_mfma_f32_16x16x32_bf16 v[48:51], v[8:11], v[200:203], v[48:51]
    v_mfma_f32_16x16x32_bf16 v[52:55], v[8:11], v[216:219], v[52:55]
    v_mfma_f32_16x16x32_bf16 v[56:59], v[8:11], v[232:235], v[56:59]
    v_mfma_f32_16x16x32_bf16 v[60:63], v[8:11], v[248:251], v[60:63]
    s_waitcnt lgkmcnt(0)
    s_barrier
    v_mfma_f32_16x16x32_bf16 v[48:51], v[12:15], v[204:207], v[48:51]
    v_mfma_f32_16x16x32_bf16 v[52:55], v[12:15], v[220:223], v[52:55]
    v_mfma_f32_16x16x32_bf16 v[56:59], v[12:15], v[236:239], v[56:59]
    v_mfma_f32_16x16x32_bf16 v[60:63], v[12:15], v[252:255], v[60:63]
    s_add_u32 s20, s20, 4096
    buffer_load_dwordx2 v[124:125], v71, s[12:15], s20 offen offset:0 sc1
    buffer_load_dwordx2 v[126:127], v71, s[12:15], s20 offen offset:1024 sc1
    buffer_load_dwordx4 v[0:3], v71, s[12:15], s44 offen offset:0
    buffer_load_dwordx4 v[4:7], v71, s[12:15], s44 offen offset:1024
    buffer_load_dwordx4 v[8:11], v71, s[12:15], s45 offen offset:0
    buffer_load_dwordx4 v[12:15], v71, s[12:15], s45 offen offset:1024
    s_waitcnt vmcnt(14)
    s_lshl_b32 s24, s36, 16
    s_and_b32 s25, s36, 0xffff0000
    s_lshl_b32 s26, s37, 16
    s_and_b32 s27, s37, 0xffff0000

    v_mfma_f32_16x16x32_bf16 v[88:91], v[16:19], v[128:131], 0
    v_mfma_f32_16x16x32_bf16 v[92:95], v[16:19], v[144:147], 0
    v_mfma_f32_16x16x32_bf16 v[88:91], v[20:23], v[132:135], v[88:91]
    v_mfma_f32_16x16x32_bf16 v[92:95], v[20:23], v[148:151], v[92:95]
    v_mfma_f32_16x16x32_bf16 v[88:91], v[24:27], v[136:139], v[88:91]
    v_cvt_pk_bf16_f32 v32, v32, v33
    v_mfma_f32_16x16x32_bf16 v[92:95], v[24:27], v[152:155], v[92:95]
    v_cvt_pk_bf16_f32 v33, v34, v35
    v_mfma_f32_16x16x32_bf16 v[88:91], v[28:31], v[140:143], v[88:91]
    ds_write_b64 v64, v[32:33] offset:0
    v_mfma_f32_16x16x32_bf16 v[92:95], v[28:31], v[156:159], v[92:95]
    v_cvt_pk_bf16_f32 v36, v36, v37
    v_mfma_f32_16x16x32_bf16 v[96:99], v[16:19], v[160:163], 0
    v_cvt_pk_bf16_f32 v37, v38, v39
    v_mfma_f32_16x16x32_bf16 v[100:103], v[16:19], v[176:179], 0
    ds_write_b64 v64, v[36:37] offset:128
    v_mfma_f32_16x16x32_bf16 v[96:99], v[20:23], v[164:167], v[96:99]
    v_cvt_pk_bf16_f32 v88, v88, v89
    v_cvt_pk_bf16_f32 v40, v40, v41
    v_mfma_f32_16x16x32_bf16 v[100:103], v[20:23], v[180:183], v[100:103]
    v_cvt_pk_bf16_f32 v89, v90, v91
    v_cvt_pk_bf16_f32 v41, v42, v43
    v_mfma_f32_16x16x32_bf16 v[96:99], v[24:27], v[168:171], v[96:99]
    ds_write_b64 v64, v[88:89] offset:32768
    ds_write_b64 v64, v[40:41] offset:256
    v_mfma_f32_16x16x32_bf16 v[100:103], v[24:27], v[184:187], v[100:103]
    v_cvt_pk_bf16_f32 v92, v92, v93
    v_cvt_pk_bf16_f32 v44, v44, v45
    v_mfma_f32_16x16x32_bf16 v[96:99], v[28:31], v[172:175], v[96:99]
    v_cvt_pk_bf16_f32 v93, v94, v95
    v_cvt_pk_bf16_f32 v45, v46, v47
    v_mfma_f32_16x16x32_bf16 v[100:103], v[28:31], v[188:191], v[100:103]
    ds_write_b64 v64, v[92:93] offset:32896
    ds_write_b64 v64, v[44:45] offset:384
    v_mfma_f32_16x16x32_bf16 v[104:107], v[16:19], v[192:195], 0
    v_cvt_pk_bf16_f32 v48, v48, v49
    v_mfma_f32_16x16x32_bf16 v[108:111], v[16:19], v[208:211], 0
    v_cvt_pk_bf16_f32 v49, v50, v51
    v_mfma_f32_16x16x32_bf16 v[104:107], v[20:23], v[196:199], v[104:107]
    v_cvt_pk_bf16_f32 v96, v96, v97
    ds_write_b64 v64, v[48:49] offset:512
    v_mfma_f32_16x16x32_bf16 v[108:111], v[20:23], v[212:215], v[108:111]
    v_cvt_pk_bf16_f32 v97, v98, v99
    v_cvt_pk_bf16_f32 v52, v52, v53
    v_mfma_f32_16x16x32_bf16 v[104:107], v[24:27], v[200:203], v[104:107]
    ds_write_b64 v64, v[96:97] offset:33024
    v_cvt_pk_bf16_f32 v53, v54, v55
    v_mfma_f32_16x16x32_bf16 v[108:111], v[24:27], v[216:219], v[108:111]
    v_cvt_pk_bf16_f32 v100, v100, v101
    ds_write_b64 v64, v[52:53] offset:640
    v_mfma_f32_16x16x32_bf16 v[104:107], v[28:31], v[204:207], v[104:107]
    v_cvt_pk_bf16_f32 v101, v102, v103
    v_cvt_pk_bf16_f32 v56, v56, v57
    v_mfma_f32_16x16x32_bf16 v[108:111], v[28:31], v[220:223], v[108:111]
    ds_write_b64 v64, v[100:101] offset:33152
    v_cvt_pk_bf16_f32 v57, v58, v59
    v_mfma_f32_16x16x32_bf16 v[88:91], v[16:19], v[224:227], 0
    ds_write_b64 v64, v[56:57] offset:768
    v_mfma_f32_16x16x32_bf16 v[92:95], v[16:19], v[240:243], 0
    v_cvt_pk_bf16_f32 v60, v60, v61
    v_mfma_f32_16x16x32_bf16 v[88:91], v[20:23], v[228:231], v[88:91]
    v_cvt_pk_bf16_f32 v104, v104, v105
    v_cvt_pk_bf16_f32 v61, v62, v63
    v_mfma_f32_16x16x32_bf16 v[92:95], v[20:23], v[244:247], v[92:95]
    v_cvt_pk_bf16_f32 v105, v106, v107
    ds_write_b64 v64, v[60:61] offset:896
    v_mfma_f32_16x16x32_bf16 v[88:91], v[24:27], v[232:235], v[88:91]
    ds_write_b64 v64, v[104:105] offset:33280
    v_mfma_f32_16x16x32_bf16 v[92:95], v[24:27], v[248:251], v[92:95]
    v_cvt_pk_bf16_f32 v108, v108, v109
    v_mfma_f32_16x16x32_bf16 v[88:91], v[28:31], v[236:239], v[88:91]
    v_cvt_pk_bf16_f32 v109, v110, v111
    v_mfma_f32_16x16x32_bf16 v[92:95], v[28:31], v[252:255], v[92:95]
    ds_write_b64 v64, v[108:109] offset:33408
    v_add_u32 v64, 0x8000, v64
    s_waitcnt vmcnt(0)
    v_mfma_f32_16x16x32_bf16 v[96:99], v[0:3], v[128:131], 0
    v_mfma_f32_16x16x32_bf16 v[100:103], v[0:3], v[144:147], 0
    v_mfma_f32_16x16x32_bf16 v[96:99], v[4:7], v[132:135], v[96:99]
    v_cvt_pk_bf16_f32 v88, v88, v89
    v_mfma_f32_16x16x32_bf16 v[100:103], v[4:7], v[148:151], v[100:103]
    v_cvt_pk_bf16_f32 v89, v90, v91
    v_mfma_f32_16x16x32_bf16 v[96:99], v[8:11], v[136:139], v[96:99]
    ds_write_b64 v64, v[88:89] offset:768
    v_mov_b32 v16, s24
    v_mov_b32 v40, s24
    v_mfma_f32_16x16x32_bf16 v[100:103], v[8:11], v[152:155], v[100:103]
    v_cvt_pk_bf16_f32 v92, v92, v93
    v_mov_b32 v17, s25
    v_mov_b32 v41, s25
    v_mfma_f32_16x16x32_bf16 v[96:99], v[12:15], v[140:143], v[96:99]
    v_cvt_pk_bf16_f32 v93, v94, v95
    v_mov_b32 v18, s26
    v_mov_b32 v42, s26
    v_mfma_f32_16x16x32_bf16 v[100:103], v[12:15], v[156:159], v[100:103]
    ds_write_b64 v64, v[92:93] offset:896
    v_mov_b32 v19, s27
    v_mov_b32 v43, s27
    v_mfma_f32_16x16x32_bf16 v[104:107], v[0:3], v[160:163], 0
    v_mov_b32 v20, s24
    v_mov_b32 v44, s24
    v_mfma_f32_16x16x32_bf16 v[108:111], v[0:3], v[176:179], 0
    v_mov_b32 v21, s25
    v_mov_b32 v45, s25
    v_mfma_f32_16x16x32_bf16 v[104:107], v[4:7], v[164:167], v[104:107]
    v_cvt_pk_bf16_f32 v96, v96, v97
    v_mov_b32 v22, s26
    v_mov_b32 v46, s26
    v_mfma_f32_16x16x32_bf16 v[108:111], v[4:7], v[180:183], v[108:111]
    v_cvt_pk_bf16_f32 v97, v98, v99
    v_mov_b32 v23, s27
    v_mov_b32 v47, s27
    v_mfma_f32_16x16x32_bf16 v[104:107], v[8:11], v[168:171], v[104:107]
    ds_write_b64 v64, v[96:97] offset:32768
    v_mov_b32 v24, s24
    v_mov_b32 v48, s24
    v_mfma_f32_16x16x32_bf16 v[108:111], v[8:11], v[184:187], v[108:111]
    v_cvt_pk_bf16_f32 v100, v100, v101
    v_mov_b32 v25, s25
    v_mov_b32 v49, s25
    v_mfma_f32_16x16x32_bf16 v[104:107], v[12:15], v[172:175], v[104:107]
    v_cvt_pk_bf16_f32 v101, v102, v103
    v_mov_b32 v26, s26
    v_mov_b32 v50, s26
    v_mfma_f32_16x16x32_bf16 v[108:111], v[12:15], v[188:191], v[108:111]
    ds_write_b64 v64, v[100:101] offset:32896
    v_mov_b32 v27, s27
    v_mov_b32 v51, s27
    v_mfma_f32_16x16x32_bf16 v[88:91], v[0:3], v[192:195], 0
    v_mov_b32 v28, s24
    v_mov_b32 v52, s24
    v_mfma_f32_16x16x32_bf16 v[92:95], v[0:3], v[208:211], 0
    v_mov_b32 v29, s25
    v_mov_b32 v53, s25
    v_mfma_f32_16x16x32_bf16 v[88:91], v[4:7], v[196:199], v[88:91]
    v_cvt_pk_bf16_f32 v104, v104, v105
    v_mov_b32 v30, s26
    v_mov_b32 v54, s26
    v_mfma_f32_16x16x32_bf16 v[92:95], v[4:7], v[212:215], v[92:95]
    v_cvt_pk_bf16_f32 v105, v106, v107
    v_mov_b32 v31, s27
    v_mov_b32 v55, s27
    v_mfma_f32_16x16x32_bf16 v[88:91], v[8:11], v[200:203], v[88:91]
    ds_write_b64 v64, v[104:105] offset:33024
    v_mov_b32 v32, s24
    v_mov_b32 v56, s24
    v_mfma_f32_16x16x32_bf16 v[92:95], v[8:11], v[216:219], v[92:95]
    v_cvt_pk_bf16_f32 v108, v108, v109
    v_mov_b32 v33, s25
    v_mov_b32 v57, s25
    v_mfma_f32_16x16x32_bf16 v[88:91], v[12:15], v[204:207], v[88:91]
    v_cvt_pk_bf16_f32 v109, v110, v111
    v_mov_b32 v34, s26
    v_mov_b32 v58, s26
    v_mfma_f32_16x16x32_bf16 v[92:95], v[12:15], v[220:223], v[92:95]
    ds_write_b64 v64, v[108:109] offset:33152
    v_mov_b32 v35, s27
    v_mov_b32 v59, s27
    v_mfma_f32_16x16x32_bf16 v[96:99], v[0:3], v[224:227], 0
    v_mov_b32 v36, s24
    v_mov_b32 v60, s24
    v_mfma_f32_16x16x32_bf16 v[100:103], v[0:3], v[240:243], 0
    v_mov_b32 v37, s25
    v_mov_b32 v61, s25
    v_mfma_f32_16x16x32_bf16 v[96:99], v[4:7], v[228:231], v[96:99]
    v_cvt_pk_bf16_f32 v88, v88, v89
    v_mov_b32 v38, s26
    v_mov_b32 v62, s26
    v_mfma_f32_16x16x32_bf16 v[100:103], v[4:7], v[244:247], v[100:103]
    v_cvt_pk_bf16_f32 v89, v90, v91
    v_mov_b32 v39, s27
    v_mov_b32 v63, s27
    v_mfma_f32_16x16x32_bf16 v[96:99], v[8:11], v[232:235], v[96:99]
    ds_write_b64 v64, v[88:89] offset:33280
    s_nop 0
    v_mfma_f32_16x16x32_bf16 v[100:103], v[8:11], v[248:251], v[100:103]
    v_cvt_pk_bf16_f32 v92, v92, v93
    s_nop 0
    v_mfma_f32_16x16x32_bf16 v[96:99], v[12:15], v[236:239], v[96:99]
    v_cvt_pk_bf16_f32 v93, v94, v95
    s_nop 0
    v_mfma_f32_16x16x32_bf16 v[100:103], v[12:15], v[252:255], v[100:103]
    ds_write_b64 v64, v[92:93] offset:33408
    s_nop 0
    v_mov_b32 v0, s24
    v_mov_b32 v1, s25
    v_mov_b32 v2, s26
    v_mov_b32 v3, s27
    v_mov_b32 v4, s24
    v_mov_b32 v5, s25
    v_mov_b32 v6, s26
    v_mov_b32 v7, s27
    v_mov_b32 v8, s24
    v_mov_b32 v9, s25
    v_mov_b32 v10, s26
    v_mov_b32 v11, s27
    v_mov_b32 v12, s24
    v_mov_b32 v13, s25
    v_mov_b32 v14, s26
    v_mov_b32 v15, s27
    s_nop 7
    v_cvt_pk_bf16_f32 v96, v96, v97
    v_cvt_pk_bf16_f32 v97, v98, v99
    ds_write_b64 v64, v[96:97] offset:33536
    v_cvt_pk_bf16_f32 v100, v100, v101
    v_cvt_pk_bf16_f32 v101, v102, v103
    ds_write_b64 v64, v[100:101] offset:33664

    s_cmp_lg_u32 s3, 7
    s_cbranch_scc1 k1_kernel_k2j
k1_kernel_k2w:
    s_bfe_u32 s35, s64, 0x1001e
    v_mov_b32 v65, 0
    v_mov_b32 v64, s35
    ds_write_b32 v65, v64 offset:8184
    s_branch k1_kernel_k2j

k1_kernel_k2m:
    buffer_load_dwordx4 v[0:3], v71, s[12:15], s21 offen offset:0
    buffer_load_dwordx4 v[4:7], v71, s[12:15], s21 offen offset:1024
    buffer_load_dwordx4 v[8:11], v71, s[12:15], s19 offen offset:0
    buffer_load_dwordx4 v[12:15], v71, s[12:15], s19 offen offset:1024
    s_add_u32 s21, s21, 4096
    s_add_u32 s19, s19, 4096
    buffer_load_dwordx4 v[16:19], v71, s[12:15], s21 offen offset:0
    buffer_load_dwordx4 v[20:23], v71, s[12:15], s21 offen offset:1024
    buffer_load_dwordx4 v[24:27], v71, s[12:15], s19 offen offset:0
    buffer_load_dwordx4 v[28:31], v71, s[12:15], s19 offen offset:1024
    s_add_u32 s21, s21, 4096
    s_add_u32 s19, s19, 4096
    s_mov_b32 s44, s21
    s_mov_b32 s45, s19
    s_add_u32 s21, s21, 4096
    s_add_u32 s19, s19, 4096
    buffer_load_dwordx4 v[72:75], v71, s[12:15], s21 offen offset:0
    buffer_load_dwordx4 v[76:79], v71, s[12:15], s21 offen offset:1024
    buffer_load_dwordx4 v[80:83], v71, s[12:15], s19 offen offset:0
    buffer_load_dwordx4 v[84:87], v71, s[12:15], s19 offen offset:1024
    s_add_u32 s21, s21, 4096
    s_add_u32 s19, s19, 4096
    buffer_load_dwordx2 v[116:117], v71, s[12:15], s20 offen offset:0 sc1
    buffer_load_dwordx2 v[118:119], v71, s[12:15], s20 offen offset:1024 sc1
    buffer_load_dwordx2 v[120:121], v71, s[12:15], s20 offen offset:2048 sc1
    buffer_load_dwordx2 v[122:123], v71, s[12:15], s20 offen offset:3072 sc1
    s_add_u32 s20, s20, 4096
    buffer_load_dwordx2 v[124:125], v71, s[12:15], s20 offen offset:0 sc1
    buffer_load_dwordx2 v[126:127], v71, s[12:15], s20 offen offset:1024 sc1
    buffer_load_dwordx4 v[32:35], v71, s[12:15], s44 offen offset:0
    buffer_load_dwordx4 v[36:39], v71, s[12:15], s44 offen offset:1024
    buffer_load_dwordx4 v[40:43], v71, s[12:15], s45 offen offset:0
    buffer_load_dwordx4 v[44:47], v71, s[12:15], s45 offen offset:1024
    s_mov_b32 exec_lo, 0x00ff00ff
    s_mov_b32 exec_hi, 0x00ff00ff
    buffer_store_dword v112, v113, s[12:15], s74 offen sc1
    s_mov_b64 exec, -1
    s_waitcnt lgkmcnt(0)
    s_barrier
    ds_read_b128 v[136:139], v65 offset:0
    ds_read_b128 v[140:143], v65 offset:1024
    ds_read_b128 v[152:155], v65 offset:2048
    ds_read_b128 v[156:159], v65 offset:3072
    ds_read_b128 v[168:171], v65 offset:4096
    ds_read_b128 v[172:175], v65 offset:5120
    ds_read_b128 v[184:187], v65 offset:6144
    ds_read_b128 v[188:191], v65 offset:7168
    ds_read_b128 v[200:203], v65 offset:8192
    ds_read_b128 v[204:207], v65 offset:9216
    ds_read_b128 v[216:219], v65 offset:10240
    ds_read_b128 v[220:223], v65 offset:11264
    ds_read_b128 v[232:235], v65 offset:12288
    ds_read_b128 v[236:239], v65 offset:13312
    ds_read_b128 v[248:251], v65 offset:14336
    ds_read_b128 v[252:255], v65 offset:15360
    s_waitcnt vmcnt(19)
    v_mfma_f32_16x16x32_bf16 v[48:51], v[0:3], v[128:131], 0
    v_mfma_f32_16x16x32_bf16 v[52:55], v[0:3], v[144:147], 0
    v_mfma_f32_16x16x32_bf16 v[56:59], v[0:3], v[160:163], 0
    v_mfma_f32_16x16x32_bf16 v[60:63], v[0:3], v[176:179], 0
    v_mfma_f32_16x16x32_bf16 v[88:91], v[0:3], v[192:195], 0
    v_mfma_f32_16x16x32_bf16 v[92:95], v[0:3], v[208:211], 0
    v_mfma_f32_16x16x32_bf16 v[96:99], v[0:3], v[224:227], 0
    v_mfma_f32_16x16x32_bf16 v[100:103], v[0:3], v[240:243], 0
    v_mfma_f32_16x16x32_bf16 v[48:51], v[4:7], v[132:135], v[48:51]
    v_mfma_f32_16x16x32_bf16 v[52:55], v[4:7], v[148:151], v[52:55]
    v_mfma_f32_16x16x32_bf16 v[56:59], v[4:7], v[164:167], v[56:59]
    v_mfma_f32_16x16x32_bf16 v[60:63], v[4:7], v[180:183], v[60:63]
    v_mfma_f32_16x16x32_bf16 v[88:91], v[4:7], v[196:199], v[88:91]
    v_mfma_f32_16x16x32_bf16 v[92:95], v[4:7], v[212:215], v[92:95]
    v_mfma_f32_16x16x32_bf16 v[96:99], v[4:7], v[228:231], v[96:99]
    v_mfma_f32_16x16x32_bf16 v[100:103], v[4:7], v[244:247], v[100:103]

    s_lshl_b32 s24, s36, 16
    s_and_b32 s25, s36, 0xffff0000
    s_lshl_b32 s26, s37, 16
    s_and_b32 s27, s37, 0xffff0000

    s_waitcnt lgkmcnt(12)
    v_mfma_f32_16x16x32_bf16 v[48:51], v[8:11], v[136:139], v[48:51]
    v_mfma_f32_16x16x32_bf16 v[52:55], v[8:11], v[152:155], v[52:55]
    v_mfma_f32_16x16x32_bf16 v[48:51], v[12:15], v[140:143], v[48:51]
    v_mfma_f32_16x16x32_bf16 v[52:55], v[12:15], v[156:159], v[52:55]
    s_waitcnt lgkmcnt(8)
    v_mfma_f32_16x16x32_bf16 v[56:59], v[8:11], v[168:171], v[56:59]
    v_mfma_f32_16x16x32_bf16 v[60:63], v[8:11], v[184:187], v[60:63]
    v_mfma_f32_16x16x32_bf16 v[56:59], v[12:15], v[172:175], v[56:59]
    v_mfma_f32_16x16x32_bf16 v[60:63], v[12:15], v[188:191], v[60:63]
    s_waitcnt lgkmcnt(4)
    v_mfma_f32_16x16x32_bf16 v[88:91], v[8:11], v[200:203], v[88:91]
    v_mfma_f32_16x16x32_bf16 v[92:95], v[8:11], v[216:219], v[92:95]
    v_mfma_f32_16x16x32_bf16 v[88:91], v[12:15], v[204:207], v[88:91]
    v_mfma_f32_16x16x32_bf16 v[92:95], v[12:15], v[220:223], v[92:95]
    v_cvt_pk_bf16_f32 v48, v48, v49
    v_cvt_pk_bf16_f32 v49, v50, v51
    ds_write_b64 v64, v[48:49] offset:0
    v_cvt_pk_bf16_f32 v52, v52, v53
    v_cvt_pk_bf16_f32 v53, v54, v55
    ds_write_b64 v64, v[52:53] offset:128
    s_waitcnt lgkmcnt(2)
    v_mfma_f32_16x16x32_bf16 v[96:99], v[8:11], v[232:235], v[96:99]
    v_mfma_f32_16x16x32_bf16 v[100:103], v[8:11], v[248:251], v[100:103]
    v_mfma_f32_16x16x32_bf16 v[96:99], v[12:15], v[236:239], v[96:99]
    v_mfma_f32_16x16x32_bf16 v[100:103], v[12:15], v[252:255], v[100:103]
    v_cvt_pk_bf16_f32 v56, v56, v57
    v_cvt_pk_bf16_f32 v57, v58, v59
    ds_write_b64 v64, v[56:57] offset:256
    v_cvt_pk_bf16_f32 v60, v60, v61
    v_cvt_pk_bf16_f32 v61, v62, v63
    ds_write_b64 v64, v[60:61] offset:384
    s_nop 3
    v_cvt_pk_bf16_f32 v88, v88, v89
    v_cvt_pk_bf16_f32 v89, v90, v91
    ds_write_b64 v64, v[88:89] offset:512
    v_cvt_pk_bf16_f32 v92, v92, v93
    v_cvt_pk_bf16_f32 v93, v94, v95
    ds_write_b64 v64, v[92:93] offset:640
    s_nop 3
    v_cvt_pk_bf16_f32 v96, v96, v97
    v_cvt_pk_bf16_f32 v97, v98, v99
    ds_write_b64 v64, v[96:97] offset:768
    v_cvt_pk_bf16_f32 v100, v100, v101
    v_cvt_pk_bf16_f32 v101, v102, v103
    ds_write_b64 v64, v[100:101] offset:896
    v_add_u32 v64, 0x8000, v64
    s_waitcnt vmcnt(15)
    v_mfma_f32_16x16x32_bf16 v[104:107], v[16:19], v[128:131], 0
    v_mfma_f32_16x16x32_bf16 v[108:111], v[16:19], v[144:147], 0
    v_mfma_f32_16x16x32_bf16 v[104:107], v[20:23], v[132:135], v[104:107]
    v_mfma_f32_16x16x32_bf16 v[108:111], v[20:23], v[148:151], v[108:111]
    v_mfma_f32_16x16x32_bf16 v[104:107], v[24:27], v[136:139], v[104:107]
    v_mov_b32 v48, s24
    v_mfma_f32_16x16x32_bf16 v[108:111], v[24:27], v[152:155], v[108:111]
    v_mov_b32 v49, s25
    v_mfma_f32_16x16x32_bf16 v[104:107], v[28:31], v[140:143], v[104:107]
    v_mov_b32 v50, s26
    v_mfma_f32_16x16x32_bf16 v[108:111], v[28:31], v[156:159], v[108:111]
    v_mov_b32 v51, s27
    v_mfma_f32_16x16x32_bf16 v[88:91], v[16:19], v[160:163], 0
    v_mov_b32 v52, s24
    v_mfma_f32_16x16x32_bf16 v[92:95], v[16:19], v[176:179], 0
    v_mov_b32 v53, s25
    v_mfma_f32_16x16x32_bf16 v[88:91], v[20:23], v[164:167], v[88:91]
    v_cvt_pk_bf16_f32 v104, v104, v105
    v_mov_b32 v54, s26
    v_mfma_f32_16x16x32_bf16 v[92:95], v[20:23], v[180:183], v[92:95]
    v_cvt_pk_bf16_f32 v105, v106, v107
    v_mov_b32 v55, s27
    v_mfma_f32_16x16x32_bf16 v[88:91], v[24:27], v[168:171], v[88:91]
    ds_write_b64 v64, v[104:105] offset:0
    v_mov_b32 v56, s24
    v_mfma_f32_16x16x32_bf16 v[92:95], v[24:27], v[184:187], v[92:95]
    v_cvt_pk_bf16_f32 v108, v108, v109
    v_mov_b32 v57, s25
    v_mfma_f32_16x16x32_bf16 v[88:91], v[28:31], v[172:175], v[88:91]
    v_cvt_pk_bf16_f32 v109, v110, v111
    v_mov_b32 v58, s26
    v_mfma_f32_16x16x32_bf16 v[92:95], v[28:31], v[188:191], v[92:95]
    ds_write_b64 v64, v[108:109] offset:128
    v_mov_b32 v59, s27
    v_mfma_f32_16x16x32_bf16 v[96:99], v[16:19], v[192:195], 0
    v_mov_b32 v60, s24
    v_mfma_f32_16x16x32_bf16 v[100:103], v[16:19], v[208:211], 0
    v_mov_b32 v61, s25
    v_mfma_f32_16x16x32_bf16 v[96:99], v[20:23], v[196:199], v[96:99]
    v_cvt_pk_bf16_f32 v88, v88, v89
    v_mov_b32 v62, s26
    v_mfma_f32_16x16x32_bf16 v[100:103], v[20:23], v[212:215], v[100:103]
    v_cvt_pk_bf16_f32 v89, v90, v91
    v_mov_b32 v63, s27
    v_mfma_f32_16x16x32_bf16 v[96:99], v[24:27], v[200:203], v[96:99]
    ds_write_b64 v64, v[88:89] offset:256
    v_mov_b32 v0, s24
    v_mfma_f32_16x16x32_bf16 v[100:103], v[24:27], v[216:219], v[100:103]
    v_cvt_pk_bf16_f32 v92, v92, v93
    v_mov_b32 v1, s25
    v_mfma_f32_16x16x32_bf16 v[96:99], v[28:31], v[204:207], v[96:99]
    v_cvt_pk_bf16_f32 v93, v94, v95
    v_mov_b32 v2, s26
    v_mfma_f32_16x16x32_bf16 v[100:103], v[28:31], v[220:223], v[100:103]
    ds_write_b64 v64, v[92:93] offset:384
    v_mov_b32 v3, s27
    v_mfma_f32_16x16x32_bf16 v[104:107], v[16:19], v[224:227], 0
    v_mov_b32 v4, s24
    v_mfma_f32_16x16x32_bf16 v[108:111], v[16:19], v[240:243], 0
    v_mov_b32 v5, s25
    v_mfma_f32_16x16x32_bf16 v[104:107], v[20:23], v[228:231], v[104:107]
    v_cvt_pk_bf16_f32 v96, v96, v97
    v_mov_b32 v6, s26
    v_mfma_f32_16x16x32_bf16 v[108:111], v[20:23], v[244:247], v[108:111]
    v_cvt_pk_bf16_f32 v97, v98, v99
    v_mov_b32 v7, s27
    v_mfma_f32_16x16x32_bf16 v[104:107], v[24:27], v[232:235], v[104:107]
    ds_write_b64 v64, v[96:97] offset:512
    v_mov_b32 v8, s24
    v_mfma_f32_16x16x32_bf16 v[108:111], v[24:27], v[248:251], v[108:111]
    v_cvt_pk_bf16_f32 v100, v100, v101
    v_mov_b32 v9, s25
    v_mfma_f32_16x16x32_bf16 v[104:107], v[28:31], v[236:239], v[104:107]
    v_cvt_pk_bf16_f32 v101, v102, v103
    v_mov_b32 v10, s26
    v_mfma_f32_16x16x32_bf16 v[108:111], v[28:31], v[252:255], v[108:111]
    ds_write_b64 v64, v[100:101] offset:640
    v_mov_b32 v11, s27
    s_waitcnt vmcnt(1)
    v_mfma_f32_16x16x32_bf16 v[88:91], v[32:35], v[128:131], 0
    v_mfma_f32_16x16x32_bf16 v[92:95], v[32:35], v[144:147], 0
    v_mfma_f32_16x16x32_bf16 v[88:91], v[36:39], v[132:135], v[88:91]
    v_cvt_pk_bf16_f32 v104, v104, v105
    v_mfma_f32_16x16x32_bf16 v[92:95], v[36:39], v[148:151], v[92:95]
    v_cvt_pk_bf16_f32 v105, v106, v107
    v_mfma_f32_16x16x32_bf16 v[88:91], v[40:43], v[136:139], v[88:91]
    ds_write_b64 v64, v[104:105] offset:768
    v_mov_b32 v12, s24
    v_mfma_f32_16x16x32_bf16 v[92:95], v[40:43], v[152:155], v[92:95]
    v_cvt_pk_bf16_f32 v108, v108, v109
    v_mov_b32 v13, s25
    v_mfma_f32_16x16x32_bf16 v[88:91], v[44:47], v[140:143], v[88:91]
    v_cvt_pk_bf16_f32 v109, v110, v111
    v_mov_b32 v14, s26
    v_mfma_f32_16x16x32_bf16 v[92:95], v[44:47], v[156:159], v[92:95]
    ds_write_b64 v64, v[108:109] offset:896
    v_mov_b32 v15, s27
    v_mfma_f32_16x16x32_bf16 v[96:99], v[32:35], v[160:163], 0
    v_mov_b32 v16, s24
    v_mfma_f32_16x16x32_bf16 v[100:103], v[32:35], v[176:179], 0
    v_mov_b32 v17, s25
    v_mfma_f32_16x16x32_bf16 v[96:99], v[36:39], v[164:167], v[96:99]
    v_cvt_pk_bf16_f32 v88, v88, v89
    v_mov_b32 v18, s26
    v_mfma_f32_16x16x32_bf16 v[100:103], v[36:39], v[180:183], v[100:103]
    v_cvt_pk_bf16_f32 v89, v90, v91
    v_mov_b32 v19, s27
    v_mfma_f32_16x16x32_bf16 v[96:99], v[40:43], v[168:171], v[96:99]
    ds_write_b64 v64, v[88:89] offset:32768
    v_mov_b32 v20, s24
    v_mfma_f32_16x16x32_bf16 v[100:103], v[40:43], v[184:187], v[100:103]
    v_cvt_pk_bf16_f32 v92, v92, v93
    v_mov_b32 v21, s25
    v_mfma_f32_16x16x32_bf16 v[96:99], v[44:47], v[172:175], v[96:99]
    v_cvt_pk_bf16_f32 v93, v94, v95
    v_mov_b32 v22, s26
    v_mfma_f32_16x16x32_bf16 v[100:103], v[44:47], v[188:191], v[100:103]
    ds_write_b64 v64, v[92:93] offset:32896
    v_mov_b32 v23, s27
    v_mfma_f32_16x16x32_bf16 v[104:107], v[32:35], v[192:195], 0
    v_mov_b32 v24, s24
    v_mfma_f32_16x16x32_bf16 v[108:111], v[32:35], v[208:211], 0
    v_mov_b32 v25, s25
    v_mfma_f32_16x16x32_bf16 v[104:107], v[36:39], v[196:199], v[104:107]
    v_cvt_pk_bf16_f32 v96, v96, v97
    v_mov_b32 v26, s26
    v_mfma_f32_16x16x32_bf16 v[108:111], v[36:39], v[212:215], v[108:111]
    v_cvt_pk_bf16_f32 v97, v98, v99
    v_mov_b32 v27, s27
    v_mfma_f32_16x16x32_bf16 v[104:107], v[40:43], v[200:203], v[104:107]
    ds_write_b64 v64, v[96:97] offset:33024
    v_mov_b32 v28, s24
    v_mfma_f32_16x16x32_bf16 v[108:111], v[40:43], v[216:219], v[108:111]
    v_cvt_pk_bf16_f32 v100, v100, v101
    v_mov_b32 v29, s25
    v_mfma_f32_16x16x32_bf16 v[104:107], v[44:47], v[204:207], v[104:107]
    v_cvt_pk_bf16_f32 v101, v102, v103
    v_mov_b32 v30, s26
    v_mfma_f32_16x16x32_bf16 v[108:111], v[44:47], v[220:223], v[108:111]
    ds_write_b64 v64, v[100:101] offset:33152
    v_mov_b32 v31, s27
    v_mfma_f32_16x16x32_bf16 v[88:91], v[32:35], v[224:227], 0
    s_nop 0
    v_mfma_f32_16x16x32_bf16 v[92:95], v[32:35], v[240:243], 0
    s_nop 0
    v_mfma_f32_16x16x32_bf16 v[88:91], v[36:39], v[228:231], v[88:91]
    v_cvt_pk_bf16_f32 v104, v104, v105
    s_nop 0
    v_mfma_f32_16x16x32_bf16 v[92:95], v[36:39], v[244:247], v[92:95]
    v_cvt_pk_bf16_f32 v105, v106, v107
    s_nop 0
    v_mfma_f32_16x16x32_bf16 v[88:91], v[40:43], v[232:235], v[88:91]
    ds_write_b64 v64, v[104:105] offset:33280
    s_nop 0
    v_mfma_f32_16x16x32_bf16 v[92:95], v[40:43], v[248:251], v[92:95]
    v_cvt_pk_bf16_f32 v108, v108, v109
    s_nop 0
    v_mfma_f32_16x16x32_bf16 v[88:91], v[44:47], v[236:239], v[88:91]
    v_cvt_pk_bf16_f32 v109, v110, v111
    s_nop 0
    v_mfma_f32_16x16x32_bf16 v[92:95], v[44:47], v[252:255], v[92:95]
    ds_write_b64 v64, v[108:109] offset:33408
    s_nop 0
    v_mov_b32 v32, s24
    v_mov_b32 v33, s25
    v_mov_b32 v34, s26
    v_mov_b32 v35, s27
    v_mov_b32 v36, s24
    v_mov_b32 v37, s25
    v_mov_b32 v38, s26
    v_mov_b32 v39, s27
    v_mov_b32 v40, s24
    v_mov_b32 v41, s25
    v_mov_b32 v42, s26
    v_mov_b32 v43, s27
    v_mov_b32 v44, s24
    v_mov_b32 v45, s25
    v_mov_b32 v46, s26
    v_mov_b32 v47, s27
    s_nop 7
    v_cvt_pk_bf16_f32 v88, v88, v89
    v_cvt_pk_bf16_f32 v89, v90, v91
    ds_write_b64 v64, v[88:89] offset:33536
    v_cvt_pk_bf16_f32 v92, v92, v93
    v_cvt_pk_bf16_f32 v93, v94, v95
    ds_write_b64 v64, v[92:93] offset:33664
k1_kernel_k2j:

    v_mov_b32 v65, 0
    s_waitcnt lgkmcnt(0)
    s_barrier
    ds_read_b32 v65, v65 offset:8184

    s_setprio 3
    v_lshlrev_b32_sdwa v88, 3, v116 dst_sel:DWORD dst_unused:UNUSED_PAD src0_sel:DWORD src1_sel:WORD_0
    v_lshlrev_b32_sdwa v90, 3, v116 dst_sel:DWORD dst_unused:UNUSED_PAD src0_sel:DWORD src1_sel:WORD_1
    ds_read_b64 v[88:89], v88
    ds_read_b64 v[90:91], v90
    v_lshlrev_b32_sdwa v92, 3, v117 dst_sel:DWORD dst_unused:UNUSED_PAD src0_sel:DWORD src1_sel:WORD_0
    v_lshlrev_b32_sdwa v94, 3, v117 dst_sel:DWORD dst_unused:UNUSED_PAD src0_sel:DWORD src1_sel:WORD_1
    ds_read_b64 v[92:93], v92
    ds_read_b64 v[94:95], v94
    v_lshlrev_b32_sdwa v96, 3, v118 dst_sel:DWORD dst_unused:UNUSED_PAD src0_sel:DWORD src1_sel:WORD_0
    v_lshlrev_b32_sdwa v98, 3, v118 dst_sel:DWORD dst_unused:UNUSED_PAD src0_sel:DWORD src1_sel:WORD_1
    ds_read_b64 v[96:97], v96
    ds_read_b64 v[98:99], v98
    v_lshlrev_b32_sdwa v100, 3, v119 dst_sel:DWORD dst_unused:UNUSED_PAD src0_sel:DWORD src1_sel:WORD_0
    v_lshlrev_b32_sdwa v102, 3, v119 dst_sel:DWORD dst_unused:UNUSED_PAD src0_sel:DWORD src1_sel:WORD_1
    ds_read_b64 v[100:101], v100
    ds_read_b64 v[102:103], v102
    buffer_load_dwordx2 v[116:117], v71, s[12:15], s20 offen offset:2048 sc1
    buffer_load_dwordx2 v[118:119], v71, s[12:15], s20 offen offset:3072 sc1
    s_waitcnt lgkmcnt(8)
    v_readfirstlane_b32 s44, v65
    s_cmp_lg_u32 s44, 0
    s_cbranch_scc1 k1_kernel_solo1
    v_mfma_f32_16x16x32_bf16 v[112:115], v[72:75], v[128:131], 0
    v_lshlrev_b32_sdwa v104, 3, v120 dst_sel:DWORD dst_unused:UNUSED_PAD src0_sel:DWORD src1_sel:WORD_0
    v_lshlrev_b32_sdwa v106, 3, v120 dst_sel:DWORD dst_unused:UNUSED_PAD src0_sel:DWORD src1_sel:WORD_1
    ds_read_b64 v[104:105], v104
    ds_read_b64 v[106:107], v106
    v_mfma_f32_16x16x32_bf16 v[112:115], v[76:79], v[132:135], v[112:115]
    v_add_u32 v70, 0x20000000, v70
    v_lshlrev_b32_sdwa v108, 3, v121 dst_sel:DWORD dst_unused:UNUSED_PAD src0_sel:DWORD src1_sel:WORD_0
    v_lshlrev_b32_sdwa v110, 3, v121 dst_sel:DWORD dst_unused:UNUSED_PAD src0_sel:DWORD src1_sel:WORD_1
    ds_read_b64 v[108:109], v108
    ds_read_b64 v[110:111], v110
    s_waitcnt lgkmcnt(8)
    v_smfmac_f32_16x16x64_bf16 v[0:3], v[66:69], v[88:95], v70
    v_mfma_f32_16x16x32_bf16 v[112:115], v[80:83], v[136:139], v[112:115]
    v_lshlrev_b32_sdwa v88, 3, v122 dst_sel:DWORD dst_unused:UNUSED_PAD src0_sel:DWORD src1_sel:WORD_0
    v_lshlrev_b32_sdwa v90, 3, v122 dst_sel:DWORD dst_unused:UNUSED_PAD src0_sel:DWORD src1_sel:WORD_1
    ds_read_b64 v[88:89], v88
    ds_read_b64 v[90:91], v90
    v_mfma_f32_16x16x32_bf16 v[112:115], v[84:87], v[140:143], v[112:115]
    v_lshlrev_b32_sdwa v92, 3, v123 dst_sel:DWORD dst_unused:UNUSED_PAD src0_sel:DWORD src1_sel:WORD_0
    v_lshlrev_b32_sdwa v94, 3, v123 dst_sel:DWORD dst_unused:UNUSED_PAD src0_sel:DWORD src1_sel:WORD_1
    v_cvt_pk_bf16_f32 v0, v0, v1
    v_cvt_pk_bf16_f32 v1, v2, v3
    ds_read_b64 v[92:93], v92
    ds_read_b64 v[94:95], v94
    s_add_u32 s20, s20, 0x1000
    buffer_load_dwordx2 v[120:121], v71, s[12:15], s20 offen offset:0 sc1
    buffer_load_dwordx2 v[122:123], v71, s[12:15], s20 offen offset:1024 sc1
    s_waitcnt lgkmcnt(8)
    v_smfmac_f32_16x16x64_bf16 v[4:7], v[66:69], v[96:103], v70
    v_cvt_pk_bf16_f32 v112, v112, v113
    v_cvt_pk_bf16_f32 v113, v114, v115
    v_lshlrev_b32_sdwa v114, 3, v70 dst_sel:DWORD dst_unused:UNUSED_PAD src0_sel:DWORD src1_sel:WORD_1
    ds_write_b64 v114, v[112:113] offset:32768
    v_lshlrev_b32_sdwa v96, 3, v124 dst_sel:DWORD dst_unused:UNUSED_PAD src0_sel:DWORD src1_sel:WORD_0
    v_lshlrev_b32_sdwa v98, 3, v124 dst_sel:DWORD dst_unused:UNUSED_PAD src0_sel:DWORD src1_sel:WORD_1
    ds_read_b64 v[96:97], v96
    ds_read_b64 v[98:99], v98
    v_lshlrev_b32_sdwa v100, 3, v125 dst_sel:DWORD dst_unused:UNUSED_PAD src0_sel:DWORD src1_sel:WORD_0
    v_lshlrev_b32_sdwa v102, 3, v125 dst_sel:DWORD dst_unused:UNUSED_PAD src0_sel:DWORD src1_sel:WORD_1
    v_cvt_pk_bf16_f32 v2, v4, v5
    v_cvt_pk_bf16_f32 v3, v6, v7
    ds_read_b64 v[100:101], v100
    ds_read_b64 v[102:103], v102
    s_waitcnt lgkmcnt(9)
    v_smfmac_f32_16x16x64_bf16 v[8:11], v[66:69], v[104:111], v70
    v_lshlrev_b32_sdwa v104, 3, v126 dst_sel:DWORD dst_unused:UNUSED_PAD src0_sel:DWORD src1_sel:WORD_0
    v_lshlrev_b32_sdwa v106, 3, v126 dst_sel:DWORD dst_unused:UNUSED_PAD src0_sel:DWORD src1_sel:WORD_1
    ds_read_b64 v[104:105], v104
    ds_read_b64 v[106:107], v106
    v_lshlrev_b32_sdwa v108, 3, v127 dst_sel:DWORD dst_unused:UNUSED_PAD src0_sel:DWORD src1_sel:WORD_0
    v_lshlrev_b32_sdwa v110, 3, v127 dst_sel:DWORD dst_unused:UNUSED_PAD src0_sel:DWORD src1_sel:WORD_1
    s_nop 1
    v_cvt_pk_bf16_f32 v4, v8, v9
    v_cvt_pk_bf16_f32 v5, v10, v11
    ds_read_b64 v[108:109], v108
    ds_read_b64 v[110:111], v110
    buffer_load_dwordx2 v[124:125], v71, s[12:15], s20 offen offset:2048 sc1
    buffer_load_dwordx2 v[126:127], v71, s[12:15], s20 offen offset:3072 sc1
    s_waitcnt lgkmcnt(9)
    v_smfmac_f32_16x16x64_bf16 v[12:15], v[66:69], v[88:95], v70
    s_waitcnt vmcnt(4)
    v_lshlrev_b32_sdwa v88, 3, v116 dst_sel:DWORD dst_unused:UNUSED_PAD src0_sel:DWORD src1_sel:WORD_0
    v_lshlrev_b32_sdwa v90, 3, v116 dst_sel:DWORD dst_unused:UNUSED_PAD src0_sel:DWORD src1_sel:WORD_1
    ds_read_b64 v[88:89], v88
    ds_read_b64 v[90:91], v90
    v_lshlrev_b32_sdwa v92, 3, v117 dst_sel:DWORD dst_unused:UNUSED_PAD src0_sel:DWORD src1_sel:WORD_0
    v_lshlrev_b32_sdwa v94, 3, v117 dst_sel:DWORD dst_unused:UNUSED_PAD src0_sel:DWORD src1_sel:WORD_1
    s_nop 0
    v_cvt_pk_bf16_f32 v6, v12, v13
    v_cvt_pk_bf16_f32 v7, v14, v15
    ds_read_b64 v[92:93], v92
    ds_read_b64 v[94:95], v94
    s_waitcnt lgkmcnt(8)
    v_smfmac_f32_16x16x64_bf16 v[16:19], v[66:69], v[96:103], v70
    v_mfma_f32_16x16x32_bf16 v[112:115], v[72:75], v[144:147], 0
    v_lshlrev_b32_sdwa v96, 3, v118 dst_sel:DWORD dst_unused:UNUSED_PAD src0_sel:DWORD src1_sel:WORD_0
    v_lshlrev_b32_sdwa v98, 3, v118 dst_sel:DWORD dst_unused:UNUSED_PAD src0_sel:DWORD src1_sel:WORD_1
    ds_read_b64 v[96:97], v96
    ds_read_b64 v[98:99], v98
    v_mfma_f32_16x16x32_bf16 v[112:115], v[76:79], v[148:151], v[112:115]
    v_lshlrev_b32_sdwa v100, 3, v119 dst_sel:DWORD dst_unused:UNUSED_PAD src0_sel:DWORD src1_sel:WORD_0
    v_lshlrev_b32_sdwa v102, 3, v119 dst_sel:DWORD dst_unused:UNUSED_PAD src0_sel:DWORD src1_sel:WORD_1
    v_cvt_pk_bf16_f32 v8, v16, v17
    v_cvt_pk_bf16_f32 v9, v18, v19
    ds_read_b64 v[100:101], v100
    ds_read_b64 v[102:103], v102
    s_add_u32 s20, s20, 0x1000
    buffer_load_dwordx2 v[116:117], v71, s[12:15], s20 offen offset:0 sc1
    buffer_load_dwordx2 v[118:119], v71, s[12:15], s20 offen offset:1024 sc1
    s_waitcnt lgkmcnt(8)
    v_smfmac_f32_16x16x64_bf16 v[20:23], v[66:69], v[104:111], v70
    v_mfma_f32_16x16x32_bf16 v[112:115], v[80:83], v[152:155], v[112:115]
    s_waitcnt vmcnt(4)
    v_lshlrev_b32_sdwa v104, 3, v120 dst_sel:DWORD dst_unused:UNUSED_PAD src0_sel:DWORD src1_sel:WORD_0
    v_lshlrev_b32_sdwa v106, 3, v120 dst_sel:DWORD dst_unused:UNUSED_PAD src0_sel:DWORD src1_sel:WORD_1
    ds_read_b64 v[104:105], v104
    ds_read_b64 v[106:107], v106
    v_mfma_f32_16x16x32_bf16 v[112:115], v[84:87], v[156:159], v[112:115]
    v_lshlrev_b32_sdwa v108, 3, v121 dst_sel:DWORD dst_unused:UNUSED_PAD src0_sel:DWORD src1_sel:WORD_0
    v_lshlrev_b32_sdwa v110, 3, v121 dst_sel:DWORD dst_unused:UNUSED_PAD src0_sel:DWORD src1_sel:WORD_1
    v_cvt_pk_bf16_f32 v10, v20, v21
    v_cvt_pk_bf16_f32 v11, v22, v23
    ds_read_b64 v[108:109], v108
    ds_read_b64 v[110:111], v110
    s_waitcnt lgkmcnt(8)
    v_smfmac_f32_16x16x64_bf16 v[24:27], v[66:69], v[88:95], v70
    v_cvt_pk_bf16_f32 v112, v112, v113
    v_cvt_pk_bf16_f32 v113, v114, v115
    v_lshlrev_b32_sdwa v114, 3, v70 dst_sel:DWORD dst_unused:UNUSED_PAD src0_sel:DWORD src1_sel:WORD_1
    ds_write_b64 v114, v[112:113] offset:32896
    v_lshlrev_b32_sdwa v88, 3, v122 dst_sel:DWORD dst_unused:UNUSED_PAD src0_sel:DWORD src1_sel:WORD_0
    v_lshlrev_b32_sdwa v90, 3, v122 dst_sel:DWORD dst_unused:UNUSED_PAD src0_sel:DWORD src1_sel:WORD_1
    ds_read_b64 v[88:89], v88
    ds_read_b64 v[90:91], v90
    v_lshlrev_b32_sdwa v92, 3, v123 dst_sel:DWORD dst_unused:UNUSED_PAD src0_sel:DWORD src1_sel:WORD_0
    v_lshlrev_b32_sdwa v94, 3, v123 dst_sel:DWORD dst_unused:UNUSED_PAD src0_sel:DWORD src1_sel:WORD_1
    v_cvt_pk_bf16_f32 v12, v24, v25
    v_cvt_pk_bf16_f32 v13, v26, v27
    ds_read_b64 v[92:93], v92
    ds_read_b64 v[94:95], v94
    buffer_load_dwordx2 v[120:121], v71, s[12:15], s20 offen offset:2048 sc1
    buffer_load_dwordx2 v[122:123], v71, s[12:15], s20 offen offset:3072 sc1
    s_waitcnt lgkmcnt(9)
    v_smfmac_f32_16x16x64_bf16 v[28:31], v[66:69], v[96:103], v70
    s_waitcnt vmcnt(4)
    v_lshlrev_b32_sdwa v96, 3, v124 dst_sel:DWORD dst_unused:UNUSED_PAD src0_sel:DWORD src1_sel:WORD_0
    v_lshlrev_b32_sdwa v98, 3, v124 dst_sel:DWORD dst_unused:UNUSED_PAD src0_sel:DWORD src1_sel:WORD_1
    ds_read_b64 v[96:97], v96
    ds_read_b64 v[98:99], v98
    v_lshlrev_b32_sdwa v100, 3, v125 dst_sel:DWORD dst_unused:UNUSED_PAD src0_sel:DWORD src1_sel:WORD_0
    v_lshlrev_b32_sdwa v102, 3, v125 dst_sel:DWORD dst_unused:UNUSED_PAD src0_sel:DWORD src1_sel:WORD_1
    s_nop 0
    v_cvt_pk_bf16_f32 v14, v28, v29
    v_cvt_pk_bf16_f32 v15, v30, v31
    ds_read_b64 v[100:101], v100
    ds_read_b64 v[102:103], v102
    s_waitcnt lgkmcnt(9)
    v_smfmac_f32_16x16x64_bf16 v[32:35], v[66:69], v[104:111], v70
    v_lshlrev_b32_sdwa v104, 3, v126 dst_sel:DWORD dst_unused:UNUSED_PAD src0_sel:DWORD src1_sel:WORD_0
    v_lshlrev_b32_sdwa v106, 3, v126 dst_sel:DWORD dst_unused:UNUSED_PAD src0_sel:DWORD src1_sel:WORD_1
    ds_read_b64 v[104:105], v104
    ds_read_b64 v[106:107], v106
    v_lshlrev_b32_sdwa v108, 3, v127 dst_sel:DWORD dst_unused:UNUSED_PAD src0_sel:DWORD src1_sel:WORD_0
    v_lshlrev_b32_sdwa v110, 3, v127 dst_sel:DWORD dst_unused:UNUSED_PAD src0_sel:DWORD src1_sel:WORD_1
    s_nop 1
    v_cvt_pk_bf16_f32 v16, v32, v33
    v_cvt_pk_bf16_f32 v17, v34, v35
    ds_read_b64 v[108:109], v108
    ds_read_b64 v[110:111], v110
    s_add_u32 s20, s20, 0x1d000
    buffer_load_dwordx4 v[124:127], v71, s[12:15], s20 offen offset:0 sc1
    s_waitcnt lgkmcnt(8)
    v_smfmac_f32_16x16x64_bf16 v[36:39], v[66:69], v[88:95], v70
    v_mfma_f32_16x16x32_bf16 v[112:115], v[72:75], v[160:163], 0
    s_waitcnt vmcnt(3)
    v_lshlrev_b32_sdwa v88, 3, v116 dst_sel:DWORD dst_unused:UNUSED_PAD src0_sel:DWORD src1_sel:WORD_0
    v_lshlrev_b32_sdwa v90, 3, v116 dst_sel:DWORD dst_unused:UNUSED_PAD src0_sel:DWORD src1_sel:WORD_1
    ds_read_b64 v[88:89], v88
    ds_read_b64 v[90:91], v90
    v_mfma_f32_16x16x32_bf16 v[112:115], v[76:79], v[164:167], v[112:115]
    v_lshlrev_b32_sdwa v92, 3, v117 dst_sel:DWORD dst_unused:UNUSED_PAD src0_sel:DWORD src1_sel:WORD_0
    v_lshlrev_b32_sdwa v94, 3, v117 dst_sel:DWORD dst_unused:UNUSED_PAD src0_sel:DWORD src1_sel:WORD_1
    v_cvt_pk_bf16_f32 v18, v36, v37
    v_cvt_pk_bf16_f32 v19, v38, v39
    ds_read_b64 v[92:93], v92
    ds_read_b64 v[94:95], v94
    s_waitcnt lgkmcnt(8)
    v_smfmac_f32_16x16x64_bf16 v[40:43], v[66:69], v[96:103], v70
    v_mfma_f32_16x16x32_bf16 v[112:115], v[80:83], v[168:171], v[112:115]
    v_lshlrev_b32_sdwa v96, 3, v118 dst_sel:DWORD dst_unused:UNUSED_PAD src0_sel:DWORD src1_sel:WORD_0
    v_lshlrev_b32_sdwa v98, 3, v118 dst_sel:DWORD dst_unused:UNUSED_PAD src0_sel:DWORD src1_sel:WORD_1
    ds_read_b64 v[96:97], v96
    ds_read_b64 v[98:99], v98
    v_mfma_f32_16x16x32_bf16 v[112:115], v[84:87], v[172:175], v[112:115]
    v_lshlrev_b32_sdwa v100, 3, v119 dst_sel:DWORD dst_unused:UNUSED_PAD src0_sel:DWORD src1_sel:WORD_0
    v_lshlrev_b32_sdwa v102, 3, v119 dst_sel:DWORD dst_unused:UNUSED_PAD src0_sel:DWORD src1_sel:WORD_1
    v_cvt_pk_bf16_f32 v20, v40, v41
    v_cvt_pk_bf16_f32 v21, v42, v43
    ds_read_b64 v[100:101], v100
    ds_read_b64 v[102:103], v102
    buffer_load_dwordx4 v[116:119], v71, s[12:15], s20 offen offset:1024 sc1
    s_waitcnt lgkmcnt(8)
    v_smfmac_f32_16x16x64_bf16 v[44:47], v[66:69], v[104:111], v70
    v_cvt_pk_bf16_f32 v112, v112, v113
    v_cvt_pk_bf16_f32 v113, v114, v115
    v_lshlrev_b32_sdwa v114, 3, v70 dst_sel:DWORD dst_unused:UNUSED_PAD src0_sel:DWORD src1_sel:WORD_1
    ds_write_b64 v114, v[112:113] offset:33024
    s_waitcnt vmcnt(2)
    v_lshlrev_b32_sdwa v104, 3, v120 dst_sel:DWORD dst_unused:UNUSED_PAD src0_sel:DWORD src1_sel:WORD_0
    v_lshlrev_b32_sdwa v106, 3, v120 dst_sel:DWORD dst_unused:UNUSED_PAD src0_sel:DWORD src1_sel:WORD_1
    ds_read_b64 v[104:105], v104
    ds_read_b64 v[106:107], v106
    v_lshlrev_b32_sdwa v108, 3, v121 dst_sel:DWORD dst_unused:UNUSED_PAD src0_sel:DWORD src1_sel:WORD_0
    v_lshlrev_b32_sdwa v110, 3, v121 dst_sel:DWORD dst_unused:UNUSED_PAD src0_sel:DWORD src1_sel:WORD_1
    v_cvt_pk_bf16_f32 v22, v44, v45
    v_cvt_pk_bf16_f32 v23, v46, v47
    ds_read_b64 v[108:109], v108
    ds_read_b64 v[110:111], v110
    s_waitcnt lgkmcnt(9)
    v_smfmac_f32_16x16x64_bf16 v[48:51], v[66:69], v[88:95], v70
    v_lshlrev_b32_sdwa v88, 3, v122 dst_sel:DWORD dst_unused:UNUSED_PAD src0_sel:DWORD src1_sel:WORD_0
    v_lshlrev_b32_sdwa v90, 3, v122 dst_sel:DWORD dst_unused:UNUSED_PAD src0_sel:DWORD src1_sel:WORD_1
    ds_read_b64 v[88:89], v88
    ds_read_b64 v[90:91], v90
    v_lshlrev_b32_sdwa v92, 3, v123 dst_sel:DWORD dst_unused:UNUSED_PAD src0_sel:DWORD src1_sel:WORD_0
    v_lshlrev_b32_sdwa v94, 3, v123 dst_sel:DWORD dst_unused:UNUSED_PAD src0_sel:DWORD src1_sel:WORD_1
    s_nop 1
    v_cvt_pk_bf16_f32 v24, v48, v49
    v_cvt_pk_bf16_f32 v25, v50, v51
    ds_read_b64 v[92:93], v92
    ds_read_b64 v[94:95], v94
    buffer_load_dwordx4 v[120:123], v71, s[12:15], s20 offen offset:2048 sc1
    s_waitcnt lgkmcnt(9)
    v_smfmac_f32_16x16x64_bf16 v[52:55], v[66:69], v[96:103], v70
    s_waitcnt vmcnt(2)
    v_lshlrev_b32_sdwa v96, 3, v124 dst_sel:DWORD dst_unused:UNUSED_PAD src0_sel:DWORD src1_sel:WORD_0
    v_lshlrev_b32_sdwa v98, 3, v124 dst_sel:DWORD dst_unused:UNUSED_PAD src0_sel:DWORD src1_sel:WORD_1
    ds_read_b64 v[96:97], v96
    ds_read_b64 v[98:99], v98
    v_lshlrev_b32_sdwa v100, 3, v125 dst_sel:DWORD dst_unused:UNUSED_PAD src0_sel:DWORD src1_sel:WORD_0
    v_lshlrev_b32_sdwa v102, 3, v125 dst_sel:DWORD dst_unused:UNUSED_PAD src0_sel:DWORD src1_sel:WORD_1
    s_nop 0
    v_cvt_pk_bf16_f32 v26, v52, v53
    v_cvt_pk_bf16_f32 v27, v54, v55
    ds_read_b64 v[100:101], v100
    ds_read_b64 v[102:103], v102
    s_waitcnt lgkmcnt(8)
    v_smfmac_f32_16x16x64_bf16 v[56:59], v[66:69], v[104:111], v70
    v_mfma_f32_16x16x32_bf16 v[112:115], v[72:75], v[176:179], 0
    v_lshlrev_b32_sdwa v104, 3, v126 dst_sel:DWORD dst_unused:UNUSED_PAD src0_sel:DWORD src1_sel:WORD_0
    v_lshlrev_b32_sdwa v106, 3, v126 dst_sel:DWORD dst_unused:UNUSED_PAD src0_sel:DWORD src1_sel:WORD_1
    ds_read_b64 v[104:105], v104
    ds_read_b64 v[106:107], v106
    v_mfma_f32_16x16x32_bf16 v[112:115], v[76:79], v[180:183], v[112:115]
    v_lshlrev_b32_sdwa v108, 3, v127 dst_sel:DWORD dst_unused:UNUSED_PAD src0_sel:DWORD src1_sel:WORD_0
    v_lshlrev_b32_sdwa v110, 3, v127 dst_sel:DWORD dst_unused:UNUSED_PAD src0_sel:DWORD src1_sel:WORD_1
    v_cvt_pk_bf16_f32 v28, v56, v57
    v_cvt_pk_bf16_f32 v29, v58, v59
    ds_read_b64 v[108:109], v108
    ds_read_b64 v[110:111], v110
    buffer_load_dwordx4 v[124:127], v71, s[12:15], s20 offen offset:3072 sc1
    s_waitcnt lgkmcnt(8)
    v_smfmac_f32_16x16x64_bf16 v[60:63], v[66:69], v[88:95], v70
    v_mfma_f32_16x16x32_bf16 v[112:115], v[80:83], v[184:187], v[112:115]
    s_waitcnt vmcnt(2)
    v_lshlrev_b32_sdwa v88, 3, v116 dst_sel:DWORD dst_unused:UNUSED_PAD src0_sel:DWORD src1_sel:WORD_0
    v_lshlrev_b32_sdwa v90, 3, v116 dst_sel:DWORD dst_unused:UNUSED_PAD src0_sel:DWORD src1_sel:WORD_1
    ds_read_b64 v[88:89], v88
    ds_read_b64 v[90:91], v90
    v_mfma_f32_16x16x32_bf16 v[112:115], v[84:87], v[188:191], v[112:115]
    v_lshlrev_b32_sdwa v92, 3, v117 dst_sel:DWORD dst_unused:UNUSED_PAD src0_sel:DWORD src1_sel:WORD_0
    v_lshlrev_b32_sdwa v94, 3, v117 dst_sel:DWORD dst_unused:UNUSED_PAD src0_sel:DWORD src1_sel:WORD_1
    v_cvt_pk_bf16_f32 v30, v60, v61
    v_cvt_pk_bf16_f32 v31, v62, v63
    v_mov_b64 v[62:63], 0
    v_mov_b64 v[64:65], 0
    ds_read_b64 v[92:93], v92
    ds_read_b64 v[94:95], v94
    s_waitcnt lgkmcnt(8)
    v_smfmac_f32_16x16x64_bf16 v[62:65], v[66:69], v[96:103], v70
    v_cvt_pk_bf16_f32 v112, v112, v113
    v_cvt_pk_bf16_f32 v113, v114, v115
    v_lshlrev_b32_sdwa v114, 3, v70 dst_sel:DWORD dst_unused:UNUSED_PAD src0_sel:DWORD src1_sel:WORD_1
    ds_write_b64 v114, v[112:113] offset:33152
    v_lshlrev_b32_sdwa v96, 3, v118 dst_sel:DWORD dst_unused:UNUSED_PAD src0_sel:DWORD src1_sel:WORD_0
    v_lshlrev_b32_sdwa v98, 3, v118 dst_sel:DWORD dst_unused:UNUSED_PAD src0_sel:DWORD src1_sel:WORD_1
    ds_read_b64 v[96:97], v96
    ds_read_b64 v[98:99], v98
    v_lshlrev_b32_sdwa v100, 3, v119 dst_sel:DWORD dst_unused:UNUSED_PAD src0_sel:DWORD src1_sel:WORD_0
    v_lshlrev_b32_sdwa v102, 3, v119 dst_sel:DWORD dst_unused:UNUSED_PAD src0_sel:DWORD src1_sel:WORD_1
    ds_read_b64 v[100:101], v100
    ds_read_b64 v[102:103], v102
    s_add_u32 s20, s20, 0x1000
    buffer_load_dwordx4 v[116:119], v71, s[12:15], s20 offen offset:0 sc1
    s_waitcnt lgkmcnt(9)
    v_smfmac_f32_16x16x64_bf16 v[62:65], v[66:69], v[104:111], v70
    s_waitcnt vmcnt(2)
    v_lshlrev_b32_sdwa v104, 3, v120 dst_sel:DWORD dst_unused:UNUSED_PAD src0_sel:DWORD src1_sel:WORD_0
    v_lshlrev_b32_sdwa v106, 3, v120 dst_sel:DWORD dst_unused:UNUSED_PAD src0_sel:DWORD src1_sel:WORD_1
    ds_read_b64 v[104:105], v104
    ds_read_b64 v[106:107], v106
    v_lshlrev_b32_sdwa v108, 3, v121 dst_sel:DWORD dst_unused:UNUSED_PAD src0_sel:DWORD src1_sel:WORD_0
    v_lshlrev_b32_sdwa v110, 3, v121 dst_sel:DWORD dst_unused:UNUSED_PAD src0_sel:DWORD src1_sel:WORD_1
    s_nop 0
    v_cvt_pk_bf16_f32 v65, v64, v65
    v_cvt_pk_bf16_f32 v64, v62, v63
    v_mov_b64 v[60:61], 0
    v_mov_b64 v[62:63], 0
    ds_read_b64 v[108:109], v108
    ds_read_b64 v[110:111], v110
    s_waitcnt lgkmcnt(9)
    v_smfmac_f32_16x16x64_bf16 v[60:63], v[66:69], v[88:95], v70
    v_lshlrev_b32_sdwa v88, 3, v122 dst_sel:DWORD dst_unused:UNUSED_PAD src0_sel:DWORD src1_sel:WORD_0
    v_lshlrev_b32_sdwa v90, 3, v122 dst_sel:DWORD dst_unused:UNUSED_PAD src0_sel:DWORD src1_sel:WORD_1
    ds_read_b64 v[88:89], v88
    ds_read_b64 v[90:91], v90
    v_lshlrev_b32_sdwa v92, 3, v123 dst_sel:DWORD dst_unused:UNUSED_PAD src0_sel:DWORD src1_sel:WORD_0
    v_lshlrev_b32_sdwa v94, 3, v123 dst_sel:DWORD dst_unused:UNUSED_PAD src0_sel:DWORD src1_sel:WORD_1
    ds_read_b64 v[92:93], v92
    ds_read_b64 v[94:95], v94
    buffer_load_dwordx4 v[120:123], v71, s[12:15], s20 offen offset:1024 sc1
    s_waitcnt lgkmcnt(8)
    v_smfmac_f32_16x16x64_bf16 v[60:63], v[66:69], v[96:103], v70
    v_mfma_f32_16x16x32_bf16 v[112:115], v[72:75], v[192:195], 0
    s_waitcnt vmcnt(2)
    v_lshlrev_b32_sdwa v96, 3, v124 dst_sel:DWORD dst_unused:UNUSED_PAD src0_sel:DWORD src1_sel:WORD_0
    v_lshlrev_b32_sdwa v98, 3, v124 dst_sel:DWORD dst_unused:UNUSED_PAD src0_sel:DWORD src1_sel:WORD_1
    ds_read_b64 v[96:97], v96
    ds_read_b64 v[98:99], v98
    v_mfma_f32_16x16x32_bf16 v[112:115], v[76:79], v[196:199], v[112:115]
    v_lshlrev_b32_sdwa v100, 3, v125 dst_sel:DWORD dst_unused:UNUSED_PAD src0_sel:DWORD src1_sel:WORD_0
    v_lshlrev_b32_sdwa v102, 3, v125 dst_sel:DWORD dst_unused:UNUSED_PAD src0_sel:DWORD src1_sel:WORD_1
    v_cvt_pk_bf16_f32 v63, v62, v63
    v_cvt_pk_bf16_f32 v62, v60, v61
    v_mov_b64 v[58:59], 0
    v_mov_b64 v[60:61], 0
    ds_read_b64 v[100:101], v100
    ds_read_b64 v[102:103], v102
    s_waitcnt lgkmcnt(8)
    v_smfmac_f32_16x16x64_bf16 v[58:61], v[66:69], v[104:111], v70
    v_mfma_f32_16x16x32_bf16 v[112:115], v[80:83], v[200:203], v[112:115]
    v_lshlrev_b32_sdwa v104, 3, v126 dst_sel:DWORD dst_unused:UNUSED_PAD src0_sel:DWORD src1_sel:WORD_0
    v_lshlrev_b32_sdwa v106, 3, v126 dst_sel:DWORD dst_unused:UNUSED_PAD src0_sel:DWORD src1_sel:WORD_1
    ds_read_b64 v[104:105], v104
    ds_read_b64 v[106:107], v106
    v_mfma_f32_16x16x32_bf16 v[112:115], v[84:87], v[204:207], v[112:115]
    v_lshlrev_b32_sdwa v108, 3, v127 dst_sel:DWORD dst_unused:UNUSED_PAD src0_sel:DWORD src1_sel:WORD_0
    v_lshlrev_b32_sdwa v110, 3, v127 dst_sel:DWORD dst_unused:UNUSED_PAD src0_sel:DWORD src1_sel:WORD_1
    ds_read_b64 v[108:109], v108
    ds_read_b64 v[110:111], v110
    buffer_load_dwordx4 v[124:127], v71, s[12:15], s20 offen offset:2048 sc1
    s_waitcnt lgkmcnt(8)
    v_smfmac_f32_16x16x64_bf16 v[58:61], v[66:69], v[88:95], v70
    s_nop 0
    v_cvt_pk_bf16_f32 v112, v112, v113
    v_cvt_pk_bf16_f32 v113, v114, v115
    v_lshlrev_b32_sdwa v114, 3, v70 dst_sel:DWORD dst_unused:UNUSED_PAD src0_sel:DWORD src1_sel:WORD_1
    ds_write_b64 v114, v[112:113] offset:33280
    s_waitcnt vmcnt(2)
    v_lshlrev_b32_sdwa v88, 3, v116 dst_sel:DWORD dst_unused:UNUSED_PAD src0_sel:DWORD src1_sel:WORD_0
    v_lshlrev_b32_sdwa v90, 3, v116 dst_sel:DWORD dst_unused:UNUSED_PAD src0_sel:DWORD src1_sel:WORD_1
    ds_read_b64 v[88:89], v88
    ds_read_b64 v[90:91], v90
    v_lshlrev_b32_sdwa v92, 3, v117 dst_sel:DWORD dst_unused:UNUSED_PAD src0_sel:DWORD src1_sel:WORD_0
    v_lshlrev_b32_sdwa v94, 3, v117 dst_sel:DWORD dst_unused:UNUSED_PAD src0_sel:DWORD src1_sel:WORD_1
    v_cvt_pk_bf16_f32 v61, v60, v61
    v_cvt_pk_bf16_f32 v60, v58, v59
    v_mov_b64 v[56:57], 0
    v_mov_b64 v[58:59], 0
    ds_read_b64 v[92:93], v92
    ds_read_b64 v[94:95], v94
    s_waitcnt lgkmcnt(9)
    v_smfmac_f32_16x16x64_bf16 v[56:59], v[66:69], v[96:103], v70
    v_lshlrev_b32_sdwa v96, 3, v118 dst_sel:DWORD dst_unused:UNUSED_PAD src0_sel:DWORD src1_sel:WORD_0
    v_lshlrev_b32_sdwa v98, 3, v118 dst_sel:DWORD dst_unused:UNUSED_PAD src0_sel:DWORD src1_sel:WORD_1
    ds_read_b64 v[96:97], v96
    ds_read_b64 v[98:99], v98
    v_lshlrev_b32_sdwa v100, 3, v119 dst_sel:DWORD dst_unused:UNUSED_PAD src0_sel:DWORD src1_sel:WORD_0
    v_lshlrev_b32_sdwa v102, 3, v119 dst_sel:DWORD dst_unused:UNUSED_PAD src0_sel:DWORD src1_sel:WORD_1
    ds_read_b64 v[100:101], v100
    ds_read_b64 v[102:103], v102
    buffer_load_dwordx4 v[116:119], v71, s[12:15], s20 offen offset:3072 sc1
    s_waitcnt lgkmcnt(9)
    v_smfmac_f32_16x16x64_bf16 v[56:59], v[66:69], v[104:111], v70
    s_waitcnt vmcnt(2)
    v_lshlrev_b32_sdwa v104, 3, v120 dst_sel:DWORD dst_unused:UNUSED_PAD src0_sel:DWORD src1_sel:WORD_0
    v_lshlrev_b32_sdwa v106, 3, v120 dst_sel:DWORD dst_unused:UNUSED_PAD src0_sel:DWORD src1_sel:WORD_1
    ds_read_b64 v[104:105], v104
    ds_read_b64 v[106:107], v106
    v_lshlrev_b32_sdwa v108, 3, v121 dst_sel:DWORD dst_unused:UNUSED_PAD src0_sel:DWORD src1_sel:WORD_0
    v_lshlrev_b32_sdwa v110, 3, v121 dst_sel:DWORD dst_unused:UNUSED_PAD src0_sel:DWORD src1_sel:WORD_1
    s_nop 0
    v_cvt_pk_bf16_f32 v59, v58, v59
    v_cvt_pk_bf16_f32 v58, v56, v57
    v_mov_b64 v[54:55], 0
    v_mov_b64 v[56:57], 0
    ds_read_b64 v[108:109], v108
    ds_read_b64 v[110:111], v110
    s_waitcnt lgkmcnt(8)
    v_smfmac_f32_16x16x64_bf16 v[54:57], v[66:69], v[88:95], v70
    v_mfma_f32_16x16x32_bf16 v[112:115], v[72:75], v[208:211], 0
    v_lshlrev_b32_sdwa v88, 3, v122 dst_sel:DWORD dst_unused:UNUSED_PAD src0_sel:DWORD src1_sel:WORD_0
    v_lshlrev_b32_sdwa v90, 3, v122 dst_sel:DWORD dst_unused:UNUSED_PAD src0_sel:DWORD src1_sel:WORD_1
    ds_read_b64 v[88:89], v88
    ds_read_b64 v[90:91], v90
    v_mfma_f32_16x16x32_bf16 v[112:115], v[76:79], v[212:215], v[112:115]
    v_lshlrev_b32_sdwa v92, 3, v123 dst_sel:DWORD dst_unused:UNUSED_PAD src0_sel:DWORD src1_sel:WORD_0
    v_lshlrev_b32_sdwa v94, 3, v123 dst_sel:DWORD dst_unused:UNUSED_PAD src0_sel:DWORD src1_sel:WORD_1
    ds_read_b64 v[92:93], v92
    ds_read_b64 v[94:95], v94
    s_add_u32 s20, s20, 0x1000
    buffer_load_dwordx4 v[120:123], v71, s[12:15], s20 offen offset:0 sc1
    s_waitcnt lgkmcnt(8)
    v_smfmac_f32_16x16x64_bf16 v[54:57], v[66:69], v[96:103], v70
    v_mfma_f32_16x16x32_bf16 v[112:115], v[80:83], v[216:219], v[112:115]
    s_waitcnt vmcnt(2)
    v_lshlrev_b32_sdwa v96, 3, v124 dst_sel:DWORD dst_unused:UNUSED_PAD src0_sel:DWORD src1_sel:WORD_0
    v_lshlrev_b32_sdwa v98, 3, v124 dst_sel:DWORD dst_unused:UNUSED_PAD src0_sel:DWORD src1_sel:WORD_1
    ds_read_b64 v[96:97], v96
    ds_read_b64 v[98:99], v98
    v_mfma_f32_16x16x32_bf16 v[112:115], v[84:87], v[220:223], v[112:115]
    v_lshlrev_b32_sdwa v100, 3, v125 dst_sel:DWORD dst_unused:UNUSED_PAD src0_sel:DWORD src1_sel:WORD_0
    v_lshlrev_b32_sdwa v102, 3, v125 dst_sel:DWORD dst_unused:UNUSED_PAD src0_sel:DWORD src1_sel:WORD_1
    v_cvt_pk_bf16_f32 v57, v56, v57
    v_cvt_pk_bf16_f32 v56, v54, v55
    v_mov_b64 v[52:53], 0
    v_mov_b64 v[54:55], 0
    ds_read_b64 v[100:101], v100
    ds_read_b64 v[102:103], v102
    s_waitcnt lgkmcnt(8)
    v_smfmac_f32_16x16x64_bf16 v[52:55], v[66:69], v[104:111], v70
    v_cvt_pk_bf16_f32 v112, v112, v113
    v_cvt_pk_bf16_f32 v113, v114, v115
    v_lshlrev_b32_sdwa v114, 3, v70 dst_sel:DWORD dst_unused:UNUSED_PAD src0_sel:DWORD src1_sel:WORD_1
    ds_write_b64 v114, v[112:113] offset:33408
    v_lshlrev_b32_sdwa v104, 3, v126 dst_sel:DWORD dst_unused:UNUSED_PAD src0_sel:DWORD src1_sel:WORD_0
    v_lshlrev_b32_sdwa v106, 3, v126 dst_sel:DWORD dst_unused:UNUSED_PAD src0_sel:DWORD src1_sel:WORD_1
    ds_read_b64 v[104:105], v104
    ds_read_b64 v[106:107], v106
    v_lshlrev_b32_sdwa v108, 3, v127 dst_sel:DWORD dst_unused:UNUSED_PAD src0_sel:DWORD src1_sel:WORD_0
    v_lshlrev_b32_sdwa v110, 3, v127 dst_sel:DWORD dst_unused:UNUSED_PAD src0_sel:DWORD src1_sel:WORD_1
    ds_read_b64 v[108:109], v108
    ds_read_b64 v[110:111], v110
    buffer_load_dwordx4 v[124:127], v71, s[12:15], s20 offen offset:1024 sc1
    s_waitcnt lgkmcnt(9)
    v_smfmac_f32_16x16x64_bf16 v[52:55], v[66:69], v[88:95], v70
    s_waitcnt vmcnt(2)
    v_lshlrev_b32_sdwa v88, 3, v116 dst_sel:DWORD dst_unused:UNUSED_PAD src0_sel:DWORD src1_sel:WORD_0
    v_lshlrev_b32_sdwa v90, 3, v116 dst_sel:DWORD dst_unused:UNUSED_PAD src0_sel:DWORD src1_sel:WORD_1
    ds_read_b64 v[88:89], v88
    ds_read_b64 v[90:91], v90
    v_lshlrev_b32_sdwa v92, 3, v117 dst_sel:DWORD dst_unused:UNUSED_PAD src0_sel:DWORD src1_sel:WORD_0
    v_lshlrev_b32_sdwa v94, 3, v117 dst_sel:DWORD dst_unused:UNUSED_PAD src0_sel:DWORD src1_sel:WORD_1
    s_nop 0
    v_cvt_pk_bf16_f32 v55, v54, v55
    v_cvt_pk_bf16_f32 v54, v52, v53
    v_mov_b64 v[50:51], 0
    v_mov_b64 v[52:53], 0
    ds_read_b64 v[92:93], v92
    ds_read_b64 v[94:95], v94
    s_waitcnt lgkmcnt(9)
    v_smfmac_f32_16x16x64_bf16 v[50:53], v[66:69], v[96:103], v70
    v_lshlrev_b32_sdwa v96, 3, v118 dst_sel:DWORD dst_unused:UNUSED_PAD src0_sel:DWORD src1_sel:WORD_0
    v_lshlrev_b32_sdwa v98, 3, v118 dst_sel:DWORD dst_unused:UNUSED_PAD src0_sel:DWORD src1_sel:WORD_1
    ds_read_b64 v[96:97], v96
    ds_read_b64 v[98:99], v98
    v_lshlrev_b32_sdwa v100, 3, v119 dst_sel:DWORD dst_unused:UNUSED_PAD src0_sel:DWORD src1_sel:WORD_0
    v_lshlrev_b32_sdwa v102, 3, v119 dst_sel:DWORD dst_unused:UNUSED_PAD src0_sel:DWORD src1_sel:WORD_1
    ds_read_b64 v[100:101], v100
    ds_read_b64 v[102:103], v102
    buffer_load_dwordx4 v[116:119], v71, s[12:15], s20 offen offset:2048 sc1
    s_waitcnt lgkmcnt(8)
    v_smfmac_f32_16x16x64_bf16 v[50:53], v[66:69], v[104:111], v70
    v_mfma_f32_16x16x32_bf16 v[112:115], v[72:75], v[224:227], 0
    s_waitcnt vmcnt(2)
    v_lshlrev_b32_sdwa v104, 3, v120 dst_sel:DWORD dst_unused:UNUSED_PAD src0_sel:DWORD src1_sel:WORD_0
    v_lshlrev_b32_sdwa v106, 3, v120 dst_sel:DWORD dst_unused:UNUSED_PAD src0_sel:DWORD src1_sel:WORD_1
    ds_read_b64 v[104:105], v104
    ds_read_b64 v[106:107], v106
    v_mfma_f32_16x16x32_bf16 v[112:115], v[76:79], v[228:231], v[112:115]
    v_lshlrev_b32_sdwa v108, 3, v121 dst_sel:DWORD dst_unused:UNUSED_PAD src0_sel:DWORD src1_sel:WORD_0
    v_lshlrev_b32_sdwa v110, 3, v121 dst_sel:DWORD dst_unused:UNUSED_PAD src0_sel:DWORD src1_sel:WORD_1
    v_cvt_pk_bf16_f32 v53, v52, v53
    v_cvt_pk_bf16_f32 v52, v50, v51
    v_mov_b64 v[48:49], 0
    v_mov_b64 v[50:51], 0
    ds_read_b64 v[108:109], v108
    ds_read_b64 v[110:111], v110
    s_waitcnt lgkmcnt(8)
    v_smfmac_f32_16x16x64_bf16 v[48:51], v[66:69], v[88:95], v70
    s_setprio 2
    v_mfma_f32_16x16x32_bf16 v[112:115], v[80:83], v[232:235], v[112:115]
    v_lshlrev_b32_sdwa v88, 3, v122 dst_sel:DWORD dst_unused:UNUSED_PAD src0_sel:DWORD src1_sel:WORD_0
    v_lshlrev_b32_sdwa v90, 3, v122 dst_sel:DWORD dst_unused:UNUSED_PAD src0_sel:DWORD src1_sel:WORD_1
    ds_read_b64 v[88:89], v88
    ds_read_b64 v[90:91], v90
    v_mfma_f32_16x16x32_bf16 v[112:115], v[84:87], v[236:239], v[112:115]
    v_lshlrev_b32_sdwa v92, 3, v123 dst_sel:DWORD dst_unused:UNUSED_PAD src0_sel:DWORD src1_sel:WORD_0
    v_lshlrev_b32_sdwa v94, 3, v123 dst_sel:DWORD dst_unused:UNUSED_PAD src0_sel:DWORD src1_sel:WORD_1
    ds_read_b64 v[92:93], v92
    ds_read_b64 v[94:95], v94
    buffer_load_dwordx4 v[120:123], v71, s[12:15], s20 offen offset:3072 sc1
    s_waitcnt lgkmcnt(8)
    v_smfmac_f32_16x16x64_bf16 v[48:51], v[66:69], v[96:103], v70
    s_nop 0
    v_cvt_pk_bf16_f32 v112, v112, v113
    v_cvt_pk_bf16_f32 v113, v114, v115
    v_lshlrev_b32_sdwa v114, 3, v70 dst_sel:DWORD dst_unused:UNUSED_PAD src0_sel:DWORD src1_sel:WORD_1
    ds_write_b64 v114, v[112:113] offset:33536
    s_waitcnt vmcnt(2)
    v_lshlrev_b32_sdwa v96, 3, v124 dst_sel:DWORD dst_unused:UNUSED_PAD src0_sel:DWORD src1_sel:WORD_0
    v_lshlrev_b32_sdwa v98, 3, v124 dst_sel:DWORD dst_unused:UNUSED_PAD src0_sel:DWORD src1_sel:WORD_1
    ds_read_b64 v[96:97], v96
    ds_read_b64 v[98:99], v98
    v_lshlrev_b32_sdwa v100, 3, v125 dst_sel:DWORD dst_unused:UNUSED_PAD src0_sel:DWORD src1_sel:WORD_0
    v_lshlrev_b32_sdwa v102, 3, v125 dst_sel:DWORD dst_unused:UNUSED_PAD src0_sel:DWORD src1_sel:WORD_1
    v_cvt_pk_bf16_f32 v51, v50, v51
    v_cvt_pk_bf16_f32 v50, v48, v49
    v_mov_b64 v[46:47], 0
    v_mov_b64 v[48:49], 0
    ds_read_b64 v[100:101], v100
    ds_read_b64 v[102:103], v102
    s_waitcnt lgkmcnt(9)
    v_smfmac_f32_16x16x64_bf16 v[46:49], v[66:69], v[104:111], v70
    v_lshlrev_b32_sdwa v104, 3, v126 dst_sel:DWORD dst_unused:UNUSED_PAD src0_sel:DWORD src1_sel:WORD_0
    v_lshlrev_b32_sdwa v106, 3, v126 dst_sel:DWORD dst_unused:UNUSED_PAD src0_sel:DWORD src1_sel:WORD_1
    ds_read_b64 v[104:105], v104
    ds_read_b64 v[106:107], v106
    v_lshlrev_b32_sdwa v108, 3, v127 dst_sel:DWORD dst_unused:UNUSED_PAD src0_sel:DWORD src1_sel:WORD_0
    v_lshlrev_b32_sdwa v110, 3, v127 dst_sel:DWORD dst_unused:UNUSED_PAD src0_sel:DWORD src1_sel:WORD_1
    ds_read_b64 v[108:109], v108
    ds_read_b64 v[110:111], v110
    s_add_u32 s20, s20, 0x1000
    buffer_load_dwordx4 v[124:127], v71, s[12:15], s20 offen offset:0 sc1
    s_waitcnt lgkmcnt(9)
    v_smfmac_f32_16x16x64_bf16 v[46:49], v[66:69], v[88:95], v70
    s_waitcnt vmcnt(2)
    v_lshlrev_b32_sdwa v88, 3, v116 dst_sel:DWORD dst_unused:UNUSED_PAD src0_sel:DWORD src1_sel:WORD_0
    v_lshlrev_b32_sdwa v90, 3, v116 dst_sel:DWORD dst_unused:UNUSED_PAD src0_sel:DWORD src1_sel:WORD_1
    ds_read_b64 v[88:89], v88
    ds_read_b64 v[90:91], v90
    v_lshlrev_b32_sdwa v92, 3, v117 dst_sel:DWORD dst_unused:UNUSED_PAD src0_sel:DWORD src1_sel:WORD_0
    v_lshlrev_b32_sdwa v94, 3, v117 dst_sel:DWORD dst_unused:UNUSED_PAD src0_sel:DWORD src1_sel:WORD_1
    s_nop 0
    v_cvt_pk_bf16_f32 v49, v48, v49
    v_cvt_pk_bf16_f32 v48, v46, v47
    v_mov_b64 v[44:45], 0
    v_mov_b64 v[46:47], 0
    ds_read_b64 v[92:93], v92
    ds_read_b64 v[94:95], v94
    s_waitcnt lgkmcnt(8)
    v_smfmac_f32_16x16x64_bf16 v[44:47], v[66:69], v[96:103], v70
    v_mfma_f32_16x16x32_bf16 v[112:115], v[72:75], v[240:243], 0
    buffer_load_dwordx4 v[72:75], v71, s[12:15], s21 offen offset:0
    v_lshlrev_b32_sdwa v96, 3, v118 dst_sel:DWORD dst_unused:UNUSED_PAD src0_sel:DWORD src1_sel:WORD_0
    v_lshlrev_b32_sdwa v98, 3, v118 dst_sel:DWORD dst_unused:UNUSED_PAD src0_sel:DWORD src1_sel:WORD_1
    ds_read_b64 v[96:97], v96
    ds_read_b64 v[98:99], v98
    v_mfma_f32_16x16x32_bf16 v[112:115], v[76:79], v[244:247], v[112:115]
    buffer_load_dwordx4 v[76:79], v71, s[12:15], s21 offen offset:1024
    v_lshlrev_b32_sdwa v100, 3, v119 dst_sel:DWORD dst_unused:UNUSED_PAD src0_sel:DWORD src1_sel:WORD_0
    v_lshlrev_b32_sdwa v102, 3, v119 dst_sel:DWORD dst_unused:UNUSED_PAD src0_sel:DWORD src1_sel:WORD_1
    ds_read_b64 v[100:101], v100
    ds_read_b64 v[102:103], v102
    buffer_load_dwordx4 v[116:119], v71, s[12:15], s20 offen offset:1024 sc1
    s_waitcnt lgkmcnt(8)
    v_smfmac_f32_16x16x64_bf16 v[44:47], v[66:69], v[104:111], v70
    v_mfma_f32_16x16x32_bf16 v[112:115], v[80:83], v[248:251], v[112:115]
    buffer_load_dwordx4 v[80:83], v71, s[12:15], s19 offen offset:0
    s_waitcnt vmcnt(5)
    v_lshlrev_b32_sdwa v104, 3, v120 dst_sel:DWORD dst_unused:UNUSED_PAD src0_sel:DWORD src1_sel:WORD_0
    v_lshlrev_b32_sdwa v106, 3, v120 dst_sel:DWORD dst_unused:UNUSED_PAD src0_sel:DWORD src1_sel:WORD_1
    ds_read_b64 v[104:105], v104
    ds_read_b64 v[106:107], v106
    v_mfma_f32_16x16x32_bf16 v[112:115], v[84:87], v[252:255], v[112:115]
    buffer_load_dwordx4 v[84:87], v71, s[12:15], s19 offen offset:1024
    s_add_u32 s21, s21, 4096
    s_add_u32 s19, s19, 4096
    v_lshlrev_b32_sdwa v108, 3, v121 dst_sel:DWORD dst_unused:UNUSED_PAD src0_sel:DWORD src1_sel:WORD_0
    v_lshlrev_b32_sdwa v110, 3, v121 dst_sel:DWORD dst_unused:UNUSED_PAD src0_sel:DWORD src1_sel:WORD_1
    v_cvt_pk_bf16_f32 v47, v46, v47
    v_cvt_pk_bf16_f32 v46, v44, v45
    v_mov_b64 v[42:43], 0
    v_mov_b64 v[44:45], 0
    ds_read_b64 v[108:109], v108
    ds_read_b64 v[110:111], v110
    s_waitcnt lgkmcnt(8)
    v_smfmac_f32_16x16x64_bf16 v[42:45], v[66:69], v[88:95], v70
    v_cvt_pk_bf16_f32 v112, v112, v113
    v_cvt_pk_bf16_f32 v113, v114, v115
    v_lshlrev_b32_sdwa v114, 3, v70 dst_sel:DWORD dst_unused:UNUSED_PAD src0_sel:DWORD src1_sel:WORD_1
    ds_write_b64 v114, v[112:113] offset:33664
    v_lshlrev_b32_sdwa v88, 3, v122 dst_sel:DWORD dst_unused:UNUSED_PAD src0_sel:DWORD src1_sel:WORD_0
    v_lshlrev_b32_sdwa v90, 3, v122 dst_sel:DWORD dst_unused:UNUSED_PAD src0_sel:DWORD src1_sel:WORD_1
    ds_read_b64 v[88:89], v88
    ds_read_b64 v[90:91], v90
    v_lshlrev_b32_sdwa v92, 3, v123 dst_sel:DWORD dst_unused:UNUSED_PAD src0_sel:DWORD src1_sel:WORD_0
    v_lshlrev_b32_sdwa v94, 3, v123 dst_sel:DWORD dst_unused:UNUSED_PAD src0_sel:DWORD src1_sel:WORD_1
    ds_read_b64 v[92:93], v92
    ds_read_b64 v[94:95], v94
    buffer_load_dwordx4 v[120:123], v71, s[12:15], s20 offen offset:2048 sc1
    s_waitcnt lgkmcnt(9)
    v_smfmac_f32_16x16x64_bf16 v[42:45], v[66:69], v[96:103], v70
    s_waitcnt vmcnt(6)
    v_lshlrev_b32_sdwa v96, 3, v124 dst_sel:DWORD dst_unused:UNUSED_PAD src0_sel:DWORD src1_sel:WORD_0
    v_lshlrev_b32_sdwa v98, 3, v124 dst_sel:DWORD dst_unused:UNUSED_PAD src0_sel:DWORD src1_sel:WORD_1
    ds_read_b64 v[96:97], v96
    ds_read_b64 v[98:99], v98
    v_lshlrev_b32_sdwa v100, 3, v125 dst_sel:DWORD dst_unused:UNUSED_PAD src0_sel:DWORD src1_sel:WORD_0
    v_lshlrev_b32_sdwa v102, 3, v125 dst_sel:DWORD dst_unused:UNUSED_PAD src0_sel:DWORD src1_sel:WORD_1
    s_nop 0
    v_cvt_pk_bf16_f32 v45, v44, v45
    v_cvt_pk_bf16_f32 v44, v42, v43
    v_mov_b64 v[40:41], 0
    v_mov_b64 v[42:43], 0
    ds_read_b64 v[100:101], v100
    ds_read_b64 v[102:103], v102
    s_waitcnt lgkmcnt(9)
    v_smfmac_f32_16x16x64_bf16 v[40:43], v[66:69], v[104:111], v70
    s_setprio 1
    v_lshlrev_b32_sdwa v104, 3, v126 dst_sel:DWORD dst_unused:UNUSED_PAD src0_sel:DWORD src1_sel:WORD_0
    v_lshlrev_b32_sdwa v106, 3, v126 dst_sel:DWORD dst_unused:UNUSED_PAD src0_sel:DWORD src1_sel:WORD_1
    ds_read_b64 v[104:105], v104
    ds_read_b64 v[106:107], v106
    v_lshlrev_b32_sdwa v108, 3, v127 dst_sel:DWORD dst_unused:UNUSED_PAD src0_sel:DWORD src1_sel:WORD_0
    v_lshlrev_b32_sdwa v110, 3, v127 dst_sel:DWORD dst_unused:UNUSED_PAD src0_sel:DWORD src1_sel:WORD_1
    ds_read_b64 v[108:109], v108
    ds_read_b64 v[110:111], v110
    buffer_load_dwordx4 v[124:127], v71, s[12:15], s20 offen offset:3072 sc1
    s_waitcnt lgkmcnt(8)
    v_smfmac_f32_16x16x64_bf16 v[40:43], v[66:69], v[88:95], v70
    s_waitcnt vmcnt(4)
    v_lshlrev_b32_sdwa v88, 3, v116 dst_sel:DWORD dst_unused:UNUSED_PAD src0_sel:DWORD src1_sel:WORD_0
    v_lshlrev_b32_sdwa v90, 3, v116 dst_sel:DWORD dst_unused:UNUSED_PAD src0_sel:DWORD src1_sel:WORD_1
    ds_read_b64 v[88:89], v88
    ds_read_b64 v[90:91], v90
    v_lshlrev_b32_sdwa v92, 3, v117 dst_sel:DWORD dst_unused:UNUSED_PAD src0_sel:DWORD src1_sel:WORD_0
    v_lshlrev_b32_sdwa v94, 3, v117 dst_sel:DWORD dst_unused:UNUSED_PAD src0_sel:DWORD src1_sel:WORD_1
    s_nop 0
    v_cvt_pk_bf16_f32 v43, v42, v43
    v_cvt_pk_bf16_f32 v42, v40, v41
    v_mov_b64 v[38:39], 0
    v_mov_b64 v[40:41], 0
    ds_read_b64 v[92:93], v92
    ds_read_b64 v[94:95], v94
    s_waitcnt lgkmcnt(8)
    v_smfmac_f32_16x16x64_bf16 v[38:41], v[66:69], v[96:103], v70
    v_lshlrev_b32_sdwa v96, 3, v118 dst_sel:DWORD dst_unused:UNUSED_PAD src0_sel:DWORD src1_sel:WORD_0
    v_lshlrev_b32_sdwa v98, 3, v118 dst_sel:DWORD dst_unused:UNUSED_PAD src0_sel:DWORD src1_sel:WORD_1
    ds_read_b64 v[96:97], v96
    ds_read_b64 v[98:99], v98
    v_lshlrev_b32_sdwa v100, 3, v119 dst_sel:DWORD dst_unused:UNUSED_PAD src0_sel:DWORD src1_sel:WORD_0
    v_lshlrev_b32_sdwa v102, 3, v119 dst_sel:DWORD dst_unused:UNUSED_PAD src0_sel:DWORD src1_sel:WORD_1
    ds_read_b64 v[100:101], v100
    ds_read_b64 v[102:103], v102
    s_add_u32 s20, s20, 0x20000
    buffer_load_dwordx4 v[116:119], v71, s[12:15], s20 offen offset:3072 sc1
    s_waitcnt lgkmcnt(8)
    v_smfmac_f32_16x16x64_bf16 v[38:41], v[66:69], v[104:111], v70
    s_waitcnt vmcnt(2)
    v_lshlrev_b32_sdwa v104, 3, v120 dst_sel:DWORD dst_unused:UNUSED_PAD src0_sel:DWORD src1_sel:WORD_0
    v_lshlrev_b32_sdwa v106, 3, v120 dst_sel:DWORD dst_unused:UNUSED_PAD src0_sel:DWORD src1_sel:WORD_1
    ds_read_b64 v[104:105], v104
    ds_read_b64 v[106:107], v106
    v_lshlrev_b32_sdwa v108, 3, v121 dst_sel:DWORD dst_unused:UNUSED_PAD src0_sel:DWORD src1_sel:WORD_0
    v_lshlrev_b32_sdwa v110, 3, v121 dst_sel:DWORD dst_unused:UNUSED_PAD src0_sel:DWORD src1_sel:WORD_1
    s_nop 0
    v_cvt_pk_bf16_f32 v41, v40, v41
    v_cvt_pk_bf16_f32 v40, v38, v39
    v_mov_b64 v[36:37], 0
    v_mov_b64 v[38:39], 0
    ds_read_b64 v[108:109], v108
    ds_read_b64 v[110:111], v110
    s_waitcnt lgkmcnt(8)
    v_smfmac_f32_16x16x64_bf16 v[36:39], v[66:69], v[88:95], v70
    v_lshlrev_b32_sdwa v88, 3, v122 dst_sel:DWORD dst_unused:UNUSED_PAD src0_sel:DWORD src1_sel:WORD_0
    v_lshlrev_b32_sdwa v90, 3, v122 dst_sel:DWORD dst_unused:UNUSED_PAD src0_sel:DWORD src1_sel:WORD_1
    ds_read_b64 v[88:89], v88
    ds_read_b64 v[90:91], v90
    v_lshlrev_b32_sdwa v92, 3, v123 dst_sel:DWORD dst_unused:UNUSED_PAD src0_sel:DWORD src1_sel:WORD_0
    v_lshlrev_b32_sdwa v94, 3, v123 dst_sel:DWORD dst_unused:UNUSED_PAD src0_sel:DWORD src1_sel:WORD_1
    ds_read_b64 v[92:93], v92
    ds_read_b64 v[94:95], v94
    buffer_load_dwordx4 v[120:123], v71, s[12:15], s20 offen offset:2048 sc1
    s_waitcnt lgkmcnt(8)
    v_smfmac_f32_16x16x64_bf16 v[36:39], v[66:69], v[96:103], v70
    s_waitcnt vmcnt(2)
    v_lshlrev_b32_sdwa v96, 3, v124 dst_sel:DWORD dst_unused:UNUSED_PAD src0_sel:DWORD src1_sel:WORD_0
    v_lshlrev_b32_sdwa v98, 3, v124 dst_sel:DWORD dst_unused:UNUSED_PAD src0_sel:DWORD src1_sel:WORD_1
    ds_read_b64 v[96:97], v96
    ds_read_b64 v[98:99], v98
    v_lshlrev_b32_sdwa v100, 3, v125 dst_sel:DWORD dst_unused:UNUSED_PAD src0_sel:DWORD src1_sel:WORD_0
    v_lshlrev_b32_sdwa v102, 3, v125 dst_sel:DWORD dst_unused:UNUSED_PAD src0_sel:DWORD src1_sel:WORD_1
    s_nop 0
    v_cvt_pk_bf16_f32 v39, v38, v39
    v_cvt_pk_bf16_f32 v38, v36, v37
    v_mov_b64 v[34:35], 0
    v_mov_b64 v[36:37], 0
    ds_read_b64 v[100:101], v100
    ds_read_b64 v[102:103], v102
    s_waitcnt lgkmcnt(8)
    v_smfmac_f32_16x16x64_bf16 v[34:37], v[66:69], v[104:111], v70
    s_setprio 0
    v_lshlrev_b32_sdwa v104, 3, v126 dst_sel:DWORD dst_unused:UNUSED_PAD src0_sel:DWORD src1_sel:WORD_0
    v_lshlrev_b32_sdwa v106, 3, v126 dst_sel:DWORD dst_unused:UNUSED_PAD src0_sel:DWORD src1_sel:WORD_1
    ds_read_b64 v[104:105], v104
    ds_read_b64 v[106:107], v106
    v_lshlrev_b32_sdwa v108, 3, v127 dst_sel:DWORD dst_unused:UNUSED_PAD src0_sel:DWORD src1_sel:WORD_0
    v_lshlrev_b32_sdwa v110, 3, v127 dst_sel:DWORD dst_unused:UNUSED_PAD src0_sel:DWORD src1_sel:WORD_1
    ds_read_b64 v[108:109], v108
    ds_read_b64 v[110:111], v110
    buffer_load_dwordx4 v[124:127], v71, s[12:15], s20 offen offset:1024 sc1
    s_waitcnt lgkmcnt(8)
    v_smfmac_f32_16x16x64_bf16 v[34:37], v[66:69], v[88:95], v70
    s_waitcnt vmcnt(2)
    v_lshlrev_b32_sdwa v88, 3, v118 dst_sel:DWORD dst_unused:UNUSED_PAD src0_sel:DWORD src1_sel:WORD_0
    v_lshlrev_b32_sdwa v90, 3, v118 dst_sel:DWORD dst_unused:UNUSED_PAD src0_sel:DWORD src1_sel:WORD_1
    ds_read_b64 v[88:89], v88
    ds_read_b64 v[90:91], v90
    v_lshlrev_b32_sdwa v92, 3, v119 dst_sel:DWORD dst_unused:UNUSED_PAD src0_sel:DWORD src1_sel:WORD_0
    v_lshlrev_b32_sdwa v94, 3, v119 dst_sel:DWORD dst_unused:UNUSED_PAD src0_sel:DWORD src1_sel:WORD_1
    s_nop 0
    v_cvt_pk_bf16_f32 v37, v36, v37
    v_cvt_pk_bf16_f32 v36, v34, v35
    v_mov_b64 v[32:33], 0
    v_mov_b64 v[34:35], 0
    ds_read_b64 v[92:93], v92
    ds_read_b64 v[94:95], v94
    s_waitcnt lgkmcnt(8)
    v_smfmac_f32_16x16x64_bf16 v[32:35], v[66:69], v[96:103], v70
    s_barrier
    s_setprio 3
    v_lshlrev_b32_sdwa v96, 3, v116 dst_sel:DWORD dst_unused:UNUSED_PAD src0_sel:DWORD src1_sel:WORD_0
    v_lshlrev_b32_sdwa v98, 3, v116 dst_sel:DWORD dst_unused:UNUSED_PAD src0_sel:DWORD src1_sel:WORD_1
    ds_read_b64 v[96:97], v96
    ds_read_b64 v[98:99], v98
    v_lshlrev_b32_sdwa v100, 3, v117 dst_sel:DWORD dst_unused:UNUSED_PAD src0_sel:DWORD src1_sel:WORD_0
    v_lshlrev_b32_sdwa v102, 3, v117 dst_sel:DWORD dst_unused:UNUSED_PAD src0_sel:DWORD src1_sel:WORD_1
    ds_read_b64 v[100:101], v100
    ds_read_b64 v[102:103], v102
    buffer_load_dwordx4 v[116:119], v71, s[12:15], s20 offen offset:0 sc1
    s_waitcnt lgkmcnt(8)
    v_smfmac_f32_16x16x64_bf16 v[32:35], v[66:69], v[104:111], v70
    v_mfma_f32_16x16x32_bf16 v[112:115], v[72:75], v[128:131], 0
    s_waitcnt vmcnt(2)
    v_lshlrev_b32_sdwa v104, 3, v122 dst_sel:DWORD dst_unused:UNUSED_PAD src0_sel:DWORD src1_sel:WORD_0
    v_lshlrev_b32_sdwa v106, 3, v122 dst_sel:DWORD dst_unused:UNUSED_PAD src0_sel:DWORD src1_sel:WORD_1
    ds_read_b64 v[104:105], v104
    ds_read_b64 v[106:107], v106
    v_mfma_f32_16x16x32_bf16 v[112:115], v[76:79], v[132:135], v[112:115]
    v_add_u32 v70, 0x20000000, v70
    v_lshlrev_b32_sdwa v108, 3, v123 dst_sel:DWORD dst_unused:UNUSED_PAD src0_sel:DWORD src1_sel:WORD_0
    v_lshlrev_b32_sdwa v110, 3, v123 dst_sel:DWORD dst_unused:UNUSED_PAD src0_sel:DWORD src1_sel:WORD_1
    v_cvt_pk_bf16_f32 v35, v34, v35
    v_cvt_pk_bf16_f32 v34, v32, v33
    v_and_b32 v33, s23, v31
    v_lshlrev_b32 v32, 16, v31
    v_and_b32 v31, s23, v30
    v_lshlrev_b32 v30, 16, v30
    ds_read_b64 v[108:109], v108
    ds_read_b64 v[110:111], v110
    s_waitcnt lgkmcnt(8)
    v_smfmac_f32_16x16x64_bf16 v[30:33], v[66:69], v[88:95], v70
    v_mfma_f32_16x16x32_bf16 v[112:115], v[80:83], v[136:139], v[112:115]
    v_lshlrev_b32_sdwa v88, 3, v120 dst_sel:DWORD dst_unused:UNUSED_PAD src0_sel:DWORD src1_sel:WORD_0
    v_lshlrev_b32_sdwa v90, 3, v120 dst_sel:DWORD dst_unused:UNUSED_PAD src0_sel:DWORD src1_sel:WORD_1
    ds_read_b64 v[88:89], v88
    ds_read_b64 v[90:91], v90
    v_mfma_f32_16x16x32_bf16 v[112:115], v[84:87], v[140:143], v[112:115]
    v_lshlrev_b32_sdwa v92, 3, v121 dst_sel:DWORD dst_unused:UNUSED_PAD src0_sel:DWORD src1_sel:WORD_0
    v_lshlrev_b32_sdwa v94, 3, v121 dst_sel:DWORD dst_unused:UNUSED_PAD src0_sel:DWORD src1_sel:WORD_1
    ds_read_b64 v[92:93], v92
    ds_read_b64 v[94:95], v94
    s_add_u32 s20, s20, 0xfffff000
    buffer_load_dwordx4 v[120:123], v71, s[12:15], s20 offen offset:3072 sc1
    s_waitcnt lgkmcnt(8)
    v_smfmac_f32_16x16x64_bf16 v[30:33], v[66:69], v[96:103], v70
    v_cvt_pk_bf16_f32 v112, v112, v113
    v_cvt_pk_bf16_f32 v113, v114, v115
    v_lshlrev_b32_sdwa v114, 3, v70 dst_sel:DWORD dst_unused:UNUSED_PAD src0_sel:DWORD src1_sel:WORD_1
    ds_write_b64 v114, v[112:113] offset:0
    s_waitcnt vmcnt(2)
    v_lshlrev_b32_sdwa v96, 3, v126 dst_sel:DWORD dst_unused:UNUSED_PAD src0_sel:DWORD src1_sel:WORD_0
    v_lshlrev_b32_sdwa v98, 3, v126 dst_sel:DWORD dst_unused:UNUSED_PAD src0_sel:DWORD src1_sel:WORD_1
    ds_read_b64 v[96:97], v96
    ds_read_b64 v[98:99], v98
    v_lshlrev_b32_sdwa v100, 3, v127 dst_sel:DWORD dst_unused:UNUSED_PAD src0_sel:DWORD src1_sel:WORD_0
    v_lshlrev_b32_sdwa v102, 3, v127 dst_sel:DWORD dst_unused:UNUSED_PAD src0_sel:DWORD src1_sel:WORD_1
    v_cvt_pk_bf16_f32 v33, v32, v33
    v_cvt_pk_bf16_f32 v32, v30, v31
    v_and_b32 v31, s23, v29
    v_lshlrev_b32 v30, 16, v29
    v_and_b32 v29, s23, v28
    v_lshlrev_b32 v28, 16, v28
    ds_read_b64 v[100:101], v100
    ds_read_b64 v[102:103], v102
    s_waitcnt lgkmcnt(9)
    v_smfmac_f32_16x16x64_bf16 v[28:31], v[66:69], v[104:111], v70
    v_mfma_f32_16x16x32_bf16 v[112:115], v[72:75], v[144:147], 0
    v_lshlrev_b32_sdwa v104, 3, v124 dst_sel:DWORD dst_unused:UNUSED_PAD src0_sel:DWORD src1_sel:WORD_0
    v_lshlrev_b32_sdwa v106, 3, v124 dst_sel:DWORD dst_unused:UNUSED_PAD src0_sel:DWORD src1_sel:WORD_1
    ds_read_b64 v[104:105], v104
    ds_read_b64 v[106:107], v106
    v_mfma_f32_16x16x32_bf16 v[112:115], v[76:79], v[148:151], v[112:115]
    v_lshlrev_b32_sdwa v108, 3, v125 dst_sel:DWORD dst_unused:UNUSED_PAD src0_sel:DWORD src1_sel:WORD_0
    v_lshlrev_b32_sdwa v110, 3, v125 dst_sel:DWORD dst_unused:UNUSED_PAD src0_sel:DWORD src1_sel:WORD_1
    ds_read_b64 v[108:109], v108
    ds_read_b64 v[110:111], v110
    buffer_load_dwordx4 v[124:127], v71, s[12:15], s20 offen offset:2048 sc1
    s_waitcnt lgkmcnt(9)
    v_smfmac_f32_16x16x64_bf16 v[28:31], v[66:69], v[88:95], v70
    v_mfma_f32_16x16x32_bf16 v[112:115], v[80:83], v[152:155], v[112:115]
    s_waitcnt vmcnt(2)
    v_lshlrev_b32_sdwa v88, 3, v118 dst_sel:DWORD dst_unused:UNUSED_PAD src0_sel:DWORD src1_sel:WORD_0
    v_lshlrev_b32_sdwa v90, 3, v118 dst_sel:DWORD dst_unused:UNUSED_PAD src0_sel:DWORD src1_sel:WORD_1
    ds_read_b64 v[88:89], v88
    ds_read_b64 v[90:91], v90
    v_mfma_f32_16x16x32_bf16 v[112:115], v[84:87], v[156:159], v[112:115]
    v_lshlrev_b32_sdwa v92, 3, v119 dst_sel:DWORD dst_unused:UNUSED_PAD src0_sel:DWORD src1_sel:WORD_0
    v_lshlrev_b32_sdwa v94, 3, v119 dst_sel:DWORD dst_unused:UNUSED_PAD src0_sel:DWORD src1_sel:WORD_1
    v_cvt_pk_bf16_f32 v31, v30, v31
    v_cvt_pk_bf16_f32 v30, v28, v29
    v_and_b32 v29, s23, v27
    v_lshlrev_b32 v28, 16, v27
    v_and_b32 v27, s23, v26
    v_lshlrev_b32 v26, 16, v26
    ds_read_b64 v[92:93], v92
    ds_read_b64 v[94:95], v94
    s_waitcnt lgkmcnt(8)
    v_smfmac_f32_16x16x64_bf16 v[26:29], v[66:69], v[96:103], v70
    v_cvt_pk_bf16_f32 v112, v112, v113
    v_cvt_pk_bf16_f32 v113, v114, v115
    v_lshlrev_b32_sdwa v114, 3, v70 dst_sel:DWORD dst_unused:UNUSED_PAD src0_sel:DWORD src1_sel:WORD_1
    ds_write_b64 v114, v[112:113] offset:128
    v_lshlrev_b32_sdwa v96, 3, v116 dst_sel:DWORD dst_unused:UNUSED_PAD src0_sel:DWORD src1_sel:WORD_0
    v_lshlrev_b32_sdwa v98, 3, v116 dst_sel:DWORD dst_unused:UNUSED_PAD src0_sel:DWORD src1_sel:WORD_1
    ds_read_b64 v[96:97], v96
    ds_read_b64 v[98:99], v98
    v_lshlrev_b32_sdwa v100, 3, v117 dst_sel:DWORD dst_unused:UNUSED_PAD src0_sel:DWORD src1_sel:WORD_0
    v_lshlrev_b32_sdwa v102, 3, v117 dst_sel:DWORD dst_unused:UNUSED_PAD src0_sel:DWORD src1_sel:WORD_1
    ds_read_b64 v[100:101], v100
    ds_read_b64 v[102:103], v102
    buffer_load_dwordx4 v[116:119], v71, s[12:15], s20 offen offset:1024 sc1
    s_waitcnt lgkmcnt(9)
    v_smfmac_f32_16x16x64_bf16 v[26:29], v[66:69], v[104:111], v70
    v_mfma_f32_16x16x32_bf16 v[112:115], v[72:75], v[160:163], 0
    s_waitcnt vmcnt(2)
    v_lshlrev_b32_sdwa v104, 3, v122 dst_sel:DWORD dst_unused:UNUSED_PAD src0_sel:DWORD src1_sel:WORD_0
    v_lshlrev_b32_sdwa v106, 3, v122 dst_sel:DWORD dst_unused:UNUSED_PAD src0_sel:DWORD src1_sel:WORD_1
    ds_read_b64 v[104:105], v104
    ds_read_b64 v[106:107], v106
    v_mfma_f32_16x16x32_bf16 v[112:115], v[76:79], v[164:167], v[112:115]
    v_lshlrev_b32_sdwa v108, 3, v123 dst_sel:DWORD dst_unused:UNUSED_PAD src0_sel:DWORD src1_sel:WORD_0
    v_lshlrev_b32_sdwa v110, 3, v123 dst_sel:DWORD dst_unused:UNUSED_PAD src0_sel:DWORD src1_sel:WORD_1
    v_cvt_pk_bf16_f32 v29, v28, v29
    v_cvt_pk_bf16_f32 v28, v26, v27
    v_and_b32 v27, s23, v25
    v_lshlrev_b32 v26, 16, v25
    v_and_b32 v25, s23, v24
    v_lshlrev_b32 v24, 16, v24
    ds_read_b64 v[108:109], v108
    ds_read_b64 v[110:111], v110
    s_waitcnt lgkmcnt(9)
    v_smfmac_f32_16x16x64_bf16 v[24:27], v[66:69], v[88:95], v70
    v_mfma_f32_16x16x32_bf16 v[112:115], v[80:83], v[168:171], v[112:115]
    v_lshlrev_b32_sdwa v88, 3, v120 dst_sel:DWORD dst_unused:UNUSED_PAD src0_sel:DWORD src1_sel:WORD_0
    v_lshlrev_b32_sdwa v90, 3, v120 dst_sel:DWORD dst_unused:UNUSED_PAD src0_sel:DWORD src1_sel:WORD_1
    ds_read_b64 v[88:89], v88
    ds_read_b64 v[90:91], v90
    v_mfma_f32_16x16x32_bf16 v[112:115], v[84:87], v[172:175], v[112:115]
    v_lshlrev_b32_sdwa v92, 3, v121 dst_sel:DWORD dst_unused:UNUSED_PAD src0_sel:DWORD src1_sel:WORD_0
    v_lshlrev_b32_sdwa v94, 3, v121 dst_sel:DWORD dst_unused:UNUSED_PAD src0_sel:DWORD src1_sel:WORD_1
    ds_read_b64 v[92:93], v92
    ds_read_b64 v[94:95], v94
    buffer_load_dwordx4 v[120:123], v71, s[12:15], s20 offen offset:0 sc1
    s_waitcnt lgkmcnt(8)
    v_smfmac_f32_16x16x64_bf16 v[24:27], v[66:69], v[96:103], v70
    s_nop 0
    v_cvt_pk_bf16_f32 v112, v112, v113
    v_cvt_pk_bf16_f32 v113, v114, v115
    v_lshlrev_b32_sdwa v114, 3, v70 dst_sel:DWORD dst_unused:UNUSED_PAD src0_sel:DWORD src1_sel:WORD_1
    ds_write_b64 v114, v[112:113] offset:256
    s_waitcnt vmcnt(2)
    v_lshlrev_b32_sdwa v96, 3, v126 dst_sel:DWORD dst_unused:UNUSED_PAD src0_sel:DWORD src1_sel:WORD_0
    v_lshlrev_b32_sdwa v98, 3, v126 dst_sel:DWORD dst_unused:UNUSED_PAD src0_sel:DWORD src1_sel:WORD_1
    ds_read_b64 v[96:97], v96
    ds_read_b64 v[98:99], v98
    v_lshlrev_b32_sdwa v100, 3, v127 dst_sel:DWORD dst_unused:UNUSED_PAD src0_sel:DWORD src1_sel:WORD_0
    v_lshlrev_b32_sdwa v102, 3, v127 dst_sel:DWORD dst_unused:UNUSED_PAD src0_sel:DWORD src1_sel:WORD_1
    v_cvt_pk_bf16_f32 v27, v26, v27
    v_cvt_pk_bf16_f32 v26, v24, v25
    v_and_b32 v25, s23, v23
    v_lshlrev_b32 v24, 16, v23
    v_and_b32 v23, s23, v22
    v_lshlrev_b32 v22, 16, v22
    ds_read_b64 v[100:101], v100
    ds_read_b64 v[102:103], v102
    s_waitcnt lgkmcnt(9)
    v_smfmac_f32_16x16x64_bf16 v[22:25], v[66:69], v[104:111], v70
    v_mfma_f32_16x16x32_bf16 v[112:115], v[72:75], v[176:179], 0
    v_lshlrev_b32_sdwa v104, 3, v124 dst_sel:DWORD dst_unused:UNUSED_PAD src0_sel:DWORD src1_sel:WORD_0
    v_lshlrev_b32_sdwa v106, 3, v124 dst_sel:DWORD dst_unused:UNUSED_PAD src0_sel:DWORD src1_sel:WORD_1
    ds_read_b64 v[104:105], v104
    ds_read_b64 v[106:107], v106
    v_mfma_f32_16x16x32_bf16 v[112:115], v[76:79], v[180:183], v[112:115]
    v_lshlrev_b32_sdwa v108, 3, v125 dst_sel:DWORD dst_unused:UNUSED_PAD src0_sel:DWORD src1_sel:WORD_0
    v_lshlrev_b32_sdwa v110, 3, v125 dst_sel:DWORD dst_unused:UNUSED_PAD src0_sel:DWORD src1_sel:WORD_1
    ds_read_b64 v[108:109], v108
    ds_read_b64 v[110:111], v110
    s_add_u32 s20, s20, 0xfffff000
    buffer_load_dwordx4 v[124:127], v71, s[12:15], s20 offen offset:3072 sc1
    s_waitcnt lgkmcnt(9)
    v_smfmac_f32_16x16x64_bf16 v[22:25], v[66:69], v[88:95], v70
    v_mfma_f32_16x16x32_bf16 v[112:115], v[80:83], v[184:187], v[112:115]
    s_waitcnt vmcnt(2)
    v_lshlrev_b32_sdwa v88, 3, v118 dst_sel:DWORD dst_unused:UNUSED_PAD src0_sel:DWORD src1_sel:WORD_0
    v_lshlrev_b32_sdwa v90, 3, v118 dst_sel:DWORD dst_unused:UNUSED_PAD src0_sel:DWORD src1_sel:WORD_1
    ds_read_b64 v[88:89], v88
    ds_read_b64 v[90:91], v90
    v_mfma_f32_16x16x32_bf16 v[112:115], v[84:87], v[188:191], v[112:115]
    v_lshlrev_b32_sdwa v92, 3, v119 dst_sel:DWORD dst_unused:UNUSED_PAD src0_sel:DWORD src1_sel:WORD_0
    v_lshlrev_b32_sdwa v94, 3, v119 dst_sel:DWORD dst_unused:UNUSED_PAD src0_sel:DWORD src1_sel:WORD_1
    v_cvt_pk_bf16_f32 v25, v24, v25
    v_cvt_pk_bf16_f32 v24, v22, v23
    v_and_b32 v23, s23, v21
    v_lshlrev_b32 v22, 16, v21
    v_and_b32 v21, s23, v20
    v_lshlrev_b32 v20, 16, v20
    ds_read_b64 v[92:93], v92
    ds_read_b64 v[94:95], v94
    s_waitcnt lgkmcnt(8)
    v_smfmac_f32_16x16x64_bf16 v[20:23], v[66:69], v[96:103], v70
    v_cvt_pk_bf16_f32 v112, v112, v113
    v_cvt_pk_bf16_f32 v113, v114, v115
    v_lshlrev_b32_sdwa v114, 3, v70 dst_sel:DWORD dst_unused:UNUSED_PAD src0_sel:DWORD src1_sel:WORD_1
    ds_write_b64 v114, v[112:113] offset:384
    v_lshlrev_b32_sdwa v96, 3, v116 dst_sel:DWORD dst_unused:UNUSED_PAD src0_sel:DWORD src1_sel:WORD_0
    v_lshlrev_b32_sdwa v98, 3, v116 dst_sel:DWORD dst_unused:UNUSED_PAD src0_sel:DWORD src1_sel:WORD_1
    ds_read_b64 v[96:97], v96
    ds_read_b64 v[98:99], v98
    v_lshlrev_b32_sdwa v100, 3, v117 dst_sel:DWORD dst_unused:UNUSED_PAD src0_sel:DWORD src1_sel:WORD_0
    v_lshlrev_b32_sdwa v102, 3, v117 dst_sel:DWORD dst_unused:UNUSED_PAD src0_sel:DWORD src1_sel:WORD_1
    ds_read_b64 v[100:101], v100
    ds_read_b64 v[102:103], v102
    buffer_load_dwordx4 v[116:119], v71, s[12:15], s20 offen offset:2048 sc1
    s_waitcnt lgkmcnt(9)
    v_smfmac_f32_16x16x64_bf16 v[20:23], v[66:69], v[104:111], v70
    v_mfma_f32_16x16x32_bf16 v[112:115], v[72:75], v[192:195], 0
    s_waitcnt vmcnt(2)
    v_lshlrev_b32_sdwa v104, 3, v122 dst_sel:DWORD dst_unused:UNUSED_PAD src0_sel:DWORD src1_sel:WORD_0
    v_lshlrev_b32_sdwa v106, 3, v122 dst_sel:DWORD dst_unused:UNUSED_PAD src0_sel:DWORD src1_sel:WORD_1
    ds_read_b64 v[104:105], v104
    ds_read_b64 v[106:107], v106
    v_mfma_f32_16x16x32_bf16 v[112:115], v[76:79], v[196:199], v[112:115]
    v_lshlrev_b32_sdwa v108, 3, v123 dst_sel:DWORD dst_unused:UNUSED_PAD src0_sel:DWORD src1_sel:WORD_0
    v_lshlrev_b32_sdwa v110, 3, v123 dst_sel:DWORD dst_unused:UNUSED_PAD src0_sel:DWORD src1_sel:WORD_1
    v_cvt_pk_bf16_f32 v23, v22, v23
    v_cvt_pk_bf16_f32 v22, v20, v21
    v_and_b32 v21, s23, v19
    v_lshlrev_b32 v20, 16, v19
    v_and_b32 v19, s23, v18
    v_lshlrev_b32 v18, 16, v18
    ds_read_b64 v[108:109], v108
    ds_read_b64 v[110:111], v110
    s_waitcnt lgkmcnt(9)
    v_smfmac_f32_16x16x64_bf16 v[18:21], v[66:69], v[88:95], v70
    v_mfma_f32_16x16x32_bf16 v[112:115], v[80:83], v[200:203], v[112:115]
    v_lshlrev_b32_sdwa v88, 3, v120 dst_sel:DWORD dst_unused:UNUSED_PAD src0_sel:DWORD src1_sel:WORD_0
    v_lshlrev_b32_sdwa v90, 3, v120 dst_sel:DWORD dst_unused:UNUSED_PAD src0_sel:DWORD src1_sel:WORD_1
    ds_read_b64 v[88:89], v88
    ds_read_b64 v[90:91], v90
    v_mfma_f32_16x16x32_bf16 v[112:115], v[84:87], v[204:207], v[112:115]
    v_lshlrev_b32_sdwa v92, 3, v121 dst_sel:DWORD dst_unused:UNUSED_PAD src0_sel:DWORD src1_sel:WORD_0
    v_lshlrev_b32_sdwa v94, 3, v121 dst_sel:DWORD dst_unused:UNUSED_PAD src0_sel:DWORD src1_sel:WORD_1
    ds_read_b64 v[92:93], v92
    ds_read_b64 v[94:95], v94
    buffer_load_dwordx4 v[120:123], v71, s[12:15], s20 offen offset:1024 sc1
    s_waitcnt lgkmcnt(8)
    v_smfmac_f32_16x16x64_bf16 v[18:21], v[66:69], v[96:103], v70
    s_nop 0
    v_cvt_pk_bf16_f32 v112, v112, v113
    v_cvt_pk_bf16_f32 v113, v114, v115
    v_lshlrev_b32_sdwa v114, 3, v70 dst_sel:DWORD dst_unused:UNUSED_PAD src0_sel:DWORD src1_sel:WORD_1
    ds_write_b64 v114, v[112:113] offset:512
    s_waitcnt vmcnt(2)
    v_lshlrev_b32_sdwa v96, 3, v126 dst_sel:DWORD dst_unused:UNUSED_PAD src0_sel:DWORD src1_sel:WORD_0
    v_lshlrev_b32_sdwa v98, 3, v126 dst_sel:DWORD dst_unused:UNUSED_PAD src0_sel:DWORD src1_sel:WORD_1
    ds_read_b64 v[96:97], v96
    ds_read_b64 v[98:99], v98
    v_lshlrev_b32_sdwa v100, 3, v127 dst_sel:DWORD dst_unused:UNUSED_PAD src0_sel:DWORD src1_sel:WORD_0
    v_lshlrev_b32_sdwa v102, 3, v127 dst_sel:DWORD dst_unused:UNUSED_PAD src0_sel:DWORD src1_sel:WORD_1
    v_cvt_pk_bf16_f32 v21, v20, v21
    v_cvt_pk_bf16_f32 v20, v18, v19
    v_and_b32 v19, s23, v17
    v_lshlrev_b32 v18, 16, v17
    v_and_b32 v17, s23, v16
    v_lshlrev_b32 v16, 16, v16
    ds_read_b64 v[100:101], v100
    ds_read_b64 v[102:103], v102
    s_waitcnt lgkmcnt(9)
    v_smfmac_f32_16x16x64_bf16 v[16:19], v[66:69], v[104:111], v70
    s_setprio 2
    v_mfma_f32_16x16x32_bf16 v[112:115], v[72:75], v[208:211], 0
    v_lshlrev_b32_sdwa v104, 3, v124 dst_sel:DWORD dst_unused:UNUSED_PAD src0_sel:DWORD src1_sel:WORD_0
    v_lshlrev_b32_sdwa v106, 3, v124 dst_sel:DWORD dst_unused:UNUSED_PAD src0_sel:DWORD src1_sel:WORD_1
    ds_read_b64 v[104:105], v104
    ds_read_b64 v[106:107], v106
    v_mfma_f32_16x16x32_bf16 v[112:115], v[76:79], v[212:215], v[112:115]
    v_lshlrev_b32_sdwa v108, 3, v125 dst_sel:DWORD dst_unused:UNUSED_PAD src0_sel:DWORD src1_sel:WORD_0
    v_lshlrev_b32_sdwa v110, 3, v125 dst_sel:DWORD dst_unused:UNUSED_PAD src0_sel:DWORD src1_sel:WORD_1
    ds_read_b64 v[108:109], v108
    ds_read_b64 v[110:111], v110
    buffer_load_dwordx4 v[124:127], v71, s[12:15], s20 offen offset:0 sc1
    s_waitcnt lgkmcnt(9)
    v_smfmac_f32_16x16x64_bf16 v[16:19], v[66:69], v[88:95], v70
    v_mfma_f32_16x16x32_bf16 v[112:115], v[80:83], v[216:219], v[112:115]
    s_waitcnt vmcnt(2)
    v_lshlrev_b32_sdwa v88, 3, v118 dst_sel:DWORD dst_unused:UNUSED_PAD src0_sel:DWORD src1_sel:WORD_0
    v_lshlrev_b32_sdwa v90, 3, v118 dst_sel:DWORD dst_unused:UNUSED_PAD src0_sel:DWORD src1_sel:WORD_1
    ds_read_b64 v[88:89], v88
    ds_read_b64 v[90:91], v90
    v_mfma_f32_16x16x32_bf16 v[112:115], v[84:87], v[220:223], v[112:115]
    v_lshlrev_b32_sdwa v92, 3, v119 dst_sel:DWORD dst_unused:UNUSED_PAD src0_sel:DWORD src1_sel:WORD_0
    v_lshlrev_b32_sdwa v94, 3, v119 dst_sel:DWORD dst_unused:UNUSED_PAD src0_sel:DWORD src1_sel:WORD_1
    v_cvt_pk_bf16_f32 v19, v18, v19
    v_cvt_pk_bf16_f32 v18, v16, v17
    v_and_b32 v17, s23, v15
    v_lshlrev_b32 v16, 16, v15
    v_and_b32 v15, s23, v14
    v_lshlrev_b32 v14, 16, v14
    ds_read_b64 v[92:93], v92
    ds_read_b64 v[94:95], v94
    s_waitcnt lgkmcnt(8)
    v_smfmac_f32_16x16x64_bf16 v[14:17], v[66:69], v[96:103], v70
    v_cvt_pk_bf16_f32 v112, v112, v113
    v_cvt_pk_bf16_f32 v113, v114, v115
    v_lshlrev_b32_sdwa v114, 3, v70 dst_sel:DWORD dst_unused:UNUSED_PAD src0_sel:DWORD src1_sel:WORD_1
    ds_write_b64 v114, v[112:113] offset:640
    v_lshlrev_b32_sdwa v96, 3, v116 dst_sel:DWORD dst_unused:UNUSED_PAD src0_sel:DWORD src1_sel:WORD_0
    v_lshlrev_b32_sdwa v98, 3, v116 dst_sel:DWORD dst_unused:UNUSED_PAD src0_sel:DWORD src1_sel:WORD_1
    ds_read_b64 v[96:97], v96
    ds_read_b64 v[98:99], v98
    v_lshlrev_b32_sdwa v100, 3, v117 dst_sel:DWORD dst_unused:UNUSED_PAD src0_sel:DWORD src1_sel:WORD_0
    v_lshlrev_b32_sdwa v102, 3, v117 dst_sel:DWORD dst_unused:UNUSED_PAD src0_sel:DWORD src1_sel:WORD_1
    ds_read_b64 v[100:101], v100
    ds_read_b64 v[102:103], v102
    s_add_u32 s20, s20, 0xfffff000
    buffer_load_dwordx4 v[116:119], v71, s[12:15], s20 offen offset:3072 sc1
    s_waitcnt lgkmcnt(9)
    v_smfmac_f32_16x16x64_bf16 v[14:17], v[66:69], v[104:111], v70
    v_mfma_f32_16x16x32_bf16 v[112:115], v[72:75], v[224:227], 0
    s_waitcnt vmcnt(2)
    v_lshlrev_b32_sdwa v104, 3, v122 dst_sel:DWORD dst_unused:UNUSED_PAD src0_sel:DWORD src1_sel:WORD_0
    v_lshlrev_b32_sdwa v106, 3, v122 dst_sel:DWORD dst_unused:UNUSED_PAD src0_sel:DWORD src1_sel:WORD_1
    ds_read_b64 v[104:105], v104
    ds_read_b64 v[106:107], v106
    v_mfma_f32_16x16x32_bf16 v[112:115], v[76:79], v[228:231], v[112:115]
    v_lshlrev_b32_sdwa v108, 3, v123 dst_sel:DWORD dst_unused:UNUSED_PAD src0_sel:DWORD src1_sel:WORD_0
    v_lshlrev_b32_sdwa v110, 3, v123 dst_sel:DWORD dst_unused:UNUSED_PAD src0_sel:DWORD src1_sel:WORD_1
    v_cvt_pk_bf16_f32 v17, v16, v17
    v_cvt_pk_bf16_f32 v16, v14, v15
    v_and_b32 v15, s23, v13
    v_lshlrev_b32 v14, 16, v13
    v_and_b32 v13, s23, v12
    v_lshlrev_b32 v12, 16, v12
    ds_read_b64 v[108:109], v108
    ds_read_b64 v[110:111], v110
    s_waitcnt lgkmcnt(9)
    v_smfmac_f32_16x16x64_bf16 v[12:15], v[66:69], v[88:95], v70
    v_mfma_f32_16x16x32_bf16 v[112:115], v[80:83], v[232:235], v[112:115]
    v_lshlrev_b32_sdwa v88, 3, v120 dst_sel:DWORD dst_unused:UNUSED_PAD src0_sel:DWORD src1_sel:WORD_0
    v_lshlrev_b32_sdwa v90, 3, v120 dst_sel:DWORD dst_unused:UNUSED_PAD src0_sel:DWORD src1_sel:WORD_1
    ds_read_b64 v[88:89], v88
    ds_read_b64 v[90:91], v90
    v_mfma_f32_16x16x32_bf16 v[112:115], v[84:87], v[236:239], v[112:115]
    v_lshlrev_b32_sdwa v92, 3, v121 dst_sel:DWORD dst_unused:UNUSED_PAD src0_sel:DWORD src1_sel:WORD_0
    v_lshlrev_b32_sdwa v94, 3, v121 dst_sel:DWORD dst_unused:UNUSED_PAD src0_sel:DWORD src1_sel:WORD_1
    ds_read_b64 v[92:93], v92
    ds_read_b64 v[94:95], v94
    buffer_load_dwordx4 v[120:123], v71, s[12:15], s20 offen offset:2048 sc1
    s_waitcnt lgkmcnt(8)
    v_smfmac_f32_16x16x64_bf16 v[12:15], v[66:69], v[96:103], v70
    s_nop 0
    v_cvt_pk_bf16_f32 v112, v112, v113
    v_cvt_pk_bf16_f32 v113, v114, v115
    v_lshlrev_b32_sdwa v114, 3, v70 dst_sel:DWORD dst_unused:UNUSED_PAD src0_sel:DWORD src1_sel:WORD_1
    ds_write_b64 v114, v[112:113] offset:768
    s_waitcnt vmcnt(2)
    v_lshlrev_b32_sdwa v96, 3, v126 dst_sel:DWORD dst_unused:UNUSED_PAD src0_sel:DWORD src1_sel:WORD_0
    v_lshlrev_b32_sdwa v98, 3, v126 dst_sel:DWORD dst_unused:UNUSED_PAD src0_sel:DWORD src1_sel:WORD_1
    ds_read_b64 v[96:97], v96
    ds_read_b64 v[98:99], v98
    v_lshlrev_b32_sdwa v100, 3, v127 dst_sel:DWORD dst_unused:UNUSED_PAD src0_sel:DWORD src1_sel:WORD_0
    v_lshlrev_b32_sdwa v102, 3, v127 dst_sel:DWORD dst_unused:UNUSED_PAD src0_sel:DWORD src1_sel:WORD_1
    v_cvt_pk_bf16_f32 v15, v14, v15
    v_cvt_pk_bf16_f32 v14, v12, v13
    v_and_b32 v13, s23, v11
    v_lshlrev_b32 v12, 16, v11
    v_and_b32 v11, s23, v10
    v_lshlrev_b32 v10, 16, v10
    ds_read_b64 v[100:101], v100
    ds_read_b64 v[102:103], v102
    s_waitcnt lgkmcnt(9)
    v_smfmac_f32_16x16x64_bf16 v[10:13], v[66:69], v[104:111], v70
    v_mfma_f32_16x16x32_bf16 v[112:115], v[72:75], v[240:243], 0
    buffer_load_dwordx4 v[72:75], v71, s[12:15], s21 offen offset:0
    v_lshlrev_b32_sdwa v104, 3, v124 dst_sel:DWORD dst_unused:UNUSED_PAD src0_sel:DWORD src1_sel:WORD_0
    v_lshlrev_b32_sdwa v106, 3, v124 dst_sel:DWORD dst_unused:UNUSED_PAD src0_sel:DWORD src1_sel:WORD_1
    ds_read_b64 v[104:105], v104
    ds_read_b64 v[106:107], v106
    v_mfma_f32_16x16x32_bf16 v[112:115], v[76:79], v[244:247], v[112:115]
    buffer_load_dwordx4 v[76:79], v71, s[12:15], s21 offen offset:1024
    v_lshlrev_b32_sdwa v108, 3, v125 dst_sel:DWORD dst_unused:UNUSED_PAD src0_sel:DWORD src1_sel:WORD_0
    v_lshlrev_b32_sdwa v110, 3, v125 dst_sel:DWORD dst_unused:UNUSED_PAD src0_sel:DWORD src1_sel:WORD_1
    ds_read_b64 v[108:109], v108
    ds_read_b64 v[110:111], v110
    buffer_load_dwordx4 v[124:127], v71, s[12:15], s20 offen offset:1024 sc1
    s_waitcnt lgkmcnt(9)
    v_smfmac_f32_16x16x64_bf16 v[10:13], v[66:69], v[88:95], v70
    v_mfma_f32_16x16x32_bf16 v[112:115], v[80:83], v[248:251], v[112:115]
    buffer_load_dwordx4 v[80:83], v71, s[12:15], s19 offen offset:0
    s_waitcnt vmcnt(5)
    v_lshlrev_b32_sdwa v88, 3, v118 dst_sel:DWORD dst_unused:UNUSED_PAD src0_sel:DWORD src1_sel:WORD_0
    v_lshlrev_b32_sdwa v90, 3, v118 dst_sel:DWORD dst_unused:UNUSED_PAD src0_sel:DWORD src1_sel:WORD_1
    ds_read_b64 v[88:89], v88
    ds_read_b64 v[90:91], v90
    v_mfma_f32_16x16x32_bf16 v[112:115], v[84:87], v[252:255], v[112:115]
    buffer_load_dwordx4 v[84:87], v71, s[12:15], s19 offen offset:1024
    s_add_u32 s21, s21, 4096
    s_add_u32 s19, s19, 4096
    v_lshlrev_b32_sdwa v92, 3, v119 dst_sel:DWORD dst_unused:UNUSED_PAD src0_sel:DWORD src1_sel:WORD_0
    v_lshlrev_b32_sdwa v94, 3, v119 dst_sel:DWORD dst_unused:UNUSED_PAD src0_sel:DWORD src1_sel:WORD_1
    v_cvt_pk_bf16_f32 v13, v12, v13
    v_cvt_pk_bf16_f32 v12, v10, v11
    v_and_b32 v11, s23, v9
    v_lshlrev_b32 v10, 16, v9
    v_and_b32 v9, s23, v8
    v_lshlrev_b32 v8, 16, v8
    ds_read_b64 v[92:93], v92
    ds_read_b64 v[94:95], v94
    s_waitcnt lgkmcnt(8)
    v_smfmac_f32_16x16x64_bf16 v[8:11], v[66:69], v[96:103], v70
    v_cvt_pk_bf16_f32 v112, v112, v113
    v_cvt_pk_bf16_f32 v113, v114, v115
    v_lshlrev_b32_sdwa v114, 3, v70 dst_sel:DWORD dst_unused:UNUSED_PAD src0_sel:DWORD src1_sel:WORD_1
    ds_write_b64 v114, v[112:113] offset:896
    s_setprio 1
    v_lshlrev_b32_sdwa v96, 3, v116 dst_sel:DWORD dst_unused:UNUSED_PAD src0_sel:DWORD src1_sel:WORD_0
    v_lshlrev_b32_sdwa v98, 3, v116 dst_sel:DWORD dst_unused:UNUSED_PAD src0_sel:DWORD src1_sel:WORD_1
    ds_read_b64 v[96:97], v96
    ds_read_b64 v[98:99], v98
    v_lshlrev_b32_sdwa v100, 3, v117 dst_sel:DWORD dst_unused:UNUSED_PAD src0_sel:DWORD src1_sel:WORD_0
    v_lshlrev_b32_sdwa v102, 3, v117 dst_sel:DWORD dst_unused:UNUSED_PAD src0_sel:DWORD src1_sel:WORD_1
    ds_read_b64 v[100:101], v100
    ds_read_b64 v[102:103], v102
    buffer_load_dwordx4 v[116:119], v71, s[12:15], s20 offen offset:0 sc1
    s_waitcnt lgkmcnt(9)
    v_smfmac_f32_16x16x64_bf16 v[8:11], v[66:69], v[104:111], v70
    s_waitcnt vmcnt(6)
    v_lshlrev_b32_sdwa v104, 3, v122 dst_sel:DWORD dst_unused:UNUSED_PAD src0_sel:DWORD src1_sel:WORD_0
    v_lshlrev_b32_sdwa v106, 3, v122 dst_sel:DWORD dst_unused:UNUSED_PAD src0_sel:DWORD src1_sel:WORD_1
    ds_read_b64 v[104:105], v104
    ds_read_b64 v[106:107], v106
    v_lshlrev_b32_sdwa v108, 3, v123 dst_sel:DWORD dst_unused:UNUSED_PAD src0_sel:DWORD src1_sel:WORD_0
    v_lshlrev_b32_sdwa v110, 3, v123 dst_sel:DWORD dst_unused:UNUSED_PAD src0_sel:DWORD src1_sel:WORD_1
    s_nop 0
    v_cvt_pk_bf16_f32 v11, v10, v11
    v_cvt_pk_bf16_f32 v10, v8, v9
    v_and_b32 v9, s23, v7
    v_lshlrev_b32 v8, 16, v7
    v_and_b32 v7, s23, v6
    v_lshlrev_b32 v6, 16, v6
    ds_read_b64 v[108:109], v108
    ds_read_b64 v[110:111], v110
    s_waitcnt lgkmcnt(9)
    v_smfmac_f32_16x16x64_bf16 v[6:9], v[66:69], v[88:95], v70
    v_lshlrev_b32_sdwa v88, 3, v120 dst_sel:DWORD dst_unused:UNUSED_PAD src0_sel:DWORD src1_sel:WORD_0
    v_lshlrev_b32_sdwa v90, 3, v120 dst_sel:DWORD dst_unused:UNUSED_PAD src0_sel:DWORD src1_sel:WORD_1
    ds_read_b64 v[88:89], v88
    ds_read_b64 v[90:91], v90
    v_lshlrev_b32_sdwa v92, 3, v121 dst_sel:DWORD dst_unused:UNUSED_PAD src0_sel:DWORD src1_sel:WORD_0
    v_lshlrev_b32_sdwa v94, 3, v121 dst_sel:DWORD dst_unused:UNUSED_PAD src0_sel:DWORD src1_sel:WORD_1
    ds_read_b64 v[92:93], v92
    ds_read_b64 v[94:95], v94
    s_add_u32 s20, s20, 0x23000
    buffer_load_dwordx4 v[120:123], v71, s[12:15], s20 offen offset:3072 sc1
    s_waitcnt lgkmcnt(8)
    v_smfmac_f32_16x16x64_bf16 v[6:9], v[66:69], v[96:103], v70
    s_waitcnt vmcnt(4)
    v_lshlrev_b32_sdwa v96, 3, v126 dst_sel:DWORD dst_unused:UNUSED_PAD src0_sel:DWORD src1_sel:WORD_0
    v_lshlrev_b32_sdwa v98, 3, v126 dst_sel:DWORD dst_unused:UNUSED_PAD src0_sel:DWORD src1_sel:WORD_1
    ds_read_b64 v[96:97], v96
    ds_read_b64 v[98:99], v98
    v_lshlrev_b32_sdwa v100, 3, v127 dst_sel:DWORD dst_unused:UNUSED_PAD src0_sel:DWORD src1_sel:WORD_0
    v_lshlrev_b32_sdwa v102, 3, v127 dst_sel:DWORD dst_unused:UNUSED_PAD src0_sel:DWORD src1_sel:WORD_1
    s_nop 0
    v_cvt_pk_bf16_f32 v9, v8, v9
    v_cvt_pk_bf16_f32 v8, v6, v7
    v_and_b32 v7, s23, v5
    v_lshlrev_b32 v6, 16, v5
    v_and_b32 v5, s23, v4
    v_lshlrev_b32 v4, 16, v4
    ds_read_b64 v[100:101], v100
    ds_read_b64 v[102:103], v102
    s_waitcnt lgkmcnt(8)
    v_smfmac_f32_16x16x64_bf16 v[4:7], v[66:69], v[104:111], v70
    v_lshlrev_b32_sdwa v104, 3, v124 dst_sel:DWORD dst_unused:UNUSED_PAD src0_sel:DWORD src1_sel:WORD_0
    v_lshlrev_b32_sdwa v106, 3, v124 dst_sel:DWORD dst_unused:UNUSED_PAD src0_sel:DWORD src1_sel:WORD_1
    ds_read_b64 v[104:105], v104
    ds_read_b64 v[106:107], v106
    v_lshlrev_b32_sdwa v108, 3, v125 dst_sel:DWORD dst_unused:UNUSED_PAD src0_sel:DWORD src1_sel:WORD_0
    v_lshlrev_b32_sdwa v110, 3, v125 dst_sel:DWORD dst_unused:UNUSED_PAD src0_sel:DWORD src1_sel:WORD_1
    ds_read_b64 v[108:109], v108
    ds_read_b64 v[110:111], v110
    buffer_load_dwordx4 v[124:127], v71, s[12:15], s20 offen offset:2048 sc1
    s_waitcnt lgkmcnt(8)
    v_smfmac_f32_16x16x64_bf16 v[4:7], v[66:69], v[88:95], v70
    s_waitcnt vmcnt(2)
    v_lshlrev_b32_sdwa v88, 3, v118 dst_sel:DWORD dst_unused:UNUSED_PAD src0_sel:DWORD src1_sel:WORD_0
    v_lshlrev_b32_sdwa v90, 3, v118 dst_sel:DWORD dst_unused:UNUSED_PAD src0_sel:DWORD src1_sel:WORD_1
    ds_read_b64 v[88:89], v88
    ds_read_b64 v[90:91], v90
    v_lshlrev_b32_sdwa v92, 3, v119 dst_sel:DWORD dst_unused:UNUSED_PAD src0_sel:DWORD src1_sel:WORD_0
    v_lshlrev_b32_sdwa v94, 3, v119 dst_sel:DWORD dst_unused:UNUSED_PAD src0_sel:DWORD src1_sel:WORD_1
    s_nop 0
    v_cvt_pk_bf16_f32 v7, v6, v7
    v_cvt_pk_bf16_f32 v6, v4, v5
    v_and_b32 v5, s23, v3
    v_lshlrev_b32 v4, 16, v3
    v_and_b32 v3, s23, v2
    v_lshlrev_b32 v2, 16, v2
    ds_read_b64 v[92:93], v92
    ds_read_b64 v[94:95], v94
    s_waitcnt lgkmcnt(8)
    v_smfmac_f32_16x16x64_bf16 v[2:5], v[66:69], v[96:103], v70
    s_setprio 0
    v_lshlrev_b32_sdwa v96, 3, v116 dst_sel:DWORD dst_unused:UNUSED_PAD src0_sel:DWORD src1_sel:WORD_0
    v_lshlrev_b32_sdwa v98, 3, v116 dst_sel:DWORD dst_unused:UNUSED_PAD src0_sel:DWORD src1_sel:WORD_1
    ds_read_b64 v[96:97], v96
    ds_read_b64 v[98:99], v98
    v_lshlrev_b32_sdwa v100, 3, v117 dst_sel:DWORD dst_unused:UNUSED_PAD src0_sel:DWORD src1_sel:WORD_0
    v_lshlrev_b32_sdwa v102, 3, v117 dst_sel:DWORD dst_unused:UNUSED_PAD src0_sel:DWORD src1_sel:WORD_1
    ds_read_b64 v[100:101], v100
    ds_read_b64 v[102:103], v102
    buffer_load_dwordx4 v[116:119], v71, s[12:15], s20 offen offset:1024 sc1
    s_waitcnt lgkmcnt(8)
    v_smfmac_f32_16x16x64_bf16 v[2:5], v[66:69], v[104:111], v70
    s_waitcnt vmcnt(2)
    v_lshlrev_b32_sdwa v104, 3, v120 dst_sel:DWORD dst_unused:UNUSED_PAD src0_sel:DWORD src1_sel:WORD_0
    v_lshlrev_b32_sdwa v106, 3, v120 dst_sel:DWORD dst_unused:UNUSED_PAD src0_sel:DWORD src1_sel:WORD_1
    ds_read_b64 v[104:105], v104
    ds_read_b64 v[106:107], v106
    v_lshlrev_b32_sdwa v108, 3, v121 dst_sel:DWORD dst_unused:UNUSED_PAD src0_sel:DWORD src1_sel:WORD_0
    v_lshlrev_b32_sdwa v110, 3, v121 dst_sel:DWORD dst_unused:UNUSED_PAD src0_sel:DWORD src1_sel:WORD_1
    s_nop 0
    v_cvt_pk_bf16_f32 v5, v4, v5
    v_cvt_pk_bf16_f32 v4, v2, v3
    v_and_b32 v3, s23, v1
    v_lshlrev_b32 v2, 16, v1
    v_and_b32 v1, s23, v0
    v_lshlrev_b32 v0, 16, v0
    ds_read_b64 v[108:109], v108
    ds_read_b64 v[110:111], v110
    s_waitcnt lgkmcnt(8)
    v_smfmac_f32_16x16x64_bf16 v[0:3], v[66:69], v[88:95], v70
    s_barrier
    s_setprio 3
    v_lshlrev_b32_sdwa v88, 3, v122 dst_sel:DWORD dst_unused:UNUSED_PAD src0_sel:DWORD src1_sel:WORD_0
    v_lshlrev_b32_sdwa v90, 3, v122 dst_sel:DWORD dst_unused:UNUSED_PAD src0_sel:DWORD src1_sel:WORD_1
    ds_read_b64 v[88:89], v88
    ds_read_b64 v[90:91], v90
    v_lshlrev_b32_sdwa v92, 3, v123 dst_sel:DWORD dst_unused:UNUSED_PAD src0_sel:DWORD src1_sel:WORD_0
    v_lshlrev_b32_sdwa v94, 3, v123 dst_sel:DWORD dst_unused:UNUSED_PAD src0_sel:DWORD src1_sel:WORD_1
    ds_read_b64 v[92:93], v92
    ds_read_b64 v[94:95], v94
    buffer_load_dwordx4 v[120:123], v71, s[12:15], s20 offen offset:0 sc1
    s_waitcnt lgkmcnt(8)
    v_smfmac_f32_16x16x64_bf16 v[0:3], v[66:69], v[96:103], v70
    v_mfma_f32_16x16x32_bf16 v[112:115], v[72:75], v[128:131], 0
    s_waitcnt vmcnt(2)
    v_lshlrev_b32_sdwa v96, 3, v124 dst_sel:DWORD dst_unused:UNUSED_PAD src0_sel:DWORD src1_sel:WORD_0
    v_lshlrev_b32_sdwa v98, 3, v124 dst_sel:DWORD dst_unused:UNUSED_PAD src0_sel:DWORD src1_sel:WORD_1
    ds_read_b64 v[96:97], v96
    ds_read_b64 v[98:99], v98
    v_mfma_f32_16x16x32_bf16 v[112:115], v[76:79], v[132:135], v[112:115]
    v_add_u32 v70, 0xc0000000, v70
    v_lshlrev_b32_sdwa v100, 3, v125 dst_sel:DWORD dst_unused:UNUSED_PAD src0_sel:DWORD src1_sel:WORD_0
    v_lshlrev_b32_sdwa v102, 3, v125 dst_sel:DWORD dst_unused:UNUSED_PAD src0_sel:DWORD src1_sel:WORD_1
    v_cvt_pk_bf16_f32 v3, v2, v3
    v_cvt_pk_bf16_f32 v2, v0, v1
    v_mov_b64 v[0:1], v[32:33]
    v_lshlrev_b32 v32, 16, v34
    v_and_b32 v33, s23, v34
    v_lshlrev_b32 v34, 16, v35
    v_and_b32 v35, s23, v35
    ds_read_b64 v[100:101], v100
    ds_read_b64 v[102:103], v102
    s_waitcnt lgkmcnt(8)
    v_smfmac_f32_16x16x64_bf16 v[32:35], v[66:69], v[104:111], v70
    v_mfma_f32_16x16x32_bf16 v[112:115], v[80:83], v[136:139], v[112:115]
    v_lshlrev_b32_sdwa v104, 3, v126 dst_sel:DWORD dst_unused:UNUSED_PAD src0_sel:DWORD src1_sel:WORD_0
    v_lshlrev_b32_sdwa v106, 3, v126 dst_sel:DWORD dst_unused:UNUSED_PAD src0_sel:DWORD src1_sel:WORD_1
    ds_read_b64 v[104:105], v104
    ds_read_b64 v[106:107], v106
    v_mfma_f32_16x16x32_bf16 v[112:115], v[84:87], v[140:143], v[112:115]
    v_lshlrev_b32_sdwa v108, 3, v127 dst_sel:DWORD dst_unused:UNUSED_PAD src0_sel:DWORD src1_sel:WORD_0
    v_lshlrev_b32_sdwa v110, 3, v127 dst_sel:DWORD dst_unused:UNUSED_PAD src0_sel:DWORD src1_sel:WORD_1
    ds_read_b64 v[108:109], v108
    ds_read_b64 v[110:111], v110
    s_add_u32 s20, s20, 0xfffff000
    buffer_load_dwordx4 v[124:127], v71, s[12:15], s20 offen offset:3072 sc1
    s_waitcnt lgkmcnt(8)
    v_smfmac_f32_16x16x64_bf16 v[32:35], v[66:69], v[88:95], v70
    v_cvt_pk_bf16_f32 v112, v112, v113
    v_cvt_pk_bf16_f32 v113, v114, v115
    v_lshlrev_b32_sdwa v114, 3, v70 dst_sel:DWORD dst_unused:UNUSED_PAD src0_sel:DWORD src1_sel:WORD_1
    ds_write_b64 v114, v[112:113] offset:0
    s_waitcnt vmcnt(2)
    v_lshlrev_b32_sdwa v88, 3, v116 dst_sel:DWORD dst_unused:UNUSED_PAD src0_sel:DWORD src1_sel:WORD_0
    v_lshlrev_b32_sdwa v90, 3, v116 dst_sel:DWORD dst_unused:UNUSED_PAD src0_sel:DWORD src1_sel:WORD_1
    ds_read_b64 v[88:89], v88
    ds_read_b64 v[90:91], v90
    v_lshlrev_b32_sdwa v92, 3, v117 dst_sel:DWORD dst_unused:UNUSED_PAD src0_sel:DWORD src1_sel:WORD_0
    v_lshlrev_b32_sdwa v94, 3, v117 dst_sel:DWORD dst_unused:UNUSED_PAD src0_sel:DWORD src1_sel:WORD_1
    v_cvt_pk_bf16_f32 v32, v32, v33
    v_cvt_pk_bf16_f32 v33, v34, v35
    v_lshlrev_b32 v34, 16, v36
    v_and_b32 v35, s23, v36
    v_lshlrev_b32 v36, 16, v37
    v_and_b32 v37, s23, v37
    ds_read_b64 v[92:93], v92
    ds_read_b64 v[94:95], v94
    s_waitcnt lgkmcnt(9)
    v_smfmac_f32_16x16x64_bf16 v[34:37], v[66:69], v[96:103], v70
    v_mfma_f32_16x16x32_bf16 v[112:115], v[72:75], v[144:147], 0
    v_lshlrev_b32_sdwa v96, 3, v118 dst_sel:DWORD dst_unused:UNUSED_PAD src0_sel:DWORD src1_sel:WORD_0
    v_lshlrev_b32_sdwa v98, 3, v118 dst_sel:DWORD dst_unused:UNUSED_PAD src0_sel:DWORD src1_sel:WORD_1
    ds_read_b64 v[96:97], v96
    ds_read_b64 v[98:99], v98
    v_mfma_f32_16x16x32_bf16 v[112:115], v[76:79], v[148:151], v[112:115]
    v_lshlrev_b32_sdwa v100, 3, v119 dst_sel:DWORD dst_unused:UNUSED_PAD src0_sel:DWORD src1_sel:WORD_0
    v_lshlrev_b32_sdwa v102, 3, v119 dst_sel:DWORD dst_unused:UNUSED_PAD src0_sel:DWORD src1_sel:WORD_1
    ds_read_b64 v[100:101], v100
    ds_read_b64 v[102:103], v102
    buffer_load_dwordx4 v[116:119], v71, s[12:15], s20 offen offset:2048 sc1
    s_waitcnt lgkmcnt(9)
    v_smfmac_f32_16x16x64_bf16 v[34:37], v[66:69], v[104:111], v70
    v_mfma_f32_16x16x32_bf16 v[112:115], v[80:83], v[152:155], v[112:115]
    s_waitcnt vmcnt(2)
    v_lshlrev_b32_sdwa v104, 3, v120 dst_sel:DWORD dst_unused:UNUSED_PAD src0_sel:DWORD src1_sel:WORD_0
    v_lshlrev_b32_sdwa v106, 3, v120 dst_sel:DWORD dst_unused:UNUSED_PAD src0_sel:DWORD src1_sel:WORD_1
    ds_read_b64 v[104:105], v104
    ds_read_b64 v[106:107], v106
    v_mfma_f32_16x16x32_bf16 v[112:115], v[84:87], v[156:159], v[112:115]
    v_lshlrev_b32_sdwa v108, 3, v121 dst_sel:DWORD dst_unused:UNUSED_PAD src0_sel:DWORD src1_sel:WORD_0
    v_lshlrev_b32_sdwa v110, 3, v121 dst_sel:DWORD dst_unused:UNUSED_PAD src0_sel:DWORD src1_sel:WORD_1
    v_cvt_pk_bf16_f32 v34, v34, v35
    v_cvt_pk_bf16_f32 v35, v36, v37
    v_lshlrev_b32 v36, 16, v38
    v_and_b32 v37, s23, v38
    v_lshlrev_b32 v38, 16, v39
    v_and_b32 v39, s23, v39
    ds_read_b64 v[108:109], v108
    ds_read_b64 v[110:111], v110
    s_waitcnt lgkmcnt(8)
    v_smfmac_f32_16x16x64_bf16 v[36:39], v[66:69], v[88:95], v70
    v_cvt_pk_bf16_f32 v112, v112, v113
    v_cvt_pk_bf16_f32 v113, v114, v115
    v_lshlrev_b32_sdwa v114, 3, v70 dst_sel:DWORD dst_unused:UNUSED_PAD src0_sel:DWORD src1_sel:WORD_1
    ds_write_b64 v114, v[112:113] offset:128
    v_lshlrev_b32_sdwa v88, 3, v122 dst_sel:DWORD dst_unused:UNUSED_PAD src0_sel:DWORD src1_sel:WORD_0
    v_lshlrev_b32_sdwa v90, 3, v122 dst_sel:DWORD dst_unused:UNUSED_PAD src0_sel:DWORD src1_sel:WORD_1
    ds_read_b64 v[88:89], v88
    ds_read_b64 v[90:91], v90
    v_lshlrev_b32_sdwa v92, 3, v123 dst_sel:DWORD dst_unused:UNUSED_PAD src0_sel:DWORD src1_sel:WORD_0
    v_lshlrev_b32_sdwa v94, 3, v123 dst_sel:DWORD dst_unused:UNUSED_PAD src0_sel:DWORD src1_sel:WORD_1
    ds_read_b64 v[92:93], v92
    ds_read_b64 v[94:95], v94
    buffer_load_dwordx4 v[120:123], v71, s[12:15], s20 offen offset:1024 sc1
    s_waitcnt lgkmcnt(9)
    v_smfmac_f32_16x16x64_bf16 v[36:39], v[66:69], v[96:103], v70
    v_mfma_f32_16x16x32_bf16 v[112:115], v[72:75], v[160:163], 0
    s_waitcnt vmcnt(2)
    v_lshlrev_b32_sdwa v96, 3, v124 dst_sel:DWORD dst_unused:UNUSED_PAD src0_sel:DWORD src1_sel:WORD_0
    v_lshlrev_b32_sdwa v98, 3, v124 dst_sel:DWORD dst_unused:UNUSED_PAD src0_sel:DWORD src1_sel:WORD_1
    ds_read_b64 v[96:97], v96
    ds_read_b64 v[98:99], v98
    v_mfma_f32_16x16x32_bf16 v[112:115], v[76:79], v[164:167], v[112:115]
    v_lshlrev_b32_sdwa v100, 3, v125 dst_sel:DWORD dst_unused:UNUSED_PAD src0_sel:DWORD src1_sel:WORD_0
    v_lshlrev_b32_sdwa v102, 3, v125 dst_sel:DWORD dst_unused:UNUSED_PAD src0_sel:DWORD src1_sel:WORD_1
    v_cvt_pk_bf16_f32 v36, v36, v37
    v_cvt_pk_bf16_f32 v37, v38, v39
    v_lshlrev_b32 v38, 16, v40
    v_and_b32 v39, s23, v40
    v_lshlrev_b32 v40, 16, v41
    v_and_b32 v41, s23, v41
    ds_read_b64 v[100:101], v100
    ds_read_b64 v[102:103], v102
    s_waitcnt lgkmcnt(9)
    v_smfmac_f32_16x16x64_bf16 v[38:41], v[66:69], v[104:111], v70
    v_mfma_f32_16x16x32_bf16 v[112:115], v[80:83], v[168:171], v[112:115]
    v_lshlrev_b32_sdwa v104, 3, v126 dst_sel:DWORD dst_unused:UNUSED_PAD src0_sel:DWORD src1_sel:WORD_0
    v_lshlrev_b32_sdwa v106, 3, v126 dst_sel:DWORD dst_unused:UNUSED_PAD src0_sel:DWORD src1_sel:WORD_1
    ds_read_b64 v[104:105], v104
    ds_read_b64 v[106:107], v106
    v_mfma_f32_16x16x32_bf16 v[112:115], v[84:87], v[172:175], v[112:115]
    v_lshlrev_b32_sdwa v108, 3, v127 dst_sel:DWORD dst_unused:UNUSED_PAD src0_sel:DWORD src1_sel:WORD_0
    v_lshlrev_b32_sdwa v110, 3, v127 dst_sel:DWORD dst_unused:UNUSED_PAD src0_sel:DWORD src1_sel:WORD_1
    ds_read_b64 v[108:109], v108
    ds_read_b64 v[110:111], v110
    buffer_load_dwordx4 v[124:127], v71, s[12:15], s20 offen offset:0 sc1
    s_waitcnt lgkmcnt(8)
    v_smfmac_f32_16x16x64_bf16 v[38:41], v[66:69], v[88:95], v70
    s_nop 0
    v_cvt_pk_bf16_f32 v112, v112, v113
    v_cvt_pk_bf16_f32 v113, v114, v115
    v_lshlrev_b32_sdwa v114, 3, v70 dst_sel:DWORD dst_unused:UNUSED_PAD src0_sel:DWORD src1_sel:WORD_1
    ds_write_b64 v114, v[112:113] offset:256
    s_waitcnt vmcnt(2)
    v_lshlrev_b32_sdwa v88, 3, v116 dst_sel:DWORD dst_unused:UNUSED_PAD src0_sel:DWORD src1_sel:WORD_0
    v_lshlrev_b32_sdwa v90, 3, v116 dst_sel:DWORD dst_unused:UNUSED_PAD src0_sel:DWORD src1_sel:WORD_1
    ds_read_b64 v[88:89], v88
    ds_read_b64 v[90:91], v90
    v_lshlrev_b32_sdwa v92, 3, v117 dst_sel:DWORD dst_unused:UNUSED_PAD src0_sel:DWORD src1_sel:WORD_0
    v_lshlrev_b32_sdwa v94, 3, v117 dst_sel:DWORD dst_unused:UNUSED_PAD src0_sel:DWORD src1_sel:WORD_1
    v_cvt_pk_bf16_f32 v38, v38, v39
    v_cvt_pk_bf16_f32 v39, v40, v41
    v_lshlrev_b32 v40, 16, v42
    v_and_b32 v41, s23, v42
    v_lshlrev_b32 v42, 16, v43
    v_and_b32 v43, s23, v43
    ds_read_b64 v[92:93], v92
    ds_read_b64 v[94:95], v94
    s_waitcnt lgkmcnt(9)
    v_smfmac_f32_16x16x64_bf16 v[40:43], v[66:69], v[96:103], v70
    v_mfma_f32_16x16x32_bf16 v[112:115], v[72:75], v[176:179], 0
    v_lshlrev_b32_sdwa v96, 3, v118 dst_sel:DWORD dst_unused:UNUSED_PAD src0_sel:DWORD src1_sel:WORD_0
    v_lshlrev_b32_sdwa v98, 3, v118 dst_sel:DWORD dst_unused:UNUSED_PAD src0_sel:DWORD src1_sel:WORD_1
    ds_read_b64 v[96:97], v96
    ds_read_b64 v[98:99], v98
    v_mfma_f32_16x16x32_bf16 v[112:115], v[76:79], v[180:183], v[112:115]
    v_lshlrev_b32_sdwa v100, 3, v119 dst_sel:DWORD dst_unused:UNUSED_PAD src0_sel:DWORD src1_sel:WORD_0
    v_lshlrev_b32_sdwa v102, 3, v119 dst_sel:DWORD dst_unused:UNUSED_PAD src0_sel:DWORD src1_sel:WORD_1
    ds_read_b64 v[100:101], v100
    ds_read_b64 v[102:103], v102
    s_add_u32 s20, s20, 0xfffff000
    buffer_load_dwordx4 v[116:119], v71, s[12:15], s20 offen offset:3072 sc1
    s_waitcnt lgkmcnt(9)
    v_smfmac_f32_16x16x64_bf16 v[40:43], v[66:69], v[104:111], v70
    v_mfma_f32_16x16x32_bf16 v[112:115], v[80:83], v[184:187], v[112:115]
    s_waitcnt vmcnt(2)
    v_lshlrev_b32_sdwa v104, 3, v120 dst_sel:DWORD dst_unused:UNUSED_PAD src0_sel:DWORD src1_sel:WORD_0
    v_lshlrev_b32_sdwa v106, 3, v120 dst_sel:DWORD dst_unused:UNUSED_PAD src0_sel:DWORD src1_sel:WORD_1
    ds_read_b64 v[104:105], v104
    ds_read_b64 v[106:107], v106
    v_mfma_f32_16x16x32_bf16 v[112:115], v[84:87], v[188:191], v[112:115]
    v_lshlrev_b32_sdwa v108, 3, v121 dst_sel:DWORD dst_unused:UNUSED_PAD src0_sel:DWORD src1_sel:WORD_0
    v_lshlrev_b32_sdwa v110, 3, v121 dst_sel:DWORD dst_unused:UNUSED_PAD src0_sel:DWORD src1_sel:WORD_1
    v_cvt_pk_bf16_f32 v40, v40, v41
    v_cvt_pk_bf16_f32 v41, v42, v43
    v_lshlrev_b32 v42, 16, v44
    v_and_b32 v43, s23, v44
    v_lshlrev_b32 v44, 16, v45
    v_and_b32 v45, s23, v45
    ds_read_b64 v[108:109], v108
    ds_read_b64 v[110:111], v110
    s_waitcnt lgkmcnt(8)
    v_smfmac_f32_16x16x64_bf16 v[42:45], v[66:69], v[88:95], v70
    v_cvt_pk_bf16_f32 v112, v112, v113
    v_cvt_pk_bf16_f32 v113, v114, v115
    v_lshlrev_b32_sdwa v114, 3, v70 dst_sel:DWORD dst_unused:UNUSED_PAD src0_sel:DWORD src1_sel:WORD_1
    ds_write_b64 v114, v[112:113] offset:384
    v_lshlrev_b32_sdwa v88, 3, v122 dst_sel:DWORD dst_unused:UNUSED_PAD src0_sel:DWORD src1_sel:WORD_0
    v_lshlrev_b32_sdwa v90, 3, v122 dst_sel:DWORD dst_unused:UNUSED_PAD src0_sel:DWORD src1_sel:WORD_1
    ds_read_b64 v[88:89], v88
    ds_read_b64 v[90:91], v90
    v_lshlrev_b32_sdwa v92, 3, v123 dst_sel:DWORD dst_unused:UNUSED_PAD src0_sel:DWORD src1_sel:WORD_0
    v_lshlrev_b32_sdwa v94, 3, v123 dst_sel:DWORD dst_unused:UNUSED_PAD src0_sel:DWORD src1_sel:WORD_1
    ds_read_b64 v[92:93], v92
    ds_read_b64 v[94:95], v94
    buffer_load_dwordx4 v[120:123], v71, s[12:15], s20 offen offset:2048 sc1
    s_waitcnt lgkmcnt(9)
    v_smfmac_f32_16x16x64_bf16 v[42:45], v[66:69], v[96:103], v70
    v_mfma_f32_16x16x32_bf16 v[112:115], v[72:75], v[192:195], 0
    s_waitcnt vmcnt(2)
    v_lshlrev_b32_sdwa v96, 3, v124 dst_sel:DWORD dst_unused:UNUSED_PAD src0_sel:DWORD src1_sel:WORD_0
    v_lshlrev_b32_sdwa v98, 3, v124 dst_sel:DWORD dst_unused:UNUSED_PAD src0_sel:DWORD src1_sel:WORD_1
    ds_read_b64 v[96:97], v96
    ds_read_b64 v[98:99], v98
    v_mfma_f32_16x16x32_bf16 v[112:115], v[76:79], v[196:199], v[112:115]
    v_lshlrev_b32_sdwa v100, 3, v125 dst_sel:DWORD dst_unused:UNUSED_PAD src0_sel:DWORD src1_sel:WORD_0
    v_lshlrev_b32_sdwa v102, 3, v125 dst_sel:DWORD dst_unused:UNUSED_PAD src0_sel:DWORD src1_sel:WORD_1
    v_cvt_pk_bf16_f32 v42, v42, v43
    v_cvt_pk_bf16_f32 v43, v44, v45
    v_lshlrev_b32 v44, 16, v46
    v_and_b32 v45, s23, v46
    v_lshlrev_b32 v46, 16, v47
    v_and_b32 v47, s23, v47
    ds_read_b64 v[100:101], v100
    ds_read_b64 v[102:103], v102
    s_waitcnt lgkmcnt(9)
    v_smfmac_f32_16x16x64_bf16 v[44:47], v[66:69], v[104:111], v70
    v_mfma_f32_16x16x32_bf16 v[112:115], v[80:83], v[200:203], v[112:115]
    v_lshlrev_b32_sdwa v104, 3, v126 dst_sel:DWORD dst_unused:UNUSED_PAD src0_sel:DWORD src1_sel:WORD_0
    v_lshlrev_b32_sdwa v106, 3, v126 dst_sel:DWORD dst_unused:UNUSED_PAD src0_sel:DWORD src1_sel:WORD_1
    ds_read_b64 v[104:105], v104
    ds_read_b64 v[106:107], v106
    v_mfma_f32_16x16x32_bf16 v[112:115], v[84:87], v[204:207], v[112:115]
    v_lshlrev_b32_sdwa v108, 3, v127 dst_sel:DWORD dst_unused:UNUSED_PAD src0_sel:DWORD src1_sel:WORD_0
    v_lshlrev_b32_sdwa v110, 3, v127 dst_sel:DWORD dst_unused:UNUSED_PAD src0_sel:DWORD src1_sel:WORD_1
    ds_read_b64 v[108:109], v108
    ds_read_b64 v[110:111], v110
    buffer_load_dwordx4 v[124:127], v71, s[12:15], s20 offen offset:1024 sc1
    s_waitcnt lgkmcnt(8)
    v_smfmac_f32_16x16x64_bf16 v[44:47], v[66:69], v[88:95], v70
    s_nop 0
    v_cvt_pk_bf16_f32 v112, v112, v113
    v_cvt_pk_bf16_f32 v113, v114, v115
    v_lshlrev_b32_sdwa v114, 3, v70 dst_sel:DWORD dst_unused:UNUSED_PAD src0_sel:DWORD src1_sel:WORD_1
    ds_write_b64 v114, v[112:113] offset:512
    s_waitcnt vmcnt(2)
    v_lshlrev_b32_sdwa v88, 3, v116 dst_sel:DWORD dst_unused:UNUSED_PAD src0_sel:DWORD src1_sel:WORD_0
    v_lshlrev_b32_sdwa v90, 3, v116 dst_sel:DWORD dst_unused:UNUSED_PAD src0_sel:DWORD src1_sel:WORD_1
    ds_read_b64 v[88:89], v88
    ds_read_b64 v[90:91], v90
    v_lshlrev_b32_sdwa v92, 3, v117 dst_sel:DWORD dst_unused:UNUSED_PAD src0_sel:DWORD src1_sel:WORD_0
    v_lshlrev_b32_sdwa v94, 3, v117 dst_sel:DWORD dst_unused:UNUSED_PAD src0_sel:DWORD src1_sel:WORD_1
    v_cvt_pk_bf16_f32 v44, v44, v45
    v_cvt_pk_bf16_f32 v45, v46, v47
    v_lshlrev_b32 v46, 16, v48
    v_and_b32 v47, s23, v48
    v_lshlrev_b32 v48, 16, v49
    v_and_b32 v49, s23, v49
    ds_read_b64 v[92:93], v92
    ds_read_b64 v[94:95], v94
    s_waitcnt lgkmcnt(9)
    v_smfmac_f32_16x16x64_bf16 v[46:49], v[66:69], v[96:103], v70
    s_setprio 2
    v_mfma_f32_16x16x32_bf16 v[112:115], v[72:75], v[208:211], 0
    v_lshlrev_b32_sdwa v96, 3, v118 dst_sel:DWORD dst_unused:UNUSED_PAD src0_sel:DWORD src1_sel:WORD_0
    v_lshlrev_b32_sdwa v98, 3, v118 dst_sel:DWORD dst_unused:UNUSED_PAD src0_sel:DWORD src1_sel:WORD_1
    ds_read_b64 v[96:97], v96
    ds_read_b64 v[98:99], v98
    v_mfma_f32_16x16x32_bf16 v[112:115], v[76:79], v[212:215], v[112:115]
    v_lshlrev_b32_sdwa v100, 3, v119 dst_sel:DWORD dst_unused:UNUSED_PAD src0_sel:DWORD src1_sel:WORD_0
    v_lshlrev_b32_sdwa v102, 3, v119 dst_sel:DWORD dst_unused:UNUSED_PAD src0_sel:DWORD src1_sel:WORD_1
    ds_read_b64 v[100:101], v100
    ds_read_b64 v[102:103], v102
    buffer_load_dwordx4 v[116:119], v71, s[12:15], s20 offen offset:0 sc1
    s_waitcnt lgkmcnt(9)
    v_smfmac_f32_16x16x64_bf16 v[46:49], v[66:69], v[104:111], v70
    v_mfma_f32_16x16x32_bf16 v[112:115], v[80:83], v[216:219], v[112:115]
    s_waitcnt vmcnt(2)
    v_lshlrev_b32_sdwa v104, 3, v120 dst_sel:DWORD dst_unused:UNUSED_PAD src0_sel:DWORD src1_sel:WORD_0
    v_lshlrev_b32_sdwa v106, 3, v120 dst_sel:DWORD dst_unused:UNUSED_PAD src0_sel:DWORD src1_sel:WORD_1
    ds_read_b64 v[104:105], v104
    ds_read_b64 v[106:107], v106
    v_mfma_f32_16x16x32_bf16 v[112:115], v[84:87], v[220:223], v[112:115]
    v_lshlrev_b32_sdwa v108, 3, v121 dst_sel:DWORD dst_unused:UNUSED_PAD src0_sel:DWORD src1_sel:WORD_0
    v_lshlrev_b32_sdwa v110, 3, v121 dst_sel:DWORD dst_unused:UNUSED_PAD src0_sel:DWORD src1_sel:WORD_1
    v_cvt_pk_bf16_f32 v46, v46, v47
    v_cvt_pk_bf16_f32 v47, v48, v49
    v_lshlrev_b32 v48, 16, v50
    v_and_b32 v49, s23, v50
    v_lshlrev_b32 v50, 16, v51
    v_and_b32 v51, s23, v51
    ds_read_b64 v[108:109], v108
    ds_read_b64 v[110:111], v110
    s_waitcnt lgkmcnt(8)
    v_smfmac_f32_16x16x64_bf16 v[48:51], v[66:69], v[88:95], v70
    v_cvt_pk_bf16_f32 v112, v112, v113
    v_cvt_pk_bf16_f32 v113, v114, v115
    v_lshlrev_b32_sdwa v114, 3, v70 dst_sel:DWORD dst_unused:UNUSED_PAD src0_sel:DWORD src1_sel:WORD_1
    ds_write_b64 v114, v[112:113] offset:640
    v_lshlrev_b32_sdwa v88, 3, v122 dst_sel:DWORD dst_unused:UNUSED_PAD src0_sel:DWORD src1_sel:WORD_0
    v_lshlrev_b32_sdwa v90, 3, v122 dst_sel:DWORD dst_unused:UNUSED_PAD src0_sel:DWORD src1_sel:WORD_1
    ds_read_b64 v[88:89], v88
    ds_read_b64 v[90:91], v90
    v_lshlrev_b32_sdwa v92, 3, v123 dst_sel:DWORD dst_unused:UNUSED_PAD src0_sel:DWORD src1_sel:WORD_0
    v_lshlrev_b32_sdwa v94, 3, v123 dst_sel:DWORD dst_unused:UNUSED_PAD src0_sel:DWORD src1_sel:WORD_1
    ds_read_b64 v[92:93], v92
    ds_read_b64 v[94:95], v94
    s_add_u32 s20, s20, 0xfffff000
    buffer_load_dwordx4 v[120:123], v71, s[12:15], s20 offen offset:3072 sc1
    s_waitcnt lgkmcnt(9)
    v_smfmac_f32_16x16x64_bf16 v[48:51], v[66:69], v[96:103], v70
    v_mfma_f32_16x16x32_bf16 v[112:115], v[72:75], v[224:227], 0
    s_waitcnt vmcnt(2)
    v_lshlrev_b32_sdwa v96, 3, v124 dst_sel:DWORD dst_unused:UNUSED_PAD src0_sel:DWORD src1_sel:WORD_0
    v_lshlrev_b32_sdwa v98, 3, v124 dst_sel:DWORD dst_unused:UNUSED_PAD src0_sel:DWORD src1_sel:WORD_1
    ds_read_b64 v[96:97], v96
    ds_read_b64 v[98:99], v98
    v_mfma_f32_16x16x32_bf16 v[112:115], v[76:79], v[228:231], v[112:115]
    v_lshlrev_b32_sdwa v100, 3, v125 dst_sel:DWORD dst_unused:UNUSED_PAD src0_sel:DWORD src1_sel:WORD_0
    v_lshlrev_b32_sdwa v102, 3, v125 dst_sel:DWORD dst_unused:UNUSED_PAD src0_sel:DWORD src1_sel:WORD_1
    v_cvt_pk_bf16_f32 v48, v48, v49
    v_cvt_pk_bf16_f32 v49, v50, v51
    v_lshlrev_b32 v50, 16, v52
    v_and_b32 v51, s23, v52
    v_lshlrev_b32 v52, 16, v53
    v_and_b32 v53, s23, v53
    ds_read_b64 v[100:101], v100
    ds_read_b64 v[102:103], v102
    s_waitcnt lgkmcnt(9)
    v_smfmac_f32_16x16x64_bf16 v[50:53], v[66:69], v[104:111], v70
    v_mfma_f32_16x16x32_bf16 v[112:115], v[80:83], v[232:235], v[112:115]
    v_lshlrev_b32_sdwa v104, 3, v126 dst_sel:DWORD dst_unused:UNUSED_PAD src0_sel:DWORD src1_sel:WORD_0
    v_lshlrev_b32_sdwa v106, 3, v126 dst_sel:DWORD dst_unused:UNUSED_PAD src0_sel:DWORD src1_sel:WORD_1
    ds_read_b64 v[104:105], v104
    ds_read_b64 v[106:107], v106
    v_mfma_f32_16x16x32_bf16 v[112:115], v[84:87], v[236:239], v[112:115]
    v_lshlrev_b32_sdwa v108, 3, v127 dst_sel:DWORD dst_unused:UNUSED_PAD src0_sel:DWORD src1_sel:WORD_0
    v_lshlrev_b32_sdwa v110, 3, v127 dst_sel:DWORD dst_unused:UNUSED_PAD src0_sel:DWORD src1_sel:WORD_1
    ds_read_b64 v[108:109], v108
    ds_read_b64 v[110:111], v110
    buffer_load_dwordx4 v[124:127], v71, s[12:15], s20 offen offset:2048 sc1
    s_waitcnt lgkmcnt(8)
    v_smfmac_f32_16x16x64_bf16 v[50:53], v[66:69], v[88:95], v70
    s_nop 0
    v_cvt_pk_bf16_f32 v112, v112, v113
    v_cvt_pk_bf16_f32 v113, v114, v115
    v_lshlrev_b32_sdwa v114, 3, v70 dst_sel:DWORD dst_unused:UNUSED_PAD src0_sel:DWORD src1_sel:WORD_1
    ds_write_b64 v114, v[112:113] offset:768
    s_waitcnt vmcnt(2)
    v_lshlrev_b32_sdwa v88, 3, v116 dst_sel:DWORD dst_unused:UNUSED_PAD src0_sel:DWORD src1_sel:WORD_0
    v_lshlrev_b32_sdwa v90, 3, v116 dst_sel:DWORD dst_unused:UNUSED_PAD src0_sel:DWORD src1_sel:WORD_1
    ds_read_b64 v[88:89], v88
    ds_read_b64 v[90:91], v90
    v_lshlrev_b32_sdwa v92, 3, v117 dst_sel:DWORD dst_unused:UNUSED_PAD src0_sel:DWORD src1_sel:WORD_0
    v_lshlrev_b32_sdwa v94, 3, v117 dst_sel:DWORD dst_unused:UNUSED_PAD src0_sel:DWORD src1_sel:WORD_1
    v_cvt_pk_bf16_f32 v50, v50, v51
    v_cvt_pk_bf16_f32 v51, v52, v53
    v_lshlrev_b32 v52, 16, v54
    v_and_b32 v53, s23, v54
    v_lshlrev_b32 v54, 16, v55
    v_and_b32 v55, s23, v55
    ds_read_b64 v[92:93], v92
    ds_read_b64 v[94:95], v94
    s_waitcnt lgkmcnt(9)
    v_smfmac_f32_16x16x64_bf16 v[52:55], v[66:69], v[96:103], v70
    v_mfma_f32_16x16x32_bf16 v[112:115], v[72:75], v[240:243], 0
    buffer_load_dwordx4 v[72:75], v71, s[12:15], s21 offen offset:0
    v_lshlrev_b32_sdwa v96, 3, v118 dst_sel:DWORD dst_unused:UNUSED_PAD src0_sel:DWORD src1_sel:WORD_0
    v_lshlrev_b32_sdwa v98, 3, v118 dst_sel:DWORD dst_unused:UNUSED_PAD src0_sel:DWORD src1_sel:WORD_1
    ds_read_b64 v[96:97], v96
    ds_read_b64 v[98:99], v98
    v_mfma_f32_16x16x32_bf16 v[112:115], v[76:79], v[244:247], v[112:115]
    buffer_load_dwordx4 v[76:79], v71, s[12:15], s21 offen offset:1024
    v_lshlrev_b32_sdwa v100, 3, v119 dst_sel:DWORD dst_unused:UNUSED_PAD src0_sel:DWORD src1_sel:WORD_0
    v_lshlrev_b32_sdwa v102, 3, v119 dst_sel:DWORD dst_unused:UNUSED_PAD src0_sel:DWORD src1_sel:WORD_1
    ds_read_b64 v[100:101], v100
    ds_read_b64 v[102:103], v102
    buffer_load_dwordx4 v[116:119], v71, s[12:15], s20 offen offset:1024 sc1
    s_waitcnt lgkmcnt(9)
    v_smfmac_f32_16x16x64_bf16 v[52:55], v[66:69], v[104:111], v70
    v_mfma_f32_16x16x32_bf16 v[112:115], v[80:83], v[248:251], v[112:115]
    buffer_load_dwordx4 v[80:83], v71, s[12:15], s19 offen offset:0
    s_waitcnt vmcnt(5)
    v_lshlrev_b32_sdwa v104, 3, v120 dst_sel:DWORD dst_unused:UNUSED_PAD src0_sel:DWORD src1_sel:WORD_0
    v_lshlrev_b32_sdwa v106, 3, v120 dst_sel:DWORD dst_unused:UNUSED_PAD src0_sel:DWORD src1_sel:WORD_1
    ds_read_b64 v[104:105], v104
    ds_read_b64 v[106:107], v106
    v_mfma_f32_16x16x32_bf16 v[112:115], v[84:87], v[252:255], v[112:115]
    buffer_load_dwordx4 v[84:87], v71, s[12:15], s19 offen offset:1024
    s_add_u32 s21, s21, 4096
    s_add_u32 s19, s19, 4096
    v_lshlrev_b32_sdwa v108, 3, v121 dst_sel:DWORD dst_unused:UNUSED_PAD src0_sel:DWORD src1_sel:WORD_0
    v_lshlrev_b32_sdwa v110, 3, v121 dst_sel:DWORD dst_unused:UNUSED_PAD src0_sel:DWORD src1_sel:WORD_1
    v_cvt_pk_bf16_f32 v52, v52, v53
    v_cvt_pk_bf16_f32 v53, v54, v55
    v_lshlrev_b32 v54, 16, v56
    v_and_b32 v55, s23, v56
    v_lshlrev_b32 v56, 16, v57
    v_and_b32 v57, s23, v57
    ds_read_b64 v[108:109], v108
    ds_read_b64 v[110:111], v110
    s_waitcnt lgkmcnt(8)
    v_smfmac_f32_16x16x64_bf16 v[54:57], v[66:69], v[88:95], v70
    v_cvt_pk_bf16_f32 v112, v112, v113
    v_cvt_pk_bf16_f32 v113, v114, v115
    v_lshlrev_b32_sdwa v114, 3, v70 dst_sel:DWORD dst_unused:UNUSED_PAD src0_sel:DWORD src1_sel:WORD_1
    ds_write_b64 v114, v[112:113] offset:896
    s_setprio 1
    v_lshlrev_b32_sdwa v88, 3, v122 dst_sel:DWORD dst_unused:UNUSED_PAD src0_sel:DWORD src1_sel:WORD_0
    v_lshlrev_b32_sdwa v90, 3, v122 dst_sel:DWORD dst_unused:UNUSED_PAD src0_sel:DWORD src1_sel:WORD_1
    ds_read_b64 v[88:89], v88
    ds_read_b64 v[90:91], v90
    v_lshlrev_b32_sdwa v92, 3, v123 dst_sel:DWORD dst_unused:UNUSED_PAD src0_sel:DWORD src1_sel:WORD_0
    v_lshlrev_b32_sdwa v94, 3, v123 dst_sel:DWORD dst_unused:UNUSED_PAD src0_sel:DWORD src1_sel:WORD_1
    ds_read_b64 v[92:93], v92
    ds_read_b64 v[94:95], v94
    buffer_load_dwordx4 v[120:123], v71, s[12:15], s20 offen offset:0 sc1
    s_waitcnt lgkmcnt(9)
    v_smfmac_f32_16x16x64_bf16 v[54:57], v[66:69], v[96:103], v70
    s_waitcnt vmcnt(6)
    v_lshlrev_b32_sdwa v96, 3, v124 dst_sel:DWORD dst_unused:UNUSED_PAD src0_sel:DWORD src1_sel:WORD_0
    v_lshlrev_b32_sdwa v98, 3, v124 dst_sel:DWORD dst_unused:UNUSED_PAD src0_sel:DWORD src1_sel:WORD_1
    ds_read_b64 v[96:97], v96
    ds_read_b64 v[98:99], v98
    v_lshlrev_b32_sdwa v100, 3, v125 dst_sel:DWORD dst_unused:UNUSED_PAD src0_sel:DWORD src1_sel:WORD_0
    v_lshlrev_b32_sdwa v102, 3, v125 dst_sel:DWORD dst_unused:UNUSED_PAD src0_sel:DWORD src1_sel:WORD_1
    s_nop 0
    v_cvt_pk_bf16_f32 v54, v54, v55
    v_cvt_pk_bf16_f32 v55, v56, v57
    v_lshlrev_b32 v56, 16, v58
    v_and_b32 v57, s23, v58
    v_lshlrev_b32 v58, 16, v59
    v_and_b32 v59, s23, v59
    ds_read_b64 v[100:101], v100
    ds_read_b64 v[102:103], v102
    s_waitcnt lgkmcnt(9)
    v_smfmac_f32_16x16x64_bf16 v[56:59], v[66:69], v[104:111], v70
    v_lshlrev_b32_sdwa v104, 3, v126 dst_sel:DWORD dst_unused:UNUSED_PAD src0_sel:DWORD src1_sel:WORD_0
    v_lshlrev_b32_sdwa v106, 3, v126 dst_sel:DWORD dst_unused:UNUSED_PAD src0_sel:DWORD src1_sel:WORD_1
    ds_read_b64 v[104:105], v104
    ds_read_b64 v[106:107], v106
    v_lshlrev_b32_sdwa v108, 3, v127 dst_sel:DWORD dst_unused:UNUSED_PAD src0_sel:DWORD src1_sel:WORD_0
    v_lshlrev_b32_sdwa v110, 3, v127 dst_sel:DWORD dst_unused:UNUSED_PAD src0_sel:DWORD src1_sel:WORD_1
    ds_read_b64 v[108:109], v108
    ds_read_b64 v[110:111], v110
    s_add_u32 s20, s20, 0x22c00
    buffer_load_dwordx4 v[124:127], v71, s[12:15], s20 offen offset:3072 sc1
    s_waitcnt lgkmcnt(8)
    v_smfmac_f32_16x16x64_bf16 v[56:59], v[66:69], v[88:95], v70
    s_waitcnt vmcnt(4)
    v_lshlrev_b32_sdwa v88, 3, v116 dst_sel:DWORD dst_unused:UNUSED_PAD src0_sel:DWORD src1_sel:WORD_0
    v_lshlrev_b32_sdwa v90, 3, v116 dst_sel:DWORD dst_unused:UNUSED_PAD src0_sel:DWORD src1_sel:WORD_1
    ds_read_b64 v[88:89], v88
    ds_read_b64 v[90:91], v90
    v_lshlrev_b32_sdwa v92, 3, v117 dst_sel:DWORD dst_unused:UNUSED_PAD src0_sel:DWORD src1_sel:WORD_0
    v_lshlrev_b32_sdwa v94, 3, v117 dst_sel:DWORD dst_unused:UNUSED_PAD src0_sel:DWORD src1_sel:WORD_1
    s_nop 0
    v_cvt_pk_bf16_f32 v56, v56, v57
    v_cvt_pk_bf16_f32 v57, v58, v59
    v_lshlrev_b32 v58, 16, v60
    v_and_b32 v59, s23, v60
    v_lshlrev_b32 v60, 16, v61
    v_and_b32 v61, s23, v61
    ds_read_b64 v[92:93], v92
    ds_read_b64 v[94:95], v94
    s_waitcnt lgkmcnt(8)
    v_smfmac_f32_16x16x64_bf16 v[58:61], v[66:69], v[96:103], v70
    v_lshlrev_b32_sdwa v96, 3, v118 dst_sel:DWORD dst_unused:UNUSED_PAD src0_sel:DWORD src1_sel:WORD_0
    v_lshlrev_b32_sdwa v98, 3, v118 dst_sel:DWORD dst_unused:UNUSED_PAD src0_sel:DWORD src1_sel:WORD_1
    ds_read_b64 v[96:97], v96
    ds_read_b64 v[98:99], v98
    v_lshlrev_b32_sdwa v100, 3, v119 dst_sel:DWORD dst_unused:UNUSED_PAD src0_sel:DWORD src1_sel:WORD_0
    v_lshlrev_b32_sdwa v102, 3, v119 dst_sel:DWORD dst_unused:UNUSED_PAD src0_sel:DWORD src1_sel:WORD_1
    ds_read_b64 v[100:101], v100
    ds_read_b64 v[102:103], v102
    buffer_load_dwordx4 v[116:119], v71, s[12:15], s20 offen offset:2048 sc1
    s_waitcnt lgkmcnt(8)
    v_smfmac_f32_16x16x64_bf16 v[58:61], v[66:69], v[104:111], v70
    s_waitcnt vmcnt(2)
    v_lshlrev_b32_sdwa v104, 3, v120 dst_sel:DWORD dst_unused:UNUSED_PAD src0_sel:DWORD src1_sel:WORD_0
    v_lshlrev_b32_sdwa v106, 3, v120 dst_sel:DWORD dst_unused:UNUSED_PAD src0_sel:DWORD src1_sel:WORD_1
    ds_read_b64 v[104:105], v104
    ds_read_b64 v[106:107], v106
    v_lshlrev_b32_sdwa v108, 3, v121 dst_sel:DWORD dst_unused:UNUSED_PAD src0_sel:DWORD src1_sel:WORD_0
    v_lshlrev_b32_sdwa v110, 3, v121 dst_sel:DWORD dst_unused:UNUSED_PAD src0_sel:DWORD src1_sel:WORD_1
    s_nop 0
    v_cvt_pk_bf16_f32 v58, v58, v59
    v_cvt_pk_bf16_f32 v59, v60, v61
    v_lshlrev_b32 v60, 16, v62
    v_and_b32 v61, s23, v62
    v_lshlrev_b32 v62, 16, v63
    v_and_b32 v63, s23, v63
    ds_read_b64 v[108:109], v108
    ds_read_b64 v[110:111], v110
    s_waitcnt lgkmcnt(8)
    v_smfmac_f32_16x16x64_bf16 v[60:63], v[66:69], v[88:95], v70
    s_setprio 0
    v_lshlrev_b32_sdwa v88, 3, v122 dst_sel:DWORD dst_unused:UNUSED_PAD src0_sel:DWORD src1_sel:WORD_0
    v_lshlrev_b32_sdwa v90, 3, v122 dst_sel:DWORD dst_unused:UNUSED_PAD src0_sel:DWORD src1_sel:WORD_1
    ds_read_b64 v[88:89], v88
    ds_read_b64 v[90:91], v90
    v_lshlrev_b32_sdwa v92, 3, v123 dst_sel:DWORD dst_unused:UNUSED_PAD src0_sel:DWORD src1_sel:WORD_0
    v_lshlrev_b32_sdwa v94, 3, v123 dst_sel:DWORD dst_unused:UNUSED_PAD src0_sel:DWORD src1_sel:WORD_1
    ds_read_b64 v[92:93], v92
    ds_read_b64 v[94:95], v94
    buffer_load_dwordx4 v[120:123], v71, s[12:15], s20 offen offset:1024 sc1
    s_waitcnt lgkmcnt(8)
    v_smfmac_f32_16x16x64_bf16 v[60:63], v[66:69], v[96:103], v70
    s_waitcnt vmcnt(2)
    v_lshlrev_b32_sdwa v96, 3, v126 dst_sel:DWORD dst_unused:UNUSED_PAD src0_sel:DWORD src1_sel:WORD_0
    v_lshlrev_b32_sdwa v98, 3, v126 dst_sel:DWORD dst_unused:UNUSED_PAD src0_sel:DWORD src1_sel:WORD_1
    ds_read_b64 v[96:97], v96
    ds_read_b64 v[98:99], v98
    v_lshlrev_b32_sdwa v100, 3, v127 dst_sel:DWORD dst_unused:UNUSED_PAD src0_sel:DWORD src1_sel:WORD_0
    v_lshlrev_b32_sdwa v102, 3, v127 dst_sel:DWORD dst_unused:UNUSED_PAD src0_sel:DWORD src1_sel:WORD_1
    s_nop 0
    v_cvt_pk_bf16_f32 v60, v60, v61
    v_cvt_pk_bf16_f32 v61, v62, v63
    v_lshlrev_b32 v62, 16, v64
    v_and_b32 v63, s23, v64
    v_lshlrev_b32 v64, 16, v65
    v_and_b32 v65, s23, v65
    ds_read_b64 v[100:101], v100
    ds_read_b64 v[102:103], v102
    s_waitcnt lgkmcnt(8)
    v_smfmac_f32_16x16x64_bf16 v[62:65], v[66:69], v[104:111], v70
    s_barrier
    s_setprio 3
    v_lshlrev_b32_sdwa v104, 3, v124 dst_sel:DWORD dst_unused:UNUSED_PAD src0_sel:DWORD src1_sel:WORD_0
    v_lshlrev_b32_sdwa v106, 3, v124 dst_sel:DWORD dst_unused:UNUSED_PAD src0_sel:DWORD src1_sel:WORD_1
    ds_read_b64 v[104:105], v104
    ds_read_b64 v[106:107], v106
    v_lshlrev_b32_sdwa v108, 3, v125 dst_sel:DWORD dst_unused:UNUSED_PAD src0_sel:DWORD src1_sel:WORD_0
    v_lshlrev_b32_sdwa v110, 3, v125 dst_sel:DWORD dst_unused:UNUSED_PAD src0_sel:DWORD src1_sel:WORD_1
    ds_read_b64 v[108:109], v108
    ds_read_b64 v[110:111], v110
    buffer_load_dwordx4 v[124:127], v71, s[12:15], s20 offen offset:0 sc1
    s_waitcnt lgkmcnt(8)
    v_smfmac_f32_16x16x64_bf16 v[62:65], v[66:69], v[88:95], v70
    v_mfma_f32_16x16x32_bf16 v[112:115], v[72:75], v[128:131], 0
    s_waitcnt vmcnt(2)
    v_lshlrev_b32_sdwa v88, 3, v118 dst_sel:DWORD dst_unused:UNUSED_PAD src0_sel:DWORD src1_sel:WORD_0
    v_lshlrev_b32_sdwa v90, 3, v118 dst_sel:DWORD dst_unused:UNUSED_PAD src0_sel:DWORD src1_sel:WORD_1
    ds_read_b64 v[88:89], v88
    ds_read_b64 v[90:91], v90
    v_mfma_f32_16x16x32_bf16 v[112:115], v[76:79], v[132:135], v[112:115]
    v_lshlrev_b32_sdwa v92, 3, v119 dst_sel:DWORD dst_unused:UNUSED_PAD src0_sel:DWORD src1_sel:WORD_0
    v_lshlrev_b32_sdwa v94, 3, v119 dst_sel:DWORD dst_unused:UNUSED_PAD src0_sel:DWORD src1_sel:WORD_1
    v_cvt_pk_bf16_f32 v62, v62, v63
    v_cvt_pk_bf16_f32 v63, v64, v65
    v_mov_b64 v[64:65], v[32:33]
    v_and_b32 v33, s23, v31
    v_lshlrev_b32 v32, 16, v31
    v_and_b32 v31, s23, v30
    v_lshlrev_b32 v30, 16, v30
    ds_read_b64 v[92:93], v92
    ds_read_b64 v[94:95], v94
    s_waitcnt lgkmcnt(8)
    v_smfmac_f32_16x16x64_bf16 v[30:33], v[66:69], v[96:103], v70
    v_mfma_f32_16x16x32_bf16 v[112:115], v[80:83], v[136:139], v[112:115]
    v_lshlrev_b32_sdwa v96, 3, v116 dst_sel:DWORD dst_unused:UNUSED_PAD src0_sel:DWORD src1_sel:WORD_0
    v_lshlrev_b32_sdwa v98, 3, v116 dst_sel:DWORD dst_unused:UNUSED_PAD src0_sel:DWORD src1_sel:WORD_1
    ds_read_b64 v[96:97], v96
    ds_read_b64 v[98:99], v98
    v_mfma_f32_16x16x32_bf16 v[112:115], v[84:87], v[140:143], v[112:115]
    v_lshlrev_b32_sdwa v100, 3, v117 dst_sel:DWORD dst_unused:UNUSED_PAD src0_sel:DWORD src1_sel:WORD_0
    v_lshlrev_b32_sdwa v102, 3, v117 dst_sel:DWORD dst_unused:UNUSED_PAD src0_sel:DWORD src1_sel:WORD_1
    ds_read_b64 v[100:101], v100
    ds_read_b64 v[102:103], v102
    s_add_u32 s20, s20, 0xfffff000
    buffer_load_dwordx4 v[116:119], v71, s[12:15], s20 offen offset:3072 sc1
    s_waitcnt lgkmcnt(8)
    v_smfmac_f32_16x16x64_bf16 v[30:33], v[66:69], v[104:111], v70
    v_cvt_pk_bf16_f32 v112, v112, v113
    v_cvt_pk_bf16_f32 v113, v114, v115
    v_lshlrev_b32_sdwa v114, 3, v70 dst_sel:DWORD dst_unused:UNUSED_PAD src0_sel:DWORD src1_sel:WORD_1
    ds_write_b64 v114, v[112:113] offset:32768
    s_waitcnt vmcnt(2)
    v_lshlrev_b32_sdwa v104, 3, v122 dst_sel:DWORD dst_unused:UNUSED_PAD src0_sel:DWORD src1_sel:WORD_0
    v_lshlrev_b32_sdwa v106, 3, v122 dst_sel:DWORD dst_unused:UNUSED_PAD src0_sel:DWORD src1_sel:WORD_1
    ds_read_b64 v[104:105], v104
    ds_read_b64 v[106:107], v106
    v_lshlrev_b32_sdwa v108, 3, v123 dst_sel:DWORD dst_unused:UNUSED_PAD src0_sel:DWORD src1_sel:WORD_0
    v_lshlrev_b32_sdwa v110, 3, v123 dst_sel:DWORD dst_unused:UNUSED_PAD src0_sel:DWORD src1_sel:WORD_1
    v_cvt_pk_bf16_f32 v33, v32, v33
    v_cvt_pk_bf16_f32 v32, v30, v31
    v_and_b32 v31, s23, v29
    v_lshlrev_b32 v30, 16, v29
    v_and_b32 v29, s23, v28
    v_lshlrev_b32 v28, 16, v28
    ds_read_b64 v[108:109], v108
    ds_read_b64 v[110:111], v110
    s_waitcnt lgkmcnt(9)
    v_smfmac_f32_16x16x64_bf16 v[28:31], v[66:69], v[88:95], v70
    v_mfma_f32_16x16x32_bf16 v[112:115], v[72:75], v[144:147], 0
    v_lshlrev_b32_sdwa v88, 3, v120 dst_sel:DWORD dst_unused:UNUSED_PAD src0_sel:DWORD src1_sel:WORD_0
    v_lshlrev_b32_sdwa v90, 3, v120 dst_sel:DWORD dst_unused:UNUSED_PAD src0_sel:DWORD src1_sel:WORD_1
    ds_read_b64 v[88:89], v88
    ds_read_b64 v[90:91], v90
    v_mfma_f32_16x16x32_bf16 v[112:115], v[76:79], v[148:151], v[112:115]
    v_lshlrev_b32_sdwa v92, 3, v121 dst_sel:DWORD dst_unused:UNUSED_PAD src0_sel:DWORD src1_sel:WORD_0
    v_lshlrev_b32_sdwa v94, 3, v121 dst_sel:DWORD dst_unused:UNUSED_PAD src0_sel:DWORD src1_sel:WORD_1
    ds_read_b64 v[92:93], v92
    ds_read_b64 v[94:95], v94
    buffer_load_dwordx4 v[120:123], v71, s[12:15], s20 offen offset:2048 sc1
    s_waitcnt lgkmcnt(9)
    v_smfmac_f32_16x16x64_bf16 v[28:31], v[66:69], v[96:103], v70
    v_mfma_f32_16x16x32_bf16 v[112:115], v[80:83], v[152:155], v[112:115]
    s_waitcnt vmcnt(2)
    v_lshlrev_b32_sdwa v96, 3, v126 dst_sel:DWORD dst_unused:UNUSED_PAD src0_sel:DWORD src1_sel:WORD_0
    v_lshlrev_b32_sdwa v98, 3, v126 dst_sel:DWORD dst_unused:UNUSED_PAD src0_sel:DWORD src1_sel:WORD_1
    ds_read_b64 v[96:97], v96
    ds_read_b64 v[98:99], v98
    v_mfma_f32_16x16x32_bf16 v[112:115], v[84:87], v[156:159], v[112:115]
    v_lshlrev_b32_sdwa v100, 3, v127 dst_sel:DWORD dst_unused:UNUSED_PAD src0_sel:DWORD src1_sel:WORD_0
    v_lshlrev_b32_sdwa v102, 3, v127 dst_sel:DWORD dst_unused:UNUSED_PAD src0_sel:DWORD src1_sel:WORD_1
    v_cvt_pk_bf16_f32 v31, v30, v31
    v_cvt_pk_bf16_f32 v30, v28, v29
    v_and_b32 v29, s23, v27
    v_lshlrev_b32 v28, 16, v27
    v_and_b32 v27, s23, v26
    v_lshlrev_b32 v26, 16, v26
    ds_read_b64 v[100:101], v100
    ds_read_b64 v[102:103], v102
    s_waitcnt lgkmcnt(8)
    v_smfmac_f32_16x16x64_bf16 v[26:29], v[66:69], v[104:111], v70
    v_cvt_pk_bf16_f32 v112, v112, v113
    v_cvt_pk_bf16_f32 v113, v114, v115
    v_lshlrev_b32_sdwa v114, 3, v70 dst_sel:DWORD dst_unused:UNUSED_PAD src0_sel:DWORD src1_sel:WORD_1
    ds_write_b64 v114, v[112:113] offset:32896
    v_lshlrev_b32_sdwa v104, 3, v124 dst_sel:DWORD dst_unused:UNUSED_PAD src0_sel:DWORD src1_sel:WORD_0
    v_lshlrev_b32_sdwa v106, 3, v124 dst_sel:DWORD dst_unused:UNUSED_PAD src0_sel:DWORD src1_sel:WORD_1
    ds_read_b64 v[104:105], v104
    ds_read_b64 v[106:107], v106
    v_lshlrev_b32_sdwa v108, 3, v125 dst_sel:DWORD dst_unused:UNUSED_PAD src0_sel:DWORD src1_sel:WORD_0
    v_lshlrev_b32_sdwa v110, 3, v125 dst_sel:DWORD dst_unused:UNUSED_PAD src0_sel:DWORD src1_sel:WORD_1
    ds_read_b64 v[108:109], v108
    ds_read_b64 v[110:111], v110
    buffer_load_dwordx4 v[124:127], v71, s[12:15], s20 offen offset:1024 sc1
    s_waitcnt lgkmcnt(9)
    v_smfmac_f32_16x16x64_bf16 v[26:29], v[66:69], v[88:95], v70
    v_mfma_f32_16x16x32_bf16 v[112:115], v[72:75], v[160:163], 0
    s_waitcnt vmcnt(2)
    v_lshlrev_b32_sdwa v88, 3, v118 dst_sel:DWORD dst_unused:UNUSED_PAD src0_sel:DWORD src1_sel:WORD_0
    v_lshlrev_b32_sdwa v90, 3, v118 dst_sel:DWORD dst_unused:UNUSED_PAD src0_sel:DWORD src1_sel:WORD_1
    ds_read_b64 v[88:89], v88
    ds_read_b64 v[90:91], v90
    v_mfma_f32_16x16x32_bf16 v[112:115], v[76:79], v[164:167], v[112:115]
    v_lshlrev_b32_sdwa v92, 3, v119 dst_sel:DWORD dst_unused:UNUSED_PAD src0_sel:DWORD src1_sel:WORD_0
    v_lshlrev_b32_sdwa v94, 3, v119 dst_sel:DWORD dst_unused:UNUSED_PAD src0_sel:DWORD src1_sel:WORD_1
    v_cvt_pk_bf16_f32 v29, v28, v29
    v_cvt_pk_bf16_f32 v28, v26, v27
    v_and_b32 v27, s23, v25
    v_lshlrev_b32 v26, 16, v25
    v_and_b32 v25, s23, v24
    v_lshlrev_b32 v24, 16, v24
    ds_read_b64 v[92:93], v92
    ds_read_b64 v[94:95], v94
    s_waitcnt lgkmcnt(9)
    v_smfmac_f32_16x16x64_bf16 v[24:27], v[66:69], v[96:103], v70
    v_mfma_f32_16x16x32_bf16 v[112:115], v[80:83], v[168:171], v[112:115]
    v_lshlrev_b32_sdwa v96, 3, v116 dst_sel:DWORD dst_unused:UNUSED_PAD src0_sel:DWORD src1_sel:WORD_0
    v_lshlrev_b32_sdwa v98, 3, v116 dst_sel:DWORD dst_unused:UNUSED_PAD src0_sel:DWORD src1_sel:WORD_1
    ds_read_b64 v[96:97], v96
    ds_read_b64 v[98:99], v98
    v_mfma_f32_16x16x32_bf16 v[112:115], v[84:87], v[172:175], v[112:115]
    v_lshlrev_b32_sdwa v100, 3, v117 dst_sel:DWORD dst_unused:UNUSED_PAD src0_sel:DWORD src1_sel:WORD_0
    v_lshlrev_b32_sdwa v102, 3, v117 dst_sel:DWORD dst_unused:UNUSED_PAD src0_sel:DWORD src1_sel:WORD_1
    ds_read_b64 v[100:101], v100
    ds_read_b64 v[102:103], v102
    buffer_load_dwordx4 v[116:119], v71, s[12:15], s20 offen offset:0 sc1
    s_waitcnt lgkmcnt(8)
    v_smfmac_f32_16x16x64_bf16 v[24:27], v[66:69], v[104:111], v70
    s_nop 0
    v_cvt_pk_bf16_f32 v112, v112, v113
    v_cvt_pk_bf16_f32 v113, v114, v115
    v_lshlrev_b32_sdwa v114, 3, v70 dst_sel:DWORD dst_unused:UNUSED_PAD src0_sel:DWORD src1_sel:WORD_1
    ds_write_b64 v114, v[112:113] offset:33024
    s_waitcnt vmcnt(2)
    v_lshlrev_b32_sdwa v104, 3, v122 dst_sel:DWORD dst_unused:UNUSED_PAD src0_sel:DWORD src1_sel:WORD_0
    v_lshlrev_b32_sdwa v106, 3, v122 dst_sel:DWORD dst_unused:UNUSED_PAD src0_sel:DWORD src1_sel:WORD_1
    ds_read_b64 v[104:105], v104
    ds_read_b64 v[106:107], v106
    v_lshlrev_b32_sdwa v108, 3, v123 dst_sel:DWORD dst_unused:UNUSED_PAD src0_sel:DWORD src1_sel:WORD_0
    v_lshlrev_b32_sdwa v110, 3, v123 dst_sel:DWORD dst_unused:UNUSED_PAD src0_sel:DWORD src1_sel:WORD_1
    v_cvt_pk_bf16_f32 v27, v26, v27
    v_cvt_pk_bf16_f32 v26, v24, v25
    v_and_b32 v25, s23, v23
    v_lshlrev_b32 v24, 16, v23
    v_and_b32 v23, s23, v22
    v_lshlrev_b32 v22, 16, v22
    ds_read_b64 v[108:109], v108
    ds_read_b64 v[110:111], v110
    s_waitcnt lgkmcnt(9)
    v_smfmac_f32_16x16x64_bf16 v[22:25], v[66:69], v[88:95], v70
    v_mfma_f32_16x16x32_bf16 v[112:115], v[72:75], v[176:179], 0
    v_lshlrev_b32_sdwa v88, 3, v120 dst_sel:DWORD dst_unused:UNUSED_PAD src0_sel:DWORD src1_sel:WORD_0
    v_lshlrev_b32_sdwa v90, 3, v120 dst_sel:DWORD dst_unused:UNUSED_PAD src0_sel:DWORD src1_sel:WORD_1
    ds_read_b64 v[88:89], v88
    ds_read_b64 v[90:91], v90
    v_mfma_f32_16x16x32_bf16 v[112:115], v[76:79], v[180:183], v[112:115]
    v_lshlrev_b32_sdwa v92, 3, v121 dst_sel:DWORD dst_unused:UNUSED_PAD src0_sel:DWORD src1_sel:WORD_0
    v_lshlrev_b32_sdwa v94, 3, v121 dst_sel:DWORD dst_unused:UNUSED_PAD src0_sel:DWORD src1_sel:WORD_1
    ds_read_b64 v[92:93], v92
    ds_read_b64 v[94:95], v94
    s_add_u32 s20, s20, 0xfffff000
    buffer_load_dwordx4 v[120:123], v71, s[12:15], s20 offen offset:3072 sc1
    s_waitcnt lgkmcnt(9)
    v_smfmac_f32_16x16x64_bf16 v[22:25], v[66:69], v[96:103], v70
    v_mfma_f32_16x16x32_bf16 v[112:115], v[80:83], v[184:187], v[112:115]
    s_waitcnt vmcnt(2)
    v_lshlrev_b32_sdwa v96, 3, v126 dst_sel:DWORD dst_unused:UNUSED_PAD src0_sel:DWORD src1_sel:WORD_0
    v_lshlrev_b32_sdwa v98, 3, v126 dst_sel:DWORD dst_unused:UNUSED_PAD src0_sel:DWORD src1_sel:WORD_1
    ds_read_b64 v[96:97], v96
    ds_read_b64 v[98:99], v98
    v_mfma_f32_16x16x32_bf16 v[112:115], v[84:87], v[188:191], v[112:115]
    v_lshlrev_b32_sdwa v100, 3, v127 dst_sel:DWORD dst_unused:UNUSED_PAD src0_sel:DWORD src1_sel:WORD_0
    v_lshlrev_b32_sdwa v102, 3, v127 dst_sel:DWORD dst_unused:UNUSED_PAD src0_sel:DWORD src1_sel:WORD_1
    v_cvt_pk_bf16_f32 v25, v24, v25
    v_cvt_pk_bf16_f32 v24, v22, v23
    v_and_b32 v23, s23, v21
    v_lshlrev_b32 v22, 16, v21
    v_and_b32 v21, s23, v20
    v_lshlrev_b32 v20, 16, v20
    ds_read_b64 v[100:101], v100
    ds_read_b64 v[102:103], v102
    s_waitcnt lgkmcnt(8)
    v_smfmac_f32_16x16x64_bf16 v[20:23], v[66:69], v[104:111], v70
    v_cvt_pk_bf16_f32 v112, v112, v113
    v_cvt_pk_bf16_f32 v113, v114, v115
    v_lshlrev_b32_sdwa v114, 3, v70 dst_sel:DWORD dst_unused:UNUSED_PAD src0_sel:DWORD src1_sel:WORD_1
    ds_write_b64 v114, v[112:113] offset:33152
    v_lshlrev_b32_sdwa v104, 3, v124 dst_sel:DWORD dst_unused:UNUSED_PAD src0_sel:DWORD src1_sel:WORD_0
    v_lshlrev_b32_sdwa v106, 3, v124 dst_sel:DWORD dst_unused:UNUSED_PAD src0_sel:DWORD src1_sel:WORD_1
    ds_read_b64 v[104:105], v104
    ds_read_b64 v[106:107], v106
    v_lshlrev_b32_sdwa v108, 3, v125 dst_sel:DWORD dst_unused:UNUSED_PAD src0_sel:DWORD src1_sel:WORD_0
    v_lshlrev_b32_sdwa v110, 3, v125 dst_sel:DWORD dst_unused:UNUSED_PAD src0_sel:DWORD src1_sel:WORD_1
    ds_read_b64 v[108:109], v108
    ds_read_b64 v[110:111], v110
    buffer_load_dwordx4 v[124:127], v71, s[12:15], s20 offen offset:2048 sc1
    s_waitcnt lgkmcnt(9)
    v_smfmac_f32_16x16x64_bf16 v[20:23], v[66:69], v[88:95], v70
    v_mfma_f32_16x16x32_bf16 v[112:115], v[72:75], v[192:195], 0
    s_waitcnt vmcnt(2)
    v_lshlrev_b32_sdwa v88, 3, v118 dst_sel:DWORD dst_unused:UNUSED_PAD src0_sel:DWORD src1_sel:WORD_0
    v_lshlrev_b32_sdwa v90, 3, v118 dst_sel:DWORD dst_unused:UNUSED_PAD src0_sel:DWORD src1_sel:WORD_1
    ds_read_b64 v[88:89], v88
    ds_read_b64 v[90:91], v90
    v_mfma_f32_16x16x32_bf16 v[112:115], v[76:79], v[196:199], v[112:115]
    v_lshlrev_b32_sdwa v92, 3, v119 dst_sel:DWORD dst_unused:UNUSED_PAD src0_sel:DWORD src1_sel:WORD_0
    v_lshlrev_b32_sdwa v94, 3, v119 dst_sel:DWORD dst_unused:UNUSED_PAD src0_sel:DWORD src1_sel:WORD_1
    v_cvt_pk_bf16_f32 v23, v22, v23
    v_cvt_pk_bf16_f32 v22, v20, v21
    v_and_b32 v21, s23, v19
    v_lshlrev_b32 v20, 16, v19
    v_and_b32 v19, s23, v18
    v_lshlrev_b32 v18, 16, v18
    ds_read_b64 v[92:93], v92
    ds_read_b64 v[94:95], v94
    s_waitcnt lgkmcnt(9)
    v_smfmac_f32_16x16x64_bf16 v[18:21], v[66:69], v[96:103], v70
    v_mfma_f32_16x16x32_bf16 v[112:115], v[80:83], v[200:203], v[112:115]
    v_lshlrev_b32_sdwa v96, 3, v116 dst_sel:DWORD dst_unused:UNUSED_PAD src0_sel:DWORD src1_sel:WORD_0
    v_lshlrev_b32_sdwa v98, 3, v116 dst_sel:DWORD dst_unused:UNUSED_PAD src0_sel:DWORD src1_sel:WORD_1
    ds_read_b64 v[96:97], v96
    ds_read_b64 v[98:99], v98
    v_mfma_f32_16x16x32_bf16 v[112:115], v[84:87], v[204:207], v[112:115]
    v_lshlrev_b32_sdwa v100, 3, v117 dst_sel:DWORD dst_unused:UNUSED_PAD src0_sel:DWORD src1_sel:WORD_0
    v_lshlrev_b32_sdwa v102, 3, v117 dst_sel:DWORD dst_unused:UNUSED_PAD src0_sel:DWORD src1_sel:WORD_1
    ds_read_b64 v[100:101], v100
    ds_read_b64 v[102:103], v102
    buffer_load_dwordx4 v[116:119], v71, s[12:15], s20 offen offset:1024 sc1
    s_waitcnt lgkmcnt(8)
    v_smfmac_f32_16x16x64_bf16 v[18:21], v[66:69], v[104:111], v70
    s_nop 0
    v_cvt_pk_bf16_f32 v112, v112, v113
    v_cvt_pk_bf16_f32 v113, v114, v115
    v_lshlrev_b32_sdwa v114, 3, v70 dst_sel:DWORD dst_unused:UNUSED_PAD src0_sel:DWORD src1_sel:WORD_1
    ds_write_b64 v114, v[112:113] offset:33280
    s_waitcnt vmcnt(2)
    v_lshlrev_b32_sdwa v104, 3, v122 dst_sel:DWORD dst_unused:UNUSED_PAD src0_sel:DWORD src1_sel:WORD_0
    v_lshlrev_b32_sdwa v106, 3, v122 dst_sel:DWORD dst_unused:UNUSED_PAD src0_sel:DWORD src1_sel:WORD_1
    ds_read_b64 v[104:105], v104
    ds_read_b64 v[106:107], v106
    v_lshlrev_b32_sdwa v108, 3, v123 dst_sel:DWORD dst_unused:UNUSED_PAD src0_sel:DWORD src1_sel:WORD_0
    v_lshlrev_b32_sdwa v110, 3, v123 dst_sel:DWORD dst_unused:UNUSED_PAD src0_sel:DWORD src1_sel:WORD_1
    v_cvt_pk_bf16_f32 v21, v20, v21
    v_cvt_pk_bf16_f32 v20, v18, v19
    v_and_b32 v19, s23, v17
    v_lshlrev_b32 v18, 16, v17
    v_and_b32 v17, s23, v16
    v_lshlrev_b32 v16, 16, v16
    ds_read_b64 v[108:109], v108
    ds_read_b64 v[110:111], v110
    s_waitcnt lgkmcnt(9)
    v_smfmac_f32_16x16x64_bf16 v[16:19], v[66:69], v[88:95], v70
    s_setprio 2
    v_mfma_f32_16x16x32_bf16 v[112:115], v[72:75], v[208:211], 0
    v_lshlrev_b32_sdwa v88, 3, v120 dst_sel:DWORD dst_unused:UNUSED_PAD src0_sel:DWORD src1_sel:WORD_0
    v_lshlrev_b32_sdwa v90, 3, v120 dst_sel:DWORD dst_unused:UNUSED_PAD src0_sel:DWORD src1_sel:WORD_1
    ds_read_b64 v[88:89], v88
    ds_read_b64 v[90:91], v90
    v_mfma_f32_16x16x32_bf16 v[112:115], v[76:79], v[212:215], v[112:115]
    v_lshlrev_b32_sdwa v92, 3, v121 dst_sel:DWORD dst_unused:UNUSED_PAD src0_sel:DWORD src1_sel:WORD_0
    v_lshlrev_b32_sdwa v94, 3, v121 dst_sel:DWORD dst_unused:UNUSED_PAD src0_sel:DWORD src1_sel:WORD_1
    ds_read_b64 v[92:93], v92
    ds_read_b64 v[94:95], v94
    buffer_load_dwordx4 v[120:123], v71, s[12:15], s20 offen offset:0 sc1
    s_waitcnt lgkmcnt(9)
    v_smfmac_f32_16x16x64_bf16 v[16:19], v[66:69], v[96:103], v70
    v_mfma_f32_16x16x32_bf16 v[112:115], v[80:83], v[216:219], v[112:115]
    s_waitcnt vmcnt(2)
    v_lshlrev_b32_sdwa v96, 3, v126 dst_sel:DWORD dst_unused:UNUSED_PAD src0_sel:DWORD src1_sel:WORD_0
    v_lshlrev_b32_sdwa v98, 3, v126 dst_sel:DWORD dst_unused:UNUSED_PAD src0_sel:DWORD src1_sel:WORD_1
    ds_read_b64 v[96:97], v96
    ds_read_b64 v[98:99], v98
    v_mfma_f32_16x16x32_bf16 v[112:115], v[84:87], v[220:223], v[112:115]
    v_lshlrev_b32_sdwa v100, 3, v127 dst_sel:DWORD dst_unused:UNUSED_PAD src0_sel:DWORD src1_sel:WORD_0
    v_lshlrev_b32_sdwa v102, 3, v127 dst_sel:DWORD dst_unused:UNUSED_PAD src0_sel:DWORD src1_sel:WORD_1
    v_cvt_pk_bf16_f32 v19, v18, v19
    v_cvt_pk_bf16_f32 v18, v16, v17
    v_and_b32 v17, s23, v15
    v_lshlrev_b32 v16, 16, v15
    v_and_b32 v15, s23, v14
    v_lshlrev_b32 v14, 16, v14
    ds_read_b64 v[100:101], v100
    ds_read_b64 v[102:103], v102
    s_waitcnt lgkmcnt(8)
    v_smfmac_f32_16x16x64_bf16 v[14:17], v[66:69], v[104:111], v70
    v_cvt_pk_bf16_f32 v112, v112, v113
    v_cvt_pk_bf16_f32 v113, v114, v115
    v_lshlrev_b32_sdwa v114, 3, v70 dst_sel:DWORD dst_unused:UNUSED_PAD src0_sel:DWORD src1_sel:WORD_1
    ds_write_b64 v114, v[112:113] offset:33408
    v_lshlrev_b32_sdwa v104, 3, v124 dst_sel:DWORD dst_unused:UNUSED_PAD src0_sel:DWORD src1_sel:WORD_0
    v_lshlrev_b32_sdwa v106, 3, v124 dst_sel:DWORD dst_unused:UNUSED_PAD src0_sel:DWORD src1_sel:WORD_1
    ds_read_b64 v[104:105], v104
    ds_read_b64 v[106:107], v106
    v_lshlrev_b32_sdwa v108, 3, v125 dst_sel:DWORD dst_unused:UNUSED_PAD src0_sel:DWORD src1_sel:WORD_0
    v_lshlrev_b32_sdwa v110, 3, v125 dst_sel:DWORD dst_unused:UNUSED_PAD src0_sel:DWORD src1_sel:WORD_1
    ds_read_b64 v[108:109], v108
    ds_read_b64 v[110:111], v110
    s_add_u32 s20, s20, 0xfffff000
    buffer_load_dwordx4 v[124:127], v71, s[12:15], s20 offen offset:3072 sc1
    s_waitcnt lgkmcnt(9)
    v_smfmac_f32_16x16x64_bf16 v[14:17], v[66:69], v[88:95], v70
    v_mfma_f32_16x16x32_bf16 v[112:115], v[72:75], v[224:227], 0
    s_waitcnt vmcnt(2)
    v_lshlrev_b32_sdwa v88, 3, v118 dst_sel:DWORD dst_unused:UNUSED_PAD src0_sel:DWORD src1_sel:WORD_0
    v_lshlrev_b32_sdwa v90, 3, v118 dst_sel:DWORD dst_unused:UNUSED_PAD src0_sel:DWORD src1_sel:WORD_1
    ds_read_b64 v[88:89], v88
    ds_read_b64 v[90:91], v90
    v_mfma_f32_16x16x32_bf16 v[112:115], v[76:79], v[228:231], v[112:115]
    v_lshlrev_b32_sdwa v92, 3, v119 dst_sel:DWORD dst_unused:UNUSED_PAD src0_sel:DWORD src1_sel:WORD_0
    v_lshlrev_b32_sdwa v94, 3, v119 dst_sel:DWORD dst_unused:UNUSED_PAD src0_sel:DWORD src1_sel:WORD_1
    v_cvt_pk_bf16_f32 v17, v16, v17
    v_cvt_pk_bf16_f32 v16, v14, v15
    v_and_b32 v15, s23, v13
    v_lshlrev_b32 v14, 16, v13
    v_and_b32 v13, s23, v12
    v_lshlrev_b32 v12, 16, v12
    ds_read_b64 v[92:93], v92
    ds_read_b64 v[94:95], v94
    s_waitcnt lgkmcnt(9)
    v_smfmac_f32_16x16x64_bf16 v[12:15], v[66:69], v[96:103], v70
    v_mfma_f32_16x16x32_bf16 v[112:115], v[80:83], v[232:235], v[112:115]
    v_lshlrev_b32_sdwa v96, 3, v116 dst_sel:DWORD dst_unused:UNUSED_PAD src0_sel:DWORD src1_sel:WORD_0
    v_lshlrev_b32_sdwa v98, 3, v116 dst_sel:DWORD dst_unused:UNUSED_PAD src0_sel:DWORD src1_sel:WORD_1
    ds_read_b64 v[96:97], v96
    ds_read_b64 v[98:99], v98
    v_mfma_f32_16x16x32_bf16 v[112:115], v[84:87], v[236:239], v[112:115]
    v_lshlrev_b32_sdwa v100, 3, v117 dst_sel:DWORD dst_unused:UNUSED_PAD src0_sel:DWORD src1_sel:WORD_0
    v_lshlrev_b32_sdwa v102, 3, v117 dst_sel:DWORD dst_unused:UNUSED_PAD src0_sel:DWORD src1_sel:WORD_1
    ds_read_b64 v[100:101], v100
    ds_read_b64 v[102:103], v102
    buffer_load_dwordx4 v[116:119], v71, s[12:15], s20 offen offset:2048 sc1
    s_waitcnt lgkmcnt(8)
    v_smfmac_f32_16x16x64_bf16 v[12:15], v[66:69], v[104:111], v70
    s_nop 0
    v_cvt_pk_bf16_f32 v112, v112, v113
    v_cvt_pk_bf16_f32 v113, v114, v115
    v_lshlrev_b32_sdwa v114, 3, v70 dst_sel:DWORD dst_unused:UNUSED_PAD src0_sel:DWORD src1_sel:WORD_1
    ds_write_b64 v114, v[112:113] offset:33536
    s_waitcnt vmcnt(2)
    v_lshlrev_b32_sdwa v104, 3, v122 dst_sel:DWORD dst_unused:UNUSED_PAD src0_sel:DWORD src1_sel:WORD_0
    v_lshlrev_b32_sdwa v106, 3, v122 dst_sel:DWORD dst_unused:UNUSED_PAD src0_sel:DWORD src1_sel:WORD_1
    ds_read_b64 v[104:105], v104
    ds_read_b64 v[106:107], v106
    v_lshlrev_b32_sdwa v108, 3, v123 dst_sel:DWORD dst_unused:UNUSED_PAD src0_sel:DWORD src1_sel:WORD_0
    v_lshlrev_b32_sdwa v110, 3, v123 dst_sel:DWORD dst_unused:UNUSED_PAD src0_sel:DWORD src1_sel:WORD_1
    v_cvt_pk_bf16_f32 v15, v14, v15
    v_cvt_pk_bf16_f32 v14, v12, v13
    v_and_b32 v13, s23, v11
    v_lshlrev_b32 v12, 16, v11
    v_and_b32 v11, s23, v10
    v_lshlrev_b32 v10, 16, v10
    ds_read_b64 v[108:109], v108
    ds_read_b64 v[110:111], v110
    s_waitcnt lgkmcnt(9)
    v_smfmac_f32_16x16x64_bf16 v[10:13], v[66:69], v[88:95], v70
    v_mfma_f32_16x16x32_bf16 v[112:115], v[72:75], v[240:243], 0
    buffer_load_dwordx4 v[72:75], v71, s[12:15], s21 offen offset:0
    v_lshlrev_b32_sdwa v88, 3, v120 dst_sel:DWORD dst_unused:UNUSED_PAD src0_sel:DWORD src1_sel:WORD_0
    v_lshlrev_b32_sdwa v90, 3, v120 dst_sel:DWORD dst_unused:UNUSED_PAD src0_sel:DWORD src1_sel:WORD_1
    ds_read_b64 v[88:89], v88
    ds_read_b64 v[90:91], v90
    v_mfma_f32_16x16x32_bf16 v[112:115], v[76:79], v[244:247], v[112:115]
    buffer_load_dwordx4 v[76:79], v71, s[12:15], s21 offen offset:1024
    v_lshlrev_b32_sdwa v92, 3, v121 dst_sel:DWORD dst_unused:UNUSED_PAD src0_sel:DWORD src1_sel:WORD_0
    v_lshlrev_b32_sdwa v94, 3, v121 dst_sel:DWORD dst_unused:UNUSED_PAD src0_sel:DWORD src1_sel:WORD_1
    ds_read_b64 v[92:93], v92
    ds_read_b64 v[94:95], v94
    buffer_load_dwordx4 v[120:123], v71, s[12:15], s20 offen offset:1024 sc1
    s_waitcnt lgkmcnt(9)
    v_smfmac_f32_16x16x64_bf16 v[10:13], v[66:69], v[96:103], v70
    v_mfma_f32_16x16x32_bf16 v[112:115], v[80:83], v[248:251], v[112:115]
    buffer_load_dwordx4 v[80:83], v71, s[12:15], s19 offen offset:0
    s_waitcnt vmcnt(5)
    v_lshlrev_b32_sdwa v96, 3, v126 dst_sel:DWORD dst_unused:UNUSED_PAD src0_sel:DWORD src1_sel:WORD_0
    v_lshlrev_b32_sdwa v98, 3, v126 dst_sel:DWORD dst_unused:UNUSED_PAD src0_sel:DWORD src1_sel:WORD_1
    ds_read_b64 v[96:97], v96
    ds_read_b64 v[98:99], v98
    v_mfma_f32_16x16x32_bf16 v[112:115], v[84:87], v[252:255], v[112:115]
    buffer_load_dwordx4 v[84:87], v71, s[12:15], s19 offen offset:1024
    s_add_u32 s21, s21, 4096
    s_add_u32 s19, s19, 4096
    v_lshlrev_b32_sdwa v100, 3, v127 dst_sel:DWORD dst_unused:UNUSED_PAD src0_sel:DWORD src1_sel:WORD_0
    v_lshlrev_b32_sdwa v102, 3, v127 dst_sel:DWORD dst_unused:UNUSED_PAD src0_sel:DWORD src1_sel:WORD_1
    v_cvt_pk_bf16_f32 v13, v12, v13
    v_cvt_pk_bf16_f32 v12, v10, v11
    v_and_b32 v11, s23, v9
    v_lshlrev_b32 v10, 16, v9
    v_and_b32 v9, s23, v8
    v_lshlrev_b32 v8, 16, v8
    ds_read_b64 v[100:101], v100
    ds_read_b64 v[102:103], v102
    s_waitcnt lgkmcnt(8)
    v_smfmac_f32_16x16x64_bf16 v[8:11], v[66:69], v[104:111], v70
    v_cvt_pk_bf16_f32 v112, v112, v113
    v_cvt_pk_bf16_f32 v113, v114, v115
    v_lshlrev_b32_sdwa v114, 3, v70 dst_sel:DWORD dst_unused:UNUSED_PAD src0_sel:DWORD src1_sel:WORD_1
    ds_write_b64 v114, v[112:113] offset:33664
    s_setprio 1
    v_lshlrev_b32_sdwa v104, 3, v124 dst_sel:DWORD dst_unused:UNUSED_PAD src0_sel:DWORD src1_sel:WORD_0
    v_lshlrev_b32_sdwa v106, 3, v124 dst_sel:DWORD dst_unused:UNUSED_PAD src0_sel:DWORD src1_sel:WORD_1
    ds_read_b64 v[104:105], v104
    ds_read_b64 v[106:107], v106
    v_lshlrev_b32_sdwa v108, 3, v125 dst_sel:DWORD dst_unused:UNUSED_PAD src0_sel:DWORD src1_sel:WORD_0
    v_lshlrev_b32_sdwa v110, 3, v125 dst_sel:DWORD dst_unused:UNUSED_PAD src0_sel:DWORD src1_sel:WORD_1
    ds_read_b64 v[108:109], v108
    ds_read_b64 v[110:111], v110
    s_add_u32 s20, s20, 0x4000
    buffer_load_dwordx4 v[124:127], v71, s[12:15], s20 offen offset:0 sc1
    s_waitcnt lgkmcnt(9)
    v_smfmac_f32_16x16x64_bf16 v[8:11], v[66:69], v[88:95], v70
    s_waitcnt vmcnt(6)
    v_lshlrev_b32_sdwa v88, 3, v118 dst_sel:DWORD dst_unused:UNUSED_PAD src0_sel:DWORD src1_sel:WORD_0
    v_lshlrev_b32_sdwa v90, 3, v118 dst_sel:DWORD dst_unused:UNUSED_PAD src0_sel:DWORD src1_sel:WORD_1
    ds_read_b64 v[88:89], v88
    ds_read_b64 v[90:91], v90
    v_lshlrev_b32_sdwa v92, 3, v119 dst_sel:DWORD dst_unused:UNUSED_PAD src0_sel:DWORD src1_sel:WORD_0
    v_lshlrev_b32_sdwa v94, 3, v119 dst_sel:DWORD dst_unused:UNUSED_PAD src0_sel:DWORD src1_sel:WORD_1
    s_nop 0
    v_cvt_pk_bf16_f32 v11, v10, v11
    v_cvt_pk_bf16_f32 v10, v8, v9
    v_and_b32 v9, s23, v7
    v_lshlrev_b32 v8, 16, v7
    v_and_b32 v7, s23, v6
    v_lshlrev_b32 v6, 16, v6
    ds_read_b64 v[92:93], v92
    ds_read_b64 v[94:95], v94
    s_waitcnt lgkmcnt(9)
    v_smfmac_f32_16x16x64_bf16 v[6:9], v[66:69], v[96:103], v70
    v_lshlrev_b32_sdwa v96, 3, v116 dst_sel:DWORD dst_unused:UNUSED_PAD src0_sel:DWORD src1_sel:WORD_0
    v_lshlrev_b32_sdwa v98, 3, v116 dst_sel:DWORD dst_unused:UNUSED_PAD src0_sel:DWORD src1_sel:WORD_1
    ds_read_b64 v[96:97], v96
    ds_read_b64 v[98:99], v98
    v_lshlrev_b32_sdwa v100, 3, v117 dst_sel:DWORD dst_unused:UNUSED_PAD src0_sel:DWORD src1_sel:WORD_0
    v_lshlrev_b32_sdwa v102, 3, v117 dst_sel:DWORD dst_unused:UNUSED_PAD src0_sel:DWORD src1_sel:WORD_1
    ds_read_b64 v[100:101], v100
    ds_read_b64 v[102:103], v102
    s_add_u32 s20, s20, 0x1f000
    buffer_load_dwordx4 v[116:119], v71, s[12:15], s20 offen offset:3072 sc1
    s_waitcnt lgkmcnt(8)
    v_smfmac_f32_16x16x64_bf16 v[6:9], v[66:69], v[104:111], v70
    s_waitcnt vmcnt(4)
    v_lshlrev_b32_sdwa v104, 3, v122 dst_sel:DWORD dst_unused:UNUSED_PAD src0_sel:DWORD src1_sel:WORD_0
    v_lshlrev_b32_sdwa v106, 3, v122 dst_sel:DWORD dst_unused:UNUSED_PAD src0_sel:DWORD src1_sel:WORD_1
    ds_read_b64 v[104:105], v104
    ds_read_b64 v[106:107], v106
    v_lshlrev_b32_sdwa v108, 3, v123 dst_sel:DWORD dst_unused:UNUSED_PAD src0_sel:DWORD src1_sel:WORD_0
    v_lshlrev_b32_sdwa v110, 3, v123 dst_sel:DWORD dst_unused:UNUSED_PAD src0_sel:DWORD src1_sel:WORD_1
    s_nop 0
    v_cvt_pk_bf16_f32 v9, v8, v9
    v_cvt_pk_bf16_f32 v8, v6, v7
    v_and_b32 v7, s23, v5
    v_lshlrev_b32 v6, 16, v5
    v_and_b32 v5, s23, v4
    v_lshlrev_b32 v4, 16, v4
    ds_read_b64 v[108:109], v108
    ds_read_b64 v[110:111], v110
    s_waitcnt lgkmcnt(8)
    v_smfmac_f32_16x16x64_bf16 v[4:7], v[66:69], v[88:95], v70
    v_lshlrev_b32_sdwa v88, 3, v120 dst_sel:DWORD dst_unused:UNUSED_PAD src0_sel:DWORD src1_sel:WORD_0
    v_lshlrev_b32_sdwa v90, 3, v120 dst_sel:DWORD dst_unused:UNUSED_PAD src0_sel:DWORD src1_sel:WORD_1
    ds_read_b64 v[88:89], v88
    ds_read_b64 v[90:91], v90
    v_lshlrev_b32_sdwa v92, 3, v121 dst_sel:DWORD dst_unused:UNUSED_PAD src0_sel:DWORD src1_sel:WORD_0
    v_lshlrev_b32_sdwa v94, 3, v121 dst_sel:DWORD dst_unused:UNUSED_PAD src0_sel:DWORD src1_sel:WORD_1
    ds_read_b64 v[92:93], v92
    ds_read_b64 v[94:95], v94
    buffer_load_dwordx4 v[120:123], v71, s[12:15], s20 offen offset:2048 sc1
    s_waitcnt lgkmcnt(8)
    v_smfmac_f32_16x16x64_bf16 v[4:7], v[66:69], v[96:103], v70
    s_waitcnt vmcnt(2)
    v_lshlrev_b32_sdwa v96, 3, v126 dst_sel:DWORD dst_unused:UNUSED_PAD src0_sel:DWORD src1_sel:WORD_0
    v_lshlrev_b32_sdwa v98, 3, v126 dst_sel:DWORD dst_unused:UNUSED_PAD src0_sel:DWORD src1_sel:WORD_1
    ds_read_b64 v[96:97], v96
    ds_read_b64 v[98:99], v98
    v_lshlrev_b32_sdwa v100, 3, v127 dst_sel:DWORD dst_unused:UNUSED_PAD src0_sel:DWORD src1_sel:WORD_0
    v_lshlrev_b32_sdwa v102, 3, v127 dst_sel:DWORD dst_unused:UNUSED_PAD src0_sel:DWORD src1_sel:WORD_1
    s_nop 0
    v_cvt_pk_bf16_f32 v7, v6, v7
    v_cvt_pk_bf16_f32 v6, v4, v5
    v_and_b32 v5, s23, v3
    v_lshlrev_b32 v4, 16, v3
    v_and_b32 v3, s23, v2
    v_lshlrev_b32 v2, 16, v2
    ds_read_b64 v[100:101], v100
    ds_read_b64 v[102:103], v102
    s_waitcnt lgkmcnt(8)
    v_smfmac_f32_16x16x64_bf16 v[2:5], v[66:69], v[104:111], v70
    s_setprio 0
    v_lshlrev_b32_sdwa v104, 3, v124 dst_sel:DWORD dst_unused:UNUSED_PAD src0_sel:DWORD src1_sel:WORD_0
    v_lshlrev_b32_sdwa v106, 3, v124 dst_sel:DWORD dst_unused:UNUSED_PAD src0_sel:DWORD src1_sel:WORD_1
    ds_read_b64 v[104:105], v104
    ds_read_b64 v[106:107], v106
    v_lshlrev_b32_sdwa v108, 3, v125 dst_sel:DWORD dst_unused:UNUSED_PAD src0_sel:DWORD src1_sel:WORD_0
    v_lshlrev_b32_sdwa v110, 3, v125 dst_sel:DWORD dst_unused:UNUSED_PAD src0_sel:DWORD src1_sel:WORD_1
    ds_read_b64 v[108:109], v108
    ds_read_b64 v[110:111], v110
    buffer_load_dwordx4 v[124:127], v71, s[12:15], s20 offen offset:1024 sc1
    s_waitcnt lgkmcnt(8)
    v_smfmac_f32_16x16x64_bf16 v[2:5], v[66:69], v[88:95], v70
    s_waitcnt vmcnt(2)
    v_lshlrev_b32_sdwa v88, 3, v116 dst_sel:DWORD dst_unused:UNUSED_PAD src0_sel:DWORD src1_sel:WORD_0
    v_lshlrev_b32_sdwa v90, 3, v116 dst_sel:DWORD dst_unused:UNUSED_PAD src0_sel:DWORD src1_sel:WORD_1
    ds_read_b64 v[88:89], v88
    ds_read_b64 v[90:91], v90
    v_lshlrev_b32_sdwa v92, 3, v117 dst_sel:DWORD dst_unused:UNUSED_PAD src0_sel:DWORD src1_sel:WORD_0
    v_lshlrev_b32_sdwa v94, 3, v117 dst_sel:DWORD dst_unused:UNUSED_PAD src0_sel:DWORD src1_sel:WORD_1
    s_nop 0
    v_cvt_pk_bf16_f32 v5, v4, v5
    v_cvt_pk_bf16_f32 v4, v2, v3
    v_and_b32 v3, s23, v1
    v_lshlrev_b32 v2, 16, v1
    v_and_b32 v1, s23, v0
    v_lshlrev_b32 v0, 16, v0
    ds_read_b64 v[92:93], v92
    ds_read_b64 v[94:95], v94
    s_waitcnt lgkmcnt(8)
    v_smfmac_f32_16x16x64_bf16 v[0:3], v[66:69], v[96:103], v70
    s_barrier
    s_setprio 3
    v_lshlrev_b32_sdwa v96, 3, v118 dst_sel:DWORD dst_unused:UNUSED_PAD src0_sel:DWORD src1_sel:WORD_0
    v_lshlrev_b32_sdwa v98, 3, v118 dst_sel:DWORD dst_unused:UNUSED_PAD src0_sel:DWORD src1_sel:WORD_1
    ds_read_b64 v[96:97], v96
    ds_read_b64 v[98:99], v98
    v_lshlrev_b32_sdwa v100, 3, v119 dst_sel:DWORD dst_unused:UNUSED_PAD src0_sel:DWORD src1_sel:WORD_0
    v_lshlrev_b32_sdwa v102, 3, v119 dst_sel:DWORD dst_unused:UNUSED_PAD src0_sel:DWORD src1_sel:WORD_1
    ds_read_b64 v[100:101], v100
    ds_read_b64 v[102:103], v102
    buffer_load_dwordx4 v[116:119], v71, s[12:15], s20 offen offset:0 sc1
    s_waitcnt lgkmcnt(8)
    v_smfmac_f32_16x16x64_bf16 v[0:3], v[66:69], v[104:111], v70
    v_mfma_f32_16x16x32_bf16 v[112:115], v[72:75], v[128:131], 0
    s_waitcnt vmcnt(2)
    v_lshlrev_b32_sdwa v104, 3, v120 dst_sel:DWORD dst_unused:UNUSED_PAD src0_sel:DWORD src1_sel:WORD_0
    v_lshlrev_b32_sdwa v106, 3, v120 dst_sel:DWORD dst_unused:UNUSED_PAD src0_sel:DWORD src1_sel:WORD_1
    ds_read_b64 v[104:105], v104
    ds_read_b64 v[106:107], v106
    v_mfma_f32_16x16x32_bf16 v[112:115], v[76:79], v[132:135], v[112:115]
    v_add_u32 v70, 0x20000000, v70
    v_lshlrev_b32_sdwa v108, 3, v121 dst_sel:DWORD dst_unused:UNUSED_PAD src0_sel:DWORD src1_sel:WORD_0
    v_lshlrev_b32_sdwa v110, 3, v121 dst_sel:DWORD dst_unused:UNUSED_PAD src0_sel:DWORD src1_sel:WORD_1
    v_cvt_pk_bf16_f32 v3, v2, v3
    v_cvt_pk_bf16_f32 v2, v0, v1
    v_mov_b64 v[0:1], v[32:33]
    v_lshlrev_b32 v32, 16, v34
    v_and_b32 v33, s23, v34
    v_lshlrev_b32 v34, 16, v35
    v_and_b32 v35, s23, v35
    ds_read_b64 v[108:109], v108
    ds_read_b64 v[110:111], v110
    s_waitcnt lgkmcnt(8)
    v_smfmac_f32_16x16x64_bf16 v[32:35], v[66:69], v[88:95], v70
    v_mfma_f32_16x16x32_bf16 v[112:115], v[80:83], v[136:139], v[112:115]
    v_lshlrev_b32_sdwa v88, 3, v122 dst_sel:DWORD dst_unused:UNUSED_PAD src0_sel:DWORD src1_sel:WORD_0
    v_lshlrev_b32_sdwa v90, 3, v122 dst_sel:DWORD dst_unused:UNUSED_PAD src0_sel:DWORD src1_sel:WORD_1
    ds_read_b64 v[88:89], v88
    ds_read_b64 v[90:91], v90
    v_mfma_f32_16x16x32_bf16 v[112:115], v[84:87], v[140:143], v[112:115]
    v_lshlrev_b32_sdwa v92, 3, v123 dst_sel:DWORD dst_unused:UNUSED_PAD src0_sel:DWORD src1_sel:WORD_0
    v_lshlrev_b32_sdwa v94, 3, v123 dst_sel:DWORD dst_unused:UNUSED_PAD src0_sel:DWORD src1_sel:WORD_1
    ds_read_b64 v[92:93], v92
    ds_read_b64 v[94:95], v94
    s_add_u32 s20, s20, 0xfffff000
    buffer_load_dwordx4 v[120:123], v71, s[12:15], s20 offen offset:3072 sc1
    s_waitcnt lgkmcnt(8)
    v_smfmac_f32_16x16x64_bf16 v[32:35], v[66:69], v[96:103], v70
    v_cvt_pk_bf16_f32 v112, v112, v113
    v_cvt_pk_bf16_f32 v113, v114, v115
    v_lshlrev_b32_sdwa v114, 3, v70 dst_sel:DWORD dst_unused:UNUSED_PAD src0_sel:DWORD src1_sel:WORD_1
    ds_write_b64 v114, v[112:113] offset:0
    s_waitcnt vmcnt(2)
    v_lshlrev_b32_sdwa v96, 3, v124 dst_sel:DWORD dst_unused:UNUSED_PAD src0_sel:DWORD src1_sel:WORD_0
    v_lshlrev_b32_sdwa v98, 3, v124 dst_sel:DWORD dst_unused:UNUSED_PAD src0_sel:DWORD src1_sel:WORD_1
    ds_read_b64 v[96:97], v96
    ds_read_b64 v[98:99], v98
    v_lshlrev_b32_sdwa v100, 3, v125 dst_sel:DWORD dst_unused:UNUSED_PAD src0_sel:DWORD src1_sel:WORD_0
    v_lshlrev_b32_sdwa v102, 3, v125 dst_sel:DWORD dst_unused:UNUSED_PAD src0_sel:DWORD src1_sel:WORD_1
    v_cvt_pk_bf16_f32 v32, v32, v33
    v_cvt_pk_bf16_f32 v33, v34, v35
    v_lshlrev_b32 v34, 16, v36
    v_and_b32 v35, s23, v36
    v_lshlrev_b32 v36, 16, v37
    v_and_b32 v37, s23, v37
    ds_read_b64 v[100:101], v100
    ds_read_b64 v[102:103], v102
    s_waitcnt lgkmcnt(9)
    v_smfmac_f32_16x16x64_bf16 v[34:37], v[66:69], v[104:111], v70
    v_mfma_f32_16x16x32_bf16 v[112:115], v[72:75], v[144:147], 0
    v_lshlrev_b32_sdwa v104, 3, v126 dst_sel:DWORD dst_unused:UNUSED_PAD src0_sel:DWORD src1_sel:WORD_0
    v_lshlrev_b32_sdwa v106, 3, v126 dst_sel:DWORD dst_unused:UNUSED_PAD src0_sel:DWORD src1_sel:WORD_1
    ds_read_b64 v[104:105], v104
    ds_read_b64 v[106:107], v106
    v_mfma_f32_16x16x32_bf16 v[112:115], v[76:79], v[148:151], v[112:115]
    v_lshlrev_b32_sdwa v108, 3, v127 dst_sel:DWORD dst_unused:UNUSED_PAD src0_sel:DWORD src1_sel:WORD_0
    v_lshlrev_b32_sdwa v110, 3, v127 dst_sel:DWORD dst_unused:UNUSED_PAD src0_sel:DWORD src1_sel:WORD_1
    ds_read_b64 v[108:109], v108
    ds_read_b64 v[110:111], v110
    buffer_load_dwordx4 v[124:127], v71, s[12:15], s20 offen offset:2048 sc1
    s_waitcnt lgkmcnt(9)
    v_smfmac_f32_16x16x64_bf16 v[34:37], v[66:69], v[88:95], v70
    v_mfma_f32_16x16x32_bf16 v[112:115], v[80:83], v[152:155], v[112:115]
    s_waitcnt vmcnt(2)
    v_lshlrev_b32_sdwa v88, 3, v116 dst_sel:DWORD dst_unused:UNUSED_PAD src0_sel:DWORD src1_sel:WORD_0
    v_lshlrev_b32_sdwa v90, 3, v116 dst_sel:DWORD dst_unused:UNUSED_PAD src0_sel:DWORD src1_sel:WORD_1
    ds_read_b64 v[88:89], v88
    ds_read_b64 v[90:91], v90
    v_mfma_f32_16x16x32_bf16 v[112:115], v[84:87], v[156:159], v[112:115]
    v_lshlrev_b32_sdwa v92, 3, v117 dst_sel:DWORD dst_unused:UNUSED_PAD src0_sel:DWORD src1_sel:WORD_0
    v_lshlrev_b32_sdwa v94, 3, v117 dst_sel:DWORD dst_unused:UNUSED_PAD src0_sel:DWORD src1_sel:WORD_1
    v_cvt_pk_bf16_f32 v34, v34, v35
    v_cvt_pk_bf16_f32 v35, v36, v37
    v_lshlrev_b32 v36, 16, v38
    v_and_b32 v37, s23, v38
    v_lshlrev_b32 v38, 16, v39
    v_and_b32 v39, s23, v39
    ds_read_b64 v[92:93], v92
    ds_read_b64 v[94:95], v94
    s_waitcnt lgkmcnt(8)
    v_smfmac_f32_16x16x64_bf16 v[36:39], v[66:69], v[96:103], v70
    v_cvt_pk_bf16_f32 v112, v112, v113
    v_cvt_pk_bf16_f32 v113, v114, v115
    v_lshlrev_b32_sdwa v114, 3, v70 dst_sel:DWORD dst_unused:UNUSED_PAD src0_sel:DWORD src1_sel:WORD_1
    ds_write_b64 v114, v[112:113] offset:128
    v_lshlrev_b32_sdwa v96, 3, v118 dst_sel:DWORD dst_unused:UNUSED_PAD src0_sel:DWORD src1_sel:WORD_0
    v_lshlrev_b32_sdwa v98, 3, v118 dst_sel:DWORD dst_unused:UNUSED_PAD src0_sel:DWORD src1_sel:WORD_1
    ds_read_b64 v[96:97], v96
    ds_read_b64 v[98:99], v98
    v_lshlrev_b32_sdwa v100, 3, v119 dst_sel:DWORD dst_unused:UNUSED_PAD src0_sel:DWORD src1_sel:WORD_0
    v_lshlrev_b32_sdwa v102, 3, v119 dst_sel:DWORD dst_unused:UNUSED_PAD src0_sel:DWORD src1_sel:WORD_1
    ds_read_b64 v[100:101], v100
    ds_read_b64 v[102:103], v102
    buffer_load_dwordx4 v[116:119], v71, s[12:15], s20 offen offset:1024 sc1
    s_waitcnt lgkmcnt(9)
    v_smfmac_f32_16x16x64_bf16 v[36:39], v[66:69], v[104:111], v70
    v_mfma_f32_16x16x32_bf16 v[112:115], v[72:75], v[160:163], 0
    s_waitcnt vmcnt(2)
    v_lshlrev_b32_sdwa v104, 3, v120 dst_sel:DWORD dst_unused:UNUSED_PAD src0_sel:DWORD src1_sel:WORD_0
    v_lshlrev_b32_sdwa v106, 3, v120 dst_sel:DWORD dst_unused:UNUSED_PAD src0_sel:DWORD src1_sel:WORD_1
    ds_read_b64 v[104:105], v104
    ds_read_b64 v[106:107], v106
    v_mfma_f32_16x16x32_bf16 v[112:115], v[76:79], v[164:167], v[112:115]
    v_lshlrev_b32_sdwa v108, 3, v121 dst_sel:DWORD dst_unused:UNUSED_PAD src0_sel:DWORD src1_sel:WORD_0
    v_lshlrev_b32_sdwa v110, 3, v121 dst_sel:DWORD dst_unused:UNUSED_PAD src0_sel:DWORD src1_sel:WORD_1
    v_cvt_pk_bf16_f32 v36, v36, v37
    v_cvt_pk_bf16_f32 v37, v38, v39
    v_lshlrev_b32 v38, 16, v40
    v_and_b32 v39, s23, v40
    v_lshlrev_b32 v40, 16, v41
    v_and_b32 v41, s23, v41
    ds_read_b64 v[108:109], v108
    ds_read_b64 v[110:111], v110
    s_waitcnt lgkmcnt(9)
    v_smfmac_f32_16x16x64_bf16 v[38:41], v[66:69], v[88:95], v70
    v_mfma_f32_16x16x32_bf16 v[112:115], v[80:83], v[168:171], v[112:115]
    v_lshlrev_b32_sdwa v88, 3, v122 dst_sel:DWORD dst_unused:UNUSED_PAD src0_sel:DWORD src1_sel:WORD_0
    v_lshlrev_b32_sdwa v90, 3, v122 dst_sel:DWORD dst_unused:UNUSED_PAD src0_sel:DWORD src1_sel:WORD_1
    ds_read_b64 v[88:89], v88
    ds_read_b64 v[90:91], v90
    v_mfma_f32_16x16x32_bf16 v[112:115], v[84:87], v[172:175], v[112:115]
    v_lshlrev_b32_sdwa v92, 3, v123 dst_sel:DWORD dst_unused:UNUSED_PAD src0_sel:DWORD src1_sel:WORD_0
    v_lshlrev_b32_sdwa v94, 3, v123 dst_sel:DWORD dst_unused:UNUSED_PAD src0_sel:DWORD src1_sel:WORD_1
    ds_read_b64 v[92:93], v92
    ds_read_b64 v[94:95], v94
    buffer_load_dwordx4 v[120:123], v71, s[12:15], s20 offen offset:0 sc1
    s_waitcnt lgkmcnt(8)
    v_smfmac_f32_16x16x64_bf16 v[38:41], v[66:69], v[96:103], v70
    s_nop 0
    v_cvt_pk_bf16_f32 v112, v112, v113
    v_cvt_pk_bf16_f32 v113, v114, v115
    v_lshlrev_b32_sdwa v114, 3, v70 dst_sel:DWORD dst_unused:UNUSED_PAD src0_sel:DWORD src1_sel:WORD_1
    ds_write_b64 v114, v[112:113] offset:256
    s_waitcnt vmcnt(2)
    v_lshlrev_b32_sdwa v96, 3, v124 dst_sel:DWORD dst_unused:UNUSED_PAD src0_sel:DWORD src1_sel:WORD_0
    v_lshlrev_b32_sdwa v98, 3, v124 dst_sel:DWORD dst_unused:UNUSED_PAD src0_sel:DWORD src1_sel:WORD_1
    ds_read_b64 v[96:97], v96
    ds_read_b64 v[98:99], v98
    v_lshlrev_b32_sdwa v100, 3, v125 dst_sel:DWORD dst_unused:UNUSED_PAD src0_sel:DWORD src1_sel:WORD_0
    v_lshlrev_b32_sdwa v102, 3, v125 dst_sel:DWORD dst_unused:UNUSED_PAD src0_sel:DWORD src1_sel:WORD_1
    v_cvt_pk_bf16_f32 v38, v38, v39
    v_cvt_pk_bf16_f32 v39, v40, v41
    v_lshlrev_b32 v40, 16, v42
    v_and_b32 v41, s23, v42
    v_lshlrev_b32 v42, 16, v43
    v_and_b32 v43, s23, v43
    ds_read_b64 v[100:101], v100
    ds_read_b64 v[102:103], v102
    s_waitcnt lgkmcnt(9)
    v_smfmac_f32_16x16x64_bf16 v[40:43], v[66:69], v[104:111], v70
    v_mfma_f32_16x16x32_bf16 v[112:115], v[72:75], v[176:179], 0
    v_lshlrev_b32_sdwa v104, 3, v126 dst_sel:DWORD dst_unused:UNUSED_PAD src0_sel:DWORD src1_sel:WORD_0
    v_lshlrev_b32_sdwa v106, 3, v126 dst_sel:DWORD dst_unused:UNUSED_PAD src0_sel:DWORD src1_sel:WORD_1
    ds_read_b64 v[104:105], v104
    ds_read_b64 v[106:107], v106
    v_mfma_f32_16x16x32_bf16 v[112:115], v[76:79], v[180:183], v[112:115]
    v_lshlrev_b32_sdwa v108, 3, v127 dst_sel:DWORD dst_unused:UNUSED_PAD src0_sel:DWORD src1_sel:WORD_0
    v_lshlrev_b32_sdwa v110, 3, v127 dst_sel:DWORD dst_unused:UNUSED_PAD src0_sel:DWORD src1_sel:WORD_1
    ds_read_b64 v[108:109], v108
    ds_read_b64 v[110:111], v110
    s_add_u32 s20, s20, 0xfffff000
    buffer_load_dwordx4 v[124:127], v71, s[12:15], s20 offen offset:3072 sc1
    s_waitcnt lgkmcnt(9)
    v_smfmac_f32_16x16x64_bf16 v[40:43], v[66:69], v[88:95], v70
    v_mfma_f32_16x16x32_bf16 v[112:115], v[80:83], v[184:187], v[112:115]
    s_waitcnt vmcnt(2)
    v_lshlrev_b32_sdwa v88, 3, v116 dst_sel:DWORD dst_unused:UNUSED_PAD src0_sel:DWORD src1_sel:WORD_0
    v_lshlrev_b32_sdwa v90, 3, v116 dst_sel:DWORD dst_unused:UNUSED_PAD src0_sel:DWORD src1_sel:WORD_1
    ds_read_b64 v[88:89], v88
    ds_read_b64 v[90:91], v90
    v_mfma_f32_16x16x32_bf16 v[112:115], v[84:87], v[188:191], v[112:115]
    v_lshlrev_b32_sdwa v92, 3, v117 dst_sel:DWORD dst_unused:UNUSED_PAD src0_sel:DWORD src1_sel:WORD_0
    v_lshlrev_b32_sdwa v94, 3, v117 dst_sel:DWORD dst_unused:UNUSED_PAD src0_sel:DWORD src1_sel:WORD_1
    v_cvt_pk_bf16_f32 v40, v40, v41
    v_cvt_pk_bf16_f32 v41, v42, v43
    v_lshlrev_b32 v42, 16, v44
    v_and_b32 v43, s23, v44
    v_lshlrev_b32 v44, 16, v45
    v_and_b32 v45, s23, v45
    ds_read_b64 v[92:93], v92
    ds_read_b64 v[94:95], v94
    s_waitcnt lgkmcnt(8)
    v_smfmac_f32_16x16x64_bf16 v[42:45], v[66:69], v[96:103], v70
    v_cvt_pk_bf16_f32 v112, v112, v113
    v_cvt_pk_bf16_f32 v113, v114, v115
    v_lshlrev_b32_sdwa v114, 3, v70 dst_sel:DWORD dst_unused:UNUSED_PAD src0_sel:DWORD src1_sel:WORD_1
    ds_write_b64 v114, v[112:113] offset:384
    v_lshlrev_b32_sdwa v96, 3, v118 dst_sel:DWORD dst_unused:UNUSED_PAD src0_sel:DWORD src1_sel:WORD_0
    v_lshlrev_b32_sdwa v98, 3, v118 dst_sel:DWORD dst_unused:UNUSED_PAD src0_sel:DWORD src1_sel:WORD_1
    ds_read_b64 v[96:97], v96
    ds_read_b64 v[98:99], v98
    v_lshlrev_b32_sdwa v100, 3, v119 dst_sel:DWORD dst_unused:UNUSED_PAD src0_sel:DWORD src1_sel:WORD_0
    v_lshlrev_b32_sdwa v102, 3, v119 dst_sel:DWORD dst_unused:UNUSED_PAD src0_sel:DWORD src1_sel:WORD_1
    ds_read_b64 v[100:101], v100
    ds_read_b64 v[102:103], v102
    buffer_load_dwordx4 v[116:119], v71, s[12:15], s20 offen offset:2048 sc1
    s_waitcnt lgkmcnt(9)
    v_smfmac_f32_16x16x64_bf16 v[42:45], v[66:69], v[104:111], v70
    v_mfma_f32_16x16x32_bf16 v[112:115], v[72:75], v[192:195], 0
    s_waitcnt vmcnt(2)
    v_lshlrev_b32_sdwa v104, 3, v120 dst_sel:DWORD dst_unused:UNUSED_PAD src0_sel:DWORD src1_sel:WORD_0
    v_lshlrev_b32_sdwa v106, 3, v120 dst_sel:DWORD dst_unused:UNUSED_PAD src0_sel:DWORD src1_sel:WORD_1
    ds_read_b64 v[104:105], v104
    ds_read_b64 v[106:107], v106
    v_mfma_f32_16x16x32_bf16 v[112:115], v[76:79], v[196:199], v[112:115]
    v_lshlrev_b32_sdwa v108, 3, v121 dst_sel:DWORD dst_unused:UNUSED_PAD src0_sel:DWORD src1_sel:WORD_0
    v_lshlrev_b32_sdwa v110, 3, v121 dst_sel:DWORD dst_unused:UNUSED_PAD src0_sel:DWORD src1_sel:WORD_1
    v_cvt_pk_bf16_f32 v42, v42, v43
    v_cvt_pk_bf16_f32 v43, v44, v45
    v_lshlrev_b32 v44, 16, v46
    v_and_b32 v45, s23, v46
    v_lshlrev_b32 v46, 16, v47
    v_and_b32 v47, s23, v47
    ds_read_b64 v[108:109], v108
    ds_read_b64 v[110:111], v110
    s_waitcnt lgkmcnt(9)
    v_smfmac_f32_16x16x64_bf16 v[44:47], v[66:69], v[88:95], v70
    v_mfma_f32_16x16x32_bf16 v[112:115], v[80:83], v[200:203], v[112:115]
    v_lshlrev_b32_sdwa v88, 3, v122 dst_sel:DWORD dst_unused:UNUSED_PAD src0_sel:DWORD src1_sel:WORD_0
    v_lshlrev_b32_sdwa v90, 3, v122 dst_sel:DWORD dst_unused:UNUSED_PAD src0_sel:DWORD src1_sel:WORD_1
    ds_read_b64 v[88:89], v88
    ds_read_b64 v[90:91], v90
    v_mfma_f32_16x16x32_bf16 v[112:115], v[84:87], v[204:207], v[112:115]
    v_lshlrev_b32_sdwa v92, 3, v123 dst_sel:DWORD dst_unused:UNUSED_PAD src0_sel:DWORD src1_sel:WORD_0
    v_lshlrev_b32_sdwa v94, 3, v123 dst_sel:DWORD dst_unused:UNUSED_PAD src0_sel:DWORD src1_sel:WORD_1
    ds_read_b64 v[92:93], v92
    ds_read_b64 v[94:95], v94
    buffer_load_dwordx4 v[120:123], v71, s[12:15], s20 offen offset:1024 sc1
    s_waitcnt lgkmcnt(8)
    v_smfmac_f32_16x16x64_bf16 v[44:47], v[66:69], v[96:103], v70
    s_nop 0
    v_cvt_pk_bf16_f32 v112, v112, v113
    v_cvt_pk_bf16_f32 v113, v114, v115
    v_lshlrev_b32_sdwa v114, 3, v70 dst_sel:DWORD dst_unused:UNUSED_PAD src0_sel:DWORD src1_sel:WORD_1
    ds_write_b64 v114, v[112:113] offset:512
    s_waitcnt vmcnt(2)
    v_lshlrev_b32_sdwa v96, 3, v124 dst_sel:DWORD dst_unused:UNUSED_PAD src0_sel:DWORD src1_sel:WORD_0
    v_lshlrev_b32_sdwa v98, 3, v124 dst_sel:DWORD dst_unused:UNUSED_PAD src0_sel:DWORD src1_sel:WORD_1
    ds_read_b64 v[96:97], v96
    ds_read_b64 v[98:99], v98
    v_lshlrev_b32_sdwa v100, 3, v125 dst_sel:DWORD dst_unused:UNUSED_PAD src0_sel:DWORD src1_sel:WORD_0
    v_lshlrev_b32_sdwa v102, 3, v125 dst_sel:DWORD dst_unused:UNUSED_PAD src0_sel:DWORD src1_sel:WORD_1
    v_cvt_pk_bf16_f32 v44, v44, v45
    v_cvt_pk_bf16_f32 v45, v46, v47
    v_lshlrev_b32 v46, 16, v48
    v_and_b32 v47, s23, v48
    v_lshlrev_b32 v48, 16, v49
    v_and_b32 v49, s23, v49
    ds_read_b64 v[100:101], v100
    ds_read_b64 v[102:103], v102
    s_waitcnt lgkmcnt(9)
    v_smfmac_f32_16x16x64_bf16 v[46:49], v[66:69], v[104:111], v70
    s_setprio 2
    v_mfma_f32_16x16x32_bf16 v[112:115], v[72:75], v[208:211], 0
    v_lshlrev_b32_sdwa v104, 3, v126 dst_sel:DWORD dst_unused:UNUSED_PAD src0_sel:DWORD src1_sel:WORD_0
    v_lshlrev_b32_sdwa v106, 3, v126 dst_sel:DWORD dst_unused:UNUSED_PAD src0_sel:DWORD src1_sel:WORD_1
    ds_read_b64 v[104:105], v104
    ds_read_b64 v[106:107], v106
    v_mfma_f32_16x16x32_bf16 v[112:115], v[76:79], v[212:215], v[112:115]
    v_lshlrev_b32_sdwa v108, 3, v127 dst_sel:DWORD dst_unused:UNUSED_PAD src0_sel:DWORD src1_sel:WORD_0
    v_lshlrev_b32_sdwa v110, 3, v127 dst_sel:DWORD dst_unused:UNUSED_PAD src0_sel:DWORD src1_sel:WORD_1
    ds_read_b64 v[108:109], v108
    ds_read_b64 v[110:111], v110
    buffer_load_dwordx4 v[124:127], v71, s[12:15], s20 offen offset:0 sc1
    s_waitcnt lgkmcnt(9)
    v_smfmac_f32_16x16x64_bf16 v[46:49], v[66:69], v[88:95], v70
    v_mfma_f32_16x16x32_bf16 v[112:115], v[80:83], v[216:219], v[112:115]
    s_waitcnt vmcnt(2)
    v_lshlrev_b32_sdwa v88, 3, v116 dst_sel:DWORD dst_unused:UNUSED_PAD src0_sel:DWORD src1_sel:WORD_0
    v_lshlrev_b32_sdwa v90, 3, v116 dst_sel:DWORD dst_unused:UNUSED_PAD src0_sel:DWORD src1_sel:WORD_1
    ds_read_b64 v[88:89], v88
    ds_read_b64 v[90:91], v90
    v_mfma_f32_16x16x32_bf16 v[112:115], v[84:87], v[220:223], v[112:115]
    v_lshlrev_b32_sdwa v92, 3, v117 dst_sel:DWORD dst_unused:UNUSED_PAD src0_sel:DWORD src1_sel:WORD_0
    v_lshlrev_b32_sdwa v94, 3, v117 dst_sel:DWORD dst_unused:UNUSED_PAD src0_sel:DWORD src1_sel:WORD_1
    v_cvt_pk_bf16_f32 v46, v46, v47
    v_cvt_pk_bf16_f32 v47, v48, v49
    v_lshlrev_b32 v48, 16, v50
    v_and_b32 v49, s23, v50
    v_lshlrev_b32 v50, 16, v51
    v_and_b32 v51, s23, v51
    ds_read_b64 v[92:93], v92
    ds_read_b64 v[94:95], v94
    s_waitcnt lgkmcnt(8)
    v_smfmac_f32_16x16x64_bf16 v[48:51], v[66:69], v[96:103], v70
    v_cvt_pk_bf16_f32 v112, v112, v113
    v_cvt_pk_bf16_f32 v113, v114, v115
    v_lshlrev_b32_sdwa v114, 3, v70 dst_sel:DWORD dst_unused:UNUSED_PAD src0_sel:DWORD src1_sel:WORD_1
    ds_write_b64 v114, v[112:113] offset:640
    v_lshlrev_b32_sdwa v96, 3, v118 dst_sel:DWORD dst_unused:UNUSED_PAD src0_sel:DWORD src1_sel:WORD_0
    v_lshlrev_b32_sdwa v98, 3, v118 dst_sel:DWORD dst_unused:UNUSED_PAD src0_sel:DWORD src1_sel:WORD_1
    ds_read_b64 v[96:97], v96
    ds_read_b64 v[98:99], v98
    v_lshlrev_b32_sdwa v100, 3, v119 dst_sel:DWORD dst_unused:UNUSED_PAD src0_sel:DWORD src1_sel:WORD_0
    v_lshlrev_b32_sdwa v102, 3, v119 dst_sel:DWORD dst_unused:UNUSED_PAD src0_sel:DWORD src1_sel:WORD_1
    ds_read_b64 v[100:101], v100
    ds_read_b64 v[102:103], v102
    s_add_u32 s20, s20, 0xfffff000
    buffer_load_dwordx4 v[116:119], v71, s[12:15], s20 offen offset:3072 sc1
    s_waitcnt lgkmcnt(9)
    v_smfmac_f32_16x16x64_bf16 v[48:51], v[66:69], v[104:111], v70
    v_mfma_f32_16x16x32_bf16 v[112:115], v[72:75], v[224:227], 0
    s_waitcnt vmcnt(2)
    v_lshlrev_b32_sdwa v104, 3, v120 dst_sel:DWORD dst_unused:UNUSED_PAD src0_sel:DWORD src1_sel:WORD_0
    v_lshlrev_b32_sdwa v106, 3, v120 dst_sel:DWORD dst_unused:UNUSED_PAD src0_sel:DWORD src1_sel:WORD_1
    ds_read_b64 v[104:105], v104
    ds_read_b64 v[106:107], v106
    v_mfma_f32_16x16x32_bf16 v[112:115], v[76:79], v[228:231], v[112:115]
    v_lshlrev_b32_sdwa v108, 3, v121 dst_sel:DWORD dst_unused:UNUSED_PAD src0_sel:DWORD src1_sel:WORD_0
    v_lshlrev_b32_sdwa v110, 3, v121 dst_sel:DWORD dst_unused:UNUSED_PAD src0_sel:DWORD src1_sel:WORD_1
    v_cvt_pk_bf16_f32 v48, v48, v49
    v_cvt_pk_bf16_f32 v49, v50, v51
    v_lshlrev_b32 v50, 16, v52
    v_and_b32 v51, s23, v52
    v_lshlrev_b32 v52, 16, v53
    v_and_b32 v53, s23, v53
    ds_read_b64 v[108:109], v108
    ds_read_b64 v[110:111], v110
    s_waitcnt lgkmcnt(9)
    v_smfmac_f32_16x16x64_bf16 v[50:53], v[66:69], v[88:95], v70
    v_mfma_f32_16x16x32_bf16 v[112:115], v[80:83], v[232:235], v[112:115]
    v_lshlrev_b32_sdwa v88, 3, v122 dst_sel:DWORD dst_unused:UNUSED_PAD src0_sel:DWORD src1_sel:WORD_0
    v_lshlrev_b32_sdwa v90, 3, v122 dst_sel:DWORD dst_unused:UNUSED_PAD src0_sel:DWORD src1_sel:WORD_1
    ds_read_b64 v[88:89], v88
    ds_read_b64 v[90:91], v90
    v_mfma_f32_16x16x32_bf16 v[112:115], v[84:87], v[236:239], v[112:115]
    v_lshlrev_b32_sdwa v92, 3, v123 dst_sel:DWORD dst_unused:UNUSED_PAD src0_sel:DWORD src1_sel:WORD_0
    v_lshlrev_b32_sdwa v94, 3, v123 dst_sel:DWORD dst_unused:UNUSED_PAD src0_sel:DWORD src1_sel:WORD_1
    ds_read_b64 v[92:93], v92
    ds_read_b64 v[94:95], v94
    buffer_load_dwordx4 v[120:123], v71, s[12:15], s20 offen offset:2048 sc1
    s_waitcnt lgkmcnt(8)
    v_smfmac_f32_16x16x64_bf16 v[50:53], v[66:69], v[96:103], v70
    s_nop 0
    v_cvt_pk_bf16_f32 v112, v112, v113
    v_cvt_pk_bf16_f32 v113, v114, v115
    v_lshlrev_b32_sdwa v114, 3, v70 dst_sel:DWORD dst_unused:UNUSED_PAD src0_sel:DWORD src1_sel:WORD_1
    ds_write_b64 v114, v[112:113] offset:768
    s_waitcnt vmcnt(2)
    v_lshlrev_b32_sdwa v96, 3, v124 dst_sel:DWORD dst_unused:UNUSED_PAD src0_sel:DWORD src1_sel:WORD_0
    v_lshlrev_b32_sdwa v98, 3, v124 dst_sel:DWORD dst_unused:UNUSED_PAD src0_sel:DWORD src1_sel:WORD_1
    ds_read_b64 v[96:97], v96
    ds_read_b64 v[98:99], v98
    v_lshlrev_b32_sdwa v100, 3, v125 dst_sel:DWORD dst_unused:UNUSED_PAD src0_sel:DWORD src1_sel:WORD_0
    v_lshlrev_b32_sdwa v102, 3, v125 dst_sel:DWORD dst_unused:UNUSED_PAD src0_sel:DWORD src1_sel:WORD_1
    v_cvt_pk_bf16_f32 v50, v50, v51
    v_cvt_pk_bf16_f32 v51, v52, v53
    v_lshlrev_b32 v52, 16, v54
    v_and_b32 v53, s23, v54
    v_lshlrev_b32 v54, 16, v55
    v_and_b32 v55, s23, v55
    ds_read_b64 v[100:101], v100
    ds_read_b64 v[102:103], v102
    s_waitcnt lgkmcnt(9)
    v_smfmac_f32_16x16x64_bf16 v[52:55], v[66:69], v[104:111], v70
    v_mfma_f32_16x16x32_bf16 v[112:115], v[72:75], v[240:243], 0
    buffer_load_dwordx4 v[72:75], v71, s[12:15], s21 offen offset:0
    v_lshlrev_b32_sdwa v104, 3, v126 dst_sel:DWORD dst_unused:UNUSED_PAD src0_sel:DWORD src1_sel:WORD_0
    v_lshlrev_b32_sdwa v106, 3, v126 dst_sel:DWORD dst_unused:UNUSED_PAD src0_sel:DWORD src1_sel:WORD_1
    ds_read_b64 v[104:105], v104
    ds_read_b64 v[106:107], v106
    v_mfma_f32_16x16x32_bf16 v[112:115], v[76:79], v[244:247], v[112:115]
    buffer_load_dwordx4 v[76:79], v71, s[12:15], s21 offen offset:1024
    v_lshlrev_b32_sdwa v108, 3, v127 dst_sel:DWORD dst_unused:UNUSED_PAD src0_sel:DWORD src1_sel:WORD_0
    v_lshlrev_b32_sdwa v110, 3, v127 dst_sel:DWORD dst_unused:UNUSED_PAD src0_sel:DWORD src1_sel:WORD_1
    ds_read_b64 v[108:109], v108
    ds_read_b64 v[110:111], v110
    buffer_load_dwordx4 v[124:127], v71, s[12:15], s20 offen offset:1024 sc1
    s_waitcnt lgkmcnt(9)
    v_smfmac_f32_16x16x64_bf16 v[52:55], v[66:69], v[88:95], v70
    v_mfma_f32_16x16x32_bf16 v[112:115], v[80:83], v[248:251], v[112:115]
    buffer_load_dwordx4 v[80:83], v71, s[12:15], s19 offen offset:0
    s_waitcnt vmcnt(5)
    v_lshlrev_b32_sdwa v88, 3, v116 dst_sel:DWORD dst_unused:UNUSED_PAD src0_sel:DWORD src1_sel:WORD_0
    v_lshlrev_b32_sdwa v90, 3, v116 dst_sel:DWORD dst_unused:UNUSED_PAD src0_sel:DWORD src1_sel:WORD_1
    ds_read_b64 v[88:89], v88
    ds_read_b64 v[90:91], v90
    v_mfma_f32_16x16x32_bf16 v[112:115], v[84:87], v[252:255], v[112:115]
    buffer_load_dwordx4 v[84:87], v71, s[12:15], s19 offen offset:1024
    s_add_u32 s21, s21, 4096
    s_add_u32 s19, s19, 4096
    v_lshlrev_b32_sdwa v92, 3, v117 dst_sel:DWORD dst_unused:UNUSED_PAD src0_sel:DWORD src1_sel:WORD_0
    v_lshlrev_b32_sdwa v94, 3, v117 dst_sel:DWORD dst_unused:UNUSED_PAD src0_sel:DWORD src1_sel:WORD_1
    v_cvt_pk_bf16_f32 v52, v52, v53
    v_cvt_pk_bf16_f32 v53, v54, v55
    v_lshlrev_b32 v54, 16, v56
    v_and_b32 v55, s23, v56
    v_lshlrev_b32 v56, 16, v57
    v_and_b32 v57, s23, v57
    ds_read_b64 v[92:93], v92
    ds_read_b64 v[94:95], v94
    s_waitcnt lgkmcnt(8)
    v_smfmac_f32_16x16x64_bf16 v[54:57], v[66:69], v[96:103], v70
    v_cvt_pk_bf16_f32 v112, v112, v113
    v_cvt_pk_bf16_f32 v113, v114, v115
    v_lshlrev_b32_sdwa v114, 3, v70 dst_sel:DWORD dst_unused:UNUSED_PAD src0_sel:DWORD src1_sel:WORD_1
    ds_write_b64 v114, v[112:113] offset:896
    s_setprio 1
    v_lshlrev_b32_sdwa v96, 3, v118 dst_sel:DWORD dst_unused:UNUSED_PAD src0_sel:DWORD src1_sel:WORD_0
    v_lshlrev_b32_sdwa v98, 3, v118 dst_sel:DWORD dst_unused:UNUSED_PAD src0_sel:DWORD src1_sel:WORD_1
    ds_read_b64 v[96:97], v96
    ds_read_b64 v[98:99], v98
    v_lshlrev_b32_sdwa v100, 3, v119 dst_sel:DWORD dst_unused:UNUSED_PAD src0_sel:DWORD src1_sel:WORD_0
    v_lshlrev_b32_sdwa v102, 3, v119 dst_sel:DWORD dst_unused:UNUSED_PAD src0_sel:DWORD src1_sel:WORD_1
    ds_read_b64 v[100:101], v100
    ds_read_b64 v[102:103], v102
    s_add_u32 s20, s20, 0x4000
    buffer_load_dwordx4 v[116:119], v71, s[12:15], s20 offen offset:0 sc1
    s_waitcnt lgkmcnt(9)
    v_smfmac_f32_16x16x64_bf16 v[54:57], v[66:69], v[104:111], v70
    s_waitcnt vmcnt(6)
    v_lshlrev_b32_sdwa v104, 3, v120 dst_sel:DWORD dst_unused:UNUSED_PAD src0_sel:DWORD src1_sel:WORD_0
    v_lshlrev_b32_sdwa v106, 3, v120 dst_sel:DWORD dst_unused:UNUSED_PAD src0_sel:DWORD src1_sel:WORD_1
    ds_read_b64 v[104:105], v104
    ds_read_b64 v[106:107], v106
    v_lshlrev_b32_sdwa v108, 3, v121 dst_sel:DWORD dst_unused:UNUSED_PAD src0_sel:DWORD src1_sel:WORD_0
    v_lshlrev_b32_sdwa v110, 3, v121 dst_sel:DWORD dst_unused:UNUSED_PAD src0_sel:DWORD src1_sel:WORD_1
    s_nop 0
    v_cvt_pk_bf16_f32 v54, v54, v55
    v_cvt_pk_bf16_f32 v55, v56, v57
    v_lshlrev_b32 v56, 16, v58
    v_and_b32 v57, s23, v58
    v_lshlrev_b32 v58, 16, v59
    v_and_b32 v59, s23, v59
    ds_read_b64 v[108:109], v108
    ds_read_b64 v[110:111], v110
    s_waitcnt lgkmcnt(9)
    v_smfmac_f32_16x16x64_bf16 v[56:59], v[66:69], v[88:95], v70
    v_lshlrev_b32_sdwa v88, 3, v122 dst_sel:DWORD dst_unused:UNUSED_PAD src0_sel:DWORD src1_sel:WORD_0
    v_lshlrev_b32_sdwa v90, 3, v122 dst_sel:DWORD dst_unused:UNUSED_PAD src0_sel:DWORD src1_sel:WORD_1
    ds_read_b64 v[88:89], v88
    ds_read_b64 v[90:91], v90
    v_lshlrev_b32_sdwa v92, 3, v123 dst_sel:DWORD dst_unused:UNUSED_PAD src0_sel:DWORD src1_sel:WORD_0
    v_lshlrev_b32_sdwa v94, 3, v123 dst_sel:DWORD dst_unused:UNUSED_PAD src0_sel:DWORD src1_sel:WORD_1
    ds_read_b64 v[92:93], v92
    ds_read_b64 v[94:95], v94
    s_add_u32 s20, s20, 0x1ec00
    buffer_load_dwordx4 v[120:123], v71, s[12:15], s20 offen offset:3072 sc1
    s_waitcnt lgkmcnt(8)
    v_smfmac_f32_16x16x64_bf16 v[56:59], v[66:69], v[96:103], v70
    s_waitcnt vmcnt(4)
    v_lshlrev_b32_sdwa v96, 3, v124 dst_sel:DWORD dst_unused:UNUSED_PAD src0_sel:DWORD src1_sel:WORD_0
    v_lshlrev_b32_sdwa v98, 3, v124 dst_sel:DWORD dst_unused:UNUSED_PAD src0_sel:DWORD src1_sel:WORD_1
    ds_read_b64 v[96:97], v96
    ds_read_b64 v[98:99], v98
    v_lshlrev_b32_sdwa v100, 3, v125 dst_sel:DWORD dst_unused:UNUSED_PAD src0_sel:DWORD src1_sel:WORD_0
    v_lshlrev_b32_sdwa v102, 3, v125 dst_sel:DWORD dst_unused:UNUSED_PAD src0_sel:DWORD src1_sel:WORD_1
    s_nop 0
    v_cvt_pk_bf16_f32 v56, v56, v57
    v_cvt_pk_bf16_f32 v57, v58, v59
    v_lshlrev_b32 v58, 16, v60
    v_and_b32 v59, s23, v60
    v_lshlrev_b32 v60, 16, v61
    v_and_b32 v61, s23, v61
    ds_read_b64 v[100:101], v100
    ds_read_b64 v[102:103], v102
    s_waitcnt lgkmcnt(8)
    v_smfmac_f32_16x16x64_bf16 v[58:61], v[66:69], v[104:111], v70
    v_lshlrev_b32_sdwa v104, 3, v126 dst_sel:DWORD dst_unused:UNUSED_PAD src0_sel:DWORD src1_sel:WORD_0
    v_lshlrev_b32_sdwa v106, 3, v126 dst_sel:DWORD dst_unused:UNUSED_PAD src0_sel:DWORD src1_sel:WORD_1
    ds_read_b64 v[104:105], v104
    ds_read_b64 v[106:107], v106
    v_lshlrev_b32_sdwa v108, 3, v127 dst_sel:DWORD dst_unused:UNUSED_PAD src0_sel:DWORD src1_sel:WORD_0
    v_lshlrev_b32_sdwa v110, 3, v127 dst_sel:DWORD dst_unused:UNUSED_PAD src0_sel:DWORD src1_sel:WORD_1
    ds_read_b64 v[108:109], v108
    ds_read_b64 v[110:111], v110
    buffer_load_dwordx4 v[124:127], v71, s[12:15], s20 offen offset:2048 sc1
    s_waitcnt lgkmcnt(8)
    v_smfmac_f32_16x16x64_bf16 v[58:61], v[66:69], v[88:95], v70
    s_waitcnt vmcnt(2)
    v_lshlrev_b32_sdwa v88, 3, v116 dst_sel:DWORD dst_unused:UNUSED_PAD src0_sel:DWORD src1_sel:WORD_0
    v_lshlrev_b32_sdwa v90, 3, v116 dst_sel:DWORD dst_unused:UNUSED_PAD src0_sel:DWORD src1_sel:WORD_1
    ds_read_b64 v[88:89], v88
    ds_read_b64 v[90:91], v90
    v_lshlrev_b32_sdwa v92, 3, v117 dst_sel:DWORD dst_unused:UNUSED_PAD src0_sel:DWORD src1_sel:WORD_0
    v_lshlrev_b32_sdwa v94, 3, v117 dst_sel:DWORD dst_unused:UNUSED_PAD src0_sel:DWORD src1_sel:WORD_1
    s_nop 0
    v_cvt_pk_bf16_f32 v58, v58, v59
    v_cvt_pk_bf16_f32 v59, v60, v61
    v_lshlrev_b32 v60, 16, v62
    v_and_b32 v61, s23, v62
    v_lshlrev_b32 v62, 16, v63
    v_and_b32 v63, s23, v63
    ds_read_b64 v[92:93], v92
    ds_read_b64 v[94:95], v94
    s_waitcnt lgkmcnt(8)
    v_smfmac_f32_16x16x64_bf16 v[60:63], v[66:69], v[96:103], v70
    s_setprio 0
    v_lshlrev_b32_sdwa v96, 3, v118 dst_sel:DWORD dst_unused:UNUSED_PAD src0_sel:DWORD src1_sel:WORD_0
    v_lshlrev_b32_sdwa v98, 3, v118 dst_sel:DWORD dst_unused:UNUSED_PAD src0_sel:DWORD src1_sel:WORD_1
    ds_read_b64 v[96:97], v96
    ds_read_b64 v[98:99], v98
    v_lshlrev_b32_sdwa v100, 3, v119 dst_sel:DWORD dst_unused:UNUSED_PAD src0_sel:DWORD src1_sel:WORD_0
    v_lshlrev_b32_sdwa v102, 3, v119 dst_sel:DWORD dst_unused:UNUSED_PAD src0_sel:DWORD src1_sel:WORD_1
    ds_read_b64 v[100:101], v100
    ds_read_b64 v[102:103], v102
    buffer_load_dwordx4 v[116:119], v71, s[12:15], s20 offen offset:1024 sc1
    s_waitcnt lgkmcnt(8)
    v_smfmac_f32_16x16x64_bf16 v[60:63], v[66:69], v[104:111], v70
    s_waitcnt vmcnt(2)
    v_lshlrev_b32_sdwa v104, 3, v122 dst_sel:DWORD dst_unused:UNUSED_PAD src0_sel:DWORD src1_sel:WORD_0
    v_lshlrev_b32_sdwa v106, 3, v122 dst_sel:DWORD dst_unused:UNUSED_PAD src0_sel:DWORD src1_sel:WORD_1
    ds_read_b64 v[104:105], v104
    ds_read_b64 v[106:107], v106
    v_lshlrev_b32_sdwa v108, 3, v123 dst_sel:DWORD dst_unused:UNUSED_PAD src0_sel:DWORD src1_sel:WORD_0
    v_lshlrev_b32_sdwa v110, 3, v123 dst_sel:DWORD dst_unused:UNUSED_PAD src0_sel:DWORD src1_sel:WORD_1
    s_nop 0
    v_cvt_pk_bf16_f32 v60, v60, v61
    v_cvt_pk_bf16_f32 v61, v62, v63
    v_lshlrev_b32 v62, 16, v64
    v_and_b32 v63, s23, v64
    v_lshlrev_b32 v64, 16, v65
    v_and_b32 v65, s23, v65
    ds_read_b64 v[108:109], v108
    ds_read_b64 v[110:111], v110
    s_waitcnt lgkmcnt(8)
    v_smfmac_f32_16x16x64_bf16 v[62:65], v[66:69], v[88:95], v70
    s_barrier
    s_setprio 3
    v_lshlrev_b32_sdwa v88, 3, v120 dst_sel:DWORD dst_unused:UNUSED_PAD src0_sel:DWORD src1_sel:WORD_0
    v_lshlrev_b32_sdwa v90, 3, v120 dst_sel:DWORD dst_unused:UNUSED_PAD src0_sel:DWORD src1_sel:WORD_1
    ds_read_b64 v[88:89], v88
    ds_read_b64 v[90:91], v90
    v_lshlrev_b32_sdwa v92, 3, v121 dst_sel:DWORD dst_unused:UNUSED_PAD src0_sel:DWORD src1_sel:WORD_0
    v_lshlrev_b32_sdwa v94, 3, v121 dst_sel:DWORD dst_unused:UNUSED_PAD src0_sel:DWORD src1_sel:WORD_1
    ds_read_b64 v[92:93], v92
    ds_read_b64 v[94:95], v94
    buffer_load_dwordx4 v[120:123], v71, s[12:15], s20 offen offset:0 sc1
    s_waitcnt lgkmcnt(8)
    v_smfmac_f32_16x16x64_bf16 v[62:65], v[66:69], v[96:103], v70
    v_mfma_f32_16x16x32_bf16 v[112:115], v[72:75], v[128:131], 0
    s_waitcnt vmcnt(2)
    v_lshlrev_b32_sdwa v96, 3, v126 dst_sel:DWORD dst_unused:UNUSED_PAD src0_sel:DWORD src1_sel:WORD_0
    v_lshlrev_b32_sdwa v98, 3, v126 dst_sel:DWORD dst_unused:UNUSED_PAD src0_sel:DWORD src1_sel:WORD_1
    ds_read_b64 v[96:97], v96
    ds_read_b64 v[98:99], v98
    v_mfma_f32_16x16x32_bf16 v[112:115], v[76:79], v[132:135], v[112:115]
    v_lshlrev_b32_sdwa v100, 3, v127 dst_sel:DWORD dst_unused:UNUSED_PAD src0_sel:DWORD src1_sel:WORD_0
    v_lshlrev_b32_sdwa v102, 3, v127 dst_sel:DWORD dst_unused:UNUSED_PAD src0_sel:DWORD src1_sel:WORD_1
    v_cvt_pk_bf16_f32 v62, v62, v63
    v_cvt_pk_bf16_f32 v63, v64, v65
    v_mov_b64 v[64:65], v[32:33]
    v_and_b32 v33, s23, v31
    v_lshlrev_b32 v32, 16, v31
    v_and_b32 v31, s23, v30
    v_lshlrev_b32 v30, 16, v30
    ds_read_b64 v[100:101], v100
    ds_read_b64 v[102:103], v102
    s_waitcnt lgkmcnt(8)
    v_smfmac_f32_16x16x64_bf16 v[30:33], v[66:69], v[104:111], v70
    v_mfma_f32_16x16x32_bf16 v[112:115], v[80:83], v[136:139], v[112:115]
    v_lshlrev_b32_sdwa v104, 3, v124 dst_sel:DWORD dst_unused:UNUSED_PAD src0_sel:DWORD src1_sel:WORD_0
    v_lshlrev_b32_sdwa v106, 3, v124 dst_sel:DWORD dst_unused:UNUSED_PAD src0_sel:DWORD src1_sel:WORD_1
    ds_read_b64 v[104:105], v104
    ds_read_b64 v[106:107], v106
    v_mfma_f32_16x16x32_bf16 v[112:115], v[84:87], v[140:143], v[112:115]
    v_lshlrev_b32_sdwa v108, 3, v125 dst_sel:DWORD dst_unused:UNUSED_PAD src0_sel:DWORD src1_sel:WORD_0
    v_lshlrev_b32_sdwa v110, 3, v125 dst_sel:DWORD dst_unused:UNUSED_PAD src0_sel:DWORD src1_sel:WORD_1
    ds_read_b64 v[108:109], v108
    ds_read_b64 v[110:111], v110
    s_add_u32 s20, s20, 0xfffff000
    buffer_load_dwordx4 v[124:127], v71, s[12:15], s20 offen offset:3072 sc1
    s_waitcnt lgkmcnt(8)
    v_smfmac_f32_16x16x64_bf16 v[30:33], v[66:69], v[88:95], v70
    v_cvt_pk_bf16_f32 v112, v112, v113
    v_cvt_pk_bf16_f32 v113, v114, v115
    v_lshlrev_b32_sdwa v114, 3, v70 dst_sel:DWORD dst_unused:UNUSED_PAD src0_sel:DWORD src1_sel:WORD_1
    ds_write_b64 v114, v[112:113] offset:32768
    s_waitcnt vmcnt(2)
    v_lshlrev_b32_sdwa v88, 3, v118 dst_sel:DWORD dst_unused:UNUSED_PAD src0_sel:DWORD src1_sel:WORD_0
    v_lshlrev_b32_sdwa v90, 3, v118 dst_sel:DWORD dst_unused:UNUSED_PAD src0_sel:DWORD src1_sel:WORD_1
    ds_read_b64 v[88:89], v88
    ds_read_b64 v[90:91], v90
    v_lshlrev_b32_sdwa v92, 3, v119 dst_sel:DWORD dst_unused:UNUSED_PAD src0_sel:DWORD src1_sel:WORD_0
    v_lshlrev_b32_sdwa v94, 3, v119 dst_sel:DWORD dst_unused:UNUSED_PAD src0_sel:DWORD src1_sel:WORD_1
    v_cvt_pk_bf16_f32 v33, v32, v33
    v_cvt_pk_bf16_f32 v32, v30, v31
    v_and_b32 v31, s23, v29
    v_lshlrev_b32 v30, 16, v29
    v_and_b32 v29, s23, v28
    v_lshlrev_b32 v28, 16, v28
    ds_read_b64 v[92:93], v92
    ds_read_b64 v[94:95], v94
    s_waitcnt lgkmcnt(9)
    v_smfmac_f32_16x16x64_bf16 v[28:31], v[66:69], v[96:103], v70
    v_mfma_f32_16x16x32_bf16 v[112:115], v[72:75], v[144:147], 0
    v_lshlrev_b32_sdwa v96, 3, v116 dst_sel:DWORD dst_unused:UNUSED_PAD src0_sel:DWORD src1_sel:WORD_0
    v_lshlrev_b32_sdwa v98, 3, v116 dst_sel:DWORD dst_unused:UNUSED_PAD src0_sel:DWORD src1_sel:WORD_1
    ds_read_b64 v[96:97], v96
    ds_read_b64 v[98:99], v98
    v_mfma_f32_16x16x32_bf16 v[112:115], v[76:79], v[148:151], v[112:115]
    v_lshlrev_b32_sdwa v100, 3, v117 dst_sel:DWORD dst_unused:UNUSED_PAD src0_sel:DWORD src1_sel:WORD_0
    v_lshlrev_b32_sdwa v102, 3, v117 dst_sel:DWORD dst_unused:UNUSED_PAD src0_sel:DWORD src1_sel:WORD_1
    ds_read_b64 v[100:101], v100
    ds_read_b64 v[102:103], v102
    buffer_load_dwordx4 v[116:119], v71, s[12:15], s20 offen offset:2048 sc1
    s_waitcnt lgkmcnt(9)
    v_smfmac_f32_16x16x64_bf16 v[28:31], v[66:69], v[104:111], v70
    v_mfma_f32_16x16x32_bf16 v[112:115], v[80:83], v[152:155], v[112:115]
    s_waitcnt vmcnt(2)
    v_lshlrev_b32_sdwa v104, 3, v122 dst_sel:DWORD dst_unused:UNUSED_PAD src0_sel:DWORD src1_sel:WORD_0
    v_lshlrev_b32_sdwa v106, 3, v122 dst_sel:DWORD dst_unused:UNUSED_PAD src0_sel:DWORD src1_sel:WORD_1
    ds_read_b64 v[104:105], v104
    ds_read_b64 v[106:107], v106
    v_mfma_f32_16x16x32_bf16 v[112:115], v[84:87], v[156:159], v[112:115]
    v_lshlrev_b32_sdwa v108, 3, v123 dst_sel:DWORD dst_unused:UNUSED_PAD src0_sel:DWORD src1_sel:WORD_0
    v_lshlrev_b32_sdwa v110, 3, v123 dst_sel:DWORD dst_unused:UNUSED_PAD src0_sel:DWORD src1_sel:WORD_1
    v_cvt_pk_bf16_f32 v31, v30, v31
    v_cvt_pk_bf16_f32 v30, v28, v29
    v_and_b32 v29, s23, v27
    v_lshlrev_b32 v28, 16, v27
    v_and_b32 v27, s23, v26
    v_lshlrev_b32 v26, 16, v26
    ds_read_b64 v[108:109], v108
    ds_read_b64 v[110:111], v110
    s_waitcnt lgkmcnt(8)
    v_smfmac_f32_16x16x64_bf16 v[26:29], v[66:69], v[88:95], v70
    v_cvt_pk_bf16_f32 v112, v112, v113
    v_cvt_pk_bf16_f32 v113, v114, v115
    v_lshlrev_b32_sdwa v114, 3, v70 dst_sel:DWORD dst_unused:UNUSED_PAD src0_sel:DWORD src1_sel:WORD_1
    ds_write_b64 v114, v[112:113] offset:32896
    v_lshlrev_b32_sdwa v88, 3, v120 dst_sel:DWORD dst_unused:UNUSED_PAD src0_sel:DWORD src1_sel:WORD_0
    v_lshlrev_b32_sdwa v90, 3, v120 dst_sel:DWORD dst_unused:UNUSED_PAD src0_sel:DWORD src1_sel:WORD_1
    ds_read_b64 v[88:89], v88
    ds_read_b64 v[90:91], v90
    v_lshlrev_b32_sdwa v92, 3, v121 dst_sel:DWORD dst_unused:UNUSED_PAD src0_sel:DWORD src1_sel:WORD_0
    v_lshlrev_b32_sdwa v94, 3, v121 dst_sel:DWORD dst_unused:UNUSED_PAD src0_sel:DWORD src1_sel:WORD_1
    ds_read_b64 v[92:93], v92
    ds_read_b64 v[94:95], v94
    buffer_load_dwordx4 v[120:123], v71, s[12:15], s20 offen offset:1024 sc1
    s_waitcnt lgkmcnt(9)
    v_smfmac_f32_16x16x64_bf16 v[26:29], v[66:69], v[96:103], v70
    v_mfma_f32_16x16x32_bf16 v[112:115], v[72:75], v[160:163], 0
    s_waitcnt vmcnt(2)
    v_lshlrev_b32_sdwa v96, 3, v126 dst_sel:DWORD dst_unused:UNUSED_PAD src0_sel:DWORD src1_sel:WORD_0
    v_lshlrev_b32_sdwa v98, 3, v126 dst_sel:DWORD dst_unused:UNUSED_PAD src0_sel:DWORD src1_sel:WORD_1
    ds_read_b64 v[96:97], v96
    ds_read_b64 v[98:99], v98
    v_mfma_f32_16x16x32_bf16 v[112:115], v[76:79], v[164:167], v[112:115]
    v_lshlrev_b32_sdwa v100, 3, v127 dst_sel:DWORD dst_unused:UNUSED_PAD src0_sel:DWORD src1_sel:WORD_0
    v_lshlrev_b32_sdwa v102, 3, v127 dst_sel:DWORD dst_unused:UNUSED_PAD src0_sel:DWORD src1_sel:WORD_1
    v_cvt_pk_bf16_f32 v29, v28, v29
    v_cvt_pk_bf16_f32 v28, v26, v27
    v_and_b32 v27, s23, v25
    v_lshlrev_b32 v26, 16, v25
    v_and_b32 v25, s23, v24
    v_lshlrev_b32 v24, 16, v24
    ds_read_b64 v[100:101], v100
    ds_read_b64 v[102:103], v102
    s_waitcnt lgkmcnt(9)
    v_smfmac_f32_16x16x64_bf16 v[24:27], v[66:69], v[104:111], v70
    v_mfma_f32_16x16x32_bf16 v[112:115], v[80:83], v[168:171], v[112:115]
    v_lshlrev_b32_sdwa v104, 3, v124 dst_sel:DWORD dst_unused:UNUSED_PAD src0_sel:DWORD src1_sel:WORD_0
    v_lshlrev_b32_sdwa v106, 3, v124 dst_sel:DWORD dst_unused:UNUSED_PAD src0_sel:DWORD src1_sel:WORD_1
    ds_read_b64 v[104:105], v104
    ds_read_b64 v[106:107], v106
    v_mfma_f32_16x16x32_bf16 v[112:115], v[84:87], v[172:175], v[112:115]
    v_lshlrev_b32_sdwa v108, 3, v125 dst_sel:DWORD dst_unused:UNUSED_PAD src0_sel:DWORD src1_sel:WORD_0
    v_lshlrev_b32_sdwa v110, 3, v125 dst_sel:DWORD dst_unused:UNUSED_PAD src0_sel:DWORD src1_sel:WORD_1
    ds_read_b64 v[108:109], v108
    ds_read_b64 v[110:111], v110
    buffer_load_dwordx4 v[124:127], v71, s[12:15], s20 offen offset:0 sc1
    s_waitcnt lgkmcnt(8)
    v_smfmac_f32_16x16x64_bf16 v[24:27], v[66:69], v[88:95], v70
    s_nop 0
    v_cvt_pk_bf16_f32 v112, v112, v113
    v_cvt_pk_bf16_f32 v113, v114, v115
    v_lshlrev_b32_sdwa v114, 3, v70 dst_sel:DWORD dst_unused:UNUSED_PAD src0_sel:DWORD src1_sel:WORD_1
    ds_write_b64 v114, v[112:113] offset:33024
    s_waitcnt vmcnt(2)
    v_lshlrev_b32_sdwa v88, 3, v118 dst_sel:DWORD dst_unused:UNUSED_PAD src0_sel:DWORD src1_sel:WORD_0
    v_lshlrev_b32_sdwa v90, 3, v118 dst_sel:DWORD dst_unused:UNUSED_PAD src0_sel:DWORD src1_sel:WORD_1
    ds_read_b64 v[88:89], v88
    ds_read_b64 v[90:91], v90
    v_lshlrev_b32_sdwa v92, 3, v119 dst_sel:DWORD dst_unused:UNUSED_PAD src0_sel:DWORD src1_sel:WORD_0
    v_lshlrev_b32_sdwa v94, 3, v119 dst_sel:DWORD dst_unused:UNUSED_PAD src0_sel:DWORD src1_sel:WORD_1
    v_cvt_pk_bf16_f32 v27, v26, v27
    v_cvt_pk_bf16_f32 v26, v24, v25
    v_and_b32 v25, s23, v23
    v_lshlrev_b32 v24, 16, v23
    v_and_b32 v23, s23, v22
    v_lshlrev_b32 v22, 16, v22
    ds_read_b64 v[92:93], v92
    ds_read_b64 v[94:95], v94
    s_waitcnt lgkmcnt(9)
    v_smfmac_f32_16x16x64_bf16 v[22:25], v[66:69], v[96:103], v70
    v_mfma_f32_16x16x32_bf16 v[112:115], v[72:75], v[176:179], 0
    v_lshlrev_b32_sdwa v96, 3, v116 dst_sel:DWORD dst_unused:UNUSED_PAD src0_sel:DWORD src1_sel:WORD_0
    v_lshlrev_b32_sdwa v98, 3, v116 dst_sel:DWORD dst_unused:UNUSED_PAD src0_sel:DWORD src1_sel:WORD_1
    ds_read_b64 v[96:97], v96
    ds_read_b64 v[98:99], v98
    v_mfma_f32_16x16x32_bf16 v[112:115], v[76:79], v[180:183], v[112:115]
    v_lshlrev_b32_sdwa v100, 3, v117 dst_sel:DWORD dst_unused:UNUSED_PAD src0_sel:DWORD src1_sel:WORD_0
    v_lshlrev_b32_sdwa v102, 3, v117 dst_sel:DWORD dst_unused:UNUSED_PAD src0_sel:DWORD src1_sel:WORD_1
    ds_read_b64 v[100:101], v100
    ds_read_b64 v[102:103], v102
    s_add_u32 s20, s20, 0xfffff000
    buffer_load_dwordx4 v[116:119], v71, s[12:15], s20 offen offset:3072 sc1
    s_waitcnt lgkmcnt(9)
    v_smfmac_f32_16x16x64_bf16 v[22:25], v[66:69], v[104:111], v70
    v_mfma_f32_16x16x32_bf16 v[112:115], v[80:83], v[184:187], v[112:115]
    s_waitcnt vmcnt(2)
    v_lshlrev_b32_sdwa v104, 3, v122 dst_sel:DWORD dst_unused:UNUSED_PAD src0_sel:DWORD src1_sel:WORD_0
    v_lshlrev_b32_sdwa v106, 3, v122 dst_sel:DWORD dst_unused:UNUSED_PAD src0_sel:DWORD src1_sel:WORD_1
    ds_read_b64 v[104:105], v104
    ds_read_b64 v[106:107], v106
    v_mfma_f32_16x16x32_bf16 v[112:115], v[84:87], v[188:191], v[112:115]
    v_lshlrev_b32_sdwa v108, 3, v123 dst_sel:DWORD dst_unused:UNUSED_PAD src0_sel:DWORD src1_sel:WORD_0
    v_lshlrev_b32_sdwa v110, 3, v123 dst_sel:DWORD dst_unused:UNUSED_PAD src0_sel:DWORD src1_sel:WORD_1
    v_cvt_pk_bf16_f32 v25, v24, v25
    v_cvt_pk_bf16_f32 v24, v22, v23
    v_and_b32 v23, s23, v21
    v_lshlrev_b32 v22, 16, v21
    v_and_b32 v21, s23, v20
    v_lshlrev_b32 v20, 16, v20
    ds_read_b64 v[108:109], v108
    ds_read_b64 v[110:111], v110
    s_waitcnt lgkmcnt(8)
    v_smfmac_f32_16x16x64_bf16 v[20:23], v[66:69], v[88:95], v70
    v_cvt_pk_bf16_f32 v112, v112, v113
    v_cvt_pk_bf16_f32 v113, v114, v115
    v_lshlrev_b32_sdwa v114, 3, v70 dst_sel:DWORD dst_unused:UNUSED_PAD src0_sel:DWORD src1_sel:WORD_1
    ds_write_b64 v114, v[112:113] offset:33152
    v_lshlrev_b32_sdwa v88, 3, v120 dst_sel:DWORD dst_unused:UNUSED_PAD src0_sel:DWORD src1_sel:WORD_0
    v_lshlrev_b32_sdwa v90, 3, v120 dst_sel:DWORD dst_unused:UNUSED_PAD src0_sel:DWORD src1_sel:WORD_1
    ds_read_b64 v[88:89], v88
    ds_read_b64 v[90:91], v90
    v_lshlrev_b32_sdwa v92, 3, v121 dst_sel:DWORD dst_unused:UNUSED_PAD src0_sel:DWORD src1_sel:WORD_0
    v_lshlrev_b32_sdwa v94, 3, v121 dst_sel:DWORD dst_unused:UNUSED_PAD src0_sel:DWORD src1_sel:WORD_1
    ds_read_b64 v[92:93], v92
    ds_read_b64 v[94:95], v94
    buffer_load_dwordx4 v[120:123], v71, s[12:15], s20 offen offset:2048 sc1
    s_waitcnt lgkmcnt(9)
    v_smfmac_f32_16x16x64_bf16 v[20:23], v[66:69], v[96:103], v70
    v_mfma_f32_16x16x32_bf16 v[112:115], v[72:75], v[192:195], 0
    s_waitcnt vmcnt(2)
    v_lshlrev_b32_sdwa v96, 3, v126 dst_sel:DWORD dst_unused:UNUSED_PAD src0_sel:DWORD src1_sel:WORD_0
    v_lshlrev_b32_sdwa v98, 3, v126 dst_sel:DWORD dst_unused:UNUSED_PAD src0_sel:DWORD src1_sel:WORD_1
    ds_read_b64 v[96:97], v96
    ds_read_b64 v[98:99], v98
    v_mfma_f32_16x16x32_bf16 v[112:115], v[76:79], v[196:199], v[112:115]
    v_lshlrev_b32_sdwa v100, 3, v127 dst_sel:DWORD dst_unused:UNUSED_PAD src0_sel:DWORD src1_sel:WORD_0
    v_lshlrev_b32_sdwa v102, 3, v127 dst_sel:DWORD dst_unused:UNUSED_PAD src0_sel:DWORD src1_sel:WORD_1
    v_cvt_pk_bf16_f32 v23, v22, v23
    v_cvt_pk_bf16_f32 v22, v20, v21
    v_and_b32 v21, s23, v19
    v_lshlrev_b32 v20, 16, v19
    v_and_b32 v19, s23, v18
    v_lshlrev_b32 v18, 16, v18
    ds_read_b64 v[100:101], v100
    ds_read_b64 v[102:103], v102
    s_waitcnt lgkmcnt(9)
    v_smfmac_f32_16x16x64_bf16 v[18:21], v[66:69], v[104:111], v70
    v_mfma_f32_16x16x32_bf16 v[112:115], v[80:83], v[200:203], v[112:115]
    v_lshlrev_b32_sdwa v104, 3, v124 dst_sel:DWORD dst_unused:UNUSED_PAD src0_sel:DWORD src1_sel:WORD_0
    v_lshlrev_b32_sdwa v106, 3, v124 dst_sel:DWORD dst_unused:UNUSED_PAD src0_sel:DWORD src1_sel:WORD_1
    ds_read_b64 v[104:105], v104
    ds_read_b64 v[106:107], v106
    v_mfma_f32_16x16x32_bf16 v[112:115], v[84:87], v[204:207], v[112:115]
    v_lshlrev_b32_sdwa v108, 3, v125 dst_sel:DWORD dst_unused:UNUSED_PAD src0_sel:DWORD src1_sel:WORD_0
    v_lshlrev_b32_sdwa v110, 3, v125 dst_sel:DWORD dst_unused:UNUSED_PAD src0_sel:DWORD src1_sel:WORD_1
    ds_read_b64 v[108:109], v108
    ds_read_b64 v[110:111], v110
    buffer_load_dwordx4 v[124:127], v71, s[12:15], s20 offen offset:1024 sc1
    s_waitcnt lgkmcnt(8)
    v_smfmac_f32_16x16x64_bf16 v[18:21], v[66:69], v[88:95], v70
    s_nop 0
    v_cvt_pk_bf16_f32 v112, v112, v113
    v_cvt_pk_bf16_f32 v113, v114, v115
    v_lshlrev_b32_sdwa v114, 3, v70 dst_sel:DWORD dst_unused:UNUSED_PAD src0_sel:DWORD src1_sel:WORD_1
    ds_write_b64 v114, v[112:113] offset:33280
    s_waitcnt vmcnt(2)
    v_lshlrev_b32_sdwa v88, 3, v118 dst_sel:DWORD dst_unused:UNUSED_PAD src0_sel:DWORD src1_sel:WORD_0
    v_lshlrev_b32_sdwa v90, 3, v118 dst_sel:DWORD dst_unused:UNUSED_PAD src0_sel:DWORD src1_sel:WORD_1
    ds_read_b64 v[88:89], v88
    ds_read_b64 v[90:91], v90
    v_lshlrev_b32_sdwa v92, 3, v119 dst_sel:DWORD dst_unused:UNUSED_PAD src0_sel:DWORD src1_sel:WORD_0
    v_lshlrev_b32_sdwa v94, 3, v119 dst_sel:DWORD dst_unused:UNUSED_PAD src0_sel:DWORD src1_sel:WORD_1
    v_cvt_pk_bf16_f32 v21, v20, v21
    v_cvt_pk_bf16_f32 v20, v18, v19
    v_and_b32 v19, s23, v17
    v_lshlrev_b32 v18, 16, v17
    v_and_b32 v17, s23, v16
    v_lshlrev_b32 v16, 16, v16
    ds_read_b64 v[92:93], v92
    ds_read_b64 v[94:95], v94
    s_waitcnt lgkmcnt(9)
    v_smfmac_f32_16x16x64_bf16 v[16:19], v[66:69], v[96:103], v70
    s_setprio 2
    v_mfma_f32_16x16x32_bf16 v[112:115], v[72:75], v[208:211], 0
    v_lshlrev_b32_sdwa v96, 3, v116 dst_sel:DWORD dst_unused:UNUSED_PAD src0_sel:DWORD src1_sel:WORD_0
    v_lshlrev_b32_sdwa v98, 3, v116 dst_sel:DWORD dst_unused:UNUSED_PAD src0_sel:DWORD src1_sel:WORD_1
    ds_read_b64 v[96:97], v96
    ds_read_b64 v[98:99], v98
    v_mfma_f32_16x16x32_bf16 v[112:115], v[76:79], v[212:215], v[112:115]
    v_lshlrev_b32_sdwa v100, 3, v117 dst_sel:DWORD dst_unused:UNUSED_PAD src0_sel:DWORD src1_sel:WORD_0
    v_lshlrev_b32_sdwa v102, 3, v117 dst_sel:DWORD dst_unused:UNUSED_PAD src0_sel:DWORD src1_sel:WORD_1
    ds_read_b64 v[100:101], v100
    ds_read_b64 v[102:103], v102
    buffer_load_dwordx4 v[116:119], v71, s[12:15], s20 offen offset:0 sc1
    s_waitcnt lgkmcnt(9)
    v_smfmac_f32_16x16x64_bf16 v[16:19], v[66:69], v[104:111], v70
    v_mfma_f32_16x16x32_bf16 v[112:115], v[80:83], v[216:219], v[112:115]
    s_waitcnt vmcnt(2)
    v_lshlrev_b32_sdwa v104, 3, v122 dst_sel:DWORD dst_unused:UNUSED_PAD src0_sel:DWORD src1_sel:WORD_0
    v_lshlrev_b32_sdwa v106, 3, v122 dst_sel:DWORD dst_unused:UNUSED_PAD src0_sel:DWORD src1_sel:WORD_1
    ds_read_b64 v[104:105], v104
    ds_read_b64 v[106:107], v106
    v_mfma_f32_16x16x32_bf16 v[112:115], v[84:87], v[220:223], v[112:115]
    v_lshlrev_b32_sdwa v108, 3, v123 dst_sel:DWORD dst_unused:UNUSED_PAD src0_sel:DWORD src1_sel:WORD_0
    v_lshlrev_b32_sdwa v110, 3, v123 dst_sel:DWORD dst_unused:UNUSED_PAD src0_sel:DWORD src1_sel:WORD_1
    v_cvt_pk_bf16_f32 v19, v18, v19
    v_cvt_pk_bf16_f32 v18, v16, v17
    v_and_b32 v17, s23, v15
    v_lshlrev_b32 v16, 16, v15
    v_and_b32 v15, s23, v14
    v_lshlrev_b32 v14, 16, v14
    ds_read_b64 v[108:109], v108
    ds_read_b64 v[110:111], v110
    s_waitcnt lgkmcnt(8)
    v_smfmac_f32_16x16x64_bf16 v[14:17], v[66:69], v[88:95], v70
    v_cvt_pk_bf16_f32 v112, v112, v113
    v_cvt_pk_bf16_f32 v113, v114, v115
    v_lshlrev_b32_sdwa v114, 3, v70 dst_sel:DWORD dst_unused:UNUSED_PAD src0_sel:DWORD src1_sel:WORD_1
    ds_write_b64 v114, v[112:113] offset:33408
    v_lshlrev_b32_sdwa v88, 3, v120 dst_sel:DWORD dst_unused:UNUSED_PAD src0_sel:DWORD src1_sel:WORD_0
    v_lshlrev_b32_sdwa v90, 3, v120 dst_sel:DWORD dst_unused:UNUSED_PAD src0_sel:DWORD src1_sel:WORD_1
    ds_read_b64 v[88:89], v88
    ds_read_b64 v[90:91], v90
    v_lshlrev_b32_sdwa v92, 3, v121 dst_sel:DWORD dst_unused:UNUSED_PAD src0_sel:DWORD src1_sel:WORD_0
    v_lshlrev_b32_sdwa v94, 3, v121 dst_sel:DWORD dst_unused:UNUSED_PAD src0_sel:DWORD src1_sel:WORD_1
    ds_read_b64 v[92:93], v92
    ds_read_b64 v[94:95], v94
    s_add_u32 s20, s20, 0xfffffc00
    buffer_load_dwordx4 v[120:123], v71, s[12:15], s20 offen offset:0 sc1
    s_waitcnt lgkmcnt(9)
    v_smfmac_f32_16x16x64_bf16 v[14:17], v[66:69], v[96:103], v70
    v_mfma_f32_16x16x32_bf16 v[112:115], v[72:75], v[224:227], 0
    s_waitcnt vmcnt(2)
    v_lshlrev_b32_sdwa v96, 3, v126 dst_sel:DWORD dst_unused:UNUSED_PAD src0_sel:DWORD src1_sel:WORD_0
    v_lshlrev_b32_sdwa v98, 3, v126 dst_sel:DWORD dst_unused:UNUSED_PAD src0_sel:DWORD src1_sel:WORD_1
    ds_read_b64 v[96:97], v96
    ds_read_b64 v[98:99], v98
    v_mfma_f32_16x16x32_bf16 v[112:115], v[76:79], v[228:231], v[112:115]
    v_lshlrev_b32_sdwa v100, 3, v127 dst_sel:DWORD dst_unused:UNUSED_PAD src0_sel:DWORD src1_sel:WORD_0
    v_lshlrev_b32_sdwa v102, 3, v127 dst_sel:DWORD dst_unused:UNUSED_PAD src0_sel:DWORD src1_sel:WORD_1
    v_cvt_pk_bf16_f32 v17, v16, v17
    v_cvt_pk_bf16_f32 v16, v14, v15
    v_and_b32 v15, s23, v13
    v_lshlrev_b32 v14, 16, v13
    v_and_b32 v13, s23, v12
    v_lshlrev_b32 v12, 16, v12
    ds_read_b64 v[100:101], v100
    ds_read_b64 v[102:103], v102
    s_waitcnt lgkmcnt(9)
    v_smfmac_f32_16x16x64_bf16 v[12:15], v[66:69], v[104:111], v70
    v_mfma_f32_16x16x32_bf16 v[112:115], v[80:83], v[232:235], v[112:115]
    v_lshlrev_b32_sdwa v104, 3, v124 dst_sel:DWORD dst_unused:UNUSED_PAD src0_sel:DWORD src1_sel:WORD_0
    v_lshlrev_b32_sdwa v106, 3, v124 dst_sel:DWORD dst_unused:UNUSED_PAD src0_sel:DWORD src1_sel:WORD_1
    ds_read_b64 v[104:105], v104
    ds_read_b64 v[106:107], v106
    v_mfma_f32_16x16x32_bf16 v[112:115], v[84:87], v[236:239], v[112:115]
    v_lshlrev_b32_sdwa v108, 3, v125 dst_sel:DWORD dst_unused:UNUSED_PAD src0_sel:DWORD src1_sel:WORD_0
    v_lshlrev_b32_sdwa v110, 3, v125 dst_sel:DWORD dst_unused:UNUSED_PAD src0_sel:DWORD src1_sel:WORD_1
    ds_read_b64 v[108:109], v108
    ds_read_b64 v[110:111], v110
    s_add_u32 s20, s20, 0xfffffc00
    buffer_load_dwordx4 v[124:127], v71, s[12:15], s20 offen offset:0 sc1
    s_waitcnt lgkmcnt(8)
    v_smfmac_f32_16x16x64_bf16 v[12:15], v[66:69], v[88:95], v70
    v_cvt_pk_bf16_f32 v112, v112, v113
    v_cvt_pk_bf16_f32 v113, v114, v115
    v_lshlrev_b32_sdwa v114, 3, v70 dst_sel:DWORD dst_unused:UNUSED_PAD src0_sel:DWORD src1_sel:WORD_1
    ds_write_b64 v114, v[112:113] offset:33536
    s_waitcnt vmcnt(2)
    v_lshlrev_b32_sdwa v88, 3, v118 dst_sel:DWORD dst_unused:UNUSED_PAD src0_sel:DWORD src1_sel:WORD_0
    v_lshlrev_b32_sdwa v90, 3, v118 dst_sel:DWORD dst_unused:UNUSED_PAD src0_sel:DWORD src1_sel:WORD_1
    ds_read_b64 v[88:89], v88
    ds_read_b64 v[90:91], v90
    v_lshlrev_b32_sdwa v92, 3, v119 dst_sel:DWORD dst_unused:UNUSED_PAD src0_sel:DWORD src1_sel:WORD_0
    v_lshlrev_b32_sdwa v94, 3, v119 dst_sel:DWORD dst_unused:UNUSED_PAD src0_sel:DWORD src1_sel:WORD_1
    v_cvt_pk_bf16_f32 v15, v14, v15
    v_cvt_pk_bf16_f32 v14, v12, v13
    v_and_b32 v13, s23, v11
    v_lshlrev_b32 v12, 16, v11
    v_and_b32 v11, s23, v10
    v_lshlrev_b32 v10, 16, v10
    ds_read_b64 v[92:93], v92
    ds_read_b64 v[94:95], v94
    s_waitcnt lgkmcnt(9)
    v_smfmac_f32_16x16x64_bf16 v[10:13], v[66:69], v[96:103], v70
    v_mfma_f32_16x16x32_bf16 v[112:115], v[72:75], v[240:243], 0
    buffer_load_dwordx4 v[72:75], v71, s[12:15], s21 offen offset:0
    v_lshlrev_b32_sdwa v96, 3, v116 dst_sel:DWORD dst_unused:UNUSED_PAD src0_sel:DWORD src1_sel:WORD_0
    v_lshlrev_b32_sdwa v98, 3, v116 dst_sel:DWORD dst_unused:UNUSED_PAD src0_sel:DWORD src1_sel:WORD_1
    ds_read_b64 v[96:97], v96
    ds_read_b64 v[98:99], v98
    v_mfma_f32_16x16x32_bf16 v[112:115], v[76:79], v[244:247], v[112:115]
    buffer_load_dwordx4 v[76:79], v71, s[12:15], s21 offen offset:1024
    v_lshlrev_b32_sdwa v100, 3, v117 dst_sel:DWORD dst_unused:UNUSED_PAD src0_sel:DWORD src1_sel:WORD_0
    v_lshlrev_b32_sdwa v102, 3, v117 dst_sel:DWORD dst_unused:UNUSED_PAD src0_sel:DWORD src1_sel:WORD_1
    ds_read_b64 v[100:101], v100
    ds_read_b64 v[102:103], v102
    s_add_u32 s20, s20, 0x3c00
    buffer_load_dwordx4 v[116:119], v71, s[12:15], s20 offen offset:0 sc1
    s_waitcnt lgkmcnt(9)
    v_smfmac_f32_16x16x64_bf16 v[10:13], v[66:69], v[104:111], v70
    v_mfma_f32_16x16x32_bf16 v[112:115], v[80:83], v[248:251], v[112:115]
    buffer_load_dwordx4 v[80:83], v71, s[12:15], s19 offen offset:0
    s_waitcnt vmcnt(5)
    v_lshlrev_b32_sdwa v104, 3, v122 dst_sel:DWORD dst_unused:UNUSED_PAD src0_sel:DWORD src1_sel:WORD_0
    v_lshlrev_b32_sdwa v106, 3, v122 dst_sel:DWORD dst_unused:UNUSED_PAD src0_sel:DWORD src1_sel:WORD_1
    ds_read_b64 v[104:105], v104
    ds_read_b64 v[106:107], v106
    v_mfma_f32_16x16x32_bf16 v[112:115], v[84:87], v[252:255], v[112:115]
    buffer_load_dwordx4 v[84:87], v71, s[12:15], s19 offen offset:1024
    s_add_u32 s21, s21, 4096
    s_add_u32 s19, s19, 4096
    v_lshlrev_b32_sdwa v108, 3, v123 dst_sel:DWORD dst_unused:UNUSED_PAD src0_sel:DWORD src1_sel:WORD_0
    v_lshlrev_b32_sdwa v110, 3, v123 dst_sel:DWORD dst_unused:UNUSED_PAD src0_sel:DWORD src1_sel:WORD_1
    v_cvt_pk_bf16_f32 v13, v12, v13
    v_cvt_pk_bf16_f32 v12, v10, v11
    v_and_b32 v11, s23, v9
    v_lshlrev_b32 v10, 16, v9
    v_and_b32 v9, s23, v8
    v_lshlrev_b32 v8, 16, v8
    ds_read_b64 v[108:109], v108
    ds_read_b64 v[110:111], v110
    s_waitcnt lgkmcnt(8)
    v_smfmac_f32_16x16x64_bf16 v[8:11], v[66:69], v[88:95], v70
    v_cvt_pk_bf16_f32 v112, v112, v113
    v_cvt_pk_bf16_f32 v113, v114, v115
    v_lshlrev_b32_sdwa v114, 3, v70 dst_sel:DWORD dst_unused:UNUSED_PAD src0_sel:DWORD src1_sel:WORD_1
    ds_write_b64 v114, v[112:113] offset:33664
    s_setprio 1
    v_lshlrev_b32_sdwa v88, 3, v120 dst_sel:DWORD dst_unused:UNUSED_PAD src0_sel:DWORD src1_sel:WORD_0
    v_lshlrev_b32_sdwa v90, 3, v120 dst_sel:DWORD dst_unused:UNUSED_PAD src0_sel:DWORD src1_sel:WORD_1
    ds_read_b64 v[88:89], v88
    ds_read_b64 v[90:91], v90
    v_lshlrev_b32_sdwa v92, 3, v121 dst_sel:DWORD dst_unused:UNUSED_PAD src0_sel:DWORD src1_sel:WORD_0
    v_lshlrev_b32_sdwa v94, 3, v121 dst_sel:DWORD dst_unused:UNUSED_PAD src0_sel:DWORD src1_sel:WORD_1
    ds_read_b64 v[92:93], v92
    ds_read_b64 v[94:95], v94
    s_add_u32 s20, s20, 0xfffffc00
    buffer_load_dwordx4 v[120:123], v71, s[12:15], s20 offen offset:0 sc1
    s_waitcnt lgkmcnt(9)
    v_smfmac_f32_16x16x64_bf16 v[8:11], v[66:69], v[96:103], v70
    s_waitcnt vmcnt(6)
    v_lshlrev_b32_sdwa v96, 3, v126 dst_sel:DWORD dst_unused:UNUSED_PAD src0_sel:DWORD src1_sel:WORD_0
    v_lshlrev_b32_sdwa v98, 3, v126 dst_sel:DWORD dst_unused:UNUSED_PAD src0_sel:DWORD src1_sel:WORD_1
    ds_read_b64 v[96:97], v96
    ds_read_b64 v[98:99], v98
    v_lshlrev_b32_sdwa v100, 3, v127 dst_sel:DWORD dst_unused:UNUSED_PAD src0_sel:DWORD src1_sel:WORD_0
    v_lshlrev_b32_sdwa v102, 3, v127 dst_sel:DWORD dst_unused:UNUSED_PAD src0_sel:DWORD src1_sel:WORD_1
    s_nop 0
    v_cvt_pk_bf16_f32 v11, v10, v11
    v_cvt_pk_bf16_f32 v10, v8, v9
    v_and_b32 v9, s23, v7
    v_lshlrev_b32 v8, 16, v7
    v_and_b32 v7, s23, v6
    v_lshlrev_b32 v6, 16, v6
    ds_read_b64 v[100:101], v100
    ds_read_b64 v[102:103], v102
    s_waitcnt lgkmcnt(9)
    v_smfmac_f32_16x16x64_bf16 v[6:9], v[66:69], v[104:111], v70
    v_lshlrev_b32_sdwa v104, 3, v124 dst_sel:DWORD dst_unused:UNUSED_PAD src0_sel:DWORD src1_sel:WORD_0
    v_lshlrev_b32_sdwa v106, 3, v124 dst_sel:DWORD dst_unused:UNUSED_PAD src0_sel:DWORD src1_sel:WORD_1
    ds_read_b64 v[104:105], v104
    ds_read_b64 v[106:107], v106
    v_lshlrev_b32_sdwa v108, 3, v125 dst_sel:DWORD dst_unused:UNUSED_PAD src0_sel:DWORD src1_sel:WORD_0
    v_lshlrev_b32_sdwa v110, 3, v125 dst_sel:DWORD dst_unused:UNUSED_PAD src0_sel:DWORD src1_sel:WORD_1
    ds_read_b64 v[108:109], v108
    ds_read_b64 v[110:111], v110
    s_add_u32 s20, s20, 0x1f000
    buffer_load_dwordx4 v[124:127], v71, s[12:15], s20 offen offset:3072 sc1
    s_waitcnt lgkmcnt(8)
    v_smfmac_f32_16x16x64_bf16 v[6:9], v[66:69], v[88:95], v70
    s_waitcnt vmcnt(4)
    v_lshlrev_b32_sdwa v88, 3, v118 dst_sel:DWORD dst_unused:UNUSED_PAD src0_sel:DWORD src1_sel:WORD_0
    v_lshlrev_b32_sdwa v90, 3, v118 dst_sel:DWORD dst_unused:UNUSED_PAD src0_sel:DWORD src1_sel:WORD_1
    ds_read_b64 v[88:89], v88
    ds_read_b64 v[90:91], v90
    v_lshlrev_b32_sdwa v92, 3, v119 dst_sel:DWORD dst_unused:UNUSED_PAD src0_sel:DWORD src1_sel:WORD_0
    v_lshlrev_b32_sdwa v94, 3, v119 dst_sel:DWORD dst_unused:UNUSED_PAD src0_sel:DWORD src1_sel:WORD_1
    s_nop 0
    v_cvt_pk_bf16_f32 v9, v8, v9
    v_cvt_pk_bf16_f32 v8, v6, v7
    v_and_b32 v7, s23, v5
    v_lshlrev_b32 v6, 16, v5
    v_and_b32 v5, s23, v4
    v_lshlrev_b32 v4, 16, v4
    ds_read_b64 v[92:93], v92
    ds_read_b64 v[94:95], v94
    s_waitcnt lgkmcnt(8)
    v_smfmac_f32_16x16x64_bf16 v[4:7], v[66:69], v[96:103], v70
    v_lshlrev_b32_sdwa v96, 3, v116 dst_sel:DWORD dst_unused:UNUSED_PAD src0_sel:DWORD src1_sel:WORD_0
    v_lshlrev_b32_sdwa v98, 3, v116 dst_sel:DWORD dst_unused:UNUSED_PAD src0_sel:DWORD src1_sel:WORD_1
    ds_read_b64 v[96:97], v96
    ds_read_b64 v[98:99], v98
    v_lshlrev_b32_sdwa v100, 3, v117 dst_sel:DWORD dst_unused:UNUSED_PAD src0_sel:DWORD src1_sel:WORD_0
    v_lshlrev_b32_sdwa v102, 3, v117 dst_sel:DWORD dst_unused:UNUSED_PAD src0_sel:DWORD src1_sel:WORD_1
    ds_read_b64 v[100:101], v100
    ds_read_b64 v[102:103], v102
    buffer_load_dwordx4 v[116:119], v71, s[12:15], s20 offen offset:2048 sc1
    s_waitcnt lgkmcnt(8)
    v_smfmac_f32_16x16x64_bf16 v[4:7], v[66:69], v[104:111], v70
    s_waitcnt vmcnt(2)
    v_lshlrev_b32_sdwa v104, 3, v122 dst_sel:DWORD dst_unused:UNUSED_PAD src0_sel:DWORD src1_sel:WORD_0
    v_lshlrev_b32_sdwa v106, 3, v122 dst_sel:DWORD dst_unused:UNUSED_PAD src0_sel:DWORD src1_sel:WORD_1
    ds_read_b64 v[104:105], v104
    ds_read_b64 v[106:107], v106
    v_lshlrev_b32_sdwa v108, 3, v123 dst_sel:DWORD dst_unused:UNUSED_PAD src0_sel:DWORD src1_sel:WORD_0
    v_lshlrev_b32_sdwa v110, 3, v123 dst_sel:DWORD dst_unused:UNUSED_PAD src0_sel:DWORD src1_sel:WORD_1
    s_nop 0
    v_cvt_pk_bf16_f32 v7, v6, v7
    v_cvt_pk_bf16_f32 v6, v4, v5
    v_and_b32 v5, s23, v3
    v_lshlrev_b32 v4, 16, v3
    v_and_b32 v3, s23, v2
    v_lshlrev_b32 v2, 16, v2
    ds_read_b64 v[108:109], v108
    ds_read_b64 v[110:111], v110
    s_waitcnt lgkmcnt(8)
    v_smfmac_f32_16x16x64_bf16 v[2:5], v[66:69], v[88:95], v70
    s_setprio 0
    v_lshlrev_b32_sdwa v88, 3, v120 dst_sel:DWORD dst_unused:UNUSED_PAD src0_sel:DWORD src1_sel:WORD_0
    v_lshlrev_b32_sdwa v90, 3, v120 dst_sel:DWORD dst_unused:UNUSED_PAD src0_sel:DWORD src1_sel:WORD_1
    ds_read_b64 v[88:89], v88
    ds_read_b64 v[90:91], v90
    v_lshlrev_b32_sdwa v92, 3, v121 dst_sel:DWORD dst_unused:UNUSED_PAD src0_sel:DWORD src1_sel:WORD_0
    v_lshlrev_b32_sdwa v94, 3, v121 dst_sel:DWORD dst_unused:UNUSED_PAD src0_sel:DWORD src1_sel:WORD_1
    ds_read_b64 v[92:93], v92
    ds_read_b64 v[94:95], v94
    buffer_load_dwordx4 v[120:123], v71, s[12:15], s20 offen offset:1024 sc1
    s_waitcnt lgkmcnt(8)
    v_smfmac_f32_16x16x64_bf16 v[2:5], v[66:69], v[96:103], v70
    s_waitcnt vmcnt(2)
    v_lshlrev_b32_sdwa v96, 3, v124 dst_sel:DWORD dst_unused:UNUSED_PAD src0_sel:DWORD src1_sel:WORD_0
    v_lshlrev_b32_sdwa v98, 3, v124 dst_sel:DWORD dst_unused:UNUSED_PAD src0_sel:DWORD src1_sel:WORD_1
    ds_read_b64 v[96:97], v96
    ds_read_b64 v[98:99], v98
    v_lshlrev_b32_sdwa v100, 3, v125 dst_sel:DWORD dst_unused:UNUSED_PAD src0_sel:DWORD src1_sel:WORD_0
    v_lshlrev_b32_sdwa v102, 3, v125 dst_sel:DWORD dst_unused:UNUSED_PAD src0_sel:DWORD src1_sel:WORD_1
    s_nop 0
    v_cvt_pk_bf16_f32 v5, v4, v5
    v_cvt_pk_bf16_f32 v4, v2, v3
    v_and_b32 v3, s23, v1
    v_lshlrev_b32 v2, 16, v1
    v_and_b32 v1, s23, v0
    v_lshlrev_b32 v0, 16, v0
    ds_read_b64 v[100:101], v100
    ds_read_b64 v[102:103], v102
    s_waitcnt lgkmcnt(8)
    v_smfmac_f32_16x16x64_bf16 v[0:3], v[66:69], v[104:111], v70
    s_waitcnt lgkmcnt(4)
    s_barrier
    s_setprio 3
    v_lshlrev_b32_sdwa v104, 3, v126 dst_sel:DWORD dst_unused:UNUSED_PAD src0_sel:DWORD src1_sel:WORD_0
    v_lshlrev_b32_sdwa v106, 3, v126 dst_sel:DWORD dst_unused:UNUSED_PAD src0_sel:DWORD src1_sel:WORD_1
    ds_read_b64 v[104:105], v104
    ds_read_b64 v[106:107], v106
    v_lshlrev_b32_sdwa v108, 3, v127 dst_sel:DWORD dst_unused:UNUSED_PAD src0_sel:DWORD src1_sel:WORD_0
    v_lshlrev_b32_sdwa v110, 3, v127 dst_sel:DWORD dst_unused:UNUSED_PAD src0_sel:DWORD src1_sel:WORD_1
    ds_read_b64 v[108:109], v108
    ds_read_b64 v[110:111], v110
    buffer_load_dwordx4 v[124:127], v71, s[12:15], s20 offen offset:0 sc1
    v_smfmac_f32_16x16x64_bf16 v[0:3], v[66:69], v[88:95], v70
    v_mfma_f32_16x16x32_bf16 v[112:115], v[72:75], v[128:131], 0
    v_mfma_f32_16x16x32_bf16 v[112:115], v[76:79], v[132:135], v[112:115]
    s_nop 0
    v_add_u32 v70, 0x20000000, v70
    s_waitcnt vmcnt(2)
    v_lshlrev_b32_sdwa v88, 3, v116 dst_sel:DWORD dst_unused:UNUSED_PAD src0_sel:DWORD src1_sel:WORD_0
    v_lshlrev_b32_sdwa v90, 3, v116 dst_sel:DWORD dst_unused:UNUSED_PAD src0_sel:DWORD src1_sel:WORD_1
    ds_read_b64 v[88:89], v88
    ds_read_b64 v[90:91], v90
    v_mfma_f32_16x16x32_bf16 v[112:115], v[80:83], v[136:139], v[112:115]
    v_mfma_f32_16x16x32_bf16 v[112:115], v[84:87], v[140:143], v[112:115]
    v_lshlrev_b32_sdwa v92, 3, v117 dst_sel:DWORD dst_unused:UNUSED_PAD src0_sel:DWORD src1_sel:WORD_0
    v_lshlrev_b32_sdwa v94, 3, v117 dst_sel:DWORD dst_unused:UNUSED_PAD src0_sel:DWORD src1_sel:WORD_1
    v_cvt_pk_bf16_f32 v3, v2, v3
    v_cvt_pk_bf16_f32 v2, v0, v1
    v_mov_b64 v[0:1], v[32:33]
    v_lshlrev_b32 v32, 16, v34
    v_and_b32 v33, s23, v34
    v_lshlrev_b32 v34, 16, v35
    v_and_b32 v35, s23, v35
    ds_read_b64 v[92:93], v92
    ds_read_b64 v[94:95], v94
    s_waitcnt lgkmcnt(8)
    v_smfmac_f32_16x16x64_bf16 v[32:35], v[66:69], v[96:103], v70
    v_cvt_pk_bf16_f32 v112, v112, v113
    v_cvt_pk_bf16_f32 v113, v114, v115
    v_lshlrev_b32_sdwa v114, 3, v70 dst_sel:DWORD dst_unused:UNUSED_PAD src0_sel:DWORD src1_sel:WORD_1
    ds_write_b64 v114, v[112:113] offset:0
    v_mfma_f32_16x16x32_bf16 v[112:115], v[72:75], v[144:147], 0
    v_mfma_f32_16x16x32_bf16 v[112:115], v[76:79], v[148:151], v[112:115]
    v_lshlrev_b32_sdwa v96, 3, v118 dst_sel:DWORD dst_unused:UNUSED_PAD src0_sel:DWORD src1_sel:WORD_0
    v_lshlrev_b32_sdwa v98, 3, v118 dst_sel:DWORD dst_unused:UNUSED_PAD src0_sel:DWORD src1_sel:WORD_1
    ds_read_b64 v[96:97], v96
    ds_read_b64 v[98:99], v98
    v_mfma_f32_16x16x32_bf16 v[112:115], v[80:83], v[152:155], v[112:115]
    v_mfma_f32_16x16x32_bf16 v[112:115], v[84:87], v[156:159], v[112:115]
    v_lshlrev_b32_sdwa v100, 3, v119 dst_sel:DWORD dst_unused:UNUSED_PAD src0_sel:DWORD src1_sel:WORD_0
    v_lshlrev_b32_sdwa v102, 3, v119 dst_sel:DWORD dst_unused:UNUSED_PAD src0_sel:DWORD src1_sel:WORD_1
    ds_read_b64 v[100:101], v100
    ds_read_b64 v[102:103], v102
    s_add_u32 s20, s20, 0xfffff000
    buffer_load_dwordx4 v[116:119], v71, s[12:15], s20 offen offset:3072 sc1
    s_waitcnt lgkmcnt(9)
    v_smfmac_f32_16x16x64_bf16 v[32:35], v[66:69], v[104:111], v70
    v_cvt_pk_bf16_f32 v112, v112, v113
    v_cvt_pk_bf16_f32 v113, v114, v115
    v_lshlrev_b32_sdwa v114, 3, v70 dst_sel:DWORD dst_unused:UNUSED_PAD src0_sel:DWORD src1_sel:WORD_1
    ds_write_b64 v114, v[112:113] offset:128
    v_mfma_f32_16x16x32_bf16 v[112:115], v[72:75], v[160:163], 0
    v_mfma_f32_16x16x32_bf16 v[112:115], v[76:79], v[164:167], v[112:115]
    s_waitcnt vmcnt(2)
    v_lshlrev_b32_sdwa v104, 3, v120 dst_sel:DWORD dst_unused:UNUSED_PAD src0_sel:DWORD src1_sel:WORD_0
    v_lshlrev_b32_sdwa v106, 3, v120 dst_sel:DWORD dst_unused:UNUSED_PAD src0_sel:DWORD src1_sel:WORD_1
    ds_read_b64 v[104:105], v104
    ds_read_b64 v[106:107], v106
    v_mfma_f32_16x16x32_bf16 v[112:115], v[80:83], v[168:171], v[112:115]
    v_mfma_f32_16x16x32_bf16 v[112:115], v[84:87], v[172:175], v[112:115]
    v_lshlrev_b32_sdwa v108, 3, v121 dst_sel:DWORD dst_unused:UNUSED_PAD src0_sel:DWORD src1_sel:WORD_0
    v_lshlrev_b32_sdwa v110, 3, v121 dst_sel:DWORD dst_unused:UNUSED_PAD src0_sel:DWORD src1_sel:WORD_1
    v_cvt_pk_bf16_f32 v32, v32, v33
    v_cvt_pk_bf16_f32 v33, v34, v35
    v_lshlrev_b32 v34, 16, v36
    v_and_b32 v35, s23, v36
    v_lshlrev_b32 v36, 16, v37
    v_and_b32 v37, s23, v37
    ds_read_b64 v[108:109], v108
    ds_read_b64 v[110:111], v110
    s_waitcnt lgkmcnt(10)
    v_smfmac_f32_16x16x64_bf16 v[34:37], v[66:69], v[88:95], v70
    v_cvt_pk_bf16_f32 v112, v112, v113
    v_cvt_pk_bf16_f32 v113, v114, v115
    v_lshlrev_b32_sdwa v114, 3, v70 dst_sel:DWORD dst_unused:UNUSED_PAD src0_sel:DWORD src1_sel:WORD_1
    ds_write_b64 v114, v[112:113] offset:256
    v_mfma_f32_16x16x32_bf16 v[112:115], v[72:75], v[176:179], 0
    v_mfma_f32_16x16x32_bf16 v[112:115], v[76:79], v[180:183], v[112:115]
    v_lshlrev_b32_sdwa v88, 3, v122 dst_sel:DWORD dst_unused:UNUSED_PAD src0_sel:DWORD src1_sel:WORD_0
    v_lshlrev_b32_sdwa v90, 3, v122 dst_sel:DWORD dst_unused:UNUSED_PAD src0_sel:DWORD src1_sel:WORD_1
    ds_read_b64 v[88:89], v88
    ds_read_b64 v[90:91], v90
    v_mfma_f32_16x16x32_bf16 v[112:115], v[80:83], v[184:187], v[112:115]
    v_mfma_f32_16x16x32_bf16 v[112:115], v[84:87], v[188:191], v[112:115]
    v_lshlrev_b32_sdwa v92, 3, v123 dst_sel:DWORD dst_unused:UNUSED_PAD src0_sel:DWORD src1_sel:WORD_0
    v_lshlrev_b32_sdwa v94, 3, v123 dst_sel:DWORD dst_unused:UNUSED_PAD src0_sel:DWORD src1_sel:WORD_1
    ds_read_b64 v[92:93], v92
    ds_read_b64 v[94:95], v94
    buffer_load_dwordx4 v[120:123], v71, s[12:15], s20 offen offset:2048 sc1
    s_waitcnt lgkmcnt(10)
    v_smfmac_f32_16x16x64_bf16 v[34:37], v[66:69], v[96:103], v70
    s_nop 0
    v_cvt_pk_bf16_f32 v112, v112, v113
    v_cvt_pk_bf16_f32 v113, v114, v115
    v_lshlrev_b32_sdwa v114, 3, v70 dst_sel:DWORD dst_unused:UNUSED_PAD src0_sel:DWORD src1_sel:WORD_1
    ds_write_b64 v114, v[112:113] offset:384
    v_mfma_f32_16x16x32_bf16 v[112:115], v[72:75], v[192:195], 0
    v_mfma_f32_16x16x32_bf16 v[112:115], v[76:79], v[196:199], v[112:115]
    s_waitcnt vmcnt(2)
    v_lshlrev_b32_sdwa v96, 3, v124 dst_sel:DWORD dst_unused:UNUSED_PAD src0_sel:DWORD src1_sel:WORD_0
    v_lshlrev_b32_sdwa v98, 3, v124 dst_sel:DWORD dst_unused:UNUSED_PAD src0_sel:DWORD src1_sel:WORD_1
    ds_read_b64 v[96:97], v96
    ds_read_b64 v[98:99], v98
    v_mfma_f32_16x16x32_bf16 v[112:115], v[80:83], v[200:203], v[112:115]
    v_mfma_f32_16x16x32_bf16 v[112:115], v[84:87], v[204:207], v[112:115]
    v_lshlrev_b32_sdwa v100, 3, v125 dst_sel:DWORD dst_unused:UNUSED_PAD src0_sel:DWORD src1_sel:WORD_0
    v_lshlrev_b32_sdwa v102, 3, v125 dst_sel:DWORD dst_unused:UNUSED_PAD src0_sel:DWORD src1_sel:WORD_1
    v_cvt_pk_bf16_f32 v34, v34, v35
    v_cvt_pk_bf16_f32 v35, v36, v37
    v_lshlrev_b32 v36, 16, v38
    v_and_b32 v37, s23, v38
    v_lshlrev_b32 v38, 16, v39
    v_and_b32 v39, s23, v39
    ds_read_b64 v[100:101], v100
    ds_read_b64 v[102:103], v102
    s_waitcnt lgkmcnt(10)
    v_smfmac_f32_16x16x64_bf16 v[36:39], v[66:69], v[104:111], v70
    v_cvt_pk_bf16_f32 v112, v112, v113
    v_cvt_pk_bf16_f32 v113, v114, v115
    v_lshlrev_b32_sdwa v114, 3, v70 dst_sel:DWORD dst_unused:UNUSED_PAD src0_sel:DWORD src1_sel:WORD_1
    ds_write_b64 v114, v[112:113] offset:512
    v_mfma_f32_16x16x32_bf16 v[112:115], v[72:75], v[208:211], 0
    v_mfma_f32_16x16x32_bf16 v[112:115], v[76:79], v[212:215], v[112:115]
    v_lshlrev_b32_sdwa v104, 3, v126 dst_sel:DWORD dst_unused:UNUSED_PAD src0_sel:DWORD src1_sel:WORD_0
    v_lshlrev_b32_sdwa v106, 3, v126 dst_sel:DWORD dst_unused:UNUSED_PAD src0_sel:DWORD src1_sel:WORD_1
    ds_read_b64 v[104:105], v104
    ds_read_b64 v[106:107], v106
    v_mfma_f32_16x16x32_bf16 v[112:115], v[80:83], v[216:219], v[112:115]
    v_mfma_f32_16x16x32_bf16 v[112:115], v[84:87], v[220:223], v[112:115]
    v_lshlrev_b32_sdwa v108, 3, v127 dst_sel:DWORD dst_unused:UNUSED_PAD src0_sel:DWORD src1_sel:WORD_0
    v_lshlrev_b32_sdwa v110, 3, v127 dst_sel:DWORD dst_unused:UNUSED_PAD src0_sel:DWORD src1_sel:WORD_1
    ds_read_b64 v[108:109], v108
    ds_read_b64 v[110:111], v110
    buffer_load_dwordx4 v[124:127], v71, s[12:15], s20 offen offset:1024 sc1
    s_waitcnt lgkmcnt(10)
    v_smfmac_f32_16x16x64_bf16 v[36:39], v[66:69], v[88:95], v70
    s_nop 0
    v_cvt_pk_bf16_f32 v112, v112, v113
    v_cvt_pk_bf16_f32 v113, v114, v115
    v_lshlrev_b32_sdwa v114, 3, v70 dst_sel:DWORD dst_unused:UNUSED_PAD src0_sel:DWORD src1_sel:WORD_1
    ds_write_b64 v114, v[112:113] offset:640
    v_mfma_f32_16x16x32_bf16 v[112:115], v[72:75], v[224:227], 0
    v_mfma_f32_16x16x32_bf16 v[112:115], v[76:79], v[228:231], v[112:115]
    s_waitcnt vmcnt(2)
    v_lshlrev_b32_sdwa v88, 3, v116 dst_sel:DWORD dst_unused:UNUSED_PAD src0_sel:DWORD src1_sel:WORD_0
    v_lshlrev_b32_sdwa v90, 3, v116 dst_sel:DWORD dst_unused:UNUSED_PAD src0_sel:DWORD src1_sel:WORD_1
    ds_read_b64 v[88:89], v88
    ds_read_b64 v[90:91], v90
    v_mfma_f32_16x16x32_bf16 v[112:115], v[80:83], v[232:235], v[112:115]
    v_mfma_f32_16x16x32_bf16 v[112:115], v[84:87], v[236:239], v[112:115]
    v_lshlrev_b32_sdwa v92, 3, v117 dst_sel:DWORD dst_unused:UNUSED_PAD src0_sel:DWORD src1_sel:WORD_0
    v_lshlrev_b32_sdwa v94, 3, v117 dst_sel:DWORD dst_unused:UNUSED_PAD src0_sel:DWORD src1_sel:WORD_1
    v_cvt_pk_bf16_f32 v36, v36, v37
    v_cvt_pk_bf16_f32 v37, v38, v39
    v_lshlrev_b32 v38, 16, v40
    v_and_b32 v39, s23, v40
    v_lshlrev_b32 v40, 16, v41
    v_and_b32 v41, s23, v41
    ds_read_b64 v[92:93], v92
    ds_read_b64 v[94:95], v94
    s_waitcnt lgkmcnt(10)
    v_smfmac_f32_16x16x64_bf16 v[38:41], v[66:69], v[96:103], v70
    v_cvt_pk_bf16_f32 v112, v112, v113
    v_cvt_pk_bf16_f32 v113, v114, v115
    v_lshlrev_b32_sdwa v114, 3, v70 dst_sel:DWORD dst_unused:UNUSED_PAD src0_sel:DWORD src1_sel:WORD_1
    ds_write_b64 v114, v[112:113] offset:768
    v_mfma_f32_16x16x32_bf16 v[112:115], v[72:75], v[240:243], 0
    buffer_load_dwordx4 v[72:75], v71, s[12:15], s21 offen offset:0
    v_mfma_f32_16x16x32_bf16 v[112:115], v[76:79], v[244:247], v[112:115]
    buffer_load_dwordx4 v[76:79], v71, s[12:15], s21 offen offset:1024
    v_lshlrev_b32_sdwa v96, 3, v118 dst_sel:DWORD dst_unused:UNUSED_PAD src0_sel:DWORD src1_sel:WORD_0
    v_lshlrev_b32_sdwa v98, 3, v118 dst_sel:DWORD dst_unused:UNUSED_PAD src0_sel:DWORD src1_sel:WORD_1
    ds_read_b64 v[96:97], v96
    ds_read_b64 v[98:99], v98
    v_mfma_f32_16x16x32_bf16 v[112:115], v[80:83], v[248:251], v[112:115]
    buffer_load_dwordx4 v[80:83], v71, s[12:15], s19 offen offset:0
    v_mfma_f32_16x16x32_bf16 v[112:115], v[84:87], v[252:255], v[112:115]
    buffer_load_dwordx4 v[84:87], v71, s[12:15], s19 offen offset:1024
    s_add_u32 s21, s21, 4096
    s_add_u32 s19, s19, 4096
    v_lshlrev_b32_sdwa v100, 3, v119 dst_sel:DWORD dst_unused:UNUSED_PAD src0_sel:DWORD src1_sel:WORD_0
    v_lshlrev_b32_sdwa v102, 3, v119 dst_sel:DWORD dst_unused:UNUSED_PAD src0_sel:DWORD src1_sel:WORD_1
    ds_read_b64 v[100:101], v100
    ds_read_b64 v[102:103], v102
    buffer_load_dwordx4 v[116:119], v71, s[12:15], s20 offen offset:0 sc1
    s_waitcnt lgkmcnt(10)
    v_smfmac_f32_16x16x64_bf16 v[38:41], v[66:69], v[104:111], v70
    v_cvt_pk_bf16_f32 v112, v112, v113
    v_cvt_pk_bf16_f32 v113, v114, v115
    v_lshlrev_b32_sdwa v114, 3, v70 dst_sel:DWORD dst_unused:UNUSED_PAD src0_sel:DWORD src1_sel:WORD_1
    ds_write_b64 v114, v[112:113] offset:896
    s_waitcnt vmcnt(6)
    v_lshlrev_b32_sdwa v104, 3, v120 dst_sel:DWORD dst_unused:UNUSED_PAD src0_sel:DWORD src1_sel:WORD_0
    v_lshlrev_b32_sdwa v106, 3, v120 dst_sel:DWORD dst_unused:UNUSED_PAD src0_sel:DWORD src1_sel:WORD_1
    ds_read_b64 v[104:105], v104
    ds_read_b64 v[106:107], v106
    v_lshlrev_b32_sdwa v108, 3, v121 dst_sel:DWORD dst_unused:UNUSED_PAD src0_sel:DWORD src1_sel:WORD_0
    v_lshlrev_b32_sdwa v110, 3, v121 dst_sel:DWORD dst_unused:UNUSED_PAD src0_sel:DWORD src1_sel:WORD_1
    v_cvt_pk_bf16_f32 v38, v38, v39
    v_cvt_pk_bf16_f32 v39, v40, v41
    v_lshlrev_b32 v40, 16, v42
    v_and_b32 v41, s23, v42
    v_lshlrev_b32 v42, 16, v43
    v_and_b32 v43, s23, v43
    ds_read_b64 v[108:109], v108
    ds_read_b64 v[110:111], v110
    s_waitcnt lgkmcnt(10)
    v_smfmac_f32_16x16x64_bf16 v[40:43], v[66:69], v[88:95], v70
    v_lshlrev_b32_sdwa v88, 3, v122 dst_sel:DWORD dst_unused:UNUSED_PAD src0_sel:DWORD src1_sel:WORD_0
    v_lshlrev_b32_sdwa v90, 3, v122 dst_sel:DWORD dst_unused:UNUSED_PAD src0_sel:DWORD src1_sel:WORD_1
    ds_read_b64 v[88:89], v88
    ds_read_b64 v[90:91], v90
    v_lshlrev_b32_sdwa v92, 3, v123 dst_sel:DWORD dst_unused:UNUSED_PAD src0_sel:DWORD src1_sel:WORD_0
    v_lshlrev_b32_sdwa v94, 3, v123 dst_sel:DWORD dst_unused:UNUSED_PAD src0_sel:DWORD src1_sel:WORD_1
    ds_read_b64 v[92:93], v92
    ds_read_b64 v[94:95], v94
    s_add_u32 s20, s20, 0xfffff000
    buffer_load_dwordx4 v[120:123], v71, s[12:15], s20 offen offset:3072 sc1
    s_waitcnt lgkmcnt(9)
    v_smfmac_f32_16x16x64_bf16 v[40:43], v[66:69], v[96:103], v70
    s_waitcnt vmcnt(6)
    v_lshlrev_b32_sdwa v96, 3, v124 dst_sel:DWORD dst_unused:UNUSED_PAD src0_sel:DWORD src1_sel:WORD_0
    v_lshlrev_b32_sdwa v98, 3, v124 dst_sel:DWORD dst_unused:UNUSED_PAD src0_sel:DWORD src1_sel:WORD_1
    ds_read_b64 v[96:97], v96
    ds_read_b64 v[98:99], v98
    v_lshlrev_b32_sdwa v100, 3, v125 dst_sel:DWORD dst_unused:UNUSED_PAD src0_sel:DWORD src1_sel:WORD_0
    v_lshlrev_b32_sdwa v102, 3, v125 dst_sel:DWORD dst_unused:UNUSED_PAD src0_sel:DWORD src1_sel:WORD_1
    s_nop 0
    v_cvt_pk_bf16_f32 v40, v40, v41
    v_cvt_pk_bf16_f32 v41, v42, v43
    v_lshlrev_b32 v42, 16, v44
    v_and_b32 v43, s23, v44
    v_lshlrev_b32 v44, 16, v45
    v_and_b32 v45, s23, v45
    ds_read_b64 v[100:101], v100
    ds_read_b64 v[102:103], v102
    s_waitcnt lgkmcnt(8)
    v_smfmac_f32_16x16x64_bf16 v[42:45], v[66:69], v[104:111], v70
    v_lshlrev_b32_sdwa v104, 3, v126 dst_sel:DWORD dst_unused:UNUSED_PAD src0_sel:DWORD src1_sel:WORD_0
    v_lshlrev_b32_sdwa v106, 3, v126 dst_sel:DWORD dst_unused:UNUSED_PAD src0_sel:DWORD src1_sel:WORD_1
    ds_read_b64 v[104:105], v104
    ds_read_b64 v[106:107], v106
    v_lshlrev_b32_sdwa v108, 3, v127 dst_sel:DWORD dst_unused:UNUSED_PAD src0_sel:DWORD src1_sel:WORD_0
    v_lshlrev_b32_sdwa v110, 3, v127 dst_sel:DWORD dst_unused:UNUSED_PAD src0_sel:DWORD src1_sel:WORD_1
    ds_read_b64 v[108:109], v108
    ds_read_b64 v[110:111], v110
    buffer_load_dwordx4 v[124:127], v71, s[12:15], s20 offen offset:2048 sc1
    s_waitcnt lgkmcnt(8)
    v_smfmac_f32_16x16x64_bf16 v[42:45], v[66:69], v[88:95], v70
    s_waitcnt vmcnt(2)
    v_lshlrev_b32_sdwa v88, 3, v116 dst_sel:DWORD dst_unused:UNUSED_PAD src0_sel:DWORD src1_sel:WORD_0
    v_lshlrev_b32_sdwa v90, 3, v116 dst_sel:DWORD dst_unused:UNUSED_PAD src0_sel:DWORD src1_sel:WORD_1
    ds_read_b64 v[88:89], v88
    ds_read_b64 v[90:91], v90
    v_lshlrev_b32_sdwa v92, 3, v117 dst_sel:DWORD dst_unused:UNUSED_PAD src0_sel:DWORD src1_sel:WORD_0
    v_lshlrev_b32_sdwa v94, 3, v117 dst_sel:DWORD dst_unused:UNUSED_PAD src0_sel:DWORD src1_sel:WORD_1
    s_nop 0
    v_cvt_pk_bf16_f32 v42, v42, v43
    v_cvt_pk_bf16_f32 v43, v44, v45
    v_lshlrev_b32 v44, 16, v46
    v_and_b32 v45, s23, v46
    v_lshlrev_b32 v46, 16, v47
    v_and_b32 v47, s23, v47
    ds_read_b64 v[92:93], v92
    ds_read_b64 v[94:95], v94
    s_waitcnt lgkmcnt(8)
    v_smfmac_f32_16x16x64_bf16 v[44:47], v[66:69], v[96:103], v70
    v_lshlrev_b32_sdwa v96, 3, v118 dst_sel:DWORD dst_unused:UNUSED_PAD src0_sel:DWORD src1_sel:WORD_0
    v_lshlrev_b32_sdwa v98, 3, v118 dst_sel:DWORD dst_unused:UNUSED_PAD src0_sel:DWORD src1_sel:WORD_1
    ds_read_b64 v[96:97], v96
    ds_read_b64 v[98:99], v98
    v_lshlrev_b32_sdwa v100, 3, v119 dst_sel:DWORD dst_unused:UNUSED_PAD src0_sel:DWORD src1_sel:WORD_0
    v_lshlrev_b32_sdwa v102, 3, v119 dst_sel:DWORD dst_unused:UNUSED_PAD src0_sel:DWORD src1_sel:WORD_1
    ds_read_b64 v[100:101], v100
    ds_read_b64 v[102:103], v102
    buffer_load_dwordx4 v[116:119], v71, s[12:15], s20 offen offset:1024 sc1
    s_waitcnt lgkmcnt(8)
    v_smfmac_f32_16x16x64_bf16 v[44:47], v[66:69], v[104:111], v70
    s_setprio 2
    s_waitcnt vmcnt(2)
    v_lshlrev_b32_sdwa v104, 3, v120 dst_sel:DWORD dst_unused:UNUSED_PAD src0_sel:DWORD src1_sel:WORD_0
    v_lshlrev_b32_sdwa v106, 3, v120 dst_sel:DWORD dst_unused:UNUSED_PAD src0_sel:DWORD src1_sel:WORD_1
    ds_read_b64 v[104:105], v104
    ds_read_b64 v[106:107], v106
    v_lshlrev_b32_sdwa v108, 3, v121 dst_sel:DWORD dst_unused:UNUSED_PAD src0_sel:DWORD src1_sel:WORD_0
    v_lshlrev_b32_sdwa v110, 3, v121 dst_sel:DWORD dst_unused:UNUSED_PAD src0_sel:DWORD src1_sel:WORD_1
    v_cvt_pk_bf16_f32 v44, v44, v45
    v_cvt_pk_bf16_f32 v45, v46, v47
    v_lshlrev_b32 v46, 16, v48
    v_and_b32 v47, s23, v48
    v_lshlrev_b32 v48, 16, v49
    v_and_b32 v49, s23, v49
    ds_read_b64 v[108:109], v108
    ds_read_b64 v[110:111], v110
    s_waitcnt lgkmcnt(8)
    v_smfmac_f32_16x16x64_bf16 v[46:49], v[66:69], v[88:95], v70
    v_lshlrev_b32_sdwa v88, 3, v122 dst_sel:DWORD dst_unused:UNUSED_PAD src0_sel:DWORD src1_sel:WORD_0
    v_lshlrev_b32_sdwa v90, 3, v122 dst_sel:DWORD dst_unused:UNUSED_PAD src0_sel:DWORD src1_sel:WORD_1
    ds_read_b64 v[88:89], v88
    ds_read_b64 v[90:91], v90
    v_lshlrev_b32_sdwa v92, 3, v123 dst_sel:DWORD dst_unused:UNUSED_PAD src0_sel:DWORD src1_sel:WORD_0
    v_lshlrev_b32_sdwa v94, 3, v123 dst_sel:DWORD dst_unused:UNUSED_PAD src0_sel:DWORD src1_sel:WORD_1
    ds_read_b64 v[92:93], v92
    ds_read_b64 v[94:95], v94
    buffer_load_dwordx4 v[120:123], v71, s[12:15], s20 offen offset:0 sc1
    s_waitcnt lgkmcnt(8)
    v_smfmac_f32_16x16x64_bf16 v[46:49], v[66:69], v[96:103], v70
    s_waitcnt vmcnt(2)
    v_lshlrev_b32_sdwa v96, 3, v124 dst_sel:DWORD dst_unused:UNUSED_PAD src0_sel:DWORD src1_sel:WORD_0
    v_lshlrev_b32_sdwa v98, 3, v124 dst_sel:DWORD dst_unused:UNUSED_PAD src0_sel:DWORD src1_sel:WORD_1
    ds_read_b64 v[96:97], v96
    ds_read_b64 v[98:99], v98
    v_lshlrev_b32_sdwa v100, 3, v125 dst_sel:DWORD dst_unused:UNUSED_PAD src0_sel:DWORD src1_sel:WORD_0
    v_lshlrev_b32_sdwa v102, 3, v125 dst_sel:DWORD dst_unused:UNUSED_PAD src0_sel:DWORD src1_sel:WORD_1
    s_nop 0
    v_cvt_pk_bf16_f32 v46, v46, v47
    v_cvt_pk_bf16_f32 v47, v48, v49
    v_lshlrev_b32 v48, 16, v50
    v_and_b32 v49, s23, v50
    v_lshlrev_b32 v50, 16, v51
    v_and_b32 v51, s23, v51
    ds_read_b64 v[100:101], v100
    ds_read_b64 v[102:103], v102
    s_waitcnt lgkmcnt(8)
    v_smfmac_f32_16x16x64_bf16 v[48:51], v[66:69], v[104:111], v70
    v_lshlrev_b32_sdwa v104, 3, v126 dst_sel:DWORD dst_unused:UNUSED_PAD src0_sel:DWORD src1_sel:WORD_0
    v_lshlrev_b32_sdwa v106, 3, v126 dst_sel:DWORD dst_unused:UNUSED_PAD src0_sel:DWORD src1_sel:WORD_1
    ds_read_b64 v[104:105], v104
    ds_read_b64 v[106:107], v106
    v_lshlrev_b32_sdwa v108, 3, v127 dst_sel:DWORD dst_unused:UNUSED_PAD src0_sel:DWORD src1_sel:WORD_0
    v_lshlrev_b32_sdwa v110, 3, v127 dst_sel:DWORD dst_unused:UNUSED_PAD src0_sel:DWORD src1_sel:WORD_1
    ds_read_b64 v[108:109], v108
    ds_read_b64 v[110:111], v110
    s_add_u32 s20, s20, 0xfffffc00
    buffer_load_dwordx4 v[124:127], v71, s[12:15], s20 offen offset:0 sc1
    s_waitcnt lgkmcnt(8)
    v_smfmac_f32_16x16x64_bf16 v[48:51], v[66:69], v[88:95], v70
    s_waitcnt vmcnt(2)
    v_lshlrev_b32_sdwa v88, 3, v116 dst_sel:DWORD dst_unused:UNUSED_PAD src0_sel:DWORD src1_sel:WORD_0
    v_lshlrev_b32_sdwa v90, 3, v116 dst_sel:DWORD dst_unused:UNUSED_PAD src0_sel:DWORD src1_sel:WORD_1
    ds_read_b64 v[88:89], v88
    ds_read_b64 v[90:91], v90
    v_lshlrev_b32_sdwa v92, 3, v117 dst_sel:DWORD dst_unused:UNUSED_PAD src0_sel:DWORD src1_sel:WORD_0
    v_lshlrev_b32_sdwa v94, 3, v117 dst_sel:DWORD dst_unused:UNUSED_PAD src0_sel:DWORD src1_sel:WORD_1
    s_nop 0
    v_cvt_pk_bf16_f32 v48, v48, v49
    v_cvt_pk_bf16_f32 v49, v50, v51
    v_lshlrev_b32 v50, 16, v52
    v_and_b32 v51, s23, v52
    v_lshlrev_b32 v52, 16, v53
    v_and_b32 v53, s23, v53
    ds_read_b64 v[92:93], v92
    ds_read_b64 v[94:95], v94
    s_waitcnt lgkmcnt(8)
    v_smfmac_f32_16x16x64_bf16 v[50:53], v[66:69], v[96:103], v70
    v_lshlrev_b32_sdwa v96, 3, v118 dst_sel:DWORD dst_unused:UNUSED_PAD src0_sel:DWORD src1_sel:WORD_0
    v_lshlrev_b32_sdwa v98, 3, v118 dst_sel:DWORD dst_unused:UNUSED_PAD src0_sel:DWORD src1_sel:WORD_1
    ds_read_b64 v[96:97], v96
    ds_read_b64 v[98:99], v98
    v_lshlrev_b32_sdwa v100, 3, v119 dst_sel:DWORD dst_unused:UNUSED_PAD src0_sel:DWORD src1_sel:WORD_0
    v_lshlrev_b32_sdwa v102, 3, v119 dst_sel:DWORD dst_unused:UNUSED_PAD src0_sel:DWORD src1_sel:WORD_1
    ds_read_b64 v[100:101], v100
    ds_read_b64 v[102:103], v102
    s_add_u32 s20, s20, 0xfffffc00
    buffer_load_dwordx4 v[116:119], v71, s[12:15], s20 offen offset:0 sc1
    s_waitcnt lgkmcnt(8)
    v_smfmac_f32_16x16x64_bf16 v[50:53], v[66:69], v[104:111], v70
    v_mfma_f32_16x16x32_bf16 v[112:115], v[72:75], v[128:131], 0
    v_mfma_f32_16x16x32_bf16 v[112:115], v[76:79], v[132:135], v[112:115]
    s_nop 0
    v_add_u32 v70, 0xc0000000, v70
    s_waitcnt vmcnt(2)
    v_lshlrev_b32_sdwa v104, 3, v120 dst_sel:DWORD dst_unused:UNUSED_PAD src0_sel:DWORD src1_sel:WORD_0
    v_lshlrev_b32_sdwa v106, 3, v120 dst_sel:DWORD dst_unused:UNUSED_PAD src0_sel:DWORD src1_sel:WORD_1
    ds_read_b64 v[104:105], v104
    ds_read_b64 v[106:107], v106
    v_mfma_f32_16x16x32_bf16 v[112:115], v[80:83], v[136:139], v[112:115]
    v_mfma_f32_16x16x32_bf16 v[112:115], v[84:87], v[140:143], v[112:115]
    v_lshlrev_b32_sdwa v108, 3, v121 dst_sel:DWORD dst_unused:UNUSED_PAD src0_sel:DWORD src1_sel:WORD_0
    v_lshlrev_b32_sdwa v110, 3, v121 dst_sel:DWORD dst_unused:UNUSED_PAD src0_sel:DWORD src1_sel:WORD_1
    v_cvt_pk_bf16_f32 v50, v50, v51
    v_cvt_pk_bf16_f32 v51, v52, v53
    v_lshlrev_b32 v52, 16, v54
    v_and_b32 v53, s23, v54
    v_lshlrev_b32 v54, 16, v55
    v_and_b32 v55, s23, v55
    ds_read_b64 v[108:109], v108
    ds_read_b64 v[110:111], v110
    s_waitcnt lgkmcnt(8)
    v_smfmac_f32_16x16x64_bf16 v[52:55], v[66:69], v[88:95], v70
    v_cvt_pk_bf16_f32 v112, v112, v113
    v_cvt_pk_bf16_f32 v113, v114, v115
    v_lshlrev_b32_sdwa v114, 3, v70 dst_sel:DWORD dst_unused:UNUSED_PAD src0_sel:DWORD src1_sel:WORD_1
    ds_write_b64 v114, v[112:113] offset:0
    v_mfma_f32_16x16x32_bf16 v[112:115], v[72:75], v[144:147], 0
    v_mfma_f32_16x16x32_bf16 v[112:115], v[76:79], v[148:151], v[112:115]
    v_lshlrev_b32_sdwa v88, 3, v122 dst_sel:DWORD dst_unused:UNUSED_PAD src0_sel:DWORD src1_sel:WORD_0
    v_lshlrev_b32_sdwa v90, 3, v122 dst_sel:DWORD dst_unused:UNUSED_PAD src0_sel:DWORD src1_sel:WORD_1
    ds_read_b64 v[88:89], v88
    ds_read_b64 v[90:91], v90
    v_mfma_f32_16x16x32_bf16 v[112:115], v[80:83], v[152:155], v[112:115]
    v_mfma_f32_16x16x32_bf16 v[112:115], v[84:87], v[156:159], v[112:115]
    v_lshlrev_b32_sdwa v92, 3, v123 dst_sel:DWORD dst_unused:UNUSED_PAD src0_sel:DWORD src1_sel:WORD_0
    v_lshlrev_b32_sdwa v94, 3, v123 dst_sel:DWORD dst_unused:UNUSED_PAD src0_sel:DWORD src1_sel:WORD_1
    ds_read_b64 v[92:93], v92
    ds_read_b64 v[94:95], v94
    s_add_u32 s20, s20, 0x3c00
    buffer_load_dwordx4 v[120:123], v71, s[12:15], s20 offen offset:0 sc1
    s_waitcnt lgkmcnt(9)
    v_smfmac_f32_16x16x64_bf16 v[52:55], v[66:69], v[96:103], v70
    v_cvt_pk_bf16_f32 v112, v112, v113
    v_cvt_pk_bf16_f32 v113, v114, v115
    v_lshlrev_b32_sdwa v114, 3, v70 dst_sel:DWORD dst_unused:UNUSED_PAD src0_sel:DWORD src1_sel:WORD_1
    ds_write_b64 v114, v[112:113] offset:128
    s_setprio 1
    v_mfma_f32_16x16x32_bf16 v[112:115], v[72:75], v[160:163], 0
    v_mfma_f32_16x16x32_bf16 v[112:115], v[76:79], v[164:167], v[112:115]
    s_waitcnt vmcnt(2)
    v_lshlrev_b32_sdwa v96, 3, v124 dst_sel:DWORD dst_unused:UNUSED_PAD src0_sel:DWORD src1_sel:WORD_0
    v_lshlrev_b32_sdwa v98, 3, v124 dst_sel:DWORD dst_unused:UNUSED_PAD src0_sel:DWORD src1_sel:WORD_1
    ds_read_b64 v[96:97], v96
    ds_read_b64 v[98:99], v98
    v_mfma_f32_16x16x32_bf16 v[112:115], v[80:83], v[168:171], v[112:115]
    v_mfma_f32_16x16x32_bf16 v[112:115], v[84:87], v[172:175], v[112:115]
    v_lshlrev_b32_sdwa v100, 3, v125 dst_sel:DWORD dst_unused:UNUSED_PAD src0_sel:DWORD src1_sel:WORD_0
    v_lshlrev_b32_sdwa v102, 3, v125 dst_sel:DWORD dst_unused:UNUSED_PAD src0_sel:DWORD src1_sel:WORD_1
    v_cvt_pk_bf16_f32 v52, v52, v53
    v_cvt_pk_bf16_f32 v53, v54, v55
    v_lshlrev_b32 v54, 16, v56
    v_and_b32 v55, s23, v56
    v_lshlrev_b32 v56, 16, v57
    v_and_b32 v57, s23, v57
    ds_read_b64 v[100:101], v100
    ds_read_b64 v[102:103], v102
    s_waitcnt lgkmcnt(10)
    v_smfmac_f32_16x16x64_bf16 v[54:57], v[66:69], v[104:111], v70
    v_cvt_pk_bf16_f32 v112, v112, v113
    v_cvt_pk_bf16_f32 v113, v114, v115
    v_lshlrev_b32_sdwa v114, 3, v70 dst_sel:DWORD dst_unused:UNUSED_PAD src0_sel:DWORD src1_sel:WORD_1
    ds_write_b64 v114, v[112:113] offset:256
    v_mfma_f32_16x16x32_bf16 v[112:115], v[72:75], v[176:179], 0
    v_mfma_f32_16x16x32_bf16 v[112:115], v[76:79], v[180:183], v[112:115]
    v_lshlrev_b32_sdwa v104, 3, v126 dst_sel:DWORD dst_unused:UNUSED_PAD src0_sel:DWORD src1_sel:WORD_0
    v_lshlrev_b32_sdwa v106, 3, v126 dst_sel:DWORD dst_unused:UNUSED_PAD src0_sel:DWORD src1_sel:WORD_1
    ds_read_b64 v[104:105], v104
    ds_read_b64 v[106:107], v106
    v_mfma_f32_16x16x32_bf16 v[112:115], v[80:83], v[184:187], v[112:115]
    v_mfma_f32_16x16x32_bf16 v[112:115], v[84:87], v[188:191], v[112:115]
    v_lshlrev_b32_sdwa v108, 3, v127 dst_sel:DWORD dst_unused:UNUSED_PAD src0_sel:DWORD src1_sel:WORD_0
    v_lshlrev_b32_sdwa v110, 3, v127 dst_sel:DWORD dst_unused:UNUSED_PAD src0_sel:DWORD src1_sel:WORD_1
    ds_read_b64 v[108:109], v108
    ds_read_b64 v[110:111], v110
    s_add_u32 s20, s20, 0xfffffc00
    buffer_load_dwordx4 v[124:127], v71, s[12:15], s20 offen offset:0 sc1
    s_waitcnt lgkmcnt(10)
    v_smfmac_f32_16x16x64_bf16 v[54:57], v[66:69], v[88:95], v70
    v_cvt_pk_bf16_f32 v112, v112, v113
    v_cvt_pk_bf16_f32 v113, v114, v115
    v_lshlrev_b32_sdwa v114, 3, v70 dst_sel:DWORD dst_unused:UNUSED_PAD src0_sel:DWORD src1_sel:WORD_1
    ds_write_b64 v114, v[112:113] offset:384
    v_mfma_f32_16x16x32_bf16 v[112:115], v[72:75], v[192:195], 0
    v_mfma_f32_16x16x32_bf16 v[112:115], v[76:79], v[196:199], v[112:115]
    s_waitcnt vmcnt(2)
    v_lshlrev_b32_sdwa v88, 3, v116 dst_sel:DWORD dst_unused:UNUSED_PAD src0_sel:DWORD src1_sel:WORD_0
    v_lshlrev_b32_sdwa v90, 3, v116 dst_sel:DWORD dst_unused:UNUSED_PAD src0_sel:DWORD src1_sel:WORD_1
    ds_read_b64 v[88:89], v88
    ds_read_b64 v[90:91], v90
    v_mfma_f32_16x16x32_bf16 v[112:115], v[80:83], v[200:203], v[112:115]
    v_mfma_f32_16x16x32_bf16 v[112:115], v[84:87], v[204:207], v[112:115]
    v_lshlrev_b32_sdwa v92, 3, v117 dst_sel:DWORD dst_unused:UNUSED_PAD src0_sel:DWORD src1_sel:WORD_0
    v_lshlrev_b32_sdwa v94, 3, v117 dst_sel:DWORD dst_unused:UNUSED_PAD src0_sel:DWORD src1_sel:WORD_1
    v_cvt_pk_bf16_f32 v54, v54, v55
    v_cvt_pk_bf16_f32 v55, v56, v57
    v_lshlrev_b32 v56, 16, v58
    v_and_b32 v57, s23, v58
    v_lshlrev_b32 v58, 16, v59
    v_and_b32 v59, s23, v59
    ds_read_b64 v[92:93], v92
    ds_read_b64 v[94:95], v94
    s_waitcnt lgkmcnt(10)
    v_smfmac_f32_16x16x64_bf16 v[56:59], v[66:69], v[96:103], v70
    v_cvt_pk_bf16_f32 v112, v112, v113
    v_cvt_pk_bf16_f32 v113, v114, v115
    v_lshlrev_b32_sdwa v114, 3, v70 dst_sel:DWORD dst_unused:UNUSED_PAD src0_sel:DWORD src1_sel:WORD_1
    ds_write_b64 v114, v[112:113] offset:512
    v_mfma_f32_16x16x32_bf16 v[112:115], v[72:75], v[208:211], 0
    v_mfma_f32_16x16x32_bf16 v[112:115], v[76:79], v[212:215], v[112:115]
    v_lshlrev_b32_sdwa v96, 3, v118 dst_sel:DWORD dst_unused:UNUSED_PAD src0_sel:DWORD src1_sel:WORD_0
    v_lshlrev_b32_sdwa v98, 3, v118 dst_sel:DWORD dst_unused:UNUSED_PAD src0_sel:DWORD src1_sel:WORD_1
    ds_read_b64 v[96:97], v96
    ds_read_b64 v[98:99], v98
    v_mfma_f32_16x16x32_bf16 v[112:115], v[80:83], v[216:219], v[112:115]
    v_mfma_f32_16x16x32_bf16 v[112:115], v[84:87], v[220:223], v[112:115]
    v_lshlrev_b32_sdwa v100, 3, v119 dst_sel:DWORD dst_unused:UNUSED_PAD src0_sel:DWORD src1_sel:WORD_0
    v_lshlrev_b32_sdwa v102, 3, v119 dst_sel:DWORD dst_unused:UNUSED_PAD src0_sel:DWORD src1_sel:WORD_1
    ds_read_b64 v[100:101], v100
    ds_read_b64 v[102:103], v102
    s_add_u32 s20, s20, 0x3f400
    buffer_load_dwordx4 v[116:119], v71, s[12:15], s20 offen offset:3072 sc1
    s_waitcnt lgkmcnt(10)
    v_smfmac_f32_16x16x64_bf16 v[56:59], v[66:69], v[104:111], v70
    v_cvt_pk_bf16_f32 v112, v112, v113
    v_cvt_pk_bf16_f32 v113, v114, v115
    v_lshlrev_b32_sdwa v114, 3, v70 dst_sel:DWORD dst_unused:UNUSED_PAD src0_sel:DWORD src1_sel:WORD_1
    ds_write_b64 v114, v[112:113] offset:640
    v_mfma_f32_16x16x32_bf16 v[112:115], v[72:75], v[224:227], 0
    v_mfma_f32_16x16x32_bf16 v[112:115], v[76:79], v[228:231], v[112:115]
    s_waitcnt vmcnt(2)
    v_lshlrev_b32_sdwa v104, 3, v120 dst_sel:DWORD dst_unused:UNUSED_PAD src0_sel:DWORD src1_sel:WORD_0
    v_lshlrev_b32_sdwa v106, 3, v120 dst_sel:DWORD dst_unused:UNUSED_PAD src0_sel:DWORD src1_sel:WORD_1
    ds_read_b64 v[104:105], v104
    ds_read_b64 v[106:107], v106
    v_mfma_f32_16x16x32_bf16 v[112:115], v[80:83], v[232:235], v[112:115]
    v_mfma_f32_16x16x32_bf16 v[112:115], v[84:87], v[236:239], v[112:115]
    v_lshlrev_b32_sdwa v108, 3, v121 dst_sel:DWORD dst_unused:UNUSED_PAD src0_sel:DWORD src1_sel:WORD_0
    v_lshlrev_b32_sdwa v110, 3, v121 dst_sel:DWORD dst_unused:UNUSED_PAD src0_sel:DWORD src1_sel:WORD_1
    v_cvt_pk_bf16_f32 v56, v56, v57
    v_cvt_pk_bf16_f32 v57, v58, v59
    v_lshlrev_b32 v58, 16, v60
    v_and_b32 v59, s23, v60
    v_lshlrev_b32 v60, 16, v61
    v_and_b32 v61, s23, v61
    ds_read_b64 v[108:109], v108
    ds_read_b64 v[110:111], v110
    s_waitcnt lgkmcnt(10)
    v_smfmac_f32_16x16x64_bf16 v[58:61], v[66:69], v[88:95], v70
    v_cvt_pk_bf16_f32 v112, v112, v113
    v_cvt_pk_bf16_f32 v113, v114, v115
    v_lshlrev_b32_sdwa v114, 3, v70 dst_sel:DWORD dst_unused:UNUSED_PAD src0_sel:DWORD src1_sel:WORD_1
    ds_write_b64 v114, v[112:113] offset:768
    v_mfma_f32_16x16x32_bf16 v[112:115], v[72:75], v[240:243], 0
    buffer_load_dwordx4 v[72:75], v71, s[12:15], s21 offen offset:0
    v_mfma_f32_16x16x32_bf16 v[112:115], v[76:79], v[244:247], v[112:115]
    buffer_load_dwordx4 v[76:79], v71, s[12:15], s21 offen offset:1024
    v_lshlrev_b32_sdwa v88, 3, v122 dst_sel:DWORD dst_unused:UNUSED_PAD src0_sel:DWORD src1_sel:WORD_0
    v_lshlrev_b32_sdwa v90, 3, v122 dst_sel:DWORD dst_unused:UNUSED_PAD src0_sel:DWORD src1_sel:WORD_1
    ds_read_b64 v[88:89], v88
    ds_read_b64 v[90:91], v90
    v_mfma_f32_16x16x32_bf16 v[112:115], v[80:83], v[248:251], v[112:115]
    buffer_load_dwordx4 v[80:83], v71, s[12:15], s19 offen offset:0
    v_mfma_f32_16x16x32_bf16 v[112:115], v[84:87], v[252:255], v[112:115]
    buffer_load_dwordx4 v[84:87], v71, s[12:15], s19 offen offset:1024
    s_add_u32 s21, s21, s22
    s_add_u32 s19, s19, s22
    v_lshlrev_b32_sdwa v92, 3, v123 dst_sel:DWORD dst_unused:UNUSED_PAD src0_sel:DWORD src1_sel:WORD_0
    v_lshlrev_b32_sdwa v94, 3, v123 dst_sel:DWORD dst_unused:UNUSED_PAD src0_sel:DWORD src1_sel:WORD_1
    ds_read_b64 v[92:93], v92
    ds_read_b64 v[94:95], v94
    s_add_u32 s20, s20, 0x400
    buffer_load_dwordx4 v[120:123], v71, s[12:15], s20 offen offset:3072 sc1
    s_waitcnt lgkmcnt(10)
    v_smfmac_f32_16x16x64_bf16 v[58:61], v[66:69], v[96:103], v70
    v_cvt_pk_bf16_f32 v112, v112, v113
    v_cvt_pk_bf16_f32 v113, v114, v115
    v_lshlrev_b32_sdwa v114, 3, v70 dst_sel:DWORD dst_unused:UNUSED_PAD src0_sel:DWORD src1_sel:WORD_1
    ds_write_b64 v114, v[112:113] offset:896
    s_setprio 0
    s_waitcnt vmcnt(6)
    v_lshlrev_b32_sdwa v96, 3, v124 dst_sel:DWORD dst_unused:UNUSED_PAD src0_sel:DWORD src1_sel:WORD_0
    v_lshlrev_b32_sdwa v98, 3, v124 dst_sel:DWORD dst_unused:UNUSED_PAD src0_sel:DWORD src1_sel:WORD_1
    ds_read_b64 v[96:97], v96
    ds_read_b64 v[98:99], v98
    v_lshlrev_b32_sdwa v100, 3, v125 dst_sel:DWORD dst_unused:UNUSED_PAD src0_sel:DWORD src1_sel:WORD_0
    v_lshlrev_b32_sdwa v102, 3, v125 dst_sel:DWORD dst_unused:UNUSED_PAD src0_sel:DWORD src1_sel:WORD_1
    v_cvt_pk_bf16_f32 v58, v58, v59
    v_cvt_pk_bf16_f32 v59, v60, v61
    v_lshlrev_b32 v60, 16, v62
    v_and_b32 v61, s23, v62
    v_lshlrev_b32 v62, 16, v63
    v_and_b32 v63, s23, v63
    ds_read_b64 v[100:101], v100
    ds_read_b64 v[102:103], v102
    s_waitcnt lgkmcnt(10)
    v_smfmac_f32_16x16x64_bf16 v[60:63], v[66:69], v[104:111], v70
    v_lshlrev_b32_sdwa v104, 3, v126 dst_sel:DWORD dst_unused:UNUSED_PAD src0_sel:DWORD src1_sel:WORD_0
    v_lshlrev_b32_sdwa v106, 3, v126 dst_sel:DWORD dst_unused:UNUSED_PAD src0_sel:DWORD src1_sel:WORD_1
    ds_read_b64 v[104:105], v104
    ds_read_b64 v[106:107], v106
    v_lshlrev_b32_sdwa v108, 3, v127 dst_sel:DWORD dst_unused:UNUSED_PAD src0_sel:DWORD src1_sel:WORD_0
    v_lshlrev_b32_sdwa v110, 3, v127 dst_sel:DWORD dst_unused:UNUSED_PAD src0_sel:DWORD src1_sel:WORD_1
    ds_read_b64 v[108:109], v108
    ds_read_b64 v[110:111], v110
    s_add_u32 s20, s20, 0xffffd000
    buffer_load_dwordx4 v[124:127], v71, s[12:15], s20 offen offset:0 sc1
    s_waitcnt lgkmcnt(9)
    v_smfmac_f32_16x16x64_bf16 v[60:63], v[66:69], v[88:95], v70
    s_waitcnt lgkmcnt(0)
    s_barrier
    s_setprio 3
    s_waitcnt vmcnt(6)
    v_lshlrev_b32_sdwa v88, 3, v116 dst_sel:DWORD dst_unused:UNUSED_PAD src0_sel:DWORD src1_sel:WORD_0
    v_lshlrev_b32_sdwa v90, 3, v116 dst_sel:DWORD dst_unused:UNUSED_PAD src0_sel:DWORD src1_sel:WORD_1
    ds_read_b64 v[88:89], v88
    ds_read_b64 v[90:91], v90
    v_lshlrev_b32_sdwa v92, 3, v117 dst_sel:DWORD dst_unused:UNUSED_PAD src0_sel:DWORD src1_sel:WORD_0
    v_lshlrev_b32_sdwa v94, 3, v117 dst_sel:DWORD dst_unused:UNUSED_PAD src0_sel:DWORD src1_sel:WORD_1
    v_cvt_pk_bf16_f32 v60, v60, v61
    v_cvt_pk_bf16_f32 v61, v62, v63
    v_lshlrev_b32 v62, 16, v64
    v_and_b32 v63, s23, v64
    v_lshlrev_b32 v64, 16, v65
    v_and_b32 v65, s23, v65
    ds_read_b64 v[92:93], v92
    ds_read_b64 v[94:95], v94
    v_smfmac_f32_16x16x64_bf16 v[62:65], v[66:69], v[96:103], v70
    v_lshlrev_b32_sdwa v96, 3, v118 dst_sel:DWORD dst_unused:UNUSED_PAD src0_sel:DWORD src1_sel:WORD_0
    v_lshlrev_b32_sdwa v98, 3, v118 dst_sel:DWORD dst_unused:UNUSED_PAD src0_sel:DWORD src1_sel:WORD_1
    ds_read_b64 v[96:97], v96
    ds_read_b64 v[98:99], v98
    v_lshlrev_b32_sdwa v100, 3, v119 dst_sel:DWORD dst_unused:UNUSED_PAD src0_sel:DWORD src1_sel:WORD_0
    v_lshlrev_b32_sdwa v102, 3, v119 dst_sel:DWORD dst_unused:UNUSED_PAD src0_sel:DWORD src1_sel:WORD_1
    ds_read_b64 v[100:101], v100
    ds_read_b64 v[102:103], v102
    buffer_load_dwordx4 v[116:119], v71, s[12:15], s20 offen offset:1024 sc1
    v_smfmac_f32_16x16x64_bf16 v[62:65], v[66:69], v[104:111], v70
    s_waitcnt vmcnt(2)
    v_lshlrev_b32_sdwa v104, 3, v120 dst_sel:DWORD dst_unused:UNUSED_PAD src0_sel:DWORD src1_sel:WORD_0
    v_lshlrev_b32_sdwa v106, 3, v120 dst_sel:DWORD dst_unused:UNUSED_PAD src0_sel:DWORD src1_sel:WORD_1
    ds_read_b64 v[104:105], v104
    ds_read_b64 v[106:107], v106
    v_lshlrev_b32_sdwa v108, 3, v121 dst_sel:DWORD dst_unused:UNUSED_PAD src0_sel:DWORD src1_sel:WORD_0
    v_lshlrev_b32_sdwa v110, 3, v121 dst_sel:DWORD dst_unused:UNUSED_PAD src0_sel:DWORD src1_sel:WORD_1
    s_nop 0
    v_cvt_pk_bf16_f32 v62, v62, v63
    v_cvt_pk_bf16_f32 v63, v64, v65
    v_and_b32 v65, s23, v63
    v_lshlrev_b32 v64, 16, v63
    v_and_b32 v63, s23, v62
    v_lshlrev_b32 v62, 16, v62
    ds_read_b64 v[108:109], v108
    ds_read_b64 v[110:111], v110
    s_waitcnt lgkmcnt(8)
    v_smfmac_f32_16x16x64_bf16 v[62:65], v[66:69], v[88:95], v70
    v_lshlrev_b32_sdwa v88, 3, v122 dst_sel:DWORD dst_unused:UNUSED_PAD src0_sel:DWORD src1_sel:WORD_0
    v_lshlrev_b32_sdwa v90, 3, v122 dst_sel:DWORD dst_unused:UNUSED_PAD src0_sel:DWORD src1_sel:WORD_1
    ds_read_b64 v[88:89], v88
    ds_read_b64 v[90:91], v90
    v_lshlrev_b32_sdwa v92, 3, v123 dst_sel:DWORD dst_unused:UNUSED_PAD src0_sel:DWORD src1_sel:WORD_0
    v_lshlrev_b32_sdwa v94, 3, v123 dst_sel:DWORD dst_unused:UNUSED_PAD src0_sel:DWORD src1_sel:WORD_1
    ds_read_b64 v[92:93], v92
    ds_read_b64 v[94:95], v94
    buffer_load_dwordx4 v[120:123], v71, s[12:15], s20 offen offset:2048 sc1
    s_waitcnt lgkmcnt(8)
    v_smfmac_f32_16x16x64_bf16 v[62:65], v[66:69], v[96:103], v70
    s_waitcnt vmcnt(2)
    v_lshlrev_b32_sdwa v96, 3, v124 dst_sel:DWORD dst_unused:UNUSED_PAD src0_sel:DWORD src1_sel:WORD_0
    v_lshlrev_b32_sdwa v98, 3, v124 dst_sel:DWORD dst_unused:UNUSED_PAD src0_sel:DWORD src1_sel:WORD_1
    ds_read_b64 v[96:97], v96
    ds_read_b64 v[98:99], v98
    v_lshlrev_b32_sdwa v100, 3, v125 dst_sel:DWORD dst_unused:UNUSED_PAD src0_sel:DWORD src1_sel:WORD_0
    v_lshlrev_b32_sdwa v102, 3, v125 dst_sel:DWORD dst_unused:UNUSED_PAD src0_sel:DWORD src1_sel:WORD_1
    s_nop 0
    v_cvt_pk_bf16_f32 v65, v64, v65
    v_cvt_pk_bf16_f32 v64, v62, v63
    v_and_b32 v63, s23, v61
    v_lshlrev_b32 v62, 16, v61
    v_and_b32 v61, s23, v60
    v_lshlrev_b32 v60, 16, v60
    ds_read_b64 v[100:101], v100
    ds_read_b64 v[102:103], v102
    s_waitcnt lgkmcnt(8)
    v_smfmac_f32_16x16x64_bf16 v[60:63], v[66:69], v[104:111], v70
    v_lshlrev_b32_sdwa v104, 3, v126 dst_sel:DWORD dst_unused:UNUSED_PAD src0_sel:DWORD src1_sel:WORD_0
    v_lshlrev_b32_sdwa v106, 3, v126 dst_sel:DWORD dst_unused:UNUSED_PAD src0_sel:DWORD src1_sel:WORD_1
    ds_read_b64 v[104:105], v104
    ds_read_b64 v[106:107], v106
    v_lshlrev_b32_sdwa v108, 3, v127 dst_sel:DWORD dst_unused:UNUSED_PAD src0_sel:DWORD src1_sel:WORD_0
    v_lshlrev_b32_sdwa v110, 3, v127 dst_sel:DWORD dst_unused:UNUSED_PAD src0_sel:DWORD src1_sel:WORD_1
    ds_read_b64 v[108:109], v108
    ds_read_b64 v[110:111], v110
    buffer_load_dwordx4 v[124:127], v71, s[12:15], s20 offen offset:3072 sc1
    s_waitcnt lgkmcnt(8)
    v_smfmac_f32_16x16x64_bf16 v[60:63], v[66:69], v[88:95], v70
    s_waitcnt vmcnt(2)
    v_lshlrev_b32_sdwa v88, 3, v116 dst_sel:DWORD dst_unused:UNUSED_PAD src0_sel:DWORD src1_sel:WORD_0
    v_lshlrev_b32_sdwa v90, 3, v116 dst_sel:DWORD dst_unused:UNUSED_PAD src0_sel:DWORD src1_sel:WORD_1
    ds_read_b64 v[88:89], v88
    ds_read_b64 v[90:91], v90
    v_lshlrev_b32_sdwa v92, 3, v117 dst_sel:DWORD dst_unused:UNUSED_PAD src0_sel:DWORD src1_sel:WORD_0
    v_lshlrev_b32_sdwa v94, 3, v117 dst_sel:DWORD dst_unused:UNUSED_PAD src0_sel:DWORD src1_sel:WORD_1
    s_nop 0
    v_cvt_pk_bf16_f32 v63, v62, v63
    v_cvt_pk_bf16_f32 v62, v60, v61
    v_and_b32 v61, s23, v59
    v_lshlrev_b32 v60, 16, v59
    v_and_b32 v59, s23, v58
    v_lshlrev_b32 v58, 16, v58
    ds_read_b64 v[92:93], v92
    ds_read_b64 v[94:95], v94
    s_waitcnt lgkmcnt(8)
    v_smfmac_f32_16x16x64_bf16 v[58:61], v[66:69], v[96:103], v70
    v_lshlrev_b32_sdwa v96, 3, v118 dst_sel:DWORD dst_unused:UNUSED_PAD src0_sel:DWORD src1_sel:WORD_0
    v_lshlrev_b32_sdwa v98, 3, v118 dst_sel:DWORD dst_unused:UNUSED_PAD src0_sel:DWORD src1_sel:WORD_1
    ds_read_b64 v[96:97], v96
    ds_read_b64 v[98:99], v98
    v_lshlrev_b32_sdwa v100, 3, v119 dst_sel:DWORD dst_unused:UNUSED_PAD src0_sel:DWORD src1_sel:WORD_0
    v_lshlrev_b32_sdwa v102, 3, v119 dst_sel:DWORD dst_unused:UNUSED_PAD src0_sel:DWORD src1_sel:WORD_1
    ds_read_b64 v[100:101], v100
    ds_read_b64 v[102:103], v102
    s_add_u32 s20, s20, 0x1000
    buffer_load_dwordx4 v[116:119], v71, s[12:15], s20 offen offset:0 sc1
    s_waitcnt lgkmcnt(8)
    v_smfmac_f32_16x16x64_bf16 v[58:61], v[66:69], v[104:111], v70
    v_mfma_f32_16x16x32_bf16 v[112:115], v[72:75], v[128:131], 0
    s_waitcnt vmcnt(2)
    v_lshlrev_b32_sdwa v104, 3, v120 dst_sel:DWORD dst_unused:UNUSED_PAD src0_sel:DWORD src1_sel:WORD_0
    v_lshlrev_b32_sdwa v106, 3, v120 dst_sel:DWORD dst_unused:UNUSED_PAD src0_sel:DWORD src1_sel:WORD_1
    ds_read_b64 v[104:105], v104
    ds_read_b64 v[106:107], v106
    v_mfma_f32_16x16x32_bf16 v[112:115], v[76:79], v[132:135], v[112:115]
    v_lshlrev_b32_sdwa v108, 3, v121 dst_sel:DWORD dst_unused:UNUSED_PAD src0_sel:DWORD src1_sel:WORD_0
    v_lshlrev_b32_sdwa v110, 3, v121 dst_sel:DWORD dst_unused:UNUSED_PAD src0_sel:DWORD src1_sel:WORD_1
    v_cvt_pk_bf16_f32 v61, v60, v61
    v_cvt_pk_bf16_f32 v60, v58, v59
    v_and_b32 v59, s23, v57
    v_lshlrev_b32 v58, 16, v57
    v_and_b32 v57, s23, v56
    v_lshlrev_b32 v56, 16, v56
    ds_read_b64 v[108:109], v108
    ds_read_b64 v[110:111], v110
    s_waitcnt lgkmcnt(8)
    v_smfmac_f32_16x16x64_bf16 v[56:59], v[66:69], v[88:95], v70
    v_mfma_f32_16x16x32_bf16 v[112:115], v[80:83], v[136:139], v[112:115]
    v_lshlrev_b32_sdwa v88, 3, v122 dst_sel:DWORD dst_unused:UNUSED_PAD src0_sel:DWORD src1_sel:WORD_0
    v_lshlrev_b32_sdwa v90, 3, v122 dst_sel:DWORD dst_unused:UNUSED_PAD src0_sel:DWORD src1_sel:WORD_1
    ds_read_b64 v[88:89], v88
    ds_read_b64 v[90:91], v90
    v_mfma_f32_16x16x32_bf16 v[112:115], v[84:87], v[140:143], v[112:115]
    v_lshlrev_b32_sdwa v92, 3, v123 dst_sel:DWORD dst_unused:UNUSED_PAD src0_sel:DWORD src1_sel:WORD_0
    v_lshlrev_b32_sdwa v94, 3, v123 dst_sel:DWORD dst_unused:UNUSED_PAD src0_sel:DWORD src1_sel:WORD_1
    ds_read_b64 v[92:93], v92
    ds_read_b64 v[94:95], v94
    buffer_load_dwordx4 v[120:123], v71, s[12:15], s20 offen offset:1024 sc1
    s_waitcnt lgkmcnt(8)
    v_smfmac_f32_16x16x64_bf16 v[56:59], v[66:69], v[96:103], v70
    s_nop 0
    v_cvt_pk_bf16_f32 v112, v112, v113
    v_cvt_pk_bf16_f32 v113, v114, v115
    v_lshlrev_b32_sdwa v114, 3, v70 dst_sel:DWORD dst_unused:UNUSED_PAD src0_sel:DWORD src1_sel:WORD_1
    ds_write_b64 v114, v[112:113] offset:32768
    s_waitcnt vmcnt(2)
    v_lshlrev_b32_sdwa v96, 3, v124 dst_sel:DWORD dst_unused:UNUSED_PAD src0_sel:DWORD src1_sel:WORD_0
    v_lshlrev_b32_sdwa v98, 3, v124 dst_sel:DWORD dst_unused:UNUSED_PAD src0_sel:DWORD src1_sel:WORD_1
    ds_read_b64 v[96:97], v96
    ds_read_b64 v[98:99], v98
    v_lshlrev_b32_sdwa v100, 3, v125 dst_sel:DWORD dst_unused:UNUSED_PAD src0_sel:DWORD src1_sel:WORD_0
    v_lshlrev_b32_sdwa v102, 3, v125 dst_sel:DWORD dst_unused:UNUSED_PAD src0_sel:DWORD src1_sel:WORD_1
    v_cvt_pk_bf16_f32 v59, v58, v59
    v_cvt_pk_bf16_f32 v58, v56, v57
    v_and_b32 v57, s23, v55
    v_lshlrev_b32 v56, 16, v55
    v_and_b32 v55, s23, v54
    v_lshlrev_b32 v54, 16, v54
    ds_read_b64 v[100:101], v100
    ds_read_b64 v[102:103], v102
    s_waitcnt lgkmcnt(9)
    v_smfmac_f32_16x16x64_bf16 v[54:57], v[66:69], v[104:111], v70
    v_mfma_f32_16x16x32_bf16 v[112:115], v[72:75], v[144:147], 0
    v_lshlrev_b32_sdwa v104, 3, v126 dst_sel:DWORD dst_unused:UNUSED_PAD src0_sel:DWORD src1_sel:WORD_0
    v_lshlrev_b32_sdwa v106, 3, v126 dst_sel:DWORD dst_unused:UNUSED_PAD src0_sel:DWORD src1_sel:WORD_1
    ds_read_b64 v[104:105], v104
    ds_read_b64 v[106:107], v106
    v_mfma_f32_16x16x32_bf16 v[112:115], v[76:79], v[148:151], v[112:115]
    v_lshlrev_b32_sdwa v108, 3, v127 dst_sel:DWORD dst_unused:UNUSED_PAD src0_sel:DWORD src1_sel:WORD_0
    v_lshlrev_b32_sdwa v110, 3, v127 dst_sel:DWORD dst_unused:UNUSED_PAD src0_sel:DWORD src1_sel:WORD_1
    ds_read_b64 v[108:109], v108
    ds_read_b64 v[110:111], v110
    buffer_load_dwordx4 v[124:127], v71, s[12:15], s20 offen offset:2048 sc1
    s_waitcnt lgkmcnt(9)
    v_smfmac_f32_16x16x64_bf16 v[54:57], v[66:69], v[88:95], v70
    v_mfma_f32_16x16x32_bf16 v[112:115], v[80:83], v[152:155], v[112:115]
    s_waitcnt vmcnt(2)
    v_lshlrev_b32_sdwa v88, 3, v116 dst_sel:DWORD dst_unused:UNUSED_PAD src0_sel:DWORD src1_sel:WORD_0
    v_lshlrev_b32_sdwa v90, 3, v116 dst_sel:DWORD dst_unused:UNUSED_PAD src0_sel:DWORD src1_sel:WORD_1
    ds_read_b64 v[88:89], v88
    ds_read_b64 v[90:91], v90
    v_mfma_f32_16x16x32_bf16 v[112:115], v[84:87], v[156:159], v[112:115]
    v_lshlrev_b32_sdwa v92, 3, v117 dst_sel:DWORD dst_unused:UNUSED_PAD src0_sel:DWORD src1_sel:WORD_0
    v_lshlrev_b32_sdwa v94, 3, v117 dst_sel:DWORD dst_unused:UNUSED_PAD src0_sel:DWORD src1_sel:WORD_1
    v_cvt_pk_bf16_f32 v57, v56, v57
    v_cvt_pk_bf16_f32 v56, v54, v55
    v_and_b32 v55, s23, v53
    v_lshlrev_b32 v54, 16, v53
    v_and_b32 v53, s23, v52
    v_lshlrev_b32 v52, 16, v52
    ds_read_b64 v[92:93], v92
    ds_read_b64 v[94:95], v94
    s_waitcnt lgkmcnt(8)
    v_smfmac_f32_16x16x64_bf16 v[52:55], v[66:69], v[96:103], v70
    v_cvt_pk_bf16_f32 v112, v112, v113
    v_cvt_pk_bf16_f32 v113, v114, v115
    v_lshlrev_b32_sdwa v114, 3, v70 dst_sel:DWORD dst_unused:UNUSED_PAD src0_sel:DWORD src1_sel:WORD_1
    ds_write_b64 v114, v[112:113] offset:32896
    v_lshlrev_b32_sdwa v96, 3, v118 dst_sel:DWORD dst_unused:UNUSED_PAD src0_sel:DWORD src1_sel:WORD_0
    v_lshlrev_b32_sdwa v98, 3, v118 dst_sel:DWORD dst_unused:UNUSED_PAD src0_sel:DWORD src1_sel:WORD_1
    ds_read_b64 v[96:97], v96
    ds_read_b64 v[98:99], v98
    v_lshlrev_b32_sdwa v100, 3, v119 dst_sel:DWORD dst_unused:UNUSED_PAD src0_sel:DWORD src1_sel:WORD_0
    v_lshlrev_b32_sdwa v102, 3, v119 dst_sel:DWORD dst_unused:UNUSED_PAD src0_sel:DWORD src1_sel:WORD_1
    ds_read_b64 v[100:101], v100
    ds_read_b64 v[102:103], v102
    buffer_load_dwordx4 v[116:119], v71, s[12:15], s20 offen offset:3072 sc1
    s_waitcnt lgkmcnt(9)
    v_smfmac_f32_16x16x64_bf16 v[52:55], v[66:69], v[104:111], v70
    v_mfma_f32_16x16x32_bf16 v[112:115], v[72:75], v[160:163], 0
    s_waitcnt vmcnt(2)
    v_lshlrev_b32_sdwa v104, 3, v120 dst_sel:DWORD dst_unused:UNUSED_PAD src0_sel:DWORD src1_sel:WORD_0
    v_lshlrev_b32_sdwa v106, 3, v120 dst_sel:DWORD dst_unused:UNUSED_PAD src0_sel:DWORD src1_sel:WORD_1
    ds_read_b64 v[104:105], v104
    ds_read_b64 v[106:107], v106
    v_mfma_f32_16x16x32_bf16 v[112:115], v[76:79], v[164:167], v[112:115]
    v_lshlrev_b32_sdwa v108, 3, v121 dst_sel:DWORD dst_unused:UNUSED_PAD src0_sel:DWORD src1_sel:WORD_0
    v_lshlrev_b32_sdwa v110, 3, v121 dst_sel:DWORD dst_unused:UNUSED_PAD src0_sel:DWORD src1_sel:WORD_1
    v_cvt_pk_bf16_f32 v55, v54, v55
    v_cvt_pk_bf16_f32 v54, v52, v53
    v_and_b32 v53, s23, v51
    v_lshlrev_b32 v52, 16, v51
    v_and_b32 v51, s23, v50
    v_lshlrev_b32 v50, 16, v50
    ds_read_b64 v[108:109], v108
    ds_read_b64 v[110:111], v110
    s_waitcnt lgkmcnt(9)
    v_smfmac_f32_16x16x64_bf16 v[50:53], v[66:69], v[88:95], v70
    v_mfma_f32_16x16x32_bf16 v[112:115], v[80:83], v[168:171], v[112:115]
    v_lshlrev_b32_sdwa v88, 3, v122 dst_sel:DWORD dst_unused:UNUSED_PAD src0_sel:DWORD src1_sel:WORD_0
    v_lshlrev_b32_sdwa v90, 3, v122 dst_sel:DWORD dst_unused:UNUSED_PAD src0_sel:DWORD src1_sel:WORD_1
    ds_read_b64 v[88:89], v88
    ds_read_b64 v[90:91], v90
    v_mfma_f32_16x16x32_bf16 v[112:115], v[84:87], v[172:175], v[112:115]
    v_lshlrev_b32_sdwa v92, 3, v123 dst_sel:DWORD dst_unused:UNUSED_PAD src0_sel:DWORD src1_sel:WORD_0
    v_lshlrev_b32_sdwa v94, 3, v123 dst_sel:DWORD dst_unused:UNUSED_PAD src0_sel:DWORD src1_sel:WORD_1
    ds_read_b64 v[92:93], v92
    ds_read_b64 v[94:95], v94
    s_add_u32 s20, s20, 0x1000
    buffer_load_dwordx4 v[120:123], v71, s[12:15], s20 offen offset:0 sc1
    s_waitcnt lgkmcnt(8)
    v_smfmac_f32_16x16x64_bf16 v[50:53], v[66:69], v[96:103], v70
    v_cvt_pk_bf16_f32 v112, v112, v113
    v_cvt_pk_bf16_f32 v113, v114, v115
    v_lshlrev_b32_sdwa v114, 3, v70 dst_sel:DWORD dst_unused:UNUSED_PAD src0_sel:DWORD src1_sel:WORD_1
    ds_write_b64 v114, v[112:113] offset:33024
    s_setprio 2
    s_waitcnt vmcnt(2)
    v_lshlrev_b32_sdwa v96, 3, v124 dst_sel:DWORD dst_unused:UNUSED_PAD src0_sel:DWORD src1_sel:WORD_0
    v_lshlrev_b32_sdwa v98, 3, v124 dst_sel:DWORD dst_unused:UNUSED_PAD src0_sel:DWORD src1_sel:WORD_1
    ds_read_b64 v[96:97], v96
    ds_read_b64 v[98:99], v98
    v_lshlrev_b32_sdwa v100, 3, v125 dst_sel:DWORD dst_unused:UNUSED_PAD src0_sel:DWORD src1_sel:WORD_0
    v_lshlrev_b32_sdwa v102, 3, v125 dst_sel:DWORD dst_unused:UNUSED_PAD src0_sel:DWORD src1_sel:WORD_1
    v_cvt_pk_bf16_f32 v53, v52, v53
    v_cvt_pk_bf16_f32 v52, v50, v51
    v_and_b32 v51, s23, v49
    v_lshlrev_b32 v50, 16, v49
    v_and_b32 v49, s23, v48
    v_lshlrev_b32 v48, 16, v48
    ds_read_b64 v[100:101], v100
    ds_read_b64 v[102:103], v102
    s_waitcnt lgkmcnt(9)
    v_smfmac_f32_16x16x64_bf16 v[48:51], v[66:69], v[104:111], v70
    s_lshl_b32 s28, s38, 16
    s_and_b32 s29, s38, 0xffff0000
    v_mfma_f32_16x16x32_bf16 v[112:115], v[72:75], v[176:179], 0
    v_lshlrev_b32_sdwa v104, 3, v126 dst_sel:DWORD dst_unused:UNUSED_PAD src0_sel:DWORD src1_sel:WORD_0
    v_lshlrev_b32_sdwa v106, 3, v126 dst_sel:DWORD dst_unused:UNUSED_PAD src0_sel:DWORD src1_sel:WORD_1
    ds_read_b64 v[104:105], v104
    ds_read_b64 v[106:107], v106
    v_mfma_f32_16x16x32_bf16 v[112:115], v[76:79], v[180:183], v[112:115]
    v_lshlrev_b32_sdwa v108, 3, v127 dst_sel:DWORD dst_unused:UNUSED_PAD src0_sel:DWORD src1_sel:WORD_0
    v_lshlrev_b32_sdwa v110, 3, v127 dst_sel:DWORD dst_unused:UNUSED_PAD src0_sel:DWORD src1_sel:WORD_1
    ds_read_b64 v[108:109], v108
    ds_read_b64 v[110:111], v110
    buffer_load_dwordx4 v[124:127], v71, s[12:15], s20 offen offset:1024 sc1
    s_waitcnt lgkmcnt(9)
    v_smfmac_f32_16x16x64_bf16 v[48:51], v[66:69], v[88:95], v70
    s_lshl_b32 s30, s39, 16
    s_and_b32 s31, s39, 0xffff0000
    v_mfma_f32_16x16x32_bf16 v[112:115], v[80:83], v[184:187], v[112:115]
    s_waitcnt vmcnt(2)
    v_lshlrev_b32_sdwa v88, 3, v116 dst_sel:DWORD dst_unused:UNUSED_PAD src0_sel:DWORD src1_sel:WORD_0
    v_lshlrev_b32_sdwa v90, 3, v116 dst_sel:DWORD dst_unused:UNUSED_PAD src0_sel:DWORD src1_sel:WORD_1
    ds_read_b64 v[88:89], v88
    ds_read_b64 v[90:91], v90
    v_mfma_f32_16x16x32_bf16 v[112:115], v[84:87], v[188:191], v[112:115]
    v_lshlrev_b32_sdwa v92, 3, v117 dst_sel:DWORD dst_unused:UNUSED_PAD src0_sel:DWORD src1_sel:WORD_0
    v_lshlrev_b32_sdwa v94, 3, v117 dst_sel:DWORD dst_unused:UNUSED_PAD src0_sel:DWORD src1_sel:WORD_1
    v_cvt_pk_bf16_f32 v51, v50, v51
    v_cvt_pk_bf16_f32 v50, v48, v49
    v_and_b32 v49, s23, v47
    v_lshlrev_b32 v48, 16, v47
    v_and_b32 v47, s23, v46
    v_lshlrev_b32 v46, 16, v46
    ds_read_b64 v[92:93], v92
    ds_read_b64 v[94:95], v94
    s_waitcnt lgkmcnt(8)
    v_smfmac_f32_16x16x64_bf16 v[46:49], v[66:69], v[96:103], v70
    v_cvt_pk_bf16_f32 v112, v112, v113
    v_cvt_pk_bf16_f32 v113, v114, v115
    v_lshlrev_b32_sdwa v114, 3, v70 dst_sel:DWORD dst_unused:UNUSED_PAD src0_sel:DWORD src1_sel:WORD_1
    ds_write_b64 v114, v[112:113] offset:33152
    s_lshl1_add_u32 s35, s33, s34
    s_lshl3_add_u32 s35, s35, s3
    v_lshlrev_b32_sdwa v96, 3, v118 dst_sel:DWORD dst_unused:UNUSED_PAD src0_sel:DWORD src1_sel:WORD_0
    v_lshlrev_b32_sdwa v98, 3, v118 dst_sel:DWORD dst_unused:UNUSED_PAD src0_sel:DWORD src1_sel:WORD_1
    ds_read_b64 v[96:97], v96
    ds_read_b64 v[98:99], v98
    v_lshlrev_b32_sdwa v100, 3, v119 dst_sel:DWORD dst_unused:UNUSED_PAD src0_sel:DWORD src1_sel:WORD_0
    v_lshlrev_b32_sdwa v102, 3, v119 dst_sel:DWORD dst_unused:UNUSED_PAD src0_sel:DWORD src1_sel:WORD_1
    ds_read_b64 v[100:101], v100
    ds_read_b64 v[102:103], v102
    buffer_load_dwordx4 v[116:119], v71, s[12:15], s20 offen offset:2048 sc1
    s_waitcnt lgkmcnt(9)
    v_smfmac_f32_16x16x64_bf16 v[46:49], v[66:69], v[104:111], v70
    s_lshl_b32 s35, s35, 12
    s_add_u32 s35, s35, 20971520
    v_mfma_f32_16x16x32_bf16 v[112:115], v[72:75], v[192:195], 0
    s_waitcnt vmcnt(2)
    v_lshlrev_b32_sdwa v104, 3, v120 dst_sel:DWORD dst_unused:UNUSED_PAD src0_sel:DWORD src1_sel:WORD_0
    v_lshlrev_b32_sdwa v106, 3, v120 dst_sel:DWORD dst_unused:UNUSED_PAD src0_sel:DWORD src1_sel:WORD_1
    ds_read_b64 v[104:105], v104
    ds_read_b64 v[106:107], v106
    v_mfma_f32_16x16x32_bf16 v[112:115], v[76:79], v[196:199], v[112:115]
    v_lshlrev_b32_sdwa v108, 3, v121 dst_sel:DWORD dst_unused:UNUSED_PAD src0_sel:DWORD src1_sel:WORD_0
    v_lshlrev_b32_sdwa v110, 3, v121 dst_sel:DWORD dst_unused:UNUSED_PAD src0_sel:DWORD src1_sel:WORD_1
    v_cvt_pk_bf16_f32 v49, v48, v49
    v_cvt_pk_bf16_f32 v48, v46, v47
    v_and_b32 v47, s23, v45
    v_lshlrev_b32 v46, 16, v45
    v_and_b32 v45, s23, v44
    v_lshlrev_b32 v44, 16, v44
    ds_read_b64 v[108:109], v108
    ds_read_b64 v[110:111], v110
    s_waitcnt lgkmcnt(9)
    v_smfmac_f32_16x16x64_bf16 v[44:47], v[66:69], v[88:95], v70
    s_and_b32 s57, s57, 0xffff
    s_mov_b32 s58, 2
    v_mfma_f32_16x16x32_bf16 v[112:115], v[80:83], v[200:203], v[112:115]
    v_lshlrev_b32_sdwa v88, 3, v122 dst_sel:DWORD dst_unused:UNUSED_PAD src0_sel:DWORD src1_sel:WORD_0
    v_lshlrev_b32_sdwa v90, 3, v122 dst_sel:DWORD dst_unused:UNUSED_PAD src0_sel:DWORD src1_sel:WORD_1
    ds_read_b64 v[88:89], v88
    ds_read_b64 v[90:91], v90
    v_mfma_f32_16x16x32_bf16 v[112:115], v[84:87], v[204:207], v[112:115]
    v_lshlrev_b32_sdwa v92, 3, v123 dst_sel:DWORD dst_unused:UNUSED_PAD src0_sel:DWORD src1_sel:WORD_0
    v_lshlrev_b32_sdwa v94, 3, v123 dst_sel:DWORD dst_unused:UNUSED_PAD src0_sel:DWORD src1_sel:WORD_1
    ds_read_b64 v[92:93], v92
    ds_read_b64 v[94:95], v94
    buffer_load_dwordx4 v[120:123], v71, s[12:15], s20 offen offset:3072 sc1
    s_waitcnt lgkmcnt(8)
    v_smfmac_f32_16x16x64_bf16 v[44:47], v[66:69], v[96:103], v70
    s_nop 0
    v_cvt_pk_bf16_f32 v112, v112, v113
    v_cvt_pk_bf16_f32 v113, v114, v115
    v_lshlrev_b32_sdwa v114, 3, v70 dst_sel:DWORD dst_unused:UNUSED_PAD src0_sel:DWORD src1_sel:WORD_1
    ds_write_b64 v114, v[112:113] offset:33280
    s_mov_b32 s59, 0x00020000
    s_and_b32 s61, s61, 0xffff
    s_waitcnt vmcnt(2)
    v_lshlrev_b32_sdwa v96, 3, v124 dst_sel:DWORD dst_unused:UNUSED_PAD src0_sel:DWORD src1_sel:WORD_0
    v_lshlrev_b32_sdwa v98, 3, v124 dst_sel:DWORD dst_unused:UNUSED_PAD src0_sel:DWORD src1_sel:WORD_1
    ds_read_b64 v[96:97], v96
    ds_read_b64 v[98:99], v98
    v_lshlrev_b32_sdwa v100, 3, v125 dst_sel:DWORD dst_unused:UNUSED_PAD src0_sel:DWORD src1_sel:WORD_0
    v_lshlrev_b32_sdwa v102, 3, v125 dst_sel:DWORD dst_unused:UNUSED_PAD src0_sel:DWORD src1_sel:WORD_1
    v_cvt_pk_bf16_f32 v47, v46, v47
    v_cvt_pk_bf16_f32 v46, v44, v45
    v_and_b32 v45, s23, v43
    v_lshlrev_b32 v44, 16, v43
    v_and_b32 v43, s23, v42
    v_lshlrev_b32 v42, 16, v42
    ds_read_b64 v[100:101], v100
    ds_read_b64 v[102:103], v102
    s_waitcnt lgkmcnt(9)
    v_smfmac_f32_16x16x64_bf16 v[42:45], v[66:69], v[104:111], v70
    s_mov_b32 s62, 32768
    s_mov_b32 s63, 0x00020000
    v_mfma_f32_16x16x32_bf16 v[112:115], v[72:75], v[208:211], 0
    v_lshlrev_b32_sdwa v104, 3, v126 dst_sel:DWORD dst_unused:UNUSED_PAD src0_sel:DWORD src1_sel:WORD_0
    v_lshlrev_b32_sdwa v106, 3, v126 dst_sel:DWORD dst_unused:UNUSED_PAD src0_sel:DWORD src1_sel:WORD_1
    ds_read_b64 v[104:105], v104
    ds_read_b64 v[106:107], v106
    v_mfma_f32_16x16x32_bf16 v[112:115], v[76:79], v[212:215], v[112:115]
    v_lshlrev_b32_sdwa v108, 3, v127 dst_sel:DWORD dst_unused:UNUSED_PAD src0_sel:DWORD src1_sel:WORD_0
    v_lshlrev_b32_sdwa v110, 3, v127 dst_sel:DWORD dst_unused:UNUSED_PAD src0_sel:DWORD src1_sel:WORD_1
    ds_read_b64 v[108:109], v108
    ds_read_b64 v[110:111], v110
    s_add_u32 s20, s20, 0x1000
    buffer_load_dwordx4 v[124:127], v71, s[12:15], s20 offen offset:0 sc1
    s_waitcnt lgkmcnt(9)
    v_smfmac_f32_16x16x64_bf16 v[42:45], v[66:69], v[88:95], v70
    s_setprio 1
    s_xor_b32 s64, s34, 1
    s_lshl_b32 s64, s64, 7
    v_mfma_f32_16x16x32_bf16 v[112:115], v[80:83], v[216:219], v[112:115]
    s_waitcnt vmcnt(2)
    v_lshlrev_b32_sdwa v88, 3, v116 dst_sel:DWORD dst_unused:UNUSED_PAD src0_sel:DWORD src1_sel:WORD_0
    v_lshlrev_b32_sdwa v90, 3, v116 dst_sel:DWORD dst_unused:UNUSED_PAD src0_sel:DWORD src1_sel:WORD_1
    ds_read_b64 v[88:89], v88
    ds_read_b64 v[90:91], v90
    v_mfma_f32_16x16x32_bf16 v[112:115], v[84:87], v[220:223], v[112:115]
    v_lshlrev_b32_sdwa v92, 3, v117 dst_sel:DWORD dst_unused:UNUSED_PAD src0_sel:DWORD src1_sel:WORD_0
    v_lshlrev_b32_sdwa v94, 3, v117 dst_sel:DWORD dst_unused:UNUSED_PAD src0_sel:DWORD src1_sel:WORD_1
    v_cvt_pk_bf16_f32 v45, v44, v45
    v_cvt_pk_bf16_f32 v44, v42, v43
    v_and_b32 v43, s23, v41
    v_lshlrev_b32 v42, 16, v41
    v_and_b32 v41, s23, v40
    v_lshlrev_b32 v40, 16, v40
    ds_read_b64 v[92:93], v92
    ds_read_b64 v[94:95], v94
    s_waitcnt lgkmcnt(8)
    v_smfmac_f32_16x16x64_bf16 v[40:43], v[66:69], v[96:103], v70
    v_cvt_pk_bf16_f32 v112, v112, v113
    v_cvt_pk_bf16_f32 v113, v114, v115
    v_lshlrev_b32_sdwa v114, 3, v70 dst_sel:DWORD dst_unused:UNUSED_PAD src0_sel:DWORD src1_sel:WORD_1
    ds_write_b64 v114, v[112:113] offset:33408
    s_add_u32 s64, s64, s33
    s_lshl_b32 s65, s3, 20
    v_lshlrev_b32_sdwa v96, 3, v118 dst_sel:DWORD dst_unused:UNUSED_PAD src0_sel:DWORD src1_sel:WORD_0
    v_lshlrev_b32_sdwa v98, 3, v118 dst_sel:DWORD dst_unused:UNUSED_PAD src0_sel:DWORD src1_sel:WORD_1
    ds_read_b64 v[96:97], v96
    ds_read_b64 v[98:99], v98
    v_lshlrev_b32_sdwa v100, 3, v119 dst_sel:DWORD dst_unused:UNUSED_PAD src0_sel:DWORD src1_sel:WORD_0
    v_lshlrev_b32_sdwa v102, 3, v119 dst_sel:DWORD dst_unused:UNUSED_PAD src0_sel:DWORD src1_sel:WORD_1
    ds_read_b64 v[100:101], v100
    ds_read_b64 v[102:103], v102
    buffer_load_dwordx4 v[116:119], v71, s[12:15], s20 offen offset:1024 sc1
    s_waitcnt lgkmcnt(9)
    v_smfmac_f32_16x16x64_bf16 v[40:43], v[66:69], v[104:111], v70
    s_add_u32 s66, s65, 1048576
    s_lshl_b32 s67, s3, 14
    v_mfma_f32_16x16x32_bf16 v[112:115], v[72:75], v[224:227], 0
    s_waitcnt vmcnt(2)
    v_lshlrev_b32_sdwa v104, 3, v120 dst_sel:DWORD dst_unused:UNUSED_PAD src0_sel:DWORD src1_sel:WORD_0
    v_lshlrev_b32_sdwa v106, 3, v120 dst_sel:DWORD dst_unused:UNUSED_PAD src0_sel:DWORD src1_sel:WORD_1
    ds_read_b64 v[104:105], v104
    ds_read_b64 v[106:107], v106
    v_mfma_f32_16x16x32_bf16 v[112:115], v[76:79], v[228:231], v[112:115]
    v_lshlrev_b32_sdwa v108, 3, v121 dst_sel:DWORD dst_unused:UNUSED_PAD src0_sel:DWORD src1_sel:WORD_0
    v_lshlrev_b32_sdwa v110, 3, v121 dst_sel:DWORD dst_unused:UNUSED_PAD src0_sel:DWORD src1_sel:WORD_1
    v_cvt_pk_bf16_f32 v43, v42, v43
    v_cvt_pk_bf16_f32 v42, v40, v41
    v_and_b32 v41, s23, v39
    v_lshlrev_b32 v40, 16, v39
    v_and_b32 v39, s23, v38
    v_lshlrev_b32 v38, 16, v38
    ds_read_b64 v[108:109], v108
    ds_read_b64 v[110:111], v110
    s_waitcnt lgkmcnt(9)
    v_smfmac_f32_16x16x64_bf16 v[38:41], v[66:69], v[88:95], v70
    s_add_u32 s67, s67, 8000
    s_lshl_b32 s68, s64, 7
    v_mfma_f32_16x16x32_bf16 v[112:115], v[80:83], v[232:235], v[112:115]
    v_lshlrev_b32_sdwa v88, 3, v122 dst_sel:DWORD dst_unused:UNUSED_PAD src0_sel:DWORD src1_sel:WORD_0
    v_lshlrev_b32_sdwa v90, 3, v122 dst_sel:DWORD dst_unused:UNUSED_PAD src0_sel:DWORD src1_sel:WORD_1
    ds_read_b64 v[88:89], v88
    ds_read_b64 v[90:91], v90
    v_mfma_f32_16x16x32_bf16 v[112:115], v[84:87], v[236:239], v[112:115]
    v_lshlrev_b32_sdwa v92, 3, v123 dst_sel:DWORD dst_unused:UNUSED_PAD src0_sel:DWORD src1_sel:WORD_0
    v_lshlrev_b32_sdwa v94, 3, v123 dst_sel:DWORD dst_unused:UNUSED_PAD src0_sel:DWORD src1_sel:WORD_1
    ds_read_b64 v[92:93], v92
    ds_read_b64 v[94:95], v94
    s_add_u32 s20, s20, 0x3f800
    buffer_load_dwordx4 v[120:123], v71, s[12:15], s20 offen offset:3072 sc1
    s_waitcnt lgkmcnt(8)
    v_smfmac_f32_16x16x64_bf16 v[38:41], v[66:69], v[96:103], v70
    v_cvt_pk_bf16_f32 v112, v112, v113
    v_cvt_pk_bf16_f32 v113, v114, v115
    v_lshlrev_b32_sdwa v114, 3, v70 dst_sel:DWORD dst_unused:UNUSED_PAD src0_sel:DWORD src1_sel:WORD_1
    ds_write_b64 v114, v[112:113] offset:33536
    s_lshl_b32 s69, s64, 8
    s_add_u32 s69, s69, s65
    s_waitcnt vmcnt(2)
    v_lshlrev_b32_sdwa v96, 3, v124 dst_sel:DWORD dst_unused:UNUSED_PAD src0_sel:DWORD src1_sel:WORD_0
    v_lshlrev_b32_sdwa v98, 3, v124 dst_sel:DWORD dst_unused:UNUSED_PAD src0_sel:DWORD src1_sel:WORD_1
    ds_read_b64 v[96:97], v96
    ds_read_b64 v[98:99], v98
    v_lshlrev_b32_sdwa v100, 3, v125 dst_sel:DWORD dst_unused:UNUSED_PAD src0_sel:DWORD src1_sel:WORD_0
    v_lshlrev_b32_sdwa v102, 3, v125 dst_sel:DWORD dst_unused:UNUSED_PAD src0_sel:DWORD src1_sel:WORD_1
    v_cvt_pk_bf16_f32 v41, v40, v41
    v_cvt_pk_bf16_f32 v40, v38, v39
    v_and_b32 v39, s23, v37
    v_lshlrev_b32 v38, 16, v37
    v_and_b32 v37, s23, v36
    v_lshlrev_b32 v36, 16, v36
    ds_read_b64 v[100:101], v100
    ds_read_b64 v[102:103], v102
    s_waitcnt lgkmcnt(9)
    v_smfmac_f32_16x16x64_bf16 v[36:39], v[66:69], v[104:111], v70
    s_add_u32 s69, s69, 20971520
    s_mov_b32 s42, 0
    v_mfma_f32_16x16x32_bf16 v[112:115], v[72:75], v[240:243], 0
    v_lshlrev_b32_sdwa v104, 3, v126 dst_sel:DWORD dst_unused:UNUSED_PAD src0_sel:DWORD src1_sel:WORD_0
    v_lshlrev_b32_sdwa v106, 3, v126 dst_sel:DWORD dst_unused:UNUSED_PAD src0_sel:DWORD src1_sel:WORD_1
    ds_read_b64 v[104:105], v104
    ds_read_b64 v[106:107], v106
    v_mfma_f32_16x16x32_bf16 v[112:115], v[76:79], v[244:247], v[112:115]
    v_lshlrev_b32_sdwa v108, 3, v127 dst_sel:DWORD dst_unused:UNUSED_PAD src0_sel:DWORD src1_sel:WORD_0
    v_lshlrev_b32_sdwa v110, 3, v127 dst_sel:DWORD dst_unused:UNUSED_PAD src0_sel:DWORD src1_sel:WORD_1
    ds_read_b64 v[108:109], v108
    ds_read_b64 v[110:111], v110
    buffer_load_dwordx4 v[72:75], v71, s[12:15], s20 offen offset:2048 sc1
    s_waitcnt lgkmcnt(9)
    v_smfmac_f32_16x16x64_bf16 v[36:39], v[66:69], v[88:95], v70
    s_setprio 0
    s_mov_b32 s43, 0
    s_add_u32 s17, s16, 4096
    v_mfma_f32_16x16x32_bf16 v[112:115], v[80:83], v[248:251], v[112:115]
    s_waitcnt vmcnt(2)
    v_lshlrev_b32_sdwa v88, 3, v116 dst_sel:DWORD dst_unused:UNUSED_PAD src0_sel:DWORD src1_sel:WORD_0
    v_lshlrev_b32_sdwa v90, 3, v116 dst_sel:DWORD dst_unused:UNUSED_PAD src0_sel:DWORD src1_sel:WORD_1
    ds_read_b64 v[88:89], v88
    ds_read_b64 v[90:91], v90
    v_mfma_f32_16x16x32_bf16 v[112:115], v[84:87], v[252:255], v[112:115]
    v_lshlrev_b32_sdwa v92, 3, v117 dst_sel:DWORD dst_unused:UNUSED_PAD src0_sel:DWORD src1_sel:WORD_0
    v_lshlrev_b32_sdwa v94, 3, v117 dst_sel:DWORD dst_unused:UNUSED_PAD src0_sel:DWORD src1_sel:WORD_1
    v_cvt_pk_bf16_f32 v39, v38, v39
    v_cvt_pk_bf16_f32 v38, v36, v37
    v_and_b32 v37, s23, v35
    v_lshlrev_b32 v36, 16, v35
    v_and_b32 v35, s23, v34
    v_lshlrev_b32 v34, 16, v34
    ds_read_b64 v[92:93], v92
    ds_read_b64 v[94:95], v94
    buffer_load_dwordx4 v[76:79], v71, s[12:15], s20 offen offset:1024 sc1
    s_waitcnt lgkmcnt(8)
    v_smfmac_f32_16x16x64_bf16 v[34:37], v[66:69], v[96:103], v70
    v_cvt_pk_bf16_f32 v112, v112, v113
    v_cvt_pk_bf16_f32 v113, v114, v115
    v_lshlrev_b32_sdwa v114, 3, v70 dst_sel:DWORD dst_unused:UNUSED_PAD src0_sel:DWORD src1_sel:WORD_1
    ds_write_b64 v114, v[112:113] offset:33664
    s_add_u32 s32, s18, 4096
    v_lshlrev_b32_sdwa v96, 3, v118 dst_sel:DWORD dst_unused:UNUSED_PAD src0_sel:DWORD src1_sel:WORD_0
    v_lshlrev_b32_sdwa v98, 3, v118 dst_sel:DWORD dst_unused:UNUSED_PAD src0_sel:DWORD src1_sel:WORD_1
    ds_read_b64 v[96:97], v96
    ds_read_b64 v[98:99], v98
    v_lshlrev_b32_sdwa v100, 3, v119 dst_sel:DWORD dst_unused:UNUSED_PAD src0_sel:DWORD src1_sel:WORD_0
    v_lshlrev_b32_sdwa v102, 3, v119 dst_sel:DWORD dst_unused:UNUSED_PAD src0_sel:DWORD src1_sel:WORD_1
    ds_read_b64 v[100:101], v100
    ds_read_b64 v[102:103], v102
    buffer_load_dwordx4 v[124:127], v71, s[12:15], s20 offen offset:0 sc1
    s_waitcnt lgkmcnt(9)
    v_smfmac_f32_16x16x64_bf16 v[34:37], v[66:69], v[104:111], v70
    s_waitcnt lgkmcnt(4)
    s_barrier
    s_setprio 3
    s_waitcnt vmcnt(3)
    v_lshlrev_b32_sdwa v104, 3, v120 dst_sel:DWORD dst_unused:UNUSED_PAD src0_sel:DWORD src1_sel:WORD_0
    v_lshlrev_b32_sdwa v106, 3, v120 dst_sel:DWORD dst_unused:UNUSED_PAD src0_sel:DWORD src1_sel:WORD_1
    ds_read_b64 v[104:105], v104
    ds_read_b64 v[106:107], v106
    v_lshlrev_b32_sdwa v108, 3, v121 dst_sel:DWORD dst_unused:UNUSED_PAD src0_sel:DWORD src1_sel:WORD_0
    v_lshlrev_b32_sdwa v110, 3, v121 dst_sel:DWORD dst_unused:UNUSED_PAD src0_sel:DWORD src1_sel:WORD_1
    v_cvt_pk_bf16_f32 v37, v36, v37
    v_cvt_pk_bf16_f32 v36, v34, v35
    v_and_b32 v35, s23, v33
    v_lshlrev_b32 v34, 16, v33
    v_and_b32 v33, s23, v32
    v_lshlrev_b32 v32, 16, v32
    ds_read_b64 v[108:109], v108
    ds_read_b64 v[110:111], v110
    s_add_u32 s20, s20, 0xfffff000
    buffer_load_dwordx4 v[80:83], v71, s[12:15], s20 offen offset:3072 sc1
    v_smfmac_f32_16x16x64_bf16 v[32:35], v[66:69], v[88:95], v70
    v_lshlrev_b32_sdwa v88, 3, v122 dst_sel:DWORD dst_unused:UNUSED_PAD src0_sel:DWORD src1_sel:WORD_0
    v_lshlrev_b32_sdwa v90, 3, v122 dst_sel:DWORD dst_unused:UNUSED_PAD src0_sel:DWORD src1_sel:WORD_1
    ds_read_b64 v[88:89], v88
    ds_read_b64 v[90:91], v90
    v_lshlrev_b32_sdwa v92, 3, v123 dst_sel:DWORD dst_unused:UNUSED_PAD src0_sel:DWORD src1_sel:WORD_0
    v_lshlrev_b32_sdwa v94, 3, v123 dst_sel:DWORD dst_unused:UNUSED_PAD src0_sel:DWORD src1_sel:WORD_1
    ds_read_b64 v[92:93], v92
    ds_read_b64 v[94:95], v94
    buffer_load_dwordx4 v[84:87], v71, s[12:15], s20 offen offset:2048 sc1
    s_waitcnt lgkmcnt(8)
    v_smfmac_f32_16x16x64_bf16 v[32:35], v[66:69], v[96:103], v70
    s_waitcnt vmcnt(4)
    v_lshlrev_b32_sdwa v96, 3, v72 dst_sel:DWORD dst_unused:UNUSED_PAD src0_sel:DWORD src1_sel:WORD_0
    v_lshlrev_b32_sdwa v98, 3, v72 dst_sel:DWORD dst_unused:UNUSED_PAD src0_sel:DWORD src1_sel:WORD_1
    ds_read_b64 v[96:97], v96
    ds_read_b64 v[98:99], v98
    v_lshlrev_b32_sdwa v100, 3, v73 dst_sel:DWORD dst_unused:UNUSED_PAD src0_sel:DWORD src1_sel:WORD_0
    v_lshlrev_b32_sdwa v102, 3, v73 dst_sel:DWORD dst_unused:UNUSED_PAD src0_sel:DWORD src1_sel:WORD_1
    s_nop 0
    v_cvt_pk_bf16_f32 v35, v34, v35
    v_cvt_pk_bf16_f32 v34, v32, v33
    v_lshlrev_b32 v32, 16, v34
    v_and_b32 v33, s23, v34
    v_lshlrev_b32 v34, 16, v35
    v_and_b32 v35, s23, v35
    ds_read_b64 v[100:101], v100
    ds_read_b64 v[102:103], v102
    buffer_load_dwordx4 v[116:119], v71, s[12:15], s20 offen offset:1024 sc1
    s_waitcnt lgkmcnt(8)
    v_smfmac_f32_16x16x64_bf16 v[32:35], v[66:69], v[104:111], v70
    v_lshlrev_b32_sdwa v104, 3, v74 dst_sel:DWORD dst_unused:UNUSED_PAD src0_sel:DWORD src1_sel:WORD_0
    v_lshlrev_b32_sdwa v106, 3, v74 dst_sel:DWORD dst_unused:UNUSED_PAD src0_sel:DWORD src1_sel:WORD_1
    ds_read_b64 v[104:105], v104
    ds_read_b64 v[106:107], v106
    v_lshlrev_b32_sdwa v108, 3, v75 dst_sel:DWORD dst_unused:UNUSED_PAD src0_sel:DWORD src1_sel:WORD_0
    v_lshlrev_b32_sdwa v110, 3, v75 dst_sel:DWORD dst_unused:UNUSED_PAD src0_sel:DWORD src1_sel:WORD_1
    ds_read_b64 v[108:109], v108
    ds_read_b64 v[110:111], v110
    buffer_load_dwordx4 v[120:123], v71, s[12:15], s20 offen offset:0 sc1
    s_waitcnt lgkmcnt(8)
    v_smfmac_f32_16x16x64_bf16 v[32:35], v[66:69], v[88:95], v70
    s_waitcnt vmcnt(5)
    v_lshlrev_b32_sdwa v88, 3, v76 dst_sel:DWORD dst_unused:UNUSED_PAD src0_sel:DWORD src1_sel:WORD_0
    v_lshlrev_b32_sdwa v90, 3, v76 dst_sel:DWORD dst_unused:UNUSED_PAD src0_sel:DWORD src1_sel:WORD_1
    ds_read_b64 v[88:89], v88
    ds_read_b64 v[90:91], v90
    v_lshlrev_b32_sdwa v92, 3, v77 dst_sel:DWORD dst_unused:UNUSED_PAD src0_sel:DWORD src1_sel:WORD_0
    v_lshlrev_b32_sdwa v94, 3, v77 dst_sel:DWORD dst_unused:UNUSED_PAD src0_sel:DWORD src1_sel:WORD_1
    s_nop 0
    v_cvt_pk_bf16_f32 v32, v32, v33
    v_cvt_pk_bf16_f32 v33, v34, v35
    v_lshlrev_b32 v34, 16, v36
    v_and_b32 v35, s23, v36
    v_lshlrev_b32 v36, 16, v37
    v_and_b32 v37, s23, v37
    ds_read_b64 v[92:93], v92
    ds_read_b64 v[94:95], v94
    s_add_u32 s20, s20, 0xfffff000
    buffer_load_dwordx4 v[72:75], v71, s[12:15], s20 offen offset:3072 sc1
    s_waitcnt lgkmcnt(8)
    v_smfmac_f32_16x16x64_bf16 v[34:37], v[66:69], v[96:103], v70
    v_lshlrev_b32_sdwa v96, 3, v78 dst_sel:DWORD dst_unused:UNUSED_PAD src0_sel:DWORD src1_sel:WORD_0
    v_lshlrev_b32_sdwa v98, 3, v78 dst_sel:DWORD dst_unused:UNUSED_PAD src0_sel:DWORD src1_sel:WORD_1
    ds_read_b64 v[96:97], v96
    ds_read_b64 v[98:99], v98
    v_lshlrev_b32_sdwa v100, 3, v79 dst_sel:DWORD dst_unused:UNUSED_PAD src0_sel:DWORD src1_sel:WORD_0
    v_lshlrev_b32_sdwa v102, 3, v79 dst_sel:DWORD dst_unused:UNUSED_PAD src0_sel:DWORD src1_sel:WORD_1
    ds_read_b64 v[100:101], v100
    ds_read_b64 v[102:103], v102
    buffer_load_dwordx4 v[76:79], v71, s[12:15], s20 offen offset:2048 sc1
    s_waitcnt lgkmcnt(8)
    v_smfmac_f32_16x16x64_bf16 v[34:37], v[66:69], v[104:111], v70
    s_waitcnt vmcnt(6)
    v_lshlrev_b32_sdwa v104, 3, v124 dst_sel:DWORD dst_unused:UNUSED_PAD src0_sel:DWORD src1_sel:WORD_0
    v_lshlrev_b32_sdwa v106, 3, v124 dst_sel:DWORD dst_unused:UNUSED_PAD src0_sel:DWORD src1_sel:WORD_1
    ds_read_b64 v[104:105], v104
    ds_read_b64 v[106:107], v106
    v_lshlrev_b32_sdwa v108, 3, v125 dst_sel:DWORD dst_unused:UNUSED_PAD src0_sel:DWORD src1_sel:WORD_0
    v_lshlrev_b32_sdwa v110, 3, v125 dst_sel:DWORD dst_unused:UNUSED_PAD src0_sel:DWORD src1_sel:WORD_1
    s_nop 0
    v_cvt_pk_bf16_f32 v34, v34, v35
    v_cvt_pk_bf16_f32 v35, v36, v37
    v_lshlrev_b32 v36, 16, v38
    v_and_b32 v37, s23, v38
    v_lshlrev_b32 v38, 16, v39
    v_and_b32 v39, s23, v39
    ds_read_b64 v[108:109], v108
    ds_read_b64 v[110:111], v110
    buffer_store_dwordx4 v[32:35], v71, s[12:15], s16 offen offset:0 sc1
    s_waitcnt lgkmcnt(8)
    v_smfmac_f32_16x16x64_bf16 v[36:39], v[66:69], v[88:95], v70
    v_lshlrev_b32_sdwa v88, 3, v126 dst_sel:DWORD dst_unused:UNUSED_PAD src0_sel:DWORD src1_sel:WORD_0
    v_lshlrev_b32_sdwa v90, 3, v126 dst_sel:DWORD dst_unused:UNUSED_PAD src0_sel:DWORD src1_sel:WORD_1
    ds_read_b64 v[88:89], v88
    ds_read_b64 v[90:91], v90
    v_lshlrev_b32_sdwa v92, 3, v127 dst_sel:DWORD dst_unused:UNUSED_PAD src0_sel:DWORD src1_sel:WORD_0
    v_lshlrev_b32_sdwa v94, 3, v127 dst_sel:DWORD dst_unused:UNUSED_PAD src0_sel:DWORD src1_sel:WORD_1
    ds_read_b64 v[92:93], v92
    ds_read_b64 v[94:95], v94
    buffer_load_dwordx4 v[124:127], v71, s[12:15], s20 offen offset:1024 sc1
    s_waitcnt lgkmcnt(8)
    v_smfmac_f32_16x16x64_bf16 v[36:39], v[66:69], v[96:103], v70
    s_waitcnt vmcnt(7)
    v_lshlrev_b32_sdwa v96, 3, v80 dst_sel:DWORD dst_unused:UNUSED_PAD src0_sel:DWORD src1_sel:WORD_0
    v_lshlrev_b32_sdwa v98, 3, v80 dst_sel:DWORD dst_unused:UNUSED_PAD src0_sel:DWORD src1_sel:WORD_1
    ds_read_b64 v[96:97], v96
    ds_read_b64 v[98:99], v98
    v_lshlrev_b32_sdwa v100, 3, v81 dst_sel:DWORD dst_unused:UNUSED_PAD src0_sel:DWORD src1_sel:WORD_0
    v_lshlrev_b32_sdwa v102, 3, v81 dst_sel:DWORD dst_unused:UNUSED_PAD src0_sel:DWORD src1_sel:WORD_1
    s_nop 0
    v_cvt_pk_bf16_f32 v36, v36, v37
    v_cvt_pk_bf16_f32 v37, v38, v39
    v_lshlrev_b32 v38, 16, v40
    v_and_b32 v39, s23, v40
    v_lshlrev_b32 v40, 16, v41
    v_and_b32 v41, s23, v41
    ds_read_b64 v[100:101], v100
    ds_read_b64 v[102:103], v102
    s_waitcnt lgkmcnt(8)
    v_smfmac_f32_16x16x64_bf16 v[38:41], v[66:69], v[104:111], v70
    v_lshlrev_b32_sdwa v104, 3, v82 dst_sel:DWORD dst_unused:UNUSED_PAD src0_sel:DWORD src1_sel:WORD_0
    v_lshlrev_b32_sdwa v106, 3, v82 dst_sel:DWORD dst_unused:UNUSED_PAD src0_sel:DWORD src1_sel:WORD_1
    ds_read_b64 v[104:105], v104
    ds_read_b64 v[106:107], v106
    v_lshlrev_b32_sdwa v108, 3, v83 dst_sel:DWORD dst_unused:UNUSED_PAD src0_sel:DWORD src1_sel:WORD_0
    v_lshlrev_b32_sdwa v110, 3, v83 dst_sel:DWORD dst_unused:UNUSED_PAD src0_sel:DWORD src1_sel:WORD_1
    ds_read_b64 v[108:109], v108
    ds_read_b64 v[110:111], v110
    buffer_load_dwordx4 v[80:83], v71, s[12:15], s20 offen offset:0 sc1
    s_waitcnt lgkmcnt(8)
    v_smfmac_f32_16x16x64_bf16 v[38:41], v[66:69], v[88:95], v70
    s_waitcnt vmcnt(7)
    v_lshlrev_b32_sdwa v88, 3, v84 dst_sel:DWORD dst_unused:UNUSED_PAD src0_sel:DWORD src1_sel:WORD_0
    v_lshlrev_b32_sdwa v90, 3, v84 dst_sel:DWORD dst_unused:UNUSED_PAD src0_sel:DWORD src1_sel:WORD_1
    ds_read_b64 v[88:89], v88
    ds_read_b64 v[90:91], v90
    v_lshlrev_b32_sdwa v92, 3, v85 dst_sel:DWORD dst_unused:UNUSED_PAD src0_sel:DWORD src1_sel:WORD_0
    v_lshlrev_b32_sdwa v94, 3, v85 dst_sel:DWORD dst_unused:UNUSED_PAD src0_sel:DWORD src1_sel:WORD_1
    s_nop 0
    v_cvt_pk_bf16_f32 v38, v38, v39
    v_cvt_pk_bf16_f32 v39, v40, v41
    v_lshlrev_b32 v40, 16, v42
    v_and_b32 v41, s23, v42
    v_lshlrev_b32 v42, 16, v43
    v_and_b32 v43, s23, v43
    ds_read_b64 v[92:93], v92
    ds_read_b64 v[94:95], v94
    s_waitcnt lgkmcnt(8)
    v_smfmac_f32_16x16x64_bf16 v[40:43], v[66:69], v[96:103], v70
    v_lshlrev_b32_sdwa v96, 3, v86 dst_sel:DWORD dst_unused:UNUSED_PAD src0_sel:DWORD src1_sel:WORD_0
    v_lshlrev_b32_sdwa v98, 3, v86 dst_sel:DWORD dst_unused:UNUSED_PAD src0_sel:DWORD src1_sel:WORD_1
    ds_read_b64 v[96:97], v96
    ds_read_b64 v[98:99], v98
    v_lshlrev_b32_sdwa v100, 3, v87 dst_sel:DWORD dst_unused:UNUSED_PAD src0_sel:DWORD src1_sel:WORD_0
    v_lshlrev_b32_sdwa v102, 3, v87 dst_sel:DWORD dst_unused:UNUSED_PAD src0_sel:DWORD src1_sel:WORD_1
    ds_read_b64 v[100:101], v100
    ds_read_b64 v[102:103], v102
    s_add_u32 s20, s20, 0xfffffc00
    buffer_load_dwordx4 v[84:87], v71, s[12:15], s20 offen offset:0 sc1
    s_waitcnt lgkmcnt(8)
    v_smfmac_f32_16x16x64_bf16 v[40:43], v[66:69], v[104:111], v70
    s_waitcnt vmcnt(7)
    v_lshlrev_b32_sdwa v104, 3, v116 dst_sel:DWORD dst_unused:UNUSED_PAD src0_sel:DWORD src1_sel:WORD_0
    v_lshlrev_b32_sdwa v106, 3, v116 dst_sel:DWORD dst_unused:UNUSED_PAD src0_sel:DWORD src1_sel:WORD_1
    ds_read_b64 v[104:105], v104
    ds_read_b64 v[106:107], v106
    v_lshlrev_b32_sdwa v108, 3, v117 dst_sel:DWORD dst_unused:UNUSED_PAD src0_sel:DWORD src1_sel:WORD_0
    v_lshlrev_b32_sdwa v110, 3, v117 dst_sel:DWORD dst_unused:UNUSED_PAD src0_sel:DWORD src1_sel:WORD_1
    s_nop 0
    v_cvt_pk_bf16_f32 v40, v40, v41
    v_cvt_pk_bf16_f32 v41, v42, v43
    v_lshlrev_b32 v42, 16, v44
    v_and_b32 v43, s23, v44
    v_lshlrev_b32 v44, 16, v45
    v_and_b32 v45, s23, v45
    ds_read_b64 v[108:109], v108
    ds_read_b64 v[110:111], v110
    s_waitcnt lgkmcnt(8)
    v_smfmac_f32_16x16x64_bf16 v[42:45], v[66:69], v[88:95], v70
    v_lshlrev_b32_sdwa v88, 3, v118 dst_sel:DWORD dst_unused:UNUSED_PAD src0_sel:DWORD src1_sel:WORD_0
    v_lshlrev_b32_sdwa v90, 3, v118 dst_sel:DWORD dst_unused:UNUSED_PAD src0_sel:DWORD src1_sel:WORD_1
    ds_read_b64 v[88:89], v88
    ds_read_b64 v[90:91], v90
    v_lshlrev_b32_sdwa v92, 3, v119 dst_sel:DWORD dst_unused:UNUSED_PAD src0_sel:DWORD src1_sel:WORD_0
    v_lshlrev_b32_sdwa v94, 3, v119 dst_sel:DWORD dst_unused:UNUSED_PAD src0_sel:DWORD src1_sel:WORD_1
    ds_read_b64 v[92:93], v92
    ds_read_b64 v[94:95], v94
    s_add_u32 s20, s20, 0xfffffc00
    buffer_load_dwordx4 v[116:119], v71, s[12:15], s20 offen offset:0 sc1
    s_waitcnt lgkmcnt(8)
    v_smfmac_f32_16x16x64_bf16 v[42:45], v[66:69], v[96:103], v70
    s_waitcnt vmcnt(7)
    v_lshlrev_b32_sdwa v96, 3, v120 dst_sel:DWORD dst_unused:UNUSED_PAD src0_sel:DWORD src1_sel:WORD_0
    v_lshlrev_b32_sdwa v98, 3, v120 dst_sel:DWORD dst_unused:UNUSED_PAD src0_sel:DWORD src1_sel:WORD_1
    ds_read_b64 v[96:97], v96
    ds_read_b64 v[98:99], v98
    v_lshlrev_b32_sdwa v100, 3, v121 dst_sel:DWORD dst_unused:UNUSED_PAD src0_sel:DWORD src1_sel:WORD_0
    v_lshlrev_b32_sdwa v102, 3, v121 dst_sel:DWORD dst_unused:UNUSED_PAD src0_sel:DWORD src1_sel:WORD_1
    s_nop 0
    v_cvt_pk_bf16_f32 v42, v42, v43
    v_cvt_pk_bf16_f32 v43, v44, v45
    v_lshlrev_b32 v44, 16, v46
    v_and_b32 v45, s23, v46
    v_lshlrev_b32 v46, 16, v47
    v_and_b32 v47, s23, v47
    ds_read_b64 v[100:101], v100
    ds_read_b64 v[102:103], v102
    buffer_store_dwordx4 v[36:39], v71, s[12:15], s16 offen offset:1024 sc1
    s_waitcnt lgkmcnt(8)
    v_smfmac_f32_16x16x64_bf16 v[44:47], v[66:69], v[104:111], v70
    v_lshlrev_b32_sdwa v104, 3, v122 dst_sel:DWORD dst_unused:UNUSED_PAD src0_sel:DWORD src1_sel:WORD_0
    v_lshlrev_b32_sdwa v106, 3, v122 dst_sel:DWORD dst_unused:UNUSED_PAD src0_sel:DWORD src1_sel:WORD_1
    ds_read_b64 v[104:105], v104
    ds_read_b64 v[106:107], v106
    v_lshlrev_b32_sdwa v108, 3, v123 dst_sel:DWORD dst_unused:UNUSED_PAD src0_sel:DWORD src1_sel:WORD_0
    v_lshlrev_b32_sdwa v110, 3, v123 dst_sel:DWORD dst_unused:UNUSED_PAD src0_sel:DWORD src1_sel:WORD_1
    ds_read_b64 v[108:109], v108
    ds_read_b64 v[110:111], v110
    s_add_u32 s20, s20, 0x3c00
    buffer_load_dwordx4 v[36:39], v71, s[12:15], s20 offen offset:0 sc1
    s_waitcnt lgkmcnt(8)
    v_smfmac_f32_16x16x64_bf16 v[44:47], v[66:69], v[88:95], v70
    s_waitcnt vmcnt(8)
    v_lshlrev_b32_sdwa v88, 3, v72 dst_sel:DWORD dst_unused:UNUSED_PAD src0_sel:DWORD src1_sel:WORD_0
    v_lshlrev_b32_sdwa v90, 3, v72 dst_sel:DWORD dst_unused:UNUSED_PAD src0_sel:DWORD src1_sel:WORD_1
    ds_read_b64 v[88:89], v88
    ds_read_b64 v[90:91], v90
    v_lshlrev_b32_sdwa v92, 3, v73 dst_sel:DWORD dst_unused:UNUSED_PAD src0_sel:DWORD src1_sel:WORD_0
    v_lshlrev_b32_sdwa v94, 3, v73 dst_sel:DWORD dst_unused:UNUSED_PAD src0_sel:DWORD src1_sel:WORD_1
    s_nop 0
    v_cvt_pk_bf16_f32 v44, v44, v45
    v_cvt_pk_bf16_f32 v45, v46, v47
    v_lshlrev_b32 v46, 16, v48
    v_and_b32 v47, s23, v48
    v_lshlrev_b32 v48, 16, v49
    v_and_b32 v49, s23, v49
    ds_read_b64 v[92:93], v92
    ds_read_b64 v[94:95], v94
    s_add_u32 s20, s20, 0xfffffc00
    buffer_load_dwordx4 v[120:123], v71, s[12:15], s20 offen offset:0 sc1
    s_waitcnt lgkmcnt(8)
    v_smfmac_f32_16x16x64_bf16 v[46:49], v[66:69], v[96:103], v70
    v_lshlrev_b32_sdwa v96, 3, v74 dst_sel:DWORD dst_unused:UNUSED_PAD src0_sel:DWORD src1_sel:WORD_0
    v_lshlrev_b32_sdwa v98, 3, v74 dst_sel:DWORD dst_unused:UNUSED_PAD src0_sel:DWORD src1_sel:WORD_1
    ds_read_b64 v[96:97], v96
    ds_read_b64 v[98:99], v98
    v_lshlrev_b32_sdwa v100, 3, v75 dst_sel:DWORD dst_unused:UNUSED_PAD src0_sel:DWORD src1_sel:WORD_0
    v_lshlrev_b32_sdwa v102, 3, v75 dst_sel:DWORD dst_unused:UNUSED_PAD src0_sel:DWORD src1_sel:WORD_1
    ds_read_b64 v[100:101], v100
    ds_read_b64 v[102:103], v102
    s_waitcnt lgkmcnt(8)
    v_smfmac_f32_16x16x64_bf16 v[46:49], v[66:69], v[104:111], v70
    s_waitcnt vmcnt(8)
    v_lshlrev_b32_sdwa v104, 3, v76 dst_sel:DWORD dst_unused:UNUSED_PAD src0_sel:DWORD src1_sel:WORD_0
    v_lshlrev_b32_sdwa v106, 3, v76 dst_sel:DWORD dst_unused:UNUSED_PAD src0_sel:DWORD src1_sel:WORD_1
    ds_read_b64 v[104:105], v104
    ds_read_b64 v[106:107], v106
    v_lshlrev_b32_sdwa v108, 3, v77 dst_sel:DWORD dst_unused:UNUSED_PAD src0_sel:DWORD src1_sel:WORD_0
    v_lshlrev_b32_sdwa v110, 3, v77 dst_sel:DWORD dst_unused:UNUSED_PAD src0_sel:DWORD src1_sel:WORD_1
    s_nop 0
    v_cvt_pk_bf16_f32 v46, v46, v47
    v_cvt_pk_bf16_f32 v47, v48, v49
    v_lshlrev_b32 v48, 16, v50
    v_and_b32 v49, s23, v50
    v_lshlrev_b32 v50, 16, v51
    v_and_b32 v51, s23, v51
    ds_read_b64 v[108:109], v108
    ds_read_b64 v[110:111], v110
    s_add_u32 s20, s20, 0xfff9ec00
    buffer_load_dwordx4 v[72:75], v71, s[12:15], s20 offen offset:3072 sc1
    s_waitcnt lgkmcnt(8)
    v_smfmac_f32_16x16x64_bf16 v[48:51], v[66:69], v[88:95], v70
    v_lshlrev_b32_sdwa v88, 3, v78 dst_sel:DWORD dst_unused:UNUSED_PAD src0_sel:DWORD src1_sel:WORD_0
    v_lshlrev_b32_sdwa v90, 3, v78 dst_sel:DWORD dst_unused:UNUSED_PAD src0_sel:DWORD src1_sel:WORD_1
    ds_read_b64 v[88:89], v88
    ds_read_b64 v[90:91], v90
    v_lshlrev_b32_sdwa v92, 3, v79 dst_sel:DWORD dst_unused:UNUSED_PAD src0_sel:DWORD src1_sel:WORD_0
    v_lshlrev_b32_sdwa v94, 3, v79 dst_sel:DWORD dst_unused:UNUSED_PAD src0_sel:DWORD src1_sel:WORD_1
    ds_read_b64 v[92:93], v92
    ds_read_b64 v[94:95], v94
    s_waitcnt lgkmcnt(8)
    v_smfmac_f32_16x16x64_bf16 v[48:51], v[66:69], v[96:103], v70
    s_waitcnt vmcnt(7)
    v_lshlrev_b32_sdwa v96, 3, v124 dst_sel:DWORD dst_unused:UNUSED_PAD src0_sel:DWORD src1_sel:WORD_0
    v_lshlrev_b32_sdwa v98, 3, v124 dst_sel:DWORD dst_unused:UNUSED_PAD src0_sel:DWORD src1_sel:WORD_1
    ds_read_b64 v[96:97], v96
    ds_read_b64 v[98:99], v98
    v_lshlrev_b32_sdwa v100, 3, v125 dst_sel:DWORD dst_unused:UNUSED_PAD src0_sel:DWORD src1_sel:WORD_0
    v_lshlrev_b32_sdwa v102, 3, v125 dst_sel:DWORD dst_unused:UNUSED_PAD src0_sel:DWORD src1_sel:WORD_1
    s_nop 0
    v_cvt_pk_bf16_f32 v48, v48, v49
    v_cvt_pk_bf16_f32 v49, v50, v51
    v_lshlrev_b32 v50, 16, v52
    v_and_b32 v51, s23, v52
    v_lshlrev_b32 v52, 16, v53
    v_and_b32 v53, s23, v53
    ds_read_b64 v[100:101], v100
    ds_read_b64 v[102:103], v102
    buffer_load_dwordx4 v[76:79], v71, s[12:15], s20 offen offset:2048 sc1
    s_waitcnt lgkmcnt(8)
    v_smfmac_f32_16x16x64_bf16 v[50:53], v[66:69], v[104:111], v70
    v_lshlrev_b32_sdwa v104, 3, v126 dst_sel:DWORD dst_unused:UNUSED_PAD src0_sel:DWORD src1_sel:WORD_0
    v_lshlrev_b32_sdwa v106, 3, v126 dst_sel:DWORD dst_unused:UNUSED_PAD src0_sel:DWORD src1_sel:WORD_1
    ds_read_b64 v[104:105], v104
    ds_read_b64 v[106:107], v106
    v_lshlrev_b32_sdwa v108, 3, v127 dst_sel:DWORD dst_unused:UNUSED_PAD src0_sel:DWORD src1_sel:WORD_0
    v_lshlrev_b32_sdwa v110, 3, v127 dst_sel:DWORD dst_unused:UNUSED_PAD src0_sel:DWORD src1_sel:WORD_1
    ds_read_b64 v[108:109], v108
    ds_read_b64 v[110:111], v110
    s_waitcnt lgkmcnt(8)
    v_smfmac_f32_16x16x64_bf16 v[50:53], v[66:69], v[88:95], v70
    s_waitcnt vmcnt(7)
    v_lshlrev_b32_sdwa v88, 3, v80 dst_sel:DWORD dst_unused:UNUSED_PAD src0_sel:DWORD src1_sel:WORD_0
    v_lshlrev_b32_sdwa v90, 3, v80 dst_sel:DWORD dst_unused:UNUSED_PAD src0_sel:DWORD src1_sel:WORD_1
    ds_read_b64 v[88:89], v88
    ds_read_b64 v[90:91], v90
    v_lshlrev_b32_sdwa v92, 3, v81 dst_sel:DWORD dst_unused:UNUSED_PAD src0_sel:DWORD src1_sel:WORD_0
    v_lshlrev_b32_sdwa v94, 3, v81 dst_sel:DWORD dst_unused:UNUSED_PAD src0_sel:DWORD src1_sel:WORD_1
    s_nop 0
    v_cvt_pk_bf16_f32 v50, v50, v51
    v_cvt_pk_bf16_f32 v51, v52, v53
    v_lshlrev_b32 v52, 16, v54
    v_and_b32 v53, s23, v54
    v_lshlrev_b32 v54, 16, v55
    v_and_b32 v55, s23, v55
    ds_read_b64 v[92:93], v92
    ds_read_b64 v[94:95], v94
    buffer_load_dwordx4 v[124:127], v71, s[12:15], s20 offen offset:1024 sc1
    buffer_store_dwordx4 v[40:43], v71, s[12:15], s16 offen offset:2048 sc1
    s_waitcnt lgkmcnt(8)
    v_smfmac_f32_16x16x64_bf16 v[52:55], v[66:69], v[96:103], v70
    v_lshlrev_b32_sdwa v96, 3, v82 dst_sel:DWORD dst_unused:UNUSED_PAD src0_sel:DWORD src1_sel:WORD_0
    v_lshlrev_b32_sdwa v98, 3, v82 dst_sel:DWORD dst_unused:UNUSED_PAD src0_sel:DWORD src1_sel:WORD_1
    ds_read_b64 v[96:97], v96
    ds_read_b64 v[98:99], v98
    v_lshlrev_b32_sdwa v100, 3, v83 dst_sel:DWORD dst_unused:UNUSED_PAD src0_sel:DWORD src1_sel:WORD_0
    v_lshlrev_b32_sdwa v102, 3, v83 dst_sel:DWORD dst_unused:UNUSED_PAD src0_sel:DWORD src1_sel:WORD_1
    ds_read_b64 v[100:101], v100
    ds_read_b64 v[102:103], v102
    s_waitcnt lgkmcnt(8)
    v_smfmac_f32_16x16x64_bf16 v[52:55], v[66:69], v[104:111], v70
    s_waitcnt vmcnt(8)
    v_lshlrev_b32_sdwa v104, 3, v84 dst_sel:DWORD dst_unused:UNUSED_PAD src0_sel:DWORD src1_sel:WORD_0
    v_lshlrev_b32_sdwa v106, 3, v84 dst_sel:DWORD dst_unused:UNUSED_PAD src0_sel:DWORD src1_sel:WORD_1
    ds_read_b64 v[104:105], v104
    ds_read_b64 v[106:107], v106
    v_lshlrev_b32_sdwa v108, 3, v85 dst_sel:DWORD dst_unused:UNUSED_PAD src0_sel:DWORD src1_sel:WORD_0
    v_lshlrev_b32_sdwa v110, 3, v85 dst_sel:DWORD dst_unused:UNUSED_PAD src0_sel:DWORD src1_sel:WORD_1
    s_nop 0
    v_cvt_pk_bf16_f32 v52, v52, v53
    v_cvt_pk_bf16_f32 v53, v54, v55
    v_lshlrev_b32 v54, 16, v56
    v_and_b32 v55, s23, v56
    v_lshlrev_b32 v56, 16, v57
    v_and_b32 v57, s23, v57
    ds_read_b64 v[108:109], v108
    ds_read_b64 v[110:111], v110
    buffer_load_dwordx4 v[80:83], v71, s[12:15], s19 offen offset:0
    buffer_load_dwordx4 v[40:43], v71, s[12:15], s20 offen offset:0 sc1
    s_waitcnt lgkmcnt(8)
    v_smfmac_f32_16x16x64_bf16 v[54:57], v[66:69], v[88:95], v70
    v_lshlrev_b32_sdwa v88, 3, v86 dst_sel:DWORD dst_unused:UNUSED_PAD src0_sel:DWORD src1_sel:WORD_0
    v_lshlrev_b32_sdwa v90, 3, v86 dst_sel:DWORD dst_unused:UNUSED_PAD src0_sel:DWORD src1_sel:WORD_1
    ds_read_b64 v[88:89], v88
    ds_read_b64 v[90:91], v90
    v_lshlrev_b32_sdwa v92, 3, v87 dst_sel:DWORD dst_unused:UNUSED_PAD src0_sel:DWORD src1_sel:WORD_0
    v_lshlrev_b32_sdwa v94, 3, v87 dst_sel:DWORD dst_unused:UNUSED_PAD src0_sel:DWORD src1_sel:WORD_1
    ds_read_b64 v[92:93], v92
    ds_read_b64 v[94:95], v94
    buffer_load_dwordx4 v[84:87], v71, s[12:15], s19 offen offset:1024
    s_waitcnt lgkmcnt(8)
    v_smfmac_f32_16x16x64_bf16 v[54:57], v[66:69], v[96:103], v70
    s_waitcnt vmcnt(10)
    v_lshlrev_b32_sdwa v96, 3, v116 dst_sel:DWORD dst_unused:UNUSED_PAD src0_sel:DWORD src1_sel:WORD_0
    v_lshlrev_b32_sdwa v98, 3, v116 dst_sel:DWORD dst_unused:UNUSED_PAD src0_sel:DWORD src1_sel:WORD_1
    ds_read_b64 v[96:97], v96
    ds_read_b64 v[98:99], v98
    v_lshlrev_b32_sdwa v100, 3, v117 dst_sel:DWORD dst_unused:UNUSED_PAD src0_sel:DWORD src1_sel:WORD_0
    v_lshlrev_b32_sdwa v102, 3, v117 dst_sel:DWORD dst_unused:UNUSED_PAD src0_sel:DWORD src1_sel:WORD_1
    s_nop 0
    v_cvt_pk_bf16_f32 v54, v54, v55
    v_cvt_pk_bf16_f32 v55, v56, v57
    v_lshlrev_b32 v56, 16, v58
    v_and_b32 v57, s23, v58
    v_lshlrev_b32 v58, 16, v59
    v_and_b32 v59, s23, v59
    ds_read_b64 v[100:101], v100
    ds_read_b64 v[102:103], v102
    s_waitcnt lgkmcnt(8)
    v_smfmac_f32_16x16x64_bf16 v[56:59], v[66:69], v[104:111], v70
    v_lshlrev_b32_sdwa v104, 3, v118 dst_sel:DWORD dst_unused:UNUSED_PAD src0_sel:DWORD src1_sel:WORD_0
    v_lshlrev_b32_sdwa v106, 3, v118 dst_sel:DWORD dst_unused:UNUSED_PAD src0_sel:DWORD src1_sel:WORD_1
    ds_read_b64 v[104:105], v104
    ds_read_b64 v[106:107], v106
    v_lshlrev_b32_sdwa v108, 3, v119 dst_sel:DWORD dst_unused:UNUSED_PAD src0_sel:DWORD src1_sel:WORD_0
    v_lshlrev_b32_sdwa v110, 3, v119 dst_sel:DWORD dst_unused:UNUSED_PAD src0_sel:DWORD src1_sel:WORD_1
    ds_read_b64 v[108:109], v108
    ds_read_b64 v[110:111], v110
    s_add_u32 s20, s20, 0xfffff000
    buffer_load_dwordx4 v[116:119], v71, s[12:15], s20 offen offset:3072 sc1
    s_waitcnt lgkmcnt(8)
    v_smfmac_f32_16x16x64_bf16 v[56:59], v[66:69], v[88:95], v70
    s_waitcnt vmcnt(9)
    v_lshlrev_b32_sdwa v88, 3, v36 dst_sel:DWORD dst_unused:UNUSED_PAD src0_sel:DWORD src1_sel:WORD_0
    v_lshlrev_b32_sdwa v90, 3, v36 dst_sel:DWORD dst_unused:UNUSED_PAD src0_sel:DWORD src1_sel:WORD_1
    ds_read_b64 v[88:89], v88
    ds_read_b64 v[90:91], v90
    v_lshlrev_b32_sdwa v92, 3, v37 dst_sel:DWORD dst_unused:UNUSED_PAD src0_sel:DWORD src1_sel:WORD_0
    v_lshlrev_b32_sdwa v94, 3, v37 dst_sel:DWORD dst_unused:UNUSED_PAD src0_sel:DWORD src1_sel:WORD_1
    s_nop 0
    v_cvt_pk_bf16_f32 v56, v56, v57
    v_cvt_pk_bf16_f32 v57, v58, v59
    v_lshlrev_b32 v58, 16, v60
    v_and_b32 v59, s23, v60
    v_lshlrev_b32 v60, 16, v61
    v_and_b32 v61, s23, v61
    ds_read_b64 v[92:93], v92
    ds_read_b64 v[94:95], v94
    s_waitcnt lgkmcnt(8)
    v_smfmac_f32_16x16x64_bf16 v[58:61], v[66:69], v[96:103], v70
    v_lshlrev_b32_sdwa v96, 3, v38 dst_sel:DWORD dst_unused:UNUSED_PAD src0_sel:DWORD src1_sel:WORD_0
    v_lshlrev_b32_sdwa v98, 3, v38 dst_sel:DWORD dst_unused:UNUSED_PAD src0_sel:DWORD src1_sel:WORD_1
    ds_read_b64 v[96:97], v96
    ds_read_b64 v[98:99], v98
    v_lshlrev_b32_sdwa v100, 3, v39 dst_sel:DWORD dst_unused:UNUSED_PAD src0_sel:DWORD src1_sel:WORD_0
    v_lshlrev_b32_sdwa v102, 3, v39 dst_sel:DWORD dst_unused:UNUSED_PAD src0_sel:DWORD src1_sel:WORD_1
    ds_read_b64 v[100:101], v100
    ds_read_b64 v[102:103], v102
    buffer_load_dwordx4 v[36:39], v71, s[12:15], s20 offen offset:2048 sc1
    s_waitcnt lgkmcnt(8)
    v_smfmac_f32_16x16x64_bf16 v[58:61], v[66:69], v[104:111], v70
    s_waitcnt vmcnt(9)
    v_lshlrev_b32_sdwa v104, 3, v120 dst_sel:DWORD dst_unused:UNUSED_PAD src0_sel:DWORD src1_sel:WORD_0
    v_lshlrev_b32_sdwa v106, 3, v120 dst_sel:DWORD dst_unused:UNUSED_PAD src0_sel:DWORD src1_sel:WORD_1
    ds_read_b64 v[104:105], v104
    ds_read_b64 v[106:107], v106
    v_lshlrev_b32_sdwa v108, 3, v121 dst_sel:DWORD dst_unused:UNUSED_PAD src0_sel:DWORD src1_sel:WORD_0
    v_lshlrev_b32_sdwa v110, 3, v121 dst_sel:DWORD dst_unused:UNUSED_PAD src0_sel:DWORD src1_sel:WORD_1
    s_nop 0
    v_cvt_pk_bf16_f32 v58, v58, v59
    v_cvt_pk_bf16_f32 v59, v60, v61
    v_lshlrev_b32 v60, 16, v62
    v_and_b32 v61, s23, v62
    v_lshlrev_b32 v62, 16, v63
    v_and_b32 v63, s23, v63
    ds_read_b64 v[108:109], v108
    ds_read_b64 v[110:111], v110
    buffer_store_dwordx4 v[44:47], v71, s[12:15], s16 offen offset:3072 sc1
    s_waitcnt lgkmcnt(8)
    v_smfmac_f32_16x16x64_bf16 v[60:63], v[66:69], v[88:95], v70
    v_lshlrev_b32_sdwa v88, 3, v122 dst_sel:DWORD dst_unused:UNUSED_PAD src0_sel:DWORD src1_sel:WORD_0
    v_lshlrev_b32_sdwa v90, 3, v122 dst_sel:DWORD dst_unused:UNUSED_PAD src0_sel:DWORD src1_sel:WORD_1
    ds_read_b64 v[88:89], v88
    ds_read_b64 v[90:91], v90
    v_lshlrev_b32_sdwa v92, 3, v123 dst_sel:DWORD dst_unused:UNUSED_PAD src0_sel:DWORD src1_sel:WORD_0
    v_lshlrev_b32_sdwa v94, 3, v123 dst_sel:DWORD dst_unused:UNUSED_PAD src0_sel:DWORD src1_sel:WORD_1
    ds_read_b64 v[92:93], v92
    ds_read_b64 v[94:95], v94
    buffer_load_dwordx4 v[44:47], v71, s[12:15], s20 offen offset:1024 sc1
    s_waitcnt lgkmcnt(8)
    v_smfmac_f32_16x16x64_bf16 v[60:63], v[66:69], v[96:103], v70
    s_waitcnt vmcnt(10)
    v_lshlrev_b32_sdwa v96, 3, v72 dst_sel:DWORD dst_unused:UNUSED_PAD src0_sel:DWORD src1_sel:WORD_0
    v_lshlrev_b32_sdwa v98, 3, v72 dst_sel:DWORD dst_unused:UNUSED_PAD src0_sel:DWORD src1_sel:WORD_1
    ds_read_b64 v[96:97], v96
    ds_read_b64 v[98:99], v98
    v_lshlrev_b32_sdwa v100, 3, v73 dst_sel:DWORD dst_unused:UNUSED_PAD src0_sel:DWORD src1_sel:WORD_0
    v_lshlrev_b32_sdwa v102, 3, v73 dst_sel:DWORD dst_unused:UNUSED_PAD src0_sel:DWORD src1_sel:WORD_1
    s_nop 0
    v_cvt_pk_bf16_f32 v60, v60, v61
    v_cvt_pk_bf16_f32 v61, v62, v63
    v_lshlrev_b32 v62, 16, v64
    v_and_b32 v63, s23, v64
    v_lshlrev_b32 v64, 16, v65
    v_and_b32 v65, s23, v65
    ds_read_b64 v[100:101], v100
    ds_read_b64 v[102:103], v102
    buffer_load_dwordx4 v[120:123], v71, s[12:15], s20 offen offset:0 sc1
    s_waitcnt lgkmcnt(8)
    v_smfmac_f32_16x16x64_bf16 v[62:65], v[66:69], v[104:111], v70
    v_lshlrev_b32_sdwa v104, 3, v74 dst_sel:DWORD dst_unused:UNUSED_PAD src0_sel:DWORD src1_sel:WORD_0
    v_lshlrev_b32_sdwa v106, 3, v74 dst_sel:DWORD dst_unused:UNUSED_PAD src0_sel:DWORD src1_sel:WORD_1
    ds_read_b64 v[104:105], v104
    ds_read_b64 v[106:107], v106
    v_lshlrev_b32_sdwa v108, 3, v75 dst_sel:DWORD dst_unused:UNUSED_PAD src0_sel:DWORD src1_sel:WORD_0
    v_lshlrev_b32_sdwa v110, 3, v75 dst_sel:DWORD dst_unused:UNUSED_PAD src0_sel:DWORD src1_sel:WORD_1
    ds_read_b64 v[108:109], v108
    ds_read_b64 v[110:111], v110
    buffer_load_dwordx4 v[72:75], v71, s[12:15], s21 offen offset:0
    s_waitcnt lgkmcnt(8)
    v_smfmac_f32_16x16x64_bf16 v[62:65], v[66:69], v[88:95], v70
    s_waitcnt vmcnt(11)
    v_lshlrev_b32_sdwa v88, 3, v76 dst_sel:DWORD dst_unused:UNUSED_PAD src0_sel:DWORD src1_sel:WORD_0
    v_lshlrev_b32_sdwa v90, 3, v76 dst_sel:DWORD dst_unused:UNUSED_PAD src0_sel:DWORD src1_sel:WORD_1
    ds_read_b64 v[88:89], v88
    ds_read_b64 v[90:91], v90
    v_lshlrev_b32_sdwa v92, 3, v77 dst_sel:DWORD dst_unused:UNUSED_PAD src0_sel:DWORD src1_sel:WORD_0
    v_lshlrev_b32_sdwa v94, 3, v77 dst_sel:DWORD dst_unused:UNUSED_PAD src0_sel:DWORD src1_sel:WORD_1
    s_nop 0
    v_cvt_pk_bf16_f32 v62, v62, v63
    v_cvt_pk_bf16_f32 v63, v64, v65
    v_and_b32 v33, s23, v31
    v_lshlrev_b32 v32, 16, v31
    v_and_b32 v31, s23, v30
    v_lshlrev_b32 v30, 16, v30
    ds_read_b64 v[92:93], v92
    ds_read_b64 v[94:95], v94
    s_waitcnt lgkmcnt(8)
    v_smfmac_f32_16x16x64_bf16 v[30:33], v[66:69], v[96:103], v70
    v_lshlrev_b32_sdwa v96, 3, v78 dst_sel:DWORD dst_unused:UNUSED_PAD src0_sel:DWORD src1_sel:WORD_0
    v_lshlrev_b32_sdwa v98, 3, v78 dst_sel:DWORD dst_unused:UNUSED_PAD src0_sel:DWORD src1_sel:WORD_1
    ds_read_b64 v[96:97], v96
    ds_read_b64 v[98:99], v98
    v_lshlrev_b32_sdwa v100, 3, v79 dst_sel:DWORD dst_unused:UNUSED_PAD src0_sel:DWORD src1_sel:WORD_0
    v_lshlrev_b32_sdwa v102, 3, v79 dst_sel:DWORD dst_unused:UNUSED_PAD src0_sel:DWORD src1_sel:WORD_1
    ds_read_b64 v[100:101], v100
    ds_read_b64 v[102:103], v102
    buffer_load_dwordx4 v[76:79], v71, s[12:15], s21 offen offset:1024
    s_waitcnt lgkmcnt(8)
    v_smfmac_f32_16x16x64_bf16 v[30:33], v[66:69], v[104:111], v70
    s_waitcnt vmcnt(11)
    v_lshlrev_b32_sdwa v104, 3, v124 dst_sel:DWORD dst_unused:UNUSED_PAD src0_sel:DWORD src1_sel:WORD_0
    v_lshlrev_b32_sdwa v106, 3, v124 dst_sel:DWORD dst_unused:UNUSED_PAD src0_sel:DWORD src1_sel:WORD_1
    ds_read_b64 v[104:105], v104
    ds_read_b64 v[106:107], v106
    v_lshlrev_b32_sdwa v108, 3, v125 dst_sel:DWORD dst_unused:UNUSED_PAD src0_sel:DWORD src1_sel:WORD_0
    v_lshlrev_b32_sdwa v110, 3, v125 dst_sel:DWORD dst_unused:UNUSED_PAD src0_sel:DWORD src1_sel:WORD_1
    s_nop 0
    v_cvt_pk_bf16_f32 v33, v32, v33
    v_cvt_pk_bf16_f32 v32, v30, v31
    v_and_b32 v31, s23, v29
    v_lshlrev_b32 v30, 16, v29
    v_and_b32 v29, s23, v28
    v_lshlrev_b32 v28, 16, v28
    ds_read_b64 v[108:109], v108
    ds_read_b64 v[110:111], v110
    s_waitcnt lgkmcnt(8)
    v_smfmac_f32_16x16x64_bf16 v[28:31], v[66:69], v[88:95], v70
    v_lshlrev_b32_sdwa v88, 3, v126 dst_sel:DWORD dst_unused:UNUSED_PAD src0_sel:DWORD src1_sel:WORD_0
    v_lshlrev_b32_sdwa v90, 3, v126 dst_sel:DWORD dst_unused:UNUSED_PAD src0_sel:DWORD src1_sel:WORD_1
    ds_read_b64 v[88:89], v88
    ds_read_b64 v[90:91], v90
    v_lshlrev_b32_sdwa v92, 3, v127 dst_sel:DWORD dst_unused:UNUSED_PAD src0_sel:DWORD src1_sel:WORD_0
    v_lshlrev_b32_sdwa v94, 3, v127 dst_sel:DWORD dst_unused:UNUSED_PAD src0_sel:DWORD src1_sel:WORD_1
    ds_read_b64 v[92:93], v92
    ds_read_b64 v[94:95], v94
    s_add_u32 s20, s20, 0xfffff000
    buffer_load_dwordx4 v[124:127], v71, s[12:15], s20 offen offset:3072 sc1
    s_waitcnt lgkmcnt(8)
    v_smfmac_f32_16x16x64_bf16 v[28:31], v[66:69], v[96:103], v70
    s_waitcnt vmcnt(9)
    v_lshlrev_b32_sdwa v96, 3, v40 dst_sel:DWORD dst_unused:UNUSED_PAD src0_sel:DWORD src1_sel:WORD_0
    v_lshlrev_b32_sdwa v98, 3, v40 dst_sel:DWORD dst_unused:UNUSED_PAD src0_sel:DWORD src1_sel:WORD_1
    ds_read_b64 v[96:97], v96
    ds_read_b64 v[98:99], v98
    v_lshlrev_b32_sdwa v100, 3, v41 dst_sel:DWORD dst_unused:UNUSED_PAD src0_sel:DWORD src1_sel:WORD_0
    v_lshlrev_b32_sdwa v102, 3, v41 dst_sel:DWORD dst_unused:UNUSED_PAD src0_sel:DWORD src1_sel:WORD_1
    s_nop 0
    v_cvt_pk_bf16_f32 v31, v30, v31
    v_cvt_pk_bf16_f32 v30, v28, v29
    v_and_b32 v29, s23, v27
    v_lshlrev_b32 v28, 16, v27
    v_and_b32 v27, s23, v26
    v_lshlrev_b32 v26, 16, v26
    ds_read_b64 v[100:101], v100
    ds_read_b64 v[102:103], v102
    buffer_store_dwordx4 v[48:51], v71, s[12:15], s17 offen offset:0 sc1
    s_waitcnt lgkmcnt(8)
    v_smfmac_f32_16x16x64_bf16 v[26:29], v[66:69], v[104:111], v70
    v_lshlrev_b32_sdwa v104, 3, v42 dst_sel:DWORD dst_unused:UNUSED_PAD src0_sel:DWORD src1_sel:WORD_0
    v_lshlrev_b32_sdwa v106, 3, v42 dst_sel:DWORD dst_unused:UNUSED_PAD src0_sel:DWORD src1_sel:WORD_1
    ds_read_b64 v[104:105], v104
    ds_read_b64 v[106:107], v106
    v_lshlrev_b32_sdwa v108, 3, v43 dst_sel:DWORD dst_unused:UNUSED_PAD src0_sel:DWORD src1_sel:WORD_0
    v_lshlrev_b32_sdwa v110, 3, v43 dst_sel:DWORD dst_unused:UNUSED_PAD src0_sel:DWORD src1_sel:WORD_1
    ds_read_b64 v[108:109], v108
    ds_read_b64 v[110:111], v110
    buffer_load_dwordx4 v[48:51], v71, s[12:15], s20 offen offset:2048 sc1
    s_waitcnt lgkmcnt(8)
    v_smfmac_f32_16x16x64_bf16 v[26:29], v[66:69], v[88:95], v70
    s_waitcnt vmcnt(9)
    v_lshlrev_b32_sdwa v88, 3, v116 dst_sel:DWORD dst_unused:UNUSED_PAD src0_sel:DWORD src1_sel:WORD_0
    v_lshlrev_b32_sdwa v90, 3, v116 dst_sel:DWORD dst_unused:UNUSED_PAD src0_sel:DWORD src1_sel:WORD_1
    ds_read_b64 v[88:89], v88
    ds_read_b64 v[90:91], v90
    v_lshlrev_b32_sdwa v92, 3, v117 dst_sel:DWORD dst_unused:UNUSED_PAD src0_sel:DWORD src1_sel:WORD_0
    v_lshlrev_b32_sdwa v94, 3, v117 dst_sel:DWORD dst_unused:UNUSED_PAD src0_sel:DWORD src1_sel:WORD_1
    s_nop 0
    v_cvt_pk_bf16_f32 v29, v28, v29
    v_cvt_pk_bf16_f32 v28, v26, v27
    v_and_b32 v27, s23, v25
    v_lshlrev_b32 v26, 16, v25
    v_and_b32 v25, s23, v24
    v_lshlrev_b32 v24, 16, v24
    ds_read_b64 v[92:93], v92
    ds_read_b64 v[94:95], v94
    buffer_load_dwordx4 v[40:43], v71, s[12:15], s20 offen offset:1024 sc1
    s_waitcnt lgkmcnt(8)
    v_smfmac_f32_16x16x64_bf16 v[24:27], v[66:69], v[96:103], v70
    v_lshlrev_b32_sdwa v96, 3, v118 dst_sel:DWORD dst_unused:UNUSED_PAD src0_sel:DWORD src1_sel:WORD_0
    v_lshlrev_b32_sdwa v98, 3, v118 dst_sel:DWORD dst_unused:UNUSED_PAD src0_sel:DWORD src1_sel:WORD_1
    ds_read_b64 v[96:97], v96
    ds_read_b64 v[98:99], v98
    v_lshlrev_b32_sdwa v100, 3, v119 dst_sel:DWORD dst_unused:UNUSED_PAD src0_sel:DWORD src1_sel:WORD_0
    v_lshlrev_b32_sdwa v102, 3, v119 dst_sel:DWORD dst_unused:UNUSED_PAD src0_sel:DWORD src1_sel:WORD_1
    ds_read_b64 v[100:101], v100
    ds_read_b64 v[102:103], v102
    buffer_load_dwordx4 v[116:119], v71, s[12:15], s20 offen offset:0 sc1
    s_waitcnt lgkmcnt(8)
    v_smfmac_f32_16x16x64_bf16 v[24:27], v[66:69], v[104:111], v70
    s_waitcnt vmcnt(10)
    v_lshlrev_b32_sdwa v104, 3, v36 dst_sel:DWORD dst_unused:UNUSED_PAD src0_sel:DWORD src1_sel:WORD_0
    v_lshlrev_b32_sdwa v106, 3, v36 dst_sel:DWORD dst_unused:UNUSED_PAD src0_sel:DWORD src1_sel:WORD_1
    ds_read_b64 v[104:105], v104
    ds_read_b64 v[106:107], v106
    v_lshlrev_b32_sdwa v108, 3, v37 dst_sel:DWORD dst_unused:UNUSED_PAD src0_sel:DWORD src1_sel:WORD_0
    v_lshlrev_b32_sdwa v110, 3, v37 dst_sel:DWORD dst_unused:UNUSED_PAD src0_sel:DWORD src1_sel:WORD_1
    s_nop 0
    v_cvt_pk_bf16_f32 v27, v26, v27
    v_cvt_pk_bf16_f32 v26, v24, v25
    v_and_b32 v25, s23, v23
    v_lshlrev_b32 v24, 16, v23
    v_and_b32 v23, s23, v22
    v_lshlrev_b32 v22, 16, v22
    ds_read_b64 v[108:109], v108
    ds_read_b64 v[110:111], v110
    s_waitcnt lgkmcnt(8)
    v_smfmac_f32_16x16x64_bf16 v[22:25], v[66:69], v[88:95], v70
    v_lshlrev_b32_sdwa v88, 3, v38 dst_sel:DWORD dst_unused:UNUSED_PAD src0_sel:DWORD src1_sel:WORD_0
    v_lshlrev_b32_sdwa v90, 3, v38 dst_sel:DWORD dst_unused:UNUSED_PAD src0_sel:DWORD src1_sel:WORD_1
    ds_read_b64 v[88:89], v88
    ds_read_b64 v[90:91], v90
    v_lshlrev_b32_sdwa v92, 3, v39 dst_sel:DWORD dst_unused:UNUSED_PAD src0_sel:DWORD src1_sel:WORD_0
    v_lshlrev_b32_sdwa v94, 3, v39 dst_sel:DWORD dst_unused:UNUSED_PAD src0_sel:DWORD src1_sel:WORD_1
    ds_read_b64 v[92:93], v92
    ds_read_b64 v[94:95], v94
    s_add_u32 s20, s20, 0xfffffc00
    buffer_load_dwordx4 v[36:39], v71, s[12:15], s20 offen offset:0 sc1
    s_waitcnt lgkmcnt(8)
    v_smfmac_f32_16x16x64_bf16 v[22:25], v[66:69], v[96:103], v70
    s_waitcnt vmcnt(9)
    v_lshlrev_b32_sdwa v96, 3, v44 dst_sel:DWORD dst_unused:UNUSED_PAD src0_sel:DWORD src1_sel:WORD_0
    v_lshlrev_b32_sdwa v98, 3, v44 dst_sel:DWORD dst_unused:UNUSED_PAD src0_sel:DWORD src1_sel:WORD_1
    ds_read_b64 v[96:97], v96
    ds_read_b64 v[98:99], v98
    v_lshlrev_b32_sdwa v100, 3, v45 dst_sel:DWORD dst_unused:UNUSED_PAD src0_sel:DWORD src1_sel:WORD_0
    v_lshlrev_b32_sdwa v102, 3, v45 dst_sel:DWORD dst_unused:UNUSED_PAD src0_sel:DWORD src1_sel:WORD_1
    s_nop 0
    v_cvt_pk_bf16_f32 v25, v24, v25
    v_cvt_pk_bf16_f32 v24, v22, v23
    v_and_b32 v23, s23, v21
    v_lshlrev_b32 v22, 16, v21
    v_and_b32 v21, s23, v20
    v_lshlrev_b32 v20, 16, v20
    ds_read_b64 v[100:101], v100
    ds_read_b64 v[102:103], v102
    v_mov_b32 v34, 1
    s_mov_b64 exec, 1
    buffer_store_dword v34, off, s[12:15], s46 sc1
    s_mov_b64 exec, -1
    s_waitcnt lgkmcnt(8)
    v_smfmac_f32_16x16x64_bf16 v[20:23], v[66:69], v[104:111], v70
    v_lshlrev_b32_sdwa v104, 3, v46 dst_sel:DWORD dst_unused:UNUSED_PAD src0_sel:DWORD src1_sel:WORD_0
    v_lshlrev_b32_sdwa v106, 3, v46 dst_sel:DWORD dst_unused:UNUSED_PAD src0_sel:DWORD src1_sel:WORD_1
    ds_read_b64 v[104:105], v104
    ds_read_b64 v[106:107], v106
    v_lshlrev_b32_sdwa v108, 3, v47 dst_sel:DWORD dst_unused:UNUSED_PAD src0_sel:DWORD src1_sel:WORD_0
    v_lshlrev_b32_sdwa v110, 3, v47 dst_sel:DWORD dst_unused:UNUSED_PAD src0_sel:DWORD src1_sel:WORD_1
    ds_read_b64 v[108:109], v108
    ds_read_b64 v[110:111], v110
    s_add_u32 s20, s20, 0x3000
    buffer_load_dwordx4 v[44:47], v71, s[12:15], s20 offen offset:3072 sc1
    s_waitcnt lgkmcnt(8)
    v_smfmac_f32_16x16x64_bf16 v[20:23], v[66:69], v[88:95], v70
    s_waitcnt vmcnt(10)
    v_lshlrev_b32_sdwa v88, 3, v120 dst_sel:DWORD dst_unused:UNUSED_PAD src0_sel:DWORD src1_sel:WORD_0
    v_lshlrev_b32_sdwa v90, 3, v120 dst_sel:DWORD dst_unused:UNUSED_PAD src0_sel:DWORD src1_sel:WORD_1
    ds_read_b64 v[88:89], v88
    ds_read_b64 v[90:91], v90
    v_lshlrev_b32_sdwa v92, 3, v121 dst_sel:DWORD dst_unused:UNUSED_PAD src0_sel:DWORD src1_sel:WORD_0
    v_lshlrev_b32_sdwa v94, 3, v121 dst_sel:DWORD dst_unused:UNUSED_PAD src0_sel:DWORD src1_sel:WORD_1
    s_nop 0
    v_cvt_pk_bf16_f32 v23, v22, v23
    v_cvt_pk_bf16_f32 v22, v20, v21
    v_and_b32 v21, s23, v19
    v_lshlrev_b32 v20, 16, v19
    v_and_b32 v19, s23, v18
    v_lshlrev_b32 v18, 16, v18
    ds_read_b64 v[92:93], v92
    ds_read_b64 v[94:95], v94
    buffer_store_dwordx4 v[52:55], v71, s[12:15], s17 offen offset:1024 sc1
    s_waitcnt lgkmcnt(8)
    v_smfmac_f32_16x16x64_bf16 v[18:21], v[66:69], v[96:103], v70
    v_lshlrev_b32_sdwa v96, 3, v122 dst_sel:DWORD dst_unused:UNUSED_PAD src0_sel:DWORD src1_sel:WORD_0
    v_lshlrev_b32_sdwa v98, 3, v122 dst_sel:DWORD dst_unused:UNUSED_PAD src0_sel:DWORD src1_sel:WORD_1
    ds_read_b64 v[96:97], v96
    ds_read_b64 v[98:99], v98
    v_lshlrev_b32_sdwa v100, 3, v123 dst_sel:DWORD dst_unused:UNUSED_PAD src0_sel:DWORD src1_sel:WORD_0
    v_lshlrev_b32_sdwa v102, 3, v123 dst_sel:DWORD dst_unused:UNUSED_PAD src0_sel:DWORD src1_sel:WORD_1
    ds_read_b64 v[100:101], v100
    ds_read_b64 v[102:103], v102
    buffer_load_dwordx4 v[120:123], v71, s[12:15], s20 offen offset:2048 sc1
    s_waitcnt lgkmcnt(8)
    v_smfmac_f32_16x16x64_bf16 v[18:21], v[66:69], v[104:111], v70
    s_waitcnt vmcnt(9)
    v_lshlrev_b32_sdwa v104, 3, v124 dst_sel:DWORD dst_unused:UNUSED_PAD src0_sel:DWORD src1_sel:WORD_0
    v_lshlrev_b32_sdwa v106, 3, v124 dst_sel:DWORD dst_unused:UNUSED_PAD src0_sel:DWORD src1_sel:WORD_1
    ds_read_b64 v[104:105], v104
    ds_read_b64 v[106:107], v106
    v_lshlrev_b32_sdwa v108, 3, v125 dst_sel:DWORD dst_unused:UNUSED_PAD src0_sel:DWORD src1_sel:WORD_0
    v_lshlrev_b32_sdwa v110, 3, v125 dst_sel:DWORD dst_unused:UNUSED_PAD src0_sel:DWORD src1_sel:WORD_1
    s_nop 0
    v_cvt_pk_bf16_f32 v21, v20, v21
    v_cvt_pk_bf16_f32 v20, v18, v19
    v_and_b32 v19, s23, v17
    v_lshlrev_b32 v18, 16, v17
    v_and_b32 v17, s23, v16
    v_lshlrev_b32 v16, 16, v16
    ds_read_b64 v[108:109], v108
    ds_read_b64 v[110:111], v110
    s_waitcnt lgkmcnt(8)
    v_smfmac_f32_16x16x64_bf16 v[16:19], v[66:69], v[88:95], v70
    s_setprio 2
    v_lshlrev_b32_sdwa v88, 3, v126 dst_sel:DWORD dst_unused:UNUSED_PAD src0_sel:DWORD src1_sel:WORD_0
    v_lshlrev_b32_sdwa v90, 3, v126 dst_sel:DWORD dst_unused:UNUSED_PAD src0_sel:DWORD src1_sel:WORD_1
    ds_read_b64 v[88:89], v88
    ds_read_b64 v[90:91], v90
    v_lshlrev_b32_sdwa v92, 3, v127 dst_sel:DWORD dst_unused:UNUSED_PAD src0_sel:DWORD src1_sel:WORD_0
    v_lshlrev_b32_sdwa v94, 3, v127 dst_sel:DWORD dst_unused:UNUSED_PAD src0_sel:DWORD src1_sel:WORD_1
    ds_read_b64 v[92:93], v92
    ds_read_b64 v[94:95], v94
    buffer_load_dwordx4 v[124:127], v71, s[12:15], s20 offen offset:1024 sc1
    s_waitcnt lgkmcnt(8)
    v_smfmac_f32_16x16x64_bf16 v[16:19], v[66:69], v[96:103], v70
    s_waitcnt vmcnt(8)
    v_lshlrev_b32_sdwa v96, 3, v48 dst_sel:DWORD dst_unused:UNUSED_PAD src0_sel:DWORD src1_sel:WORD_0
    v_lshlrev_b32_sdwa v98, 3, v48 dst_sel:DWORD dst_unused:UNUSED_PAD src0_sel:DWORD src1_sel:WORD_1
    ds_read_b64 v[96:97], v96
    ds_read_b64 v[98:99], v98
    v_lshlrev_b32_sdwa v100, 3, v49 dst_sel:DWORD dst_unused:UNUSED_PAD src0_sel:DWORD src1_sel:WORD_0
    v_lshlrev_b32_sdwa v102, 3, v49 dst_sel:DWORD dst_unused:UNUSED_PAD src0_sel:DWORD src1_sel:WORD_1
    s_nop 0
    v_cvt_pk_bf16_f32 v19, v18, v19
    v_cvt_pk_bf16_f32 v18, v16, v17
    v_and_b32 v17, s23, v15
    v_lshlrev_b32 v16, 16, v15
    v_and_b32 v15, s23, v14
    v_lshlrev_b32 v14, 16, v14
    ds_read_b64 v[100:101], v100
    ds_read_b64 v[102:103], v102
    s_waitcnt lgkmcnt(8)
    v_smfmac_f32_16x16x64_bf16 v[14:17], v[66:69], v[104:111], v70
    v_lshlrev_b32_sdwa v104, 3, v50 dst_sel:DWORD dst_unused:UNUSED_PAD src0_sel:DWORD src1_sel:WORD_0
    v_lshlrev_b32_sdwa v106, 3, v50 dst_sel:DWORD dst_unused:UNUSED_PAD src0_sel:DWORD src1_sel:WORD_1
    ds_read_b64 v[104:105], v104
    ds_read_b64 v[106:107], v106
    v_lshlrev_b32_sdwa v108, 3, v51 dst_sel:DWORD dst_unused:UNUSED_PAD src0_sel:DWORD src1_sel:WORD_0
    v_lshlrev_b32_sdwa v110, 3, v51 dst_sel:DWORD dst_unused:UNUSED_PAD src0_sel:DWORD src1_sel:WORD_1
    ds_read_b64 v[108:109], v108
    ds_read_b64 v[110:111], v110
    s_add_u32 s20, s20, 0x3f800
    buffer_load_dwordx4 v[48:51], v71, s[12:15], s20 offen offset:3072 sc1
    s_waitcnt lgkmcnt(8)
    v_smfmac_f32_16x16x64_bf16 v[14:17], v[66:69], v[88:95], v70
    s_waitcnt vmcnt(8)
    v_lshlrev_b32_sdwa v88, 3, v40 dst_sel:DWORD dst_unused:UNUSED_PAD src0_sel:DWORD src1_sel:WORD_0
    v_lshlrev_b32_sdwa v90, 3, v40 dst_sel:DWORD dst_unused:UNUSED_PAD src0_sel:DWORD src1_sel:WORD_1
    ds_read_b64 v[88:89], v88
    ds_read_b64 v[90:91], v90
    v_lshlrev_b32_sdwa v92, 3, v41 dst_sel:DWORD dst_unused:UNUSED_PAD src0_sel:DWORD src1_sel:WORD_0
    v_lshlrev_b32_sdwa v94, 3, v41 dst_sel:DWORD dst_unused:UNUSED_PAD src0_sel:DWORD src1_sel:WORD_1
    s_nop 0
    v_cvt_pk_bf16_f32 v17, v16, v17
    v_cvt_pk_bf16_f32 v16, v14, v15
    v_and_b32 v15, s23, v13
    v_lshlrev_b32 v14, 16, v13
    v_and_b32 v13, s23, v12
    v_lshlrev_b32 v12, 16, v12
    ds_read_b64 v[92:93], v92
    ds_read_b64 v[94:95], v94
    s_waitcnt lgkmcnt(8)
    v_smfmac_f32_16x16x64_bf16 v[12:15], v[66:69], v[96:103], v70
    v_lshlrev_b32_sdwa v96, 3, v42 dst_sel:DWORD dst_unused:UNUSED_PAD src0_sel:DWORD src1_sel:WORD_0
    v_lshlrev_b32_sdwa v98, 3, v42 dst_sel:DWORD dst_unused:UNUSED_PAD src0_sel:DWORD src1_sel:WORD_1
    ds_read_b64 v[96:97], v96
    ds_read_b64 v[98:99], v98
    v_lshlrev_b32_sdwa v100, 3, v43 dst_sel:DWORD dst_unused:UNUSED_PAD src0_sel:DWORD src1_sel:WORD_0
    v_lshlrev_b32_sdwa v102, 3, v43 dst_sel:DWORD dst_unused:UNUSED_PAD src0_sel:DWORD src1_sel:WORD_1
    ds_read_b64 v[100:101], v100
    ds_read_b64 v[102:103], v102
    buffer_load_dwordx4 v[40:43], v71, s[12:15], s20 offen offset:1024 sc1
    s_waitcnt lgkmcnt(8)
    v_smfmac_f32_16x16x64_bf16 v[12:15], v[66:69], v[104:111], v70
    s_waitcnt vmcnt(8)
    v_lshlrev_b32_sdwa v104, 3, v116 dst_sel:DWORD dst_unused:UNUSED_PAD src0_sel:DWORD src1_sel:WORD_0
    v_lshlrev_b32_sdwa v106, 3, v116 dst_sel:DWORD dst_unused:UNUSED_PAD src0_sel:DWORD src1_sel:WORD_1
    ds_read_b64 v[104:105], v104
    ds_read_b64 v[106:107], v106
    v_lshlrev_b32_sdwa v108, 3, v117 dst_sel:DWORD dst_unused:UNUSED_PAD src0_sel:DWORD src1_sel:WORD_0
    v_lshlrev_b32_sdwa v110, 3, v117 dst_sel:DWORD dst_unused:UNUSED_PAD src0_sel:DWORD src1_sel:WORD_1
    s_nop 0
    v_cvt_pk_bf16_f32 v15, v14, v15
    v_cvt_pk_bf16_f32 v14, v12, v13
    v_and_b32 v13, s23, v11
    v_lshlrev_b32 v12, 16, v11
    v_and_b32 v11, s23, v10
    v_lshlrev_b32 v10, 16, v10
    ds_read_b64 v[108:109], v108
    ds_read_b64 v[110:111], v110
    buffer_store_dwordx4 v[56:59], v71, s[12:15], s17 offen offset:2048 sc1
    s_waitcnt lgkmcnt(8)
    v_smfmac_f32_16x16x64_bf16 v[10:13], v[66:69], v[88:95], v70
    v_lshlrev_b32_sdwa v88, 3, v118 dst_sel:DWORD dst_unused:UNUSED_PAD src0_sel:DWORD src1_sel:WORD_0
    v_lshlrev_b32_sdwa v90, 3, v118 dst_sel:DWORD dst_unused:UNUSED_PAD src0_sel:DWORD src1_sel:WORD_1
    ds_read_b64 v[88:89], v88
    ds_read_b64 v[90:91], v90
    v_lshlrev_b32_sdwa v92, 3, v119 dst_sel:DWORD dst_unused:UNUSED_PAD src0_sel:DWORD src1_sel:WORD_0
    v_lshlrev_b32_sdwa v94, 3, v119 dst_sel:DWORD dst_unused:UNUSED_PAD src0_sel:DWORD src1_sel:WORD_1
    ds_read_b64 v[92:93], v92
    ds_read_b64 v[94:95], v94
    s_add_u32 s20, s20, 0xfffff000
    buffer_load_dwordx4 v[116:119], v71, s[12:15], s20 offen offset:3072 sc1
    s_waitcnt lgkmcnt(8)
    v_smfmac_f32_16x16x64_bf16 v[10:13], v[66:69], v[96:103], v70
    s_waitcnt vmcnt(9)
    v_lshlrev_b32_sdwa v96, 3, v36 dst_sel:DWORD dst_unused:UNUSED_PAD src0_sel:DWORD src1_sel:WORD_0
    v_lshlrev_b32_sdwa v98, 3, v36 dst_sel:DWORD dst_unused:UNUSED_PAD src0_sel:DWORD src1_sel:WORD_1
    ds_read_b64 v[96:97], v96
    ds_read_b64 v[98:99], v98
    v_lshlrev_b32_sdwa v100, 3, v37 dst_sel:DWORD dst_unused:UNUSED_PAD src0_sel:DWORD src1_sel:WORD_0
    v_lshlrev_b32_sdwa v102, 3, v37 dst_sel:DWORD dst_unused:UNUSED_PAD src0_sel:DWORD src1_sel:WORD_1
    s_nop 0
    v_cvt_pk_bf16_f32 v13, v12, v13
    v_cvt_pk_bf16_f32 v12, v10, v11
    v_and_b32 v11, s23, v9
    v_lshlrev_b32 v10, 16, v9
    v_and_b32 v9, s23, v8
    v_lshlrev_b32 v8, 16, v8
    ds_read_b64 v[100:101], v100
    ds_read_b64 v[102:103], v102
    s_waitcnt lgkmcnt(8)
    v_smfmac_f32_16x16x64_bf16 v[8:11], v[66:69], v[104:111], v70
    s_setprio 1
    v_lshlrev_b32_sdwa v104, 3, v38 dst_sel:DWORD dst_unused:UNUSED_PAD src0_sel:DWORD src1_sel:WORD_0
    v_lshlrev_b32_sdwa v106, 3, v38 dst_sel:DWORD dst_unused:UNUSED_PAD src0_sel:DWORD src1_sel:WORD_1
    ds_read_b64 v[104:105], v104
    ds_read_b64 v[106:107], v106
    v_lshlrev_b32_sdwa v108, 3, v39 dst_sel:DWORD dst_unused:UNUSED_PAD src0_sel:DWORD src1_sel:WORD_0
    v_lshlrev_b32_sdwa v110, 3, v39 dst_sel:DWORD dst_unused:UNUSED_PAD src0_sel:DWORD src1_sel:WORD_1
    ds_read_b64 v[108:109], v108
    ds_read_b64 v[110:111], v110
    buffer_load_dwordx4 v[36:39], v71, s[12:15], s20 offen offset:1024 sc1
    s_waitcnt lgkmcnt(8)
    v_smfmac_f32_16x16x64_bf16 v[8:11], v[66:69], v[88:95], v70
    s_waitcnt vmcnt(8)
    v_lshlrev_b32_sdwa v88, 3, v44 dst_sel:DWORD dst_unused:UNUSED_PAD src0_sel:DWORD src1_sel:WORD_0
    v_lshlrev_b32_sdwa v90, 3, v44 dst_sel:DWORD dst_unused:UNUSED_PAD src0_sel:DWORD src1_sel:WORD_1
    ds_read_b64 v[88:89], v88
    ds_read_b64 v[90:91], v90
    v_lshlrev_b32_sdwa v92, 3, v45 dst_sel:DWORD dst_unused:UNUSED_PAD src0_sel:DWORD src1_sel:WORD_0
    v_lshlrev_b32_sdwa v94, 3, v45 dst_sel:DWORD dst_unused:UNUSED_PAD src0_sel:DWORD src1_sel:WORD_1
    s_nop 0
    v_cvt_pk_bf16_f32 v11, v10, v11
    v_cvt_pk_bf16_f32 v10, v8, v9
    v_and_b32 v9, s23, v7
    v_lshlrev_b32 v8, 16, v7
    v_and_b32 v7, s23, v6
    v_lshlrev_b32 v6, 16, v6
    ds_read_b64 v[92:93], v92
    ds_read_b64 v[94:95], v94
    s_waitcnt lgkmcnt(8)
    v_smfmac_f32_16x16x64_bf16 v[6:9], v[66:69], v[96:103], v70
    v_lshlrev_b32_sdwa v96, 3, v46 dst_sel:DWORD dst_unused:UNUSED_PAD src0_sel:DWORD src1_sel:WORD_0
    v_lshlrev_b32_sdwa v98, 3, v46 dst_sel:DWORD dst_unused:UNUSED_PAD src0_sel:DWORD src1_sel:WORD_1
    ds_read_b64 v[96:97], v96
    ds_read_b64 v[98:99], v98
    v_lshlrev_b32_sdwa v100, 3, v47 dst_sel:DWORD dst_unused:UNUSED_PAD src0_sel:DWORD src1_sel:WORD_0
    v_lshlrev_b32_sdwa v102, 3, v47 dst_sel:DWORD dst_unused:UNUSED_PAD src0_sel:DWORD src1_sel:WORD_1
    ds_read_b64 v[100:101], v100
    ds_read_b64 v[102:103], v102
    s_add_u32 s20, s20, 0xfffff000
    buffer_load_dwordx4 v[44:47], v71, s[12:15], s20 offen offset:3072 sc1
    s_waitcnt lgkmcnt(8)
    v_smfmac_f32_16x16x64_bf16 v[6:9], v[66:69], v[104:111], v70
    s_waitcnt vmcnt(7)
    v_lshlrev_b32_sdwa v104, 3, v120 dst_sel:DWORD dst_unused:UNUSED_PAD src0_sel:DWORD src1_sel:WORD_0
    v_lshlrev_b32_sdwa v106, 3, v120 dst_sel:DWORD dst_unused:UNUSED_PAD src0_sel:DWORD src1_sel:WORD_1
    ds_read_b64 v[104:105], v104
    ds_read_b64 v[106:107], v106
    v_lshlrev_b32_sdwa v108, 3, v121 dst_sel:DWORD dst_unused:UNUSED_PAD src0_sel:DWORD src1_sel:WORD_0
    v_lshlrev_b32_sdwa v110, 3, v121 dst_sel:DWORD dst_unused:UNUSED_PAD src0_sel:DWORD src1_sel:WORD_1
    s_nop 0
    v_cvt_pk_bf16_f32 v9, v8, v9
    v_cvt_pk_bf16_f32 v8, v6, v7
    v_and_b32 v7, s23, v5
    v_lshlrev_b32 v6, 16, v5
    v_and_b32 v5, s23, v4
    v_lshlrev_b32 v4, 16, v4
    ds_read_b64 v[108:109], v108
    ds_read_b64 v[110:111], v110
    s_mov_b64 exec, 1
    buffer_load_dword v35, off, s[12:15], s47 sc1
    s_mov_b64 exec, -1
    s_waitcnt lgkmcnt(8)
    v_smfmac_f32_16x16x64_bf16 v[4:7], v[66:69], v[88:95], v70
    v_lshlrev_b32_sdwa v88, 3, v122 dst_sel:DWORD dst_unused:UNUSED_PAD src0_sel:DWORD src1_sel:WORD_0
    v_lshlrev_b32_sdwa v90, 3, v122 dst_sel:DWORD dst_unused:UNUSED_PAD src0_sel:DWORD src1_sel:WORD_1
    ds_read_b64 v[88:89], v88
    ds_read_b64 v[90:91], v90
    v_lshlrev_b32_sdwa v92, 3, v123 dst_sel:DWORD dst_unused:UNUSED_PAD src0_sel:DWORD src1_sel:WORD_0
    v_lshlrev_b32_sdwa v94, 3, v123 dst_sel:DWORD dst_unused:UNUSED_PAD src0_sel:DWORD src1_sel:WORD_1
    ds_read_b64 v[92:93], v92
    ds_read_b64 v[94:95], v94
    buffer_load_dwordx4 v[120:123], v71, s[12:15], s20 offen offset:1024 sc1
    s_waitcnt lgkmcnt(8)
    v_smfmac_f32_16x16x64_bf16 v[4:7], v[66:69], v[96:103], v70
    s_waitcnt vmcnt(8)
    v_lshlrev_b32_sdwa v96, 3, v124 dst_sel:DWORD dst_unused:UNUSED_PAD src0_sel:DWORD src1_sel:WORD_0
    v_lshlrev_b32_sdwa v98, 3, v124 dst_sel:DWORD dst_unused:UNUSED_PAD src0_sel:DWORD src1_sel:WORD_1
    ds_read_b64 v[96:97], v96
    ds_read_b64 v[98:99], v98
    v_lshlrev_b32_sdwa v100, 3, v125 dst_sel:DWORD dst_unused:UNUSED_PAD src0_sel:DWORD src1_sel:WORD_0
    v_lshlrev_b32_sdwa v102, 3, v125 dst_sel:DWORD dst_unused:UNUSED_PAD src0_sel:DWORD src1_sel:WORD_1
    s_nop 0
    v_cvt_pk_bf16_f32 v7, v6, v7
    v_cvt_pk_bf16_f32 v6, v4, v5
    v_and_b32 v5, s23, v3
    v_lshlrev_b32 v4, 16, v3
    v_and_b32 v3, s23, v2
    v_lshlrev_b32 v2, 16, v2
    ds_read_b64 v[100:101], v100
    ds_read_b64 v[102:103], v102
    buffer_store_dwordx4 v[60:63], v71, s[12:15], s17 offen offset:3072 sc1
    s_cmp_eq_u32 s48, 1
    s_cbranch_scc1 k1_kernel_solo2
    s_waitcnt lgkmcnt(8)
    v_smfmac_f32_16x16x64_bf16 v[2:5], v[66:69], v[104:111], v70
    s_setprio 0
    v_lshlrev_b32_sdwa v104, 3, v126 dst_sel:DWORD dst_unused:UNUSED_PAD src0_sel:DWORD src1_sel:WORD_0
    v_lshlrev_b32_sdwa v106, 3, v126 dst_sel:DWORD dst_unused:UNUSED_PAD src0_sel:DWORD src1_sel:WORD_1
    ds_read_b64 v[104:105], v104
    ds_read_b64 v[106:107], v106
    v_lshlrev_b32_sdwa v108, 3, v127 dst_sel:DWORD dst_unused:UNUSED_PAD src0_sel:DWORD src1_sel:WORD_0
    v_lshlrev_b32_sdwa v110, 3, v127 dst_sel:DWORD dst_unused:UNUSED_PAD src0_sel:DWORD src1_sel:WORD_1
    ds_read_b64 v[108:109], v108
    ds_read_b64 v[110:111], v110
    s_add_u32 s20, s20, 0xfffffc00
    buffer_load_dwordx4 v[124:127], v71, s[12:15], s20 offen offset:0 sc1
    s_waitcnt lgkmcnt(8)
    v_smfmac_f32_16x16x64_bf16 v[2:5], v[66:69], v[88:95], v70
    v_mfma_f32_16x16x32_bf16 v[112:115], v[72:75], v[128:131], 0
    s_waitcnt vmcnt(9)
    v_lshlrev_b32_sdwa v88, 3, v48 dst_sel:DWORD dst_unused:UNUSED_PAD src0_sel:DWORD src1_sel:WORD_0
    v_lshlrev_b32_sdwa v90, 3, v48 dst_sel:DWORD dst_unused:UNUSED_PAD src0_sel:DWORD src1_sel:WORD_1
    ds_read_b64 v[88:89], v88
    ds_read_b64 v[90:91], v90
    v_mfma_f32_16x16x32_bf16 v[112:115], v[76:79], v[132:135], v[112:115]
    v_add_u32 v70, 0x20000000, v70
    v_lshlrev_b32_sdwa v92, 3, v49 dst_sel:DWORD dst_unused:UNUSED_PAD src0_sel:DWORD src1_sel:WORD_0
    v_lshlrev_b32_sdwa v94, 3, v49 dst_sel:DWORD dst_unused:UNUSED_PAD src0_sel:DWORD src1_sel:WORD_1
    v_cvt_pk_bf16_f32 v5, v4, v5
    v_cvt_pk_bf16_f32 v4, v2, v3
    v_and_b32 v3, s23, v1
    v_lshlrev_b32 v2, 16, v1
    v_and_b32 v1, s23, v0
    v_lshlrev_b32 v0, 16, v0
    ds_read_b64 v[92:93], v92
    ds_read_b64 v[94:95], v94
    s_waitcnt lgkmcnt(8)
    v_smfmac_f32_16x16x64_bf16 v[0:3], v[66:69], v[96:103], v70
    s_waitcnt lgkmcnt(4)
    s_barrier
    s_setprio 3
    v_mfma_f32_16x16x32_bf16 v[112:115], v[80:83], v[136:139], v[112:115]
    v_lshlrev_b32_sdwa v96, 3, v50 dst_sel:DWORD dst_unused:UNUSED_PAD src0_sel:DWORD src1_sel:WORD_0
    v_lshlrev_b32_sdwa v98, 3, v50 dst_sel:DWORD dst_unused:UNUSED_PAD src0_sel:DWORD src1_sel:WORD_1
    ds_read_b64 v[96:97], v96
    ds_read_b64 v[98:99], v98
    v_mfma_f32_16x16x32_bf16 v[112:115], v[84:87], v[140:143], v[112:115]
    v_lshlrev_b32_sdwa v100, 3, v51 dst_sel:DWORD dst_unused:UNUSED_PAD src0_sel:DWORD src1_sel:WORD_0
    v_lshlrev_b32_sdwa v102, 3, v51 dst_sel:DWORD dst_unused:UNUSED_PAD src0_sel:DWORD src1_sel:WORD_1
    ds_read_b64 v[100:101], v100
    ds_read_b64 v[102:103], v102
    s_add_u32 s20, s20, 0x2c00
    buffer_load_dwordx4 v[48:51], v71, s[12:15], s20 offen offset:3072 sc1
    v_smfmac_f32_16x16x64_bf16 v[0:3], v[66:69], v[104:111], v70
    s_nop 0
    v_cvt_pk_bf16_f32 v112, v112, v113
    v_cvt_pk_bf16_f32 v113, v114, v115
    v_lshlrev_b32_sdwa v114, 3, v70 dst_sel:DWORD dst_unused:UNUSED_PAD src0_sel:DWORD src1_sel:WORD_1
    ds_write_b64 v114, v[112:113] offset:0
    v_mfma_f32_16x16x32_bf16 v[112:115], v[72:75], v[144:147], 0
    s_waitcnt vmcnt(9)
    v_lshlrev_b32_sdwa v104, 3, v40 dst_sel:DWORD dst_unused:UNUSED_PAD src0_sel:DWORD src1_sel:WORD_0
    v_lshlrev_b32_sdwa v106, 3, v40 dst_sel:DWORD dst_unused:UNUSED_PAD src0_sel:DWORD src1_sel:WORD_1
    ds_read_b64 v[104:105], v104
    ds_read_b64 v[106:107], v106
    v_mfma_f32_16x16x32_bf16 v[112:115], v[76:79], v[148:151], v[112:115]
    v_lshlrev_b32_sdwa v108, 3, v41 dst_sel:DWORD dst_unused:UNUSED_PAD src0_sel:DWORD src1_sel:WORD_0
    v_lshlrev_b32_sdwa v110, 3, v41 dst_sel:DWORD dst_unused:UNUSED_PAD src0_sel:DWORD src1_sel:WORD_1
    v_cvt_pk_bf16_f32 v3, v2, v3
    v_cvt_pk_bf16_f32 v2, v0, v1
    v_lshlrev_b32 v52, 16, v2
    v_and_b32 v53, s23, v2
    v_lshlrev_b32 v54, 16, v3
    v_and_b32 v55, s23, v3
    ds_read_b64 v[108:109], v108
    ds_read_b64 v[110:111], v110
    s_waitcnt lgkmcnt(9)
    v_smfmac_f32_16x16x64_bf16 v[52:55], v[66:69], v[88:95], v70
    v_mfma_f32_16x16x32_bf16 v[112:115], v[80:83], v[152:155], v[112:115]
    v_lshlrev_b32_sdwa v88, 3, v42 dst_sel:DWORD dst_unused:UNUSED_PAD src0_sel:DWORD src1_sel:WORD_0
    v_lshlrev_b32_sdwa v90, 3, v42 dst_sel:DWORD dst_unused:UNUSED_PAD src0_sel:DWORD src1_sel:WORD_1
    ds_read_b64 v[88:89], v88
    ds_read_b64 v[90:91], v90
    v_mfma_f32_16x16x32_bf16 v[112:115], v[84:87], v[156:159], v[112:115]
    v_lshlrev_b32_sdwa v92, 3, v43 dst_sel:DWORD dst_unused:UNUSED_PAD src0_sel:DWORD src1_sel:WORD_0
    v_lshlrev_b32_sdwa v94, 3, v43 dst_sel:DWORD dst_unused:UNUSED_PAD src0_sel:DWORD src1_sel:WORD_1
    ds_read_b64 v[92:93], v92
    ds_read_b64 v[94:95], v94
    s_add_u32 s20, s20, 0x3f800
    buffer_load_dwordx4 v[40:43], v71, s[12:15], s20 offen offset:3072 sc1
    s_waitcnt lgkmcnt(9)
    v_smfmac_f32_16x16x64_bf16 v[52:55], v[66:69], v[96:103], v70
    v_cvt_pk_bf16_f32 v112, v112, v113
    v_cvt_pk_bf16_f32 v113, v114, v115
    v_lshlrev_b32_sdwa v114, 3, v70 dst_sel:DWORD dst_unused:UNUSED_PAD src0_sel:DWORD src1_sel:WORD_1
    ds_write_b64 v114, v[112:113] offset:128
    v_mfma_f32_16x16x32_bf16 v[112:115], v[72:75], v[160:163], 0
    s_waitcnt vmcnt(8)
    v_lshlrev_b32_sdwa v96, 3, v116 dst_sel:DWORD dst_unused:UNUSED_PAD src0_sel:DWORD src1_sel:WORD_0
    v_lshlrev_b32_sdwa v98, 3, v116 dst_sel:DWORD dst_unused:UNUSED_PAD src0_sel:DWORD src1_sel:WORD_1
    ds_read_b64 v[96:97], v96
    ds_read_b64 v[98:99], v98
    v_mfma_f32_16x16x32_bf16 v[112:115], v[76:79], v[164:167], v[112:115]
    v_lshlrev_b32_sdwa v100, 3, v117 dst_sel:DWORD dst_unused:UNUSED_PAD src0_sel:DWORD src1_sel:WORD_0
    v_lshlrev_b32_sdwa v102, 3, v117 dst_sel:DWORD dst_unused:UNUSED_PAD src0_sel:DWORD src1_sel:WORD_1
    v_lshlrev_b32 v56, 16, v30
    v_and_b32 v57, s23, v30
    v_lshlrev_b32 v58, 16, v31
    v_and_b32 v59, s23, v31
    ds_read_b64 v[100:101], v100
    ds_read_b64 v[102:103], v102
    s_waitcnt vmcnt(5)
    v_readfirstlane_b32 s44, v35
    s_cmp_le_u32 s44, 0
    s_cbranch_scc1 k1_kernel_xw0
k1_kernel_xb0:
    buffer_load_dwordx4 v[128:131], v71, s[12:15], s18 offen offset:0 sc1
    s_waitcnt lgkmcnt(9)
    v_smfmac_f32_16x16x64_bf16 v[56:59], v[66:69], v[104:111], v70
    v_mfma_f32_16x16x32_bf16 v[112:115], v[80:83], v[168:171], v[112:115]
    v_lshlrev_b32_sdwa v104, 3, v118 dst_sel:DWORD dst_unused:UNUSED_PAD src0_sel:DWORD src1_sel:WORD_0
    v_lshlrev_b32_sdwa v106, 3, v118 dst_sel:DWORD dst_unused:UNUSED_PAD src0_sel:DWORD src1_sel:WORD_1
    ds_read_b64 v[104:105], v104
    ds_read_b64 v[106:107], v106
    v_mfma_f32_16x16x32_bf16 v[112:115], v[84:87], v[172:175], v[112:115]
    v_lshlrev_b32_sdwa v108, 3, v119 dst_sel:DWORD dst_unused:UNUSED_PAD src0_sel:DWORD src1_sel:WORD_0
    v_lshlrev_b32_sdwa v110, 3, v119 dst_sel:DWORD dst_unused:UNUSED_PAD src0_sel:DWORD src1_sel:WORD_1
    ds_read_b64 v[108:109], v108
    ds_read_b64 v[110:111], v110
    s_add_u32 s20, s20, 0xfffc0800
    buffer_load_dwordx4 v[116:119], v71, s[12:15], s20 offen offset:0 sc1
    s_waitcnt lgkmcnt(9)
    v_smfmac_f32_16x16x64_bf16 v[56:59], v[66:69], v[88:95], v70
    v_cvt_pk_bf16_f32 v112, v112, v113
    v_cvt_pk_bf16_f32 v113, v114, v115
    v_lshlrev_b32_sdwa v114, 3, v70 dst_sel:DWORD dst_unused:UNUSED_PAD src0_sel:DWORD src1_sel:WORD_1
    ds_write_b64 v114, v[112:113] offset:256
    v_mfma_f32_16x16x32_bf16 v[112:115], v[72:75], v[176:179], 0
    v_lshlrev_b32_sdwa v88, 3, v36 dst_sel:DWORD dst_unused:UNUSED_PAD src0_sel:DWORD src1_sel:WORD_0
    v_lshlrev_b32_sdwa v90, 3, v36 dst_sel:DWORD dst_unused:UNUSED_PAD src0_sel:DWORD src1_sel:WORD_1
    ds_read_b64 v[88:89], v88
    ds_read_b64 v[90:91], v90
    v_mfma_f32_16x16x32_bf16 v[112:115], v[76:79], v[180:183], v[112:115]
    v_lshlrev_b32_sdwa v92, 3, v37 dst_sel:DWORD dst_unused:UNUSED_PAD src0_sel:DWORD src1_sel:WORD_0
    v_lshlrev_b32_sdwa v94, 3, v37 dst_sel:DWORD dst_unused:UNUSED_PAD src0_sel:DWORD src1_sel:WORD_1
    v_lshlrev_b32 v60, 16, v26
    v_and_b32 v61, s23, v26
    v_lshlrev_b32 v62, 16, v27
    v_and_b32 v63, s23, v27
    ds_read_b64 v[92:93], v92
    ds_read_b64 v[94:95], v94
    s_waitcnt lgkmcnt(9)
    v_smfmac_f32_16x16x64_bf16 v[60:63], v[66:69], v[96:103], v70
    v_mfma_f32_16x16x32_bf16 v[112:115], v[80:83], v[184:187], v[112:115]
    v_lshlrev_b32_sdwa v96, 3, v38 dst_sel:DWORD dst_unused:UNUSED_PAD src0_sel:DWORD src1_sel:WORD_0
    v_lshlrev_b32_sdwa v98, 3, v38 dst_sel:DWORD dst_unused:UNUSED_PAD src0_sel:DWORD src1_sel:WORD_1
    ds_read_b64 v[96:97], v96
    ds_read_b64 v[98:99], v98
    v_mfma_f32_16x16x32_bf16 v[112:115], v[84:87], v[188:191], v[112:115]
    v_lshlrev_b32_sdwa v100, 3, v39 dst_sel:DWORD dst_unused:UNUSED_PAD src0_sel:DWORD src1_sel:WORD_0
    v_lshlrev_b32_sdwa v102, 3, v39 dst_sel:DWORD dst_unused:UNUSED_PAD src0_sel:DWORD src1_sel:WORD_1
    ds_read_b64 v[100:101], v100
    ds_read_b64 v[102:103], v102
    s_add_u32 s20, s20, 0x40000
    buffer_load_dwordx4 v[36:39], v71, s[12:15], s20 offen offset:0 sc1
    s_waitcnt lgkmcnt(9)
    v_smfmac_f32_16x16x64_bf16 v[60:63], v[66:69], v[104:111], v70
    v_cvt_pk_bf16_f32 v112, v112, v113
    v_cvt_pk_bf16_f32 v113, v114, v115
    v_lshlrev_b32_sdwa v114, 3, v70 dst_sel:DWORD dst_unused:UNUSED_PAD src0_sel:DWORD src1_sel:WORD_1
    ds_write_b64 v114, v[112:113] offset:384
    s_setprio 1
    v_mfma_f32_16x16x32_bf16 v[112:115], v[72:75], v[192:195], 0
    v_lshlrev_b32_sdwa v104, 3, v44 dst_sel:DWORD dst_unused:UNUSED_PAD src0_sel:DWORD src1_sel:WORD_0
    v_lshlrev_b32_sdwa v106, 3, v44 dst_sel:DWORD dst_unused:UNUSED_PAD src0_sel:DWORD src1_sel:WORD_1
    ds_read_b64 v[104:105], v104
    ds_read_b64 v[106:107], v106
    v_mfma_f32_16x16x32_bf16 v[112:115], v[76:79], v[196:199], v[112:115]
    v_lshlrev_b32_sdwa v108, 3, v45 dst_sel:DWORD dst_unused:UNUSED_PAD src0_sel:DWORD src1_sel:WORD_0
    v_lshlrev_b32_sdwa v110, 3, v45 dst_sel:DWORD dst_unused:UNUSED_PAD src0_sel:DWORD src1_sel:WORD_1
    v_lshlrev_b32 v160, 16, v22
    v_and_b32 v161, s23, v22
    v_lshlrev_b32 v162, 16, v23
    v_and_b32 v163, s23, v23
    ds_read_b64 v[108:109], v108
    ds_read_b64 v[110:111], v110
    s_waitcnt lgkmcnt(9)
    v_smfmac_f32_16x16x64_bf16 v[160:163], v[66:69], v[88:95], v70
    v_mfma_f32_16x16x32_bf16 v[112:115], v[80:83], v[200:203], v[112:115]
    v_lshlrev_b32_sdwa v88, 3, v46 dst_sel:DWORD dst_unused:UNUSED_PAD src0_sel:DWORD src1_sel:WORD_0
    v_lshlrev_b32_sdwa v90, 3, v46 dst_sel:DWORD dst_unused:UNUSED_PAD src0_sel:DWORD src1_sel:WORD_1
    ds_read_b64 v[88:89], v88
    ds_read_b64 v[90:91], v90
    v_mfma_f32_16x16x32_bf16 v[112:115], v[84:87], v[204:207], v[112:115]
    v_lshlrev_b32_sdwa v92, 3, v47 dst_sel:DWORD dst_unused:UNUSED_PAD src0_sel:DWORD src1_sel:WORD_0
    v_lshlrev_b32_sdwa v94, 3, v47 dst_sel:DWORD dst_unused:UNUSED_PAD src0_sel:DWORD src1_sel:WORD_1
    ds_read_b64 v[92:93], v92
    ds_read_b64 v[94:95], v94
    s_add_u32 s20, s20, 0xfffff000
    buffer_load_dwordx4 v[44:47], v71, s[12:15], s20 offen offset:3072 sc1
    s_waitcnt lgkmcnt(9)
    v_smfmac_f32_16x16x64_bf16 v[160:163], v[66:69], v[96:103], v70
    v_cvt_pk_bf16_f32 v112, v112, v113
    v_cvt_pk_bf16_f32 v113, v114, v115
    v_lshlrev_b32_sdwa v114, 3, v70 dst_sel:DWORD dst_unused:UNUSED_PAD src0_sel:DWORD src1_sel:WORD_1
    ds_write_b64 v114, v[112:113] offset:512
    v_mfma_f32_16x16x32_bf16 v[112:115], v[72:75], v[208:211], 0
    s_waitcnt vmcnt(8)
    v_lshlrev_b32_sdwa v96, 3, v120 dst_sel:DWORD dst_unused:UNUSED_PAD src0_sel:DWORD src1_sel:WORD_0
    v_lshlrev_b32_sdwa v98, 3, v120 dst_sel:DWORD dst_unused:UNUSED_PAD src0_sel:DWORD src1_sel:WORD_1
    ds_read_b64 v[96:97], v96
    ds_read_b64 v[98:99], v98
    v_mfma_f32_16x16x32_bf16 v[112:115], v[76:79], v[212:215], v[112:115]
    v_lshlrev_b32_sdwa v100, 3, v121 dst_sel:DWORD dst_unused:UNUSED_PAD src0_sel:DWORD src1_sel:WORD_0
    v_lshlrev_b32_sdwa v102, 3, v121 dst_sel:DWORD dst_unused:UNUSED_PAD src0_sel:DWORD src1_sel:WORD_1
    v_lshlrev_b32 v164, 16, v18
    v_and_b32 v165, s23, v18
    v_lshlrev_b32 v166, 16, v19
    v_and_b32 v167, s23, v19
    ds_read_b64 v[100:101], v100
    ds_read_b64 v[102:103], v102
    buffer_load_dwordx4 v[132:135], v71, s[12:15], s18 offen offset:1024 sc1
    s_waitcnt lgkmcnt(9)
    v_smfmac_f32_16x16x64_bf16 v[164:167], v[66:69], v[104:111], v70
    v_mfma_f32_16x16x32_bf16 v[112:115], v[80:83], v[216:219], v[112:115]
    v_lshlrev_b32_sdwa v104, 3, v122 dst_sel:DWORD dst_unused:UNUSED_PAD src0_sel:DWORD src1_sel:WORD_0
    v_lshlrev_b32_sdwa v106, 3, v122 dst_sel:DWORD dst_unused:UNUSED_PAD src0_sel:DWORD src1_sel:WORD_1
    ds_read_b64 v[104:105], v104
    ds_read_b64 v[106:107], v106
    v_mfma_f32_16x16x32_bf16 v[112:115], v[84:87], v[220:223], v[112:115]
    v_lshlrev_b32_sdwa v108, 3, v123 dst_sel:DWORD dst_unused:UNUSED_PAD src0_sel:DWORD src1_sel:WORD_0
    v_lshlrev_b32_sdwa v110, 3, v123 dst_sel:DWORD dst_unused:UNUSED_PAD src0_sel:DWORD src1_sel:WORD_1
    ds_read_b64 v[108:109], v108
    ds_read_b64 v[110:111], v110
    s_add_u32 s20, s20, 0xfffc0800
    buffer_load_dwordx4 v[120:123], v71, s[12:15], s20 offen offset:0 sc1
    s_waitcnt lgkmcnt(9)
    v_smfmac_f32_16x16x64_bf16 v[164:167], v[66:69], v[88:95], v70
    v_cvt_pk_bf16_f32 v112, v112, v113
    v_cvt_pk_bf16_f32 v113, v114, v115
    v_lshlrev_b32_sdwa v114, 3, v70 dst_sel:DWORD dst_unused:UNUSED_PAD src0_sel:DWORD src1_sel:WORD_1
    ds_write_b64 v114, v[112:113] offset:640
    v_mfma_f32_16x16x32_bf16 v[112:115], v[72:75], v[224:227], 0
    s_waitcnt vmcnt(8)
    v_lshlrev_b32_sdwa v88, 3, v124 dst_sel:DWORD dst_unused:UNUSED_PAD src0_sel:DWORD src1_sel:WORD_0
    v_lshlrev_b32_sdwa v90, 3, v124 dst_sel:DWORD dst_unused:UNUSED_PAD src0_sel:DWORD src1_sel:WORD_1
    ds_read_b64 v[88:89], v88
    ds_read_b64 v[90:91], v90
    v_mfma_f32_16x16x32_bf16 v[112:115], v[76:79], v[228:231], v[112:115]
    v_lshlrev_b32_sdwa v92, 3, v125 dst_sel:DWORD dst_unused:UNUSED_PAD src0_sel:DWORD src1_sel:WORD_0
    v_lshlrev_b32_sdwa v94, 3, v125 dst_sel:DWORD dst_unused:UNUSED_PAD src0_sel:DWORD src1_sel:WORD_1
    v_lshlrev_b32 v168, 16, v14
    v_and_b32 v169, s23, v14
    v_lshlrev_b32 v170, 16, v15
    v_and_b32 v171, s23, v15
    ds_read_b64 v[92:93], v92
    ds_read_b64 v[94:95], v94
    v_mov_b32 v34, 2
    s_mov_b64 exec, 1
    buffer_store_dword v34, off, s[12:15], s46 sc1
    s_mov_b64 exec, -1
    s_waitcnt lgkmcnt(9)
    v_smfmac_f32_16x16x64_bf16 v[168:171], v[66:69], v[96:103], v70
    v_mfma_f32_16x16x32_bf16 v[112:115], v[80:83], v[232:235], v[112:115]
    v_lshlrev_b32_sdwa v96, 3, v126 dst_sel:DWORD dst_unused:UNUSED_PAD src0_sel:DWORD src1_sel:WORD_0
    v_lshlrev_b32_sdwa v98, 3, v126 dst_sel:DWORD dst_unused:UNUSED_PAD src0_sel:DWORD src1_sel:WORD_1
    ds_read_b64 v[96:97], v96
    ds_read_b64 v[98:99], v98
    v_mfma_f32_16x16x32_bf16 v[112:115], v[84:87], v[236:239], v[112:115]
    v_lshlrev_b32_sdwa v100, 3, v127 dst_sel:DWORD dst_unused:UNUSED_PAD src0_sel:DWORD src1_sel:WORD_0
    v_lshlrev_b32_sdwa v102, 3, v127 dst_sel:DWORD dst_unused:UNUSED_PAD src0_sel:DWORD src1_sel:WORD_1
    ds_read_b64 v[100:101], v100
    ds_read_b64 v[102:103], v102
    s_add_u32 s20, s20, 0x40000
    buffer_load_dwordx4 v[124:127], v71, s[12:15], s20 offen offset:0 sc1
    s_waitcnt lgkmcnt(9)
    v_smfmac_f32_16x16x64_bf16 v[168:171], v[66:69], v[104:111], v70
    v_cvt_pk_bf16_f32 v112, v112, v113
    v_cvt_pk_bf16_f32 v113, v114, v115
    v_lshlrev_b32_sdwa v114, 3, v70 dst_sel:DWORD dst_unused:UNUSED_PAD src0_sel:DWORD src1_sel:WORD_1
    ds_write_b64 v114, v[112:113] offset:768
    s_setprio 0
    v_mfma_f32_16x16x32_bf16 v[112:115], v[72:75], v[240:243], 0
    s_waitcnt vmcnt(9)
    v_lshlrev_b32_sdwa v104, 3, v48 dst_sel:DWORD dst_unused:UNUSED_PAD src0_sel:DWORD src1_sel:WORD_0
    v_lshlrev_b32_sdwa v106, 3, v48 dst_sel:DWORD dst_unused:UNUSED_PAD src0_sel:DWORD src1_sel:WORD_1
    ds_read_b64 v[104:105], v104
    ds_read_b64 v[106:107], v106
    v_mfma_f32_16x16x32_bf16 v[112:115], v[76:79], v[244:247], v[112:115]
    v_lshlrev_b32_sdwa v108, 3, v49 dst_sel:DWORD dst_unused:UNUSED_PAD src0_sel:DWORD src1_sel:WORD_0
    v_lshlrev_b32_sdwa v110, 3, v49 dst_sel:DWORD dst_unused:UNUSED_PAD src0_sel:DWORD src1_sel:WORD_1
    v_lshlrev_b32 v172, 16, v10
    v_and_b32 v173, s23, v10
    v_lshlrev_b32 v174, 16, v11
    v_and_b32 v175, s23, v11
    ds_read_b64 v[108:109], v108
    ds_read_b64 v[110:111], v110
    s_waitcnt lgkmcnt(9)
    v_smfmac_f32_16x16x64_bf16 v[172:175], v[66:69], v[88:95], v70
    v_mfma_f32_16x16x32_bf16 v[112:115], v[80:83], v[248:251], v[112:115]
    v_lshlrev_b32_sdwa v88, 3, v50 dst_sel:DWORD dst_unused:UNUSED_PAD src0_sel:DWORD src1_sel:WORD_0
    v_lshlrev_b32_sdwa v90, 3, v50 dst_sel:DWORD dst_unused:UNUSED_PAD src0_sel:DWORD src1_sel:WORD_1
    ds_read_b64 v[88:89], v88
    ds_read_b64 v[90:91], v90
    v_mfma_f32_16x16x32_bf16 v[112:115], v[84:87], v[252:255], v[112:115]
    v_lshlrev_b32_sdwa v92, 3, v51 dst_sel:DWORD dst_unused:UNUSED_PAD src0_sel:DWORD src1_sel:WORD_0
    v_lshlrev_b32_sdwa v94, 3, v51 dst_sel:DWORD dst_unused:UNUSED_PAD src0_sel:DWORD src1_sel:WORD_1
    ds_read_b64 v[92:93], v92
    ds_read_b64 v[94:95], v94
    s_add_u32 s20, s20, 0xfffff000
    buffer_load_dwordx4 v[48:51], v71, s[12:15], s20 offen offset:3072 sc1
    s_waitcnt lgkmcnt(9)
    v_smfmac_f32_16x16x64_bf16 v[172:175], v[66:69], v[96:103], v70
    v_cvt_pk_bf16_f32 v112, v112, v113
    v_cvt_pk_bf16_f32 v113, v114, v115
    v_lshlrev_b32_sdwa v114, 3, v70 dst_sel:DWORD dst_unused:UNUSED_PAD src0_sel:DWORD src1_sel:WORD_1
    ds_write_b64 v114, v[112:113] offset:896
    s_waitcnt lgkmcnt(0)
    s_barrier
    s_setprio 3
    v_mov_b32 v212, 0xbdd2d3e8
    v_mov_b32 v213, 0xbdd2d3e8
    v_mov_b32 v214, 0xc0135761
    v_mov_b32 v215, 0xc0135761
    v_bfe_u32 v216, v71, 4, 2
    v_mov_b32 v222, 0x3f80
    v_lshlrev_b32 v216, 4, v216
    v_mov_b32 v223, 0
    s_waitcnt vmcnt(9)
    v_lshlrev_b32_sdwa v96, 3, v40 dst_sel:DWORD dst_unused:UNUSED_PAD src0_sel:DWORD src1_sel:WORD_0
    v_lshlrev_b32_sdwa v98, 3, v40 dst_sel:DWORD dst_unused:UNUSED_PAD src0_sel:DWORD src1_sel:WORD_1
    ds_read_b64 v[96:97], v96
    ds_read_b64 v[98:99], v98
    v_lshlrev_b32_sdwa v100, 3, v41 dst_sel:DWORD dst_unused:UNUSED_PAD src0_sel:DWORD src1_sel:WORD_0
    v_lshlrev_b32_sdwa v102, 3, v41 dst_sel:DWORD dst_unused:UNUSED_PAD src0_sel:DWORD src1_sel:WORD_1
    v_lshlrev_b32 v176, 16, v6
    v_and_b32 v177, s23, v6
    v_lshlrev_b32 v178, 16, v7
    v_and_b32 v179, s23, v7
    ds_read_b64 v[100:101], v100
    ds_read_b64 v[102:103], v102
    buffer_load_dwordx4 v[136:139], v71, s[12:15], s18 offen offset:2048 sc1
    v_smfmac_f32_16x16x64_bf16 v[176:179], v[66:69], v[104:111], v70
    v_lshlrev_b64 v[222:223], v216, v[222:223]
    v_mov_b32 v218, s28
    v_mov_b32 v219, s29
    v_mov_b32 v220, s30
    v_mov_b32 v221, s31
    v_rcp_f32 v218, v218
    v_rcp_f32 v219, v219
    v_rcp_f32 v220, v220
    v_lshlrev_b32_sdwa v104, 3, v42 dst_sel:DWORD dst_unused:UNUSED_PAD src0_sel:DWORD src1_sel:WORD_0
    v_lshlrev_b32_sdwa v106, 3, v42 dst_sel:DWORD dst_unused:UNUSED_PAD src0_sel:DWORD src1_sel:WORD_1
    ds_read_b64 v[104:105], v104
    ds_read_b64 v[106:107], v106
    v_lshlrev_b32_sdwa v108, 3, v43 dst_sel:DWORD dst_unused:UNUSED_PAD src0_sel:DWORD src1_sel:WORD_0
    v_lshlrev_b32_sdwa v110, 3, v43 dst_sel:DWORD dst_unused:UNUSED_PAD src0_sel:DWORD src1_sel:WORD_1
    ds_read_b64 v[108:109], v108
    ds_read_b64 v[110:111], v110
    s_add_u32 s20, s20, 0xfffc0800
    buffer_load_dwordx4 v[40:43], v71, s[12:15], s20 offen offset:0 sc1
    v_smfmac_f32_16x16x64_bf16 v[176:179], v[66:69], v[88:95], v70
    v_rcp_f32 v221, v221
    v_mov_b32 v216, 0x7f7fffff
    v_mov_b32 v217, 0xff7fffff
    v_med3_f32 v218, v218, v216, v217
    v_med3_f32 v219, v219, v216, v217
    v_med3_f32 v220, v220, v216, v217
    v_med3_f32 v221, v221, v216, v217
    v_mov_b32 v73, 0
    s_waitcnt vmcnt(9)
    v_lshlrev_b32_sdwa v88, 3, v116 dst_sel:DWORD dst_unused:UNUSED_PAD src0_sel:DWORD src1_sel:WORD_0
    v_lshlrev_b32_sdwa v90, 3, v116 dst_sel:DWORD dst_unused:UNUSED_PAD src0_sel:DWORD src1_sel:WORD_1
    ds_read_b64 v[88:89], v88
    ds_read_b64 v[90:91], v90
    v_lshlrev_b32_sdwa v92, 3, v117 dst_sel:DWORD dst_unused:UNUSED_PAD src0_sel:DWORD src1_sel:WORD_0
    v_lshlrev_b32_sdwa v94, 3, v117 dst_sel:DWORD dst_unused:UNUSED_PAD src0_sel:DWORD src1_sel:WORD_1
    ds_read_b64 v[92:93], v92
    ds_read_b64 v[94:95], v94
    s_waitcnt lgkmcnt(8)
    v_smfmac_f32_16x16x64_bf16 v[52:55], v[66:69], v[96:103], v70
    v_lshrrev_b32 v76, 2, v71
    v_mov_b32 v79, 0
    v_and_b32 v75, 0xf0, v71
    v_lshrrev_b32 v80, 8, v71
    v_lshl_add_u32 v74, v80, 16, v75
    v_lshl_add_u32 v75, v80, 2, v75
    v_lshrrev_b32 v77, 9, v71
    v_mul_u32_u24 v77, 8064, v77
    v_lshlrev_b32_sdwa v96, 3, v118 dst_sel:DWORD dst_unused:UNUSED_PAD src0_sel:DWORD src1_sel:WORD_0
    v_lshlrev_b32_sdwa v98, 3, v118 dst_sel:DWORD dst_unused:UNUSED_PAD src0_sel:DWORD src1_sel:WORD_1
    ds_read_b64 v[96:97], v96
    ds_read_b64 v[98:99], v98
    v_lshlrev_b32_sdwa v100, 3, v119 dst_sel:DWORD dst_unused:UNUSED_PAD src0_sel:DWORD src1_sel:WORD_0
    v_lshlrev_b32_sdwa v102, 3, v119 dst_sel:DWORD dst_unused:UNUSED_PAD src0_sel:DWORD src1_sel:WORD_1
    ds_read_b64 v[100:101], v100
    ds_read_b64 v[102:103], v102
    s_add_u32 s20, s20, 0x40000
    buffer_load_dwordx4 v[116:119], v71, s[12:15], s20 offen offset:0 sc1
    s_waitcnt lgkmcnt(8)
    v_smfmac_f32_16x16x64_bf16 v[52:55], v[66:69], v[104:111], v70
    v_add3_u32 v77, v77, v76, s67
    v_lshrrev_b32 v78, 1, v75
    s_waitcnt vmcnt(9)
    v_lshlrev_b32_sdwa v104, 3, v36 dst_sel:DWORD dst_unused:UNUSED_PAD src0_sel:DWORD src1_sel:WORD_0
    v_lshlrev_b32_sdwa v106, 3, v36 dst_sel:DWORD dst_unused:UNUSED_PAD src0_sel:DWORD src1_sel:WORD_1
    ds_read_b64 v[104:105], v104
    ds_read_b64 v[106:107], v106
    v_lshlrev_b32_sdwa v108, 3, v37 dst_sel:DWORD dst_unused:UNUSED_PAD src0_sel:DWORD src1_sel:WORD_0
    v_lshlrev_b32_sdwa v110, 3, v37 dst_sel:DWORD dst_unused:UNUSED_PAD src0_sel:DWORD src1_sel:WORD_1
    v_lshlrev_b32 v180, 16, v32
    v_and_b32 v181, s23, v32
    v_lshlrev_b32 v182, 16, v33
    v_and_b32 v183, s23, v33
    ds_read_b64 v[108:109], v108
    ds_read_b64 v[110:111], v110
    s_mov_b64 exec, 1
    buffer_load_dword v35, off, s[12:15], s47 sc1
    s_mov_b64 exec, -1
    s_waitcnt lgkmcnt(8)
    v_smfmac_f32_16x16x64_bf16 v[180:183], v[66:69], v[88:95], v70
    v_mfma_f32_4x4x4_16b_bf16 v[52:55], v[222:223], v[128:129], v[52:55]
    v_lshlrev_b32_sdwa v88, 3, v38 dst_sel:DWORD dst_unused:UNUSED_PAD src0_sel:DWORD src1_sel:WORD_0
    v_lshlrev_b32_sdwa v90, 3, v38 dst_sel:DWORD dst_unused:UNUSED_PAD src0_sel:DWORD src1_sel:WORD_1
    ds_read_b64 v[88:89], v88
    ds_read_b64 v[90:91], v90
    v_lshlrev_b32_sdwa v92, 3, v39 dst_sel:DWORD dst_unused:UNUSED_PAD src0_sel:DWORD src1_sel:WORD_0
    v_lshlrev_b32_sdwa v94, 3, v39 dst_sel:DWORD dst_unused:UNUSED_PAD src0_sel:DWORD src1_sel:WORD_1
    ds_read_b64 v[92:93], v92
    ds_read_b64 v[94:95], v94
    s_add_u32 s20, s20, 0xfffff000
    buffer_load_dwordx4 v[36:39], v71, s[12:15], s20 offen offset:3072 sc1
    s_waitcnt lgkmcnt(8)
    v_smfmac_f32_16x16x64_bf16 v[180:183], v[66:69], v[96:103], v70
    v_pk_mul_f32 v[224:225], v[52:53], v[52:53]
    v_pk_mul_f32 v[226:227], v[54:55], v[54:55]
    v_pk_fma_f32 v[224:225], v[224:225], v[212:213], v[214:215]
    v_pk_fma_f32 v[226:227], v[226:227], v[212:213], v[214:215]
    v_pk_mul_f32 v[224:225], v[224:225], v[52:53]
    v_pk_mul_f32 v[226:227], v[226:227], v[54:55]
    v_exp_f32 v224, v224
    v_exp_f32 v225, v225
    s_waitcnt vmcnt(10)
    v_lshlrev_b32_sdwa v96, 3, v44 dst_sel:DWORD dst_unused:UNUSED_PAD src0_sel:DWORD src1_sel:WORD_0
    v_lshlrev_b32_sdwa v98, 3, v44 dst_sel:DWORD dst_unused:UNUSED_PAD src0_sel:DWORD src1_sel:WORD_1
    ds_read_b64 v[96:97], v96
    ds_read_b64 v[98:99], v98
    v_lshlrev_b32_sdwa v100, 3, v45 dst_sel:DWORD dst_unused:UNUSED_PAD src0_sel:DWORD src1_sel:WORD_0
    v_lshlrev_b32_sdwa v102, 3, v45 dst_sel:DWORD dst_unused:UNUSED_PAD src0_sel:DWORD src1_sel:WORD_1
    ds_read_b64 v[100:101], v100
    ds_read_b64 v[102:103], v102
    buffer_load_dwordx4 v[140:143], v71, s[12:15], s18 offen offset:3072 sc1
    s_waitcnt lgkmcnt(8)
    v_smfmac_f32_16x16x64_bf16 v[180:183], v[66:69], v[104:111], v70
    v_exp_f32 v226, v226
    v_pk_fma_f32 v[224:225], v[224:225], v[218:219], v[218:219]
    v_exp_f32 v227, v227
    v_rcp_f32 v224, v224
    v_rcp_f32 v225, v225
    v_pk_fma_f32 v[226:227], v[226:227], v[220:221], v[220:221]
    v_lshlrev_b32_sdwa v104, 3, v46 dst_sel:DWORD dst_unused:UNUSED_PAD src0_sel:DWORD src1_sel:WORD_0
    v_lshlrev_b32_sdwa v106, 3, v46 dst_sel:DWORD dst_unused:UNUSED_PAD src0_sel:DWORD src1_sel:WORD_1
    ds_read_b64 v[104:105], v104
    ds_read_b64 v[106:107], v106
    v_lshlrev_b32_sdwa v108, 3, v47 dst_sel:DWORD dst_unused:UNUSED_PAD src0_sel:DWORD src1_sel:WORD_0
    v_lshlrev_b32_sdwa v110, 3, v47 dst_sel:DWORD dst_unused:UNUSED_PAD src0_sel:DWORD src1_sel:WORD_1
    ds_read_b64 v[108:109], v108
    ds_read_b64 v[110:111], v110
    s_add_u32 s20, s20, 0xfffc0800
    buffer_load_dwordx4 v[44:47], v71, s[12:15], s20 offen offset:0 sc1
    s_waitcnt lgkmcnt(8)
    v_smfmac_f32_16x16x64_bf16 v[180:183], v[66:69], v[88:95], v70
    v_rcp_f32 v226, v226
    v_pk_mul_f32 v[228:229], v[52:53], v[224:225]
    v_rcp_f32 v227, v227
    s_waitcnt vmcnt(10)
    v_lshlrev_b32_sdwa v88, 3, v120 dst_sel:DWORD dst_unused:UNUSED_PAD src0_sel:DWORD src1_sel:WORD_0
    v_lshlrev_b32_sdwa v90, 3, v120 dst_sel:DWORD dst_unused:UNUSED_PAD src0_sel:DWORD src1_sel:WORD_1
    ds_read_b64 v[88:89], v88
    ds_read_b64 v[90:91], v90
    v_lshlrev_b32_sdwa v92, 3, v121 dst_sel:DWORD dst_unused:UNUSED_PAD src0_sel:DWORD src1_sel:WORD_0
    v_lshlrev_b32_sdwa v94, 3, v121 dst_sel:DWORD dst_unused:UNUSED_PAD src0_sel:DWORD src1_sel:WORD_1
    ds_read_b64 v[92:93], v92
    ds_read_b64 v[94:95], v94
    s_waitcnt lgkmcnt(8)
    v_smfmac_f32_16x16x64_bf16 v[56:59], v[66:69], v[96:103], v70
    v_pk_fma_f32 v[228:229], v[54:55], v[226:227], v[228:229]
    v_mfma_f32_4x4x4_16b_bf16 v[180:183], v[222:223], v[130:131], v[180:183]
    v_add_f32 v228, v228, v229
    v_lshlrev_b32_sdwa v96, 3, v122 dst_sel:DWORD dst_unused:UNUSED_PAD src0_sel:DWORD src1_sel:WORD_0
    v_lshlrev_b32_sdwa v98, 3, v122 dst_sel:DWORD dst_unused:UNUSED_PAD src0_sel:DWORD src1_sel:WORD_1
    ds_read_b64 v[96:97], v96
    ds_read_b64 v[98:99], v98
    v_lshlrev_b32_sdwa v100, 3, v123 dst_sel:DWORD dst_unused:UNUSED_PAD src0_sel:DWORD src1_sel:WORD_0
    v_lshlrev_b32_sdwa v102, 3, v123 dst_sel:DWORD dst_unused:UNUSED_PAD src0_sel:DWORD src1_sel:WORD_1
    ds_read_b64 v[100:101], v100
    ds_read_b64 v[102:103], v102
    s_add_u32 s20, s20, 0x40000
    buffer_load_dwordx4 v[120:123], v71, s[12:15], s20 offen offset:0 sc1
    s_waitcnt lgkmcnt(8)
    v_smfmac_f32_16x16x64_bf16 v[56:59], v[66:69], v[104:111], v70
    v_min_u32 v228, -2, v228
    v_pk_mul_f32 v[230:231], v[180:181], v[180:181]
    buffer_store_dword v228, v76, s[12:15], s35 offen offset:3328 sc1
    v_pk_fma_f32 v[230:231], v[230:231], v[212:213], v[214:215]
    v_pk_mul_f32 v[232:233], v[182:183], v[182:183]
    v_pk_mul_f32 v[230:231], v[230:231], v[180:181]
    v_pk_fma_f32 v[232:233], v[232:233], v[212:213], v[214:215]
    v_exp_f32 v230, v230
    s_waitcnt vmcnt(10)
    v_lshlrev_b32_sdwa v104, 3, v124 dst_sel:DWORD dst_unused:UNUSED_PAD src0_sel:DWORD src1_sel:WORD_0
    v_lshlrev_b32_sdwa v106, 3, v124 dst_sel:DWORD dst_unused:UNUSED_PAD src0_sel:DWORD src1_sel:WORD_1
    ds_read_b64 v[104:105], v104
    ds_read_b64 v[106:107], v106
    v_lshlrev_b32_sdwa v108, 3, v125 dst_sel:DWORD dst_unused:UNUSED_PAD src0_sel:DWORD src1_sel:WORD_0
    v_lshlrev_b32_sdwa v110, 3, v125 dst_sel:DWORD dst_unused:UNUSED_PAD src0_sel:DWORD src1_sel:WORD_1
    v_lshlrev_b32 v184, 16, v28
    v_and_b32 v185, s23, v28
    v_lshlrev_b32 v186, 16, v29
    v_and_b32 v187, s23, v29
    ds_read_b64 v[108:109], v108
    ds_read_b64 v[110:111], v110
    s_waitcnt lgkmcnt(8)
    v_smfmac_f32_16x16x64_bf16 v[184:187], v[66:69], v[88:95], v70
    v_exp_f32 v231, v231
    v_pk_mul_f32 v[232:233], v[232:233], v[182:183]
    v_mfma_f32_4x4x4_16b_bf16 v[56:59], v[222:223], v[132:133], v[56:59]
    v_exp_f32 v232, v232
    v_pk_fma_f32 v[230:231], v[230:231], v[218:219], v[218:219]
    v_exp_f32 v233, v233
    v_rcp_f32 v230, v230
    v_rcp_f32 v231, v231
    v_lshlrev_b32_sdwa v88, 3, v126 dst_sel:DWORD dst_unused:UNUSED_PAD src0_sel:DWORD src1_sel:WORD_0
    v_lshlrev_b32_sdwa v90, 3, v126 dst_sel:DWORD dst_unused:UNUSED_PAD src0_sel:DWORD src1_sel:WORD_1
    ds_read_b64 v[88:89], v88
    ds_read_b64 v[90:91], v90
    v_lshlrev_b32_sdwa v92, 3, v127 dst_sel:DWORD dst_unused:UNUSED_PAD src0_sel:DWORD src1_sel:WORD_0
    v_lshlrev_b32_sdwa v94, 3, v127 dst_sel:DWORD dst_unused:UNUSED_PAD src0_sel:DWORD src1_sel:WORD_1
    ds_read_b64 v[92:93], v92
    ds_read_b64 v[94:95], v94
    s_add_u32 s20, s20, 0xfffff000
    buffer_load_dwordx4 v[124:127], v71, s[12:15], s20 offen offset:3072 sc1
    s_waitcnt lgkmcnt(8)
    v_smfmac_f32_16x16x64_bf16 v[184:187], v[66:69], v[96:103], v70
    v_pk_fma_f32 v[232:233], v[232:233], v[220:221], v[220:221]
    v_pk_mul_f32 v[234:235], v[180:181], v[230:231]
    v_rcp_f32 v232, v232
    v_pk_mul_f32 v[236:237], v[56:57], v[56:57]
    v_pk_mul_f32 v[238:239], v[58:59], v[58:59]
    v_rcp_f32 v233, v233
    v_pk_fma_f32 v[236:237], v[236:237], v[212:213], v[214:215]
    v_pk_fma_f32 v[238:239], v[238:239], v[212:213], v[214:215]
    s_waitcnt vmcnt(10)
    v_lshlrev_b32_sdwa v96, 3, v48 dst_sel:DWORD dst_unused:UNUSED_PAD src0_sel:DWORD src1_sel:WORD_0
    v_lshlrev_b32_sdwa v98, 3, v48 dst_sel:DWORD dst_unused:UNUSED_PAD src0_sel:DWORD src1_sel:WORD_1
    ds_read_b64 v[96:97], v96
    ds_read_b64 v[98:99], v98
    v_lshlrev_b32_sdwa v100, 3, v49 dst_sel:DWORD dst_unused:UNUSED_PAD src0_sel:DWORD src1_sel:WORD_0
    v_lshlrev_b32_sdwa v102, 3, v49 dst_sel:DWORD dst_unused:UNUSED_PAD src0_sel:DWORD src1_sel:WORD_1
    ds_read_b64 v[100:101], v100
    ds_read_b64 v[102:103], v102
    s_waitcnt vmcnt(6)
    v_readfirstlane_b32 s44, v35
    s_cmp_le_u32 s44, 1
    s_cbranch_scc1 k1_kernel_xw1
k1_kernel_xb1:
    buffer_load_dwordx4 v[144:147], v71, s[12:15], s32 offen offset:0 sc1
    s_waitcnt lgkmcnt(8)
    v_smfmac_f32_16x16x64_bf16 v[184:187], v[66:69], v[104:111], v70
    v_pk_fma_f32 v[234:235], v[182:183], v[232:233], v[234:235]
    v_pk_mul_f32 v[236:237], v[236:237], v[56:57]
    v_add_f32 v234, v234, v235
    v_exp_f32 v236, v236
    v_min_u32 v234, -2, v234
    v_pk_mul_f32 v[238:239], v[238:239], v[58:59]
    v_exp_f32 v237, v237
    buffer_store_dword v234, v76, s[12:15], s35 offen offset:3072 sc1
    v_lshlrev_b32_sdwa v104, 3, v50 dst_sel:DWORD dst_unused:UNUSED_PAD src0_sel:DWORD src1_sel:WORD_0
    v_lshlrev_b32_sdwa v106, 3, v50 dst_sel:DWORD dst_unused:UNUSED_PAD src0_sel:DWORD src1_sel:WORD_1
    ds_read_b64 v[104:105], v104
    ds_read_b64 v[106:107], v106
    v_lshlrev_b32_sdwa v108, 3, v51 dst_sel:DWORD dst_unused:UNUSED_PAD src0_sel:DWORD src1_sel:WORD_0
    v_lshlrev_b32_sdwa v110, 3, v51 dst_sel:DWORD dst_unused:UNUSED_PAD src0_sel:DWORD src1_sel:WORD_1
    ds_read_b64 v[108:109], v108
    ds_read_b64 v[110:111], v110
    s_add_u32 s20, s20, 0xfffc0800
    buffer_load_dwordx4 v[48:51], v71, s[12:15], s20 offen offset:0 sc1
    s_waitcnt lgkmcnt(8)
    v_smfmac_f32_16x16x64_bf16 v[184:187], v[66:69], v[88:95], v70
    v_exp_f32 v238, v238
    v_pk_fma_f32 v[236:237], v[236:237], v[218:219], v[218:219]
    v_exp_f32 v239, v239
    v_rcp_f32 v236, v236
    v_rcp_f32 v237, v237
    v_pk_fma_f32 v[238:239], v[238:239], v[220:221], v[220:221]
    v_lshlrev_b32_sdwa v88, 3, v40 dst_sel:DWORD dst_unused:UNUSED_PAD src0_sel:DWORD src1_sel:WORD_0
    v_lshlrev_b32_sdwa v90, 3, v40 dst_sel:DWORD dst_unused:UNUSED_PAD src0_sel:DWORD src1_sel:WORD_1
    ds_read_b64 v[88:89], v88
    ds_read_b64 v[90:91], v90
    v_lshlrev_b32_sdwa v92, 3, v41 dst_sel:DWORD dst_unused:UNUSED_PAD src0_sel:DWORD src1_sel:WORD_0
    v_lshlrev_b32_sdwa v94, 3, v41 dst_sel:DWORD dst_unused:UNUSED_PAD src0_sel:DWORD src1_sel:WORD_1
    ds_read_b64 v[92:93], v92
    ds_read_b64 v[94:95], v94
    s_waitcnt lgkmcnt(8)
    v_smfmac_f32_16x16x64_bf16 v[60:63], v[66:69], v[96:103], v70
    v_rcp_f32 v238, v238
    v_pk_mul_f32 v[240:241], v[56:57], v[236:237]
    v_mfma_f32_4x4x4_16b_bf16 v[184:187], v[222:223], v[134:135], v[184:187]
    v_rcp_f32 v239, v239
    v_lshlrev_b32_sdwa v96, 3, v42 dst_sel:DWORD dst_unused:UNUSED_PAD src0_sel:DWORD src1_sel:WORD_0
    v_lshlrev_b32_sdwa v98, 3, v42 dst_sel:DWORD dst_unused:UNUSED_PAD src0_sel:DWORD src1_sel:WORD_1
    ds_read_b64 v[96:97], v96
    ds_read_b64 v[98:99], v98
    v_lshlrev_b32_sdwa v100, 3, v43 dst_sel:DWORD dst_unused:UNUSED_PAD src0_sel:DWORD src1_sel:WORD_0
    v_lshlrev_b32_sdwa v102, 3, v43 dst_sel:DWORD dst_unused:UNUSED_PAD src0_sel:DWORD src1_sel:WORD_1
    ds_read_b64 v[100:101], v100
    ds_read_b64 v[102:103], v102
    s_add_u32 s20, s20, 0x40000
    buffer_load_dwordx4 v[40:43], v71, s[12:15], s20 offen offset:0 sc1
    s_waitcnt lgkmcnt(8)
    v_smfmac_f32_16x16x64_bf16 v[60:63], v[66:69], v[104:111], v70
    v_pk_fma_f32 v[240:241], v[58:59], v[238:239], v[240:241]
    v_pk_mul_f32 v[242:243], v[184:185], v[184:185]
    v_add_f32 v240, v240, v241
    v_pk_fma_f32 v[242:243], v[242:243], v[212:213], v[214:215]
    v_min_u32 v240, -2, v240
    v_pk_mul_f32 v[242:243], v[242:243], v[184:185]
    buffer_store_dword v240, v76, s[12:15], s35 offen offset:2816 sc1
    v_exp_f32 v242, v242
    v_lshlrev_b32_sdwa v104, 3, v116 dst_sel:DWORD dst_unused:UNUSED_PAD src0_sel:DWORD src1_sel:WORD_0
    v_lshlrev_b32_sdwa v106, 3, v116 dst_sel:DWORD dst_unused:UNUSED_PAD src0_sel:DWORD src1_sel:WORD_1
    ds_read_b64 v[104:105], v104
    ds_read_b64 v[106:107], v106
    v_lshlrev_b32_sdwa v108, 3, v117 dst_sel:DWORD dst_unused:UNUSED_PAD src0_sel:DWORD src1_sel:WORD_0
    v_lshlrev_b32_sdwa v110, 3, v117 dst_sel:DWORD dst_unused:UNUSED_PAD src0_sel:DWORD src1_sel:WORD_1
    v_lshlrev_b32 v188, 16, v24
    v_and_b32 v189, s23, v24
    v_lshlrev_b32 v190, 16, v25
    v_and_b32 v191, s23, v25
    ds_read_b64 v[108:109], v108
    ds_read_b64 v[110:111], v110
    s_waitcnt lgkmcnt(8)
    v_smfmac_f32_16x16x64_bf16 v[188:191], v[66:69], v[88:95], v70
    v_exp_f32 v243, v243
    v_pk_mul_f32 v[244:245], v[186:187], v[186:187]
    v_mfma_f32_4x4x4_16b_bf16 v[60:63], v[222:223], v[136:137], v[60:63]
    v_pk_fma_f32 v[242:243], v[242:243], v[218:219], v[218:219]
    v_pk_fma_f32 v[244:245], v[244:245], v[212:213], v[214:215]
    v_rcp_f32 v242, v242
    v_pk_mul_f32 v[244:245], v[244:245], v[186:187]
    v_rcp_f32 v243, v243
    v_lshlrev_b32_sdwa v88, 3, v118 dst_sel:DWORD dst_unused:UNUSED_PAD src0_sel:DWORD src1_sel:WORD_0
    v_lshlrev_b32_sdwa v90, 3, v118 dst_sel:DWORD dst_unused:UNUSED_PAD src0_sel:DWORD src1_sel:WORD_1
    ds_read_b64 v[88:89], v88
    ds_read_b64 v[90:91], v90
    v_lshlrev_b32_sdwa v92, 3, v119 dst_sel:DWORD dst_unused:UNUSED_PAD src0_sel:DWORD src1_sel:WORD_0
    v_lshlrev_b32_sdwa v94, 3, v119 dst_sel:DWORD dst_unused:UNUSED_PAD src0_sel:DWORD src1_sel:WORD_1
    ds_read_b64 v[92:93], v92
    ds_read_b64 v[94:95], v94
    s_add_u32 s20, s20, 0xfffff000
    buffer_load_dwordx4 v[116:119], v71, s[12:15], s20 offen offset:3072 sc1
    s_waitcnt lgkmcnt(8)
    v_smfmac_f32_16x16x64_bf16 v[188:191], v[66:69], v[96:103], v70
    v_exp_f32 v244, v244
    v_pk_mul_f32 v[246:247], v[184:185], v[242:243]
    v_pk_mul_f32 v[248:249], v[60:61], v[60:61]
    v_exp_f32 v245, v245
    v_pk_fma_f32 v[248:249], v[248:249], v[212:213], v[214:215]
    v_pk_mul_f32 v[250:251], v[62:63], v[62:63]
    v_pk_fma_f32 v[244:245], v[244:245], v[220:221], v[220:221]
    v_pk_mul_f32 v[248:249], v[248:249], v[60:61]
    s_waitcnt vmcnt(11)
    v_lshlrev_b32_sdwa v96, 3, v36 dst_sel:DWORD dst_unused:UNUSED_PAD src0_sel:DWORD src1_sel:WORD_0
    v_lshlrev_b32_sdwa v98, 3, v36 dst_sel:DWORD dst_unused:UNUSED_PAD src0_sel:DWORD src1_sel:WORD_1
    ds_read_b64 v[96:97], v96
    ds_read_b64 v[98:99], v98
    v_lshlrev_b32_sdwa v100, 3, v37 dst_sel:DWORD dst_unused:UNUSED_PAD src0_sel:DWORD src1_sel:WORD_0
    v_lshlrev_b32_sdwa v102, 3, v37 dst_sel:DWORD dst_unused:UNUSED_PAD src0_sel:DWORD src1_sel:WORD_1
    ds_read_b64 v[100:101], v100
    ds_read_b64 v[102:103], v102
    buffer_load_dwordx4 v[148:151], v71, s[12:15], s32 offen offset:1024 sc1
    s_waitcnt lgkmcnt(8)
    v_smfmac_f32_16x16x64_bf16 v[188:191], v[66:69], v[104:111], v70
    v_rcp_f32 v244, v244
    v_pk_fma_f32 v[250:251], v[250:251], v[212:213], v[214:215]
    v_rcp_f32 v245, v245
    v_pk_mul_f32 v[250:251], v[250:251], v[62:63]
    v_exp_f32 v248, v248
    v_pk_fma_f32 v[246:247], v[186:187], v[244:245], v[246:247]
    v_exp_f32 v249, v249
    v_add_f32 v246, v246, v247
    v_lshlrev_b32_sdwa v104, 3, v38 dst_sel:DWORD dst_unused:UNUSED_PAD src0_sel:DWORD src1_sel:WORD_0
    v_lshlrev_b32_sdwa v106, 3, v38 dst_sel:DWORD dst_unused:UNUSED_PAD src0_sel:DWORD src1_sel:WORD_1
    ds_read_b64 v[104:105], v104
    ds_read_b64 v[106:107], v106
    v_lshlrev_b32_sdwa v108, 3, v39 dst_sel:DWORD dst_unused:UNUSED_PAD src0_sel:DWORD src1_sel:WORD_0
    v_lshlrev_b32_sdwa v110, 3, v39 dst_sel:DWORD dst_unused:UNUSED_PAD src0_sel:DWORD src1_sel:WORD_1
    ds_read_b64 v[108:109], v108
    ds_read_b64 v[110:111], v110
    s_add_u32 s20, s20, 0xfffc0800
    buffer_load_dwordx4 v[36:39], v71, s[12:15], s20 offen offset:0 sc1
    s_waitcnt lgkmcnt(8)
    v_smfmac_f32_16x16x64_bf16 v[188:191], v[66:69], v[88:95], v70
    v_exp_f32 v250, v250
    v_min_u32 v246, -2, v246
    v_pk_fma_f32 v[248:249], v[248:249], v[218:219], v[218:219]
    v_exp_f32 v251, v251
    buffer_store_dword v246, v76, s[12:15], s35 offen offset:2560 sc1
    v_rcp_f32 v248, v248
    v_pk_fma_f32 v[250:251], v[250:251], v[220:221], v[220:221]
    v_rcp_f32 v249, v249
    s_waitcnt vmcnt(12)
    v_lshlrev_b32_sdwa v88, 3, v44 dst_sel:DWORD dst_unused:UNUSED_PAD src0_sel:DWORD src1_sel:WORD_0
    v_lshlrev_b32_sdwa v90, 3, v44 dst_sel:DWORD dst_unused:UNUSED_PAD src0_sel:DWORD src1_sel:WORD_1
    ds_read_b64 v[88:89], v88
    ds_read_b64 v[90:91], v90
    v_lshlrev_b32_sdwa v92, 3, v45 dst_sel:DWORD dst_unused:UNUSED_PAD src0_sel:DWORD src1_sel:WORD_0
    v_lshlrev_b32_sdwa v94, 3, v45 dst_sel:DWORD dst_unused:UNUSED_PAD src0_sel:DWORD src1_sel:WORD_1
    ds_read_b64 v[92:93], v92
    ds_read_b64 v[94:95], v94
    s_waitcnt lgkmcnt(8)
    v_smfmac_f32_16x16x64_bf16 v[160:163], v[66:69], v[96:103], v70
    v_rcp_f32 v250, v250
    v_pk_mul_f32 v[252:253], v[60:61], v[248:249]
    v_mfma_f32_4x4x4_16b_bf16 v[188:191], v[222:223], v[138:139], v[188:191]
    v_rcp_f32 v251, v251
    v_lshlrev_b32_sdwa v96, 3, v46 dst_sel:DWORD dst_unused:UNUSED_PAD src0_sel:DWORD src1_sel:WORD_0
    v_lshlrev_b32_sdwa v98, 3, v46 dst_sel:DWORD dst_unused:UNUSED_PAD src0_sel:DWORD src1_sel:WORD_1
    ds_read_b64 v[96:97], v96
    ds_read_b64 v[98:99], v98
    v_lshlrev_b32_sdwa v100, 3, v47 dst_sel:DWORD dst_unused:UNUSED_PAD src0_sel:DWORD src1_sel:WORD_0
    v_lshlrev_b32_sdwa v102, 3, v47 dst_sel:DWORD dst_unused:UNUSED_PAD src0_sel:DWORD src1_sel:WORD_1
    ds_read_b64 v[100:101], v100
    ds_read_b64 v[102:103], v102
    s_add_u32 s20, s20, 0x40000
    buffer_load_dwordx4 v[44:47], v71, s[12:15], s20 offen offset:0 sc1
    s_waitcnt lgkmcnt(8)
    v_smfmac_f32_16x16x64_bf16 v[160:163], v[66:69], v[104:111], v70
    v_pk_fma_f32 v[252:253], v[62:63], v[250:251], v[252:253]
    v_pk_mul_f32 v[224:225], v[188:189], v[188:189]
    v_add_f32 v252, v252, v253
    v_pk_fma_f32 v[224:225], v[224:225], v[212:213], v[214:215]
    v_min_u32 v252, -2, v252
    v_pk_mul_f32 v[224:225], v[224:225], v[188:189]
    buffer_store_dword v252, v76, s[12:15], s35 offen offset:2304 sc1
    v_exp_f32 v224, v224
    s_waitcnt vmcnt(13)
    v_lshlrev_b32_sdwa v104, 3, v120 dst_sel:DWORD dst_unused:UNUSED_PAD src0_sel:DWORD src1_sel:WORD_0
    v_lshlrev_b32_sdwa v106, 3, v120 dst_sel:DWORD dst_unused:UNUSED_PAD src0_sel:DWORD src1_sel:WORD_1
    ds_read_b64 v[104:105], v104
    ds_read_b64 v[106:107], v106
    v_lshlrev_b32_sdwa v108, 3, v121 dst_sel:DWORD dst_unused:UNUSED_PAD src0_sel:DWORD src1_sel:WORD_0
    v_lshlrev_b32_sdwa v110, 3, v121 dst_sel:DWORD dst_unused:UNUSED_PAD src0_sel:DWORD src1_sel:WORD_1
    v_lshlrev_b32 v192, 16, v20
    v_and_b32 v193, s23, v20
    v_lshlrev_b32 v194, 16, v21
    v_and_b32 v195, s23, v21
    ds_read_b64 v[108:109], v108
    ds_read_b64 v[110:111], v110
    s_waitcnt lgkmcnt(8)
    v_smfmac_f32_16x16x64_bf16 v[192:195], v[66:69], v[88:95], v70
    s_setprio 2
    v_exp_f32 v225, v225
    v_pk_mul_f32 v[226:227], v[190:191], v[190:191]
    v_mfma_f32_4x4x4_16b_bf16 v[160:163], v[222:223], v[140:141], v[160:163]
    v_pk_fma_f32 v[224:225], v[224:225], v[218:219], v[218:219]
    v_pk_fma_f32 v[226:227], v[226:227], v[212:213], v[214:215]
    v_rcp_f32 v224, v224
    v_pk_mul_f32 v[226:227], v[226:227], v[190:191]
    v_rcp_f32 v225, v225
    v_lshlrev_b32_sdwa v88, 3, v122 dst_sel:DWORD dst_unused:UNUSED_PAD src0_sel:DWORD src1_sel:WORD_0
    v_lshlrev_b32_sdwa v90, 3, v122 dst_sel:DWORD dst_unused:UNUSED_PAD src0_sel:DWORD src1_sel:WORD_1
    ds_read_b64 v[88:89], v88
    ds_read_b64 v[90:91], v90
    v_lshlrev_b32_sdwa v92, 3, v123 dst_sel:DWORD dst_unused:UNUSED_PAD src0_sel:DWORD src1_sel:WORD_0
    v_lshlrev_b32_sdwa v94, 3, v123 dst_sel:DWORD dst_unused:UNUSED_PAD src0_sel:DWORD src1_sel:WORD_1
    ds_read_b64 v[92:93], v92
    ds_read_b64 v[94:95], v94
    s_add_u32 s20, s20, 0xfffff000
    buffer_load_dwordx4 v[120:123], v71, s[12:15], s20 offen offset:3072 sc1
    s_waitcnt lgkmcnt(8)
    v_smfmac_f32_16x16x64_bf16 v[192:195], v[66:69], v[96:103], v70
    v_exp_f32 v226, v226
    v_pk_mul_f32 v[228:229], v[188:189], v[224:225]
    v_pk_mul_f32 v[230:231], v[160:161], v[160:161]
    v_exp_f32 v227, v227
    v_pk_fma_f32 v[230:231], v[230:231], v[212:213], v[214:215]
    v_pk_mul_f32 v[232:233], v[162:163], v[162:163]
    v_pk_fma_f32 v[226:227], v[226:227], v[220:221], v[220:221]
    v_pk_mul_f32 v[230:231], v[230:231], v[160:161]
    s_waitcnt vmcnt(12)
    v_lshlrev_b32_sdwa v96, 3, v124 dst_sel:DWORD dst_unused:UNUSED_PAD src0_sel:DWORD src1_sel:WORD_0
    v_lshlrev_b32_sdwa v98, 3, v124 dst_sel:DWORD dst_unused:UNUSED_PAD src0_sel:DWORD src1_sel:WORD_1
    ds_read_b64 v[96:97], v96
    ds_read_b64 v[98:99], v98
    v_lshlrev_b32_sdwa v100, 3, v125 dst_sel:DWORD dst_unused:UNUSED_PAD src0_sel:DWORD src1_sel:WORD_0
    v_lshlrev_b32_sdwa v102, 3, v125 dst_sel:DWORD dst_unused:UNUSED_PAD src0_sel:DWORD src1_sel:WORD_1
    ds_read_b64 v[100:101], v100
    ds_read_b64 v[102:103], v102
    buffer_load_dwordx4 v[152:155], v71, s[12:15], s32 offen offset:2048 sc1
    s_waitcnt lgkmcnt(8)
    v_smfmac_f32_16x16x64_bf16 v[192:195], v[66:69], v[104:111], v70
    v_rcp_f32 v226, v226
    v_pk_fma_f32 v[232:233], v[232:233], v[212:213], v[214:215]
    v_rcp_f32 v227, v227
    v_pk_mul_f32 v[232:233], v[232:233], v[162:163]
    v_exp_f32 v230, v230
    v_pk_fma_f32 v[228:229], v[190:191], v[226:227], v[228:229]
    v_exp_f32 v231, v231
    v_add_f32 v228, v228, v229
    v_lshlrev_b32_sdwa v104, 3, v126 dst_sel:DWORD dst_unused:UNUSED_PAD src0_sel:DWORD src1_sel:WORD_0
    v_lshlrev_b32_sdwa v106, 3, v126 dst_sel:DWORD dst_unused:UNUSED_PAD src0_sel:DWORD src1_sel:WORD_1
    ds_read_b64 v[104:105], v104
    ds_read_b64 v[106:107], v106
    v_lshlrev_b32_sdwa v108, 3, v127 dst_sel:DWORD dst_unused:UNUSED_PAD src0_sel:DWORD src1_sel:WORD_0
    v_lshlrev_b32_sdwa v110, 3, v127 dst_sel:DWORD dst_unused:UNUSED_PAD src0_sel:DWORD src1_sel:WORD_1
    ds_read_b64 v[108:109], v108
    ds_read_b64 v[110:111], v110
    s_add_u32 s20, s20, 0xfffc0800
    buffer_load_dwordx4 v[124:127], v71, s[12:15], s20 offen offset:0 sc1
    s_waitcnt lgkmcnt(8)
    v_smfmac_f32_16x16x64_bf16 v[192:195], v[66:69], v[88:95], v70
    v_exp_f32 v232, v232
    v_min_u32 v228, -2, v228
    v_pk_fma_f32 v[230:231], v[230:231], v[218:219], v[218:219]
    v_exp_f32 v233, v233
    buffer_store_dword v228, v76, s[12:15], s35 offen offset:2048 sc1
    v_rcp_f32 v230, v230
    v_pk_fma_f32 v[232:233], v[232:233], v[220:221], v[220:221]
    v_rcp_f32 v231, v231
    s_waitcnt vmcnt(12)
    v_lshlrev_b32_sdwa v88, 3, v48 dst_sel:DWORD dst_unused:UNUSED_PAD src0_sel:DWORD src1_sel:WORD_0
    v_lshlrev_b32_sdwa v90, 3, v48 dst_sel:DWORD dst_unused:UNUSED_PAD src0_sel:DWORD src1_sel:WORD_1
    ds_read_b64 v[88:89], v88
    ds_read_b64 v[90:91], v90
    v_lshlrev_b32_sdwa v92, 3, v49 dst_sel:DWORD dst_unused:UNUSED_PAD src0_sel:DWORD src1_sel:WORD_0
    v_lshlrev_b32_sdwa v94, 3, v49 dst_sel:DWORD dst_unused:UNUSED_PAD src0_sel:DWORD src1_sel:WORD_1
    ds_read_b64 v[92:93], v92
    ds_read_b64 v[94:95], v94
    s_waitcnt lgkmcnt(8)
    v_smfmac_f32_16x16x64_bf16 v[164:167], v[66:69], v[96:103], v70
    v_rcp_f32 v232, v232
    v_pk_mul_f32 v[234:235], v[160:161], v[230:231]
    v_mfma_f32_4x4x4_16b_bf16 v[192:195], v[222:223], v[142:143], v[192:195]
    v_rcp_f32 v233, v233
    v_lshlrev_b32_sdwa v96, 3, v50 dst_sel:DWORD dst_unused:UNUSED_PAD src0_sel:DWORD src1_sel:WORD_0
    v_lshlrev_b32_sdwa v98, 3, v50 dst_sel:DWORD dst_unused:UNUSED_PAD src0_sel:DWORD src1_sel:WORD_1
    ds_read_b64 v[96:97], v96
    ds_read_b64 v[98:99], v98
    v_lshlrev_b32_sdwa v100, 3, v51 dst_sel:DWORD dst_unused:UNUSED_PAD src0_sel:DWORD src1_sel:WORD_0
    v_lshlrev_b32_sdwa v102, 3, v51 dst_sel:DWORD dst_unused:UNUSED_PAD src0_sel:DWORD src1_sel:WORD_1
    ds_read_b64 v[100:101], v100
    ds_read_b64 v[102:103], v102
    s_add_u32 s20, s20, 0x40000
    buffer_load_dwordx4 v[48:51], v71, s[12:15], s20 offen offset:0 sc1
    s_waitcnt lgkmcnt(8)
    v_smfmac_f32_16x16x64_bf16 v[164:167], v[66:69], v[104:111], v70
    v_pk_fma_f32 v[234:235], v[162:163], v[232:233], v[234:235]
    v_pk_mul_f32 v[236:237], v[192:193], v[192:193]
    v_add_f32 v234, v234, v235
    v_pk_fma_f32 v[236:237], v[236:237], v[212:213], v[214:215]
    v_min_u32 v234, -2, v234
    v_pk_mul_f32 v[236:237], v[236:237], v[192:193]
    buffer_store_dword v234, v76, s[12:15], s35 offen offset:1792 sc1
    v_exp_f32 v236, v236
    s_waitcnt vmcnt(13)
    v_lshlrev_b32_sdwa v104, 3, v40 dst_sel:DWORD dst_unused:UNUSED_PAD src0_sel:DWORD src1_sel:WORD_0
    v_lshlrev_b32_sdwa v106, 3, v40 dst_sel:DWORD dst_unused:UNUSED_PAD src0_sel:DWORD src1_sel:WORD_1
    ds_read_b64 v[104:105], v104
    ds_read_b64 v[106:107], v106
    v_lshlrev_b32_sdwa v108, 3, v41 dst_sel:DWORD dst_unused:UNUSED_PAD src0_sel:DWORD src1_sel:WORD_0
    v_lshlrev_b32_sdwa v110, 3, v41 dst_sel:DWORD dst_unused:UNUSED_PAD src0_sel:DWORD src1_sel:WORD_1
    v_lshlrev_b32 v196, 16, v16
    v_and_b32 v197, s23, v16
    v_lshlrev_b32 v198, 16, v17
    v_and_b32 v199, s23, v17
    ds_read_b64 v[108:109], v108
    ds_read_b64 v[110:111], v110
    s_waitcnt lgkmcnt(8)
    v_smfmac_f32_16x16x64_bf16 v[196:199], v[66:69], v[88:95], v70
    v_exp_f32 v237, v237
    v_pk_mul_f32 v[238:239], v[194:195], v[194:195]
    v_mfma_f32_4x4x4_16b_bf16 v[164:167], v[222:223], v[144:145], v[164:167]
    v_pk_fma_f32 v[236:237], v[236:237], v[218:219], v[218:219]
    v_pk_fma_f32 v[238:239], v[238:239], v[212:213], v[214:215]
    v_rcp_f32 v236, v236
    v_pk_mul_f32 v[238:239], v[238:239], v[194:195]
    v_rcp_f32 v237, v237
    v_lshlrev_b32_sdwa v88, 3, v42 dst_sel:DWORD dst_unused:UNUSED_PAD src0_sel:DWORD src1_sel:WORD_0
    v_lshlrev_b32_sdwa v90, 3, v42 dst_sel:DWORD dst_unused:UNUSED_PAD src0_sel:DWORD src1_sel:WORD_1
    ds_read_b64 v[88:89], v88
    ds_read_b64 v[90:91], v90
    v_lshlrev_b32_sdwa v92, 3, v43 dst_sel:DWORD dst_unused:UNUSED_PAD src0_sel:DWORD src1_sel:WORD_0
    v_lshlrev_b32_sdwa v94, 3, v43 dst_sel:DWORD dst_unused:UNUSED_PAD src0_sel:DWORD src1_sel:WORD_1
    ds_read_b64 v[92:93], v92
    ds_read_b64 v[94:95], v94
    s_add_u32 s20, s20, 0x3000
    buffer_load_dwordx4 v[40:43], v71, s[12:15], s20 offen offset:3072 sc1
    s_waitcnt lgkmcnt(8)
    v_smfmac_f32_16x16x64_bf16 v[196:199], v[66:69], v[96:103], v70
    v_exp_f32 v238, v238
    v_pk_mul_f32 v[240:241], v[192:193], v[236:237]
    v_pk_mul_f32 v[242:243], v[164:165], v[164:165]
    v_exp_f32 v239, v239
    v_pk_fma_f32 v[242:243], v[242:243], v[212:213], v[214:215]
    v_pk_mul_f32 v[244:245], v[166:167], v[166:167]
    v_pk_fma_f32 v[238:239], v[238:239], v[220:221], v[220:221]
    v_pk_mul_f32 v[242:243], v[242:243], v[164:165]
    s_waitcnt vmcnt(12)
    v_lshlrev_b32_sdwa v96, 3, v116 dst_sel:DWORD dst_unused:UNUSED_PAD src0_sel:DWORD src1_sel:WORD_0
    v_lshlrev_b32_sdwa v98, 3, v116 dst_sel:DWORD dst_unused:UNUSED_PAD src0_sel:DWORD src1_sel:WORD_1
    ds_read_b64 v[96:97], v96
    ds_read_b64 v[98:99], v98
    v_lshlrev_b32_sdwa v100, 3, v117 dst_sel:DWORD dst_unused:UNUSED_PAD src0_sel:DWORD src1_sel:WORD_0
    v_lshlrev_b32_sdwa v102, 3, v117 dst_sel:DWORD dst_unused:UNUSED_PAD src0_sel:DWORD src1_sel:WORD_1
    ds_read_b64 v[100:101], v100
    ds_read_b64 v[102:103], v102
    buffer_load_dwordx4 v[156:159], v71, s[12:15], s32 offen offset:3072 sc1
    s_waitcnt lgkmcnt(8)
    v_smfmac_f32_16x16x64_bf16 v[196:199], v[66:69], v[104:111], v70
    v_rcp_f32 v238, v238
    v_pk_fma_f32 v[244:245], v[244:245], v[212:213], v[214:215]
    v_rcp_f32 v239, v239
    v_pk_mul_f32 v[244:245], v[244:245], v[166:167]
    v_exp_f32 v242, v242
    v_pk_fma_f32 v[240:241], v[194:195], v[238:239], v[240:241]
    v_exp_f32 v243, v243
    v_add_f32 v240, v240, v241
    v_lshlrev_b32_sdwa v104, 3, v118 dst_sel:DWORD dst_unused:UNUSED_PAD src0_sel:DWORD src1_sel:WORD_0
    v_lshlrev_b32_sdwa v106, 3, v118 dst_sel:DWORD dst_unused:UNUSED_PAD src0_sel:DWORD src1_sel:WORD_1
    ds_read_b64 v[104:105], v104
    ds_read_b64 v[106:107], v106
    v_lshlrev_b32_sdwa v108, 3, v119 dst_sel:DWORD dst_unused:UNUSED_PAD src0_sel:DWORD src1_sel:WORD_0
    v_lshlrev_b32_sdwa v110, 3, v119 dst_sel:DWORD dst_unused:UNUSED_PAD src0_sel:DWORD src1_sel:WORD_1
    ds_read_b64 v[108:109], v108
    ds_read_b64 v[110:111], v110
    s_add_u32 s20, s20, 0xfffc0800
    buffer_load_dwordx4 v[116:119], v71, s[12:15], s20 offen offset:0 sc1
    s_waitcnt lgkmcnt(8)
    v_smfmac_f32_16x16x64_bf16 v[196:199], v[66:69], v[88:95], v70
    v_exp_f32 v244, v244
    v_min_u32 v240, -2, v240
    v_pk_fma_f32 v[242:243], v[242:243], v[218:219], v[218:219]
    v_exp_f32 v245, v245
    buffer_store_dword v240, v76, s[12:15], s35 offen offset:1536 sc1
    v_rcp_f32 v242, v242
    v_pk_fma_f32 v[244:245], v[244:245], v[220:221], v[220:221]
    v_rcp_f32 v243, v243
    s_waitcnt vmcnt(13)
    v_lshlrev_b32_sdwa v88, 3, v36 dst_sel:DWORD dst_unused:UNUSED_PAD src0_sel:DWORD src1_sel:WORD_0
    v_lshlrev_b32_sdwa v90, 3, v36 dst_sel:DWORD dst_unused:UNUSED_PAD src0_sel:DWORD src1_sel:WORD_1
    ds_read_b64 v[88:89], v88
    ds_read_b64 v[90:91], v90
    v_lshlrev_b32_sdwa v92, 3, v37 dst_sel:DWORD dst_unused:UNUSED_PAD src0_sel:DWORD src1_sel:WORD_0
    v_lshlrev_b32_sdwa v94, 3, v37 dst_sel:DWORD dst_unused:UNUSED_PAD src0_sel:DWORD src1_sel:WORD_1
    ds_read_b64 v[92:93], v92
    ds_read_b64 v[94:95], v94
    s_waitcnt lgkmcnt(8)
    v_smfmac_f32_16x16x64_bf16 v[168:171], v[66:69], v[96:103], v70
    v_rcp_f32 v244, v244
    v_pk_mul_f32 v[246:247], v[164:165], v[242:243]
    v_mfma_f32_4x4x4_16b_bf16 v[196:199], v[222:223], v[146:147], v[196:199]
    v_rcp_f32 v245, v245
    v_lshlrev_b32_sdwa v96, 3, v38 dst_sel:DWORD dst_unused:UNUSED_PAD src0_sel:DWORD src1_sel:WORD_0
    v_lshlrev_b32_sdwa v98, 3, v38 dst_sel:DWORD dst_unused:UNUSED_PAD src0_sel:DWORD src1_sel:WORD_1
    ds_read_b64 v[96:97], v96
    ds_read_b64 v[98:99], v98
    v_lshlrev_b32_sdwa v100, 3, v39 dst_sel:DWORD dst_unused:UNUSED_PAD src0_sel:DWORD src1_sel:WORD_0
    v_lshlrev_b32_sdwa v102, 3, v39 dst_sel:DWORD dst_unused:UNUSED_PAD src0_sel:DWORD src1_sel:WORD_1
    ds_read_b64 v[100:101], v100
    ds_read_b64 v[102:103], v102
    s_add_u32 s20, s20, 0x40000
    buffer_load_dwordx4 v[36:39], v71, s[12:15], s20 offen offset:0 sc1
    s_waitcnt lgkmcnt(8)
    v_smfmac_f32_16x16x64_bf16 v[168:171], v[66:69], v[104:111], v70
    v_pk_fma_f32 v[246:247], v[166:167], v[244:245], v[246:247]
    v_pk_mul_f32 v[248:249], v[196:197], v[196:197]
    v_add_f32 v246, v246, v247
    v_pk_fma_f32 v[248:249], v[248:249], v[212:213], v[214:215]
    v_min_u32 v246, -2, v246
    v_pk_mul_f32 v[248:249], v[248:249], v[196:197]
    buffer_store_dword v246, v76, s[12:15], s35 offen offset:1280 sc1
    v_exp_f32 v248, v248
    s_waitcnt vmcnt(13)
    v_lshlrev_b32_sdwa v104, 3, v44 dst_sel:DWORD dst_unused:UNUSED_PAD src0_sel:DWORD src1_sel:WORD_0
    v_lshlrev_b32_sdwa v106, 3, v44 dst_sel:DWORD dst_unused:UNUSED_PAD src0_sel:DWORD src1_sel:WORD_1
    ds_read_b64 v[104:105], v104
    ds_read_b64 v[106:107], v106
    v_lshlrev_b32_sdwa v108, 3, v45 dst_sel:DWORD dst_unused:UNUSED_PAD src0_sel:DWORD src1_sel:WORD_0
    v_lshlrev_b32_sdwa v110, 3, v45 dst_sel:DWORD dst_unused:UNUSED_PAD src0_sel:DWORD src1_sel:WORD_1
    v_lshlrev_b32 v200, 16, v12
    v_and_b32 v201, s23, v12
    v_lshlrev_b32 v202, 16, v13
    v_and_b32 v203, s23, v13
    ds_read_b64 v[108:109], v108
    ds_read_b64 v[110:111], v110
    s_waitcnt lgkmcnt(8)
    v_smfmac_f32_16x16x64_bf16 v[200:203], v[66:69], v[88:95], v70
    v_exp_f32 v249, v249
    v_pk_mul_f32 v[250:251], v[198:199], v[198:199]
    v_mfma_f32_4x4x4_16b_bf16 v[168:171], v[222:223], v[148:149], v[168:171]
    v_pk_fma_f32 v[248:249], v[248:249], v[218:219], v[218:219]
    v_pk_fma_f32 v[250:251], v[250:251], v[212:213], v[214:215]
    v_rcp_f32 v248, v248
    v_pk_mul_f32 v[250:251], v[250:251], v[198:199]
    v_rcp_f32 v249, v249
    v_lshlrev_b32_sdwa v88, 3, v46 dst_sel:DWORD dst_unused:UNUSED_PAD src0_sel:DWORD src1_sel:WORD_0
    v_lshlrev_b32_sdwa v90, 3, v46 dst_sel:DWORD dst_unused:UNUSED_PAD src0_sel:DWORD src1_sel:WORD_1
    ds_read_b64 v[88:89], v88
    ds_read_b64 v[90:91], v90
    v_lshlrev_b32_sdwa v92, 3, v47 dst_sel:DWORD dst_unused:UNUSED_PAD src0_sel:DWORD src1_sel:WORD_0
    v_lshlrev_b32_sdwa v94, 3, v47 dst_sel:DWORD dst_unused:UNUSED_PAD src0_sel:DWORD src1_sel:WORD_1
    ds_read_b64 v[92:93], v92
    ds_read_b64 v[94:95], v94
    s_waitcnt lgkmcnt(8)
    v_smfmac_f32_16x16x64_bf16 v[200:203], v[66:69], v[96:103], v70
    v_exp_f32 v250, v250
    v_pk_mul_f32 v[252:253], v[196:197], v[248:249]
    v_pk_mul_f32 v[224:225], v[168:169], v[168:169]
    v_exp_f32 v251, v251
    v_pk_fma_f32 v[224:225], v[224:225], v[212:213], v[214:215]
    v_pk_mul_f32 v[226:227], v[170:171], v[170:171]
    v_pk_fma_f32 v[250:251], v[250:251], v[220:221], v[220:221]
    v_pk_mul_f32 v[224:225], v[224:225], v[168:169]
    s_waitcnt vmcnt(11)
    v_lshlrev_b32_sdwa v96, 3, v120 dst_sel:DWORD dst_unused:UNUSED_PAD src0_sel:DWORD src1_sel:WORD_0
    v_lshlrev_b32_sdwa v98, 3, v120 dst_sel:DWORD dst_unused:UNUSED_PAD src0_sel:DWORD src1_sel:WORD_1
    ds_read_b64 v[96:97], v96
    ds_read_b64 v[98:99], v98
    v_lshlrev_b32_sdwa v100, 3, v121 dst_sel:DWORD dst_unused:UNUSED_PAD src0_sel:DWORD src1_sel:WORD_0
    v_lshlrev_b32_sdwa v102, 3, v121 dst_sel:DWORD dst_unused:UNUSED_PAD src0_sel:DWORD src1_sel:WORD_1
    ds_read_b64 v[100:101], v100
    ds_read_b64 v[102:103], v102
    s_waitcnt lgkmcnt(8)
    v_smfmac_f32_16x16x64_bf16 v[200:203], v[66:69], v[104:111], v70
    v_rcp_f32 v250, v250
    v_pk_fma_f32 v[226:227], v[226:227], v[212:213], v[214:215]
    v_rcp_f32 v251, v251
    v_pk_mul_f32 v[226:227], v[226:227], v[170:171]
    v_exp_f32 v224, v224
    v_pk_fma_f32 v[252:253], v[198:199], v[250:251], v[252:253]
    v_exp_f32 v225, v225
    v_add_f32 v252, v252, v253
    v_lshlrev_b32_sdwa v104, 3, v122 dst_sel:DWORD dst_unused:UNUSED_PAD src0_sel:DWORD src1_sel:WORD_0
    v_lshlrev_b32_sdwa v106, 3, v122 dst_sel:DWORD dst_unused:UNUSED_PAD src0_sel:DWORD src1_sel:WORD_1
    ds_read_b64 v[104:105], v104
    ds_read_b64 v[106:107], v106
    v_lshlrev_b32_sdwa v108, 3, v123 dst_sel:DWORD dst_unused:UNUSED_PAD src0_sel:DWORD src1_sel:WORD_0
    v_lshlrev_b32_sdwa v110, 3, v123 dst_sel:DWORD dst_unused:UNUSED_PAD src0_sel:DWORD src1_sel:WORD_1
    ds_read_b64 v[108:109], v108
    ds_read_b64 v[110:111], v110
    s_waitcnt lgkmcnt(8)
    v_smfmac_f32_16x16x64_bf16 v[200:203], v[66:69], v[88:95], v70
    v_exp_f32 v226, v226
    v_min_u32 v252, -2, v252
    v_pk_fma_f32 v[224:225], v[224:225], v[218:219], v[218:219]
    v_exp_f32 v227, v227
    buffer_store_dword v252, v76, s[12:15], s35 offen offset:1024 sc1
    v_rcp_f32 v224, v224
    v_pk_fma_f32 v[226:227], v[226:227], v[220:221], v[220:221]
    v_rcp_f32 v225, v225
    s_waitcnt vmcnt(10)
    v_lshlrev_b32_sdwa v88, 3, v124 dst_sel:DWORD dst_unused:UNUSED_PAD src0_sel:DWORD src1_sel:WORD_0
    v_lshlrev_b32_sdwa v90, 3, v124 dst_sel:DWORD dst_unused:UNUSED_PAD src0_sel:DWORD src1_sel:WORD_1
    ds_read_b64 v[88:89], v88
    ds_read_b64 v[90:91], v90
    v_lshlrev_b32_sdwa v92, 3, v125 dst_sel:DWORD dst_unused:UNUSED_PAD src0_sel:DWORD src1_sel:WORD_0
    v_lshlrev_b32_sdwa v94, 3, v125 dst_sel:DWORD dst_unused:UNUSED_PAD src0_sel:DWORD src1_sel:WORD_1
    ds_read_b64 v[92:93], v92
    ds_read_b64 v[94:95], v94
    s_waitcnt lgkmcnt(8)
    v_smfmac_f32_16x16x64_bf16 v[172:175], v[66:69], v[96:103], v70
    s_setprio 1
    v_rcp_f32 v226, v226
    v_pk_mul_f32 v[228:229], v[168:169], v[224:225]
    v_mfma_f32_4x4x4_16b_bf16 v[200:203], v[222:223], v[150:151], v[200:203]
    v_rcp_f32 v227, v227
    v_lshlrev_b32_sdwa v96, 3, v126 dst_sel:DWORD dst_unused:UNUSED_PAD src0_sel:DWORD src1_sel:WORD_0
    v_lshlrev_b32_sdwa v98, 3, v126 dst_sel:DWORD dst_unused:UNUSED_PAD src0_sel:DWORD src1_sel:WORD_1
    ds_read_b64 v[96:97], v96
    ds_read_b64 v[98:99], v98
    v_lshlrev_b32_sdwa v100, 3, v127 dst_sel:DWORD dst_unused:UNUSED_PAD src0_sel:DWORD src1_sel:WORD_0
    v_lshlrev_b32_sdwa v102, 3, v127 dst_sel:DWORD dst_unused:UNUSED_PAD src0_sel:DWORD src1_sel:WORD_1
    ds_read_b64 v[100:101], v100
    ds_read_b64 v[102:103], v102
    s_waitcnt lgkmcnt(8)
    v_smfmac_f32_16x16x64_bf16 v[172:175], v[66:69], v[104:111], v70
    v_pk_fma_f32 v[228:229], v[170:171], v[226:227], v[228:229]
    v_pk_mul_f32 v[230:231], v[200:201], v[200:201]
    v_add_f32 v228, v228, v229
    v_pk_fma_f32 v[230:231], v[230:231], v[212:213], v[214:215]
    v_min_u32 v228, -2, v228
    v_pk_mul_f32 v[230:231], v[230:231], v[200:201]
    buffer_store_dword v228, v76, s[12:15], s35 offen offset:768 sc1
    v_exp_f32 v230, v230
    s_waitcnt vmcnt(9)
    v_lshlrev_b32_sdwa v104, 3, v48 dst_sel:DWORD dst_unused:UNUSED_PAD src0_sel:DWORD src1_sel:WORD_0
    v_lshlrev_b32_sdwa v106, 3, v48 dst_sel:DWORD dst_unused:UNUSED_PAD src0_sel:DWORD src1_sel:WORD_1
    ds_read_b64 v[104:105], v104
    ds_read_b64 v[106:107], v106
    v_lshlrev_b32_sdwa v108, 3, v49 dst_sel:DWORD dst_unused:UNUSED_PAD src0_sel:DWORD src1_sel:WORD_0
    v_lshlrev_b32_sdwa v110, 3, v49 dst_sel:DWORD dst_unused:UNUSED_PAD src0_sel:DWORD src1_sel:WORD_1
    v_lshlrev_b32 v204, 16, v8
    v_and_b32 v205, s23, v8
    v_lshlrev_b32 v206, 16, v9
    v_and_b32 v207, s23, v9
    ds_read_b64 v[108:109], v108
    ds_read_b64 v[110:111], v110
    s_waitcnt lgkmcnt(8)
    v_smfmac_f32_16x16x64_bf16 v[204:207], v[66:69], v[88:95], v70
    v_exp_f32 v231, v231
    v_pk_mul_f32 v[232:233], v[202:203], v[202:203]
    v_mfma_f32_4x4x4_16b_bf16 v[172:175], v[222:223], v[152:153], v[172:175]
    v_pk_fma_f32 v[230:231], v[230:231], v[218:219], v[218:219]
    v_pk_fma_f32 v[232:233], v[232:233], v[212:213], v[214:215]
    v_rcp_f32 v230, v230
    v_pk_mul_f32 v[232:233], v[232:233], v[202:203]
    v_rcp_f32 v231, v231
    v_lshlrev_b32_sdwa v88, 3, v50 dst_sel:DWORD dst_unused:UNUSED_PAD src0_sel:DWORD src1_sel:WORD_0
    v_lshlrev_b32_sdwa v90, 3, v50 dst_sel:DWORD dst_unused:UNUSED_PAD src0_sel:DWORD src1_sel:WORD_1
    ds_read_b64 v[88:89], v88
    ds_read_b64 v[90:91], v90
    v_lshlrev_b32_sdwa v92, 3, v51 dst_sel:DWORD dst_unused:UNUSED_PAD src0_sel:DWORD src1_sel:WORD_0
    v_lshlrev_b32_sdwa v94, 3, v51 dst_sel:DWORD dst_unused:UNUSED_PAD src0_sel:DWORD src1_sel:WORD_1
    ds_read_b64 v[92:93], v92
    ds_read_b64 v[94:95], v94
    s_waitcnt lgkmcnt(8)
    v_smfmac_f32_16x16x64_bf16 v[204:207], v[66:69], v[96:103], v70
    v_exp_f32 v232, v232
    v_pk_mul_f32 v[234:235], v[200:201], v[230:231]
    v_pk_mul_f32 v[236:237], v[172:173], v[172:173]
    v_exp_f32 v233, v233
    v_pk_fma_f32 v[236:237], v[236:237], v[212:213], v[214:215]
    v_pk_mul_f32 v[238:239], v[174:175], v[174:175]
    v_pk_fma_f32 v[232:233], v[232:233], v[220:221], v[220:221]
    v_pk_mul_f32 v[236:237], v[236:237], v[172:173]
    s_waitcnt vmcnt(7)
    v_lshlrev_b32_sdwa v96, 3, v40 dst_sel:DWORD dst_unused:UNUSED_PAD src0_sel:DWORD src1_sel:WORD_0
    v_lshlrev_b32_sdwa v98, 3, v40 dst_sel:DWORD dst_unused:UNUSED_PAD src0_sel:DWORD src1_sel:WORD_1
    ds_read_b64 v[96:97], v96
    ds_read_b64 v[98:99], v98
    v_lshlrev_b32_sdwa v100, 3, v41 dst_sel:DWORD dst_unused:UNUSED_PAD src0_sel:DWORD src1_sel:WORD_0
    v_lshlrev_b32_sdwa v102, 3, v41 dst_sel:DWORD dst_unused:UNUSED_PAD src0_sel:DWORD src1_sel:WORD_1
    ds_read_b64 v[100:101], v100
    ds_read_b64 v[102:103], v102
    s_waitcnt lgkmcnt(8)
    v_smfmac_f32_16x16x64_bf16 v[204:207], v[66:69], v[104:111], v70
    buffer_load_dword v72, v76, s[52:55], 0 offen offset:32 sc1
    buffer_load_short_d16_hi v73, v79, s[56:59], 0 offen
    buffer_load_ushort v81, v78, s[60:63], s68 offen
    buffer_load_dword v82, v79, s[12:15], s69 offen sc1
    v_rcp_f32 v232, v232
    v_pk_fma_f32 v[238:239], v[238:239], v[212:213], v[214:215]
    v_rcp_f32 v233, v233
    v_pk_mul_f32 v[238:239], v[238:239], v[174:175]
    v_lshlrev_b32_sdwa v104, 3, v42 dst_sel:DWORD dst_unused:UNUSED_PAD src0_sel:DWORD src1_sel:WORD_0
    v_lshlrev_b32_sdwa v106, 3, v42 dst_sel:DWORD dst_unused:UNUSED_PAD src0_sel:DWORD src1_sel:WORD_1
    ds_read_b64 v[104:105], v104
    ds_read_b64 v[106:107], v106
    v_lshlrev_b32_sdwa v108, 3, v43 dst_sel:DWORD dst_unused:UNUSED_PAD src0_sel:DWORD src1_sel:WORD_0
    v_lshlrev_b32_sdwa v110, 3, v43 dst_sel:DWORD dst_unused:UNUSED_PAD src0_sel:DWORD src1_sel:WORD_1
    ds_read_b64 v[108:109], v108
    ds_read_b64 v[110:111], v110
    s_waitcnt lgkmcnt(8)
    v_smfmac_f32_16x16x64_bf16 v[204:207], v[66:69], v[88:95], v70
    v_exp_f32 v236, v236
    v_pk_fma_f32 v[234:235], v[202:203], v[232:233], v[234:235]
    v_exp_f32 v237, v237
    v_add_f32 v234, v234, v235
    v_exp_f32 v238, v238
    v_min_u32 v234, -2, v234
    v_pk_fma_f32 v[236:237], v[236:237], v[218:219], v[218:219]
    v_exp_f32 v239, v239
    s_waitcnt vmcnt(9)
    v_lshlrev_b32_sdwa v88, 3, v116 dst_sel:DWORD dst_unused:UNUSED_PAD src0_sel:DWORD src1_sel:WORD_0
    v_lshlrev_b32_sdwa v90, 3, v116 dst_sel:DWORD dst_unused:UNUSED_PAD src0_sel:DWORD src1_sel:WORD_1
    ds_read_b64 v[88:89], v88
    ds_read_b64 v[90:91], v90
    v_lshlrev_b32_sdwa v92, 3, v117 dst_sel:DWORD dst_unused:UNUSED_PAD src0_sel:DWORD src1_sel:WORD_0
    v_lshlrev_b32_sdwa v94, 3, v117 dst_sel:DWORD dst_unused:UNUSED_PAD src0_sel:DWORD src1_sel:WORD_1
    ds_read_b64 v[92:93], v92
    ds_read_b64 v[94:95], v94
    s_waitcnt lgkmcnt(8)
    v_smfmac_f32_16x16x64_bf16 v[176:179], v[66:69], v[96:103], v70
    v_rcp_f32 v236, v236
    buffer_store_dword v234, v76, s[12:15], s35 offen offset:512 sc1
    v_pk_fma_f32 v[238:239], v[238:239], v[220:221], v[220:221]
    v_rcp_f32 v237, v237
    v_mfma_f32_4x4x4_16b_bf16 v[204:207], v[222:223], v[154:155], v[204:207]
    v_rcp_f32 v238, v238
    v_pk_mul_f32 v[240:241], v[172:173], v[236:237]
    v_rcp_f32 v239, v239
    v_lshlrev_b32_sdwa v96, 3, v118 dst_sel:DWORD dst_unused:UNUSED_PAD src0_sel:DWORD src1_sel:WORD_0
    v_lshlrev_b32_sdwa v98, 3, v118 dst_sel:DWORD dst_unused:UNUSED_PAD src0_sel:DWORD src1_sel:WORD_1
    ds_read_b64 v[96:97], v96
    ds_read_b64 v[98:99], v98
    v_lshlrev_b32_sdwa v100, 3, v119 dst_sel:DWORD dst_unused:UNUSED_PAD src0_sel:DWORD src1_sel:WORD_0
    v_lshlrev_b32_sdwa v102, 3, v119 dst_sel:DWORD dst_unused:UNUSED_PAD src0_sel:DWORD src1_sel:WORD_1
    ds_read_b64 v[100:101], v100
    ds_read_b64 v[102:103], v102
    s_waitcnt lgkmcnt(8)
    v_smfmac_f32_16x16x64_bf16 v[176:179], v[66:69], v[104:111], v70
    v_pk_fma_f32 v[240:241], v[174:175], v[238:239], v[240:241]
    v_pk_mul_f32 v[242:243], v[204:205], v[204:205]
    v_add_f32 v240, v240, v241
    v_pk_fma_f32 v[242:243], v[242:243], v[212:213], v[214:215]
    v_min_u32 v240, -2, v240
    v_pk_mul_f32 v[242:243], v[242:243], v[204:205]
    buffer_store_dword v240, v76, s[12:15], s35 offen offset:256 sc1
    v_exp_f32 v242, v242
    s_waitcnt vmcnt(9)
    v_lshlrev_b32_sdwa v104, 3, v36 dst_sel:DWORD dst_unused:UNUSED_PAD src0_sel:DWORD src1_sel:WORD_0
    v_lshlrev_b32_sdwa v106, 3, v36 dst_sel:DWORD dst_unused:UNUSED_PAD src0_sel:DWORD src1_sel:WORD_1
    ds_read_b64 v[104:105], v104
    ds_read_b64 v[106:107], v106
    v_lshlrev_b32_sdwa v108, 3, v37 dst_sel:DWORD dst_unused:UNUSED_PAD src0_sel:DWORD src1_sel:WORD_0
    v_lshlrev_b32_sdwa v110, 3, v37 dst_sel:DWORD dst_unused:UNUSED_PAD src0_sel:DWORD src1_sel:WORD_1
    v_lshlrev_b32 v208, 16, v4
    v_and_b32 v209, s23, v4
    v_lshlrev_b32 v210, 16, v5
    v_and_b32 v211, s23, v5
    ds_read_b64 v[108:109], v108
    ds_read_b64 v[110:111], v110
    s_waitcnt lgkmcnt(8)
    v_smfmac_f32_16x16x64_bf16 v[208:211], v[66:69], v[88:95], v70
    s_setprio 0
    v_exp_f32 v243, v243
    v_pk_mul_f32 v[244:245], v[206:207], v[206:207]
    v_mfma_f32_4x4x4_16b_bf16 v[176:179], v[222:223], v[156:157], v[176:179]
    v_pk_fma_f32 v[242:243], v[242:243], v[218:219], v[218:219]
    v_pk_fma_f32 v[244:245], v[244:245], v[212:213], v[214:215]
    v_rcp_f32 v242, v242
    v_pk_mul_f32 v[244:245], v[244:245], v[206:207]
    v_rcp_f32 v243, v243
    v_lshlrev_b32_sdwa v88, 3, v38 dst_sel:DWORD dst_unused:UNUSED_PAD src0_sel:DWORD src1_sel:WORD_0
    v_lshlrev_b32_sdwa v90, 3, v38 dst_sel:DWORD dst_unused:UNUSED_PAD src0_sel:DWORD src1_sel:WORD_1
    ds_read_b64 v[88:89], v88
    ds_read_b64 v[90:91], v90
    v_lshlrev_b32_sdwa v92, 3, v39 dst_sel:DWORD dst_unused:UNUSED_PAD src0_sel:DWORD src1_sel:WORD_0
    v_lshlrev_b32_sdwa v94, 3, v39 dst_sel:DWORD dst_unused:UNUSED_PAD src0_sel:DWORD src1_sel:WORD_1
    ds_read_b64 v[92:93], v92
    ds_read_b64 v[94:95], v94
    s_waitcnt lgkmcnt(8)
    v_smfmac_f32_16x16x64_bf16 v[208:211], v[66:69], v[96:103], v70
    v_exp_f32 v244, v244
    v_pk_mul_f32 v[246:247], v[204:205], v[242:243]
    v_pk_mul_f32 v[248:249], v[176:177], v[176:177]
    v_exp_f32 v245, v245
    v_pk_fma_f32 v[248:249], v[248:249], v[212:213], v[214:215]
    v_pk_mul_f32 v[250:251], v[178:179], v[178:179]
    v_pk_fma_f32 v[244:245], v[244:245], v[220:221], v[220:221]
    v_pk_mul_f32 v[248:249], v[248:249], v[176:177]
    s_waitcnt lgkmcnt(4)
    v_smfmac_f32_16x16x64_bf16 v[208:211], v[66:69], v[104:111], v70
    v_rcp_f32 v244, v244
    v_pk_fma_f32 v[250:251], v[250:251], v[212:213], v[214:215]
    v_rcp_f32 v245, v245
    v_pk_mul_f32 v[250:251], v[250:251], v[178:179]
    v_exp_f32 v248, v248
    v_pk_fma_f32 v[246:247], v[206:207], v[244:245], v[246:247]
    v_exp_f32 v249, v249
    v_add_f32 v246, v246, v247
    s_waitcnt lgkmcnt(0)
    v_smfmac_f32_16x16x64_bf16 v[208:211], v[66:69], v[88:95], v70
    v_exp_f32 v250, v250
    v_min_u32 v246, -2, v246
    v_pk_fma_f32 v[248:249], v[248:249], v[218:219], v[218:219]
    v_exp_f32 v251, v251
    buffer_store_dword v246, v76, s[12:15], s35 offen offset:0 sc1
    v_rcp_f32 v248, v248
    v_pk_fma_f32 v[250:251], v[250:251], v[220:221], v[220:221]
    v_rcp_f32 v249, v249
    v_mfma_f32_4x4x4_16b_bf16 v[208:211], v[222:223], v[158:159], v[208:211]
    v_rcp_f32 v250, v250
    v_pk_mul_f32 v[252:253], v[176:177], v[248:249]
    v_rcp_f32 v251, v251
    s_nop 0
    s_nop 0
    v_pk_fma_f32 v[252:253], v[178:179], v[250:251], v[252:253]
    v_pk_mul_f32 v[224:225], v[208:209], v[208:209]
    v_add_f32 v252, v252, v253
    v_pk_fma_f32 v[224:225], v[224:225], v[212:213], v[214:215]
    v_min_u32 v252, -2, v252
    v_pk_mul_f32 v[224:225], v[224:225], v[208:209]
    buffer_store_dword v252, v76, s[12:15], s35 offen offset:3840 sc1
    v_exp_f32 v224, v224
    v_pk_mul_f32 v[226:227], v[210:211], v[210:211]
    v_exp_f32 v225, v225
    v_pk_fma_f32 v[226:227], v[226:227], v[212:213], v[214:215]
    s_nop 0
    v_pk_fma_f32 v[224:225], v[224:225], v[218:219], v[218:219]
    v_pk_mul_f32 v[226:227], v[226:227], v[210:211]
    v_rcp_f32 v224, v224
    v_rcp_f32 v225, v225
    v_exp_f32 v226, v226
    v_exp_f32 v227, v227
    v_pk_mul_f32 v[228:229], v[208:209], v[224:225]
    s_nop 0
    v_pk_fma_f32 v[226:227], v[226:227], v[220:221], v[220:221]
    s_nop 0
    v_rcp_f32 v226, v226
    v_rcp_f32 v227, v227
    s_nop 0
    s_nop 0
    v_pk_fma_f32 v[228:229], v[210:211], v[226:227], v[228:229]
    s_nop 0
    v_add_f32 v228, v228, v229
    s_nop 0
    v_min_u32 v228, -2, v228
    s_nop 0
    buffer_store_dword v228, v76, s[12:15], s35 offen offset:3584 sc1
    s_waitcnt vmcnt(5)

    v_cmp_ne_u32 vcc, 128, v72
    s_and_b32 s44, vcc_hi, 0x1
    s_and_b32 s45, vcc_lo, 0x1
    s_or_b32 s45, s45, s44
    s_cbranch_scc1 k1_kernel_rslow

k1_kernel_rjob:

    s_lshl_b32 s67, s64, 8
    s_add_u32 s68, s67, 29360128
    s_add_u32 s69, s68, 65536
    s_add_u32 s67, s67, 20971520

k1_kernel_rgrp:

    s_add_u32 s70, s67, s65
    s_add_u32 s71, s70, 262144
    s_add_u32 s72, s70, 524288
    s_add_u32 s73, s70, 786432
    s_add_u32 s65, s65, 1048576

    buffer_load_dwordx4 v[0:3], v74, s[12:15], s70 offen sc1
    buffer_load_dwordx4 v[4:7], v74, s[12:15], s71 offen sc1
    buffer_load_dwordx4 v[8:11], v74, s[12:15], s72 offen sc1
    buffer_load_dwordx4 v[12:15], v74, s[12:15], s73 offen sc1
    buffer_load_dword v16, v75, s[12:15], s68 offen sc1
    buffer_load_dword v17, v75, s[12:15], s69 offen sc1
    s_branch k1_kernel_rchk
k1_kernel_rpoll:
    s_mov_b64 exec, s[74:75]
    s_cbranch_execz k1_kernel_rsk0
    buffer_load_dwordx4 v[0:3], v74, s[12:15], s70 offen sc1
k1_kernel_rsk0:
    s_mov_b64 exec, s[76:77]
    s_cbranch_execz k1_kernel_rsk1
    buffer_load_dwordx4 v[4:7], v74, s[12:15], s71 offen sc1
k1_kernel_rsk1:
    s_mov_b64 exec, s[78:79]
    s_cbranch_execz k1_kernel_rsk2
    buffer_load_dwordx4 v[8:11], v74, s[12:15], s72 offen sc1
k1_kernel_rsk2:
    s_mov_b64 exec, s[80:81]
    s_cbranch_execz k1_kernel_rsk3
    buffer_load_dwordx4 v[12:15], v74, s[12:15], s73 offen sc1
k1_kernel_rsk3:
    s_mov_b64 exec, -1
k1_kernel_rchk:
    s_waitcnt vmcnt(0)
k1_kernel_rchk0:
    v_max3_u32 v20, v0, v1, v2
    v_max3_u32 v21, v4, v5, v6
    v_max3_u32 v22, v8, v9, v10
    v_max3_u32 v23, v12, v13, v14
    v_max_u32 v20, v20, v3
    v_max_u32 v21, v21, v7
    v_max_u32 v22, v22, v11
    v_max_u32 v23, v23, v15
    v_cmp_eq_u32 s[74:75], -1, v20
    v_cmp_eq_u32 s[76:77], -1, v21
    v_cmp_eq_u32 s[78:79], -1, v22
    v_cmp_eq_u32 s[80:81], -1, v23

    v_pk_add_f32 v[26:27], v[0:1], v[4:5]
    v_pk_add_f32 v[28:29], v[2:3], v[6:7]
    v_pk_add_f32 v[30:31], v[8:9], v[12:13]
    v_pk_add_f32 v[32:33], v[10:11], v[14:15]
    s_or_b64 s[82:83], s[74:75], s[76:77]
    s_or_b64 s[84:85], s[78:79], s[80:81]
    v_pk_add_f32 v[26:27], v[26:27], v[30:31]
    v_pk_add_f32 v[28:29], v[28:29], v[32:33]
    s_or_b64 s[82:83], s[82:83], s[84:85]
    s_cbranch_scc1 k1_kernel_rpoll
    v_permlane32_swap_b32 v26, v28
    v_permlane32_swap_b32 v27, v29
    s_cmp_lt_u32 s65, s66
    s_nop 0
    v_pk_add_f32 v[26:27], v[26:27], v[28:29]
    s_nop 1
    v_permlane16_swap_b32 v26, v27
    s_nop 1
    v_add_f32 v26, v26, v27
    v_add_f32 v79, v79, v26
    s_cbranch_scc1 k1_kernel_rgrp
    s_cmp_lg_u32 s43, 0
    s_cbranch_scc1 k1_kernel_rpn
    ds_write_b32 v77, v79
    v_add_u32 v21, 0x10000, v77
    s_cmp_lg_u32 s3, 0
    s_waitcnt lgkmcnt(0)
    s_barrier
    s_cbranch_scc1 k1_kernel_rend

    ds_read2st64_b32 v[40:41], v77 offset0:0 offset1:64
    ds_read2st64_b32 v[42:43], v77 offset0:128 offset1:192
    ds_read2st64_b32 v[44:45], v21 offset0:0 offset1:64
    ds_read2st64_b32 v[46:47], v21 offset0:128 offset1:192

    s_waitcnt lgkmcnt(2)
    v_pk_add_f32 v[26:27], v[40:41], v[42:43]
    v_max3_u32 v20, v41, v42, v43
    s_waitcnt lgkmcnt(0)
    v_pk_add_f32 v[28:29], v[44:45], v[46:47]
    v_max3_u32 v20, v20, v44, v45
    v_pk_add_f32 v[26:27], v[26:27], v[28:29]
    v_max3_u32 v20, v20, v46, v47
    v_add_f32 v79, v26, v27
    v_cmp_eq_u32 vcc, -1, v20
    s_cbranch_vccnz k1_kernel_rnext

k1_kernel_rpn:

    v_max_u32 v20, v16, v17
    v_add_f32 v21, v16, v17
    v_cmp_eq_u32 vcc, -1, v20
    v_cvt_pk_bf16_f32 v21, v79, v21
    s_cbranch_vccnz k1_kernel_rpn2
    v_lshlrev_b32 v22, 16, v21
    v_and_b32 v21, 0xffff0000, v21
    v_add_f32 v22, v22, v73
    v_cvt_pk_bf16_f32 v22, v22, v22
    v_lshlrev_b32 v22, 16, v22
    v_add_f32 v22, v22, v21
    s_lshl_b32 s45, s64, 7
    v_cvt_pk_bf16_f32 v22, v22, v22
    buffer_store_short v22, v78, s[60:63], s45 offen

k1_kernel_rnext:

    v_cmp_ne_u32 vcc, 0, v72
    s_and_b32 s45, vcc_lo, 0xff00
    s_cbranch_scc1 k1_kernel_rmore

k1_kernel_rend:
    s_endpgm
k1_kernel_rpn2:
    buffer_load_dword v16, v75, s[12:15], s68 offen sc1
    buffer_load_dword v17, v75, s[12:15], s69 offen sc1
    s_waitcnt vmcnt(0)
    s_branch k1_kernel_rpn
k1_kernel_rmore:

    s_ff1_i32_b32 s45, s45
    s_mov_b32 s43, 1
    s_mov_b32 s65, 0
    s_mov_b32 s66, 8388608
    v_readlane_b32 s44, v72, s45
    v_mov_b32 v79, 0
    s_mov_b32 m0, s45
    s_ff1_i32_b32 s64, s44
    s_bitset0_b32 s44, s64
    s_sub_u32 s45, s45, 8
    s_lshl_b32 s45, s45, 5
    s_add_u32 s64, s64, s45
    v_writelane_b32 v72, s44, m0
    s_branch k1_kernel_rjob

k1_kernel_rslow:
    s_lshl_b32 s65, s3, 20
    buffer_load_dword v72, v76, s[52:55], 0 offen offset:32 sc1
    s_waitcnt vmcnt(0)

    v_cmp_ne_u32 vcc, 128, v72
    s_and_b32 s44, vcc_hi, 0x1
    s_and_b32 s45, vcc_lo, 0x1
    s_or_b32 s45, s45, s44
    s_cbranch_scc0 k1_kernel_rjob

    s_add_u32 s42, s42, 1
    s_cmp_lt_u32 s42, 200
    s_cbranch_scc1 k1_kernel_rslow
    s_lshl_b32 s44, 1, s64
    s_lshr_b32 s45, s64, 5
    s_lshl_b32 s45, s45, 2
    v_mov_b32 v20, s44
    s_mov_b64 exec, 1
    buffer_atomic_or v20, v76, s[52:55], s45 offen offset:64 sc0
    s_mov_b64 exec, -1
    s_waitcnt vmcnt(0)
    buffer_load_dword v72, v76, s[52:55], 0 offen offset:32 sc1
    s_waitcnt vmcnt(0)

    v_cmp_ne_u32 vcc, 128, v72
    s_and_b32 s44, vcc_hi, 0x1
    s_and_b32 s45, vcc_lo, 0x1
    s_or_b32 s45, s45, s44
    s_cbranch_scc0 k1_kernel_rjob

    v_mov_b32 v20, -1
    ds_write_b32 v77, v20
    s_waitcnt lgkmcnt(0)
    s_endpgm

k1_kernel_xw0:

    buffer_load_dword v35, off, s[12:15], s47 sc1
    s_waitcnt vmcnt(0)
    v_readfirstlane_b32 s44, v35
    s_cmp_le_u32 s44, 0
    s_cbranch_scc1 k1_kernel_xw0
    s_branch k1_kernel_xb0

k1_kernel_xw1:

    buffer_load_dword v35, off, s[12:15], s47 sc1
    s_waitcnt vmcnt(0)
    v_readfirstlane_b32 s44, v35
    s_cmp_le_u32 s44, 1
    s_cbranch_scc1 k1_kernel_xw1
    s_branch k1_kernel_xb1

k1_kernel_solo1:
    s_mov_b32 s48, 1
    s_add_u32 s16, s16, 33554432
    s_add_u32 s46, s46, 33554432
    s_mov_b32 s18, s16
    s_mov_b32 s47, s46
    s_xor_b32 s49, s34, 1
    s_branch k1_kernel_solo3
k1_kernel_solo2:
    s_mov_b32 s48, 2
    s_waitcnt vmcnt(0)
    v_mov_b32 v0, 2
    buffer_store_dword v0, off, s[12:15], s46 sc1

    s_lshl_b32 s16, s2, 3
    s_add_u32 s16, s16, s3
    s_lshl_b32 s46, s16, 7
    s_mul_i32 s16, s16, 8448
    s_add_u32 s46, s46, 30408704
    s_add_u32 s16, s16, 67108864

    s_mov_b32 s49, s34
k1_kernel_solo3:
    s_load_dwordx2 s[4:5], s[0:1], 8
    s_mov_b32 s6, 256000
    s_mov_b32 s7, 0x00020000

    s_mul_i32 s21, s33, 102656
    s_mul_i32 s35, s49, 49152
    s_sub_u32 s22, 53248, s35
    s_add_u32 s21, s21, s35
    s_lshl_b32 s35, s50, 11
    s_xor_b32 s19, s35, 2048
    s_add_u32 s19, s19, s21
    s_add_u32 s21, s21, s35
    s_mul_i32 s20, s49, 1703936
    s_add_u32 s20, s20, 16777216
    s_lshl_b32 s35, s3, 14
    s_add_u32 s20, s20, s35

    s_waitcnt vmcnt(0) lgkmcnt(0)
    s_and_b32 s5, s5, 0xffff
    s_barrier
    v_bfe_u32 v1, v71, 4, 4
    v_lshrrev_b32 v2, 8, v71
    v_lshlrev_b32 v65, 8, v1
    v_lshl_add_u32 v65, v2, 4, v65
    v_and_b32 v70, 0x0fffffff, v70
    v_lshrrev_b32 v64, 16, v70
    v_lshlrev_b32 v64, 3, v64
    s_lshl_b32 s44, s3, 15
    s_lshl_b32 s45, s50, 7
    s_add_u32 s44, s44, s45
    s_xor_b32 s45, s44, 128

    buffer_load_dwordx4 v[128:131], v65, s[4:7], s44 offen offset:0
    buffer_load_dwordx4 v[132:135], v65, s[4:7], s44 offen offset:64
    buffer_load_dwordx4 v[136:139], v65, s[4:7], s45 offen offset:0
    buffer_load_dwordx4 v[140:143], v65, s[4:7], s45 offen offset:64
    s_add_u32 s44, s44, 4096
    s_add_u32 s45, s45, 4096
    buffer_load_dwordx4 v[144:147], v65, s[4:7], s44 offen offset:0
    buffer_load_dwordx4 v[148:151], v65, s[4:7], s44 offen offset:64
    buffer_load_dwordx4 v[152:155], v65, s[4:7], s45 offen offset:0
    buffer_load_dwordx4 v[156:159], v65, s[4:7], s45 offen offset:64
    s_add_u32 s44, s44, 4096
    s_add_u32 s45, s45, 4096
    buffer_load_dwordx4 v[160:163], v65, s[4:7], s44 offen offset:0
    buffer_load_dwordx4 v[164:167], v65, s[4:7], s44 offen offset:64
    buffer_load_dwordx4 v[168:171], v65, s[4:7], s45 offen offset:0
    buffer_load_dwordx4 v[172:175], v65, s[4:7], s45 offen offset:64
    s_add_u32 s44, s44, 4096
    s_add_u32 s45, s45, 4096
    buffer_load_dwordx4 v[176:179], v65, s[4:7], s44 offen offset:0
    buffer_load_dwordx4 v[180:183], v65, s[4:7], s44 offen offset:64
    buffer_load_dwordx4 v[184:187], v65, s[4:7], s45 offen offset:0
    buffer_load_dwordx4 v[188:191], v65, s[4:7], s45 offen offset:64
    s_add_u32 s44, s44, 4096
    s_add_u32 s45, s45, 4096
    buffer_load_dwordx4 v[192:195], v65, s[4:7], s44 offen offset:0
    buffer_load_dwordx4 v[196:199], v65, s[4:7], s44 offen offset:64
    buffer_load_dwordx4 v[200:203], v65, s[4:7], s45 offen offset:0
    buffer_load_dwordx4 v[204:207], v65, s[4:7], s45 offen offset:64
    s_add_u32 s44, s44, 4096
    s_add_u32 s45, s45, 4096
    buffer_load_dwordx4 v[208:211], v65, s[4:7], s44 offen offset:0
    buffer_load_dwordx4 v[212:215], v65, s[4:7], s44 offen offset:64
    buffer_load_dwordx4 v[216:219], v65, s[4:7], s45 offen offset:0
    buffer_load_dwordx4 v[220:223], v65, s[4:7], s45 offen offset:64
    s_add_u32 s44, s44, 4096
    s_add_u32 s45, s45, 4096
    buffer_load_dwordx4 v[224:227], v65, s[4:7], s44 offen offset:0
    buffer_load_dwordx4 v[228:231], v65, s[4:7], s44 offen offset:64
    buffer_load_dwordx4 v[232:235], v65, s[4:7], s45 offen offset:0
    buffer_load_dwordx4 v[236:239], v65, s[4:7], s45 offen offset:64
    s_add_u32 s44, s44, 4096
    s_add_u32 s45, s45, 4096
    buffer_load_dwordx4 v[240:243], v65, s[4:7], s44 offen offset:0
    buffer_load_dwordx4 v[244:247], v65, s[4:7], s44 offen offset:64
    buffer_load_dwordx4 v[248:251], v65, s[4:7], s45 offen offset:0
    buffer_load_dwordx4 v[252:255], v65, s[4:7], s45 offen offset:64
    s_add_u32 s44, s44, 4096
    s_add_u32 s45, s45, 4096
    buffer_load_dwordx4 v[0:3], v71, s[12:15], s21 offen offset:0
    buffer_load_dwordx4 v[4:7], v71, s[12:15], s21 offen offset:1024
    buffer_load_dwordx4 v[8:11], v71, s[12:15], s19 offen offset:0
    buffer_load_dwordx4 v[12:15], v71, s[12:15], s19 offen offset:1024
    s_add_u32 s21, s21, 4096
    s_add_u32 s19, s19, 4096
    buffer_load_dwordx4 v[16:19], v71, s[12:15], s21 offen offset:0
    buffer_load_dwordx4 v[20:23], v71, s[12:15], s21 offen offset:1024
    buffer_load_dwordx4 v[24:27], v71, s[12:15], s19 offen offset:0
    buffer_load_dwordx4 v[28:31], v71, s[12:15], s19 offen offset:1024
    s_add_u32 s21, s21, 4096
    s_add_u32 s19, s19, 4096
    buffer_load_dwordx4 v[32:35], v71, s[12:15], s21 offen offset:0
    buffer_load_dwordx4 v[36:39], v71, s[12:15], s21 offen offset:1024
    buffer_load_dwordx4 v[40:43], v71, s[12:15], s19 offen offset:0
    buffer_load_dwordx4 v[44:47], v71, s[12:15], s19 offen offset:1024
    s_add_u32 s21, s21, 4096
    s_add_u32 s19, s19, 4096
    buffer_load_dwordx4 v[72:75], v71, s[12:15], s21 offen offset:0
    buffer_load_dwordx4 v[76:79], v71, s[12:15], s21 offen offset:1024
    buffer_load_dwordx4 v[80:83], v71, s[12:15], s19 offen offset:0
    buffer_load_dwordx4 v[84:87], v71, s[12:15], s19 offen offset:1024
    s_add_u32 s21, s21, 4096
    s_add_u32 s19, s19, 4096
    buffer_load_dwordx2 v[116:117], v71, s[12:15], s20 offen offset:0 sc1
    buffer_load_dwordx2 v[118:119], v71, s[12:15], s20 offen offset:1024 sc1
    buffer_load_dwordx2 v[120:121], v71, s[12:15], s20 offen offset:2048 sc1
    buffer_load_dwordx2 v[122:123], v71, s[12:15], s20 offen offset:3072 sc1
    s_add_u32 s20, s20, 4096
    buffer_load_dwordx2 v[124:125], v71, s[12:15], s20 offen offset:0 sc1
    buffer_load_dwordx2 v[126:127], v71, s[12:15], s20 offen offset:1024 sc1
    s_waitcnt vmcnt(0)
    v_mfma_f32_16x16x32_bf16 v[96:99], v[0:3], v[128:131], 0
    v_mfma_f32_16x16x32_bf16 v[100:103], v[0:3], v[144:147], 0
    v_mfma_f32_16x16x32_bf16 v[96:99], v[4:7], v[132:135], v[96:99]
    v_mfma_f32_16x16x32_bf16 v[100:103], v[4:7], v[148:151], v[100:103]
    v_mfma_f32_16x16x32_bf16 v[96:99], v[8:11], v[136:139], v[96:99]
    v_mfma_f32_16x16x32_bf16 v[100:103], v[8:11], v[152:155], v[100:103]
    v_mfma_f32_16x16x32_bf16 v[96:99], v[12:15], v[140:143], v[96:99]
    v_mfma_f32_16x16x32_bf16 v[100:103], v[12:15], v[156:159], v[100:103]
    v_mfma_f32_16x16x32_bf16 v[104:107], v[0:3], v[160:163], 0
    v_mfma_f32_16x16x32_bf16 v[108:111], v[0:3], v[176:179], 0
    v_mfma_f32_16x16x32_bf16 v[104:107], v[4:7], v[164:167], v[104:107]
    v_cvt_pk_bf16_f32 v96, v96, v97
    v_mfma_f32_16x16x32_bf16 v[108:111], v[4:7], v[180:183], v[108:111]
    v_cvt_pk_bf16_f32 v97, v98, v99
    v_mfma_f32_16x16x32_bf16 v[104:107], v[8:11], v[168:171], v[104:107]
    ds_write_b64 v64, v[96:97] offset:0
    v_mfma_f32_16x16x32_bf16 v[108:111], v[8:11], v[184:187], v[108:111]
    v_cvt_pk_bf16_f32 v100, v100, v101
    v_mfma_f32_16x16x32_bf16 v[104:107], v[12:15], v[172:175], v[104:107]
    v_cvt_pk_bf16_f32 v101, v102, v103
    v_mfma_f32_16x16x32_bf16 v[108:111], v[12:15], v[188:191], v[108:111]
    ds_write_b64 v64, v[100:101] offset:128
    v_mfma_f32_16x16x32_bf16 v[88:91], v[0:3], v[192:195], 0
    v_mfma_f32_16x16x32_bf16 v[92:95], v[0:3], v[208:211], 0
    v_mfma_f32_16x16x32_bf16 v[88:91], v[4:7], v[196:199], v[88:91]
    v_cvt_pk_bf16_f32 v104, v104, v105
    v_mfma_f32_16x16x32_bf16 v[92:95], v[4:7], v[212:215], v[92:95]
    v_cvt_pk_bf16_f32 v105, v106, v107
    v_mfma_f32_16x16x32_bf16 v[88:91], v[8:11], v[200:203], v[88:91]
    ds_write_b64 v64, v[104:105] offset:256
    v_mfma_f32_16x16x32_bf16 v[92:95], v[8:11], v[216:219], v[92:95]
    v_cvt_pk_bf16_f32 v108, v108, v109
    v_mfma_f32_16x16x32_bf16 v[88:91], v[12:15], v[204:207], v[88:91]
    v_cvt_pk_bf16_f32 v109, v110, v111
    v_mfma_f32_16x16x32_bf16 v[92:95], v[12:15], v[220:223], v[92:95]
    ds_write_b64 v64, v[108:109] offset:384
    v_mfma_f32_16x16x32_bf16 v[96:99], v[0:3], v[224:227], 0
    v_mfma_f32_16x16x32_bf16 v[100:103], v[0:3], v[240:243], 0
    v_mfma_f32_16x16x32_bf16 v[96:99], v[4:7], v[228:231], v[96:99]
    v_cvt_pk_bf16_f32 v88, v88, v89
    v_mfma_f32_16x16x32_bf16 v[100:103], v[4:7], v[244:247], v[100:103]
    v_cvt_pk_bf16_f32 v89, v90, v91
    v_mfma_f32_16x16x32_bf16 v[96:99], v[8:11], v[232:235], v[96:99]
    ds_write_b64 v64, v[88:89] offset:512
    v_mfma_f32_16x16x32_bf16 v[100:103], v[8:11], v[248:251], v[100:103]
    v_cvt_pk_bf16_f32 v92, v92, v93
    v_mfma_f32_16x16x32_bf16 v[96:99], v[12:15], v[236:239], v[96:99]
    v_cvt_pk_bf16_f32 v93, v94, v95
    v_mfma_f32_16x16x32_bf16 v[100:103], v[12:15], v[252:255], v[100:103]
    ds_write_b64 v64, v[92:93] offset:640
    s_nop 7
    v_cvt_pk_bf16_f32 v96, v96, v97
    v_cvt_pk_bf16_f32 v97, v98, v99
    ds_write_b64 v64, v[96:97] offset:768
    v_cvt_pk_bf16_f32 v100, v100, v101
    v_cvt_pk_bf16_f32 v101, v102, v103
    ds_write_b64 v64, v[100:101] offset:896
    v_add_u32 v64, 0x8000, v64
    v_mfma_f32_16x16x32_bf16 v[104:107], v[16:19], v[128:131], 0
    v_mfma_f32_16x16x32_bf16 v[108:111], v[16:19], v[144:147], 0
    v_mfma_f32_16x16x32_bf16 v[104:107], v[20:23], v[132:135], v[104:107]
    v_mfma_f32_16x16x32_bf16 v[108:111], v[20:23], v[148:151], v[108:111]
    v_mfma_f32_16x16x32_bf16 v[104:107], v[24:27], v[136:139], v[104:107]
    v_mfma_f32_16x16x32_bf16 v[108:111], v[24:27], v[152:155], v[108:111]
    v_mfma_f32_16x16x32_bf16 v[104:107], v[28:31], v[140:143], v[104:107]
    v_mfma_f32_16x16x32_bf16 v[108:111], v[28:31], v[156:159], v[108:111]
    v_mfma_f32_16x16x32_bf16 v[88:91], v[16:19], v[160:163], 0
    v_mfma_f32_16x16x32_bf16 v[92:95], v[16:19], v[176:179], 0
    v_mfma_f32_16x16x32_bf16 v[88:91], v[20:23], v[164:167], v[88:91]
    v_cvt_pk_bf16_f32 v104, v104, v105
    v_mfma_f32_16x16x32_bf16 v[92:95], v[20:23], v[180:183], v[92:95]
    v_cvt_pk_bf16_f32 v105, v106, v107
    v_mfma_f32_16x16x32_bf16 v[88:91], v[24:27], v[168:171], v[88:91]
    ds_write_b64 v64, v[104:105] offset:0
    v_mfma_f32_16x16x32_bf16 v[92:95], v[24:27], v[184:187], v[92:95]
    v_cvt_pk_bf16_f32 v108, v108, v109
    v_mfma_f32_16x16x32_bf16 v[88:91], v[28:31], v[172:175], v[88:91]
    v_cvt_pk_bf16_f32 v109, v110, v111
    v_mfma_f32_16x16x32_bf16 v[92:95], v[28:31], v[188:191], v[92:95]
    ds_write_b64 v64, v[108:109] offset:128
    v_mfma_f32_16x16x32_bf16 v[96:99], v[16:19], v[192:195], 0
    v_mfma_f32_16x16x32_bf16 v[100:103], v[16:19], v[208:211], 0
    v_mfma_f32_16x16x32_bf16 v[96:99], v[20:23], v[196:199], v[96:99]
    v_cvt_pk_bf16_f32 v88, v88, v89
    v_mfma_f32_16x16x32_bf16 v[100:103], v[20:23], v[212:215], v[100:103]
    v_cvt_pk_bf16_f32 v89, v90, v91
    v_mfma_f32_16x16x32_bf16 v[96:99], v[24:27], v[200:203], v[96:99]
    ds_write_b64 v64, v[88:89] offset:256
    v_mfma_f32_16x16x32_bf16 v[100:103], v[24:27], v[216:219], v[100:103]
    v_cvt_pk_bf16_f32 v92, v92, v93
    v_mfma_f32_16x16x32_bf16 v[96:99], v[28:31], v[204:207], v[96:99]
    v_cvt_pk_bf16_f32 v93, v94, v95
    v_mfma_f32_16x16x32_bf16 v[100:103], v[28:31], v[220:223], v[100:103]
    ds_write_b64 v64, v[92:93] offset:384
    v_mfma_f32_16x16x32_bf16 v[104:107], v[16:19], v[224:227], 0
    v_mfma_f32_16x16x32_bf16 v[108:111], v[16:19], v[240:243], 0
    v_mfma_f32_16x16x32_bf16 v[104:107], v[20:23], v[228:231], v[104:107]
    v_cvt_pk_bf16_f32 v96, v96, v97
    v_mfma_f32_16x16x32_bf16 v[108:111], v[20:23], v[244:247], v[108:111]
    v_cvt_pk_bf16_f32 v97, v98, v99
    v_mfma_f32_16x16x32_bf16 v[104:107], v[24:27], v[232:235], v[104:107]
    ds_write_b64 v64, v[96:97] offset:512
    v_mfma_f32_16x16x32_bf16 v[108:111], v[24:27], v[248:251], v[108:111]
    v_cvt_pk_bf16_f32 v100, v100, v101
    v_mfma_f32_16x16x32_bf16 v[104:107], v[28:31], v[236:239], v[104:107]
    v_cvt_pk_bf16_f32 v101, v102, v103
    v_mfma_f32_16x16x32_bf16 v[108:111], v[28:31], v[252:255], v[108:111]
    ds_write_b64 v64, v[100:101] offset:640
    s_nop 7
    v_cvt_pk_bf16_f32 v104, v104, v105
    v_cvt_pk_bf16_f32 v105, v106, v107
    ds_write_b64 v64, v[104:105] offset:768
    v_cvt_pk_bf16_f32 v108, v108, v109
    v_cvt_pk_bf16_f32 v109, v110, v111
    ds_write_b64 v64, v[108:109] offset:896
    v_add_u32 v64, 0x8000, v64
    v_mfma_f32_16x16x32_bf16 v[88:91], v[32:35], v[128:131], 0
    v_mfma_f32_16x16x32_bf16 v[92:95], v[32:35], v[144:147], 0
    v_mfma_f32_16x16x32_bf16 v[88:91], v[36:39], v[132:135], v[88:91]
    v_mfma_f32_16x16x32_bf16 v[92:95], v[36:39], v[148:151], v[92:95]
    v_mfma_f32_16x16x32_bf16 v[88:91], v[40:43], v[136:139], v[88:91]
    v_mfma_f32_16x16x32_bf16 v[92:95], v[40:43], v[152:155], v[92:95]
    v_mfma_f32_16x16x32_bf16 v[88:91], v[44:47], v[140:143], v[88:91]
    v_mfma_f32_16x16x32_bf16 v[92:95], v[44:47], v[156:159], v[92:95]
    v_mfma_f32_16x16x32_bf16 v[96:99], v[32:35], v[160:163], 0
    v_mfma_f32_16x16x32_bf16 v[100:103], v[32:35], v[176:179], 0
    v_mfma_f32_16x16x32_bf16 v[96:99], v[36:39], v[164:167], v[96:99]
    v_cvt_pk_bf16_f32 v88, v88, v89
    v_mfma_f32_16x16x32_bf16 v[100:103], v[36:39], v[180:183], v[100:103]
    v_cvt_pk_bf16_f32 v89, v90, v91
    v_mfma_f32_16x16x32_bf16 v[96:99], v[40:43], v[168:171], v[96:99]
    ds_write_b64 v64, v[88:89] offset:0
    v_mfma_f32_16x16x32_bf16 v[100:103], v[40:43], v[184:187], v[100:103]
    v_cvt_pk_bf16_f32 v92, v92, v93
    v_mfma_f32_16x16x32_bf16 v[96:99], v[44:47], v[172:175], v[96:99]
    v_cvt_pk_bf16_f32 v93, v94, v95
    v_mfma_f32_16x16x32_bf16 v[100:103], v[44:47], v[188:191], v[100:103]
    ds_write_b64 v64, v[92:93] offset:128
    v_mfma_f32_16x16x32_bf16 v[104:107], v[32:35], v[192:195], 0
    v_mfma_f32_16x16x32_bf16 v[108:111], v[32:35], v[208:211], 0
    v_mfma_f32_16x16x32_bf16 v[104:107], v[36:39], v[196:199], v[104:107]
    v_cvt_pk_bf16_f32 v96, v96, v97
    v_mfma_f32_16x16x32_bf16 v[108:111], v[36:39], v[212:215], v[108:111]
    v_cvt_pk_bf16_f32 v97, v98, v99
    v_mfma_f32_16x16x32_bf16 v[104:107], v[40:43], v[200:203], v[104:107]
    ds_write_b64 v64, v[96:97] offset:256
    v_mfma_f32_16x16x32_bf16 v[108:111], v[40:43], v[216:219], v[108:111]
    v_cvt_pk_bf16_f32 v100, v100, v101
    v_mfma_f32_16x16x32_bf16 v[104:107], v[44:47], v[204:207], v[104:107]
    v_cvt_pk_bf16_f32 v101, v102, v103
    v_mfma_f32_16x16x32_bf16 v[108:111], v[44:47], v[220:223], v[108:111]
    ds_write_b64 v64, v[100:101] offset:384
    v_mfma_f32_16x16x32_bf16 v[88:91], v[32:35], v[224:227], 0
    v_mfma_f32_16x16x32_bf16 v[92:95], v[32:35], v[240:243], 0
    v_mfma_f32_16x16x32_bf16 v[88:91], v[36:39], v[228:231], v[88:91]
    v_cvt_pk_bf16_f32 v104, v104, v105
    v_mfma_f32_16x16x32_bf16 v[92:95], v[36:39], v[244:247], v[92:95]
    v_cvt_pk_bf16_f32 v105, v106, v107
    v_mfma_f32_16x16x32_bf16 v[88:91], v[40:43], v[232:235], v[88:91]
    ds_write_b64 v64, v[104:105] offset:512
    v_mfma_f32_16x16x32_bf16 v[92:95], v[40:43], v[248:251], v[92:95]
    v_cvt_pk_bf16_f32 v108, v108, v109
    v_mfma_f32_16x16x32_bf16 v[88:91], v[44:47], v[236:239], v[88:91]
    v_cvt_pk_bf16_f32 v109, v110, v111
    v_mfma_f32_16x16x32_bf16 v[92:95], v[44:47], v[252:255], v[92:95]
    ds_write_b64 v64, v[108:109] offset:640
    s_nop 7
    v_cvt_pk_bf16_f32 v88, v88, v89
    v_cvt_pk_bf16_f32 v89, v90, v91
    ds_write_b64 v64, v[88:89] offset:768
    v_cvt_pk_bf16_f32 v92, v92, v93
    v_cvt_pk_bf16_f32 v93, v94, v95
    ds_write_b64 v64, v[92:93] offset:896
    v_add_u32 v64, 0x8000, v64
    v_mov_b32 v0, s24
    v_mov_b32 v1, s25
    v_mov_b32 v2, s26
    v_mov_b32 v3, s27
    v_mov_b32 v4, s24
    v_mov_b32 v5, s25
    v_mov_b32 v6, s26
    v_mov_b32 v7, s27
    v_mov_b32 v8, s24
    v_mov_b32 v9, s25
    v_mov_b32 v10, s26
    v_mov_b32 v11, s27
    v_mov_b32 v12, s24
    v_mov_b32 v13, s25
    v_mov_b32 v14, s26
    v_mov_b32 v15, s27
    v_mov_b32 v16, s24
    v_mov_b32 v17, s25
    v_mov_b32 v18, s26
    v_mov_b32 v19, s27
    v_mov_b32 v20, s24
    v_mov_b32 v21, s25
    v_mov_b32 v22, s26
    v_mov_b32 v23, s27
    v_mov_b32 v24, s24
    v_mov_b32 v25, s25
    v_mov_b32 v26, s26
    v_mov_b32 v27, s27
    v_mov_b32 v28, s24
    v_mov_b32 v29, s25
    v_mov_b32 v30, s26
    v_mov_b32 v31, s27
    v_mov_b32 v32, s24
    v_mov_b32 v33, s25
    v_mov_b32 v34, s26
    v_mov_b32 v35, s27
    v_mov_b32 v36, s24
    v_mov_b32 v37, s25
    v_mov_b32 v38, s26
    v_mov_b32 v39, s27
    v_mov_b32 v40, s24
    v_mov_b32 v41, s25
    v_mov_b32 v42, s26
    v_mov_b32 v43, s27
    v_mov_b32 v44, s24
    v_mov_b32 v45, s25
    v_mov_b32 v46, s26
    v_mov_b32 v47, s27
    v_mov_b32 v48, s24
    v_mov_b32 v49, s25
    v_mov_b32 v50, s26
    v_mov_b32 v51, s27
    v_mov_b32 v52, s24
    v_mov_b32 v53, s25
    v_mov_b32 v54, s26
    v_mov_b32 v55, s27
    v_mov_b32 v56, s24
    v_mov_b32 v57, s25
    v_mov_b32 v58, s26
    v_mov_b32 v59, s27
    v_mov_b32 v60, s24
    v_mov_b32 v61, s25
    v_mov_b32 v62, s26
    v_mov_b32 v63, s27

    s_mov_b32 s64, 0
    s_cmp_eq_u32 s3, 7
    s_cbranch_scc1 k1_kernel_k2w
    s_branch k1_kernel_k2j

k1_kernel_end:
    s_endpgm
k1_kernel_main:
    s_setprio 3
    s_mov_b32 s16, s4
    s_and_b32 s17, s5, 0xffff
    s_mov_b32 s20, s6
    s_and_b32 s21, s7, 0xffff
    s_mov_b32 s28, s10
    s_and_b32 s29, s11, 0xffff
    s_mov_b32 s32, s12
    s_and_b32 s33, s13, 0xffff
    s_and_b32 s13, s13, 0xffff
    s_and_b32 s53, s53, 0xffff

    v_and_b32 v5, 15, v255
    v_lshrrev_b32 v6, 4, v255
    v_and_b32 v7, 3, v255
    v_bfe_u32 v8, v255, 2, 2
    v_lshl_add_u32 v9, v7, 2, v8
    v_cmp_eq_u32 s[46:47], 0, v7
    s_movk_i32 s45, 200
    v_mov_b32 v10, 144384
    v_mad_u32_u24 v11, v9, s45, v10
    v_and_b32 v213, 48, v255
    v_add_u32 v128, v11, v213
    v_mul_u32_u24 v12, 6400, v6
    v_add_u32 v132, v11, v12
    v_and_b32 v12, 16, v255
    v_add_u32 v10, v10, v12
    v_add_u32 v11, v11, v12
    v_and_b32 v12, 32, v255
    v_mul_u32_u24 v12, 100, v12
    v_add_u32 v131, v11, v12
    v_and_b32 v12, 8, v255
    v_lshl_add_u32 v13, v7, 1, v12
    v_and_b32 v14, 1, v8
    v_add_u32 v13, v13, v14
    v_lshrrev_b32 v14, 5, v255
    v_lshl_add_u32 v14, v13, 1, v14
    v_mad_u32_u24 v129, v14, s45, v10
    v_lshl_add_u32 v130, v12, 2, v129
    v_lshlrev_b32 v15, 2, v6
    v_sub_u32 v13, v13, v15
    v_lshrrev_b32 v14, 1, v9
    v_sub_u32 v14, v14, v15
    v_sub_u32 v15, v5, v15
    v_and_b32 v12, 1, v9
    v_lshlrev_b32 v12, 4, v12
    v_mov_b32 v16, 0x3f80
    v_lshlrev_b32 v12, v12, v16
    v_mov_b32 v17, 0x3f800000

    v_cmp_eq_u32 vcc, 0, v13
    v_cndmask_b32 v120, 0, v16, vcc
    v_cmp_eq_u32 vcc, 0, v14
    v_cndmask_b32 v112, 0, v12, vcc
    v_cmp_eq_u32 vcc, -8, v14
    v_cndmask_b32 v116, 0, v12, vcc
    v_cmp_eq_u32 vcc, 0, v15
    v_cndmask_b32 v200, 0, v17, vcc
    v_lshlrev_b32 v124, 16, v120

    v_cmp_eq_u32 vcc, 1, v13
    v_cndmask_b32 v121, 0, v16, vcc
    v_cmp_eq_u32 vcc, 1, v14
    v_cndmask_b32 v113, 0, v12, vcc
    v_cmp_eq_u32 vcc, -7, v14
    v_cndmask_b32 v117, 0, v12, vcc
    v_cmp_eq_u32 vcc, 1, v15
    v_cndmask_b32 v201, 0, v17, vcc
    v_lshlrev_b32 v125, 16, v121

    v_cmp_eq_u32 vcc, 2, v13
    v_cndmask_b32 v122, 0, v16, vcc
    v_cmp_eq_u32 vcc, 2, v14
    v_cndmask_b32 v114, 0, v12, vcc
    v_cmp_eq_u32 vcc, -6, v14
    v_cndmask_b32 v118, 0, v12, vcc
    v_cmp_eq_u32 vcc, 2, v15
    v_cndmask_b32 v202, 0, v17, vcc
    v_lshlrev_b32 v126, 16, v122

    v_cmp_eq_u32 vcc, 3, v13
    v_cndmask_b32 v123, 0, v16, vcc
    v_cmp_eq_u32 vcc, 3, v14
    v_cndmask_b32 v115, 0, v12, vcc
    v_cmp_eq_u32 vcc, -5, v14
    v_cndmask_b32 v119, 0, v12, vcc
    v_cmp_eq_u32 vcc, 3, v15
    v_cndmask_b32 v203, 0, v17, vcc
    v_lshlrev_b32 v127, 16, v123

    s_mul_i32 s45, s3, 36864
    s_add_u32 s45, s45, 128
    s_movk_i32 s57, 144
    v_mov_b32 v10, s45
    v_mad_u32_u24 v214, v5, s57, v10
    v_mad_u32_u24 v218, v255, s57, v10
    v_add_u32 v218, 12, v218
    v_cmp_lt_u32 vcc, 25, v255
    v_subrev_u32 v11, 26, v255
    v_cndmask_b32 v11, v255, v11, vcc
    v_add_u32 v12, 2304, v10
    v_cndmask_b32 v10, v10, v12, vcc
    v_and_b32 v12, 3, v11
    v_mad_u32_u24 v10, v12, s57, v10
    v_lshrrev_b32 v11, 2, v11
    v_lshl_add_u32 v215, v11, 1, v10
    v_cmp_gt_u32 vcc, 52, v255
    v_add_u32 v11, 2304, v218
    v_cndmask_b32 v215, v11, v215, vcc
    v_mov_b32 v216, 0xdddddddd
    v_mov_b32 v219, 1000
    s_mov_b32 s60, 0xff00ff00
    s_mov_b32 s61, 0xff00ff00
    s_mov_b32 s62, -1
    s_mov_b32 s63, 0xffff

    s_waitcnt vmcnt(3)

    s_mov_b64 exec, 1
    ds_add_u32 v252, v253 offset:0
    s_mov_b64 exec, -1

k1_kernel_wf1:

    ds_read_b32 v251, v252 offset:0
    s_waitcnt lgkmcnt(0)
    v_readfirstlane_b32 s45, v251
    s_cmp_lt_u32 s45, 4
    s_cbranch_scc1 k1_kernel_wf1

    v_mov_b32 v72, 0
    v_mov_b32 v73, 0
    v_mov_b32 v74, 0
    v_mov_b32 v75, 0
    s_mov_b64 exec, s[62:63]
    ds_read_b64 v[72:73], v132 offset:192
    ds_read_b64 v[74:75], v132 offset:3392
    s_mov_b64 exec, -1
    ds_read_b64 v[76:77], v128 offset:16160
    ds_read_b64 v[78:79], v128 offset:16168
    ds_read_b64 v[80:81], v128 offset:0
    ds_read_b64 v[82:83], v128 offset:8
    ds_read_b64 v[84:85], v131 offset:0
    ds_read_b64 v[86:87], v131 offset:8
    s_waitcnt vmcnt(2)
    s_waitcnt lgkmcnt(4)
    v_mfma_f32_16x16x32_bf16 v[64:67], v[112:115], v[72:75], 0
    ds_read_b64 v[88:89], v128 offset:3232
    ds_read_b64 v[90:91], v128 offset:3240
    v_mfma_f32_16x16x32_bf16 v[68:71], v[116:119], v[72:75], 0
    v_mfma_f32_16x16x32_bf16 v[60:63], v[112:115], v[76:79], 0
    v_mfma_f32_16x16x32_bf16 v[64:67], v[232:235], v[112:115], v[64:67]
    v_mov_b32 v92, 0
    v_mov_b32 v93, 0
    v_mov_b32 v94, 0
    v_mov_b32 v95, 0
    s_mov_b64 exec, s[60:61]
    ds_read_b64 v[92:93], v129 offset:3232
    ds_read_b64 v[94:95], v129 offset:3240
    s_mov_b64 exec, -1
    v_mfma_f32_16x16x32_bf16 v[68:71], v[232:235], v[116:119], v[68:71]
    s_waitcnt lgkmcnt(4)
    v_mfma_f32_16x16x32_bf16 v[0:3], v[112:115], v[80:83], 0
    ds_read_b64 v[72:73], v128 offset:64
    ds_read_b64 v[74:75], v128 offset:72
    v_mfma_f32_16x16x32_bf16 v[4:7], v[116:119], v[80:83], 0
    v_mfma_f32_16x16x32_bf16 v[4:7], v[84:87], v[116:119], v[4:7]
    v_cndmask_b32 v70, 0, v70, s[46:47]
    ds_read_b64 v[76:77], v131 offset:6400
    ds_read_b64 v[78:79], v131 offset:6408
    s_waitcnt lgkmcnt(4)
    v_mfma_f32_16x16x32_bf16 v[96:99], v[120:123], v[88:91], 0
    ds_read_b64 v[80:81], v128 offset:9632
    ds_read_b64 v[82:83], v128 offset:9640
    v_mfma_f32_16x16x32_bf16 v[100:103], v[124:127], v[88:91], 0
    v_mfma_f32_16x16x32_bf16 v[96:99], v[92:95], v[112:115], v[96:99]
    v_mfma_f32_16x16x32_bf16 v[100:103], v[92:95], v[116:119], v[100:103]
    ds_read_b64 v[84:85], v129 offset:3296
    ds_read_b64 v[86:87], v129 offset:3304
    s_waitcnt lgkmcnt(4)
    v_mfma_f32_16x16x32_bf16 v[12:15], v[112:115], v[72:75], 0
    ds_read_b64 v[88:89], v128 offset:6464
    ds_read_b64 v[90:91], v128 offset:6472
    v_mfma_f32_16x16x32_bf16 v[16:19], v[116:119], v[72:75], 0
    v_cvt_pk_bf16_f32 v8, v96, v97
    v_cvt_pk_bf16_f32 v9, v98, v99
    v_mfma_f32_16x16x32_bf16 v[12:15], v[76:79], v[112:115], v[12:15]
    v_cvt_pk_bf16_f32 v10, v100, v101
    v_cvt_pk_bf16_f32 v11, v102, v103
    v_mfma_f32_16x16x32_bf16 v[16:19], v[76:79], v[116:119], v[16:19]
    ds_read_b64 v[92:93], v128 offset:9696
    ds_read_b64 v[94:95], v128 offset:9704
    s_waitcnt lgkmcnt(4)
    v_mfma_f32_16x16x32_bf16 v[96:99], v[120:123], v[80:83], 0
    ds_read_b64 v[72:73], v128 offset:128
    ds_read_b64 v[74:75], v128 offset:136
    v_mfma_f32_16x16x32_bf16 v[100:103], v[124:127], v[80:83], 0
    v_mfma_f32_16x16x32_bf16 v[96:99], v[84:87], v[112:115], v[96:99]
    v_mfma_f32_16x16x32_bf16 v[100:103], v[84:87], v[116:119], v[100:103]
    ds_read_b64 v[76:77], v129 offset:12800
    ds_read_b64 v[78:79], v129 offset:12808
    s_waitcnt lgkmcnt(4)
    v_mfma_f32_16x16x32_bf16 v[24:27], v[112:115], v[88:91], 0
    ds_read_b64 v[80:81], v128 offset:3328
    ds_read_b64 v[82:83], v128 offset:3336
    v_mfma_f32_16x16x32_bf16 v[28:31], v[112:115], v[92:95], 0
    v_cvt_pk_bf16_f32 v20, v96, v97
    v_cvt_pk_bf16_f32 v21, v98, v99
    s_nop 3
    v_cvt_pk_bf16_f32 v22, v100, v101
    v_cvt_pk_bf16_f32 v23, v102, v103
    ds_read_b64 v[84:85], v131 offset:12832
    ds_read_b64 v[86:87], v131 offset:12840
    s_waitcnt lgkmcnt(4)
    v_mfma_f32_16x16x32_bf16 v[96:99], v[120:123], v[72:75], 0
    ds_read_b64 v[88:89], v128 offset:6528
    ds_read_b64 v[90:91], v128 offset:6536
    v_mfma_f32_16x16x32_bf16 v[100:103], v[124:127], v[72:75], 0
    v_mfma_f32_16x16x32_bf16 v[96:99], v[76:79], v[112:115], v[96:99]
    v_mfma_f32_16x16x32_bf16 v[100:103], v[76:79], v[116:119], v[100:103]
    ds_read_b64 v[92:93], v129 offset:12864
    ds_read_b64 v[94:95], v129 offset:12872
    s_waitcnt lgkmcnt(4)
    v_mfma_f32_16x16x32_bf16 v[36:39], v[112:115], v[80:83], 0
    ds_read_b64 v[72:73], v128 offset:9728
    ds_read_b64 v[74:75], v128 offset:9736
    v_mfma_f32_16x16x32_bf16 v[40:43], v[116:119], v[80:83], 0
    v_cvt_pk_bf16_f32 v32, v96, v97
    v_cvt_pk_bf16_f32 v33, v98, v99
    v_mfma_f32_16x16x32_bf16 v[36:39], v[84:87], v[112:115], v[36:39]
    v_cvt_pk_bf16_f32 v34, v100, v101
    v_cvt_pk_bf16_f32 v35, v102, v103
    v_mfma_f32_16x16x32_bf16 v[40:43], v[84:87], v[116:119], v[40:43]
    ds_read_b64 v[76:77], v131 offset:12896
    ds_read_b64 v[78:79], v131 offset:12904
    s_waitcnt lgkmcnt(4)
    v_mfma_f32_16x16x32_bf16 v[96:99], v[120:123], v[88:91], 0
    ds_read_b64 v[80:81], v128 offset:12928
    ds_read_b64 v[82:83], v128 offset:12936
    v_mfma_f32_16x16x32_bf16 v[100:103], v[124:127], v[88:91], 0
    v_mfma_f32_16x16x32_bf16 v[96:99], v[92:95], v[112:115], v[96:99]
    v_mfma_f32_16x16x32_bf16 v[100:103], v[92:95], v[116:119], v[100:103]
    v_mov_b32 v84, 0
    v_mov_b32 v85, 0
    v_mov_b32 v86, 0
    v_mov_b32 v87, 0
    s_mov_b64 exec, s[60:61]
    ds_read_b64 v[84:85], v129 offset:12928
    ds_read_b64 v[86:87], v129 offset:12936
    s_mov_b64 exec, -1
    s_waitcnt lgkmcnt(4)
    v_mfma_f32_16x16x32_bf16 v[48:51], v[112:115], v[72:75], 0
    v_mfma_f32_16x16x32_bf16 v[52:55], v[116:119], v[72:75], 0
    v_cvt_pk_bf16_f32 v44, v96, v97
    v_cvt_pk_bf16_f32 v45, v98, v99
    v_mfma_f32_16x16x32_bf16 v[48:51], v[76:79], v[112:115], v[48:51]
    v_cvt_pk_bf16_f32 v46, v100, v101
    v_cvt_pk_bf16_f32 v47, v102, v103
    v_mfma_f32_16x16x32_bf16 v[52:55], v[76:79], v[116:119], v[52:55]
    s_waitcnt lgkmcnt(0)

    s_mov_b64 exec, 1
    ds_add_u32 v252, v253 offset:12
    s_mov_b64 exec, -1

    v_mfma_f32_16x16x32_bf16 v[96:99], v[120:123], v[80:83], 0
    v_mfma_f32_16x16x32_bf16 v[100:103], v[124:127], v[80:83], 0
    v_mfma_f32_16x16x32_bf16 v[96:99], v[84:87], v[112:115], v[96:99]
    v_mfma_f32_16x16x32_bf16 v[100:103], v[84:87], v[116:119], v[100:103]
    s_nop 7
    v_cvt_pk_bf16_f32 v56, v96, v97
    v_cvt_pk_bf16_f32 v57, v98, v99
    v_cvt_pk_bf16_f32 v58, v100, v101
    v_cvt_pk_bf16_f32 v59, v102, v103

    v_mov_b32_dpp v71, v70 row_shr:1 row_mask:0xf bank_mask:0xf bound_ctrl:0
    ds_write_b32 v218, v219
    v_and_b32 v217, 1, v255
    v_lshlrev_b32 v248, 1, v213
    v_lshl_add_u32 v248, v217, 2, v248
    v_mul_u32_u24 v208, 0xaaaa, v217
    v_mov_b32 v217, 0
    s_mov_b32 vcc_lo, 0x01010101
    s_mov_b32 vcc_hi, 0x01010101
    s_movk_i32 s58, 7

    v_mov_b64 v[172:173], 0
    v_mov_b64 v[176:177], 0
    v_mov_b64 v[180:181], 0
    v_mov_b64 v[184:185], 0
    v_mov_b64 v[188:189], 0
    v_mov_b64 v[192:193], 0
    v_mov_b64 v[196:197], 0
    v_mov_b64 v[198:199], 0
    s_waitcnt vmcnt(1)
    ds_write_b16 v215, v240 offset:0
    ds_write_b16 v215, v241 offset:576
    ds_write_b16 v215, v242 offset:1152
    ds_write_b16 v215, v243 offset:1728
    v_add_u32 v250, 0x4444, v208
    ds_read_b128 v[204:207], v214 offset:0
k1_kernel_wf2:

    ds_read_b32 v251, v252 offset:16
    s_waitcnt lgkmcnt(0)
    v_readfirstlane_b32 s45, v251
    s_cmp_lt_u32 s45, 4
    s_cbranch_scc1 k1_kernel_wf2

    s_setprio 2
    v_mad_u32_u16 v76, v204, s57, v213 op_sel:[0,0,0,0]
    ds_read_b128 v[72:75], v76 offset:0
    ds_read_b128 v[76:79], v76 offset:64
    v_mad_u32_u16 v84, v204, s57, v213 op_sel:[1,0,0,0]
    ds_read_b128 v[80:83], v84 offset:0
    ds_read_b128 v[84:87], v84 offset:64
    v_mad_u32_u16 v92, v205, s57, v213 op_sel:[0,0,0,0]
    ds_read_b128 v[88:91], v92 offset:0
    ds_read_b128 v[92:95], v92 offset:64
    v_mad_u32_u16 v100, v205, s57, v213 op_sel:[1,0,0,0]
    ds_read_b128 v[96:99], v100 offset:0
    ds_read_b128 v[100:103], v100 offset:64
    v_mad_u32_u16 v108, v206, s57, v213 op_sel:[0,0,0,0]
    ds_read_b128 v[104:107], v108 offset:0
    ds_read_b128 v[108:111], v108 offset:64
    buffer_load_dwordx4 v[240:243], v249, s[16:19], s74 offen offset:0
    s_waitcnt lgkmcnt(4)
    v_mad_u32_u16 v116, v206, s57, v213 op_sel:[1,0,0,0]
    ds_read_b128 v[112:115], v116 offset:0
k1_kernel_loop:
    v_mfma_f32_16x16x32_bf16 v[124:127], v[72:75], v[72:75], 0
    ds_read_b128 v[116:119], v116 offset:64
    v_mad_u32_u16 v122, v207, s57, v248 op_sel:[0,0,0,0]
    ds_read2_b32 v[120:121], v122 offset0:0 offset1:2
    v_mfma_f32_16x16x32_bf16 v[124:127], v[76:79], v[76:79], v[124:127]
    ds_read2_b32 v[122:123], v122 offset0:4 offset1:6
    ds_read_b128 v[204:207], v214 offset:2304
    v_mfma_f32_16x16x32_bf16 v[128:131], v[80:83], v[72:75], 0
    v_fmac_f32 v217, v189, v68
    v_fmac_f32 v217, v196, v200
    v_mfma_f32_16x16x32_bf16 v[128:131], v[84:87], v[76:79], v[128:131]
    v_fmac_f32 v217, v192, v69
    v_fmac_f32 v217, v197, v201
    v_mfma_f32_16x16x32_bf16 v[132:135], v[80:83], v[80:83], 0
    v_fmac_f32 v217, v193, v69
    v_fmac_f32 v217, v198, v202
    v_mfma_f32_16x16x32_bf16 v[132:135], v[84:87], v[84:87], v[132:135]
    v_fmac_f32 v217, v199, v203
    v_fmac_f32 v209, v153, v53
    v_mfma_f32_16x16x32_bf16 v[136:139], v[88:91], v[80:83], 0
    v_fmac_f32 v208, v154, v54
    v_fmac_f32 v209, v155, v55
    v_mfma_f32_16x16x32_bf16 v[136:139], v[92:95], v[84:87], v[136:139]
    v_fmac_f32 v208, v164, v60
    v_fmac_f32 v209, v165, v61
    v_mfma_f32_16x16x32_bf16 v[140:143], v[88:91], v[72:75], 0
    v_fmac_f32 v208, v166, v62
    v_fmac_f32 v209, v167, v63
    v_mfma_f32_16x16x32_bf16 v[140:143], v[92:95], v[76:79], v[140:143]
    s_waitcnt lgkmcnt(7)
    v_add_f32 v209, v209, v217
    v_smfmac_f32_16x16x64_bf16 v[196:199], v[8:11], v[132:139], v216
    v_fmac_f32 v208, v168, v70
    v_mfma_f32_16x16x32_bf16 v[144:147], v[96:99], v[72:75], 0
    v_fmac_f32 v208, v169, v71
    v_add_f32 v211, v208, v209
    v_mfma_f32_16x16x32_bf16 v[144:147], v[100:103], v[76:79], v[144:147]
    v_fma_f32 v208, v124, v0, -v217
    v_mul_f32 v209, v125, v1
    v_mfma_f32_16x16x32_bf16 v[148:151], v[80:83], v[96:99], 0
    v_fmac_f32 v208, v126, v2
    v_fmac_f32 v209, v127, v3
    v_mfma_f32_16x16x32_bf16 v[148:151], v[84:87], v[100:103], v[148:151]
    v_fmac_f32 v208, v128, v4
    v_fmac_f32 v209, v129, v5
    v_mfma_f32_16x16x32_bf16 v[152:155], v[88:91], v[96:99], 0
    v_fmac_f32 v208, v130, v6
    v_fmac_f32 v209, v131, v7
    v_mfma_f32_16x16x32_bf16 v[152:155], v[92:95], v[100:103], v[152:155]
    v_fmac_f32 v208, v140, v12
    v_fmac_f32 v209, v141, v13
    v_mfma_f32_16x16x32_bf16 v[156:159], v[88:91], v[88:91], 0
    v_fmac_f32 v208, v142, v14
    v_fmac_f32 v209, v143, v15
    v_mfma_f32_16x16x32_bf16 v[156:159], v[92:95], v[92:95], v[156:159]
    v_fmac_f32 v208, v144, v16
    v_fmac_f32 v209, v145, v17
    v_smfmac_f32_16x16x64_bf16 v[196:199], v[20:23], v[148:155], v216
    v_fmac_f32 v208, v146, v18
    v_mfma_f32_16x16x32_bf16 v[160:163], v[96:99], v[96:99], 0
    s_waitcnt lgkmcnt(0)
    v_fmac_f32 v209, v147, v19
    v_mfma_f32_16x16x32_bf16 v[160:163], v[100:103], v[100:103], v[160:163]
    v_fmac_f32 v208, v156, v24
    v_fmac_f32 v209, v157, v25
    v_mfma_f32_16x16x32_bf16 v[124:127], v[104:107], v[72:75], 0
    v_fmac_f32 v208, v158, v26
    v_fmac_f32 v209, v159, v27
    v_mfma_f32_16x16x32_bf16 v[124:127], v[108:111], v[76:79], v[124:127]
    v_permlane32_swap_b32 v210, v211
    s_waitcnt vmcnt(1)
    v_mfma_f32_16x16x32_bf16 v[128:131], v[112:115], v[72:75], 0
    v_fmac_f32 v208, v160, v28
    v_fmac_f32 v209, v161, v29
    v_mfma_f32_16x16x32_bf16 v[128:131], v[116:119], v[76:79], v[128:131]
    v_fmac_f32 v208, v162, v30
    v_fmac_f32 v209, v163, v31
    v_smfmac_f32_16x16x64_bf16 v[172:175], v[120:123], v[72:79], v250
    v_mad_u32_u16 v76, v204, s57, v213 op_sel:[0,0,0,0]
    v_mfma_f32_16x16x32_bf16 v[132:135], v[104:107], v[80:83], 0
    ds_read_b128 v[72:75], v76 offset:0
    ds_read_b128 v[76:79], v76 offset:64
    v_smfmac_f32_16x16x64_bf16 v[196:199], v[32:35], v[124:131], v216
    v_add_f32 v219, v210, v211
    v_mfma_f32_16x16x32_bf16 v[132:135], v[108:111], v[84:87], v[132:135]
    v_mul_f32 v217, v172, v64
    ds_write_b16 v215, v244 offset:4608
    v_mfma_f32_16x16x32_bf16 v[136:139], v[112:115], v[80:83], 0
    v_fmac_f32 v217, v173, v64
    ds_write_b16 v215, v245 offset:5184
    v_mfma_f32_16x16x32_bf16 v[136:139], v[116:119], v[84:87], v[136:139]
    ds_write_b16 v215, v246 offset:5760
    ds_write_b16 v215, v247 offset:6336
    v_smfmac_f32_16x16x64_bf16 v[176:179], v[120:123], v[80:87], v250
    v_mad_u32_u16 v84, v204, s57, v213 op_sel:[1,0,0,0]
    v_mfma_f32_16x16x32_bf16 v[140:143], v[104:107], v[88:91], 0
    ds_read_b128 v[80:83], v84 offset:0
    ds_read_b128 v[84:87], v84 offset:64
    v_mfma_f32_16x16x32_bf16 v[140:143], v[108:111], v[92:95], v[140:143]
    v_fmac_f32 v208, v132, v36
    v_fmac_f32 v209, v133, v37
    v_mfma_f32_16x16x32_bf16 v[144:147], v[112:115], v[88:91], 0
    v_fmac_f32 v217, v176, v65
    v_fmac_f32 v208, v134, v38
    v_mfma_f32_16x16x32_bf16 v[144:147], v[116:119], v[92:95], v[144:147]
    v_fmac_f32 v217, v177, v65
    v_fmac_f32 v209, v135, v39
    v_smfmac_f32_16x16x64_bf16 v[180:183], v[120:123], v[88:95], v250
    v_mad_u32_u16 v92, v205, s57, v213 op_sel:[0,0,0,0]
    v_mfma_f32_16x16x32_bf16 v[148:151], v[104:107], v[96:99], 0
    ds_read_b128 v[88:91], v92 offset:0
    ds_read_b128 v[92:95], v92 offset:64
    v_smfmac_f32_16x16x64_bf16 v[196:199], v[44:47], v[140:147], v216
    v_fmac_f32 v208, v136, v40
    v_mfma_f32_16x16x32_bf16 v[148:151], v[108:111], v[100:103], v[148:151]
    v_fmac_f32 v217, v180, v66
    v_fmac_f32 v209, v137, v41
    v_mfma_f32_16x16x32_bf16 v[152:155], v[112:115], v[96:99], 0
    v_fmac_f32 v217, v181, v66
    v_fmac_f32 v208, v138, v42
    v_mfma_f32_16x16x32_bf16 v[152:155], v[116:119], v[100:103], v[152:155]
    v_fmac_f32 v209, v139, v43
    buffer_load_dwordx4 v[244:247], v249, s[16:19], s74 offen offset:800
    v_smfmac_f32_16x16x64_bf16 v[184:187], v[120:123], v[96:103], v250
    v_mad_u32_u16 v100, v205, s57, v213 op_sel:[1,0,0,0]
    v_mfma_f32_16x16x32_bf16 v[156:159], v[104:107], v[104:107], 0
    ds_read_b128 v[96:99], v100 offset:0
    ds_read_b128 v[100:103], v100 offset:64
    v_mfma_f32_16x16x32_bf16 v[156:159], v[108:111], v[108:111], v[156:159]
    v_fmac_f32 v208, v148, v48
    v_fmac_f32 v209, v149, v49
    v_mfma_f32_16x16x32_bf16 v[160:163], v[112:115], v[104:107], 0
    v_fmac_f32 v217, v184, v67
    v_fmac_f32 v208, v150, v50
    v_mfma_f32_16x16x32_bf16 v[160:163], v[116:119], v[108:111], v[160:163]
    v_fmac_f32 v217, v185, v67
    v_fmac_f32 v209, v151, v51
    v_smfmac_f32_16x16x64_bf16 v[188:191], v[120:123], v[104:111], v250
    v_mad_u32_u16 v108, v206, s57, v213 op_sel:[0,0,0,0]
    v_mfma_f32_16x16x32_bf16 v[164:167], v[112:115], v[112:115], 0
    ds_read_b128 v[104:107], v108 offset:0
    ds_read_b128 v[108:111], v108 offset:64
    v_smfmac_f32_16x16x64_bf16 v[196:199], v[56:59], v[156:163], v216
    s_waitcnt lgkmcnt(4)
    v_mfma_f32_16x16x32_bf16 v[164:167], v[116:119], v[116:119], v[164:167]
    v_fmac_f32 v217, v188, v68
    v_fmac_f32 v208, v152, v52
    v_smfmac_f32_16x16x64_bf16 v[192:195], v[120:123], v[112:119], v250
    v_mad_u32_u16 v116, v206, s57, v213 op_sel:[1,0,0,0]
    v_mfma_f32_16x16x32_bf16 v[168:171], v[120:123], v[120:123], 0
    ds_read_b128 v[112:115], v116 offset:0
    v_mfma_f32_16x16x32_bf16 v[124:127], v[72:75], v[72:75], 0
    ds_read_b128 v[116:119], v116 offset:64
    v_mad_u32_u16 v122, v207, s57, v248 op_sel:[0,0,0,0]
    ds_read2_b32 v[120:121], v122 offset0:0 offset1:2
    v_mfma_f32_16x16x32_bf16 v[124:127], v[76:79], v[76:79], v[124:127]
    ds_read2_b32 v[122:123], v122 offset0:4 offset1:6
    ds_read_b128 v[204:207], v214 offset:4608
    v_mfma_f32_16x16x32_bf16 v[128:131], v[80:83], v[72:75], 0
    v_fmac_f32 v217, v189, v68
    v_fmac_f32 v217, v196, v200
    v_mfma_f32_16x16x32_bf16 v[128:131], v[84:87], v[76:79], v[128:131]
    v_fmac_f32 v217, v192, v69
    v_fmac_f32 v217, v197, v201
    v_mfma_f32_16x16x32_bf16 v[132:135], v[80:83], v[80:83], 0
    v_fmac_f32 v217, v193, v69
    v_fmac_f32 v217, v198, v202
    v_mfma_f32_16x16x32_bf16 v[132:135], v[84:87], v[84:87], v[132:135]
    v_fmac_f32 v217, v199, v203
    v_fmac_f32 v209, v153, v53
    v_mfma_f32_16x16x32_bf16 v[136:139], v[88:91], v[80:83], 0
    v_fmac_f32 v208, v154, v54
    v_fmac_f32 v209, v155, v55
    v_mfma_f32_16x16x32_bf16 v[136:139], v[92:95], v[84:87], v[136:139]
    v_fmac_f32 v208, v164, v60
    v_fmac_f32 v209, v165, v61
    v_mfma_f32_16x16x32_bf16 v[140:143], v[88:91], v[72:75], 0
    v_fmac_f32 v208, v166, v62
    v_fmac_f32 v209, v167, v63
    v_mfma_f32_16x16x32_bf16 v[140:143], v[92:95], v[76:79], v[140:143]
    s_waitcnt lgkmcnt(7)
    v_add_f32 v209, v209, v217
    v_smfmac_f32_16x16x64_bf16 v[196:199], v[8:11], v[132:139], v216
    v_fmac_f32 v208, v168, v70
    v_mfma_f32_16x16x32_bf16 v[144:147], v[96:99], v[72:75], 0
    v_fmac_f32 v208, v169, v71
    v_add_f32 v210, v208, v209
    v_mfma_f32_16x16x32_bf16 v[144:147], v[100:103], v[76:79], v[144:147]
    v_fma_f32 v208, v124, v0, -v217
    v_mul_f32 v209, v125, v1
    v_mfma_f32_16x16x32_bf16 v[148:151], v[80:83], v[96:99], 0
    v_fmac_f32 v208, v126, v2
    v_fmac_f32 v209, v127, v3
    v_mfma_f32_16x16x32_bf16 v[148:151], v[84:87], v[100:103], v[148:151]
    v_fmac_f32 v208, v128, v4
    v_fmac_f32 v209, v129, v5
    v_mfma_f32_16x16x32_bf16 v[152:155], v[88:91], v[96:99], 0
    v_fmac_f32 v208, v130, v6
    v_fmac_f32 v209, v131, v7
    v_mfma_f32_16x16x32_bf16 v[152:155], v[92:95], v[100:103], v[152:155]
    v_fmac_f32 v208, v140, v12
    v_fmac_f32 v209, v141, v13
    v_mfma_f32_16x16x32_bf16 v[156:159], v[88:91], v[88:91], 0
    v_fmac_f32 v208, v142, v14
    v_fmac_f32 v209, v143, v15
    v_mfma_f32_16x16x32_bf16 v[156:159], v[92:95], v[92:95], v[156:159]
    v_fmac_f32 v208, v144, v16
    v_fmac_f32 v209, v145, v17
    v_smfmac_f32_16x16x64_bf16 v[196:199], v[20:23], v[148:155], v216
    v_fmac_f32 v208, v146, v18
    v_mfma_f32_16x16x32_bf16 v[160:163], v[96:99], v[96:99], 0
    s_waitcnt lgkmcnt(0)
    v_fmac_f32 v209, v147, v19
    v_mfma_f32_16x16x32_bf16 v[160:163], v[100:103], v[100:103], v[160:163]
    v_fmac_f32 v208, v156, v24
    v_fmac_f32 v209, v157, v25
    v_mfma_f32_16x16x32_bf16 v[124:127], v[104:107], v[72:75], 0
    v_fmac_f32 v208, v158, v26
    v_fmac_f32 v209, v159, v27
    v_mfma_f32_16x16x32_bf16 v[124:127], v[108:111], v[76:79], v[124:127]
    v_permlane16_swap_b32 v218, v219
    s_add_u32 s74, s74, s77
    v_mfma_f32_16x16x32_bf16 v[128:131], v[112:115], v[72:75], 0
    v_fmac_f32 v208, v160, v28
    v_fmac_f32 v209, v161, v29
    v_mfma_f32_16x16x32_bf16 v[128:131], v[116:119], v[76:79], v[128:131]
    v_fmac_f32 v208, v162, v30
    v_fmac_f32 v209, v163, v31
    v_smfmac_f32_16x16x64_bf16 v[172:175], v[120:123], v[72:79], v250
    v_mad_u32_u16 v76, v204, s57, v213 op_sel:[0,0,0,0]
    v_mfma_f32_16x16x32_bf16 v[132:135], v[104:107], v[80:83], 0
    ds_read_b128 v[72:75], v76 offset:0
    ds_read_b128 v[76:79], v76 offset:64
    v_smfmac_f32_16x16x64_bf16 v[196:199], v[32:35], v[124:131], v216
    v_add_f32 v220, v218, v219
    v_mfma_f32_16x16x32_bf16 v[132:135], v[108:111], v[84:87], v[132:135]
    v_mul_f32 v217, v172, v64
    s_min_i32 s74, s74, s79
    v_mfma_f32_16x16x32_bf16 v[136:139], v[112:115], v[80:83], 0
    v_fmac_f32 v217, v173, v64
    s_max_i32 s74, s74, s78
    v_mfma_f32_16x16x32_bf16 v[136:139], v[116:119], v[84:87], v[136:139]
    v_smfmac_f32_16x16x64_bf16 v[176:179], v[120:123], v[80:87], v250
    v_mad_u32_u16 v84, v204, s57, v213 op_sel:[1,0,0,0]
    v_mfma_f32_16x16x32_bf16 v[140:143], v[104:107], v[88:91], 0
    ds_read_b128 v[80:83], v84 offset:0
    ds_read_b128 v[84:87], v84 offset:64
    v_mfma_f32_16x16x32_bf16 v[140:143], v[108:111], v[92:95], v[140:143]
    v_fmac_f32 v208, v132, v36
    v_fmac_f32 v209, v133, v37
    v_mfma_f32_16x16x32_bf16 v[144:147], v[112:115], v[88:91], 0
    v_fmac_f32 v217, v176, v65
    v_fmac_f32 v208, v134, v38
    v_mfma_f32_16x16x32_bf16 v[144:147], v[116:119], v[92:95], v[144:147]
    v_fmac_f32 v217, v177, v65
    v_fmac_f32 v209, v135, v39
    v_smfmac_f32_16x16x64_bf16 v[180:183], v[120:123], v[88:95], v250
    v_mad_u32_u16 v92, v205, s57, v213 op_sel:[0,0,0,0]
    v_mfma_f32_16x16x32_bf16 v[148:151], v[104:107], v[96:99], 0
    ds_read_b128 v[88:91], v92 offset:0
    ds_read_b128 v[92:95], v92 offset:64
    v_smfmac_f32_16x16x64_bf16 v[196:199], v[44:47], v[140:147], v216
    v_fmac_f32 v208, v136, v40
    v_mfma_f32_16x16x32_bf16 v[148:151], v[108:111], v[100:103], v[148:151]
    v_fmac_f32 v217, v180, v66
    v_fmac_f32 v209, v137, v41
    v_mfma_f32_16x16x32_bf16 v[152:155], v[112:115], v[96:99], 0
    v_fmac_f32 v217, v181, v66
    v_fmac_f32 v208, v138, v42
    v_mfma_f32_16x16x32_bf16 v[152:155], v[116:119], v[100:103], v[152:155]
    v_fmac_f32 v209, v139, v43
    v_smfmac_f32_16x16x64_bf16 v[184:187], v[120:123], v[96:103], v250
    v_mad_u32_u16 v100, v205, s57, v213 op_sel:[1,0,0,0]
    v_mfma_f32_16x16x32_bf16 v[156:159], v[104:107], v[104:107], 0
    ds_read_b128 v[96:99], v100 offset:0
    ds_read_b128 v[100:103], v100 offset:64
    v_mfma_f32_16x16x32_bf16 v[156:159], v[108:111], v[108:111], v[156:159]
    v_fmac_f32 v208, v148, v48
    v_fmac_f32 v209, v149, v49
    v_mfma_f32_16x16x32_bf16 v[160:163], v[112:115], v[104:107], 0
    v_fmac_f32 v217, v184, v67
    v_fmac_f32 v208, v150, v50
    v_mfma_f32_16x16x32_bf16 v[160:163], v[116:119], v[108:111], v[160:163]
    v_fmac_f32 v217, v185, v67
    v_fmac_f32 v209, v151, v51
    v_smfmac_f32_16x16x64_bf16 v[188:191], v[120:123], v[104:111], v250
    v_mad_u32_u16 v108, v206, s57, v213 op_sel:[0,0,0,0]
    v_mfma_f32_16x16x32_bf16 v[164:167], v[112:115], v[112:115], 0
    ds_read_b128 v[104:107], v108 offset:0
    ds_read_b128 v[108:111], v108 offset:64
    v_smfmac_f32_16x16x64_bf16 v[196:199], v[56:59], v[156:163], v216
    s_waitcnt lgkmcnt(4)
    v_mfma_f32_16x16x32_bf16 v[164:167], v[116:119], v[116:119], v[164:167]
    v_fmac_f32 v217, v188, v68
    v_fmac_f32 v208, v152, v52
    v_smfmac_f32_16x16x64_bf16 v[192:195], v[120:123], v[112:119], v250
    v_mad_u32_u16 v116, v206, s57, v213 op_sel:[1,0,0,0]
    v_mfma_f32_16x16x32_bf16 v[168:171], v[120:123], v[120:123], 0
    ds_read_b128 v[112:115], v116 offset:0
    v_mfma_f32_16x16x32_bf16 v[124:127], v[72:75], v[72:75], 0
    ds_read_b128 v[116:119], v116 offset:64
    v_mad_u32_u16 v122, v207, s57, v248 op_sel:[0,0,0,0]
    ds_read2_b32 v[120:121], v122 offset0:0 offset1:2
    v_mfma_f32_16x16x32_bf16 v[124:127], v[76:79], v[76:79], v[124:127]
    ds_read2_b32 v[122:123], v122 offset0:4 offset1:6
    ds_read_b128 v[204:207], v214 offset:6912
    v_mfma_f32_16x16x32_bf16 v[128:131], v[80:83], v[72:75], 0
    v_fmac_f32 v217, v189, v68
    v_fmac_f32 v217, v196, v200
    v_mfma_f32_16x16x32_bf16 v[128:131], v[84:87], v[76:79], v[128:131]
    v_fmac_f32 v217, v192, v69
    v_fmac_f32 v217, v197, v201
    v_mfma_f32_16x16x32_bf16 v[132:135], v[80:83], v[80:83], 0
    v_fmac_f32 v217, v193, v69
    v_fmac_f32 v217, v198, v202
    v_mfma_f32_16x16x32_bf16 v[132:135], v[84:87], v[84:87], v[132:135]
    v_fmac_f32 v217, v199, v203
    v_fmac_f32 v209, v153, v53
    v_mfma_f32_16x16x32_bf16 v[136:139], v[88:91], v[80:83], 0
    v_fmac_f32 v208, v154, v54
    v_fmac_f32 v209, v155, v55
    v_mfma_f32_16x16x32_bf16 v[136:139], v[92:95], v[84:87], v[136:139]
    v_fmac_f32 v208, v164, v60
    v_fmac_f32 v209, v165, v61
    v_mfma_f32_16x16x32_bf16 v[140:143], v[88:91], v[72:75], 0
    v_fmac_f32 v208, v166, v62
    v_fmac_f32 v209, v167, v63
    v_mfma_f32_16x16x32_bf16 v[140:143], v[92:95], v[76:79], v[140:143]
    s_waitcnt lgkmcnt(7)
    v_add_f32 v209, v209, v217
    v_smfmac_f32_16x16x64_bf16 v[196:199], v[8:11], v[132:139], v216
    v_fmac_f32 v208, v168, v70
    v_mfma_f32_16x16x32_bf16 v[144:147], v[96:99], v[72:75], 0
    v_fmac_f32 v208, v169, v71
    v_add_f32 v211, v208, v209
    v_mfma_f32_16x16x32_bf16 v[144:147], v[100:103], v[76:79], v[144:147]
    v_fma_f32 v208, v124, v0, -v217
    v_mul_f32 v209, v125, v1
    v_mfma_f32_16x16x32_bf16 v[148:151], v[80:83], v[96:99], 0
    v_fmac_f32 v208, v126, v2
    v_fmac_f32 v209, v127, v3
    v_mfma_f32_16x16x32_bf16 v[148:151], v[84:87], v[100:103], v[148:151]
    v_fmac_f32 v208, v128, v4
    v_fmac_f32 v209, v129, v5
    v_mfma_f32_16x16x32_bf16 v[152:155], v[88:91], v[96:99], 0
    v_fmac_f32 v208, v130, v6
    v_fmac_f32 v209, v131, v7
    v_mfma_f32_16x16x32_bf16 v[152:155], v[92:95], v[100:103], v[152:155]
    v_fmac_f32 v208, v140, v12
    v_fmac_f32 v209, v141, v13
    v_mfma_f32_16x16x32_bf16 v[156:159], v[88:91], v[88:91], 0
    v_fmac_f32 v208, v142, v14
    v_fmac_f32 v209, v143, v15
    v_mfma_f32_16x16x32_bf16 v[156:159], v[92:95], v[92:95], v[156:159]
    v_fmac_f32 v208, v144, v16
    v_fmac_f32 v209, v145, v17
    v_smfmac_f32_16x16x64_bf16 v[196:199], v[20:23], v[148:155], v216
    v_fmac_f32 v208, v146, v18
    v_mfma_f32_16x16x32_bf16 v[160:163], v[96:99], v[96:99], 0
    s_waitcnt lgkmcnt(0)
    v_fmac_f32 v209, v147, v19
    v_mfma_f32_16x16x32_bf16 v[160:163], v[100:103], v[100:103], v[160:163]
    v_fmac_f32 v208, v156, v24
    v_fmac_f32 v209, v157, v25
    v_mfma_f32_16x16x32_bf16 v[124:127], v[104:107], v[72:75], 0
    v_fmac_f32 v208, v158, v26
    v_fmac_f32 v209, v159, v27
    v_mfma_f32_16x16x32_bf16 v[124:127], v[108:111], v[76:79], v[124:127]
    v_permlane32_swap_b32 v210, v211
    s_waitcnt vmcnt(1)
    v_mfma_f32_16x16x32_bf16 v[128:131], v[112:115], v[72:75], 0
    v_fmac_f32 v208, v160, v28
    v_fmac_f32 v209, v161, v29
    v_mfma_f32_16x16x32_bf16 v[128:131], v[116:119], v[76:79], v[128:131]
    v_fmac_f32 v208, v162, v30
    v_fmac_f32 v209, v163, v31
    v_smfmac_f32_16x16x64_bf16 v[172:175], v[120:123], v[72:79], v250
    v_mad_u32_u16 v76, v204, s57, v213 op_sel:[0,0,0,0]
    v_mfma_f32_16x16x32_bf16 v[132:135], v[104:107], v[80:83], 0
    ds_read_b128 v[72:75], v76 offset:0
    ds_read_b128 v[76:79], v76 offset:64
    v_smfmac_f32_16x16x64_bf16 v[196:199], v[32:35], v[124:131], v216
    v_add_f32 v218, v210, v211
    v_mfma_f32_16x16x32_bf16 v[132:135], v[108:111], v[84:87], v[132:135]
    v_mul_f32 v217, v172, v64
    ds_write_b16 v215, v240 offset:0
    v_mfma_f32_16x16x32_bf16 v[136:139], v[112:115], v[80:83], 0
    v_fmac_f32 v217, v173, v64
    ds_write_b16 v215, v241 offset:576
    v_mfma_f32_16x16x32_bf16 v[136:139], v[116:119], v[84:87], v[136:139]
    ds_write_b16 v215, v242 offset:1152
    ds_write_b16 v215, v243 offset:1728
    v_smfmac_f32_16x16x64_bf16 v[176:179], v[120:123], v[80:87], v250
    v_mad_u32_u16 v84, v204, s57, v213 op_sel:[1,0,0,0]
    v_mfma_f32_16x16x32_bf16 v[140:143], v[104:107], v[88:91], 0
    ds_read_b128 v[80:83], v84 offset:0
    ds_read_b128 v[84:87], v84 offset:64
    v_mfma_f32_16x16x32_bf16 v[140:143], v[108:111], v[92:95], v[140:143]
    v_fmac_f32 v208, v132, v36
    v_fmac_f32 v209, v133, v37
    v_mfma_f32_16x16x32_bf16 v[144:147], v[112:115], v[88:91], 0
    v_fmac_f32 v217, v176, v65
    v_fmac_f32 v208, v134, v38
    v_mfma_f32_16x16x32_bf16 v[144:147], v[116:119], v[92:95], v[144:147]
    v_fmac_f32 v217, v177, v65
    v_fmac_f32 v209, v135, v39
    v_smfmac_f32_16x16x64_bf16 v[180:183], v[120:123], v[88:95], v250
    v_mad_u32_u16 v92, v205, s57, v213 op_sel:[0,0,0,0]
    v_mfma_f32_16x16x32_bf16 v[148:151], v[104:107], v[96:99], 0
    ds_read_b128 v[88:91], v92 offset:0
    ds_read_b128 v[92:95], v92 offset:64
    v_smfmac_f32_16x16x64_bf16 v[196:199], v[44:47], v[140:147], v216
    v_fmac_f32 v208, v136, v40
    v_mfma_f32_16x16x32_bf16 v[148:151], v[108:111], v[100:103], v[148:151]
    v_fmac_f32 v217, v180, v66
    v_fmac_f32 v209, v137, v41
    v_mfma_f32_16x16x32_bf16 v[152:155], v[112:115], v[96:99], 0
    v_fmac_f32 v217, v181, v66
    v_fmac_f32 v208, v138, v42
    v_mfma_f32_16x16x32_bf16 v[152:155], v[116:119], v[100:103], v[152:155]
    v_fmac_f32 v209, v139, v43
    buffer_load_dwordx4 v[240:243], v249, s[16:19], s74 offen offset:0
    v_smfmac_f32_16x16x64_bf16 v[184:187], v[120:123], v[96:103], v250
    v_mad_u32_u16 v100, v205, s57, v213 op_sel:[1,0,0,0]
    v_mfma_f32_16x16x32_bf16 v[156:159], v[104:107], v[104:107], 0
    ds_read_b128 v[96:99], v100 offset:0
    ds_read_b128 v[100:103], v100 offset:64
    v_mfma_f32_16x16x32_bf16 v[156:159], v[108:111], v[108:111], v[156:159]
    v_fmac_f32 v208, v148, v48
    v_fmac_f32 v209, v149, v49
    v_mfma_f32_16x16x32_bf16 v[160:163], v[112:115], v[104:107], 0
    v_fmac_f32 v217, v184, v67
    v_fmac_f32 v208, v150, v50
    v_mfma_f32_16x16x32_bf16 v[160:163], v[116:119], v[108:111], v[160:163]
    v_fmac_f32 v217, v185, v67
    v_fmac_f32 v209, v151, v51
    v_smfmac_f32_16x16x64_bf16 v[188:191], v[120:123], v[104:111], v250
    v_mad_u32_u16 v108, v206, s57, v213 op_sel:[0,0,0,0]
    v_mfma_f32_16x16x32_bf16 v[164:167], v[112:115], v[112:115], 0
    ds_read_b128 v[104:107], v108 offset:0
    ds_read_b128 v[108:111], v108 offset:64
    v_smfmac_f32_16x16x64_bf16 v[196:199], v[56:59], v[156:163], v216
    s_waitcnt lgkmcnt(4)
    v_mfma_f32_16x16x32_bf16 v[164:167], v[116:119], v[116:119], v[164:167]
    v_fmac_f32 v217, v188, v68
    v_fmac_f32 v208, v152, v52
    v_smfmac_f32_16x16x64_bf16 v[192:195], v[120:123], v[112:119], v250
    v_mad_u32_u16 v116, v206, s57, v213 op_sel:[1,0,0,0]
    v_mfma_f32_16x16x32_bf16 v[168:171], v[120:123], v[120:123], 0
    ds_read_b128 v[112:115], v116 offset:0
    v_mfma_f32_16x16x32_bf16 v[124:127], v[72:75], v[72:75], 0
    ds_read_b128 v[116:119], v116 offset:64
    v_mad_u32_u16 v122, v207, s57, v248 op_sel:[0,0,0,0]
    ds_read2_b32 v[120:121], v122 offset0:0 offset1:2
    v_mfma_f32_16x16x32_bf16 v[124:127], v[76:79], v[76:79], v[124:127]
    ds_read2_b32 v[122:123], v122 offset0:4 offset1:6
    ds_read_b128 v[204:207], v214 offset:0
    v_mfma_f32_16x16x32_bf16 v[128:131], v[80:83], v[72:75], 0
    v_fmac_f32 v217, v189, v68
    v_fmac_f32 v217, v196, v200
    v_mfma_f32_16x16x32_bf16 v[128:131], v[84:87], v[76:79], v[128:131]
    v_fmac_f32 v217, v192, v69
    v_fmac_f32 v217, v197, v201
    v_mfma_f32_16x16x32_bf16 v[132:135], v[80:83], v[80:83], 0
    v_fmac_f32 v217, v193, v69
    v_fmac_f32 v217, v198, v202
    v_mfma_f32_16x16x32_bf16 v[132:135], v[84:87], v[84:87], v[132:135]
    v_fmac_f32 v217, v199, v203
    v_fmac_f32 v209, v153, v53
    v_mfma_f32_16x16x32_bf16 v[136:139], v[88:91], v[80:83], 0
    v_fmac_f32 v208, v154, v54
    v_fmac_f32 v209, v155, v55
    v_mfma_f32_16x16x32_bf16 v[136:139], v[92:95], v[84:87], v[136:139]
    v_fmac_f32 v208, v164, v60
    v_fmac_f32 v209, v165, v61
    v_mfma_f32_16x16x32_bf16 v[140:143], v[88:91], v[72:75], 0
    v_fmac_f32 v208, v166, v62
    v_fmac_f32 v209, v167, v63
    v_mfma_f32_16x16x32_bf16 v[140:143], v[92:95], v[76:79], v[140:143]
    s_waitcnt lgkmcnt(7)
    v_add_f32 v209, v209, v217
    v_smfmac_f32_16x16x64_bf16 v[196:199], v[8:11], v[132:139], v216
    v_fmac_f32 v208, v168, v70
    v_mfma_f32_16x16x32_bf16 v[144:147], v[96:99], v[72:75], 0
    v_fmac_f32 v208, v169, v71
    v_add_f32 v210, v208, v209
    v_mfma_f32_16x16x32_bf16 v[144:147], v[100:103], v[76:79], v[144:147]
    v_fma_f32 v208, v124, v0, -v217
    v_mul_f32 v209, v125, v1
    v_mfma_f32_16x16x32_bf16 v[148:151], v[80:83], v[96:99], 0
    v_fmac_f32 v208, v126, v2
    v_fmac_f32 v209, v127, v3
    v_mfma_f32_16x16x32_bf16 v[148:151], v[84:87], v[100:103], v[148:151]
    v_fmac_f32 v208, v128, v4
    v_fmac_f32 v209, v129, v5
    v_mfma_f32_16x16x32_bf16 v[152:155], v[88:91], v[96:99], 0
    v_fmac_f32 v208, v130, v6
    v_fmac_f32 v209, v131, v7
    v_mfma_f32_16x16x32_bf16 v[152:155], v[92:95], v[100:103], v[152:155]
    v_fmac_f32 v208, v140, v12
    v_fmac_f32 v209, v141, v13
    v_mfma_f32_16x16x32_bf16 v[156:159], v[88:91], v[88:91], 0
    v_fmac_f32 v208, v142, v14
    v_fmac_f32 v209, v143, v15
    v_mfma_f32_16x16x32_bf16 v[156:159], v[92:95], v[92:95], v[156:159]
    v_fmac_f32 v208, v144, v16
    v_fmac_f32 v209, v145, v17
    v_smfmac_f32_16x16x64_bf16 v[196:199], v[20:23], v[148:155], v216
    v_fmac_f32 v208, v146, v18
    v_mfma_f32_16x16x32_bf16 v[160:163], v[96:99], v[96:99], 0
    s_waitcnt lgkmcnt(0)
    v_fmac_f32 v209, v147, v19
    v_mfma_f32_16x16x32_bf16 v[160:163], v[100:103], v[100:103], v[160:163]
    v_fmac_f32 v208, v156, v24
    v_fmac_f32 v209, v157, v25
    v_mfma_f32_16x16x32_bf16 v[124:127], v[104:107], v[72:75], 0
    v_fmac_f32 v208, v158, v26
    v_fmac_f32 v209, v159, v27
    v_mfma_f32_16x16x32_bf16 v[124:127], v[108:111], v[76:79], v[124:127]
    v_add_f32_dpp v220, v220, v220 quad_perm:[1,0,3,2] row_mask:0xf bank_mask:0xf
    s_sub_u32 s58, s58, 1
    v_mfma_f32_16x16x32_bf16 v[128:131], v[112:115], v[72:75], 0
    v_fmac_f32 v208, v160, v28
    v_fmac_f32 v209, v161, v29
    v_mfma_f32_16x16x32_bf16 v[128:131], v[116:119], v[76:79], v[128:131]
    v_fmac_f32 v208, v162, v30
    v_fmac_f32 v209, v163, v31
    v_smfmac_f32_16x16x64_bf16 v[172:175], v[120:123], v[72:79], v250
    v_mad_u32_u16 v76, v204, s57, v213 op_sel:[0,0,0,0]
    v_mfma_f32_16x16x32_bf16 v[132:135], v[104:107], v[80:83], 0
    ds_read_b128 v[72:75], v76 offset:0
    ds_read_b128 v[76:79], v76 offset:64
    v_smfmac_f32_16x16x64_bf16 v[196:199], v[32:35], v[124:131], v216
    v_add_f32_dpp v220, v220, v220 quad_perm:[2,3,0,1] row_mask:0xf bank_mask:0xf
    v_mfma_f32_16x16x32_bf16 v[132:135], v[108:111], v[84:87], v[132:135]
    v_mul_f32 v217, v172, v64
    v_mfma_f32_16x16x32_bf16 v[136:139], v[112:115], v[80:83], 0
    v_fmac_f32 v217, v173, v64
    v_add_f32_dpp v220, v220, v220 row_half_mirror row_mask:0xf bank_mask:0xf
    v_mfma_f32_16x16x32_bf16 v[136:139], v[116:119], v[84:87], v[136:139]
    v_smfmac_f32_16x16x64_bf16 v[176:179], v[120:123], v[80:87], v250
    v_mad_u32_u16 v84, v204, s57, v213 op_sel:[1,0,0,0]
    v_mfma_f32_16x16x32_bf16 v[140:143], v[104:107], v[88:91], 0
    ds_read_b128 v[80:83], v84 offset:0
    ds_read_b128 v[84:87], v84 offset:64
    v_mfma_f32_16x16x32_bf16 v[140:143], v[108:111], v[92:95], v[140:143]
    v_fmac_f32 v208, v132, v36
    v_fmac_f32 v209, v133, v37
    v_mfma_f32_16x16x32_bf16 v[144:147], v[112:115], v[88:91], 0
    v_fmac_f32 v217, v176, v65
    v_fmac_f32 v208, v134, v38
    v_mfma_f32_16x16x32_bf16 v[144:147], v[116:119], v[92:95], v[144:147]
    v_fmac_f32 v217, v177, v65
    v_fmac_f32 v209, v135, v39
    v_smfmac_f32_16x16x64_bf16 v[180:183], v[120:123], v[88:95], v250
    v_mad_u32_u16 v92, v205, s57, v213 op_sel:[0,0,0,0]
    v_mfma_f32_16x16x32_bf16 v[148:151], v[104:107], v[96:99], 0
    ds_read_b128 v[88:91], v92 offset:0
    ds_read_b128 v[92:95], v92 offset:64
    v_smfmac_f32_16x16x64_bf16 v[196:199], v[44:47], v[140:147], v216
    v_fmac_f32 v208, v136, v40
    v_mfma_f32_16x16x32_bf16 v[148:151], v[108:111], v[100:103], v[148:151]
    v_fmac_f32 v217, v180, v66
    v_fmac_f32 v209, v137, v41
    v_mfma_f32_16x16x32_bf16 v[152:155], v[112:115], v[96:99], 0
    v_fmac_f32 v217, v181, v66
    v_fmac_f32 v208, v138, v42
    v_mfma_f32_16x16x32_bf16 v[152:155], v[116:119], v[100:103], v[152:155]
    v_fmac_f32 v209, v139, v43
    v_cndmask_b32_dpp v212, v212, v220, vcc row_shr:1 row_mask:0xf bank_mask:0xf bound_ctrl:0
    v_smfmac_f32_16x16x64_bf16 v[184:187], v[120:123], v[96:103], v250
    v_mad_u32_u16 v100, v205, s57, v213 op_sel:[1,0,0,0]
    v_mfma_f32_16x16x32_bf16 v[156:159], v[104:107], v[104:107], 0
    ds_read_b128 v[96:99], v100 offset:0
    ds_read_b128 v[100:103], v100 offset:64
    v_mfma_f32_16x16x32_bf16 v[156:159], v[108:111], v[108:111], v[156:159]
    v_fmac_f32 v208, v148, v48
    v_fmac_f32 v209, v149, v49
    v_mfma_f32_16x16x32_bf16 v[160:163], v[112:115], v[104:107], 0
    v_fmac_f32 v217, v184, v67
    v_fmac_f32 v208, v150, v50
    v_mfma_f32_16x16x32_bf16 v[160:163], v[116:119], v[108:111], v[160:163]
    v_fmac_f32 v217, v185, v67
    v_fmac_f32 v209, v151, v51
    v_smfmac_f32_16x16x64_bf16 v[188:191], v[120:123], v[104:111], v250
    v_mad_u32_u16 v108, v206, s57, v213 op_sel:[0,0,0,0]
    v_mfma_f32_16x16x32_bf16 v[164:167], v[112:115], v[112:115], 0
    ds_read_b128 v[104:107], v108 offset:0
    ds_read_b128 v[108:111], v108 offset:64
    v_smfmac_f32_16x16x64_bf16 v[196:199], v[56:59], v[156:163], v216
    s_waitcnt lgkmcnt(4)
    v_mfma_f32_16x16x32_bf16 v[164:167], v[116:119], v[116:119], v[164:167]
    v_fmac_f32 v217, v188, v68
    v_fmac_f32 v208, v152, v52
    v_smfmac_f32_16x16x64_bf16 v[192:195], v[120:123], v[112:119], v250
    v_mad_u32_u16 v116, v206, s57, v213 op_sel:[1,0,0,0]
    v_mfma_f32_16x16x32_bf16 v[168:171], v[120:123], v[120:123], 0
    ds_read_b128 v[112:115], v116 offset:0
    s_cbranch_scc0 k1_kernel_loop
    s_nop 7
    v_fmac_f32 v217, v189, v68
    v_fmac_f32 v217, v196, v200
    v_fmac_f32 v217, v192, v69
    v_fmac_f32 v217, v197, v201
    v_fmac_f32 v217, v193, v69
    v_fmac_f32 v217, v198, v202
    v_fmac_f32 v217, v199, v203
    v_fmac_f32 v209, v153, v53
    v_fmac_f32 v208, v154, v54
    v_fmac_f32 v209, v155, v55
    v_fmac_f32 v208, v164, v60
    v_fmac_f32 v209, v165, v61
    v_fmac_f32 v208, v166, v62
    v_fmac_f32 v209, v167, v63
    v_add_f32 v209, v209, v217
    v_fmac_f32 v208, v168, v70
    v_fmac_f32 v208, v169, v71
    v_add_f32 v211, v208, v209
    v_and_b32 v40, 7, v255
    s_mul_i32 s76, s36, 7
    v_permlane32_swap_b32 v210, v211
    v_add_f32 v219, v210, v211
    s_waitcnt lgkmcnt(0)
    v_lshrrev_b32 v41, 5, v255
    v_permlane16_swap_b32 v218, v219
    v_add_f32 v220, v218, v219
    s_xor_b32 s76, s76, 7
    v_bfe_u32 v42, v255, 4, 1
    v_add_f32_dpp v220, v220, v220 quad_perm:[1,0,3,2] row_mask:0xf bank_mask:0xf
    v_xor_b32 v40, s76, v40
    v_lshl_add_u32 v41, v42, 1, v41
    v_add_f32_dpp v220, v220, v220 quad_perm:[2,3,0,1] row_mask:0xf bank_mask:0xf
    s_lshl_b32 s74, s72, 2
    v_lshl_add_u32 v40, v40, 2, v41
    v_add_f32_dpp v220, v220, v220 row_half_mirror row_mask:0xf bank_mask:0xf
    v_cndmask_b32_dpp v212, v212, v220, vcc row_shr:1 row_mask:0xf bank_mask:0xf bound_ctrl:0
    s_lshl_b32 s76, s36, 16
    v_lshlrev_b32 v113, 2, v40
    v_add_f32_dpp v112, v212, v212 row_ror:8 row_mask:0xf bank_mask:0xf
    s_add_u32 s74, s74, s76
    s_add_u32 s74, s74, 29360128
    s_waitcnt vmcnt(0)
    v_min_u32 v112, -2, v112
    s_branch k1_kernel_k2
k1_kernel_last:
    s_endpgm
.section .rodata,"a"
.p2align 6
.amdhsa_kernel standalone__deep_cross_pnn__recsys_kernel
  .amdhsa_next_free_vgpr 256
  .amdhsa_next_free_sgpr 102
  .amdhsa_accum_offset 256
  .amdhsa_group_segment_fixed_size 0
  .amdhsa_kernarg_size 80
  .amdhsa_user_sgpr_count 2
  .amdhsa_user_sgpr_kernarg_segment_ptr 1
  .amdhsa_system_sgpr_workgroup_id_x 1
.end_amdhsa_kernel
```

```asm
; @launch grid=(256,1,1) block=(512,1,1) lds=163840
.amdgcn_target "amdgcn-amd-amdhsa--gfx950"
.text
.globl standalone__deep_cross_pnn__recsys_kernel
.p2align 8
.type standalone__deep_cross_pnn__recsys_kernel,@function
standalone__deep_cross_pnn__recsys_kernel:

    s_cmp_ge_u32 s2, 256
    s_cbranch_scc1 k1_kernel_end

    s_load_dwordx8 s[4:11], s[0:1], 0
    s_load_dwordx2 s[12:13], s[0:1], 72
    s_load_dwordx2 s[52:53], s[0:1], 64

    v_cmp_gt_u32 vcc, 40, v0
    s_and_saveexec_b64 s[48:49], vcc
    s_cbranch_execz k1_kernel_ncp
    s_getpc_b64 s[46:47]
k1_kernel_pc:
    s_bfe_u32 s38, s2, 0x40003
    s_lshl_b32 s38, s38, 7
    v_lshl_add_u32 v2, v0, 11, s38
    v_min_u32 v2, k1_kernel_last-k1_kernel_pc, v2
    global_load_dword v250, v2, s[46:47]
k1_kernel_ncp:
    s_mov_b64 exec, s[48:49]

    v_lshrrev_b32 v1, 6, v0
    v_and_b32 v255, 63, v0
    s_bfe_u32 s36, s2, 0x10003
    v_readfirstlane_b32 s3, v1
    s_lshr_b32 s37, s2, 4
    s_lshl_b32 s37, s37, 3
    s_and_b32 s38, s2, 7
    s_or_b32 s37, s37, s38
    v_lshlrev_b32 v254, 4, v255
    v_mov_b32 v252, 144144
    v_mov_b32 v253, 1
    v_mov_b32 v40, 0
    v_lshl_add_u32 v41, v0, 2, v252
    v_cmp_gt_u32 vcc, 8, v0
    s_and_saveexec_b64 s[46:47], vcc
    ds_write_b32 v41, v40
    s_mov_b64 exec, s[46:47]
    v_mul_u32_u24 v6, 57, v255
    v_lshrrev_b32 v6, 9, v6
    v_mul_u32_u24 v5, 9, v6
    v_sub_u32 v5, v255, v5
    v_cmp_gt_u32 s[40:41], 8, v5
    s_lshl_b32 s38, s36, 7
    v_lshl_add_u32 v5, v5, 4, s38
    v_lshl_add_u32 v83, v6, 8, v5
    s_and_b32 s56, s3, 3
    s_bitset0_b32 s41, 31
    s_lshr_b32 s42, s2, 3
    s_mul_i32 s42, s42, 36
    s_lshr_b32 s42, s42, 5
    s_lshl_b32 s42, s42, 2
    s_add_u32 s42, s42, s56
    s_mov_b32 s43, s42
    s_mov_b32 s50, s36
    s_lshl_b32 s72, s37, 7
    s_lshl_b32 s73, s3, 5
    s_add_u32 s72, s72, s73
    s_mul_i32 s74, s72, 400
    s_mul_i32 s45, s36, 11200
    s_add_u32 s74, s74, s45
    s_lshl_b32 s38, s3, 10
    s_add_u32 m0, s38, 144384

    s_mov_b32 s18, 6553600
    s_mov_b32 s19, 0x00020000
    s_mov_b32 s22, 256000
    s_mov_b32 s23, 0x00020000
    s_mov_b32 s26, 20000
    s_mov_b32 s27, 0x00020000
    s_mov_b32 s30, 13107200
    s_mov_b32 s31, 0x00020000
    s_mov_b32 s34, 268435456
    s_mov_b32 s35, 0x00020000
    s_mov_b32 s14, 268435456
    s_mov_b32 s15, 0x00020000
    s_mov_b32 s54, 256
    s_mov_b32 s55, 0x00020000

    v_bfe_u32 v5, v255, 2, 2
    v_mul_u32_u24 v5, 200, v5
    v_and_b32 v6, 3, v255
    v_lshl_add_u32 v5, v6, 5, v5
    v_and_b32 v6, 32, v255
    v_lshl_add_u32 v5, v6, 2, v5
    v_and_b32 v6, 16, v255
    v_add_u32 v5, v5, v6
    s_movk_i32 s39, 19200
    s_cmp_ge_u32 s3, 4
    s_waitcnt lgkmcnt(0)
    s_barrier
    s_cbranch_scc1 k1_kernel_dma

    s_mov_b32 s24, s8
    s_and_b32 s25, s9, 0xffff
    buffer_load_dwordx4 v254, s[24:27], s38 offen lds
    s_add_u32 s38, s38, 4096
    s_add_u32 m0, s38, 144384
    s_mov_b32 s16, s4
    s_and_b32 s17, s5, 0xffff
    buffer_load_dwordx4 v254, s[24:27], s38 offen lds
    s_add_u32 s38, s38, 4096
    s_add_u32 m0, s38, 144384
    v_cmp_lt_u32 vcc, 24, v255
    buffer_load_dwordx4 v254, s[24:27], s38 offen lds
    s_add_u32 s38, s38, 4096
    s_add_u32 m0, s38, 144384
    v_subbrev_co_u32 v249, vcc, 0, v255, vcc
    buffer_load_dwordx4 v254, s[24:27], s38 offen lds
    s_add_u32 s38, s38, 4096
    s_min_u32 s38, s38, 18432
    s_add_u32 m0, s38, 144384
    v_min_u32 v249, 49, v249
    v_lshlrev_b32 v249, 4, v249
    buffer_load_dwordx4 v254, s[24:27], s38 offen lds
    buffer_load_dwordx4 v[232:235], v5, s[24:27], s39 offen
    buffer_load_dwordx4 v[240:243], v249, s[16:19], s74 offen offset:0
    buffer_load_dwordx4 v[244:247], v249, s[16:19], s74 offen offset:800

    s_mul_i32 s77, s36, -3200
    s_mul_i32 s78, s72, 400
    s_addk_i32 s77, 1600
    s_add_u32 s79, s78, 11200
    s_add_u32 s74, s74, s77

    s_branch k1_kernel_main
k1_kernel_dma:
    s_mov_b32 s20, s6
    s_and_b32 s21, s7, 0xffff
    s_mov_b64 exec, s[40:41]
k1_kernel_dml:

    s_min_u32 s38, s42, 142
    s_mul_i32 m0, s38, 1008
    s_mul_i32 s39, s38, 1792
    s_add_u32 s42, s42, 4
    buffer_load_dwordx4 v83, s[20:23], s39 offen lds
    s_cmp_ge_u32 s42, 144
    s_cselect_b32 s38, 144, 0
    s_sub_u32 s42, s42, s38
    s_cmp_lg_u32 s42, s43
    s_cbranch_scc1 k1_kernel_dml
    s_mov_b64 exec, -1

    s_mov_b32 s16, s4
    s_and_b32 s17, s5, 0xffff
    s_mov_b32 s20, s6
    s_and_b32 s21, s7, 0xffff
    s_mov_b32 s28, s10
    s_and_b32 s29, s11, 0xffff
    s_mov_b32 s32, s12
    s_and_b32 s33, s13, 0xffff
    s_and_b32 s13, s13, 0xffff
    s_and_b32 s53, s53, 0xffff
k1_kernel_aux:

    s_setprio 0
    v_mov_b32 v8, v255
    v_mov_b32 v9, v254
    v_mov_b32 v10, v253
    v_mov_b32 v11, v252
    s_mov_b32 s51, s2
    s_mov_b32 s64, 0
    s_mov_b32 s65, 0

k1_kernel_unit:

    s_bfe_u32 s60, s51, 0x10003
    s_lshr_b32 s38, s51, 7
    s_xnor_b32 s36, s60, s38
    s_and_b32 s36, s36, 1

    s_lshr_b32 s38, s51, 4
    s_and_b32 s39, s51, 7
    s_sub_u32 s57, 2, s36
    s_lshl_b32 s57, s39, s57
    s_lshl_b32 s37, s36, 5
    s_add_u32 s57, s57, s37
    s_add_u32 s57, s57, s56
    s_mul_i32 s37, s38, 48
    s_add_u32 s37, s37, s57
    s_lshl_b32 s38, s38, 1
    s_lshr_b32 s39, s39, 2
    s_add_u32 s38, s38, s39
    s_add_u32 s38, s38, 768
    s_and_b32 s57, s57, 7
    s_cmp_eq_u32 s57, 2
    s_cselect_b32 s38, s38, 1000
    s_lshl_b32 s39, s36, 1
    s_and_b32 s39, s39, s56
    s_cselect_b32 s57, s38, s37

    s_mov_b32 s63, s36
    s_mov_b32 s36, s60
    s_lshr_b32 s37, s51, 4
    s_lshl_b32 s37, s37, 3
    s_and_b32 s38, s51, 7
    s_or_b32 s37, s37, s38
    s_and_b32 s58, s56, 1
    s_lshl_b32 s59, s37, 1
    s_add_u32 s58, s58, s59
    s_lshr_b32 s59, s56, 1
    s_xor_b32 s62, s59, 1
    s_and_b32 s59, s59, s63
    s_add_u32 s61, s63, 6
    s_mul_i32 s61, s61, s62
    s_mul_i32 s60, s36, 12
    s_add_u32 s61, s61, s60
    s_mul_i32 s60, s58, 25600
    s_lshl4_add_u32 s60, s61, s60
    s_cmp_eq_u32 s61, 7
    s_cselect_b32 s38, 5, 99
    s_movk_i32 s61, 400
    v_lshrrev_b32 v1, 3, v8
    v_and_b32 v2, 7, v8
    v_cmp_ne_u32 vcc, s38, v2
    v_mul_u32_u24 v0, s61, v1
    v_cmp_gt_u32 s[48:49], 7, v2
    v_cndmask_b32 v5, 17, v2, vcc
    v_lshl_add_u32 v0, v5, 4, v0
    v_and_b32 v5, 15, v8
    v_and_b32 v6, 48, v8
    v_lshl_add_u32 v7, v5, 8, v6
    s_lshl_b32 s44, s56, 15
    s_xor_b32 s38, s50, 1
    s_lshl_b32 s38, s38, 7
    s_add_u32 s44, s44, s38

    s_mov_b64 exec, s[48:49]
    buffer_load_dwordx4 v[224:227], v0, s[16:19], s60 offen
    s_add_u32 s60, s60, 3200
    buffer_load_dwordx4 v[228:231], v0, s[16:19], s60 offen
    s_add_u32 s60, s60, 3200
    buffer_load_dwordx4 v[232:235], v0, s[16:19], s60 offen
    s_add_u32 s60, s60, 3200
    buffer_load_dwordx4 v[236:239], v0, s[16:19], s60 offen
    s_add_u32 s60, s60, 3200
    buffer_load_dwordx4 v[240:243], v0, s[16:19], s60 offen
    s_add_u32 s60, s60, 3200
    buffer_load_dwordx4 v[244:247], v0, s[16:19], s60 offen
    s_add_u32 s60, s60, 3200
    buffer_load_dwordx4 v[248:251], v0, s[16:19], s60 offen
    s_add_u32 s60, s60, 3200
    buffer_load_dwordx4 v[252:255], v0, s[16:19], s60 offen
    s_add_u32 s60, s60, 3200
    s_mov_b64 exec, -1

    s_lshr_b32 s78, s57, 5
    s_bfe_u32 s79, s57, 0x20003
    s_bfe_u32 s80, s57, 0x20001
    s_and_b32 s81, s57, 1
    s_lshl_b32 s77, s78, 2
    s_lshl_b32 s83, s81, 1
    s_add_u32 s77, s77, s83
    s_lshl_b32 s77, s77, 7
    s_lshl_b32 s83, s79, 5
    s_add_u32 s77, s77, s83
    s_lshl_b32 s83, s80, 3
    s_add_u32 s77, s77, s83
    s_lshl_b32 s77, s77, 10
    s_lshl_b32 s82, s78, 12
    s_lshl_b32 s83, s79, 10
    s_add_u32 s82, s82, s83
    s_lshl_b32 s83, s80, 8
    s_add_u32 s82, s82, s83
    s_lshl_b32 s83, s81, 7
    s_add_u32 s82, s82, s83
    s_mov_b32 s84, 205312
    v_lshrrev_b32 v3, 2, v8
    v_and_b32 v4, 3, v8
    v_mul_lo_u32 v14, v3, s84
    v_lshl_add_u32 v14, v4, 4, v14
    s_lshl_b32 s61, s56, 12
    s_add_u32 s61, s61, 147456
    v_and_b32 v3, 3, v3
    v_lshlrev_b32 v36, 6, v8
    v_lshl_add_u32 v36, v3, 4, v36
    v_add_u32 v36, s61, v36
    v_xor_b32 v37, 16, v36
    v_xor_b32 v38, 32, v36
    v_xor_b32 v39, 48, v36
    v_and_b32 v3, 48, v8
    v_xor_b32 v15, v3, v9
    v_add_u32 v15, s61, v15
    s_mov_b32 s84, 0x05040100
    s_mov_b32 s85, 0x07060302
    s_cmp_eq_u32 s64, 0
    s_cbranch_scc1 k1_kernel_nsig0
    s_waitcnt vmcnt(0)

k1_kernel_nsig0:

    s_waitcnt vmcnt(8)
    s_cmp_lg_u32 s64, 0
    s_cbranch_scc1 k1_kernel_nsig

    s_mov_b64 exec, 1
    ds_add_u32 v11, v10 offset:16
    s_mov_b64 exec, -1

k1_kernel_nsig:
    s_setprio 3

    s_lshl_b32 s61, s56, 12
    s_add_u32 s61, s61, 147456
    v_lshlrev_b32 v86, 2, v8
    v_add_u32 v86, s61, v86
    v_and_b32 v85, 0xffffff80, v86
    v_and_b32 v123, 32, v8
    s_add_u32 s61, s61, 256
    v_mul_u32_u24 v31, 56, v8
    v_add_u32 v31, s61, v31
    v_mul_u32_u24 v34, 56, v1
    v_lshl_add_u32 v34, v2, 3, v34
    v_add_u32 v34, s61, v34
    s_lshl_b32 s61, s62, s63
    v_add_u32 v2, s61, v2
    v_subrev_u32 v3, 5, v2
    v_min_u32 v2, v2, v3
    v_mov_b32 v13, 0
    v_mul_u32_u24 v2, 0x10001, v2
    v_lshlrev_b32 v2, 12, v2
    v_add_u32 v32, 67108864, v2
    v_add_u32 v33, 201328640, v2
    v_mov_b32 v71, 0xf00
    s_add_u32 s61, s63, 7
    s_xor_b32 s63, s63, 1
    s_cmp_eq_u32 s62, 1
    s_cselect_b32 s62, s61, s63
    s_mul_i32 s63, s36, 13
    s_add_u32 s62, s62, s63
    s_lshl_b32 s62, s62, 7
    s_and_b32 s63, s58, 127
    s_add_u32 s62, s62, s63
    s_lshl_b32 s62, s62, 10
    s_add_u32 s62, s62, 16777216
    s_cmp_eq_u32 s59, 1
    s_cselect_b32 s63, -16, 0x0ffffff0
    s_movk_i32 s66, 0x7c
    s_mov_b32 s67, 0x001f001f
    s_mov_b32 s75, 0x06040200
    v_mov_b32 v54, 0x08040201
    v_mov_b32 v55, 0x80402010

    s_lshl_b32 s72, s2, 15
    s_lshl_b32 s73, s56, 13
    s_add_u32 s72, s72, s73
    s_add_u32 s72, s72, 20971520
    s_lshl_b32 s73, s36, 9
    s_lshl2_add_u32 s73, s37, s73
    s_add_u32 s73, s73, s56
    s_lshl_b32 s73, s73, 7
    s_add_u32 s73, s73, 29360128

k1_kernel_wf3:

    ds_read_b32 v12, v11 offset:12
    s_waitcnt lgkmcnt(0)
    v_readfirstlane_b32 s45, v12
    s_cmp_lt_u32 s45, 4
    s_cbranch_scc1 k1_kernel_wf3

    s_mov_b64 exec, s[48:49]

    s_waitcnt vmcnt(7)
    v_lshl_or_b32 v224, v225, 16, v224
    v_lshl_or_b32 v225, v227, 16, v226
    v_add_u32 v224, v32, v224
    v_add_u32 v225, v33, v225
    ds_write_b64 v34, v[224:225] offset:0

    s_waitcnt vmcnt(6)
    v_lshl_or_b32 v228, v229, 16, v228
    v_lshl_or_b32 v229, v231, 16, v230
    v_add_u32 v228, v32, v228
    v_add_u32 v229, v33, v229
    ds_write_b64 v34, v[228:229] offset:448

    s_waitcnt vmcnt(5)
    v_lshl_or_b32 v232, v233, 16, v232
    v_lshl_or_b32 v233, v235, 16, v234
    v_add_u32 v232, v32, v232
    v_add_u32 v233, v33, v233
    ds_write_b64 v34, v[232:233] offset:896

    s_waitcnt vmcnt(4)
    v_lshl_or_b32 v236, v237, 16, v236
    v_lshl_or_b32 v237, v239, 16, v238
    v_add_u32 v236, v32, v236
    v_add_u32 v237, v33, v237
    ds_write_b64 v34, v[236:237] offset:1344

    s_waitcnt vmcnt(3)
    v_lshl_or_b32 v240, v241, 16, v240
    v_lshl_or_b32 v241, v243, 16, v242
    v_add_u32 v240, v32, v240
    v_add_u32 v241, v33, v241
    ds_write_b64 v34, v[240:241] offset:1792

    s_waitcnt vmcnt(2)
    v_lshl_or_b32 v244, v245, 16, v244
    v_lshl_or_b32 v245, v247, 16, v246
    v_add_u32 v244, v32, v244
    v_add_u32 v245, v33, v245
    ds_write_b64 v34, v[244:245] offset:2240

    s_waitcnt vmcnt(1)
    v_lshl_or_b32 v248, v249, 16, v248
    v_lshl_or_b32 v249, v251, 16, v250
    v_add_u32 v248, v32, v248
    v_add_u32 v249, v33, v249
    ds_write_b64 v34, v[248:249] offset:2688

    s_waitcnt vmcnt(0)
    v_lshl_or_b32 v252, v253, 16, v252
    v_lshl_or_b32 v253, v255, 16, v254
    v_add_u32 v252, v32, v252
    v_add_u32 v253, v33, v253
    ds_write_b64 v34, v[252:253] offset:3136

    s_mov_b64 exec, -1
    ds_read_b64 v[40:41], v31 offset:0
    ds_read_b64 v[42:43], v31 offset:8
    ds_read_b64 v[44:45], v31 offset:16
    ds_read_b64 v[46:47], v31 offset:24
    ds_read_b64 v[48:49], v31 offset:32
    ds_read_b64 v[50:51], v31 offset:40
    ds_read_b64 v[52:53], v31 offset:48

    s_waitcnt lgkmcnt(6)
    v_perm_b32 v72, v41, v40, s75
    v_lshrrev_b32 v73, 3, v72
    v_lshlrev_b32 v64, 2, v72
    v_and_b32 v72, 0x07070707, v72
    v_and_b32 v0, 0x03030303, v73
    v_perm_b32 v16, v55, v54, v72
    v_xor_b32 v23, v55, v16

    s_waitcnt lgkmcnt(5)
    v_perm_b32 v72, v43, v42, s75
    v_lshrrev_b32 v73, 3, v72
    v_lshlrev_b32 v65, 2, v72
    v_and_b32 v72, 0x07070707, v72
    v_and_b32 v1, 0x03030303, v73
    v_perm_b32 v17, v55, v54, v72
    v_xor_b32 v24, v55, v17

    s_waitcnt lgkmcnt(4)
    v_perm_b32 v72, v45, v44, s75
    v_lshrrev_b32 v73, 3, v72
    v_lshlrev_b32 v66, 2, v72
    v_and_b32 v72, 0x07070707, v72
    v_and_b32 v2, 0x03030303, v73
    v_perm_b32 v18, v55, v54, v72
    v_xor_b32 v25, v55, v18

    s_waitcnt lgkmcnt(3)
    v_perm_b32 v72, v47, v46, s75
    v_lshrrev_b32 v73, 3, v72
    v_lshlrev_b32 v67, 2, v72
    v_and_b32 v72, 0x07070707, v72
    v_and_b32 v3, 0x03030303, v73
    v_perm_b32 v19, v55, v54, v72
    v_xor_b32 v26, v55, v19

    s_waitcnt lgkmcnt(2)
    v_perm_b32 v72, v49, v48, s75
    v_lshrrev_b32 v73, 3, v72
    v_lshlrev_b32 v68, 2, v72
    v_and_b32 v72, 0x07070707, v72
    v_and_b32 v4, 0x03030303, v73
    v_perm_b32 v20, v55, v54, v72
    v_xor_b32 v27, v55, v20

    s_waitcnt lgkmcnt(1)
    v_perm_b32 v72, v51, v50, s75
    v_lshrrev_b32 v73, 3, v72
    v_lshlrev_b32 v69, 2, v72
    v_and_b32 v72, 0x07070707, v72
    v_and_b32 v5, 0x03030303, v73
    v_perm_b32 v21, v55, v54, v72
    v_xor_b32 v28, v55, v21

    s_waitcnt lgkmcnt(0)
    v_perm_b32 v72, v53, v52, s75
    v_lshrrev_b32 v73, 3, v72
    v_lshlrev_b32 v70, 2, v72
    v_and_b32 v72, 0x07070707, v72
    v_and_b32 v6, 0x03030303, v73
    v_perm_b32 v22, v55, v54, v72
    v_xor_b32 v29, v55, v22

    ds_write_b32 v86, v13
    v_mov_b32 v71, s63
    v_subrev_u32 v30, 8, v31
    s_setprio 0
    v_ffbl_b32 v84, v71

    v_perm_b32 v72, v64, v64, v84
    v_and_or_b32 v72, v72, s66, v85
    ds_add_rtn_u32 v87, v72, v10
    ds_wrxchg_rtn_b32 v116, v86, v13

    s_waitcnt lgkmcnt(0)
    v_cmp_gt_u32 s[68:69], 2, v116

    v_cmpx_lt_u32 vcc, 1, v87
    s_nop 0
    v_lshrrev_b64 v[74:75], v123, s[68:69]
    v_perm_b32 v121, v74, v74, v1
    v_perm_b32 v122, v74, v74, v0
    v_and_b32 v121, v121, v17
    v_and_b32 v122, v122, v16
    v_msad_u8 v120, v24, v121, 0
    v_lshlrev_b32 v120, 4, v120
    v_msad_u8 v120, v23, v122, v120
    v_and_b32 v120, v120, v71

    v_ffbl_b32 v120, v120
    v_max_i32 v84, v120, v84
    s_mov_b64 exec, -1

    v_lshl_add_u32 v73, v84, 1, v30
    v_lshl_add_u32 v71, -1, v84, v71
    ds_read_u16 v80, v73 offset:0
    v_ffbl_b32 v84, v71

    v_perm_b32 v72, v64, v64, v84
    v_and_or_b32 v72, v72, s66, v85
    ds_add_rtn_u32 v87, v72, v10
    ds_wrxchg_rtn_b32 v116, v86, v13

    s_lshl_b32 s45, s2, 8
    s_add_u32 s45, s45, 14680064
    s_mov_b64 exec, 3
    buffer_store_dword v13, v9, s[12:15], s45 offen sc1
    s_mov_b64 exec, -1
    buffer_load_dwordx4 v[128:131], v9, s[28:31], s77 offen offset:0

    s_waitcnt lgkmcnt(0)
    v_cmp_gt_u32 s[68:69], 2, v116

    v_cmpx_lt_u32 vcc, 1, v87
    s_nop 0
    v_lshrrev_b64 v[74:75], v123, s[68:69]
    v_perm_b32 v121, v74, v74, v1
    v_perm_b32 v122, v74, v74, v0
    v_and_b32 v121, v121, v17
    v_and_b32 v122, v122, v16
    v_msad_u8 v120, v24, v121, 0
    v_lshlrev_b32 v120, 4, v120
    v_msad_u8 v120, v23, v122, v120
    v_and_b32 v120, v120, v71

    v_ffbl_b32 v120, v120
    v_max_i32 v84, v120, v84
    s_mov_b64 exec, -1

    v_lshl_add_u32 v73, v84, 1, v30
    v_lshl_add_u32 v71, -1, v84, v71
    ds_read_u16 v81, v73 offset:0
    v_ffbl_b32 v84, v71

    v_perm_b32 v72, v64, v64, v84
    v_and_or_b32 v72, v72, s66, v85
    ds_add_rtn_u32 v87, v72, v10
    ds_wrxchg_rtn_b32 v116, v86, v13

    s_lshl_b32 s45, s2, 10
    s_add_u32 s45, s45, 30408704
    s_mov_b32 exec_lo, 0x01010101
    s_mov_b32 exec_hi, 0x01010101
    buffer_store_dword v13, v9, s[12:15], s45 offen sc1
    s_mul_i32 s45, s2, 67584
    s_add_u32 s45, s45, 67108864
    s_mov_b64 exec, 1
    buffer_load_dword v117, v13, s[12:15], s45 offen
    s_mov_b64 exec, -1
    buffer_load_dwordx4 v[132:135], v9, s[28:31], s77 offen offset:1024

    s_waitcnt lgkmcnt(0)
    v_cmp_gt_u32 s[68:69], 2, v116

    v_cmpx_lt_u32 vcc, 1, v87
    s_nop 0
    v_lshrrev_b64 v[74:75], v123, s[68:69]
    v_perm_b32 v121, v74, v74, v1
    v_perm_b32 v122, v74, v74, v0
    v_and_b32 v121, v121, v17
    v_and_b32 v122, v122, v16
    v_msad_u8 v120, v24, v121, 0
    v_lshlrev_b32 v120, 4, v120
    v_msad_u8 v120, v23, v122, v120
    v_and_b32 v120, v120, v71

    v_ffbl_b32 v120, v120
    v_max_i32 v84, v120, v84
    s_mov_b64 exec, -1

    v_lshl_add_u32 v73, v84, 1, v30
    v_lshl_add_u32 v71, -1, v84, v71
    ds_read_u16 v82, v73 offset:0
    v_ffbl_b32 v84, v71

    v_perm_b32 v72, v64, v64, v84
    v_and_or_b32 v72, v72, s66, v85
    ds_add_rtn_u32 v87, v72, v10
    ds_wrxchg_rtn_b32 v116, v86, v13

    buffer_load_dwordx4 v[144:147], v9, s[28:31], s77 offen offset:2048

    s_waitcnt lgkmcnt(0)
    v_cmp_gt_u32 s[68:69], 2, v116

    v_cmpx_lt_u32 vcc, 1, v87
    s_nop 0
    v_lshrrev_b64 v[74:75], v123, s[68:69]
    v_perm_b32 v121, v74, v74, v1
    v_and_b32 v121, v121, v17
    v_msad_u8 v120, v24, v121, 0
    v_lshlrev_b32 v120, 4, v120
    v_and_b32 v120, v120, v71

    v_ffbl_b32 v120, v120
    v_max_i32 v84, v120, v84
    s_mov_b64 exec, -1

    v_lshl_add_u32 v73, v84, 1, v30
    v_lshl_add_u32 v71, -1, v84, v71
    ds_read_u16 v83, v73 offset:0
    v_lshrrev_b32 v71, 4, v71
    v_ffbl_b32 v84, v71

    v_perm_b32 v72, v65, v64, v84
    v_and_or_b32 v72, v72, s66, v85
    ds_add_rtn_u32 v87, v72, v10
    ds_wrxchg_rtn_b32 v116, v86, v13

    buffer_load_dwordx4 v[148:151], v9, s[28:31], s77 offen offset:3072
    s_add_u32 s77, s77, 4096
    s_mov_b32 s70, 0x7fff7fff

    s_waitcnt lgkmcnt(0)
    v_cmp_gt_u32 s[68:69], 2, v116

    s_cmp_eq_u32 s59, 0
    v_lshl_or_b32 v76, v81, 16, v80
    v_lshl_or_b32 v77, v83, 16, v82
    s_cbranch_scc1 k1_kernel_nf0
    buffer_store_dwordx4 v[76:79], v9, s[32:35], s62 offen sc1
    s_add_u32 s62, s62, 262144
k1_kernel_nf0:
    v_cmpx_lt_u32 vcc, 1, v87
    v_bfe_i32 v119, s70, v71, 1
    v_lshrrev_b64 v[74:75], v123, s[68:69]
    v_perm_b32 v121, v74, v74, v2
    v_perm_b32 v122, v74, v74, v1
    v_and_b32 v121, v121, v18
    v_and_b32 v122, v122, v17
    v_msad_u8 v120, v25, v121, 0
    v_lshlrev_b32 v120, 4, v120
    v_msad_u8 v120, v24, v122, v120
    v_bitop3_b32 v120, v120, v71, v119 bitop3:0x80

    v_ffbl_b32 v120, v120
    v_max_i32 v84, v120, v84
    s_mov_b64 exec, -1

    v_lshl_add_u32 v73, v84, 1, v30
    v_lshl_add_u32 v71, -1, v84, v71
    ds_read_u16 v80, v73 offset:8
    v_ffbl_b32 v84, v71

    v_perm_b32 v72, v65, v64, v84
    v_and_or_b32 v72, v72, s66, v85
    ds_add_rtn_u32 v87, v72, v10
    ds_wrxchg_rtn_b32 v116, v86, v13

    buffer_load_dwordx4 v[160:163], v9, s[28:31], s77 offen offset:0
    s_mov_b32 s70, 0x977f977f

    s_waitcnt lgkmcnt(0)
    v_cmp_gt_u32 s[68:69], 2, v116

    v_cmpx_lt_u32 vcc, 1, v87
    v_bfe_i32 v119, s70, v71, 1
    v_lshrrev_b64 v[74:75], v123, s[68:69]
    v_perm_b32 v121, v74, v74, v2
    v_perm_b32 v122, v74, v74, v1
    v_and_b32 v121, v121, v18
    v_and_b32 v122, v122, v17
    v_msad_u8 v120, v25, v121, 0
    v_lshlrev_b32 v120, 4, v120
    v_msad_u8 v120, v24, v122, v120
    v_bitop3_b32 v120, v120, v71, v119 bitop3:0x80

    v_ffbl_b32 v120, v120
    v_max_i32 v84, v120, v84
    s_mov_b64 exec, -1

    v_lshl_add_u32 v73, v84, 1, v30
    v_lshl_add_u32 v71, -1, v84, v71
    ds_read_u16 v81, v73 offset:8
    v_ffbl_b32 v84, v71

    v_perm_b32 v72, v65, v64, v84
    v_and_or_b32 v72, v72, s66, v85
    ds_add_rtn_u32 v87, v72, v10
    ds_wrxchg_rtn_b32 v116, v86, v13

    buffer_load_dwordx4 v[164:167], v9, s[28:31], s77 offen offset:1024
    s_mov_b32 s70, 0xe997e997

    s_waitcnt lgkmcnt(0)
    v_cmp_gt_u32 s[68:69], 2, v116

    v_cmpx_lt_u32 vcc, 1, v87
    v_bfe_i32 v119, s70, v71, 1
    v_lshrrev_b64 v[74:75], v123, s[68:69]
    v_perm_b32 v121, v74, v74, v2
    v_perm_b32 v122, v74, v74, v1
    v_and_b32 v121, v121, v18
    v_and_b32 v122, v122, v17
    v_msad_u8 v120, v25, v121, 0
    v_lshlrev_b32 v120, 4, v120
    v_msad_u8 v120, v24, v122, v120
    v_bitop3_b32 v120, v120, v71, v119 bitop3:0x80

    v_ffbl_b32 v120, v120
    v_max_i32 v84, v120, v84
    s_mov_b64 exec, -1

    v_lshl_add_u32 v73, v84, 1, v30
    v_lshl_add_u32 v71, -1, v84, v71
    ds_read_u16 v82, v73 offset:8
    v_ffbl_b32 v84, v71

    v_perm_b32 v72, v65, v64, v84
    v_and_or_b32 v72, v72, s66, v85
    ds_add_rtn_u32 v87, v72, v10
    ds_wrxchg_rtn_b32 v116, v86, v13

    buffer_load_dwordx4 v[176:179], v9, s[28:31], s77 offen offset:2048
    s_add_u32 s47, s44, 12288
    buffer_load_dwordx4 v[56:59], v7, s[20:23], s47 offen offset:0
    buffer_load_dwordx4 v[60:63], v7, s[20:23], s47 offen offset:64
    s_mov_b32 s70, 0xfee9fee9

    s_waitcnt lgkmcnt(0)
    v_cmp_gt_u32 s[68:69], 2, v116

    v_cmpx_lt_u32 vcc, 1, v87
    v_bfe_i32 v119, s70, v71, 1
    v_lshrrev_b64 v[74:75], v123, s[68:69]
    v_perm_b32 v121, v74, v74, v2
    v_and_b32 v121, v121, v18
    v_msad_u8 v120, v25, v121, 0
    v_lshlrev_b32 v120, 4, v120
    v_bitop3_b32 v120, v120, v71, v119 bitop3:0x80

    v_ffbl_b32 v120, v120
    v_max_i32 v84, v120, v84
    s_mov_b64 exec, -1

    v_lshl_add_u32 v73, v84, 1, v30
    v_lshl_add_u32 v71, -1, v84, v71
    ds_read_u16 v83, v73 offset:8
    v_lshrrev_b32 v71, 4, v71
    v_ffbl_b32 v84, v71

    v_perm_b32 v72, v66, v65, v84
    v_and_or_b32 v72, v72, s66, v85
    ds_add_rtn_u32 v87, v72, v10
    ds_wrxchg_rtn_b32 v116, v86, v13

    buffer_load_dwordx4 v[180:183], v9, s[28:31], s77 offen offset:3072
    s_add_u32 s77, s77, 126976
    s_cmp_lg_u32 s64, 0
    s_cbranch_scc1 k1_kernel_nc8
    v_mov_b32 v121, -1
    v_lshlrev_b32 v122, 1, v8
    buffer_store_short v121, v122, s[12:15], s73 offen sc1
k1_kernel_nc8:
    s_add_u32 s47, s44, 16384
    buffer_load_dwordx4 v[88:91], v7, s[20:23], s47 offen offset:0
    buffer_load_dwordx4 v[92:95], v7, s[20:23], s47 offen offset:64
    s_mov_b32 s70, 0x7fff7fff

    s_waitcnt lgkmcnt(0)
    v_cmp_gt_u32 s[68:69], 2, v116

    s_cmp_eq_u32 s59, 1
    v_lshl_or_b32 v78, v81, 16, v80
    v_lshl_or_b32 v79, v83, 16, v82
    s_cbranch_scc1 k1_kernel_nf1
    buffer_store_dwordx4 v[76:79], v9, s[32:35], s62 offen sc1
    s_add_u32 s62, s62, 262144
k1_kernel_nf1:
    v_cmpx_lt_u32 vcc, 1, v87
    v_bfe_i32 v119, s70, v71, 1
    v_lshrrev_b64 v[74:75], v123, s[68:69]
    v_perm_b32 v121, v74, v74, v3
    v_perm_b32 v122, v74, v74, v2
    v_and_b32 v121, v121, v19
    v_and_b32 v122, v122, v18
    v_msad_u8 v120, v26, v121, 0
    v_lshlrev_b32 v120, 4, v120
    v_msad_u8 v120, v25, v122, v120
    v_bitop3_b32 v120, v120, v71, v119 bitop3:0x80

    v_ffbl_b32 v120, v120
    v_max_i32 v84, v120, v84
    s_mov_b64 exec, -1

    v_lshl_add_u32 v73, v84, 1, v30
    v_lshl_add_u32 v71, -1, v84, v71
    ds_read_u16 v80, v73 offset:16
    v_ffbl_b32 v84, v71

    v_perm_b32 v72, v66, v65, v84
    v_and_or_b32 v72, v72, s66, v85
    ds_add_rtn_u32 v87, v72, v10
    ds_wrxchg_rtn_b32 v116, v86, v13

    buffer_load_dwordx4 v[192:195], v9, s[28:31], s77 offen offset:0
    s_add_u32 s47, s44, 20480
    buffer_load_dwordx4 v[96:99], v7, s[20:23], s47 offen offset:0
    buffer_load_dwordx4 v[100:103], v7, s[20:23], s47 offen offset:64
    s_mov_b32 s70, 0x977f977f

    s_waitcnt lgkmcnt(0)
    v_cmp_gt_u32 s[68:69], 2, v116

    v_cmpx_lt_u32 vcc, 1, v87
    v_bfe_i32 v119, s70, v71, 1
    v_lshrrev_b64 v[74:75], v123, s[68:69]
    v_perm_b32 v121, v74, v74, v3
    v_perm_b32 v122, v74, v74, v2
    v_and_b32 v121, v121, v19
    v_and_b32 v122, v122, v18
    v_msad_u8 v120, v26, v121, 0
    v_lshlrev_b32 v120, 4, v120
    v_msad_u8 v120, v25, v122, v120
    v_bitop3_b32 v120, v120, v71, v119 bitop3:0x80

    v_ffbl_b32 v120, v120
    v_max_i32 v84, v120, v84
    s_mov_b64 exec, -1

    v_lshl_add_u32 v73, v84, 1, v30
    v_lshl_add_u32 v71, -1, v84, v71
    ds_read_u16 v81, v73 offset:16
    v_ffbl_b32 v84, v71

    v_perm_b32 v72, v66, v65, v84
    v_and_or_b32 v72, v72, s66, v85
    ds_add_rtn_u32 v87, v72, v10
    ds_wrxchg_rtn_b32 v116, v86, v13

    buffer_load_dwordx4 v[196:199], v9, s[28:31], s77 offen offset:1024
    s_add_u32 s47, s44, 24576
    buffer_load_dwordx4 v[104:107], v7, s[20:23], s47 offen offset:0
    buffer_load_dwordx4 v[108:111], v7, s[20:23], s47 offen offset:64
    s_mov_b32 s70, 0xe997e997

    s_waitcnt lgkmcnt(0)
    v_cmp_gt_u32 s[68:69], 2, v116

    v_cmpx_lt_u32 vcc, 1, v87
    v_bfe_i32 v119, s70, v71, 1
    v_lshrrev_b64 v[74:75], v123, s[68:69]
    v_perm_b32 v121, v74, v74, v3
    v_perm_b32 v122, v74, v74, v2
    v_and_b32 v121, v121, v19
    v_and_b32 v122, v122, v18
    v_msad_u8 v120, v26, v121, 0
    v_lshlrev_b32 v120, 4, v120
    v_msad_u8 v120, v25, v122, v120
    v_bitop3_b32 v120, v120, v71, v119 bitop3:0x80

    v_ffbl_b32 v120, v120
    v_max_i32 v84, v120, v84
    s_mov_b64 exec, -1

    v_lshl_add_u32 v73, v84, 1, v30
    v_lshl_add_u32 v71, -1, v84, v71
    ds_read_u16 v82, v73 offset:16
    v_ffbl_b32 v84, v71

    v_perm_b32 v72, v66, v65, v84
    v_and_or_b32 v72, v72, s66, v85
    ds_add_rtn_u32 v87, v72, v10
    ds_wrxchg_rtn_b32 v116, v86, v13

    buffer_load_dwordx4 v[208:211], v9, s[28:31], s77 offen offset:2048
    s_add_u32 s47, s44, 28672
    buffer_load_dwordx4 v[112:115], v7, s[20:23], s47 offen offset:0
    buffer_load_dwordx4 v[124:127], v7, s[20:23], s47 offen offset:64
    s_mov_b32 s70, 0xfee9fee9

    s_waitcnt lgkmcnt(0)
    v_cmp_gt_u32 s[68:69], 2, v116

    v_cmpx_lt_u32 vcc, 1, v87
    v_bfe_i32 v119, s70, v71, 1
    v_lshrrev_b64 v[74:75], v123, s[68:69]
    v_perm_b32 v121, v74, v74, v3
    v_and_b32 v121, v121, v19
    v_msad_u8 v120, v26, v121, 0
    v_lshlrev_b32 v120, 4, v120
    v_bitop3_b32 v120, v120, v71, v119 bitop3:0x80

    v_ffbl_b32 v120, v120
    v_max_i32 v84, v120, v84
    s_mov_b64 exec, -1

    v_lshl_add_u32 v73, v84, 1, v30
    v_lshl_add_u32 v71, -1, v84, v71
    ds_read_u16 v83, v73 offset:16
    v_lshrrev_b32 v71, 4, v71
    v_ffbl_b32 v84, v71

    v_perm_b32 v72, v67, v66, v84
    v_and_or_b32 v72, v72, s66, v85
    ds_add_rtn_u32 v87, v72, v10
    ds_wrxchg_rtn_b32 v116, v86, v13

    buffer_load_dwordx4 v[212:215], v9, s[28:31], s77 offen offset:3072
    s_add_u32 s77, s77, 4096
    s_add_u32 s47, s44, 131072
    buffer_load_dwordx4 v[136:139], v7, s[20:23], s47 offen offset:0
    buffer_load_dwordx4 v[140:143], v7, s[20:23], s47 offen offset:64
    s_mov_b32 s70, 0x7fff7fff

    s_waitcnt lgkmcnt(0)
    v_cmp_gt_u32 s[68:69], 2, v116

    s_cmp_eq_u32 s59, 0
    v_lshl_or_b32 v76, v81, 16, v80
    v_lshl_or_b32 v77, v83, 16, v82
    s_cbranch_scc1 k1_kernel_nf2
    buffer_store_dwordx4 v[76:79], v9, s[32:35], s62 offen sc1
    s_add_u32 s62, s62, 262144
k1_kernel_nf2:
    v_cmpx_lt_u32 vcc, 1, v87
    v_bfe_i32 v119, s70, v71, 1
    v_lshrrev_b64 v[74:75], v123, s[68:69]
    v_perm_b32 v121, v74, v74, v4
    v_perm_b32 v122, v74, v74, v3
    v_and_b32 v121, v121, v20
    v_and_b32 v122, v122, v19
    v_msad_u8 v120, v27, v121, 0
    v_lshlrev_b32 v120, 4, v120
    v_msad_u8 v120, v26, v122, v120
    v_bitop3_b32 v120, v120, v71, v119 bitop3:0x80

    v_ffbl_b32 v120, v120
    v_max_i32 v84, v120, v84
    s_mov_b64 exec, -1

    v_lshl_add_u32 v73, v84, 1, v30
    v_lshl_add_u32 v71, -1, v84, v71
    ds_read_u16 v80, v73 offset:24
    v_ffbl_b32 v84, v71

    v_perm_b32 v72, v67, v66, v84
    v_and_or_b32 v72, v72, s66, v85
    ds_add_rtn_u32 v87, v72, v10
    ds_wrxchg_rtn_b32 v116, v86, v13

    buffer_load_dwordx4 v[224:227], v9, s[28:31], s77 offen offset:0
    s_add_u32 s47, s44, 135168
    buffer_load_dwordx4 v[152:155], v7, s[20:23], s47 offen offset:0
    buffer_load_dwordx4 v[156:159], v7, s[20:23], s47 offen offset:64
    s_mov_b32 s70, 0x977f977f

    s_waitcnt lgkmcnt(0)
    v_cmp_gt_u32 s[68:69], 2, v116

    v_cmpx_lt_u32 vcc, 1, v87
    v_bfe_i32 v119, s70, v71, 1
    v_lshrrev_b64 v[74:75], v123, s[68:69]
    v_perm_b32 v121, v74, v74, v4
    v_perm_b32 v122, v74, v74, v3
    v_and_b32 v121, v121, v20
    v_and_b32 v122, v122, v19
    v_msad_u8 v120, v27, v121, 0
    v_lshlrev_b32 v120, 4, v120
    v_msad_u8 v120, v26, v122, v120
    v_bitop3_b32 v120, v120, v71, v119 bitop3:0x80

    v_ffbl_b32 v120, v120
    v_max_i32 v84, v120, v84
    s_mov_b64 exec, -1

    v_lshl_add_u32 v73, v84, 1, v30
    v_lshl_add_u32 v71, -1, v84, v71
    ds_read_u16 v81, v73 offset:24
    v_ffbl_b32 v84, v71

    v_perm_b32 v72, v67, v66, v84
    v_and_or_b32 v72, v72, s66, v85
    ds_add_rtn_u32 v87, v72, v10
    ds_wrxchg_rtn_b32 v116, v86, v13

    buffer_load_dwordx4 v[228:231], v9, s[28:31], s77 offen offset:1024
    s_add_u32 s47, s44, 139264
    buffer_load_dwordx4 v[168:171], v7, s[20:23], s47 offen offset:0
    buffer_load_dwordx4 v[172:175], v7, s[20:23], s47 offen offset:64
    s_mov_b32 s70, 0xe997e997

    s_waitcnt lgkmcnt(0)
    v_cmp_gt_u32 s[68:69], 2, v116

    v_cmpx_lt_u32 vcc, 1, v87
    v_bfe_i32 v119, s70, v71, 1
    v_lshrrev_b64 v[74:75], v123, s[68:69]
    v_perm_b32 v121, v74, v74, v4
    v_perm_b32 v122, v74, v74, v3
    v_and_b32 v121, v121, v20
    v_and_b32 v122, v122, v19
    v_msad_u8 v120, v27, v121, 0
    v_lshlrev_b32 v120, 4, v120
    v_msad_u8 v120, v26, v122, v120
    v_bitop3_b32 v120, v120, v71, v119 bitop3:0x80

    v_ffbl_b32 v120, v120
    v_max_i32 v84, v120, v84
    s_mov_b64 exec, -1

    v_lshl_add_u32 v73, v84, 1, v30
    v_lshl_add_u32 v71, -1, v84, v71
    ds_read_u16 v82, v73 offset:24
    v_ffbl_b32 v84, v71

    v_perm_b32 v72, v67, v66, v84
    v_and_or_b32 v72, v72, s66, v85
    ds_add_rtn_u32 v87, v72, v10
    ds_wrxchg_rtn_b32 v116, v86, v13

    buffer_load_dwordx4 v[240:243], v9, s[28:31], s77 offen offset:2048
    s_add_u32 s47, s44, 143360
    buffer_load_dwordx4 v[184:187], v7, s[20:23], s47 offen offset:0
    buffer_load_dwordx4 v[188:191], v7, s[20:23], s47 offen offset:64
    s_mov_b32 s70, 0xfee9fee9

    s_waitcnt lgkmcnt(0)
    v_cmp_gt_u32 s[68:69], 2, v116

    v_cmpx_lt_u32 vcc, 1, v87
    v_bfe_i32 v119, s70, v71, 1
    v_lshrrev_b64 v[74:75], v123, s[68:69]
    v_perm_b32 v121, v74, v74, v4
    v_and_b32 v121, v121, v20
    v_msad_u8 v120, v27, v121, 0
    v_lshlrev_b32 v120, 4, v120
    v_bitop3_b32 v120, v120, v71, v119 bitop3:0x80

    v_ffbl_b32 v120, v120
    v_max_i32 v84, v120, v84
    s_mov_b64 exec, -1

    v_lshl_add_u32 v73, v84, 1, v30
    v_lshl_add_u32 v71, -1, v84, v71
    ds_read_u16 v83, v73 offset:24
    v_lshrrev_b32 v71, 4, v71
    v_ffbl_b32 v84, v71

    v_perm_b32 v72, v68, v67, v84
    v_and_or_b32 v72, v72, s66, v85
    ds_add_rtn_u32 v87, v72, v10
    ds_wrxchg_rtn_b32 v116, v86, v13

    buffer_load_dwordx4 v[244:247], v9, s[28:31], s77 offen offset:3072
    s_add_u32 s47, s44, 147456
    buffer_load_dwordx4 v[200:203], v7, s[20:23], s47 offen offset:0
    buffer_load_dwordx4 v[204:207], v7, s[20:23], s47 offen offset:64
    s_mov_b32 s70, 0x7fff7fff

    s_waitcnt lgkmcnt(0)
    v_cmp_gt_u32 s[68:69], 2, v116

    s_cmp_eq_u32 s59, 1
    v_lshl_or_b32 v78, v81, 16, v80
    v_lshl_or_b32 v79, v83, 16, v82
    s_cbranch_scc1 k1_kernel_nf3
    buffer_store_dwordx4 v[76:79], v9, s[32:35], s62 offen sc1
    s_add_u32 s62, s62, 262144
k1_kernel_nf3:
    v_cmpx_lt_u32 vcc, 1, v87
    v_bfe_i32 v119, s70, v71, 1
    v_lshrrev_b64 v[74:75], v123, s[68:69]
    v_perm_b32 v121, v74, v74, v5
    v_perm_b32 v122, v74, v74, v4
    v_and_b32 v121, v121, v21
    v_and_b32 v122, v122, v20
    v_msad_u8 v120, v28, v121, 0
    v_lshlrev_b32 v120, 4, v120
    v_msad_u8 v120, v27, v122, v120
    v_bitop3_b32 v120, v120, v71, v119 bitop3:0x80

    v_ffbl_b32 v120, v120
    v_max_i32 v84, v120, v84
    s_mov_b64 exec, -1

    v_lshl_add_u32 v73, v84, 1, v30
    v_lshl_add_u32 v71, -1, v84, v71
    ds_read_u16 v80, v73 offset:32
    v_ffbl_b32 v84, v71

    v_perm_b32 v72, v68, v67, v84
    v_and_or_b32 v72, v72, s66, v85
    ds_add_rtn_u32 v87, v72, v10
    ds_wrxchg_rtn_b32 v116, v86, v13

    s_add_u32 s47, s44, 151552
    buffer_load_dwordx4 v[216:219], v7, s[20:23], s47 offen offset:0
    buffer_load_dwordx4 v[220:223], v7, s[20:23], s47 offen offset:64
    s_mov_b32 s70, 0x977f977f

    s_waitcnt lgkmcnt(0)
    v_cmp_gt_u32 s[68:69], 2, v116

    v_cmpx_lt_u32 vcc, 1, v87
    v_bfe_i32 v119, s70, v71, 1
    v_lshrrev_b64 v[74:75], v123, s[68:69]
    v_perm_b32 v121, v74, v74, v5
    v_perm_b32 v122, v74, v74, v4
    v_and_b32 v121, v121, v21
    v_and_b32 v122, v122, v20
    v_msad_u8 v120, v28, v121, 0
    v_lshlrev_b32 v120, 4, v120
    v_msad_u8 v120, v27, v122, v120
    v_bitop3_b32 v120, v120, v71, v119 bitop3:0x80

    v_ffbl_b32 v120, v120
    v_max_i32 v84, v120, v84
    s_mov_b64 exec, -1

    v_lshl_add_u32 v73, v84, 1, v30
    v_lshl_add_u32 v71, -1, v84, v71
    ds_read_u16 v81, v73 offset:32
    v_ffbl_b32 v84, v71

    v_perm_b32 v72, v68, v67, v84
    v_and_or_b32 v72, v72, s66, v85
    ds_add_rtn_u32 v87, v72, v10
    ds_wrxchg_rtn_b32 v116, v86, v13

    s_add_u32 s47, s44, 155648
    buffer_load_dwordx4 v[232:235], v7, s[20:23], s47 offen offset:0
    buffer_load_dwordx4 v[236:239], v7, s[20:23], s47 offen offset:64
    s_mov_b32 s70, 0xe997e997

    s_waitcnt lgkmcnt(0)
    v_cmp_gt_u32 s[68:69], 2, v116

    v_cmpx_lt_u32 vcc, 1, v87
    v_bfe_i32 v119, s70, v71, 1
    v_lshrrev_b64 v[74:75], v123, s[68:69]
    v_perm_b32 v121, v74, v74, v5
    v_perm_b32 v122, v74, v74, v4
    v_and_b32 v121, v121, v21
    v_and_b32 v122, v122, v20
    v_msad_u8 v120, v28, v121, 0
    v_lshlrev_b32 v120, 4, v120
    v_msad_u8 v120, v27, v122, v120
    v_bitop3_b32 v120, v120, v71, v119 bitop3:0x80

    v_ffbl_b32 v120, v120
    v_max_i32 v84, v120, v84
    s_mov_b64 exec, -1

    v_lshl_add_u32 v73, v84, 1, v30
    v_lshl_add_u32 v71, -1, v84, v71
    ds_read_u16 v82, v73 offset:32
    v_ffbl_b32 v84, v71

    v_perm_b32 v72, v68, v67, v84
    v_and_or_b32 v72, v72, s66, v85
    ds_add_rtn_u32 v87, v72, v10
    ds_wrxchg_rtn_b32 v116, v86, v13

    s_add_u32 s47, s44, 159744
    buffer_load_dwordx4 v[248:251], v7, s[20:23], s47 offen offset:0
    buffer_load_dwordx4 v[252:255], v7, s[20:23], s47 offen offset:64
    s_mov_b32 s70, 0xfee9fee9

    s_waitcnt lgkmcnt(0)
    v_cmp_gt_u32 s[68:69], 2, v116

    v_cmpx_lt_u32 vcc, 1, v87
    v_bfe_i32 v119, s70, v71, 1
    v_lshrrev_b64 v[74:75], v123, s[68:69]
    v_perm_b32 v121, v74, v74, v5
    v_and_b32 v121, v121, v21
    v_msad_u8 v120, v28, v121, 0
    v_lshlrev_b32 v120, 4, v120
    v_bitop3_b32 v120, v120, v71, v119 bitop3:0x80

    v_ffbl_b32 v120, v120
    v_max_i32 v84, v120, v84
    s_mov_b64 exec, -1

    v_lshl_add_u32 v73, v84, 1, v30
    v_lshl_add_u32 v71, -1, v84, v71
    ds_read_u16 v83, v73 offset:32
    v_lshrrev_b32 v71, 4, v71

    s_cmp_ge_u32 s57, 800
    s_cbranch_scc1 k1_kernel_norl
    s_waitcnt vmcnt(0)

    v_perm_b32 v0, v132, v128, s84
    v_perm_b32 v1, v148, v144, s84
    v_perm_b32 v2, v164, v160, s84
    v_perm_b32 v3, v180, v176, s84
    v_perm_b32 v16, v132, v128, s85
    v_perm_b32 v17, v148, v144, s85
    v_perm_b32 v18, v164, v160, s85
    v_perm_b32 v19, v180, v176, s85
    v_perm_b32 v32, v133, v129, s84
    v_perm_b32 v33, v149, v145, s84
    v_perm_b32 v34, v165, v161, s84
    v_perm_b32 v35, v181, v177, s84
    v_perm_b32 v64, v133, v129, s85
    v_perm_b32 v65, v149, v145, s85
    v_perm_b32 v66, v165, v161, s85
    v_perm_b32 v67, v181, v177, s85
    ds_write_b128 v36, v[0:3]
    ds_write_b128 v37, v[16:19]
    ds_write_b128 v38, v[32:35]
    ds_write_b128 v39, v[64:67]
    ds_read_b128 v[40:43], v15 offset:0
    ds_read_b128 v[44:47], v15 offset:1024
    ds_read_b128 v[72:75], v15 offset:2048
    ds_read_b128 v[116:119], v15 offset:3072
    v_perm_b32 v0, v196, v192, s84
    v_perm_b32 v1, v212, v208, s84
    v_perm_b32 v2, v228, v224, s84
    v_perm_b32 v3, v244, v240, s84
    v_perm_b32 v16, v196, v192, s85
    v_perm_b32 v17, v212, v208, s85
    v_perm_b32 v18, v228, v224, s85
    v_perm_b32 v19, v244, v240, s85
    v_perm_b32 v32, v197, v193, s84
    v_perm_b32 v33, v213, v209, s84
    v_perm_b32 v34, v229, v225, s84
    v_perm_b32 v35, v245, v241, s84
    v_perm_b32 v64, v197, v193, s85
    v_perm_b32 v65, v213, v209, s85
    v_perm_b32 v66, v229, v225, s85
    v_perm_b32 v67, v245, v241, s85
    s_waitcnt lgkmcnt(0)
    s_add_u32 s83, s82, 0
    buffer_store_dwordx4 v[40:43], v14, s[32:35], s83 offen sc1
    s_add_u32 s83, s82, 3284992
    buffer_store_dwordx4 v[44:47], v14, s[32:35], s83 offen sc1
    s_add_u32 s83, s82, 6569984
    buffer_store_dwordx4 v[72:75], v14, s[32:35], s83 offen sc1
    s_add_u32 s83, s82, 9854976
    buffer_store_dwordx4 v[116:119], v14, s[32:35], s83 offen sc1
    ds_write_b128 v36, v[0:3]
    ds_write_b128 v37, v[16:19]
    ds_write_b128 v38, v[32:35]
    ds_write_b128 v39, v[64:67]
    ds_read_b128 v[40:43], v15 offset:0
    ds_read_b128 v[44:47], v15 offset:1024
    ds_read_b128 v[72:75], v15 offset:2048
    ds_read_b128 v[116:119], v15 offset:3072
    v_perm_b32 v0, v134, v130, s84
    v_perm_b32 v1, v150, v146, s84
    v_perm_b32 v2, v166, v162, s84
    v_perm_b32 v3, v182, v178, s84
    v_perm_b32 v16, v134, v130, s85
    v_perm_b32 v17, v150, v146, s85
    v_perm_b32 v18, v166, v162, s85
    v_perm_b32 v19, v182, v178, s85
    v_perm_b32 v32, v135, v131, s84
    v_perm_b32 v33, v151, v147, s84
    v_perm_b32 v34, v167, v163, s84
    v_perm_b32 v35, v183, v179, s84
    v_perm_b32 v64, v135, v131, s85
    v_perm_b32 v65, v151, v147, s85
    v_perm_b32 v66, v167, v163, s85
    v_perm_b32 v67, v183, v179, s85
    s_waitcnt lgkmcnt(0)
    s_add_u32 s83, s82, 64
    buffer_store_dwordx4 v[40:43], v14, s[32:35], s83 offen sc1
    s_add_u32 s83, s82, 3285056
    buffer_store_dwordx4 v[44:47], v14, s[32:35], s83 offen sc1
    s_add_u32 s83, s82, 6570048
    buffer_store_dwordx4 v[72:75], v14, s[32:35], s83 offen sc1
    s_add_u32 s83, s82, 9855040
    buffer_store_dwordx4 v[116:119], v14, s[32:35], s83 offen sc1
    ds_write_b128 v36, v[0:3]
    ds_write_b128 v37, v[16:19]
    ds_write_b128 v38, v[32:35]
    ds_write_b128 v39, v[64:67]
    ds_read_b128 v[40:43], v15 offset:0
    ds_read_b128 v[44:47], v15 offset:1024
    ds_read_b128 v[72:75], v15 offset:2048
    ds_read_b128 v[116:119], v15 offset:3072
    v_perm_b32 v0, v198, v194, s84
    v_perm_b32 v1, v214, v210, s84
    v_perm_b32 v2, v230, v226, s84
    v_perm_b32 v3, v246, v242, s84
    v_perm_b32 v16, v198, v194, s85
    v_perm_b32 v17, v214, v210, s85
    v_perm_b32 v18, v230, v226, s85
    v_perm_b32 v19, v246, v242, s85
    v_perm_b32 v32, v199, v195, s84
    v_perm_b32 v33, v215, v211, s84
    v_perm_b32 v34, v231, v227, s84
    v_perm_b32 v35, v247, v243, s84
    v_perm_b32 v64, v199, v195, s85
    v_perm_b32 v65, v215, v211, s85
    v_perm_b32 v66, v231, v227, s85
    v_perm_b32 v67, v247, v243, s85
    s_waitcnt lgkmcnt(0)
    s_add_u32 s83, s82, 102656
    buffer_store_dwordx4 v[40:43], v14, s[32:35], s83 offen sc1
    s_add_u32 s83, s82, 3387648
    buffer_store_dwordx4 v[44:47], v14, s[32:35], s83 offen sc1
    s_add_u32 s83, s82, 6672640
    buffer_store_dwordx4 v[72:75], v14, s[32:35], s83 offen sc1
    s_add_u32 s83, s82, 9957632
    buffer_store_dwordx4 v[116:119], v14, s[32:35], s83 offen sc1
    ds_write_b128 v36, v[0:3]
    ds_write_b128 v37, v[16:19]
    ds_write_b128 v38, v[32:35]
    ds_write_b128 v39, v[64:67]
    ds_read_b128 v[40:43], v15 offset:0
    ds_read_b128 v[44:47], v15 offset:1024
    ds_read_b128 v[72:75], v15 offset:2048
    ds_read_b128 v[116:119], v15 offset:3072
    ds_write_b64 v31, v[48:49] offset:32
    ds_write_b64 v31, v[50:51] offset:40
    ds_write_b64 v31, v[52:53] offset:48
    s_waitcnt lgkmcnt(3)
    s_add_u32 s83, s82, 102720
    buffer_store_dwordx4 v[40:43], v14, s[32:35], s83 offen sc1
    s_add_u32 s83, s82, 3387712
    buffer_store_dwordx4 v[44:47], v14, s[32:35], s83 offen sc1
    s_add_u32 s83, s82, 6672704
    buffer_store_dwordx4 v[72:75], v14, s[32:35], s83 offen sc1
    s_add_u32 s83, s82, 9957696
    buffer_store_dwordx4 v[116:119], v14, s[32:35], s83 offen sc1
k1_kernel_norl:
k1_kernel_rld:
    ds_write_b32 v86, v13
    v_ffbl_b32 v84, v71

    v_perm_b32 v72, v69, v68, v84
    v_and_or_b32 v72, v72, s66, v85
    ds_add_rtn_u32 v87, v72, v10
    ds_wrxchg_rtn_b32 v116, v86, v13

    s_mov_b32 s70, 0x7fff7fff

    s_waitcnt lgkmcnt(0)
    v_cmp_gt_u32 s[68:69], 2, v116

    s_cmp_eq_u32 s59, 0
    v_lshl_or_b32 v76, v81, 16, v80
    v_lshl_or_b32 v77, v83, 16, v82
    s_cbranch_scc1 k1_kernel_nf4
    buffer_store_dwordx4 v[76:79], v9, s[32:35], s62 offen sc1
    s_add_u32 s62, s62, 262144
k1_kernel_nf4:
    v_cmpx_lt_u32 vcc, 1, v87
    v_bfe_i32 v119, s70, v71, 1
    v_lshrrev_b64 v[74:75], v123, s[68:69]
    v_perm_b32 v121, v74, v74, v6
    v_perm_b32 v122, v74, v74, v5
    v_and_b32 v121, v121, v22
    v_and_b32 v122, v122, v21
    v_msad_u8 v120, v29, v121, 0
    v_lshlrev_b32 v120, 4, v120
    v_msad_u8 v120, v28, v122, v120
    v_bitop3_b32 v120, v120, v71, v119 bitop3:0x80

    v_ffbl_b32 v120, v120
    v_max_i32 v84, v120, v84
    s_mov_b64 exec, -1

    v_lshl_add_u32 v73, v84, 1, v30
    v_lshl_add_u32 v71, -1, v84, v71
    ds_read_u16 v80, v73 offset:40
    v_ffbl_b32 v84, v71

    v_perm_b32 v72, v69, v68, v84
    v_and_or_b32 v72, v72, s66, v85
    ds_add_rtn_u32 v87, v72, v10
    ds_wrxchg_rtn_b32 v116, v86, v13

    s_mov_b32 s70, 0x977f977f

    s_waitcnt lgkmcnt(0)
    v_cmp_gt_u32 s[68:69], 2, v116

    v_cmpx_lt_u32 vcc, 1, v87
    v_bfe_i32 v119, s70, v71, 1
    v_lshrrev_b64 v[74:75], v123, s[68:69]
    v_perm_b32 v121, v74, v74, v6
    v_perm_b32 v122, v74, v74, v5
    v_and_b32 v121, v121, v22
    v_and_b32 v122, v122, v21
    v_msad_u8 v120, v29, v121, 0
    v_lshlrev_b32 v120, 4, v120
    v_msad_u8 v120, v28, v122, v120
    v_bitop3_b32 v120, v120, v71, v119 bitop3:0x80

    v_ffbl_b32 v120, v120
    v_max_i32 v84, v120, v84
    s_mov_b64 exec, -1

    v_lshl_add_u32 v73, v84, 1, v30
    v_lshl_add_u32 v71, -1, v84, v71
    ds_read_u16 v81, v73 offset:40
    v_ffbl_b32 v84, v71

    v_perm_b32 v72, v69, v68, v84
    v_and_or_b32 v72, v72, s66, v85
    ds_add_rtn_u32 v87, v72, v10
    ds_wrxchg_rtn_b32 v116, v86, v13

    s_mov_b32 s70, 0xe997e997

    s_waitcnt lgkmcnt(0)
    v_cmp_gt_u32 s[68:69], 2, v116

    v_cmpx_lt_u32 vcc, 1, v87
    v_bfe_i32 v119, s70, v71, 1
    v_lshrrev_b64 v[74:75], v123, s[68:69]
    v_perm_b32 v121, v74, v74, v6
    v_perm_b32 v122, v74, v74, v5
    v_and_b32 v121, v121, v22
    v_and_b32 v122, v122, v21
    v_msad_u8 v120, v29, v121, 0
    v_lshlrev_b32 v120, 4, v120
    v_msad_u8 v120, v28, v122, v120
    v_bitop3_b32 v120, v120, v71, v119 bitop3:0x80

    v_ffbl_b32 v120, v120
    v_max_i32 v84, v120, v84
    s_mov_b64 exec, -1

    v_lshl_add_u32 v73, v84, 1, v30
    v_lshl_add_u32 v71, -1, v84, v71
    ds_read_u16 v82, v73 offset:40
    v_ffbl_b32 v84, v71

    v_perm_b32 v72, v69, v68, v84
    v_and_or_b32 v72, v72, s66, v85
    ds_add_rtn_u32 v87, v72, v10
    ds_wrxchg_rtn_b32 v116, v86, v13

    s_mov_b32 s70, 0xfee9fee9

    s_waitcnt lgkmcnt(0)
    v_cmp_gt_u32 s[68:69], 2, v116

    v_cmpx_lt_u32 vcc, 1, v87
    v_bfe_i32 v119, s70, v71, 1
    v_lshrrev_b64 v[74:75], v123, s[68:69]
    v_perm_b32 v121, v74, v74, v6
    v_and_b32 v121, v121, v22
    v_msad_u8 v120, v29, v121, 0
    v_lshlrev_b32 v120, 4, v120
    v_bitop3_b32 v120, v120, v71, v119 bitop3:0x80

    v_ffbl_b32 v120, v120
    v_max_i32 v84, v120, v84
    s_mov_b64 exec, -1

    v_lshl_add_u32 v73, v84, 1, v30
    v_lshl_add_u32 v71, -1, v84, v71
    ds_read_u16 v83, v73 offset:40
    s_cmp_lg_u32 s59, 1
    s_cbranch_scc1 k1_kernel_sdone
    v_lshrrev_b32 v71, 4, v71
    v_ffbl_b32 v84, v71

    v_perm_b32 v72, v70, v69, v84
    v_and_or_b32 v72, v72, s66, v85
    ds_add_rtn_u32 v87, v72, v10
    ds_wrxchg_rtn_b32 v116, v86, v13

    s_waitcnt lgkmcnt(0)
    v_cmp_gt_u32 s[68:69], 2, v116

    v_lshl_or_b32 v78, v81, 16, v80
    v_lshl_or_b32 v79, v83, 16, v82
    v_cmpx_lt_u32 vcc, 1, v87
    v_lshrrev_b64 v[74:75], v123, s[68:69]
    v_perm_b32 v121, v74, v74, v6
    v_and_b32 v121, v121, v22
    v_msad_u8 v120, v29, v121, 0
    v_and_b32 v120, v120, v71

    v_ffbl_b32 v120, v120
    v_max_i32 v84, v120, v84
    s_mov_b64 exec, -1

    v_lshl_add_u32 v73, v84, 1, v30
    v_lshl_add_u32 v71, -1, v84, v71
    ds_read_u16 v80, v73 offset:48
    v_ffbl_b32 v84, v71

    v_perm_b32 v72, v70, v69, v84
    v_and_or_b32 v72, v72, s66, v85
    ds_add_rtn_u32 v87, v72, v10
    ds_wrxchg_rtn_b32 v116, v86, v13

    s_waitcnt lgkmcnt(0)
    v_cmp_gt_u32 s[68:69], 2, v116

    v_cmpx_lt_u32 vcc, 1, v87
    s_nop 0
    v_lshrrev_b64 v[74:75], v123, s[68:69]
    v_perm_b32 v121, v74, v74, v6
    v_and_b32 v121, v121, v22
    v_msad_u8 v120, v29, v121, 0
    v_and_b32 v120, v120, v71

    v_ffbl_b32 v120, v120
    v_max_i32 v84, v120, v84
    s_mov_b64 exec, -1

    v_lshl_add_u32 v73, v84, 1, v30
    v_lshl_add_u32 v71, -1, v84, v71
    ds_read_u16 v81, v73 offset:48
    v_ffbl_b32 v84, v71

    v_perm_b32 v72, v70, v69, v84
    v_and_or_b32 v72, v72, s66, v85
    ds_add_rtn_u32 v87, v72, v10
    ds_wrxchg_rtn_b32 v116, v86, v13

    s_waitcnt lgkmcnt(0)
    v_cmp_gt_u32 s[68:69], 2, v116

    v_cmpx_lt_u32 vcc, 1, v87
    s_nop 0
    v_lshrrev_b64 v[74:75], v123, s[68:69]
    v_perm_b32 v121, v74, v74, v6
    v_and_b32 v121, v121, v22
    v_msad_u8 v120, v29, v121, 0
    v_and_b32 v120, v120, v71

    v_ffbl_b32 v120, v120
    v_max_i32 v84, v120, v84
    s_mov_b64 exec, -1

    v_lshl_add_u32 v73, v84, 1, v30
    v_lshl_add_u32 v71, -1, v84, v71
    ds_read_u16 v82, v73 offset:48
    v_ffbl_b32 v84, v71
    v_lshl_add_u32 v73, v84, 1, v30
    ds_read_u16 v83, v73 offset:48
    s_waitcnt lgkmcnt(0)
    v_lshl_or_b32 v76, v81, 16, v80
    v_lshl_or_b32 v77, v83, 16, v82
    s_branch k1_kernel_sst
k1_kernel_sdone:
    s_waitcnt lgkmcnt(0)
    v_lshl_or_b32 v78, v81, 16, v80
    v_lshl_or_b32 v79, v83, 16, v82
k1_kernel_sst:
    buffer_store_dwordx4 v[76:79], v9, s[32:35], s62 offen sc1
    s_add_u32 s62, s62, 262144
k1_kernel_udone:
    s_setprio 3

    s_mov_b64 exec, 1
    ds_add_rtn_u32 v12, v11, v10 offset:28
    s_waitcnt lgkmcnt(0)
    v_readfirstlane_b32 s45, v12
    s_cmp_ge_u32 s45, 2
    s_cbranch_scc1 k1_kernel_ncl
    s_mov_b64 exec, -1
    s_mul_i32 s45, s45, 16384
    s_min_u32 s45, s45, 16384
    s_lshl_b32 s72, s2, 15
    s_add_u32 s72, s72, s45
    s_add_u32 s72, s72, 20971520
    v_mov_b32 v192, -1
    v_mov_b32 v193, -1
    v_mov_b32 v194, -1
    v_mov_b32 v195, -1
    buffer_store_dwordx4 v[192:195], v9, s[12:15], s72 offen offset:0 sc1
    buffer_store_dwordx4 v[192:195], v9, s[12:15], s72 offen offset:1024 sc1
    buffer_store_dwordx4 v[192:195], v9, s[12:15], s72 offen offset:2048 sc1
    buffer_store_dwordx4 v[192:195], v9, s[12:15], s72 offen offset:3072 sc1
    s_add_u32 s72, s72, 4096
    buffer_store_dwordx4 v[192:195], v9, s[12:15], s72 offen offset:0 sc1
    buffer_store_dwordx4 v[192:195], v9, s[12:15], s72 offen offset:1024 sc1
    buffer_store_dwordx4 v[192:195], v9, s[12:15], s72 offen offset:2048 sc1
    buffer_store_dwordx4 v[192:195], v9, s[12:15], s72 offen offset:3072 sc1
    s_add_u32 s72, s72, 4096
    buffer_store_dwordx4 v[192:195], v9, s[12:15], s72 offen offset:0 sc1
    buffer_store_dwordx4 v[192:195], v9, s[12:15], s72 offen offset:1024 sc1
    buffer_store_dwordx4 v[192:195], v9, s[12:15], s72 offen offset:2048 sc1
    buffer_store_dwordx4 v[192:195], v9, s[12:15], s72 offen offset:3072 sc1
    s_add_u32 s72, s72, 4096
    buffer_store_dwordx4 v[192:195], v9, s[12:15], s72 offen offset:0 sc1
    buffer_store_dwordx4 v[192:195], v9, s[12:15], s72 offen offset:1024 sc1
    buffer_store_dwordx4 v[192:195], v9, s[12:15], s72 offen offset:2048 sc1
    buffer_store_dwordx4 v[192:195], v9, s[12:15], s72 offen offset:3072 sc1
    s_add_u32 s72, s72, 4096
k1_kernel_ncl:

    s_waitcnt vmcnt(0)

    s_mov_b64 exec, 1
    ds_add_rtn_u32 v12, v11, v10 offset:20
    v_mov_b32 v3, 1
    s_bfe_u32 s39, s2, 0x10004
    s_mul_i32 s38, s39, 128
    s_waitcnt lgkmcnt(0)
    v_readfirstlane_b32 s45, v12
    s_cmp_eq_u32 s45, 3
    s_cbranch_scc0 k1_kernel_tld0
    buffer_atomic_add v3, v13, s[52:55], s38 offen offset:32 sc0
k1_kernel_tld0:
    s_and_b32 s45, s45, 3
k1_kernel_tld:
    s_mov_b64 exec, -1
    s_add_u32 s47, s44, 0
    buffer_load_dwordx4 v[32:35], v7, s[20:23], s47 offen offset:0
    buffer_load_dwordx4 v[36:39], v7, s[20:23], s47 offen offset:64
    s_add_u32 s47, s44, 4096
    buffer_load_dwordx4 v[40:43], v7, s[20:23], s47 offen offset:0
    buffer_load_dwordx4 v[44:47], v7, s[20:23], s47 offen offset:64
    s_add_u32 s47, s44, 8192
    buffer_load_dwordx4 v[48:51], v7, s[20:23], s47 offen offset:0
    buffer_load_dwordx4 v[52:55], v7, s[20:23], s47 offen offset:64
    s_cmp_eq_u32 s45, 3
    s_cbranch_scc0 k1_kernel_wdec
    s_lshl_b32 s45, s2, 8
    s_add_u32 s45, s45, 14680064
    v_lshlrev_b32 v0, 8, v8
    v_mov_b32 v116, 0
    s_lshl4_add_u32 s38, s39, 14680064
    s_cmp_lg_u32 s64, 0
    s_cbranch_scc1 k1_kernel_bits
    s_waitcnt vmcnt(6)
    v_readfirstlane_b32 s39, v3

    s_cmp_eq_u32 s39, 127
    s_cbranch_scc0 k1_kernel_poll0

    buffer_store_dword v10, v0, s[12:15], s38 offen sc1
    s_add_u32 s38, s38, 16384
    buffer_store_dword v10, v0, s[12:15], s38 offen sc1
    s_add_u32 s38, s38, 16384
    buffer_store_dword v10, v0, s[12:15], s38 offen sc1
    s_add_u32 s38, s38, 16384
    buffer_store_dword v10, v0, s[12:15], s38 offen sc1

k1_kernel_poll0:
    s_mov_b64 exec, 3
k1_kernel_poll:
    buffer_load_dword v116, v9, s[12:15], s45 offen sc1
    s_add_u32 s65, s65, 1
    s_waitcnt vmcnt(0)
    v_cmp_ne_u32 vcc, 1, v116
    s_cbranch_vccz k1_kernel_go

    s_cmp_lt_u32 s65, 200
    s_cbranch_scc1 k1_kernel_poll
k1_kernel_bits:
    s_mov_b64 exec, -1
    s_lshr_b32 s38, s51, 5
    s_lshl_b32 s39, 1, s51
    v_cmp_eq_u32 vcc, s38, v8
    v_mov_b32 v2, s39
    v_lshlrev_b32 v0, 2, v8
    v_cndmask_b32 v2, 0, v2, vcc
    v_mov_b32 v1, v2
    buffer_atomic_or v1, v0, s[52:55], 0 offen sc0
    s_waitcnt vmcnt(0)
    v_cmp_ne_u32 vcc, 128, v1
    v_or_b32 v1, v1, v2
    s_and_b32 s38, vcc_lo, 0x100
    s_and_b32 s39, vcc_hi, 0x100
    v_cmp_ne_u32 vcc, -1, v1
    s_or_b32 s38, s38, s39
    s_cbranch_scc0 k1_kernel_go
    s_and_b32 s39, vcc_lo, 0xff
    s_mov_b32 s38, 0xc0000000
    s_cbranch_scc0 k1_kernel_dec
    s_ff1_i32_b32 s38, s39
    s_nop 3
    v_readlane_b32 s39, v1, s38
    s_ff0_i32_b32 s39, s39
    s_lshl_b32 s38, s38, 5
    s_add_u32 s38, s38, s39
    s_andn2_b32 s39, s64, 255
    s_add_u32 s39, s39, 256
    s_or_b32 s38, s38, s39
    s_branch k1_kernel_dec

k1_kernel_go:

    s_mov_b32 s38, 0x80000000

k1_kernel_dec:

    v_mov_b32 v1, s38
    s_mov_b64 exec, 1
    ds_write_b32 v11, v1 offset:24

k1_kernel_wdec:

    s_mov_b64 exec, -1
    ds_read_b32 v12, v11 offset:24
    s_waitcnt lgkmcnt(0)
    v_readfirstlane_b32 s45, v12
    s_cmp_lg_u32 s45, s64
    s_cbranch_scc1 k1_kernel_gotd
    s_sleep 2
    s_branch k1_kernel_wdec
k1_kernel_redo:
    s_waitcnt vmcnt(0) lgkmcnt(0)
    s_branch k1_kernel_unit

k1_kernel_gotd:

    s_mov_b32 s64, s45
    s_and_b32 s51, s45, 255
    s_mov_b32 s65, 0x10000
    s_bitcmp0_b32 s45, 31
    s_cbranch_scc1 k1_kernel_redo

k1_kernel_k2:

    s_setprio 0
    s_load_dwordx4 s[8:11], s[0:1], 32
    s_load_dwordx2 s[56:57], s[0:1], 48
    s_load_dwordx2 s[60:61], s[0:1], 56
    v_mbcnt_lo_u32_b32 v0, -1, 0
    v_mbcnt_hi_u32_b32 v0, -1, v0
    s_mul_i32 s35, s3, 18432
    v_and_b32 v1, 15, v0
    v_lshrrev_b32 v2, 4, v0
    v_mul_u32_u24 v65, 144, v1
    v_lshl_add_u32 v65, v2, 4, v65
    v_add_u32 v65, s35, v65

    ds_read_b128 v[128:131], v65 offset:0
    ds_read_b128 v[132:135], v65 offset:64
    ds_read_b128 v[144:147], v65 offset:2304
    ds_read_b128 v[148:151], v65 offset:2368
    ds_read_b128 v[160:163], v65 offset:4608
    ds_read_b128 v[164:167], v65 offset:4672
    ds_read_b128 v[176:179], v65 offset:6912
    ds_read_b128 v[180:183], v65 offset:6976
    ds_read_b128 v[192:195], v65 offset:9216
    ds_read_b128 v[196:199], v65 offset:9280
    ds_read_b128 v[208:211], v65 offset:11520
    ds_read_b128 v[212:215], v65 offset:11584
    ds_read_b128 v[224:227], v65 offset:13824
    ds_read_b128 v[228:231], v65 offset:13888
    ds_read_b128 v[240:243], v65 offset:16128
    ds_read_b128 v[244:247], v65 offset:16192

    s_lshr_b32 s33, s2, 1
    s_and_b32 s34, s2, 1
    v_lshlrev_b32 v71, 4, v0

    s_mul_i32 s21, s33, 102656
    s_mul_i32 s35, s34, 49152
    s_sub_u32 s22, 53248, s35
    s_add_u32 s21, s21, s35
    s_lshl_b32 s35, s50, 11
    s_xor_b32 s19, s35, 2048
    s_add_u32 s19, s19, s21
    s_add_u32 s21, s21, s35
    s_mul_i32 s20, s34, 1703936
    s_add_u32 s20, s20, 16777216
    s_lshl_b32 s35, s3, 14
    s_add_u32 s20, s20, s35

    v_lshlrev_b32 v64, 13, v2
    v_lshl_add_u32 v64, v1, 3, v64
    s_lshl_b32 s35, s3, 10
    v_add_u32 v64, s35, v64
    v_lshrrev_b32 v4, 3, v0
    v_xor_b32 v4, v4, v2
    v_and_b32 v4, 1, v4
    v_bfe_u32 v5, v0, 2, 1
    v_lshl_or_b32 v4, v4, 1, v5
    v_mov_b32 v6, 0x3f80
    v_cmp_eq_u32 vcc, 0, v4
    v_and_b32 v5, 3, v0
    v_mul_u32_u24 v70, 0x5555, v5
    v_cndmask_b32 v66, 0, v6, vcc
    v_cndmask_b32 v67, 0, v6, vcc
    v_cmp_eq_u32 vcc, 1, v4
    v_lshl_add_u32 v70, v64, 13, v70
    s_mov_b32 s23, 0xffff0000
    v_cndmask_b32 v68, 0, v6, vcc
    v_cndmask_b32 v69, 0, v6, vcc

    s_bitcmp0_b32 s64, 31
    s_cbranch_scc1 k1_kernel_k2n
    buffer_load_dwordx4 v[0:3], v71, s[12:15], s21 offen offset:0
    buffer_load_dwordx4 v[4:7], v71, s[12:15], s21 offen offset:1024
    buffer_load_dwordx4 v[8:11], v71, s[12:15], s19 offen offset:0
    buffer_load_dwordx4 v[12:15], v71, s[12:15], s19 offen offset:1024
    s_add_u32 s21, s21, 4096
    s_add_u32 s19, s19, 4096
    buffer_load_dwordx4 v[16:19], v71, s[12:15], s21 offen offset:0
    buffer_load_dwordx4 v[20:23], v71, s[12:15], s21 offen offset:1024
    buffer_load_dwordx4 v[24:27], v71, s[12:15], s19 offen offset:0
    buffer_load_dwordx4 v[28:31], v71, s[12:15], s19 offen offset:1024
    s_add_u32 s21, s21, 4096
    s_add_u32 s19, s19, 4096
    s_cmp_lt_u32 s3, 4
    s_cbranch_scc1 k1_kernel_k2n
    s_mov_b32 s44, s21
    s_mov_b32 s45, s19
    s_add_u32 s21, s21, 4096
    s_add_u32 s19, s19, 4096
    buffer_load_dwordx4 v[72:75], v71, s[12:15], s21 offen offset:0
    buffer_load_dwordx4 v[76:79], v71, s[12:15], s21 offen offset:1024
    buffer_load_dwordx4 v[80:83], v71, s[12:15], s19 offen offset:0
    buffer_load_dwordx4 v[84:87], v71, s[12:15], s19 offen offset:1024
    s_add_u32 s21, s21, 4096
    s_add_u32 s19, s19, 4096
    buffer_load_dwordx2 v[116:117], v71, s[12:15], s20 offen offset:0 sc1
    buffer_load_dwordx2 v[118:119], v71, s[12:15], s20 offen offset:1024 sc1
    buffer_load_dwordx2 v[120:121], v71, s[12:15], s20 offen offset:2048 sc1
    buffer_load_dwordx2 v[122:123], v71, s[12:15], s20 offen offset:3072 sc1
k1_kernel_k2n:

    s_and_b32 s35, s3, 3
    s_lshl_b32 s35, s35, 14
    s_add_u32 s35, s35, 98304
    v_add_u32 v65, s35, v71

    s_lshl_b32 s16, s2, 3
    s_add_u32 s16, s16, s3
    s_lshl_b32 s46, s16, 7
    s_mul_i32 s16, s16, 8448
    s_add_u32 s46, s46, 30408704
    s_add_u32 s16, s16, 67108864

    s_xor_b32 s47, s46, 1024
    s_mul_i32 s35, s34, 135168
    s_add_u32 s18, s16, 67584
    s_sub_u32 s18, s18, s35
    s_mov_b32 s48, 0
    s_lshl_b32 s35, s33, 3
    s_waitcnt lgkmcnt(0)
    s_add_u32 s8, s8, s35
    s_addc_u32 s9, s9, 0
    s_add_u32 s10, s10, s35
    s_addc_u32 s11, s11, 0
    s_load_dwordx2 s[36:37], s[8:9], 0
    s_load_dwordx2 s[38:39], s[10:11], 0
    s_barrier

    s_cmp_lt_u32 s3, 4
    s_cbranch_scc1 k1_kernel_k2m

    s_waitcnt vmcnt(12)
    s_setprio 1
    ds_write_b128 v65, v[32:35] offset:0
    ds_write_b128 v65, v[36:39] offset:1024
    ds_write_b128 v65, v[40:43] offset:2048
    ds_write_b128 v65, v[44:47] offset:3072
    v_mfma_f32_16x16x32_bf16 v[32:35], v[0:3], v[128:131], 0
    v_mfma_f32_16x16x32_bf16 v[36:39], v[0:3], v[144:147], 0
    ds_write_b128 v65, v[48:51] offset:4096
    v_mfma_f32_16x16x32_bf16 v[40:43], v[0:3], v[160:163], 0
    v_mfma_f32_16x16x32_bf16 v[44:47], v[0:3], v[176:179], 0
    ds_write_b128 v65, v[52:55] offset:5120
    v_mfma_f32_16x16x32_bf16 v[32:35], v[4:7], v[132:135], v[32:35]
    v_mfma_f32_16x16x32_bf16 v[36:39], v[4:7], v[148:151], v[36:39]
    ds_write_b128 v65, v[56:59] offset:6144
    v_mfma_f32_16x16x32_bf16 v[40:43], v[4:7], v[164:167], v[40:43]
    v_mfma_f32_16x16x32_bf16 v[44:47], v[4:7], v[180:183], v[44:47]
    ds_write_b128 v65, v[60:63] offset:7168
    v_mfma_f32_16x16x32_bf16 v[32:35], v[8:11], v[136:139], v[32:35]
    v_mfma_f32_16x16x32_bf16 v[36:39], v[8:11], v[152:155], v[36:39]
    ds_write_b128 v65, v[88:91] offset:8192
    v_mfma_f32_16x16x32_bf16 v[40:43], v[8:11], v[168:171], v[40:43]
    v_mfma_f32_16x16x32_bf16 v[44:47], v[8:11], v[184:187], v[44:47]
    ds_write_b128 v65, v[92:95] offset:9216
    v_mfma_f32_16x16x32_bf16 v[32:35], v[12:15], v[140:143], v[32:35]
    v_mfma_f32_16x16x32_bf16 v[36:39], v[12:15], v[156:159], v[36:39]
    ds_write_b128 v65, v[96:99] offset:10240
    v_mfma_f32_16x16x32_bf16 v[40:43], v[12:15], v[172:175], v[40:43]
    v_mfma_f32_16x16x32_bf16 v[44:47], v[12:15], v[188:191], v[44:47]
    ds_write_b128 v65, v[100:103] offset:11264
    v_mfma_f32_16x16x32_bf16 v[48:51], v[0:3], v[192:195], 0
    v_mfma_f32_16x16x32_bf16 v[52:55], v[0:3], v[208:211], 0
    ds_write_b128 v65, v[104:107] offset:12288
    v_mfma_f32_16x16x32_bf16 v[56:59], v[0:3], v[224:227], 0
    v_mfma_f32_16x16x32_bf16 v[60:63], v[0:3], v[240:243], 0
    ds_write_b128 v65, v[108:111] offset:13312
    v_mfma_f32_16x16x32_bf16 v[48:51], v[4:7], v[196:199], v[48:51]
    v_mfma_f32_16x16x32_bf16 v[52:55], v[4:7], v[212:215], v[52:55]
    ds_write_b128 v65, v[112:115] offset:14336
    v_mfma_f32_16x16x32_bf16 v[56:59], v[4:7], v[228:231], v[56:59]
    v_mfma_f32_16x16x32_bf16 v[60:63], v[4:7], v[244:247], v[60:63]
    ds_write_b128 v65, v[124:127] offset:15360
    v_mfma_f32_16x16x32_bf16 v[48:51], v[8:11], v[200:203], v[48:51]
    v_mfma_f32_16x16x32_bf16 v[52:55], v[8:11], v[216:219], v[52:55]
    v_mfma_f32_16x16x32_bf16 v[56:59], v[8:11], v[232:235], v[56:59]
    v_mfma_f32_16x16x32_bf16 v[60:63], v[8:11], v[248:251], v[60:63]
    s_waitcnt lgkmcnt(0)
    s_barrier
    s_setprio 0
    v_mfma_f32_16x16x32_bf16 v[48:51], v[12:15], v[204:207], v[48:51]
    v_mfma_f32_16x16x32_bf16 v[52:55], v[12:15], v[220:223], v[52:55]
    v_mfma_f32_16x16x32_bf16 v[56:59], v[12:15], v[236:239], v[56:59]
    v_mfma_f32_16x16x32_bf16 v[60:63], v[12:15], v[252:255], v[60:63]
    s_add_u32 s20, s20, 4096
    buffer_load_dwordx2 v[124:125], v71, s[12:15], s20 offen offset:0 sc1
    buffer_load_dwordx2 v[126:127], v71, s[12:15], s20 offen offset:1024 sc1
    buffer_load_dwordx4 v[0:3], v71, s[12:15], s44 offen offset:0
    buffer_load_dwordx4 v[4:7], v71, s[12:15], s44 offen offset:1024
    buffer_load_dwordx4 v[8:11], v71, s[12:15], s45 offen offset:0
    buffer_load_dwordx4 v[12:15], v71, s[12:15], s45 offen offset:1024
    s_waitcnt vmcnt(14)
    s_lshl_b32 s24, s36, 16
    s_and_b32 s25, s36, 0xffff0000
    s_lshl_b32 s26, s37, 16
    s_and_b32 s27, s37, 0xffff0000

    v_mfma_f32_16x16x32_bf16 v[88:91], v[16:19], v[128:131], 0
    v_mfma_f32_16x16x32_bf16 v[92:95], v[16:19], v[144:147], 0
    v_mfma_f32_16x16x32_bf16 v[88:91], v[20:23], v[132:135], v[88:91]
    v_mfma_f32_16x16x32_bf16 v[92:95], v[20:23], v[148:151], v[92:95]
    v_mfma_f32_16x16x32_bf16 v[88:91], v[24:27], v[136:139], v[88:91]
    v_cvt_pk_bf16_f32 v32, v32, v33
    v_mfma_f32_16x16x32_bf16 v[92:95], v[24:27], v[152:155], v[92:95]
    v_cvt_pk_bf16_f32 v33, v34, v35
    v_mfma_f32_16x16x32_bf16 v[88:91], v[28:31], v[140:143], v[88:91]
    ds_write_b64 v64, v[32:33] offset:0
    v_mfma_f32_16x16x32_bf16 v[92:95], v[28:31], v[156:159], v[92:95]
    v_cvt_pk_bf16_f32 v36, v36, v37
    v_mfma_f32_16x16x32_bf16 v[96:99], v[16:19], v[160:163], 0
    v_cvt_pk_bf16_f32 v37, v38, v39
    v_mfma_f32_16x16x32_bf16 v[100:103], v[16:19], v[176:179], 0
    ds_write_b64 v64, v[36:37] offset:128
    v_mfma_f32_16x16x32_bf16 v[96:99], v[20:23], v[164:167], v[96:99]
    v_cvt_pk_bf16_f32 v88, v88, v89
    v_cvt_pk_bf16_f32 v40, v40, v41
    v_mfma_f32_16x16x32_bf16 v[100:103], v[20:23], v[180:183], v[100:103]
    v_cvt_pk_bf16_f32 v89, v90, v91
    v_cvt_pk_bf16_f32 v41, v42, v43
    v_mfma_f32_16x16x32_bf16 v[96:99], v[24:27], v[168:171], v[96:99]
    ds_write_b64 v64, v[88:89] offset:32768
    ds_write_b64 v64, v[40:41] offset:256
    v_mfma_f32_16x16x32_bf16 v[100:103], v[24:27], v[184:187], v[100:103]
    v_cvt_pk_bf16_f32 v92, v92, v93
    v_cvt_pk_bf16_f32 v44, v44, v45
    v_mfma_f32_16x16x32_bf16 v[96:99], v[28:31], v[172:175], v[96:99]
    v_cvt_pk_bf16_f32 v93, v94, v95
    v_cvt_pk_bf16_f32 v45, v46, v47
    v_mfma_f32_16x16x32_bf16 v[100:103], v[28:31], v[188:191], v[100:103]
    ds_write_b64 v64, v[92:93] offset:32896
    ds_write_b64 v64, v[44:45] offset:384
    v_mfma_f32_16x16x32_bf16 v[104:107], v[16:19], v[192:195], 0
    v_cvt_pk_bf16_f32 v48, v48, v49
    v_mfma_f32_16x16x32_bf16 v[108:111], v[16:19], v[208:211], 0
    v_cvt_pk_bf16_f32 v49, v50, v51
    v_mfma_f32_16x16x32_bf16 v[104:107], v[20:23], v[196:199], v[104:107]
    v_cvt_pk_bf16_f32 v96, v96, v97
    ds_write_b64 v64, v[48:49] offset:512
    v_mfma_f32_16x16x32_bf16 v[108:111], v[20:23], v[212:215], v[108:111]
    v_cvt_pk_bf16_f32 v97, v98, v99
    v_cvt_pk_bf16_f32 v52, v52, v53
    v_mfma_f32_16x16x32_bf16 v[104:107], v[24:27], v[200:203], v[104:107]
    ds_write_b64 v64, v[96:97] offset:33024
    v_cvt_pk_bf16_f32 v53, v54, v55
    v_mfma_f32_16x16x32_bf16 v[108:111], v[24:27], v[216:219], v[108:111]
    v_cvt_pk_bf16_f32 v100, v100, v101
    ds_write_b64 v64, v[52:53] offset:640
    v_mfma_f32_16x16x32_bf16 v[104:107], v[28:31], v[204:207], v[104:107]
    v_cvt_pk_bf16_f32 v101, v102, v103
    v_cvt_pk_bf16_f32 v56, v56, v57
    v_mfma_f32_16x16x32_bf16 v[108:111], v[28:31], v[220:223], v[108:111]
    ds_write_b64 v64, v[100:101] offset:33152
    v_cvt_pk_bf16_f32 v57, v58, v59
    v_mfma_f32_16x16x32_bf16 v[88:91], v[16:19], v[224:227], 0
    ds_write_b64 v64, v[56:57] offset:768
    v_mfma_f32_16x16x32_bf16 v[92:95], v[16:19], v[240:243], 0
    v_cvt_pk_bf16_f32 v60, v60, v61
    v_mfma_f32_16x16x32_bf16 v[88:91], v[20:23], v[228:231], v[88:91]
    v_cvt_pk_bf16_f32 v104, v104, v105
    v_cvt_pk_bf16_f32 v61, v62, v63
    v_mfma_f32_16x16x32_bf16 v[92:95], v[20:23], v[244:247], v[92:95]
    v_cvt_pk_bf16_f32 v105, v106, v107
    ds_write_b64 v64, v[60:61] offset:896
    v_mfma_f32_16x16x32_bf16 v[88:91], v[24:27], v[232:235], v[88:91]
    ds_write_b64 v64, v[104:105] offset:33280
    v_mfma_f32_16x16x32_bf16 v[92:95], v[24:27], v[248:251], v[92:95]
    v_cvt_pk_bf16_f32 v108, v108, v109
    v_mfma_f32_16x16x32_bf16 v[88:91], v[28:31], v[236:239], v[88:91]
    v_cvt_pk_bf16_f32 v109, v110, v111
    v_mfma_f32_16x16x32_bf16 v[92:95], v[28:31], v[252:255], v[92:95]
    ds_write_b64 v64, v[108:109] offset:33408
    v_add_u32 v64, 0x8000, v64
    s_waitcnt vmcnt(0)
    v_mfma_f32_16x16x32_bf16 v[96:99], v[0:3], v[128:131], 0
    v_mfma_f32_16x16x32_bf16 v[100:103], v[0:3], v[144:147], 0
    v_mfma_f32_16x16x32_bf16 v[96:99], v[4:7], v[132:135], v[96:99]
    v_cvt_pk_bf16_f32 v88, v88, v89
    v_mfma_f32_16x16x32_bf16 v[100:103], v[4:7], v[148:151], v[100:103]
    v_cvt_pk_bf16_f32 v89, v90, v91
    v_mfma_f32_16x16x32_bf16 v[96:99], v[8:11], v[136:139], v[96:99]
    ds_write_b64 v64, v[88:89] offset:768
    v_mfma_f32_16x16x32_bf16 v[100:103], v[8:11], v[152:155], v[100:103]
    v_cvt_pk_bf16_f32 v92, v92, v93
    v_mfma_f32_16x16x32_bf16 v[96:99], v[12:15], v[140:143], v[96:99]
    v_cvt_pk_bf16_f32 v93, v94, v95
    v_mfma_f32_16x16x32_bf16 v[100:103], v[12:15], v[156:159], v[100:103]
    ds_write_b64 v64, v[92:93] offset:896
    v_mfma_f32_16x16x32_bf16 v[104:107], v[0:3], v[160:163], 0
    v_mfma_f32_16x16x32_bf16 v[108:111], v[0:3], v[176:179], 0
    v_mfma_f32_16x16x32_bf16 v[104:107], v[4:7], v[164:167], v[104:107]
    v_cvt_pk_bf16_f32 v96, v96, v97
    v_mfma_f32_16x16x32_bf16 v[108:111], v[4:7], v[180:183], v[108:111]
    v_cvt_pk_bf16_f32 v97, v98, v99
    v_mfma_f32_16x16x32_bf16 v[104:107], v[8:11], v[168:171], v[104:107]
    ds_write_b64 v64, v[96:97] offset:32768
    v_mfma_f32_16x16x32_bf16 v[108:111], v[8:11], v[184:187], v[108:111]
    v_cvt_pk_bf16_f32 v100, v100, v101
    v_mfma_f32_16x16x32_bf16 v[104:107], v[12:15], v[172:175], v[104:107]
    v_cvt_pk_bf16_f32 v101, v102, v103
    v_mfma_f32_16x16x32_bf16 v[108:111], v[12:15], v[188:191], v[108:111]
    ds_write_b64 v64, v[100:101] offset:32896
    v_mfma_f32_16x16x32_bf16 v[88:91], v[0:3], v[192:195], 0
    v_mfma_f32_16x16x32_bf16 v[92:95], v[0:3], v[208:211], 0
    v_mfma_f32_16x16x32_bf16 v[88:91], v[4:7], v[196:199], v[88:91]
    v_cvt_pk_bf16_f32 v104, v104, v105
    v_mfma_f32_16x16x32_bf16 v[92:95], v[4:7], v[212:215], v[92:95]
    v_cvt_pk_bf16_f32 v105, v106, v107
    v_mfma_f32_16x16x32_bf16 v[88:91], v[8:11], v[200:203], v[88:91]
    ds_write_b64 v64, v[104:105] offset:33024
    v_mfma_f32_16x16x32_bf16 v[92:95], v[8:11], v[216:219], v[92:95]
    v_cvt_pk_bf16_f32 v108, v108, v109
    v_mfma_f32_16x16x32_bf16 v[88:91], v[12:15], v[204:207], v[88:91]
    v_cvt_pk_bf16_f32 v109, v110, v111
    v_mfma_f32_16x16x32_bf16 v[92:95], v[12:15], v[220:223], v[92:95]
    ds_write_b64 v64, v[108:109] offset:33152
    v_mfma_f32_16x16x32_bf16 v[96:99], v[0:3], v[224:227], 0
    v_mfma_f32_16x16x32_bf16 v[100:103], v[0:3], v[240:243], 0
    v_mfma_f32_16x16x32_bf16 v[96:99], v[4:7], v[228:231], v[96:99]
    v_cvt_pk_bf16_f32 v88, v88, v89
    v_mfma_f32_16x16x32_bf16 v[100:103], v[4:7], v[244:247], v[100:103]
    v_cvt_pk_bf16_f32 v89, v90, v91
    v_mfma_f32_16x16x32_bf16 v[96:99], v[8:11], v[232:235], v[96:99]
    ds_write_b64 v64, v[88:89] offset:33280
    v_mfma_f32_16x16x32_bf16 v[100:103], v[8:11], v[248:251], v[100:103]
    v_cvt_pk_bf16_f32 v92, v92, v93
    v_mfma_f32_16x16x32_bf16 v[96:99], v[12:15], v[236:239], v[96:99]
    v_cvt_pk_bf16_f32 v93, v94, v95
    v_mfma_f32_16x16x32_bf16 v[100:103], v[12:15], v[252:255], v[100:103]
    ds_write_b64 v64, v[92:93] offset:33408
    s_nop 7
    v_cvt_pk_bf16_f32 v96, v96, v97
    v_cvt_pk_bf16_f32 v97, v98, v99
    ds_write_b64 v64, v[96:97] offset:33536
    v_cvt_pk_bf16_f32 v100, v100, v101
    v_cvt_pk_bf16_f32 v101, v102, v103
    ds_write_b64 v64, v[100:101] offset:33664

    s_cmp_lg_u32 s3, 7
    s_cbranch_scc1 k1_kernel_k2j
k1_kernel_k2w:
    s_bfe_u32 s35, s64, 0x1001e
    v_mov_b32 v65, 0
    v_mov_b32 v64, s35
    ds_write_b32 v65, v64 offset:8184
    s_branch k1_kernel_k2j

k1_kernel_k2m:
    s_bitcmp1_b32 s64, 31
    s_cbranch_scc1 k1_kernel_k2e
    buffer_load_dwordx4 v[0:3], v71, s[12:15], s21 offen offset:0
    buffer_load_dwordx4 v[4:7], v71, s[12:15], s21 offen offset:1024
    buffer_load_dwordx4 v[8:11], v71, s[12:15], s19 offen offset:0
    buffer_load_dwordx4 v[12:15], v71, s[12:15], s19 offen offset:1024
    s_add_u32 s21, s21, 4096
    s_add_u32 s19, s19, 4096
    buffer_load_dwordx4 v[16:19], v71, s[12:15], s21 offen offset:0
    buffer_load_dwordx4 v[20:23], v71, s[12:15], s21 offen offset:1024
    buffer_load_dwordx4 v[24:27], v71, s[12:15], s19 offen offset:0
    buffer_load_dwordx4 v[28:31], v71, s[12:15], s19 offen offset:1024
    s_add_u32 s21, s21, 4096
    s_add_u32 s19, s19, 4096
k1_kernel_k2e:
    s_mov_b32 s44, s21
    s_mov_b32 s45, s19
    s_add_u32 s21, s21, 4096
    s_add_u32 s19, s19, 4096
    s_waitcnt vmcnt(4)
    v_mfma_f32_16x16x32_bf16 v[48:51], v[0:3], v[128:131], 0
    v_mfma_f32_16x16x32_bf16 v[52:55], v[0:3], v[144:147], 0
    v_mfma_f32_16x16x32_bf16 v[56:59], v[0:3], v[160:163], 0
    v_mfma_f32_16x16x32_bf16 v[60:63], v[0:3], v[176:179], 0
    v_mfma_f32_16x16x32_bf16 v[88:91], v[0:3], v[192:195], 0
    v_mfma_f32_16x16x32_bf16 v[92:95], v[0:3], v[208:211], 0
    v_mfma_f32_16x16x32_bf16 v[96:99], v[0:3], v[224:227], 0
    v_mfma_f32_16x16x32_bf16 v[100:103], v[0:3], v[240:243], 0
    v_mfma_f32_16x16x32_bf16 v[48:51], v[4:7], v[132:135], v[48:51]
    v_mfma_f32_16x16x32_bf16 v[52:55], v[4:7], v[148:151], v[52:55]
    v_mfma_f32_16x16x32_bf16 v[56:59], v[4:7], v[164:167], v[56:59]
    v_mfma_f32_16x16x32_bf16 v[60:63], v[4:7], v[180:183], v[60:63]
    v_mfma_f32_16x16x32_bf16 v[88:91], v[4:7], v[196:199], v[88:91]
    v_mfma_f32_16x16x32_bf16 v[92:95], v[4:7], v[212:215], v[92:95]
    v_mfma_f32_16x16x32_bf16 v[96:99], v[4:7], v[228:231], v[96:99]
    v_mfma_f32_16x16x32_bf16 v[100:103], v[4:7], v[244:247], v[100:103]
    s_waitcnt vmcnt(0)
    v_mfma_f32_16x16x32_bf16 v[116:119], v[16:19], v[128:131], 0
    v_mfma_f32_16x16x32_bf16 v[120:123], v[16:19], v[144:147], 0
    buffer_load_dwordx4 v[32:35], v71, s[12:15], s44 offen offset:0

    v_mfma_f32_16x16x32_bf16 v[72:75], v[16:19], v[160:163], 0
    v_mfma_f32_16x16x32_bf16 v[76:79], v[16:19], v[176:179], 0
    v_mfma_f32_16x16x32_bf16 v[80:83], v[16:19], v[192:195], 0
    v_mfma_f32_16x16x32_bf16 v[84:87], v[16:19], v[208:211], 0
    buffer_load_dwordx4 v[36:39], v71, s[12:15], s44 offen offset:1024

    v_mfma_f32_16x16x32_bf16 v[104:107], v[16:19], v[224:227], 0
    v_mfma_f32_16x16x32_bf16 v[108:111], v[16:19], v[240:243], 0
    v_mfma_f32_16x16x32_bf16 v[116:119], v[20:23], v[132:135], v[116:119]
    v_mfma_f32_16x16x32_bf16 v[120:123], v[20:23], v[148:151], v[120:123]
    buffer_load_dwordx4 v[40:43], v71, s[12:15], s45 offen offset:0

    v_mfma_f32_16x16x32_bf16 v[72:75], v[20:23], v[164:167], v[72:75]
    v_mfma_f32_16x16x32_bf16 v[76:79], v[20:23], v[180:183], v[76:79]
    v_mfma_f32_16x16x32_bf16 v[80:83], v[20:23], v[196:199], v[80:83]
    v_mfma_f32_16x16x32_bf16 v[84:87], v[20:23], v[212:215], v[84:87]
    buffer_load_dwordx4 v[44:47], v71, s[12:15], s45 offen offset:1024

    v_mfma_f32_16x16x32_bf16 v[104:107], v[20:23], v[228:231], v[104:107]
    v_mfma_f32_16x16x32_bf16 v[108:111], v[20:23], v[244:247], v[108:111]
    s_waitcnt lgkmcnt(0)
    s_barrier
    ds_read_b128 v[136:139], v65 offset:0
    ds_read_b128 v[140:143], v65 offset:1024
    ds_read_b128 v[152:155], v65 offset:2048
    ds_read_b128 v[156:159], v65 offset:3072
    ds_read_b128 v[168:171], v65 offset:4096
    ds_read_b128 v[172:175], v65 offset:5120
    ds_read_b128 v[184:187], v65 offset:6144
    ds_read_b128 v[188:191], v65 offset:7168
    ds_read_b128 v[200:203], v65 offset:8192
    ds_read_b128 v[204:207], v65 offset:9216
    ds_read_b128 v[216:219], v65 offset:10240
    ds_read_b128 v[220:223], v65 offset:11264
    ds_read_b128 v[232:235], v65 offset:12288
    ds_read_b128 v[236:239], v65 offset:13312
    ds_read_b128 v[248:251], v65 offset:14336
    ds_read_b128 v[252:255], v65 offset:15360

    s_lshl_b32 s24, s36, 16
    s_and_b32 s25, s36, 0xffff0000
    s_lshl_b32 s26, s37, 16
    s_and_b32 s27, s37, 0xffff0000

    s_waitcnt lgkmcnt(12)
    v_mfma_f32_16x16x32_bf16 v[116:119], v[24:27], v[136:139], v[116:119]
    v_mfma_f32_16x16x32_bf16 v[120:123], v[24:27], v[152:155], v[120:123]
    v_mfma_f32_16x16x32_bf16 v[48:51], v[8:11], v[136:139], v[48:51]
    v_mfma_f32_16x16x32_bf16 v[52:55], v[8:11], v[152:155], v[52:55]
    v_mfma_f32_16x16x32_bf16 v[116:119], v[28:31], v[140:143], v[116:119]
    v_mfma_f32_16x16x32_bf16 v[120:123], v[28:31], v[156:159], v[120:123]
    v_mfma_f32_16x16x32_bf16 v[48:51], v[12:15], v[140:143], v[48:51]
    v_mfma_f32_16x16x32_bf16 v[52:55], v[12:15], v[156:159], v[52:55]
    s_waitcnt lgkmcnt(8)
    v_mfma_f32_16x16x32_bf16 v[72:75], v[24:27], v[168:171], v[72:75]
    v_mfma_f32_16x16x32_bf16 v[76:79], v[24:27], v[184:187], v[76:79]
    v_mfma_f32_16x16x32_bf16 v[56:59], v[8:11], v[168:171], v[56:59]
    v_cvt_pk_bf16_f32 v116, v116, v117
    v_cvt_pk_bf16_f32 v117, v118, v119
    v_mfma_f32_16x16x32_bf16 v[60:63], v[8:11], v[184:187], v[60:63]
    ds_write_b64 v64, v[116:117] offset:32768
    v_cvt_pk_bf16_f32 v120, v120, v121
    v_mfma_f32_16x16x32_bf16 v[72:75], v[28:31], v[172:175], v[72:75]
    v_cvt_pk_bf16_f32 v121, v122, v123
    ds_write_b64 v64, v[120:121] offset:32896
    v_mfma_f32_16x16x32_bf16 v[76:79], v[28:31], v[188:191], v[76:79]
    v_cvt_pk_bf16_f32 v48, v48, v49
    v_cvt_pk_bf16_f32 v49, v50, v51
    v_mfma_f32_16x16x32_bf16 v[56:59], v[12:15], v[172:175], v[56:59]
    ds_write_b64 v64, v[48:49] offset:0
    v_cvt_pk_bf16_f32 v52, v52, v53
    v_mfma_f32_16x16x32_bf16 v[60:63], v[12:15], v[188:191], v[60:63]
    v_cvt_pk_bf16_f32 v53, v54, v55
    ds_write_b64 v64, v[52:53] offset:128
    s_waitcnt lgkmcnt(8)
    v_mfma_f32_16x16x32_bf16 v[80:83], v[24:27], v[200:203], v[80:83]
    buffer_load_dwordx2 v[116:117], v71, s[12:15], s20 offen offset:0 sc1

    v_mfma_f32_16x16x32_bf16 v[84:87], v[24:27], v[216:219], v[84:87]
    v_mfma_f32_16x16x32_bf16 v[88:91], v[8:11], v[200:203], v[88:91]
    v_cvt_pk_bf16_f32 v72, v72, v73
    v_cvt_pk_bf16_f32 v73, v74, v75
    buffer_load_dwordx2 v[118:119], v71, s[12:15], s20 offen offset:1024 sc1

    v_mfma_f32_16x16x32_bf16 v[92:95], v[8:11], v[216:219], v[92:95]
    ds_write_b64 v64, v[72:73] offset:33024
    v_cvt_pk_bf16_f32 v76, v76, v77
    v_mfma_f32_16x16x32_bf16 v[80:83], v[28:31], v[204:207], v[80:83]
    v_cvt_pk_bf16_f32 v77, v78, v79
    ds_write_b64 v64, v[76:77] offset:33152
    buffer_load_dwordx2 v[120:121], v71, s[12:15], s20 offen offset:2048 sc1

    v_mfma_f32_16x16x32_bf16 v[84:87], v[28:31], v[220:223], v[84:87]
    v_cvt_pk_bf16_f32 v56, v56, v57
    v_cvt_pk_bf16_f32 v57, v58, v59
    v_mfma_f32_16x16x32_bf16 v[88:91], v[12:15], v[204:207], v[88:91]
    ds_write_b64 v64, v[56:57] offset:256
    v_cvt_pk_bf16_f32 v60, v60, v61
    buffer_load_dwordx2 v[122:123], v71, s[12:15], s20 offen offset:3072 sc1

    v_mfma_f32_16x16x32_bf16 v[92:95], v[12:15], v[220:223], v[92:95]
    v_cvt_pk_bf16_f32 v61, v62, v63
    ds_write_b64 v64, v[60:61] offset:384
    s_waitcnt lgkmcnt(8)
    v_mfma_f32_16x16x32_bf16 v[104:107], v[24:27], v[232:235], v[104:107]
    s_add_u32 s20, s20, 4096
    buffer_load_dwordx2 v[124:125], v71, s[12:15], s20 offen offset:0 sc1

    v_mfma_f32_16x16x32_bf16 v[108:111], v[24:27], v[248:251], v[108:111]
    v_mfma_f32_16x16x32_bf16 v[96:99], v[8:11], v[232:235], v[96:99]
    v_cvt_pk_bf16_f32 v80, v80, v81
    v_cvt_pk_bf16_f32 v81, v82, v83
    buffer_load_dwordx2 v[126:127], v71, s[12:15], s20 offen offset:1024 sc1

    v_mfma_f32_16x16x32_bf16 v[100:103], v[8:11], v[248:251], v[100:103]
    ds_write_b64 v64, v[80:81] offset:33280
    v_cvt_pk_bf16_f32 v84, v84, v85
    v_mfma_f32_16x16x32_bf16 v[104:107], v[28:31], v[236:239], v[104:107]
    v_cvt_pk_bf16_f32 v85, v86, v87
    ds_write_b64 v64, v[84:85] offset:33408
    v_mfma_f32_16x16x32_bf16 v[108:111], v[28:31], v[252:255], v[108:111]
    v_cvt_pk_bf16_f32 v88, v88, v89
    v_cvt_pk_bf16_f32 v89, v90, v91
    v_mfma_f32_16x16x32_bf16 v[96:99], v[12:15], v[236:239], v[96:99]
    ds_write_b64 v64, v[88:89] offset:512
    v_cvt_pk_bf16_f32 v92, v92, v93
    v_mfma_f32_16x16x32_bf16 v[100:103], v[12:15], v[252:255], v[100:103]
    v_cvt_pk_bf16_f32 v93, v94, v95
    ds_write_b64 v64, v[92:93] offset:640
    s_waitcnt vmcnt(6)
    v_mfma_f32_16x16x32_bf16 v[48:51], v[32:35], v[128:131], 0
    v_mfma_f32_16x16x32_bf16 v[52:55], v[32:35], v[144:147], 0
    v_mfma_f32_16x16x32_bf16 v[48:51], v[36:39], v[132:135], v[48:51]
    v_cvt_pk_bf16_f32 v104, v104, v105
    v_mfma_f32_16x16x32_bf16 v[52:55], v[36:39], v[148:151], v[52:55]
    v_cvt_pk_bf16_f32 v105, v106, v107
    v_mfma_f32_16x16x32_bf16 v[48:51], v[40:43], v[136:139], v[48:51]
    ds_write_b64 v64, v[104:105] offset:33536
    v_cvt_pk_bf16_f32 v96, v96, v97
    v_cvt_pk_bf16_f32 v97, v98, v99
    v_mfma_f32_16x16x32_bf16 v[52:55], v[40:43], v[152:155], v[52:55]
    v_cvt_pk_bf16_f32 v108, v108, v109
    ds_write_b64 v64, v[96:97] offset:768
    v_cvt_pk_bf16_f32 v100, v100, v101
    v_mfma_f32_16x16x32_bf16 v[48:51], v[44:47], v[140:143], v[48:51]
    v_cvt_pk_bf16_f32 v109, v110, v111
    v_cvt_pk_bf16_f32 v101, v102, v103
    ds_write_b64 v64, v[100:101] offset:896
    v_mfma_f32_16x16x32_bf16 v[52:55], v[44:47], v[156:159], v[52:55]
    ds_write_b64 v64, v[108:109] offset:33664
    v_add_u32 v64, 0x8000, v64
    v_mfma_f32_16x16x32_bf16 v[56:59], v[32:35], v[160:163], 0

    v_mfma_f32_16x16x32_bf16 v[60:63], v[32:35], v[176:179], 0
    buffer_load_dwordx4 v[72:75], v71, s[12:15], s21 offen offset:0

    v_mfma_f32_16x16x32_bf16 v[56:59], v[36:39], v[164:167], v[56:59]
    v_cvt_pk_bf16_f32 v48, v48, v49

    v_mfma_f32_16x16x32_bf16 v[60:63], v[36:39], v[180:183], v[60:63]
    v_cvt_pk_bf16_f32 v49, v50, v51

    v_mfma_f32_16x16x32_bf16 v[56:59], v[40:43], v[168:171], v[56:59]
    ds_write_b64 v64, v[48:49] offset:32768
    buffer_load_dwordx4 v[76:79], v71, s[12:15], s21 offen offset:1024

    v_mfma_f32_16x16x32_bf16 v[60:63], v[40:43], v[184:187], v[60:63]
    v_cvt_pk_bf16_f32 v52, v52, v53

    v_mfma_f32_16x16x32_bf16 v[56:59], v[44:47], v[172:175], v[56:59]
    v_cvt_pk_bf16_f32 v53, v54, v55

    v_mfma_f32_16x16x32_bf16 v[60:63], v[44:47], v[188:191], v[60:63]
    ds_write_b64 v64, v[52:53] offset:32896
    buffer_load_dwordx4 v[80:83], v71, s[12:15], s19 offen offset:0

    v_mfma_f32_16x16x32_bf16 v[88:91], v[32:35], v[192:195], 0

    v_mfma_f32_16x16x32_bf16 v[92:95], v[32:35], v[208:211], 0

    v_mfma_f32_16x16x32_bf16 v[88:91], v[36:39], v[196:199], v[88:91]
    v_cvt_pk_bf16_f32 v56, v56, v57
    buffer_load_dwordx4 v[84:87], v71, s[12:15], s19 offen offset:1024
    s_add_u32 s21, s21, 4096
    s_add_u32 s19, s19, 4096

    v_mfma_f32_16x16x32_bf16 v[92:95], v[36:39], v[212:215], v[92:95]
    v_cvt_pk_bf16_f32 v57, v58, v59

    v_mfma_f32_16x16x32_bf16 v[88:91], v[40:43], v[200:203], v[88:91]
    ds_write_b64 v64, v[56:57] offset:33024

    v_mfma_f32_16x16x32_bf16 v[92:95], v[40:43], v[216:219], v[92:95]
    v_cvt_pk_bf16_f32 v60, v60, v61
    s_mov_b32 exec_lo, 0x00ff00ff
    s_mov_b32 exec_hi, 0x00ff00ff
    buffer_store_dword v112, v113, s[12:15], s74 offen sc1
    s_mov_b64 exec, -1
    v_mfma_f32_16x16x32_bf16 v[88:91], v[44:47], v[204:207], v[88:91]
    v_cvt_pk_bf16_f32 v61, v62, v63

    v_mfma_f32_16x16x32_bf16 v[92:95], v[44:47], v[220:223], v[92:95]
    ds_write_b64 v64, v[60:61] offset:33152

    v_mfma_f32_16x16x32_bf16 v[48:51], v[32:35], v[224:227], 0

    v_mfma_f32_16x16x32_bf16 v[52:55], v[32:35], v[240:243], 0

    v_mfma_f32_16x16x32_bf16 v[48:51], v[36:39], v[228:231], v[48:51]
    v_cvt_pk_bf16_f32 v88, v88, v89

    v_mfma_f32_16x16x32_bf16 v[52:55], v[36:39], v[244:247], v[52:55]
    v_cvt_pk_bf16_f32 v89, v90, v91

    v_mfma_f32_16x16x32_bf16 v[48:51], v[40:43], v[232:235], v[48:51]
    ds_write_b64 v64, v[88:89] offset:33280

    v_mfma_f32_16x16x32_bf16 v[52:55], v[40:43], v[248:251], v[52:55]
    v_cvt_pk_bf16_f32 v92, v92, v93

    v_mfma_f32_16x16x32_bf16 v[48:51], v[44:47], v[236:239], v[48:51]
    v_cvt_pk_bf16_f32 v93, v94, v95

    v_mfma_f32_16x16x32_bf16 v[52:55], v[44:47], v[252:255], v[52:55]
    ds_write_b64 v64, v[92:93] offset:33408

    s_nop 7
    v_cvt_pk_bf16_f32 v48, v48, v49
    v_cvt_pk_bf16_f32 v49, v50, v51
    ds_write_b64 v64, v[48:49] offset:33536
    v_cvt_pk_bf16_f32 v52, v52, v53
    v_cvt_pk_bf16_f32 v53, v54, v55
    ds_write_b64 v64, v[52:53] offset:33664
    s_waitcnt vmcnt(5)
k1_kernel_k2j:

    v_mov_b32 v65, 0
    s_waitcnt lgkmcnt(0)
    s_barrier
    ds_read_b32 v65, v65 offset:8184

    s_setprio 3
    v_lshlrev_b32_sdwa v88, 3, v116 dst_sel:DWORD dst_unused:UNUSED_PAD src0_sel:DWORD src1_sel:WORD_0
    v_lshlrev_b32_sdwa v90, 3, v116 dst_sel:DWORD dst_unused:UNUSED_PAD src0_sel:DWORD src1_sel:WORD_1
    ds_read_b64 v[88:89], v88
    ds_read_b64 v[90:91], v90
    v_lshlrev_b32_sdwa v92, 3, v117 dst_sel:DWORD dst_unused:UNUSED_PAD src0_sel:DWORD src1_sel:WORD_0
    v_lshlrev_b32_sdwa v94, 3, v117 dst_sel:DWORD dst_unused:UNUSED_PAD src0_sel:DWORD src1_sel:WORD_1
    ds_read_b64 v[92:93], v92
    ds_read_b64 v[94:95], v94
    v_lshlrev_b32_sdwa v96, 3, v118 dst_sel:DWORD dst_unused:UNUSED_PAD src0_sel:DWORD src1_sel:WORD_0
    v_lshlrev_b32_sdwa v98, 3, v118 dst_sel:DWORD dst_unused:UNUSED_PAD src0_sel:DWORD src1_sel:WORD_1
    ds_read_b64 v[96:97], v96
    ds_read_b64 v[98:99], v98
    v_lshlrev_b32_sdwa v100, 3, v119 dst_sel:DWORD dst_unused:UNUSED_PAD src0_sel:DWORD src1_sel:WORD_0
    v_lshlrev_b32_sdwa v102, 3, v119 dst_sel:DWORD dst_unused:UNUSED_PAD src0_sel:DWORD src1_sel:WORD_1
    ds_read_b64 v[100:101], v100
    ds_read_b64 v[102:103], v102
    buffer_load_dwordx2 v[116:117], v71, s[12:15], s20 offen offset:2048 sc1
    buffer_load_dwordx2 v[118:119], v71, s[12:15], s20 offen offset:3072 sc1
    s_waitcnt lgkmcnt(8)
    v_readfirstlane_b32 s44, v65
    s_cmp_lg_u32 s44, 0
    s_cbranch_scc1 k1_kernel_solo1
    v_lshlrev_b32_sdwa v104, 3, v120 dst_sel:DWORD dst_unused:UNUSED_PAD src0_sel:DWORD src1_sel:WORD_0
    v_lshlrev_b32_sdwa v106, 3, v120 dst_sel:DWORD dst_unused:UNUSED_PAD src0_sel:DWORD src1_sel:WORD_1
    ds_read_b64 v[104:105], v104
    ds_read_b64 v[106:107], v106
    v_lshlrev_b32_sdwa v108, 3, v121 dst_sel:DWORD dst_unused:UNUSED_PAD src0_sel:DWORD src1_sel:WORD_0
    v_lshlrev_b32_sdwa v110, 3, v121 dst_sel:DWORD dst_unused:UNUSED_PAD src0_sel:DWORD src1_sel:WORD_1
    v_mov_b64 v[0:1], s[24:25]
    v_mov_b64 v[2:3], s[26:27]
    ds_read_b64 v[108:109], v108
    ds_read_b64 v[110:111], v110
    s_waitcnt lgkmcnt(8)
    v_smfmac_f32_16x16x64_bf16 v[0:3], v[66:69], v[88:95], v70
    v_lshlrev_b32_sdwa v88, 3, v122 dst_sel:DWORD dst_unused:UNUSED_PAD src0_sel:DWORD src1_sel:WORD_0
    v_lshlrev_b32_sdwa v90, 3, v122 dst_sel:DWORD dst_unused:UNUSED_PAD src0_sel:DWORD src1_sel:WORD_1
    ds_read_b64 v[88:89], v88
    ds_read_b64 v[90:91], v90
    v_lshlrev_b32_sdwa v92, 3, v123 dst_sel:DWORD dst_unused:UNUSED_PAD src0_sel:DWORD src1_sel:WORD_0
    v_lshlrev_b32_sdwa v94, 3, v123 dst_sel:DWORD dst_unused:UNUSED_PAD src0_sel:DWORD src1_sel:WORD_1
    s_nop 1
    v_cvt_pk_bf16_f32 v0, v0, v1
    v_cvt_pk_bf16_f32 v1, v2, v3
    v_mov_b64 v[4:5], s[24:25]
    v_mov_b64 v[6:7], s[26:27]
    ds_read_b64 v[92:93], v92
    ds_read_b64 v[94:95], v94
    s_add_u32 s20, s20, 0x1000
    buffer_load_dwordx2 v[120:121], v71, s[12:15], s20 offen offset:0 sc1
    buffer_load_dwordx2 v[122:123], v71, s[12:15], s20 offen offset:1024 sc1
    s_waitcnt lgkmcnt(8)
    v_smfmac_f32_16x16x64_bf16 v[4:7], v[66:69], v[96:103], v70
    v_lshlrev_b32_sdwa v96, 3, v124 dst_sel:DWORD dst_unused:UNUSED_PAD src0_sel:DWORD src1_sel:WORD_0
    v_lshlrev_b32_sdwa v98, 3, v124 dst_sel:DWORD dst_unused:UNUSED_PAD src0_sel:DWORD src1_sel:WORD_1
    ds_read_b64 v[96:97], v96
    ds_read_b64 v[98:99], v98
    v_lshlrev_b32_sdwa v100, 3, v125 dst_sel:DWORD dst_unused:UNUSED_PAD src0_sel:DWORD src1_sel:WORD_0
    v_lshlrev_b32_sdwa v102, 3, v125 dst_sel:DWORD dst_unused:UNUSED_PAD src0_sel:DWORD src1_sel:WORD_1
    s_nop 1
    v_cvt_pk_bf16_f32 v2, v4, v5
    v_cvt_pk_bf16_f32 v3, v6, v7
    v_mov_b64 v[8:9], s[24:25]
    v_mov_b64 v[10:11], s[26:27]
    ds_read_b64 v[100:101], v100
    ds_read_b64 v[102:103], v102
    s_waitcnt lgkmcnt(8)
    v_smfmac_f32_16x16x64_bf16 v[8:11], v[66:69], v[104:111], v70
    v_lshlrev_b32_sdwa v104, 3, v126 dst_sel:DWORD dst_unused:UNUSED_PAD src0_sel:DWORD src1_sel:WORD_0
    v_lshlrev_b32_sdwa v106, 3, v126 dst_sel:DWORD dst_unused:UNUSED_PAD src0_sel:DWORD src1_sel:WORD_1
    ds_read_b64 v[104:105], v104
    ds_read_b64 v[106:107], v106
    v_lshlrev_b32_sdwa v108, 3, v127 dst_sel:DWORD dst_unused:UNUSED_PAD src0_sel:DWORD src1_sel:WORD_0
    v_lshlrev_b32_sdwa v110, 3, v127 dst_sel:DWORD dst_unused:UNUSED_PAD src0_sel:DWORD src1_sel:WORD_1
    s_nop 1
    v_cvt_pk_bf16_f32 v4, v8, v9
    v_cvt_pk_bf16_f32 v5, v10, v11
    v_mov_b64 v[12:13], s[24:25]
    v_mov_b64 v[14:15], s[26:27]
    ds_read_b64 v[108:109], v108
    ds_read_b64 v[110:111], v110
    buffer_load_dwordx2 v[124:125], v71, s[12:15], s20 offen offset:2048 sc1
    buffer_load_dwordx2 v[126:127], v71, s[12:15], s20 offen offset:3072 sc1
    s_waitcnt lgkmcnt(8)
    v_smfmac_f32_16x16x64_bf16 v[12:15], v[66:69], v[88:95], v70
    s_waitcnt vmcnt(10)
    v_mfma_f32_16x16x32_bf16 v[112:115], v[72:75], v[128:131], 0
    s_waitcnt vmcnt(4)
    v_lshlrev_b32_sdwa v88, 3, v116 dst_sel:DWORD dst_unused:UNUSED_PAD src0_sel:DWORD src1_sel:WORD_0
    v_lshlrev_b32_sdwa v90, 3, v116 dst_sel:DWORD dst_unused:UNUSED_PAD src0_sel:DWORD src1_sel:WORD_1
    ds_read_b64 v[88:89], v88
    ds_read_b64 v[90:91], v90
    v_mfma_f32_16x16x32_bf16 v[112:115], v[76:79], v[132:135], v[112:115]
    v_add_u32 v70, 0x20000000, v70
    v_lshlrev_b32_sdwa v92, 3, v117 dst_sel:DWORD dst_unused:UNUSED_PAD src0_sel:DWORD src1_sel:WORD_0
    v_lshlrev_b32_sdwa v94, 3, v117 dst_sel:DWORD dst_unused:UNUSED_PAD src0_sel:DWORD src1_sel:WORD_1
    v_cvt_pk_bf16_f32 v6, v12, v13
    v_cvt_pk_bf16_f32 v7, v14, v15
    v_mov_b64 v[16:17], s[24:25]
    v_mov_b64 v[18:19], s[26:27]
    ds_read_b64 v[92:93], v92
    ds_read_b64 v[94:95], v94
    s_waitcnt lgkmcnt(8)
    v_smfmac_f32_16x16x64_bf16 v[16:19], v[66:69], v[96:103], v70
    v_mfma_f32_16x16x32_bf16 v[112:115], v[80:83], v[136:139], v[112:115]
    v_lshlrev_b32_sdwa v96, 3, v118 dst_sel:DWORD dst_unused:UNUSED_PAD src0_sel:DWORD src1_sel:WORD_0
    v_lshlrev_b32_sdwa v98, 3, v118 dst_sel:DWORD dst_unused:UNUSED_PAD src0_sel:DWORD src1_sel:WORD_1
    ds_read_b64 v[96:97], v96
    ds_read_b64 v[98:99], v98
    v_mfma_f32_16x16x32_bf16 v[112:115], v[84:87], v[140:143], v[112:115]
    v_lshlrev_b32_sdwa v100, 3, v119 dst_sel:DWORD dst_unused:UNUSED_PAD src0_sel:DWORD src1_sel:WORD_0
    v_lshlrev_b32_sdwa v102, 3, v119 dst_sel:DWORD dst_unused:UNUSED_PAD src0_sel:DWORD src1_sel:WORD_1
    v_cvt_pk_bf16_f32 v8, v16, v17
    v_cvt_pk_bf16_f32 v9, v18, v19
    v_mov_b64 v[20:21], s[24:25]
    v_mov_b64 v[22:23], s[26:27]
    ds_read_b64 v[100:101], v100
    ds_read_b64 v[102:103], v102
    s_add_u32 s20, s20, 0x1000
    buffer_load_dwordx2 v[116:117], v71, s[12:15], s20 offen offset:0 sc1
    buffer_load_dwordx2 v[118:119], v71, s[12:15], s20 offen offset:1024 sc1
    s_waitcnt lgkmcnt(8)
    v_smfmac_f32_16x16x64_bf16 v[20:23], v[66:69], v[104:111], v70
    v_cvt_pk_bf16_f32 v112, v112, v113
    v_cvt_pk_bf16_f32 v113, v114, v115
    v_lshlrev_b32_sdwa v114, 3, v70 dst_sel:DWORD dst_unused:UNUSED_PAD src0_sel:DWORD src1_sel:WORD_1
    ds_write_b64 v114, v[112:113] offset:32768
    s_waitcnt vmcnt(4)
    v_lshlrev_b32_sdwa v104, 3, v120 dst_sel:DWORD dst_unused:UNUSED_PAD src0_sel:DWORD src1_sel:WORD_0
    v_lshlrev_b32_sdwa v106, 3, v120 dst_sel:DWORD dst_unused:UNUSED_PAD src0_sel:DWORD src1_sel:WORD_1
    ds_read_b64 v[104:105], v104
    ds_read_b64 v[106:107], v106
    v_lshlrev_b32_sdwa v108, 3, v121 dst_sel:DWORD dst_unused:UNUSED_PAD src0_sel:DWORD src1_sel:WORD_0
    v_lshlrev_b32_sdwa v110, 3, v121 dst_sel:DWORD dst_unused:UNUSED_PAD src0_sel:DWORD src1_sel:WORD_1
    v_cvt_pk_bf16_f32 v10, v20, v21
    v_cvt_pk_bf16_f32 v11, v22, v23
    v_mov_b64 v[24:25], s[24:25]
    v_mov_b64 v[26:27], s[26:27]
    ds_read_b64 v[108:109], v108
    ds_read_b64 v[110:111], v110
    s_waitcnt lgkmcnt(9)
    v_smfmac_f32_16x16x64_bf16 v[24:27], v[66:69], v[88:95], v70
    v_lshlrev_b32_sdwa v88, 3, v122 dst_sel:DWORD dst_unused:UNUSED_PAD src0_sel:DWORD src1_sel:WORD_0
    v_lshlrev_b32_sdwa v90, 3, v122 dst_sel:DWORD dst_unused:UNUSED_PAD src0_sel:DWORD src1_sel:WORD_1
    ds_read_b64 v[88:89], v88
    ds_read_b64 v[90:91], v90
    v_lshlrev_b32_sdwa v92, 3, v123 dst_sel:DWORD dst_unused:UNUSED_PAD src0_sel:DWORD src1_sel:WORD_0
    v_lshlrev_b32_sdwa v94, 3, v123 dst_sel:DWORD dst_unused:UNUSED_PAD src0_sel:DWORD src1_sel:WORD_1
    s_nop 1
    v_cvt_pk_bf16_f32 v12, v24, v25
    v_cvt_pk_bf16_f32 v13, v26, v27
    v_mov_b64 v[28:29], s[24:25]
    v_mov_b64 v[30:31], s[26:27]
    ds_read_b64 v[92:93], v92
    ds_read_b64 v[94:95], v94
    buffer_load_dwordx2 v[120:121], v71, s[12:15], s20 offen offset:2048 sc1
    buffer_load_dwordx2 v[122:123], v71, s[12:15], s20 offen offset:3072 sc1
    s_waitcnt lgkmcnt(9)
    v_smfmac_f32_16x16x64_bf16 v[28:31], v[66:69], v[96:103], v70
    s_waitcnt vmcnt(4)
    v_lshlrev_b32_sdwa v96, 3, v124 dst_sel:DWORD dst_unused:UNUSED_PAD src0_sel:DWORD src1_sel:WORD_0
    v_lshlrev_b32_sdwa v98, 3, v124 dst_sel:DWORD dst_unused:UNUSED_PAD src0_sel:DWORD src1_sel:WORD_1
    ds_read_b64 v[96:97], v96
    ds_read_b64 v[98:99], v98
    v_lshlrev_b32_sdwa v100, 3, v125 dst_sel:DWORD dst_unused:UNUSED_PAD src0_sel:DWORD src1_sel:WORD_0
    v_lshlrev_b32_sdwa v102, 3, v125 dst_sel:DWORD dst_unused:UNUSED_PAD src0_sel:DWORD src1_sel:WORD_1
    s_nop 0
    v_cvt_pk_bf16_f32 v14, v28, v29
    v_cvt_pk_bf16_f32 v15, v30, v31
    v_mov_b64 v[32:33], s[24:25]
    v_mov_b64 v[34:35], s[26:27]
    ds_read_b64 v[100:101], v100
    ds_read_b64 v[102:103], v102
    s_waitcnt lgkmcnt(8)
    v_smfmac_f32_16x16x64_bf16 v[32:35], v[66:69], v[104:111], v70
    v_mfma_f32_16x16x32_bf16 v[112:115], v[72:75], v[144:147], 0
    v_lshlrev_b32_sdwa v104, 3, v126 dst_sel:DWORD dst_unused:UNUSED_PAD src0_sel:DWORD src1_sel:WORD_0
    v_lshlrev_b32_sdwa v106, 3, v126 dst_sel:DWORD dst_unused:UNUSED_PAD src0_sel:DWORD src1_sel:WORD_1
    ds_read_b64 v[104:105], v104
    ds_read_b64 v[106:107], v106
    v_mfma_f32_16x16x32_bf16 v[112:115], v[76:79], v[148:151], v[112:115]
    v_lshlrev_b32_sdwa v108, 3, v127 dst_sel:DWORD dst_unused:UNUSED_PAD src0_sel:DWORD src1_sel:WORD_0
    v_lshlrev_b32_sdwa v110, 3, v127 dst_sel:DWORD dst_unused:UNUSED_PAD src0_sel:DWORD src1_sel:WORD_1
    v_cvt_pk_bf16_f32 v16, v32, v33
    v_cvt_pk_bf16_f32 v17, v34, v35
    v_mov_b64 v[36:37], s[24:25]
    v_mov_b64 v[38:39], s[26:27]
    ds_read_b64 v[108:109], v108
    ds_read_b64 v[110:111], v110
    s_add_u32 s20, s20, 0x1d000
    buffer_load_dwordx4 v[124:127], v71, s[12:15], s20 offen offset:0 sc1
    s_waitcnt lgkmcnt(8)
    v_smfmac_f32_16x16x64_bf16 v[36:39], v[66:69], v[88:95], v70
    v_mfma_f32_16x16x32_bf16 v[112:115], v[80:83], v[152:155], v[112:115]
    s_waitcnt vmcnt(3)
    v_lshlrev_b32_sdwa v88, 3, v116 dst_sel:DWORD dst_unused:UNUSED_PAD src0_sel:DWORD src1_sel:WORD_0
    v_lshlrev_b32_sdwa v90, 3, v116 dst_sel:DWORD dst_unused:UNUSED_PAD src0_sel:DWORD src1_sel:WORD_1
    ds_read_b64 v[88:89], v88
    ds_read_b64 v[90:91], v90
    v_mfma_f32_16x16x32_bf16 v[112:115], v[84:87], v[156:159], v[112:115]
    v_lshlrev_b32_sdwa v92, 3, v117 dst_sel:DWORD dst_unused:UNUSED_PAD src0_sel:DWORD src1_sel:WORD_0
    v_lshlrev_b32_sdwa v94, 3, v117 dst_sel:DWORD dst_unused:UNUSED_PAD src0_sel:DWORD src1_sel:WORD_1
    v_cvt_pk_bf16_f32 v18, v36, v37
    v_cvt_pk_bf16_f32 v19, v38, v39
    v_mov_b64 v[40:41], s[24:25]
    v_mov_b64 v[42:43], s[26:27]
    ds_read_b64 v[92:93], v92
    ds_read_b64 v[94:95], v94
    s_waitcnt lgkmcnt(8)
    v_smfmac_f32_16x16x64_bf16 v[40:43], v[66:69], v[96:103], v70
    v_cvt_pk_bf16_f32 v112, v112, v113
    v_cvt_pk_bf16_f32 v113, v114, v115
    v_lshlrev_b32_sdwa v114, 3, v70 dst_sel:DWORD dst_unused:UNUSED_PAD src0_sel:DWORD src1_sel:WORD_1
    ds_write_b64 v114, v[112:113] offset:32896
    v_lshlrev_b32_sdwa v96, 3, v118 dst_sel:DWORD dst_unused:UNUSED_PAD src0_sel:DWORD src1_sel:WORD_0
    v_lshlrev_b32_sdwa v98, 3, v118 dst_sel:DWORD dst_unused:UNUSED_PAD src0_sel:DWORD src1_sel:WORD_1
    ds_read_b64 v[96:97], v96
    ds_read_b64 v[98:99], v98
    v_lshlrev_b32_sdwa v100, 3, v119 dst_sel:DWORD dst_unused:UNUSED_PAD src0_sel:DWORD src1_sel:WORD_0
    v_lshlrev_b32_sdwa v102, 3, v119 dst_sel:DWORD dst_unused:UNUSED_PAD src0_sel:DWORD src1_sel:WORD_1
    v_cvt_pk_bf16_f32 v20, v40, v41
    v_cvt_pk_bf16_f32 v21, v42, v43
    v_mov_b64 v[44:45], s[24:25]
    v_mov_b64 v[46:47], s[26:27]
    ds_read_b64 v[100:101], v100
    ds_read_b64 v[102:103], v102
    buffer_load_dwordx4 v[116:119], v71, s[12:15], s20 offen offset:1024 sc1
    s_waitcnt lgkmcnt(9)
    v_smfmac_f32_16x16x64_bf16 v[44:47], v[66:69], v[104:111], v70
    s_waitcnt vmcnt(2)
    v_lshlrev_b32_sdwa v104, 3, v120 dst_sel:DWORD dst_unused:UNUSED_PAD src0_sel:DWORD src1_sel:WORD_0
    v_lshlrev_b32_sdwa v106, 3, v120 dst_sel:DWORD dst_unused:UNUSED_PAD src0_sel:DWORD src1_sel:WORD_1
    ds_read_b64 v[104:105], v104
    ds_read_b64 v[106:107], v106
    v_lshlrev_b32_sdwa v108, 3, v121 dst_sel:DWORD dst_unused:UNUSED_PAD src0_sel:DWORD src1_sel:WORD_0
    v_lshlrev_b32_sdwa v110, 3, v121 dst_sel:DWORD dst_unused:UNUSED_PAD src0_sel:DWORD src1_sel:WORD_1
    s_nop 0
    v_cvt_pk_bf16_f32 v22, v44, v45
    v_cvt_pk_bf16_f32 v23, v46, v47
    v_mov_b64 v[48:49], s[24:25]
    v_mov_b64 v[50:51], s[26:27]
    ds_read_b64 v[108:109], v108
    ds_read_b64 v[110:111], v110
    s_waitcnt lgkmcnt(9)
    v_smfmac_f32_16x16x64_bf16 v[48:51], v[66:69], v[88:95], v70
    v_lshlrev_b32_sdwa v88, 3, v122 dst_sel:DWORD dst_unused:UNUSED_PAD src0_sel:DWORD src1_sel:WORD_0
    v_lshlrev_b32_sdwa v90, 3, v122 dst_sel:DWORD dst_unused:UNUSED_PAD src0_sel:DWORD src1_sel:WORD_1
    ds_read_b64 v[88:89], v88
    ds_read_b64 v[90:91], v90
    v_lshlrev_b32_sdwa v92, 3, v123 dst_sel:DWORD dst_unused:UNUSED_PAD src0_sel:DWORD src1_sel:WORD_0
    v_lshlrev_b32_sdwa v94, 3, v123 dst_sel:DWORD dst_unused:UNUSED_PAD src0_sel:DWORD src1_sel:WORD_1
    s_nop 1
    v_cvt_pk_bf16_f32 v24, v48, v49
    v_cvt_pk_bf16_f32 v25, v50, v51
    v_mov_b64 v[52:53], s[24:25]
    v_mov_b64 v[54:55], s[26:27]
    ds_read_b64 v[92:93], v92
    ds_read_b64 v[94:95], v94
    buffer_load_dwordx4 v[120:123], v71, s[12:15], s20 offen offset:2048 sc1
    s_waitcnt lgkmcnt(8)
    v_smfmac_f32_16x16x64_bf16 v[52:55], v[66:69], v[96:103], v70
    v_mfma_f32_16x16x32_bf16 v[112:115], v[72:75], v[160:163], 0
    s_waitcnt vmcnt(2)
    v_lshlrev_b32_sdwa v96, 3, v124 dst_sel:DWORD dst_unused:UNUSED_PAD src0_sel:DWORD src1_sel:WORD_0
    v_lshlrev_b32_sdwa v98, 3, v124 dst_sel:DWORD dst_unused:UNUSED_PAD src0_sel:DWORD src1_sel:WORD_1
    ds_read_b64 v[96:97], v96
    ds_read_b64 v[98:99], v98
    v_mfma_f32_16x16x32_bf16 v[112:115], v[76:79], v[164:167], v[112:115]
    v_lshlrev_b32_sdwa v100, 3, v125 dst_sel:DWORD dst_unused:UNUSED_PAD src0_sel:DWORD src1_sel:WORD_0
    v_lshlrev_b32_sdwa v102, 3, v125 dst_sel:DWORD dst_unused:UNUSED_PAD src0_sel:DWORD src1_sel:WORD_1
    v_cvt_pk_bf16_f32 v26, v52, v53
    v_cvt_pk_bf16_f32 v27, v54, v55
    v_mov_b64 v[56:57], s[24:25]
    v_mov_b64 v[58:59], s[26:27]
    ds_read_b64 v[100:101], v100
    ds_read_b64 v[102:103], v102
    s_waitcnt lgkmcnt(8)
    v_smfmac_f32_16x16x64_bf16 v[56:59], v[66:69], v[104:111], v70
    v_mfma_f32_16x16x32_bf16 v[112:115], v[80:83], v[168:171], v[112:115]
    v_lshlrev_b32_sdwa v104, 3, v126 dst_sel:DWORD dst_unused:UNUSED_PAD src0_sel:DWORD src1_sel:WORD_0
    v_lshlrev_b32_sdwa v106, 3, v126 dst_sel:DWORD dst_unused:UNUSED_PAD src0_sel:DWORD src1_sel:WORD_1
    ds_read_b64 v[104:105], v104
    ds_read_b64 v[106:107], v106
    v_mfma_f32_16x16x32_bf16 v[112:115], v[84:87], v[172:175], v[112:115]
    v_lshlrev_b32_sdwa v108, 3, v127 dst_sel:DWORD dst_unused:UNUSED_PAD src0_sel:DWORD src1_sel:WORD_0
    v_lshlrev_b32_sdwa v110, 3, v127 dst_sel:DWORD dst_unused:UNUSED_PAD src0_sel:DWORD src1_sel:WORD_1
    v_cvt_pk_bf16_f32 v28, v56, v57
    v_cvt_pk_bf16_f32 v29, v58, v59
    v_mov_b64 v[60:61], s[24:25]
    v_mov_b64 v[62:63], s[26:27]
    ds_read_b64 v[108:109], v108
    ds_read_b64 v[110:111], v110
    buffer_load_dwordx4 v[124:127], v71, s[12:15], s20 offen offset:3072 sc1
    s_waitcnt lgkmcnt(8)
    v_smfmac_f32_16x16x64_bf16 v[60:63], v[66:69], v[88:95], v70
    v_cvt_pk_bf16_f32 v112, v112, v113
    v_cvt_pk_bf16_f32 v113, v114, v115
    v_lshlrev_b32_sdwa v114, 3, v70 dst_sel:DWORD dst_unused:UNUSED_PAD src0_sel:DWORD src1_sel:WORD_1
    ds_write_b64 v114, v[112:113] offset:33024
    s_waitcnt vmcnt(2)
    v_lshlrev_b32_sdwa v88, 3, v116 dst_sel:DWORD dst_unused:UNUSED_PAD src0_sel:DWORD src1_sel:WORD_0
    v_lshlrev_b32_sdwa v90, 3, v116 dst_sel:DWORD dst_unused:UNUSED_PAD src0_sel:DWORD src1_sel:WORD_1
    ds_read_b64 v[88:89], v88
    ds_read_b64 v[90:91], v90
    v_lshlrev_b32_sdwa v92, 3, v117 dst_sel:DWORD dst_unused:UNUSED_PAD src0_sel:DWORD src1_sel:WORD_0
    v_lshlrev_b32_sdwa v94, 3, v117 dst_sel:DWORD dst_unused:UNUSED_PAD src0_sel:DWORD src1_sel:WORD_1
    v_cvt_pk_bf16_f32 v30, v60, v61
    v_cvt_pk_bf16_f32 v31, v62, v63
    v_mov_b64 v[62:63], 0
    v_mov_b64 v[64:65], 0
    ds_read_b64 v[92:93], v92
    ds_read_b64 v[94:95], v94
    s_waitcnt lgkmcnt(9)
    v_smfmac_f32_16x16x64_bf16 v[62:65], v[66:69], v[96:103], v70
    v_lshlrev_b32_sdwa v96, 3, v118 dst_sel:DWORD dst_unused:UNUSED_PAD src0_sel:DWORD src1_sel:WORD_0
    v_lshlrev_b32_sdwa v98, 3, v118 dst_sel:DWORD dst_unused:UNUSED_PAD src0_sel:DWORD src1_sel:WORD_1
    ds_read_b64 v[96:97], v96
    ds_read_b64 v[98:99], v98
    v_lshlrev_b32_sdwa v100, 3, v119 dst_sel:DWORD dst_unused:UNUSED_PAD src0_sel:DWORD src1_sel:WORD_0
    v_lshlrev_b32_sdwa v102, 3, v119 dst_sel:DWORD dst_unused:UNUSED_PAD src0_sel:DWORD src1_sel:WORD_1
    ds_read_b64 v[100:101], v100
    ds_read_b64 v[102:103], v102
    s_add_u32 s20, s20, 0x1000
    buffer_load_dwordx4 v[116:119], v71, s[12:15], s20 offen offset:0 sc1
    s_waitcnt lgkmcnt(9)
    v_smfmac_f32_16x16x64_bf16 v[62:65], v[66:69], v[104:111], v70
    s_waitcnt vmcnt(2)
    v_lshlrev_b32_sdwa v104, 3, v120 dst_sel:DWORD dst_unused:UNUSED_PAD src0_sel:DWORD src1_sel:WORD_0
    v_lshlrev_b32_sdwa v106, 3, v120 dst_sel:DWORD dst_unused:UNUSED_PAD src0_sel:DWORD src1_sel:WORD_1
    ds_read_b64 v[104:105], v104
    ds_read_b64 v[106:107], v106
    v_lshlrev_b32_sdwa v108, 3, v121 dst_sel:DWORD dst_unused:UNUSED_PAD src0_sel:DWORD src1_sel:WORD_0
    v_lshlrev_b32_sdwa v110, 3, v121 dst_sel:DWORD dst_unused:UNUSED_PAD src0_sel:DWORD src1_sel:WORD_1
    s_nop 0
    v_cvt_pk_bf16_f32 v65, v64, v65
    v_cvt_pk_bf16_f32 v64, v62, v63
    v_mov_b64 v[60:61], 0
    v_mov_b64 v[62:63], 0
    ds_read_b64 v[108:109], v108
    ds_read_b64 v[110:111], v110
    s_waitcnt lgkmcnt(8)
    v_smfmac_f32_16x16x64_bf16 v[60:63], v[66:69], v[88:95], v70
    v_mfma_f32_16x16x32_bf16 v[112:115], v[72:75], v[176:179], 0
    v_lshlrev_b32_sdwa v88, 3, v122 dst_sel:DWORD dst_unused:UNUSED_PAD src0_sel:DWORD src1_sel:WORD_0
    v_lshlrev_b32_sdwa v90, 3, v122 dst_sel:DWORD dst_unused:UNUSED_PAD src0_sel:DWORD src1_sel:WORD_1
    ds_read_b64 v[88:89], v88
    ds_read_b64 v[90:91], v90
    v_mfma_f32_16x16x32_bf16 v[112:115], v[76:79], v[180:183], v[112:115]
    v_lshlrev_b32_sdwa v92, 3, v123 dst_sel:DWORD dst_unused:UNUSED_PAD src0_sel:DWORD src1_sel:WORD_0
    v_lshlrev_b32_sdwa v94, 3, v123 dst_sel:DWORD dst_unused:UNUSED_PAD src0_sel:DWORD src1_sel:WORD_1
    ds_read_b64 v[92:93], v92
    ds_read_b64 v[94:95], v94
    buffer_load_dwordx4 v[120:123], v71, s[12:15], s20 offen offset:1024 sc1
    s_waitcnt lgkmcnt(8)
    v_smfmac_f32_16x16x64_bf16 v[60:63], v[66:69], v[96:103], v70
    v_mfma_f32_16x16x32_bf16 v[112:115], v[80:83], v[184:187], v[112:115]
    s_waitcnt vmcnt(2)
    v_lshlrev_b32_sdwa v96, 3, v124 dst_sel:DWORD dst_unused:UNUSED_PAD src0_sel:DWORD src1_sel:WORD_0
    v_lshlrev_b32_sdwa v98, 3, v124 dst_sel:DWORD dst_unused:UNUSED_PAD src0_sel:DWORD src1_sel:WORD_1
    ds_read_b64 v[96:97], v96
    ds_read_b64 v[98:99], v98
    v_mfma_f32_16x16x32_bf16 v[112:115], v[84:87], v[188:191], v[112:115]
    v_lshlrev_b32_sdwa v100, 3, v125 dst_sel:DWORD dst_unused:UNUSED_PAD src0_sel:DWORD src1_sel:WORD_0
    v_lshlrev_b32_sdwa v102, 3, v125 dst_sel:DWORD dst_unused:UNUSED_PAD src0_sel:DWORD src1_sel:WORD_1
    v_cvt_pk_bf16_f32 v63, v62, v63
    v_cvt_pk_bf16_f32 v62, v60, v61
    v_mov_b64 v[58:59], 0
    v_mov_b64 v[60:61], 0
    ds_read_b64 v[100:101], v100
    ds_read_b64 v[102:103], v102
    s_waitcnt lgkmcnt(8)
    v_smfmac_f32_16x16x64_bf16 v[58:61], v[66:69], v[104:111], v70
    v_cvt_pk_bf16_f32 v112, v112, v113
    v_cvt_pk_bf16_f32 v113, v114, v115
    v_lshlrev_b32_sdwa v114, 3, v70 dst_sel:DWORD dst_unused:UNUSED_PAD src0_sel:DWORD src1_sel:WORD_1
    ds_write_b64 v114, v[112:113] offset:33152
    v_lshlrev_b32_sdwa v104, 3, v126 dst_sel:DWORD dst_unused:UNUSED_PAD src0_sel:DWORD src1_sel:WORD_0
    v_lshlrev_b32_sdwa v106, 3, v126 dst_sel:DWORD dst_unused:UNUSED_PAD src0_sel:DWORD src1_sel:WORD_1
    ds_read_b64 v[104:105], v104
    ds_read_b64 v[106:107], v106
    v_lshlrev_b32_sdwa v108, 3, v127 dst_sel:DWORD dst_unused:UNUSED_PAD src0_sel:DWORD src1_sel:WORD_0
    v_lshlrev_b32_sdwa v110, 3, v127 dst_sel:DWORD dst_unused:UNUSED_PAD src0_sel:DWORD src1_sel:WORD_1
    ds_read_b64 v[108:109], v108
    ds_read_b64 v[110:111], v110
    buffer_load_dwordx4 v[124:127], v71, s[12:15], s20 offen offset:2048 sc1
    s_waitcnt lgkmcnt(9)
    v_smfmac_f32_16x16x64_bf16 v[58:61], v[66:69], v[88:95], v70
    s_waitcnt vmcnt(2)
    v_lshlrev_b32_sdwa v88, 3, v116 dst_sel:DWORD dst_unused:UNUSED_PAD src0_sel:DWORD src1_sel:WORD_0
    v_lshlrev_b32_sdwa v90, 3, v116 dst_sel:DWORD dst_unused:UNUSED_PAD src0_sel:DWORD src1_sel:WORD_1
    ds_read_b64 v[88:89], v88
    ds_read_b64 v[90:91], v90
    v_lshlrev_b32_sdwa v92, 3, v117 dst_sel:DWORD dst_unused:UNUSED_PAD src0_sel:DWORD src1_sel:WORD_0
    v_lshlrev_b32_sdwa v94, 3, v117 dst_sel:DWORD dst_unused:UNUSED_PAD src0_sel:DWORD src1_sel:WORD_1
    s_nop 0
    v_cvt_pk_bf16_f32 v61, v60, v61
    v_cvt_pk_bf16_f32 v60, v58, v59
    v_mov_b64 v[56:57], 0
    v_mov_b64 v[58:59], 0
    ds_read_b64 v[92:93], v92
    ds_read_b64 v[94:95], v94
    s_waitcnt lgkmcnt(9)
    v_smfmac_f32_16x16x64_bf16 v[56:59], v[66:69], v[96:103], v70
    v_lshlrev_b32_sdwa v96, 3, v118 dst_sel:DWORD dst_unused:UNUSED_PAD src0_sel:DWORD src1_sel:WORD_0
    v_lshlrev_b32_sdwa v98, 3, v118 dst_sel:DWORD dst_unused:UNUSED_PAD src0_sel:DWORD src1_sel:WORD_1
    ds_read_b64 v[96:97], v96
    ds_read_b64 v[98:99], v98
    v_lshlrev_b32_sdwa v100, 3, v119 dst_sel:DWORD dst_unused:UNUSED_PAD src0_sel:DWORD src1_sel:WORD_0
    v_lshlrev_b32_sdwa v102, 3, v119 dst_sel:DWORD dst_unused:UNUSED_PAD src0_sel:DWORD src1_sel:WORD_1
    ds_read_b64 v[100:101], v100
    ds_read_b64 v[102:103], v102
    buffer_load_dwordx4 v[116:119], v71, s[12:15], s20 offen offset:3072 sc1
    s_waitcnt lgkmcnt(8)
    v_smfmac_f32_16x16x64_bf16 v[56:59], v[66:69], v[104:111], v70
    v_mfma_f32_16x16x32_bf16 v[112:115], v[72:75], v[192:195], 0
    s_waitcnt vmcnt(2)
    v_lshlrev_b32_sdwa v104, 3, v120 dst_sel:DWORD dst_unused:UNUSED_PAD src0_sel:DWORD src1_sel:WORD_0
    v_lshlrev_b32_sdwa v106, 3, v120 dst_sel:DWORD dst_unused:UNUSED_PAD src0_sel:DWORD src1_sel:WORD_1
    ds_read_b64 v[104:105], v104
    ds_read_b64 v[106:107], v106
    v_mfma_f32_16x16x32_bf16 v[112:115], v[76:79], v[196:199], v[112:115]
    v_lshlrev_b32_sdwa v108, 3, v121 dst_sel:DWORD dst_unused:UNUSED_PAD src0_sel:DWORD src1_sel:WORD_0
    v_lshlrev_b32_sdwa v110, 3, v121 dst_sel:DWORD dst_unused:UNUSED_PAD src0_sel:DWORD src1_sel:WORD_1
    v_cvt_pk_bf16_f32 v59, v58, v59
    v_cvt_pk_bf16_f32 v58, v56, v57
    v_mov_b64 v[54:55], 0
    v_mov_b64 v[56:57], 0
    ds_read_b64 v[108:109], v108
    ds_read_b64 v[110:111], v110
    s_waitcnt lgkmcnt(8)
    v_smfmac_f32_16x16x64_bf16 v[54:57], v[66:69], v[88:95], v70
    v_mfma_f32_16x16x32_bf16 v[112:115], v[80:83], v[200:203], v[112:115]
    v_lshlrev_b32_sdwa v88, 3, v122 dst_sel:DWORD dst_unused:UNUSED_PAD src0_sel:DWORD src1_sel:WORD_0
    v_lshlrev_b32_sdwa v90, 3, v122 dst_sel:DWORD dst_unused:UNUSED_PAD src0_sel:DWORD src1_sel:WORD_1
    ds_read_b64 v[88:89], v88
    ds_read_b64 v[90:91], v90
    v_mfma_f32_16x16x32_bf16 v[112:115], v[84:87], v[204:207], v[112:115]
    v_lshlrev_b32_sdwa v92, 3, v123 dst_sel:DWORD dst_unused:UNUSED_PAD src0_sel:DWORD src1_sel:WORD_0
    v_lshlrev_b32_sdwa v94, 3, v123 dst_sel:DWORD dst_unused:UNUSED_PAD src0_sel:DWORD src1_sel:WORD_1
    ds_read_b64 v[92:93], v92
    ds_read_b64 v[94:95], v94
    s_add_u32 s20, s20, 0x1000
    buffer_load_dwordx4 v[120:123], v71, s[12:15], s20 offen offset:0 sc1
    s_waitcnt lgkmcnt(8)
    v_smfmac_f32_16x16x64_bf16 v[54:57], v[66:69], v[96:103], v70
    v_cvt_pk_bf16_f32 v112, v112, v113
    v_cvt_pk_bf16_f32 v113, v114, v115
    v_lshlrev_b32_sdwa v114, 3, v70 dst_sel:DWORD dst_unused:UNUSED_PAD src0_sel:DWORD src1_sel:WORD_1
    ds_write_b64 v114, v[112:113] offset:33280
    s_waitcnt vmcnt(2)
    v_lshlrev_b32_sdwa v96, 3, v124 dst_sel:DWORD dst_unused:UNUSED_PAD src0_sel:DWORD src1_sel:WORD_0
    v_lshlrev_b32_sdwa v98, 3, v124 dst_sel:DWORD dst_unused:UNUSED_PAD src0_sel:DWORD src1_sel:WORD_1
    ds_read_b64 v[96:97], v96
    ds_read_b64 v[98:99], v98
    v_lshlrev_b32_sdwa v100, 3, v125 dst_sel:DWORD dst_unused:UNUSED_PAD src0_sel:DWORD src1_sel:WORD_0
    v_lshlrev_b32_sdwa v102, 3, v125 dst_sel:DWORD dst_unused:UNUSED_PAD src0_sel:DWORD src1_sel:WORD_1
    v_cvt_pk_bf16_f32 v57, v56, v57
    v_cvt_pk_bf16_f32 v56, v54, v55
    v_mov_b64 v[52:53], 0
    v_mov_b64 v[54:55], 0
    ds_read_b64 v[100:101], v100
    ds_read_b64 v[102:103], v102
    s_waitcnt lgkmcnt(9)
    v_smfmac_f32_16x16x64_bf16 v[52:55], v[66:69], v[104:111], v70
    v_lshlrev_b32_sdwa v104, 3, v126 dst_sel:DWORD dst_unused:UNUSED_PAD src0_sel:DWORD src1_sel:WORD_0
    v_lshlrev_b32_sdwa v106, 3, v126 dst_sel:DWORD dst_unused:UNUSED_PAD src0_sel:DWORD src1_sel:WORD_1
    ds_read_b64 v[104:105], v104
    ds_read_b64 v[106:107], v106
    v_lshlrev_b32_sdwa v108, 3, v127 dst_sel:DWORD dst_unused:UNUSED_PAD src0_sel:DWORD src1_sel:WORD_0
    v_lshlrev_b32_sdwa v110, 3, v127 dst_sel:DWORD dst_unused:UNUSED_PAD src0_sel:DWORD src1_sel:WORD_1
    ds_read_b64 v[108:109], v108
    ds_read_b64 v[110:111], v110
    buffer_load_dwordx4 v[124:127], v71, s[12:15], s20 offen offset:1024 sc1
    s_waitcnt lgkmcnt(9)
    v_smfmac_f32_16x16x64_bf16 v[52:55], v[66:69], v[88:95], v70
    s_waitcnt vmcnt(2)
    v_lshlrev_b32_sdwa v88, 3, v116 dst_sel:DWORD dst_unused:UNUSED_PAD src0_sel:DWORD src1_sel:WORD_0
    v_lshlrev_b32_sdwa v90, 3, v116 dst_sel:DWORD dst_unused:UNUSED_PAD src0_sel:DWORD src1_sel:WORD_1
    ds_read_b64 v[88:89], v88
    ds_read_b64 v[90:91], v90
    v_lshlrev_b32_sdwa v92, 3, v117 dst_sel:DWORD dst_unused:UNUSED_PAD src0_sel:DWORD src1_sel:WORD_0
    v_lshlrev_b32_sdwa v94, 3, v117 dst_sel:DWORD dst_unused:UNUSED_PAD src0_sel:DWORD src1_sel:WORD_1
    s_nop 0
    v_cvt_pk_bf16_f32 v55, v54, v55
    v_cvt_pk_bf16_f32 v54, v52, v53
    v_mov_b64 v[50:51], 0
    v_mov_b64 v[52:53], 0
    ds_read_b64 v[92:93], v92
    ds_read_b64 v[94:95], v94
    s_waitcnt lgkmcnt(8)
    v_smfmac_f32_16x16x64_bf16 v[50:53], v[66:69], v[96:103], v70
    v_mfma_f32_16x16x32_bf16 v[112:115], v[72:75], v[208:211], 0
    v_lshlrev_b32_sdwa v96, 3, v118 dst_sel:DWORD dst_unused:UNUSED_PAD src0_sel:DWORD src1_sel:WORD_0
    v_lshlrev_b32_sdwa v98, 3, v118 dst_sel:DWORD dst_unused:UNUSED_PAD src0_sel:DWORD src1_sel:WORD_1
    ds_read_b64 v[96:97], v96
    ds_read_b64 v[98:99], v98
    v_mfma_f32_16x16x32_bf16 v[112:115], v[76:79], v[212:215], v[112:115]
    v_lshlrev_b32_sdwa v100, 3, v119 dst_sel:DWORD dst_unused:UNUSED_PAD src0_sel:DWORD src1_sel:WORD_0
    v_lshlrev_b32_sdwa v102, 3, v119 dst_sel:DWORD dst_unused:UNUSED_PAD src0_sel:DWORD src1_sel:WORD_1
    ds_read_b64 v[100:101], v100
    ds_read_b64 v[102:103], v102
    buffer_load_dwordx4 v[116:119], v71, s[12:15], s20 offen offset:2048 sc1
    s_waitcnt lgkmcnt(8)
    v_smfmac_f32_16x16x64_bf16 v[50:53], v[66:69], v[104:111], v70
    v_mfma_f32_16x16x32_bf16 v[112:115], v[80:83], v[216:219], v[112:115]
    s_waitcnt vmcnt(2)
    v_lshlrev_b32_sdwa v104, 3, v120 dst_sel:DWORD dst_unused:UNUSED_PAD src0_sel:DWORD src1_sel:WORD_0
    v_lshlrev_b32_sdwa v106, 3, v120 dst_sel:DWORD dst_unused:UNUSED_PAD src0_sel:DWORD src1_sel:WORD_1
    ds_read_b64 v[104:105], v104
    ds_read_b64 v[106:107], v106
    v_mfma_f32_16x16x32_bf16 v[112:115], v[84:87], v[220:223], v[112:115]
    v_lshlrev_b32_sdwa v108, 3, v121 dst_sel:DWORD dst_unused:UNUSED_PAD src0_sel:DWORD src1_sel:WORD_0
    v_lshlrev_b32_sdwa v110, 3, v121 dst_sel:DWORD dst_unused:UNUSED_PAD src0_sel:DWORD src1_sel:WORD_1
    v_cvt_pk_bf16_f32 v53, v52, v53
    v_cvt_pk_bf16_f32 v52, v50, v51
    v_mov_b64 v[48:49], 0
    v_mov_b64 v[50:51], 0
    ds_read_b64 v[108:109], v108
    ds_read_b64 v[110:111], v110
    s_waitcnt lgkmcnt(8)
    v_smfmac_f32_16x16x64_bf16 v[48:51], v[66:69], v[88:95], v70
    v_cvt_pk_bf16_f32 v112, v112, v113
    v_cvt_pk_bf16_f32 v113, v114, v115
    v_lshlrev_b32_sdwa v114, 3, v70 dst_sel:DWORD dst_unused:UNUSED_PAD src0_sel:DWORD src1_sel:WORD_1
    ds_write_b64 v114, v[112:113] offset:33408
    s_setprio 2
    v_lshlrev_b32_sdwa v88, 3, v122 dst_sel:DWORD dst_unused:UNUSED_PAD src0_sel:DWORD src1_sel:WORD_0
    v_lshlrev_b32_sdwa v90, 3, v122 dst_sel:DWORD dst_unused:UNUSED_PAD src0_sel:DWORD src1_sel:WORD_1
    ds_read_b64 v[88:89], v88
    ds_read_b64 v[90:91], v90
    v_lshlrev_b32_sdwa v92, 3, v123 dst_sel:DWORD dst_unused:UNUSED_PAD src0_sel:DWORD src1_sel:WORD_0
    v_lshlrev_b32_sdwa v94, 3, v123 dst_sel:DWORD dst_unused:UNUSED_PAD src0_sel:DWORD src1_sel:WORD_1
    ds_read_b64 v[92:93], v92
    ds_read_b64 v[94:95], v94
    buffer_load_dwordx4 v[120:123], v71, s[12:15], s20 offen offset:3072 sc1
    s_waitcnt lgkmcnt(9)
    v_smfmac_f32_16x16x64_bf16 v[48:51], v[66:69], v[96:103], v70
    s_waitcnt vmcnt(2)
    v_lshlrev_b32_sdwa v96, 3, v124 dst_sel:DWORD dst_unused:UNUSED_PAD src0_sel:DWORD src1_sel:WORD_0
    v_lshlrev_b32_sdwa v98, 3, v124 dst_sel:DWORD dst_unused:UNUSED_PAD src0_sel:DWORD src1_sel:WORD_1
    ds_read_b64 v[96:97], v96
    ds_read_b64 v[98:99], v98
    v_lshlrev_b32_sdwa v100, 3, v125 dst_sel:DWORD dst_unused:UNUSED_PAD src0_sel:DWORD src1_sel:WORD_0
    v_lshlrev_b32_sdwa v102, 3, v125 dst_sel:DWORD dst_unused:UNUSED_PAD src0_sel:DWORD src1_sel:WORD_1
    s_nop 0
    v_cvt_pk_bf16_f32 v51, v50, v51
    v_cvt_pk_bf16_f32 v50, v48, v49
    v_mov_b64 v[46:47], 0
    v_mov_b64 v[48:49], 0
    ds_read_b64 v[100:101], v100
    ds_read_b64 v[102:103], v102
    s_waitcnt lgkmcnt(9)
    v_smfmac_f32_16x16x64_bf16 v[46:49], v[66:69], v[104:111], v70
    v_lshlrev_b32_sdwa v104, 3, v126 dst_sel:DWORD dst_unused:UNUSED_PAD src0_sel:DWORD src1_sel:WORD_0
    v_lshlrev_b32_sdwa v106, 3, v126 dst_sel:DWORD dst_unused:UNUSED_PAD src0_sel:DWORD src1_sel:WORD_1
    ds_read_b64 v[104:105], v104
    ds_read_b64 v[106:107], v106
    v_lshlrev_b32_sdwa v108, 3, v127 dst_sel:DWORD dst_unused:UNUSED_PAD src0_sel:DWORD src1_sel:WORD_0
    v_lshlrev_b32_sdwa v110, 3, v127 dst_sel:DWORD dst_unused:UNUSED_PAD src0_sel:DWORD src1_sel:WORD_1
    ds_read_b64 v[108:109], v108
    ds_read_b64 v[110:111], v110
    s_add_u32 s20, s20, 0x1000
    buffer_load_dwordx4 v[124:127], v71, s[12:15], s20 offen offset:0 sc1
    s_waitcnt lgkmcnt(8)
    v_smfmac_f32_16x16x64_bf16 v[46:49], v[66:69], v[88:95], v70
    v_mfma_f32_16x16x32_bf16 v[112:115], v[72:75], v[224:227], 0
    s_waitcnt vmcnt(2)
    v_lshlrev_b32_sdwa v88, 3, v116 dst_sel:DWORD dst_unused:UNUSED_PAD src0_sel:DWORD src1_sel:WORD_0
    v_lshlrev_b32_sdwa v90, 3, v116 dst_sel:DWORD dst_unused:UNUSED_PAD src0_sel:DWORD src1_sel:WORD_1
    ds_read_b64 v[88:89], v88
    ds_read_b64 v[90:91], v90
    v_mfma_f32_16x16x32_bf16 v[112:115], v[76:79], v[228:231], v[112:115]
    v_lshlrev_b32_sdwa v92, 3, v117 dst_sel:DWORD dst_unused:UNUSED_PAD src0_sel:DWORD src1_sel:WORD_0
    v_lshlrev_b32_sdwa v94, 3, v117 dst_sel:DWORD dst_unused:UNUSED_PAD src0_sel:DWORD src1_sel:WORD_1
    v_cvt_pk_bf16_f32 v49, v48, v49
    v_cvt_pk_bf16_f32 v48, v46, v47
    v_mov_b64 v[44:45], 0
    v_mov_b64 v[46:47], 0
    ds_read_b64 v[92:93], v92
    ds_read_b64 v[94:95], v94
    s_waitcnt lgkmcnt(8)
    v_smfmac_f32_16x16x64_bf16 v[44:47], v[66:69], v[96:103], v70
    v_mfma_f32_16x16x32_bf16 v[112:115], v[80:83], v[232:235], v[112:115]
    v_lshlrev_b32_sdwa v96, 3, v118 dst_sel:DWORD dst_unused:UNUSED_PAD src0_sel:DWORD src1_sel:WORD_0
    v_lshlrev_b32_sdwa v98, 3, v118 dst_sel:DWORD dst_unused:UNUSED_PAD src0_sel:DWORD src1_sel:WORD_1
    ds_read_b64 v[96:97], v96
    ds_read_b64 v[98:99], v98
    v_mfma_f32_16x16x32_bf16 v[112:115], v[84:87], v[236:239], v[112:115]
    v_lshlrev_b32_sdwa v100, 3, v119 dst_sel:DWORD dst_unused:UNUSED_PAD src0_sel:DWORD src1_sel:WORD_0
    v_lshlrev_b32_sdwa v102, 3, v119 dst_sel:DWORD dst_unused:UNUSED_PAD src0_sel:DWORD src1_sel:WORD_1
    ds_read_b64 v[100:101], v100
    ds_read_b64 v[102:103], v102
    buffer_load_dwordx4 v[116:119], v71, s[12:15], s20 offen offset:1024 sc1
    s_waitcnt lgkmcnt(8)
    v_smfmac_f32_16x16x64_bf16 v[44:47], v[66:69], v[104:111], v70
    s_nop 0
    v_cvt_pk_bf16_f32 v112, v112, v113
    v_cvt_pk_bf16_f32 v113, v114, v115
    v_lshlrev_b32_sdwa v114, 3, v70 dst_sel:DWORD dst_unused:UNUSED_PAD src0_sel:DWORD src1_sel:WORD_1
    ds_write_b64 v114, v[112:113] offset:33536
    s_waitcnt vmcnt(2)
    v_lshlrev_b32_sdwa v104, 3, v120 dst_sel:DWORD dst_unused:UNUSED_PAD src0_sel:DWORD src1_sel:WORD_0
    v_lshlrev_b32_sdwa v106, 3, v120 dst_sel:DWORD dst_unused:UNUSED_PAD src0_sel:DWORD src1_sel:WORD_1
    ds_read_b64 v[104:105], v104
    ds_read_b64 v[106:107], v106
    v_lshlrev_b32_sdwa v108, 3, v121 dst_sel:DWORD dst_unused:UNUSED_PAD src0_sel:DWORD src1_sel:WORD_0
    v_lshlrev_b32_sdwa v110, 3, v121 dst_sel:DWORD dst_unused:UNUSED_PAD src0_sel:DWORD src1_sel:WORD_1
    v_cvt_pk_bf16_f32 v47, v46, v47
    v_cvt_pk_bf16_f32 v46, v44, v45
    v_mov_b64 v[42:43], 0
    v_mov_b64 v[44:45], 0
    ds_read_b64 v[108:109], v108
    ds_read_b64 v[110:111], v110
    s_waitcnt lgkmcnt(9)
    v_smfmac_f32_16x16x64_bf16 v[42:45], v[66:69], v[88:95], v70
    v_lshlrev_b32_sdwa v88, 3, v122 dst_sel:DWORD dst_unused:UNUSED_PAD src0_sel:DWORD src1_sel:WORD_0
    v_lshlrev_b32_sdwa v90, 3, v122 dst_sel:DWORD dst_unused:UNUSED_PAD src0_sel:DWORD src1_sel:WORD_1
    ds_read_b64 v[88:89], v88
    ds_read_b64 v[90:91], v90
    v_lshlrev_b32_sdwa v92, 3, v123 dst_sel:DWORD dst_unused:UNUSED_PAD src0_sel:DWORD src1_sel:WORD_0
    v_lshlrev_b32_sdwa v94, 3, v123 dst_sel:DWORD dst_unused:UNUSED_PAD src0_sel:DWORD src1_sel:WORD_1
    ds_read_b64 v[92:93], v92
    ds_read_b64 v[94:95], v94
    buffer_load_dwordx4 v[120:123], v71, s[12:15], s20 offen offset:2048 sc1
    s_waitcnt lgkmcnt(9)
    v_smfmac_f32_16x16x64_bf16 v[42:45], v[66:69], v[96:103], v70
    s_waitcnt vmcnt(2)
    v_lshlrev_b32_sdwa v96, 3, v124 dst_sel:DWORD dst_unused:UNUSED_PAD src0_sel:DWORD src1_sel:WORD_0
    v_lshlrev_b32_sdwa v98, 3, v124 dst_sel:DWORD dst_unused:UNUSED_PAD src0_sel:DWORD src1_sel:WORD_1
    ds_read_b64 v[96:97], v96
    ds_read_b64 v[98:99], v98
    v_lshlrev_b32_sdwa v100, 3, v125 dst_sel:DWORD dst_unused:UNUSED_PAD src0_sel:DWORD src1_sel:WORD_0
    v_lshlrev_b32_sdwa v102, 3, v125 dst_sel:DWORD dst_unused:UNUSED_PAD src0_sel:DWORD src1_sel:WORD_1
    s_nop 0
    v_cvt_pk_bf16_f32 v45, v44, v45
    v_cvt_pk_bf16_f32 v44, v42, v43
    v_mov_b64 v[40:41], 0
    v_mov_b64 v[42:43], 0
    ds_read_b64 v[100:101], v100
    ds_read_b64 v[102:103], v102
    s_waitcnt lgkmcnt(8)
    v_smfmac_f32_16x16x64_bf16 v[40:43], v[66:69], v[104:111], v70
    s_setprio 1
    v_mfma_f32_16x16x32_bf16 v[112:115], v[72:75], v[240:243], 0
    buffer_load_dwordx4 v[72:75], v71, s[12:15], s21 offen offset:0
    v_lshlrev_b32_sdwa v104, 3, v126 dst_sel:DWORD dst_unused:UNUSED_PAD src0_sel:DWORD src1_sel:WORD_0
    v_lshlrev_b32_sdwa v106, 3, v126 dst_sel:DWORD dst_unused:UNUSED_PAD src0_sel:DWORD src1_sel:WORD_1
    ds_read_b64 v[104:105], v104
    ds_read_b64 v[106:107], v106
    v_mfma_f32_16x16x32_bf16 v[112:115], v[76:79], v[244:247], v[112:115]
    buffer_load_dwordx4 v[76:79], v71, s[12:15], s21 offen offset:1024
    v_lshlrev_b32_sdwa v108, 3, v127 dst_sel:DWORD dst_unused:UNUSED_PAD src0_sel:DWORD src1_sel:WORD_0
    v_lshlrev_b32_sdwa v110, 3, v127 dst_sel:DWORD dst_unused:UNUSED_PAD src0_sel:DWORD src1_sel:WORD_1
    ds_read_b64 v[108:109], v108
    ds_read_b64 v[110:111], v110
    buffer_load_dwordx4 v[124:127], v71, s[12:15], s20 offen offset:3072 sc1
    s_waitcnt lgkmcnt(8)
    v_smfmac_f32_16x16x64_bf16 v[40:43], v[66:69], v[88:95], v70
    v_mfma_f32_16x16x32_bf16 v[112:115], v[80:83], v[248:251], v[112:115]
    buffer_load_dwordx4 v[80:83], v71, s[12:15], s19 offen offset:0
    s_waitcnt vmcnt(5)
    v_lshlrev_b32_sdwa v88, 3, v116 dst_sel:DWORD dst_unused:UNUSED_PAD src0_sel:DWORD src1_sel:WORD_0
    v_lshlrev_b32_sdwa v90, 3, v116 dst_sel:DWORD dst_unused:UNUSED_PAD src0_sel:DWORD src1_sel:WORD_1
    ds_read_b64 v[88:89], v88
    ds_read_b64 v[90:91], v90
    v_mfma_f32_16x16x32_bf16 v[112:115], v[84:87], v[252:255], v[112:115]
    buffer_load_dwordx4 v[84:87], v71, s[12:15], s19 offen offset:1024
    s_add_u32 s21, s21, 4096
    s_add_u32 s19, s19, 4096
    v_lshlrev_b32_sdwa v92, 3, v117 dst_sel:DWORD dst_unused:UNUSED_PAD src0_sel:DWORD src1_sel:WORD_0
    v_lshlrev_b32_sdwa v94, 3, v117 dst_sel:DWORD dst_unused:UNUSED_PAD src0_sel:DWORD src1_sel:WORD_1
    v_cvt_pk_bf16_f32 v43, v42, v43
    v_cvt_pk_bf16_f32 v42, v40, v41
    v_mov_b64 v[38:39], 0
    v_mov_b64 v[40:41], 0
    ds_read_b64 v[92:93], v92
    ds_read_b64 v[94:95], v94
    s_waitcnt lgkmcnt(8)
    v_smfmac_f32_16x16x64_bf16 v[38:41], v[66:69], v[96:103], v70
    v_cvt_pk_bf16_f32 v112, v112, v113
    v_cvt_pk_bf16_f32 v113, v114, v115
    v_lshlrev_b32_sdwa v114, 3, v70 dst_sel:DWORD dst_unused:UNUSED_PAD src0_sel:DWORD src1_sel:WORD_1
    ds_write_b64 v114, v[112:113] offset:33664
    v_lshlrev_b32_sdwa v96, 3, v118 dst_sel:DWORD dst_unused:UNUSED_PAD src0_sel:DWORD src1_sel:WORD_0
    v_lshlrev_b32_sdwa v98, 3, v118 dst_sel:DWORD dst_unused:UNUSED_PAD src0_sel:DWORD src1_sel:WORD_1
    ds_read_b64 v[96:97], v96
    ds_read_b64 v[98:99], v98
    v_lshlrev_b32_sdwa v100, 3, v119 dst_sel:DWORD dst_unused:UNUSED_PAD src0_sel:DWORD src1_sel:WORD_0
    v_lshlrev_b32_sdwa v102, 3, v119 dst_sel:DWORD dst_unused:UNUSED_PAD src0_sel:DWORD src1_sel:WORD_1
    ds_read_b64 v[100:101], v100
    ds_read_b64 v[102:103], v102
    s_add_u32 s20, s20, 0x20000
    buffer_load_dwordx4 v[116:119], v71, s[12:15], s20 offen offset:3072 sc1
    s_waitcnt lgkmcnt(9)
    v_smfmac_f32_16x16x64_bf16 v[38:41], v[66:69], v[104:111], v70
    s_waitcnt vmcnt(6)
    v_lshlrev_b32_sdwa v104, 3, v120 dst_sel:DWORD dst_unused:UNUSED_PAD src0_sel:DWORD src1_sel:WORD_0
    v_lshlrev_b32_sdwa v106, 3, v120 dst_sel:DWORD dst_unused:UNUSED_PAD src0_sel:DWORD src1_sel:WORD_1
    ds_read_b64 v[104:105], v104
    ds_read_b64 v[106:107], v106
    v_lshlrev_b32_sdwa v108, 3, v121 dst_sel:DWORD dst_unused:UNUSED_PAD src0_sel:DWORD src1_sel:WORD_0
    v_lshlrev_b32_sdwa v110, 3, v121 dst_sel:DWORD dst_unused:UNUSED_PAD src0_sel:DWORD src1_sel:WORD_1
    s_nop 0
    v_cvt_pk_bf16_f32 v41, v40, v41
    v_cvt_pk_bf16_f32 v40, v38, v39
    v_mov_b64 v[36:37], 0
    v_mov_b64 v[38:39], 0
    ds_read_b64 v[108:109], v108
    ds_read_b64 v[110:111], v110
    s_waitcnt lgkmcnt(9)
    v_smfmac_f32_16x16x64_bf16 v[36:39], v[66:69], v[88:95], v70
    v_lshlrev_b32_sdwa v88, 3, v122 dst_sel:DWORD dst_unused:UNUSED_PAD src0_sel:DWORD src1_sel:WORD_0
    v_lshlrev_b32_sdwa v90, 3, v122 dst_sel:DWORD dst_unused:UNUSED_PAD src0_sel:DWORD src1_sel:WORD_1
    ds_read_b64 v[88:89], v88
    ds_read_b64 v[90:91], v90
    v_lshlrev_b32_sdwa v92, 3, v123 dst_sel:DWORD dst_unused:UNUSED_PAD src0_sel:DWORD src1_sel:WORD_0
    v_lshlrev_b32_sdwa v94, 3, v123 dst_sel:DWORD dst_unused:UNUSED_PAD src0_sel:DWORD src1_sel:WORD_1
    ds_read_b64 v[92:93], v92
    ds_read_b64 v[94:95], v94
    buffer_load_dwordx4 v[120:123], v71, s[12:15], s20 offen offset:2048 sc1
    s_waitcnt lgkmcnt(8)
    v_smfmac_f32_16x16x64_bf16 v[36:39], v[66:69], v[96:103], v70
    s_waitcnt vmcnt(4)
    v_lshlrev_b32_sdwa v96, 3, v124 dst_sel:DWORD dst_unused:UNUSED_PAD src0_sel:DWORD src1_sel:WORD_0
    v_lshlrev_b32_sdwa v98, 3, v124 dst_sel:DWORD dst_unused:UNUSED_PAD src0_sel:DWORD src1_sel:WORD_1
    ds_read_b64 v[96:97], v96
    ds_read_b64 v[98:99], v98
    v_lshlrev_b32_sdwa v100, 3, v125 dst_sel:DWORD dst_unused:UNUSED_PAD src0_sel:DWORD src1_sel:WORD_0
    v_lshlrev_b32_sdwa v102, 3, v125 dst_sel:DWORD dst_unused:UNUSED_PAD src0_sel:DWORD src1_sel:WORD_1
    s_nop 0
    v_cvt_pk_bf16_f32 v39, v38, v39
    v_cvt_pk_bf16_f32 v38, v36, v37
    v_mov_b64 v[34:35], 0
    v_mov_b64 v[36:37], 0
    ds_read_b64 v[100:101], v100
    ds_read_b64 v[102:103], v102
    s_waitcnt lgkmcnt(8)
    v_smfmac_f32_16x16x64_bf16 v[34:37], v[66:69], v[104:111], v70
    s_setprio 0
    v_lshlrev_b32_sdwa v104, 3, v126 dst_sel:DWORD dst_unused:UNUSED_PAD src0_sel:DWORD src1_sel:WORD_0
    v_lshlrev_b32_sdwa v106, 3, v126 dst_sel:DWORD dst_unused:UNUSED_PAD src0_sel:DWORD src1_sel:WORD_1
    ds_read_b64 v[104:105], v104
    ds_read_b64 v[106:107], v106
    v_lshlrev_b32_sdwa v108, 3, v127 dst_sel:DWORD dst_unused:UNUSED_PAD src0_sel:DWORD src1_sel:WORD_0
    v_lshlrev_b32_sdwa v110, 3, v127 dst_sel:DWORD dst_unused:UNUSED_PAD src0_sel:DWORD src1_sel:WORD_1
    ds_read_b64 v[108:109], v108
    ds_read_b64 v[110:111], v110
    buffer_load_dwordx4 v[124:127], v71, s[12:15], s20 offen offset:1024 sc1
    s_waitcnt lgkmcnt(8)
    v_smfmac_f32_16x16x64_bf16 v[34:37], v[66:69], v[88:95], v70
    s_waitcnt vmcnt(2)
    v_lshlrev_b32_sdwa v88, 3, v118 dst_sel:DWORD dst_unused:UNUSED_PAD src0_sel:DWORD src1_sel:WORD_0
    v_lshlrev_b32_sdwa v90, 3, v118 dst_sel:DWORD dst_unused:UNUSED_PAD src0_sel:DWORD src1_sel:WORD_1
    ds_read_b64 v[88:89], v88
    ds_read_b64 v[90:91], v90
    v_lshlrev_b32_sdwa v92, 3, v119 dst_sel:DWORD dst_unused:UNUSED_PAD src0_sel:DWORD src1_sel:WORD_0
    v_lshlrev_b32_sdwa v94, 3, v119 dst_sel:DWORD dst_unused:UNUSED_PAD src0_sel:DWORD src1_sel:WORD_1
    s_nop 0
    v_cvt_pk_bf16_f32 v37, v36, v37
    v_cvt_pk_bf16_f32 v36, v34, v35
    v_mov_b64 v[32:33], 0
    v_mov_b64 v[34:35], 0
    ds_read_b64 v[92:93], v92
    ds_read_b64 v[94:95], v94
    s_waitcnt lgkmcnt(8)
    v_smfmac_f32_16x16x64_bf16 v[32:35], v[66:69], v[96:103], v70
    s_barrier
    s_setprio 3
    v_lshlrev_b32_sdwa v96, 3, v116 dst_sel:DWORD dst_unused:UNUSED_PAD src0_sel:DWORD src1_sel:WORD_0
    v_lshlrev_b32_sdwa v98, 3, v116 dst_sel:DWORD dst_unused:UNUSED_PAD src0_sel:DWORD src1_sel:WORD_1
    ds_read_b64 v[96:97], v96
    ds_read_b64 v[98:99], v98
    v_lshlrev_b32_sdwa v100, 3, v117 dst_sel:DWORD dst_unused:UNUSED_PAD src0_sel:DWORD src1_sel:WORD_0
    v_lshlrev_b32_sdwa v102, 3, v117 dst_sel:DWORD dst_unused:UNUSED_PAD src0_sel:DWORD src1_sel:WORD_1
    ds_read_b64 v[100:101], v100
    ds_read_b64 v[102:103], v102
    buffer_load_dwordx4 v[116:119], v71, s[12:15], s20 offen offset:0 sc1
    s_waitcnt lgkmcnt(8)
    v_smfmac_f32_16x16x64_bf16 v[32:35], v[66:69], v[104:111], v70
    v_mfma_f32_16x16x32_bf16 v[112:115], v[72:75], v[128:131], 0
    s_waitcnt vmcnt(2)
    v_lshlrev_b32_sdwa v104, 3, v122 dst_sel:DWORD dst_unused:UNUSED_PAD src0_sel:DWORD src1_sel:WORD_0
    v_lshlrev_b32_sdwa v106, 3, v122 dst_sel:DWORD dst_unused:UNUSED_PAD src0_sel:DWORD src1_sel:WORD_1
    ds_read_b64 v[104:105], v104
    ds_read_b64 v[106:107], v106
    v_mfma_f32_16x16x32_bf16 v[112:115], v[76:79], v[132:135], v[112:115]
    v_add_u32 v70, 0x20000000, v70
    v_lshlrev_b32_sdwa v108, 3, v123 dst_sel:DWORD dst_unused:UNUSED_PAD src0_sel:DWORD src1_sel:WORD_0
    v_lshlrev_b32_sdwa v110, 3, v123 dst_sel:DWORD dst_unused:UNUSED_PAD src0_sel:DWORD src1_sel:WORD_1
    v_cvt_pk_bf16_f32 v35, v34, v35
    v_cvt_pk_bf16_f32 v34, v32, v33
    v_and_b32 v33, s23, v31
    v_lshlrev_b32 v32, 16, v31
    v_and_b32 v31, s23, v30
    v_lshlrev_b32 v30, 16, v30
    ds_read_b64 v[108:109], v108
    ds_read_b64 v[110:111], v110
    s_waitcnt lgkmcnt(8)
    v_smfmac_f32_16x16x64_bf16 v[30:33], v[66:69], v[88:95], v70
    v_mfma_f32_16x16x32_bf16 v[112:115], v[80:83], v[136:139], v[112:115]
    v_lshlrev_b32_sdwa v88, 3, v120 dst_sel:DWORD dst_unused:UNUSED_PAD src0_sel:DWORD src1_sel:WORD_0
    v_lshlrev_b32_sdwa v90, 3, v120 dst_sel:DWORD dst_unused:UNUSED_PAD src0_sel:DWORD src1_sel:WORD_1
    ds_read_b64 v[88:89], v88
    ds_read_b64 v[90:91], v90
    v_mfma_f32_16x16x32_bf16 v[112:115], v[84:87], v[140:143], v[112:115]
    v_lshlrev_b32_sdwa v92, 3, v121 dst_sel:DWORD dst_unused:UNUSED_PAD src0_sel:DWORD src1_sel:WORD_0
    v_lshlrev_b32_sdwa v94, 3, v121 dst_sel:DWORD dst_unused:UNUSED_PAD src0_sel:DWORD src1_sel:WORD_1
    ds_read_b64 v[92:93], v92
    ds_read_b64 v[94:95], v94
    s_add_u32 s20, s20, 0xfffff000
    buffer_load_dwordx4 v[120:123], v71, s[12:15], s20 offen offset:3072 sc1
    s_waitcnt lgkmcnt(8)
    v_smfmac_f32_16x16x64_bf16 v[30:33], v[66:69], v[96:103], v70
    v_cvt_pk_bf16_f32 v112, v112, v113
    v_cvt_pk_bf16_f32 v113, v114, v115
    v_lshlrev_b32_sdwa v114, 3, v70 dst_sel:DWORD dst_unused:UNUSED_PAD src0_sel:DWORD src1_sel:WORD_1
    ds_write_b64 v114, v[112:113] offset:0
    s_waitcnt vmcnt(2)
    v_lshlrev_b32_sdwa v96, 3, v126 dst_sel:DWORD dst_unused:UNUSED_PAD src0_sel:DWORD src1_sel:WORD_0
    v_lshlrev_b32_sdwa v98, 3, v126 dst_sel:DWORD dst_unused:UNUSED_PAD src0_sel:DWORD src1_sel:WORD_1
    ds_read_b64 v[96:97], v96
    ds_read_b64 v[98:99], v98
    v_lshlrev_b32_sdwa v100, 3, v127 dst_sel:DWORD dst_unused:UNUSED_PAD src0_sel:DWORD src1_sel:WORD_0
    v_lshlrev_b32_sdwa v102, 3, v127 dst_sel:DWORD dst_unused:UNUSED_PAD src0_sel:DWORD src1_sel:WORD_1
    v_cvt_pk_bf16_f32 v33, v32, v33
    v_cvt_pk_bf16_f32 v32, v30, v31
    v_and_b32 v31, s23, v29
    v_lshlrev_b32 v30, 16, v29
    v_and_b32 v29, s23, v28
    v_lshlrev_b32 v28, 16, v28
    ds_read_b64 v[100:101], v100
    ds_read_b64 v[102:103], v102
    s_waitcnt lgkmcnt(9)
    v_smfmac_f32_16x16x64_bf16 v[28:31], v[66:69], v[104:111], v70
    v_mfma_f32_16x16x32_bf16 v[112:115], v[72:75], v[144:147], 0
    v_lshlrev_b32_sdwa v104, 3, v124 dst_sel:DWORD dst_unused:UNUSED_PAD src0_sel:DWORD src1_sel:WORD_0
    v_lshlrev_b32_sdwa v106, 3, v124 dst_sel:DWORD dst_unused:UNUSED_PAD src0_sel:DWORD src1_sel:WORD_1
    ds_read_b64 v[104:105], v104
    ds_read_b64 v[106:107], v106
    v_mfma_f32_16x16x32_bf16 v[112:115], v[76:79], v[148:151], v[112:115]
    v_lshlrev_b32_sdwa v108, 3, v125 dst_sel:DWORD dst_unused:UNUSED_PAD src0_sel:DWORD src1_sel:WORD_0
    v_lshlrev_b32_sdwa v110, 3, v125 dst_sel:DWORD dst_unused:UNUSED_PAD src0_sel:DWORD src1_sel:WORD_1
    ds_read_b64 v[108:109], v108
    ds_read_b64 v[110:111], v110
    buffer_load_dwordx4 v[124:127], v71, s[12:15], s20 offen offset:2048 sc1
    s_waitcnt lgkmcnt(9)
    v_smfmac_f32_16x16x64_bf16 v[28:31], v[66:69], v[88:95], v70
    v_mfma_f32_16x16x32_bf16 v[112:115], v[80:83], v[152:155], v[112:115]
    s_waitcnt vmcnt(2)
    v_lshlrev_b32_sdwa v88, 3, v118 dst_sel:DWORD dst_unused:UNUSED_PAD src0_sel:DWORD src1_sel:WORD_0
    v_lshlrev_b32_sdwa v90, 3, v118 dst_sel:DWORD dst_unused:UNUSED_PAD src0_sel:DWORD src1_sel:WORD_1
    ds_read_b64 v[88:89], v88
    ds_read_b64 v[90:91], v90
    v_mfma_f32_16x16x32_bf16 v[112:115], v[84:87], v[156:159], v[112:115]
    v_lshlrev_b32_sdwa v92, 3, v119 dst_sel:DWORD dst_unused:UNUSED_PAD src0_sel:DWORD src1_sel:WORD_0
    v_lshlrev_b32_sdwa v94, 3, v119 dst_sel:DWORD dst_unused:UNUSED_PAD src0_sel:DWORD src1_sel:WORD_1
    v_cvt_pk_bf16_f32 v31, v30, v31
    v_cvt_pk_bf16_f32 v30, v28, v29
    v_and_b32 v29, s23, v27
    v_lshlrev_b32 v28, 16, v27
    v_and_b32 v27, s23, v26
    v_lshlrev_b32 v26, 16, v26
    ds_read_b64 v[92:93], v92
    ds_read_b64 v[94:95], v94
    s_waitcnt lgkmcnt(8)
    v_smfmac_f32_16x16x64_bf16 v[26:29], v[66:69], v[96:103], v70
    v_cvt_pk_bf16_f32 v112, v112, v113
    v_cvt_pk_bf16_f32 v113, v114, v115
    v_lshlrev_b32_sdwa v114, 3, v70 dst_sel:DWORD dst_unused:UNUSED_PAD src0_sel:DWORD src1_sel:WORD_1
    ds_write_b64 v114, v[112:113] offset:128
    v_lshlrev_b32_sdwa v96, 3, v116 dst_sel:DWORD dst_unused:UNUSED_PAD src0_sel:DWORD src1_sel:WORD_0
    v_lshlrev_b32_sdwa v98, 3, v116 dst_sel:DWORD dst_unused:UNUSED_PAD src0_sel:DWORD src1_sel:WORD_1
    ds_read_b64 v[96:97], v96
    ds_read_b64 v[98:99], v98
    v_lshlrev_b32_sdwa v100, 3, v117 dst_sel:DWORD dst_unused:UNUSED_PAD src0_sel:DWORD src1_sel:WORD_0
    v_lshlrev_b32_sdwa v102, 3, v117 dst_sel:DWORD dst_unused:UNUSED_PAD src0_sel:DWORD src1_sel:WORD_1
    ds_read_b64 v[100:101], v100
    ds_read_b64 v[102:103], v102
    buffer_load_dwordx4 v[116:119], v71, s[12:15], s20 offen offset:1024 sc1
    s_waitcnt lgkmcnt(9)
    v_smfmac_f32_16x16x64_bf16 v[26:29], v[66:69], v[104:111], v70
    v_mfma_f32_16x16x32_bf16 v[112:115], v[72:75], v[160:163], 0
    s_waitcnt vmcnt(2)
    v_lshlrev_b32_sdwa v104, 3, v122 dst_sel:DWORD dst_unused:UNUSED_PAD src0_sel:DWORD src1_sel:WORD_0
    v_lshlrev_b32_sdwa v106, 3, v122 dst_sel:DWORD dst_unused:UNUSED_PAD src0_sel:DWORD src1_sel:WORD_1
    ds_read_b64 v[104:105], v104
    ds_read_b64 v[106:107], v106
    v_mfma_f32_16x16x32_bf16 v[112:115], v[76:79], v[164:167], v[112:115]
    v_lshlrev_b32_sdwa v108, 3, v123 dst_sel:DWORD dst_unused:UNUSED_PAD src0_sel:DWORD src1_sel:WORD_0
    v_lshlrev_b32_sdwa v110, 3, v123 dst_sel:DWORD dst_unused:UNUSED_PAD src0_sel:DWORD src1_sel:WORD_1
    v_cvt_pk_bf16_f32 v29, v28, v29
    v_cvt_pk_bf16_f32 v28, v26, v27
    v_and_b32 v27, s23, v25
    v_lshlrev_b32 v26, 16, v25
    v_and_b32 v25, s23, v24
    v_lshlrev_b32 v24, 16, v24
    ds_read_b64 v[108:109], v108
    ds_read_b64 v[110:111], v110
    s_waitcnt lgkmcnt(9)
    v_smfmac_f32_16x16x64_bf16 v[24:27], v[66:69], v[88:95], v70
    v_mfma_f32_16x16x32_bf16 v[112:115], v[80:83], v[168:171], v[112:115]
    v_lshlrev_b32_sdwa v88, 3, v120 dst_sel:DWORD dst_unused:UNUSED_PAD src0_sel:DWORD src1_sel:WORD_0
    v_lshlrev_b32_sdwa v90, 3, v120 dst_sel:DWORD dst_unused:UNUSED_PAD src0_sel:DWORD src1_sel:WORD_1
    ds_read_b64 v[88:89], v88
    ds_read_b64 v[90:91], v90
    v_mfma_f32_16x16x32_bf16 v[112:115], v[84:87], v[172:175], v[112:115]
    v_lshlrev_b32_sdwa v92, 3, v121 dst_sel:DWORD dst_unused:UNUSED_PAD src0_sel:DWORD src1_sel:WORD_0
    v_lshlrev_b32_sdwa v94, 3, v121 dst_sel:DWORD dst_unused:UNUSED_PAD src0_sel:DWORD src1_sel:WORD_1
    ds_read_b64 v[92:93], v92
    ds_read_b64 v[94:95], v94
    buffer_load_dwordx4 v[120:123], v71, s[12:15], s20 offen offset:0 sc1
    s_waitcnt lgkmcnt(8)
    v_smfmac_f32_16x16x64_bf16 v[24:27], v[66:69], v[96:103], v70
    s_nop 0
    v_cvt_pk_bf16_f32 v112, v112, v113
    v_cvt_pk_bf16_f32 v113, v114, v115
    v_lshlrev_b32_sdwa v114, 3, v70 dst_sel:DWORD dst_unused:UNUSED_PAD src0_sel:DWORD src1_sel:WORD_1
    ds_write_b64 v114, v[112:113] offset:256
    s_waitcnt vmcnt(2)
    v_lshlrev_b32_sdwa v96, 3, v126 dst_sel:DWORD dst_unused:UNUSED_PAD src0_sel:DWORD src1_sel:WORD_0
    v_lshlrev_b32_sdwa v98, 3, v126 dst_sel:DWORD dst_unused:UNUSED_PAD src0_sel:DWORD src1_sel:WORD_1
    ds_read_b64 v[96:97], v96
    ds_read_b64 v[98:99], v98
    v_lshlrev_b32_sdwa v100, 3, v127 dst_sel:DWORD dst_unused:UNUSED_PAD src0_sel:DWORD src1_sel:WORD_0
    v_lshlrev_b32_sdwa v102, 3, v127 dst_sel:DWORD dst_unused:UNUSED_PAD src0_sel:DWORD src1_sel:WORD_1
    v_cvt_pk_bf16_f32 v27, v26, v27
    v_cvt_pk_bf16_f32 v26, v24, v25
    v_and_b32 v25, s23, v23
    v_lshlrev_b32 v24, 16, v23
    v_and_b32 v23, s23, v22
    v_lshlrev_b32 v22, 16, v22
    ds_read_b64 v[100:101], v100
    ds_read_b64 v[102:103], v102
    s_waitcnt lgkmcnt(9)
    v_smfmac_f32_16x16x64_bf16 v[22:25], v[66:69], v[104:111], v70
    v_mfma_f32_16x16x32_bf16 v[112:115], v[72:75], v[176:179], 0
    v_lshlrev_b32_sdwa v104, 3, v124 dst_sel:DWORD dst_unused:UNUSED_PAD src0_sel:DWORD src1_sel:WORD_0
    v_lshlrev_b32_sdwa v106, 3, v124 dst_sel:DWORD dst_unused:UNUSED_PAD src0_sel:DWORD src1_sel:WORD_1
    ds_read_b64 v[104:105], v104
    ds_read_b64 v[106:107], v106
    v_mfma_f32_16x16x32_bf16 v[112:115], v[76:79], v[180:183], v[112:115]
    v_lshlrev_b32_sdwa v108, 3, v125 dst_sel:DWORD dst_unused:UNUSED_PAD src0_sel:DWORD src1_sel:WORD_0
    v_lshlrev_b32_sdwa v110, 3, v125 dst_sel:DWORD dst_unused:UNUSED_PAD src0_sel:DWORD src1_sel:WORD_1
    ds_read_b64 v[108:109], v108
    ds_read_b64 v[110:111], v110
    s_add_u32 s20, s20, 0xfffff000
    buffer_load_dwordx4 v[124:127], v71, s[12:15], s20 offen offset:3072 sc1
    s_waitcnt lgkmcnt(9)
    v_smfmac_f32_16x16x64_bf16 v[22:25], v[66:69], v[88:95], v70
    v_mfma_f32_16x16x32_bf16 v[112:115], v[80:83], v[184:187], v[112:115]
    s_waitcnt vmcnt(2)
    v_lshlrev_b32_sdwa v88, 3, v118 dst_sel:DWORD dst_unused:UNUSED_PAD src0_sel:DWORD src1_sel:WORD_0
    v_lshlrev_b32_sdwa v90, 3, v118 dst_sel:DWORD dst_unused:UNUSED_PAD src0_sel:DWORD src1_sel:WORD_1
    ds_read_b64 v[88:89], v88
    ds_read_b64 v[90:91], v90
    v_mfma_f32_16x16x32_bf16 v[112:115], v[84:87], v[188:191], v[112:115]
    v_lshlrev_b32_sdwa v92, 3, v119 dst_sel:DWORD dst_unused:UNUSED_PAD src0_sel:DWORD src1_sel:WORD_0
    v_lshlrev_b32_sdwa v94, 3, v119 dst_sel:DWORD dst_unused:UNUSED_PAD src0_sel:DWORD src1_sel:WORD_1
    v_cvt_pk_bf16_f32 v25, v24, v25
    v_cvt_pk_bf16_f32 v24, v22, v23
    v_and_b32 v23, s23, v21
    v_lshlrev_b32 v22, 16, v21
    v_and_b32 v21, s23, v20
    v_lshlrev_b32 v20, 16, v20
    ds_read_b64 v[92:93], v92
    ds_read_b64 v[94:95], v94
    s_waitcnt lgkmcnt(8)
    v_smfmac_f32_16x16x64_bf16 v[20:23], v[66:69], v[96:103], v70
    v_cvt_pk_bf16_f32 v112, v112, v113
    v_cvt_pk_bf16_f32 v113, v114, v115
    v_lshlrev_b32_sdwa v114, 3, v70 dst_sel:DWORD dst_unused:UNUSED_PAD src0_sel:DWORD src1_sel:WORD_1
    ds_write_b64 v114, v[112:113] offset:384
    v_lshlrev_b32_sdwa v96, 3, v116 dst_sel:DWORD dst_unused:UNUSED_PAD src0_sel:DWORD src1_sel:WORD_0
    v_lshlrev_b32_sdwa v98, 3, v116 dst_sel:DWORD dst_unused:UNUSED_PAD src0_sel:DWORD src1_sel:WORD_1
    ds_read_b64 v[96:97], v96
    ds_read_b64 v[98:99], v98
    v_lshlrev_b32_sdwa v100, 3, v117 dst_sel:DWORD dst_unused:UNUSED_PAD src0_sel:DWORD src1_sel:WORD_0
    v_lshlrev_b32_sdwa v102, 3, v117 dst_sel:DWORD dst_unused:UNUSED_PAD src0_sel:DWORD src1_sel:WORD_1
    ds_read_b64 v[100:101], v100
    ds_read_b64 v[102:103], v102
    buffer_load_dwordx4 v[116:119], v71, s[12:15], s20 offen offset:2048 sc1
    s_waitcnt lgkmcnt(9)
    v_smfmac_f32_16x16x64_bf16 v[20:23], v[66:69], v[104:111], v70
    v_mfma_f32_16x16x32_bf16 v[112:115], v[72:75], v[192:195], 0
    s_waitcnt vmcnt(2)
    v_lshlrev_b32_sdwa v104, 3, v122 dst_sel:DWORD dst_unused:UNUSED_PAD src0_sel:DWORD src1_sel:WORD_0
    v_lshlrev_b32_sdwa v106, 3, v122 dst_sel:DWORD dst_unused:UNUSED_PAD src0_sel:DWORD src1_sel:WORD_1
    ds_read_b64 v[104:105], v104
    ds_read_b64 v[106:107], v106
    v_mfma_f32_16x16x32_bf16 v[112:115], v[76:79], v[196:199], v[112:115]
    v_lshlrev_b32_sdwa v108, 3, v123 dst_sel:DWORD dst_unused:UNUSED_PAD src0_sel:DWORD src1_sel:WORD_0
    v_lshlrev_b32_sdwa v110, 3, v123 dst_sel:DWORD dst_unused:UNUSED_PAD src0_sel:DWORD src1_sel:WORD_1
    v_cvt_pk_bf16_f32 v23, v22, v23
    v_cvt_pk_bf16_f32 v22, v20, v21
    v_and_b32 v21, s23, v19
    v_lshlrev_b32 v20, 16, v19
    v_and_b32 v19, s23, v18
    v_lshlrev_b32 v18, 16, v18
    ds_read_b64 v[108:109], v108
    ds_read_b64 v[110:111], v110
    s_waitcnt lgkmcnt(9)
    v_smfmac_f32_16x16x64_bf16 v[18:21], v[66:69], v[88:95], v70
    v_mfma_f32_16x16x32_bf16 v[112:115], v[80:83], v[200:203], v[112:115]
    v_lshlrev_b32_sdwa v88, 3, v120 dst_sel:DWORD dst_unused:UNUSED_PAD src0_sel:DWORD src1_sel:WORD_0
    v_lshlrev_b32_sdwa v90, 3, v120 dst_sel:DWORD dst_unused:UNUSED_PAD src0_sel:DWORD src1_sel:WORD_1
    ds_read_b64 v[88:89], v88
    ds_read_b64 v[90:91], v90
    v_mfma_f32_16x16x32_bf16 v[112:115], v[84:87], v[204:207], v[112:115]
    v_lshlrev_b32_sdwa v92, 3, v121 dst_sel:DWORD dst_unused:UNUSED_PAD src0_sel:DWORD src1_sel:WORD_0
    v_lshlrev_b32_sdwa v94, 3, v121 dst_sel:DWORD dst_unused:UNUSED_PAD src0_sel:DWORD src1_sel:WORD_1
    ds_read_b64 v[92:93], v92
    ds_read_b64 v[94:95], v94
    buffer_load_dwordx4 v[120:123], v71, s[12:15], s20 offen offset:1024 sc1
    s_waitcnt lgkmcnt(8)
    v_smfmac_f32_16x16x64_bf16 v[18:21], v[66:69], v[96:103], v70
    s_nop 0
    v_cvt_pk_bf16_f32 v112, v112, v113
    v_cvt_pk_bf16_f32 v113, v114, v115
    v_lshlrev_b32_sdwa v114, 3, v70 dst_sel:DWORD dst_unused:UNUSED_PAD src0_sel:DWORD src1_sel:WORD_1
    ds_write_b64 v114, v[112:113] offset:512
    s_waitcnt vmcnt(2)
    v_lshlrev_b32_sdwa v96, 3, v126 dst_sel:DWORD dst_unused:UNUSED_PAD src0_sel:DWORD src1_sel:WORD_0
    v_lshlrev_b32_sdwa v98, 3, v126 dst_sel:DWORD dst_unused:UNUSED_PAD src0_sel:DWORD src1_sel:WORD_1
    ds_read_b64 v[96:97], v96
    ds_read_b64 v[98:99], v98
    v_lshlrev_b32_sdwa v100, 3, v127 dst_sel:DWORD dst_unused:UNUSED_PAD src0_sel:DWORD src1_sel:WORD_0
    v_lshlrev_b32_sdwa v102, 3, v127 dst_sel:DWORD dst_unused:UNUSED_PAD src0_sel:DWORD src1_sel:WORD_1
    v_cvt_pk_bf16_f32 v21, v20, v21
    v_cvt_pk_bf16_f32 v20, v18, v19
    v_and_b32 v19, s23, v17
    v_lshlrev_b32 v18, 16, v17
    v_and_b32 v17, s23, v16
    v_lshlrev_b32 v16, 16, v16
    ds_read_b64 v[100:101], v100
    ds_read_b64 v[102:103], v102
    s_waitcnt lgkmcnt(9)
    v_smfmac_f32_16x16x64_bf16 v[16:19], v[66:69], v[104:111], v70
    s_setprio 2
    v_mfma_f32_16x16x32_bf16 v[112:115], v[72:75], v[208:211], 0
    v_lshlrev_b32_sdwa v104, 3, v124 dst_sel:DWORD dst_unused:UNUSED_PAD src0_sel:DWORD src1_sel:WORD_0
    v_lshlrev_b32_sdwa v106, 3, v124 dst_sel:DWORD dst_unused:UNUSED_PAD src0_sel:DWORD src1_sel:WORD_1
    ds_read_b64 v[104:105], v104
    ds_read_b64 v[106:107], v106
    v_mfma_f32_16x16x32_bf16 v[112:115], v[76:79], v[212:215], v[112:115]
    v_lshlrev_b32_sdwa v108, 3, v125 dst_sel:DWORD dst_unused:UNUSED_PAD src0_sel:DWORD src1_sel:WORD_0
    v_lshlrev_b32_sdwa v110, 3, v125 dst_sel:DWORD dst_unused:UNUSED_PAD src0_sel:DWORD src1_sel:WORD_1
    ds_read_b64 v[108:109], v108
    ds_read_b64 v[110:111], v110
    buffer_load_dwordx4 v[124:127], v71, s[12:15], s20 offen offset:0 sc1
    s_waitcnt lgkmcnt(9)
    v_smfmac_f32_16x16x64_bf16 v[16:19], v[66:69], v[88:95], v70
    v_mfma_f32_16x16x32_bf16 v[112:115], v[80:83], v[216:219], v[112:115]
    s_waitcnt vmcnt(2)
    v_lshlrev_b32_sdwa v88, 3, v118 dst_sel:DWORD dst_unused:UNUSED_PAD src0_sel:DWORD src1_sel:WORD_0
    v_lshlrev_b32_sdwa v90, 3, v118 dst_sel:DWORD dst_unused:UNUSED_PAD src0_sel:DWORD src1_sel:WORD_1
    ds_read_b64 v[88:89], v88
    ds_read_b64 v[90:91], v90
    v_mfma_f32_16x16x32_bf16 v[112:115], v[84:87], v[220:223], v[112:115]
    v_lshlrev_b32_sdwa v92, 3, v119 dst_sel:DWORD dst_unused:UNUSED_PAD src0_sel:DWORD src1_sel:WORD_0
    v_lshlrev_b32_sdwa v94, 3, v119 dst_sel:DWORD dst_unused:UNUSED_PAD src0_sel:DWORD src1_sel:WORD_1
    v_cvt_pk_bf16_f32 v19, v18, v19
    v_cvt_pk_bf16_f32 v18, v16, v17
    v_and_b32 v17, s23, v15
    v_lshlrev_b32 v16, 16, v15
    v_and_b32 v15, s23, v14
    v_lshlrev_b32 v14, 16, v14
    ds_read_b64 v[92:93], v92
    ds_read_b64 v[94:95], v94
    s_waitcnt lgkmcnt(8)
    v_smfmac_f32_16x16x64_bf16 v[14:17], v[66:69], v[96:103], v70
    v_cvt_pk_bf16_f32 v112, v112, v113
    v_cvt_pk_bf16_f32 v113, v114, v115
    v_lshlrev_b32_sdwa v114, 3, v70 dst_sel:DWORD dst_unused:UNUSED_PAD src0_sel:DWORD src1_sel:WORD_1
    ds_write_b64 v114, v[112:113] offset:640
    v_lshlrev_b32_sdwa v96, 3, v116 dst_sel:DWORD dst_unused:UNUSED_PAD src0_sel:DWORD src1_sel:WORD_0
    v_lshlrev_b32_sdwa v98, 3, v116 dst_sel:DWORD dst_unused:UNUSED_PAD src0_sel:DWORD src1_sel:WORD_1
    ds_read_b64 v[96:97], v96
    ds_read_b64 v[98:99], v98
    v_lshlrev_b32_sdwa v100, 3, v117 dst_sel:DWORD dst_unused:UNUSED_PAD src0_sel:DWORD src1_sel:WORD_0
    v_lshlrev_b32_sdwa v102, 3, v117 dst_sel:DWORD dst_unused:UNUSED_PAD src0_sel:DWORD src1_sel:WORD_1
    ds_read_b64 v[100:101], v100
    ds_read_b64 v[102:103], v102
    s_add_u32 s20, s20, 0xfffff000
    buffer_load_dwordx4 v[116:119], v71, s[12:15], s20 offen offset:3072 sc1
    s_waitcnt lgkmcnt(9)
    v_smfmac_f32_16x16x64_bf16 v[14:17], v[66:69], v[104:111], v70
    v_mfma_f32_16x16x32_bf16 v[112:115], v[72:75], v[224:227], 0
    s_waitcnt vmcnt(2)
    v_lshlrev_b32_sdwa v104, 3, v122 dst_sel:DWORD dst_unused:UNUSED_PAD src0_sel:DWORD src1_sel:WORD_0
    v_lshlrev_b32_sdwa v106, 3, v122 dst_sel:DWORD dst_unused:UNUSED_PAD src0_sel:DWORD src1_sel:WORD_1
    ds_read_b64 v[104:105], v104
    ds_read_b64 v[106:107], v106
    v_mfma_f32_16x16x32_bf16 v[112:115], v[76:79], v[228:231], v[112:115]
    v_lshlrev_b32_sdwa v108, 3, v123 dst_sel:DWORD dst_unused:UNUSED_PAD src0_sel:DWORD src1_sel:WORD_0
    v_lshlrev_b32_sdwa v110, 3, v123 dst_sel:DWORD dst_unused:UNUSED_PAD src0_sel:DWORD src1_sel:WORD_1
    v_cvt_pk_bf16_f32 v17, v16, v17
    v_cvt_pk_bf16_f32 v16, v14, v15
    v_and_b32 v15, s23, v13
    v_lshlrev_b32 v14, 16, v13
    v_and_b32 v13, s23, v12
    v_lshlrev_b32 v12, 16, v12
    ds_read_b64 v[108:109], v108
    ds_read_b64 v[110:111], v110
    s_waitcnt lgkmcnt(9)
    v_smfmac_f32_16x16x64_bf16 v[12:15], v[66:69], v[88:95], v70
    v_mfma_f32_16x16x32_bf16 v[112:115], v[80:83], v[232:235], v[112:115]
    v_lshlrev_b32_sdwa v88, 3, v120 dst_sel:DWORD dst_unused:UNUSED_PAD src0_sel:DWORD src1_sel:WORD_0
    v_lshlrev_b32_sdwa v90, 3, v120 dst_sel:DWORD dst_unused:UNUSED_PAD src0_sel:DWORD src1_sel:WORD_1
    ds_read_b64 v[88:89], v88
    ds_read_b64 v[90:91], v90
    v_mfma_f32_16x16x32_bf16 v[112:115], v[84:87], v[236:239], v[112:115]
    v_lshlrev_b32_sdwa v92, 3, v121 dst_sel:DWORD dst_unused:UNUSED_PAD src0_sel:DWORD src1_sel:WORD_0
    v_lshlrev_b32_sdwa v94, 3, v121 dst_sel:DWORD dst_unused:UNUSED_PAD src0_sel:DWORD src1_sel:WORD_1
    ds_read_b64 v[92:93], v92
    ds_read_b64 v[94:95], v94
    buffer_load_dwordx4 v[120:123], v71, s[12:15], s20 offen offset:2048 sc1
    s_waitcnt lgkmcnt(8)
    v_smfmac_f32_16x16x64_bf16 v[12:15], v[66:69], v[96:103], v70
    s_nop 0
    v_cvt_pk_bf16_f32 v112, v112, v113
    v_cvt_pk_bf16_f32 v113, v114, v115
    v_lshlrev_b32_sdwa v114, 3, v70 dst_sel:DWORD dst_unused:UNUSED_PAD src0_sel:DWORD src1_sel:WORD_1
    ds_write_b64 v114, v[112:113] offset:768
    s_waitcnt vmcnt(2)
    v_lshlrev_b32_sdwa v96, 3, v126 dst_sel:DWORD dst_unused:UNUSED_PAD src0_sel:DWORD src1_sel:WORD_0
    v_lshlrev_b32_sdwa v98, 3, v126 dst_sel:DWORD dst_unused:UNUSED_PAD src0_sel:DWORD src1_sel:WORD_1
    ds_read_b64 v[96:97], v96
    ds_read_b64 v[98:99], v98
    v_lshlrev_b32_sdwa v100, 3, v127 dst_sel:DWORD dst_unused:UNUSED_PAD src0_sel:DWORD src1_sel:WORD_0
    v_lshlrev_b32_sdwa v102, 3, v127 dst_sel:DWORD dst_unused:UNUSED_PAD src0_sel:DWORD src1_sel:WORD_1
    v_cvt_pk_bf16_f32 v15, v14, v15
    v_cvt_pk_bf16_f32 v14, v12, v13
    v_and_b32 v13, s23, v11
    v_lshlrev_b32 v12, 16, v11
    v_and_b32 v11, s23, v10
    v_lshlrev_b32 v10, 16, v10
    ds_read_b64 v[100:101], v100
    ds_read_b64 v[102:103], v102
    s_waitcnt lgkmcnt(9)
    v_smfmac_f32_16x16x64_bf16 v[10:13], v[66:69], v[104:111], v70
    v_mfma_f32_16x16x32_bf16 v[112:115], v[72:75], v[240:243], 0
    buffer_load_dwordx4 v[72:75], v71, s[12:15], s21 offen offset:0
    v_lshlrev_b32_sdwa v104, 3, v124 dst_sel:DWORD dst_unused:UNUSED_PAD src0_sel:DWORD src1_sel:WORD_0
    v_lshlrev_b32_sdwa v106, 3, v124 dst_sel:DWORD dst_unused:UNUSED_PAD src0_sel:DWORD src1_sel:WORD_1
    ds_read_b64 v[104:105], v104
    ds_read_b64 v[106:107], v106
    v_mfma_f32_16x16x32_bf16 v[112:115], v[76:79], v[244:247], v[112:115]
    buffer_load_dwordx4 v[76:79], v71, s[12:15], s21 offen offset:1024
    v_lshlrev_b32_sdwa v108, 3, v125 dst_sel:DWORD dst_unused:UNUSED_PAD src0_sel:DWORD src1_sel:WORD_0
    v_lshlrev_b32_sdwa v110, 3, v125 dst_sel:DWORD dst_unused:UNUSED_PAD src0_sel:DWORD src1_sel:WORD_1
    ds_read_b64 v[108:109], v108
    ds_read_b64 v[110:111], v110
    buffer_load_dwordx4 v[124:127], v71, s[12:15], s20 offen offset:1024 sc1
    s_waitcnt lgkmcnt(9)
    v_smfmac_f32_16x16x64_bf16 v[10:13], v[66:69], v[88:95], v70
    v_mfma_f32_16x16x32_bf16 v[112:115], v[80:83], v[248:251], v[112:115]
    buffer_load_dwordx4 v[80:83], v71, s[12:15], s19 offen offset:0
    s_waitcnt vmcnt(5)
    v_lshlrev_b32_sdwa v88, 3, v118 dst_sel:DWORD dst_unused:UNUSED_PAD src0_sel:DWORD src1_sel:WORD_0
    v_lshlrev_b32_sdwa v90, 3, v118 dst_sel:DWORD dst_unused:UNUSED_PAD src0_sel:DWORD src1_sel:WORD_1
    ds_read_b64 v[88:89], v88
    ds_read_b64 v[90:91], v90
    v_mfma_f32_16x16x32_bf16 v[112:115], v[84:87], v[252:255], v[112:115]
    buffer_load_dwordx4 v[84:87], v71, s[12:15], s19 offen offset:1024
    s_add_u32 s21, s21, 4096
    s_add_u32 s19, s19, 4096
    v_lshlrev_b32_sdwa v92, 3, v119 dst_sel:DWORD dst_unused:UNUSED_PAD src0_sel:DWORD src1_sel:WORD_0
    v_lshlrev_b32_sdwa v94, 3, v119 dst_sel:DWORD dst_unused:UNUSED_PAD src0_sel:DWORD src1_sel:WORD_1
    v_cvt_pk_bf16_f32 v13, v12, v13
    v_cvt_pk_bf16_f32 v12, v10, v11
    v_and_b32 v11, s23, v9
    v_lshlrev_b32 v10, 16, v9
    v_and_b32 v9, s23, v8
    v_lshlrev_b32 v8, 16, v8
    ds_read_b64 v[92:93], v92
    ds_read_b64 v[94:95], v94
    s_waitcnt lgkmcnt(8)
    v_smfmac_f32_16x16x64_bf16 v[8:11], v[66:69], v[96:103], v70
    v_cvt_pk_bf16_f32 v112, v112, v113
    v_cvt_pk_bf16_f32 v113, v114, v115
    v_lshlrev_b32_sdwa v114, 3, v70 dst_sel:DWORD dst_unused:UNUSED_PAD src0_sel:DWORD src1_sel:WORD_1
    ds_write_b64 v114, v[112:113] offset:896
    s_setprio 1
    v_lshlrev_b32_sdwa v96, 3, v116 dst_sel:DWORD dst_unused:UNUSED_PAD src0_sel:DWORD src1_sel:WORD_0
    v_lshlrev_b32_sdwa v98, 3, v116 dst_sel:DWORD dst_unused:UNUSED_PAD src0_sel:DWORD src1_sel:WORD_1
    ds_read_b64 v[96:97], v96
    ds_read_b64 v[98:99], v98
    v_lshlrev_b32_sdwa v100, 3, v117 dst_sel:DWORD dst_unused:UNUSED_PAD src0_sel:DWORD src1_sel:WORD_0
    v_lshlrev_b32_sdwa v102, 3, v117 dst_sel:DWORD dst_unused:UNUSED_PAD src0_sel:DWORD src1_sel:WORD_1
    ds_read_b64 v[100:101], v100
    ds_read_b64 v[102:103], v102
    buffer_load_dwordx4 v[116:119], v71, s[12:15], s20 offen offset:0 sc1
    s_waitcnt lgkmcnt(9)
    v_smfmac_f32_16x16x64_bf16 v[8:11], v[66:69], v[104:111], v70
    s_waitcnt vmcnt(6)
    v_lshlrev_b32_sdwa v104, 3, v122 dst_sel:DWORD dst_unused:UNUSED_PAD src0_sel:DWORD src1_sel:WORD_0
    v_lshlrev_b32_sdwa v106, 3, v122 dst_sel:DWORD dst_unused:UNUSED_PAD src0_sel:DWORD src1_sel:WORD_1
    ds_read_b64 v[104:105], v104
    ds_read_b64 v[106:107], v106
    v_lshlrev_b32_sdwa v108, 3, v123 dst_sel:DWORD dst_unused:UNUSED_PAD src0_sel:DWORD src1_sel:WORD_0
    v_lshlrev_b32_sdwa v110, 3, v123 dst_sel:DWORD dst_unused:UNUSED_PAD src0_sel:DWORD src1_sel:WORD_1
    s_nop 0
    v_cvt_pk_bf16_f32 v11, v10, v11
    v_cvt_pk_bf16_f32 v10, v8, v9
    v_and_b32 v9, s23, v7
    v_lshlrev_b32 v8, 16, v7
    v_and_b32 v7, s23, v6
    v_lshlrev_b32 v6, 16, v6
    ds_read_b64 v[108:109], v108
    ds_read_b64 v[110:111], v110
    s_waitcnt lgkmcnt(9)
    v_smfmac_f32_16x16x64_bf16 v[6:9], v[66:69], v[88:95], v70
    v_lshlrev_b32_sdwa v88, 3, v120 dst_sel:DWORD dst_unused:UNUSED_PAD src0_sel:DWORD src1_sel:WORD_0
    v_lshlrev_b32_sdwa v90, 3, v120 dst_sel:DWORD dst_unused:UNUSED_PAD src0_sel:DWORD src1_sel:WORD_1
    ds_read_b64 v[88:89], v88
    ds_read_b64 v[90:91], v90
    v_lshlrev_b32_sdwa v92, 3, v121 dst_sel:DWORD dst_unused:UNUSED_PAD src0_sel:DWORD src1_sel:WORD_0
    v_lshlrev_b32_sdwa v94, 3, v121 dst_sel:DWORD dst_unused:UNUSED_PAD src0_sel:DWORD src1_sel:WORD_1
    ds_read_b64 v[92:93], v92
    ds_read_b64 v[94:95], v94
    s_add_u32 s20, s20, 0x23000
    buffer_load_dwordx4 v[120:123], v71, s[12:15], s20 offen offset:3072 sc1
    s_waitcnt lgkmcnt(8)
    v_smfmac_f32_16x16x64_bf16 v[6:9], v[66:69], v[96:103], v70
    s_waitcnt vmcnt(4)
    v_lshlrev_b32_sdwa v96, 3, v126 dst_sel:DWORD dst_unused:UNUSED_PAD src0_sel:DWORD src1_sel:WORD_0
    v_lshlrev_b32_sdwa v98, 3, v126 dst_sel:DWORD dst_unused:UNUSED_PAD src0_sel:DWORD src1_sel:WORD_1
    ds_read_b64 v[96:97], v96
    ds_read_b64 v[98:99], v98
    v_lshlrev_b32_sdwa v100, 3, v127 dst_sel:DWORD dst_unused:UNUSED_PAD src0_sel:DWORD src1_sel:WORD_0
    v_lshlrev_b32_sdwa v102, 3, v127 dst_sel:DWORD dst_unused:UNUSED_PAD src0_sel:DWORD src1_sel:WORD_1
    s_nop 0
    v_cvt_pk_bf16_f32 v9, v8, v9
    v_cvt_pk_bf16_f32 v8, v6, v7
    v_and_b32 v7, s23, v5
    v_lshlrev_b32 v6, 16, v5
    v_and_b32 v5, s23, v4
    v_lshlrev_b32 v4, 16, v4
    ds_read_b64 v[100:101], v100
    ds_read_b64 v[102:103], v102
    s_waitcnt lgkmcnt(8)
    v_smfmac_f32_16x16x64_bf16 v[4:7], v[66:69], v[104:111], v70
    v_lshlrev_b32_sdwa v104, 3, v124 dst_sel:DWORD dst_unused:UNUSED_PAD src0_sel:DWORD src1_sel:WORD_0
    v_lshlrev_b32_sdwa v106, 3, v124 dst_sel:DWORD dst_unused:UNUSED_PAD src0_sel:DWORD src1_sel:WORD_1
    ds_read_b64 v[104:105], v104
    ds_read_b64 v[106:107], v106
    v_lshlrev_b32_sdwa v108, 3, v125 dst_sel:DWORD dst_unused:UNUSED_PAD src0_sel:DWORD src1_sel:WORD_0
    v_lshlrev_b32_sdwa v110, 3, v125 dst_sel:DWORD dst_unused:UNUSED_PAD src0_sel:DWORD src1_sel:WORD_1
    ds_read_b64 v[108:109], v108
    ds_read_b64 v[110:111], v110
    buffer_load_dwordx4 v[124:127], v71, s[12:15], s20 offen offset:2048 sc1
    s_waitcnt lgkmcnt(8)
    v_smfmac_f32_16x16x64_bf16 v[4:7], v[66:69], v[88:95], v70
    s_waitcnt vmcnt(2)
    v_lshlrev_b32_sdwa v88, 3, v118 dst_sel:DWORD dst_unused:UNUSED_PAD src0_sel:DWORD src1_sel:WORD_0
    v_lshlrev_b32_sdwa v90, 3, v118 dst_sel:DWORD dst_unused:UNUSED_PAD src0_sel:DWORD src1_sel:WORD_1
    ds_read_b64 v[88:89], v88
    ds_read_b64 v[90:91], v90
    v_lshlrev_b32_sdwa v92, 3, v119 dst_sel:DWORD dst_unused:UNUSED_PAD src0_sel:DWORD src1_sel:WORD_0
    v_lshlrev_b32_sdwa v94, 3, v119 dst_sel:DWORD dst_unused:UNUSED_PAD src0_sel:DWORD src1_sel:WORD_1
    s_nop 0
    v_cvt_pk_bf16_f32 v7, v6, v7
    v_cvt_pk_bf16_f32 v6, v4, v5
    v_and_b32 v5, s23, v3
    v_lshlrev_b32 v4, 16, v3
    v_and_b32 v3, s23, v2
    v_lshlrev_b32 v2, 16, v2
    ds_read_b64 v[92:93], v92
    ds_read_b64 v[94:95], v94
    s_waitcnt lgkmcnt(8)
    v_smfmac_f32_16x16x64_bf16 v[2:5], v[66:69], v[96:103], v70
    s_setprio 0
    v_lshlrev_b32_sdwa v96, 3, v116 dst_sel:DWORD dst_unused:UNUSED_PAD src0_sel:DWORD src1_sel:WORD_0
    v_lshlrev_b32_sdwa v98, 3, v116 dst_sel:DWORD dst_unused:UNUSED_PAD src0_sel:DWORD src1_sel:WORD_1
    ds_read_b64 v[96:97], v96
    ds_read_b64 v[98:99], v98
    v_lshlrev_b32_sdwa v100, 3, v117 dst_sel:DWORD dst_unused:UNUSED_PAD src0_sel:DWORD src1_sel:WORD_0
    v_lshlrev_b32_sdwa v102, 3, v117 dst_sel:DWORD dst_unused:UNUSED_PAD src0_sel:DWORD src1_sel:WORD_1
    ds_read_b64 v[100:101], v100
    ds_read_b64 v[102:103], v102
    buffer_load_dwordx4 v[116:119], v71, s[12:15], s20 offen offset:1024 sc1
    s_waitcnt lgkmcnt(8)
    v_smfmac_f32_16x16x64_bf16 v[2:5], v[66:69], v[104:111], v70
    s_waitcnt vmcnt(2)
    v_lshlrev_b32_sdwa v104, 3, v120 dst_sel:DWORD dst_unused:UNUSED_PAD src0_sel:DWORD src1_sel:WORD_0
    v_lshlrev_b32_sdwa v106, 3, v120 dst_sel:DWORD dst_unused:UNUSED_PAD src0_sel:DWORD src1_sel:WORD_1
    ds_read_b64 v[104:105], v104
    ds_read_b64 v[106:107], v106
    v_lshlrev_b32_sdwa v108, 3, v121 dst_sel:DWORD dst_unused:UNUSED_PAD src0_sel:DWORD src1_sel:WORD_0
    v_lshlrev_b32_sdwa v110, 3, v121 dst_sel:DWORD dst_unused:UNUSED_PAD src0_sel:DWORD src1_sel:WORD_1
    s_nop 0
    v_cvt_pk_bf16_f32 v5, v4, v5
    v_cvt_pk_bf16_f32 v4, v2, v3
    v_and_b32 v3, s23, v1
    v_lshlrev_b32 v2, 16, v1
    v_and_b32 v1, s23, v0
    v_lshlrev_b32 v0, 16, v0
    ds_read_b64 v[108:109], v108
    ds_read_b64 v[110:111], v110
    s_waitcnt lgkmcnt(8)
    v_smfmac_f32_16x16x64_bf16 v[0:3], v[66:69], v[88:95], v70
    s_barrier
    s_setprio 3
    v_lshlrev_b32_sdwa v88, 3, v122 dst_sel:DWORD dst_unused:UNUSED_PAD src0_sel:DWORD src1_sel:WORD_0
    v_lshlrev_b32_sdwa v90, 3, v122 dst_sel:DWORD dst_unused:UNUSED_PAD src0_sel:DWORD src1_sel:WORD_1
    ds_read_b64 v[88:89], v88
    ds_read_b64 v[90:91], v90
    v_lshlrev_b32_sdwa v92, 3, v123 dst_sel:DWORD dst_unused:UNUSED_PAD src0_sel:DWORD src1_sel:WORD_0
    v_lshlrev_b32_sdwa v94, 3, v123 dst_sel:DWORD dst_unused:UNUSED_PAD src0_sel:DWORD src1_sel:WORD_1
    ds_read_b64 v[92:93], v92
    ds_read_b64 v[94:95], v94
    buffer_load_dwordx4 v[120:123], v71, s[12:15], s20 offen offset:0 sc1
    s_waitcnt lgkmcnt(8)
    v_smfmac_f32_16x16x64_bf16 v[0:3], v[66:69], v[96:103], v70
    v_mfma_f32_16x16x32_bf16 v[112:115], v[72:75], v[128:131], 0
    s_waitcnt vmcnt(2)
    v_lshlrev_b32_sdwa v96, 3, v124 dst_sel:DWORD dst_unused:UNUSED_PAD src0_sel:DWORD src1_sel:WORD_0
    v_lshlrev_b32_sdwa v98, 3, v124 dst_sel:DWORD dst_unused:UNUSED_PAD src0_sel:DWORD src1_sel:WORD_1
    ds_read_b64 v[96:97], v96
    ds_read_b64 v[98:99], v98
    v_mfma_f32_16x16x32_bf16 v[112:115], v[76:79], v[132:135], v[112:115]
    v_add_u32 v70, 0xc0000000, v70
    v_lshlrev_b32_sdwa v100, 3, v125 dst_sel:DWORD dst_unused:UNUSED_PAD src0_sel:DWORD src1_sel:WORD_0
    v_lshlrev_b32_sdwa v102, 3, v125 dst_sel:DWORD dst_unused:UNUSED_PAD src0_sel:DWORD src1_sel:WORD_1
    v_cvt_pk_bf16_f32 v3, v2, v3
    v_cvt_pk_bf16_f32 v2, v0, v1
    v_mov_b64 v[0:1], v[32:33]
    v_lshlrev_b32 v32, 16, v34
    v_and_b32 v33, s23, v34
    v_lshlrev_b32 v34, 16, v35
    v_and_b32 v35, s23, v35
    ds_read_b64 v[100:101], v100
    ds_read_b64 v[102:103], v102
    s_waitcnt lgkmcnt(8)
    v_smfmac_f32_16x16x64_bf16 v[32:35], v[66:69], v[104:111], v70
    v_mfma_f32_16x16x32_bf16 v[112:115], v[80:83], v[136:139], v[112:115]
    v_lshlrev_b32_sdwa v104, 3, v126 dst_sel:DWORD dst_unused:UNUSED_PAD src0_sel:DWORD src1_sel:WORD_0
    v_lshlrev_b32_sdwa v106, 3, v126 dst_sel:DWORD dst_unused:UNUSED_PAD src0_sel:DWORD src1_sel:WORD_1
    ds_read_b64 v[104:105], v104
    ds_read_b64 v[106:107], v106
    v_mfma_f32_16x16x32_bf16 v[112:115], v[84:87], v[140:143], v[112:115]
    v_lshlrev_b32_sdwa v108, 3, v127 dst_sel:DWORD dst_unused:UNUSED_PAD src0_sel:DWORD src1_sel:WORD_0
    v_lshlrev_b32_sdwa v110, 3, v127 dst_sel:DWORD dst_unused:UNUSED_PAD src0_sel:DWORD src1_sel:WORD_1
    ds_read_b64 v[108:109], v108
    ds_read_b64 v[110:111], v110
    s_add_u32 s20, s20, 0xfffff000
    buffer_load_dwordx4 v[124:127], v71, s[12:15], s20 offen offset:3072 sc1
    s_waitcnt lgkmcnt(8)
    v_smfmac_f32_16x16x64_bf16 v[32:35], v[66:69], v[88:95], v70
    v_cvt_pk_bf16_f32 v112, v112, v113
    v_cvt_pk_bf16_f32 v113, v114, v115
    v_lshlrev_b32_sdwa v114, 3, v70 dst_sel:DWORD dst_unused:UNUSED_PAD src0_sel:DWORD src1_sel:WORD_1
    ds_write_b64 v114, v[112:113] offset:0
    s_waitcnt vmcnt(2)
    v_lshlrev_b32_sdwa v88, 3, v116 dst_sel:DWORD dst_unused:UNUSED_PAD src0_sel:DWORD src1_sel:WORD_0
    v_lshlrev_b32_sdwa v90, 3, v116 dst_sel:DWORD dst_unused:UNUSED_PAD src0_sel:DWORD src1_sel:WORD_1
    ds_read_b64 v[88:89], v88
    ds_read_b64 v[90:91], v90
    v_lshlrev_b32_sdwa v92, 3, v117 dst_sel:DWORD dst_unused:UNUSED_PAD src0_sel:DWORD src1_sel:WORD_0
    v_lshlrev_b32_sdwa v94, 3, v117 dst_sel:DWORD dst_unused:UNUSED_PAD src0_sel:DWORD src1_sel:WORD_1
    v_cvt_pk_bf16_f32 v32, v32, v33
    v_cvt_pk_bf16_f32 v33, v34, v35
    v_lshlrev_b32 v34, 16, v36
    v_and_b32 v35, s23, v36
    v_lshlrev_b32 v36, 16, v37
    v_and_b32 v37, s23, v37
    ds_read_b64 v[92:93], v92
    ds_read_b64 v[94:95], v94
    s_waitcnt lgkmcnt(9)
    v_smfmac_f32_16x16x64_bf16 v[34:37], v[66:69], v[96:103], v70
    v_mfma_f32_16x16x32_bf16 v[112:115], v[72:75], v[144:147], 0
    v_lshlrev_b32_sdwa v96, 3, v118 dst_sel:DWORD dst_unused:UNUSED_PAD src0_sel:DWORD src1_sel:WORD_0
    v_lshlrev_b32_sdwa v98, 3, v118 dst_sel:DWORD dst_unused:UNUSED_PAD src0_sel:DWORD src1_sel:WORD_1
    ds_read_b64 v[96:97], v96
    ds_read_b64 v[98:99], v98
    v_mfma_f32_16x16x32_bf16 v[112:115], v[76:79], v[148:151], v[112:115]
    v_lshlrev_b32_sdwa v100, 3, v119 dst_sel:DWORD dst_unused:UNUSED_PAD src0_sel:DWORD src1_sel:WORD_0
    v_lshlrev_b32_sdwa v102, 3, v119 dst_sel:DWORD dst_unused:UNUSED_PAD src0_sel:DWORD src1_sel:WORD_1
    ds_read_b64 v[100:101], v100
    ds_read_b64 v[102:103], v102
    buffer_load_dwordx4 v[116:119], v71, s[12:15], s20 offen offset:2048 sc1
    s_waitcnt lgkmcnt(9)
    v_smfmac_f32_16x16x64_bf16 v[34:37], v[66:69], v[104:111], v70
    v_mfma_f32_16x16x32_bf16 v[112:115], v[80:83], v[152:155], v[112:115]
    s_waitcnt vmcnt(2)
    v_lshlrev_b32_sdwa v104, 3, v120 dst_sel:DWORD dst_unused:UNUSED_PAD src0_sel:DWORD src1_sel:WORD_0
    v_lshlrev_b32_sdwa v106, 3, v120 dst_sel:DWORD dst_unused:UNUSED_PAD src0_sel:DWORD src1_sel:WORD_1
    ds_read_b64 v[104:105], v104
    ds_read_b64 v[106:107], v106
    v_mfma_f32_16x16x32_bf16 v[112:115], v[84:87], v[156:159], v[112:115]
    v_lshlrev_b32_sdwa v108, 3, v121 dst_sel:DWORD dst_unused:UNUSED_PAD src0_sel:DWORD src1_sel:WORD_0
    v_lshlrev_b32_sdwa v110, 3, v121 dst_sel:DWORD dst_unused:UNUSED_PAD src0_sel:DWORD src1_sel:WORD_1
    v_cvt_pk_bf16_f32 v34, v34, v35
    v_cvt_pk_bf16_f32 v35, v36, v37
    v_lshlrev_b32 v36, 16, v38
    v_and_b32 v37, s23, v38
    v_lshlrev_b32 v38, 16, v39
    v_and_b32 v39, s23, v39
    ds_read_b64 v[108:109], v108
    ds_read_b64 v[110:111], v110
    s_waitcnt lgkmcnt(8)
    v_smfmac_f32_16x16x64_bf16 v[36:39], v[66:69], v[88:95], v70
    v_cvt_pk_bf16_f32 v112, v112, v113
    v_cvt_pk_bf16_f32 v113, v114, v115
    v_lshlrev_b32_sdwa v114, 3, v70 dst_sel:DWORD dst_unused:UNUSED_PAD src0_sel:DWORD src1_sel:WORD_1
    ds_write_b64 v114, v[112:113] offset:128
    v_lshlrev_b32_sdwa v88, 3, v122 dst_sel:DWORD dst_unused:UNUSED_PAD src0_sel:DWORD src1_sel:WORD_0
    v_lshlrev_b32_sdwa v90, 3, v122 dst_sel:DWORD dst_unused:UNUSED_PAD src0_sel:DWORD src1_sel:WORD_1
    ds_read_b64 v[88:89], v88
    ds_read_b64 v[90:91], v90
    v_lshlrev_b32_sdwa v92, 3, v123 dst_sel:DWORD dst_unused:UNUSED_PAD src0_sel:DWORD src1_sel:WORD_0
    v_lshlrev_b32_sdwa v94, 3, v123 dst_sel:DWORD dst_unused:UNUSED_PAD src0_sel:DWORD src1_sel:WORD_1
    ds_read_b64 v[92:93], v92
    ds_read_b64 v[94:95], v94
    buffer_load_dwordx4 v[120:123], v71, s[12:15], s20 offen offset:1024 sc1
    s_waitcnt lgkmcnt(9)
    v_smfmac_f32_16x16x64_bf16 v[36:39], v[66:69], v[96:103], v70
    v_mfma_f32_16x16x32_bf16 v[112:115], v[72:75], v[160:163], 0
    s_waitcnt vmcnt(2)
    v_lshlrev_b32_sdwa v96, 3, v124 dst_sel:DWORD dst_unused:UNUSED_PAD src0_sel:DWORD src1_sel:WORD_0
    v_lshlrev_b32_sdwa v98, 3, v124 dst_sel:DWORD dst_unused:UNUSED_PAD src0_sel:DWORD src1_sel:WORD_1
    ds_read_b64 v[96:97], v96
    ds_read_b64 v[98:99], v98
    v_mfma_f32_16x16x32_bf16 v[112:115], v[76:79], v[164:167], v[112:115]
    v_lshlrev_b32_sdwa v100, 3, v125 dst_sel:DWORD dst_unused:UNUSED_PAD src0_sel:DWORD src1_sel:WORD_0
    v_lshlrev_b32_sdwa v102, 3, v125 dst_sel:DWORD dst_unused:UNUSED_PAD src0_sel:DWORD src1_sel:WORD_1
    v_cvt_pk_bf16_f32 v36, v36, v37
    v_cvt_pk_bf16_f32 v37, v38, v39
    v_lshlrev_b32 v38, 16, v40
    v_and_b32 v39, s23, v40
    v_lshlrev_b32 v40, 16, v41
    v_and_b32 v41, s23, v41
    ds_read_b64 v[100:101], v100
    ds_read_b64 v[102:103], v102
    s_waitcnt lgkmcnt(9)
    v_smfmac_f32_16x16x64_bf16 v[38:41], v[66:69], v[104:111], v70
    v_mfma_f32_16x16x32_bf16 v[112:115], v[80:83], v[168:171], v[112:115]
    v_lshlrev_b32_sdwa v104, 3, v126 dst_sel:DWORD dst_unused:UNUSED_PAD src0_sel:DWORD src1_sel:WORD_0
    v_lshlrev_b32_sdwa v106, 3, v126 dst_sel:DWORD dst_unused:UNUSED_PAD src0_sel:DWORD src1_sel:WORD_1
    ds_read_b64 v[104:105], v104
    ds_read_b64 v[106:107], v106
    v_mfma_f32_16x16x32_bf16 v[112:115], v[84:87], v[172:175], v[112:115]
    v_lshlrev_b32_sdwa v108, 3, v127 dst_sel:DWORD dst_unused:UNUSED_PAD src0_sel:DWORD src1_sel:WORD_0
    v_lshlrev_b32_sdwa v110, 3, v127 dst_sel:DWORD dst_unused:UNUSED_PAD src0_sel:DWORD src1_sel:WORD_1
    ds_read_b64 v[108:109], v108
    ds_read_b64 v[110:111], v110
    buffer_load_dwordx4 v[124:127], v71, s[12:15], s20 offen offset:0 sc1
    s_waitcnt lgkmcnt(8)
    v_smfmac_f32_16x16x64_bf16 v[38:41], v[66:69], v[88:95], v70
    s_nop 0
    v_cvt_pk_bf16_f32 v112, v112, v113
    v_cvt_pk_bf16_f32 v113, v114, v115
    v_lshlrev_b32_sdwa v114, 3, v70 dst_sel:DWORD dst_unused:UNUSED_PAD src0_sel:DWORD src1_sel:WORD_1
    ds_write_b64 v114, v[112:113] offset:256
    s_waitcnt vmcnt(2)
    v_lshlrev_b32_sdwa v88, 3, v116 dst_sel:DWORD dst_unused:UNUSED_PAD src0_sel:DWORD src1_sel:WORD_0
    v_lshlrev_b32_sdwa v90, 3, v116 dst_sel:DWORD dst_unused:UNUSED_PAD src0_sel:DWORD src1_sel:WORD_1
    ds_read_b64 v[88:89], v88
    ds_read_b64 v[90:91], v90
    v_lshlrev_b32_sdwa v92, 3, v117 dst_sel:DWORD dst_unused:UNUSED_PAD src0_sel:DWORD src1_sel:WORD_0
    v_lshlrev_b32_sdwa v94, 3, v117 dst_sel:DWORD dst_unused:UNUSED_PAD src0_sel:DWORD src1_sel:WORD_1
    v_cvt_pk_bf16_f32 v38, v38, v39
    v_cvt_pk_bf16_f32 v39, v40, v41
    v_lshlrev_b32 v40, 16, v42
    v_and_b32 v41, s23, v42
    v_lshlrev_b32 v42, 16, v43
    v_and_b32 v43, s23, v43
    ds_read_b64 v[92:93], v92
    ds_read_b64 v[94:95], v94
    s_waitcnt lgkmcnt(9)
    v_smfmac_f32_16x16x64_bf16 v[40:43], v[66:69], v[96:103], v70
    v_mfma_f32_16x16x32_bf16 v[112:115], v[72:75], v[176:179], 0
    v_lshlrev_b32_sdwa v96, 3, v118 dst_sel:DWORD dst_unused:UNUSED_PAD src0_sel:DWORD src1_sel:WORD_0
    v_lshlrev_b32_sdwa v98, 3, v118 dst_sel:DWORD dst_unused:UNUSED_PAD src0_sel:DWORD src1_sel:WORD_1
    ds_read_b64 v[96:97], v96
    ds_read_b64 v[98:99], v98
    v_mfma_f32_16x16x32_bf16 v[112:115], v[76:79], v[180:183], v[112:115]
    v_lshlrev_b32_sdwa v100, 3, v119 dst_sel:DWORD dst_unused:UNUSED_PAD src0_sel:DWORD src1_sel:WORD_0
    v_lshlrev_b32_sdwa v102, 3, v119 dst_sel:DWORD dst_unused:UNUSED_PAD src0_sel:DWORD src1_sel:WORD_1
    ds_read_b64 v[100:101], v100
    ds_read_b64 v[102:103], v102
    s_add_u32 s20, s20, 0xfffff000
    buffer_load_dwordx4 v[116:119], v71, s[12:15], s20 offen offset:3072 sc1
    s_waitcnt lgkmcnt(9)
    v_smfmac_f32_16x16x64_bf16 v[40:43], v[66:69], v[104:111], v70
    v_mfma_f32_16x16x32_bf16 v[112:115], v[80:83], v[184:187], v[112:115]
    s_waitcnt vmcnt(2)
    v_lshlrev_b32_sdwa v104, 3, v120 dst_sel:DWORD dst_unused:UNUSED_PAD src0_sel:DWORD src1_sel:WORD_0
    v_lshlrev_b32_sdwa v106, 3, v120 dst_sel:DWORD dst_unused:UNUSED_PAD src0_sel:DWORD src1_sel:WORD_1
    ds_read_b64 v[104:105], v104
    ds_read_b64 v[106:107], v106
    v_mfma_f32_16x16x32_bf16 v[112:115], v[84:87], v[188:191], v[112:115]
    v_lshlrev_b32_sdwa v108, 3, v121 dst_sel:DWORD dst_unused:UNUSED_PAD src0_sel:DWORD src1_sel:WORD_0
    v_lshlrev_b32_sdwa v110, 3, v121 dst_sel:DWORD dst_unused:UNUSED_PAD src0_sel:DWORD src1_sel:WORD_1
    v_cvt_pk_bf16_f32 v40, v40, v41
    v_cvt_pk_bf16_f32 v41, v42, v43
    v_lshlrev_b32 v42, 16, v44
    v_and_b32 v43, s23, v44
    v_lshlrev_b32 v44, 16, v45
    v_and_b32 v45, s23, v45
    ds_read_b64 v[108:109], v108
    ds_read_b64 v[110:111], v110
    s_waitcnt lgkmcnt(8)
    v_smfmac_f32_16x16x64_bf16 v[42:45], v[66:69], v[88:95], v70
    v_cvt_pk_bf16_f32 v112, v112, v113
    v_cvt_pk_bf16_f32 v113, v114, v115
    v_lshlrev_b32_sdwa v114, 3, v70 dst_sel:DWORD dst_unused:UNUSED_PAD src0_sel:DWORD src1_sel:WORD_1
    ds_write_b64 v114, v[112:113] offset:384
    v_lshlrev_b32_sdwa v88, 3, v122 dst_sel:DWORD dst_unused:UNUSED_PAD src0_sel:DWORD src1_sel:WORD_0
    v_lshlrev_b32_sdwa v90, 3, v122 dst_sel:DWORD dst_unused:UNUSED_PAD src0_sel:DWORD src1_sel:WORD_1
    ds_read_b64 v[88:89], v88
    ds_read_b64 v[90:91], v90
    v_lshlrev_b32_sdwa v92, 3, v123 dst_sel:DWORD dst_unused:UNUSED_PAD src0_sel:DWORD src1_sel:WORD_0
    v_lshlrev_b32_sdwa v94, 3, v123 dst_sel:DWORD dst_unused:UNUSED_PAD src0_sel:DWORD src1_sel:WORD_1
    ds_read_b64 v[92:93], v92
    ds_read_b64 v[94:95], v94
    buffer_load_dwordx4 v[120:123], v71, s[12:15], s20 offen offset:2048 sc1
    s_waitcnt lgkmcnt(9)
    v_smfmac_f32_16x16x64_bf16 v[42:45], v[66:69], v[96:103], v70
    v_mfma_f32_16x16x32_bf16 v[112:115], v[72:75], v[192:195], 0
    s_waitcnt vmcnt(2)
    v_lshlrev_b32_sdwa v96, 3, v124 dst_sel:DWORD dst_unused:UNUSED_PAD src0_sel:DWORD src1_sel:WORD_0
    v_lshlrev_b32_sdwa v98, 3, v124 dst_sel:DWORD dst_unused:UNUSED_PAD src0_sel:DWORD src1_sel:WORD_1
    ds_read_b64 v[96:97], v96
    ds_read_b64 v[98:99], v98
    v_mfma_f32_16x16x32_bf16 v[112:115], v[76:79], v[196:199], v[112:115]
    v_lshlrev_b32_sdwa v100, 3, v125 dst_sel:DWORD dst_unused:UNUSED_PAD src0_sel:DWORD src1_sel:WORD_0
    v_lshlrev_b32_sdwa v102, 3, v125 dst_sel:DWORD dst_unused:UNUSED_PAD src0_sel:DWORD src1_sel:WORD_1
    v_cvt_pk_bf16_f32 v42, v42, v43
    v_cvt_pk_bf16_f32 v43, v44, v45
    v_lshlrev_b32 v44, 16, v46
    v_and_b32 v45, s23, v46
    v_lshlrev_b32 v46, 16, v47
    v_and_b32 v47, s23, v47
    ds_read_b64 v[100:101], v100
    ds_read_b64 v[102:103], v102
    s_waitcnt lgkmcnt(9)
    v_smfmac_f32_16x16x64_bf16 v[44:47], v[66:69], v[104:111], v70
    v_mfma_f32_16x16x32_bf16 v[112:115], v[80:83], v[200:203], v[112:115]
    v_lshlrev_b32_sdwa v104, 3, v126 dst_sel:DWORD dst_unused:UNUSED_PAD src0_sel:DWORD src1_sel:WORD_0
    v_lshlrev_b32_sdwa v106, 3, v126 dst_sel:DWORD dst_unused:UNUSED_PAD src0_sel:DWORD src1_sel:WORD_1
    ds_read_b64 v[104:105], v104
    ds_read_b64 v[106:107], v106
    v_mfma_f32_16x16x32_bf16 v[112:115], v[84:87], v[204:207], v[112:115]
    v_lshlrev_b32_sdwa v108, 3, v127 dst_sel:DWORD dst_unused:UNUSED_PAD src0_sel:DWORD src1_sel:WORD_0
    v_lshlrev_b32_sdwa v110, 3, v127 dst_sel:DWORD dst_unused:UNUSED_PAD src0_sel:DWORD src1_sel:WORD_1
    ds_read_b64 v[108:109], v108
    ds_read_b64 v[110:111], v110
    buffer_load_dwordx4 v[124:127], v71, s[12:15], s20 offen offset:1024 sc1
    s_waitcnt lgkmcnt(8)
    v_smfmac_f32_16x16x64_bf16 v[44:47], v[66:69], v[88:95], v70
    s_nop 0
    v_cvt_pk_bf16_f32 v112, v112, v113
    v_cvt_pk_bf16_f32 v113, v114, v115
    v_lshlrev_b32_sdwa v114, 3, v70 dst_sel:DWORD dst_unused:UNUSED_PAD src0_sel:DWORD src1_sel:WORD_1
    ds_write_b64 v114, v[112:113] offset:512
    s_waitcnt vmcnt(2)
    v_lshlrev_b32_sdwa v88, 3, v116 dst_sel:DWORD dst_unused:UNUSED_PAD src0_sel:DWORD src1_sel:WORD_0
    v_lshlrev_b32_sdwa v90, 3, v116 dst_sel:DWORD dst_unused:UNUSED_PAD src0_sel:DWORD src1_sel:WORD_1
    ds_read_b64 v[88:89], v88
    ds_read_b64 v[90:91], v90
    v_lshlrev_b32_sdwa v92, 3, v117 dst_sel:DWORD dst_unused:UNUSED_PAD src0_sel:DWORD src1_sel:WORD_0
    v_lshlrev_b32_sdwa v94, 3, v117 dst_sel:DWORD dst_unused:UNUSED_PAD src0_sel:DWORD src1_sel:WORD_1
    v_cvt_pk_bf16_f32 v44, v44, v45
    v_cvt_pk_bf16_f32 v45, v46, v47
    v_lshlrev_b32 v46, 16, v48
    v_and_b32 v47, s23, v48
    v_lshlrev_b32 v48, 16, v49
    v_and_b32 v49, s23, v49
    ds_read_b64 v[92:93], v92
    ds_read_b64 v[94:95], v94
    s_waitcnt lgkmcnt(9)
    v_smfmac_f32_16x16x64_bf16 v[46:49], v[66:69], v[96:103], v70
    s_setprio 2
    v_mfma_f32_16x16x32_bf16 v[112:115], v[72:75], v[208:211], 0
    v_lshlrev_b32_sdwa v96, 3, v118 dst_sel:DWORD dst_unused:UNUSED_PAD src0_sel:DWORD src1_sel:WORD_0
    v_lshlrev_b32_sdwa v98, 3, v118 dst_sel:DWORD dst_unused:UNUSED_PAD src0_sel:DWORD src1_sel:WORD_1
    ds_read_b64 v[96:97], v96
    ds_read_b64 v[98:99], v98
    v_mfma_f32_16x16x32_bf16 v[112:115], v[76:79], v[212:215], v[112:115]
    v_lshlrev_b32_sdwa v100, 3, v119 dst_sel:DWORD dst_unused:UNUSED_PAD src0_sel:DWORD src1_sel:WORD_0
    v_lshlrev_b32_sdwa v102, 3, v119 dst_sel:DWORD dst_unused:UNUSED_PAD src0_sel:DWORD src1_sel:WORD_1
    ds_read_b64 v[100:101], v100
    ds_read_b64 v[102:103], v102
    buffer_load_dwordx4 v[116:119], v71, s[12:15], s20 offen offset:0 sc1
    s_waitcnt lgkmcnt(9)
    v_smfmac_f32_16x16x64_bf16 v[46:49], v[66:69], v[104:111], v70
    v_mfma_f32_16x16x32_bf16 v[112:115], v[80:83], v[216:219], v[112:115]
    s_waitcnt vmcnt(2)
    v_lshlrev_b32_sdwa v104, 3, v120 dst_sel:DWORD dst_unused:UNUSED_PAD src0_sel:DWORD src1_sel:WORD_0
    v_lshlrev_b32_sdwa v106, 3, v120 dst_sel:DWORD dst_unused:UNUSED_PAD src0_sel:DWORD src1_sel:WORD_1
    ds_read_b64 v[104:105], v104
    ds_read_b64 v[106:107], v106
    v_mfma_f32_16x16x32_bf16 v[112:115], v[84:87], v[220:223], v[112:115]
    v_lshlrev_b32_sdwa v108, 3, v121 dst_sel:DWORD dst_unused:UNUSED_PAD src0_sel:DWORD src1_sel:WORD_0
    v_lshlrev_b32_sdwa v110, 3, v121 dst_sel:DWORD dst_unused:UNUSED_PAD src0_sel:DWORD src1_sel:WORD_1
    v_cvt_pk_bf16_f32 v46, v46, v47
    v_cvt_pk_bf16_f32 v47, v48, v49
    v_lshlrev_b32 v48, 16, v50
    v_and_b32 v49, s23, v50
    v_lshlrev_b32 v50, 16, v51
    v_and_b32 v51, s23, v51
    ds_read_b64 v[108:109], v108
    ds_read_b64 v[110:111], v110
    s_waitcnt lgkmcnt(8)
    v_smfmac_f32_16x16x64_bf16 v[48:51], v[66:69], v[88:95], v70
    v_cvt_pk_bf16_f32 v112, v112, v113
    v_cvt_pk_bf16_f32 v113, v114, v115
    v_lshlrev_b32_sdwa v114, 3, v70 dst_sel:DWORD dst_unused:UNUSED_PAD src0_sel:DWORD src1_sel:WORD_1
    ds_write_b64 v114, v[112:113] offset:640
    v_lshlrev_b32_sdwa v88, 3, v122 dst_sel:DWORD dst_unused:UNUSED_PAD src0_sel:DWORD src1_sel:WORD_0
    v_lshlrev_b32_sdwa v90, 3, v122 dst_sel:DWORD dst_unused:UNUSED_PAD src0_sel:DWORD src1_sel:WORD_1
    ds_read_b64 v[88:89], v88
    ds_read_b64 v[90:91], v90
    v_lshlrev_b32_sdwa v92, 3, v123 dst_sel:DWORD dst_unused:UNUSED_PAD src0_sel:DWORD src1_sel:WORD_0
    v_lshlrev_b32_sdwa v94, 3, v123 dst_sel:DWORD dst_unused:UNUSED_PAD src0_sel:DWORD src1_sel:WORD_1
    ds_read_b64 v[92:93], v92
    ds_read_b64 v[94:95], v94
    s_add_u32 s20, s20, 0xfffff000
    buffer_load_dwordx4 v[120:123], v71, s[12:15], s20 offen offset:3072 sc1
    s_waitcnt lgkmcnt(9)
    v_smfmac_f32_16x16x64_bf16 v[48:51], v[66:69], v[96:103], v70
    v_mfma_f32_16x16x32_bf16 v[112:115], v[72:75], v[224:227], 0
    s_waitcnt vmcnt(2)
    v_lshlrev_b32_sdwa v96, 3, v124 dst_sel:DWORD dst_unused:UNUSED_PAD src0_sel:DWORD src1_sel:WORD_0
    v_lshlrev_b32_sdwa v98, 3, v124 dst_sel:DWORD dst_unused:UNUSED_PAD src0_sel:DWORD src1_sel:WORD_1
    ds_read_b64 v[96:97], v96
    ds_read_b64 v[98:99], v98
    v_mfma_f32_16x16x32_bf16 v[112:115], v[76:79], v[228:231], v[112:115]
    v_lshlrev_b32_sdwa v100, 3, v125 dst_sel:DWORD dst_unused:UNUSED_PAD src0_sel:DWORD src1_sel:WORD_0
    v_lshlrev_b32_sdwa v102, 3, v125 dst_sel:DWORD dst_unused:UNUSED_PAD src0_sel:DWORD src1_sel:WORD_1
    v_cvt_pk_bf16_f32 v48, v48, v49
    v_cvt_pk_bf16_f32 v49, v50, v51
    v_lshlrev_b32 v50, 16, v52
    v_and_b32 v51, s23, v52
    v_lshlrev_b32 v52, 16, v53
    v_and_b32 v53, s23, v53
    ds_read_b64 v[100:101], v100
    ds_read_b64 v[102:103], v102
    s_waitcnt lgkmcnt(9)
    v_smfmac_f32_16x16x64_bf16 v[50:53], v[66:69], v[104:111], v70
    v_mfma_f32_16x16x32_bf16 v[112:115], v[80:83], v[232:235], v[112:115]
    v_lshlrev_b32_sdwa v104, 3, v126 dst_sel:DWORD dst_unused:UNUSED_PAD src0_sel:DWORD src1_sel:WORD_0
    v_lshlrev_b32_sdwa v106, 3, v126 dst_sel:DWORD dst_unused:UNUSED_PAD src0_sel:DWORD src1_sel:WORD_1
    ds_read_b64 v[104:105], v104
    ds_read_b64 v[106:107], v106
    v_mfma_f32_16x16x32_bf16 v[112:115], v[84:87], v[236:239], v[112:115]
    v_lshlrev_b32_sdwa v108, 3, v127 dst_sel:DWORD dst_unused:UNUSED_PAD src0_sel:DWORD src1_sel:WORD_0
    v_lshlrev_b32_sdwa v110, 3, v127 dst_sel:DWORD dst_unused:UNUSED_PAD src0_sel:DWORD src1_sel:WORD_1
    ds_read_b64 v[108:109], v108
    ds_read_b64 v[110:111], v110
    buffer_load_dwordx4 v[124:127], v71, s[12:15], s20 offen offset:2048 sc1
    s_waitcnt lgkmcnt(8)
    v_smfmac_f32_16x16x64_bf16 v[50:53], v[66:69], v[88:95], v70
    s_nop 0
    v_cvt_pk_bf16_f32 v112, v112, v113
    v_cvt_pk_bf16_f32 v113, v114, v115
    v_lshlrev_b32_sdwa v114, 3, v70 dst_sel:DWORD dst_unused:UNUSED_PAD src0_sel:DWORD src1_sel:WORD_1
    ds_write_b64 v114, v[112:113] offset:768
    s_waitcnt vmcnt(2)
    v_lshlrev_b32_sdwa v88, 3, v116 dst_sel:DWORD dst_unused:UNUSED_PAD src0_sel:DWORD src1_sel:WORD_0
    v_lshlrev_b32_sdwa v90, 3, v116 dst_sel:DWORD dst_unused:UNUSED_PAD src0_sel:DWORD src1_sel:WORD_1
    ds_read_b64 v[88:89], v88
    ds_read_b64 v[90:91], v90
    v_lshlrev_b32_sdwa v92, 3, v117 dst_sel:DWORD dst_unused:UNUSED_PAD src0_sel:DWORD src1_sel:WORD_0
    v_lshlrev_b32_sdwa v94, 3, v117 dst_sel:DWORD dst_unused:UNUSED_PAD src0_sel:DWORD src1_sel:WORD_1
    v_cvt_pk_bf16_f32 v50, v50, v51
    v_cvt_pk_bf16_f32 v51, v52, v53
    v_lshlrev_b32 v52, 16, v54
    v_and_b32 v53, s23, v54
    v_lshlrev_b32 v54, 16, v55
    v_and_b32 v55, s23, v55
    ds_read_b64 v[92:93], v92
    ds_read_b64 v[94:95], v94
    s_waitcnt lgkmcnt(9)
    v_smfmac_f32_16x16x64_bf16 v[52:55], v[66:69], v[96:103], v70
    v_mfma_f32_16x16x32_bf16 v[112:115], v[72:75], v[240:243], 0
    buffer_load_dwordx4 v[72:75], v71, s[12:15], s21 offen offset:0
    v_lshlrev_b32_sdwa v96, 3, v118 dst_sel:DWORD dst_unused:UNUSED_PAD src0_sel:DWORD src1_sel:WORD_0
    v_lshlrev_b32_sdwa v98, 3, v118 dst_sel:DWORD dst_unused:UNUSED_PAD src0_sel:DWORD src1_sel:WORD_1
    ds_read_b64 v[96:97], v96
    ds_read_b64 v[98:99], v98
    v_mfma_f32_16x16x32_bf16 v[112:115], v[76:79], v[244:247], v[112:115]
    buffer_load_dwordx4 v[76:79], v71, s[12:15], s21 offen offset:1024
    v_lshlrev_b32_sdwa v100, 3, v119 dst_sel:DWORD dst_unused:UNUSED_PAD src0_sel:DWORD src1_sel:WORD_0
    v_lshlrev_b32_sdwa v102, 3, v119 dst_sel:DWORD dst_unused:UNUSED_PAD src0_sel:DWORD src1_sel:WORD_1
    ds_read_b64 v[100:101], v100
    ds_read_b64 v[102:103], v102
    buffer_load_dwordx4 v[116:119], v71, s[12:15], s20 offen offset:1024 sc1
    s_waitcnt lgkmcnt(9)
    v_smfmac_f32_16x16x64_bf16 v[52:55], v[66:69], v[104:111], v70
    v_mfma_f32_16x16x32_bf16 v[112:115], v[80:83], v[248:251], v[112:115]
    buffer_load_dwordx4 v[80:83], v71, s[12:15], s19 offen offset:0
    s_waitcnt vmcnt(5)
    v_lshlrev_b32_sdwa v104, 3, v120 dst_sel:DWORD dst_unused:UNUSED_PAD src0_sel:DWORD src1_sel:WORD_0
    v_lshlrev_b32_sdwa v106, 3, v120 dst_sel:DWORD dst_unused:UNUSED_PAD src0_sel:DWORD src1_sel:WORD_1
    ds_read_b64 v[104:105], v104
    ds_read_b64 v[106:107], v106
    v_mfma_f32_16x16x32_bf16 v[112:115], v[84:87], v[252:255], v[112:115]
    buffer_load_dwordx4 v[84:87], v71, s[12:15], s19 offen offset:1024
    s_add_u32 s21, s21, 4096
    s_add_u32 s19, s19, 4096
    v_lshlrev_b32_sdwa v108, 3, v121 dst_sel:DWORD dst_unused:UNUSED_PAD src0_sel:DWORD src1_sel:WORD_0
    v_lshlrev_b32_sdwa v110, 3, v121 dst_sel:DWORD dst_unused:UNUSED_PAD src0_sel:DWORD src1_sel:WORD_1
    v_cvt_pk_bf16_f32 v52, v52, v53
    v_cvt_pk_bf16_f32 v53, v54, v55
    v_lshlrev_b32 v54, 16, v56
    v_and_b32 v55, s23, v56
    v_lshlrev_b32 v56, 16, v57
    v_and_b32 v57, s23, v57
    ds_read_b64 v[108:109], v108
    ds_read_b64 v[110:111], v110
    s_waitcnt lgkmcnt(8)
    v_smfmac_f32_16x16x64_bf16 v[54:57], v[66:69], v[88:95], v70
    v_cvt_pk_bf16_f32 v112, v112, v113
    v_cvt_pk_bf16_f32 v113, v114, v115
    v_lshlrev_b32_sdwa v114, 3, v70 dst_sel:DWORD dst_unused:UNUSED_PAD src0_sel:DWORD src1_sel:WORD_1
    ds_write_b64 v114, v[112:113] offset:896
    s_setprio 1
    v_lshlrev_b32_sdwa v88, 3, v122 dst_sel:DWORD dst_unused:UNUSED_PAD src0_sel:DWORD src1_sel:WORD_0
    v_lshlrev_b32_sdwa v90, 3, v122 dst_sel:DWORD dst_unused:UNUSED_PAD src0_sel:DWORD src1_sel:WORD_1
    ds_read_b64 v[88:89], v88
    ds_read_b64 v[90:91], v90
    v_lshlrev_b32_sdwa v92, 3, v123 dst_sel:DWORD dst_unused:UNUSED_PAD src0_sel:DWORD src1_sel:WORD_0
    v_lshlrev_b32_sdwa v94, 3, v123 dst_sel:DWORD dst_unused:UNUSED_PAD src0_sel:DWORD src1_sel:WORD_1
    ds_read_b64 v[92:93], v92
    ds_read_b64 v[94:95], v94
    buffer_load_dwordx4 v[120:123], v71, s[12:15], s20 offen offset:0 sc1
    s_waitcnt lgkmcnt(9)
    v_smfmac_f32_16x16x64_bf16 v[54:57], v[66:69], v[96:103], v70
    s_waitcnt vmcnt(6)
    v_lshlrev_b32_sdwa v96, 3, v124 dst_sel:DWORD dst_unused:UNUSED_PAD src0_sel:DWORD src1_sel:WORD_0
    v_lshlrev_b32_sdwa v98, 3, v124 dst_sel:DWORD dst_unused:UNUSED_PAD src0_sel:DWORD src1_sel:WORD_1
    ds_read_b64 v[96:97], v96
    ds_read_b64 v[98:99], v98
    v_lshlrev_b32_sdwa v100, 3, v125 dst_sel:DWORD dst_unused:UNUSED_PAD src0_sel:DWORD src1_sel:WORD_0
    v_lshlrev_b32_sdwa v102, 3, v125 dst_sel:DWORD dst_unused:UNUSED_PAD src0_sel:DWORD src1_sel:WORD_1
    s_nop 0
    v_cvt_pk_bf16_f32 v54, v54, v55
    v_cvt_pk_bf16_f32 v55, v56, v57
    v_lshlrev_b32 v56, 16, v58
    v_and_b32 v57, s23, v58
    v_lshlrev_b32 v58, 16, v59
    v_and_b32 v59, s23, v59
    ds_read_b64 v[100:101], v100
    ds_read_b64 v[102:103], v102
    s_waitcnt lgkmcnt(9)
    v_smfmac_f32_16x16x64_bf16 v[56:59], v[66:69], v[104:111], v70
    v_lshlrev_b32_sdwa v104, 3, v126 dst_sel:DWORD dst_unused:UNUSED_PAD src0_sel:DWORD src1_sel:WORD_0
    v_lshlrev_b32_sdwa v106, 3, v126 dst_sel:DWORD dst_unused:UNUSED_PAD src0_sel:DWORD src1_sel:WORD_1
    ds_read_b64 v[104:105], v104
    ds_read_b64 v[106:107], v106
    v_lshlrev_b32_sdwa v108, 3, v127 dst_sel:DWORD dst_unused:UNUSED_PAD src0_sel:DWORD src1_sel:WORD_0
    v_lshlrev_b32_sdwa v110, 3, v127 dst_sel:DWORD dst_unused:UNUSED_PAD src0_sel:DWORD src1_sel:WORD_1
    ds_read_b64 v[108:109], v108
    ds_read_b64 v[110:111], v110
    s_add_u32 s20, s20, 0x22c00
    buffer_load_dwordx4 v[124:127], v71, s[12:15], s20 offen offset:3072 sc1
    s_waitcnt lgkmcnt(8)
    v_smfmac_f32_16x16x64_bf16 v[56:59], v[66:69], v[88:95], v70
    s_waitcnt vmcnt(4)
    v_lshlrev_b32_sdwa v88, 3, v116 dst_sel:DWORD dst_unused:UNUSED_PAD src0_sel:DWORD src1_sel:WORD_0
    v_lshlrev_b32_sdwa v90, 3, v116 dst_sel:DWORD dst_unused:UNUSED_PAD src0_sel:DWORD src1_sel:WORD_1
    ds_read_b64 v[88:89], v88
    ds_read_b64 v[90:91], v90
    v_lshlrev_b32_sdwa v92, 3, v117 dst_sel:DWORD dst_unused:UNUSED_PAD src0_sel:DWORD src1_sel:WORD_0
    v_lshlrev_b32_sdwa v94, 3, v117 dst_sel:DWORD dst_unused:UNUSED_PAD src0_sel:DWORD src1_sel:WORD_1
    s_nop 0
    v_cvt_pk_bf16_f32 v56, v56, v57
    v_cvt_pk_bf16_f32 v57, v58, v59
    v_lshlrev_b32 v58, 16, v60
    v_and_b32 v59, s23, v60
    v_lshlrev_b32 v60, 16, v61
    v_and_b32 v61, s23, v61
    ds_read_b64 v[92:93], v92
    ds_read_b64 v[94:95], v94
    s_waitcnt lgkmcnt(8)
    v_smfmac_f32_16x16x64_bf16 v[58:61], v[66:69], v[96:103], v70
    v_lshlrev_b32_sdwa v96, 3, v118 dst_sel:DWORD dst_unused:UNUSED_PAD src0_sel:DWORD src1_sel:WORD_0
    v_lshlrev_b32_sdwa v98, 3, v118 dst_sel:DWORD dst_unused:UNUSED_PAD src0_sel:DWORD src1_sel:WORD_1
    ds_read_b64 v[96:97], v96
    ds_read_b64 v[98:99], v98
    v_lshlrev_b32_sdwa v100, 3, v119 dst_sel:DWORD dst_unused:UNUSED_PAD src0_sel:DWORD src1_sel:WORD_0
    v_lshlrev_b32_sdwa v102, 3, v119 dst_sel:DWORD dst_unused:UNUSED_PAD src0_sel:DWORD src1_sel:WORD_1
    ds_read_b64 v[100:101], v100
    ds_read_b64 v[102:103], v102
    buffer_load_dwordx4 v[116:119], v71, s[12:15], s20 offen offset:2048 sc1
    s_waitcnt lgkmcnt(8)
    v_smfmac_f32_16x16x64_bf16 v[58:61], v[66:69], v[104:111], v70
    s_waitcnt vmcnt(2)
    v_lshlrev_b32_sdwa v104, 3, v120 dst_sel:DWORD dst_unused:UNUSED_PAD src0_sel:DWORD src1_sel:WORD_0
    v_lshlrev_b32_sdwa v106, 3, v120 dst_sel:DWORD dst_unused:UNUSED_PAD src0_sel:DWORD src1_sel:WORD_1
    ds_read_b64 v[104:105], v104
    ds_read_b64 v[106:107], v106
    v_lshlrev_b32_sdwa v108, 3, v121 dst_sel:DWORD dst_unused:UNUSED_PAD src0_sel:DWORD src1_sel:WORD_0
    v_lshlrev_b32_sdwa v110, 3, v121 dst_sel:DWORD dst_unused:UNUSED_PAD src0_sel:DWORD src1_sel:WORD_1
    s_nop 0
    v_cvt_pk_bf16_f32 v58, v58, v59
    v_cvt_pk_bf16_f32 v59, v60, v61
    v_lshlrev_b32 v60, 16, v62
    v_and_b32 v61, s23, v62
    v_lshlrev_b32 v62, 16, v63
    v_and_b32 v63, s23, v63
    ds_read_b64 v[108:109], v108
    ds_read_b64 v[110:111], v110
    s_waitcnt lgkmcnt(8)
    v_smfmac_f32_16x16x64_bf16 v[60:63], v[66:69], v[88:95], v70
    s_setprio 0
    v_lshlrev_b32_sdwa v88, 3, v122 dst_sel:DWORD dst_unused:UNUSED_PAD src0_sel:DWORD src1_sel:WORD_0
    v_lshlrev_b32_sdwa v90, 3, v122 dst_sel:DWORD dst_unused:UNUSED_PAD src0_sel:DWORD src1_sel:WORD_1
    ds_read_b64 v[88:89], v88
    ds_read_b64 v[90:91], v90
    v_lshlrev_b32_sdwa v92, 3, v123 dst_sel:DWORD dst_unused:UNUSED_PAD src0_sel:DWORD src1_sel:WORD_0
    v_lshlrev_b32_sdwa v94, 3, v123 dst_sel:DWORD dst_unused:UNUSED_PAD src0_sel:DWORD src1_sel:WORD_1
    ds_read_b64 v[92:93], v92
    ds_read_b64 v[94:95], v94
    buffer_load_dwordx4 v[120:123], v71, s[12:15], s20 offen offset:1024 sc1
    s_waitcnt lgkmcnt(8)
    v_smfmac_f32_16x16x64_bf16 v[60:63], v[66:69], v[96:103], v70
    s_waitcnt vmcnt(2)
    v_lshlrev_b32_sdwa v96, 3, v126 dst_sel:DWORD dst_unused:UNUSED_PAD src0_sel:DWORD src1_sel:WORD_0
    v_lshlrev_b32_sdwa v98, 3, v126 dst_sel:DWORD dst_unused:UNUSED_PAD src0_sel:DWORD src1_sel:WORD_1
    ds_read_b64 v[96:97], v96
    ds_read_b64 v[98:99], v98
    v_lshlrev_b32_sdwa v100, 3, v127 dst_sel:DWORD dst_unused:UNUSED_PAD src0_sel:DWORD src1_sel:WORD_0
    v_lshlrev_b32_sdwa v102, 3, v127 dst_sel:DWORD dst_unused:UNUSED_PAD src0_sel:DWORD src1_sel:WORD_1
    s_nop 0
    v_cvt_pk_bf16_f32 v60, v60, v61
    v_cvt_pk_bf16_f32 v61, v62, v63
    v_lshlrev_b32 v62, 16, v64
    v_and_b32 v63, s23, v64
    v_lshlrev_b32 v64, 16, v65
    v_and_b32 v65, s23, v65
    ds_read_b64 v[100:101], v100
    ds_read_b64 v[102:103], v102
    s_waitcnt lgkmcnt(8)
    v_smfmac_f32_16x16x64_bf16 v[62:65], v[66:69], v[104:111], v70
    s_barrier
    s_setprio 3
    v_lshlrev_b32_sdwa v104, 3, v124 dst_sel:DWORD dst_unused:UNUSED_PAD src0_sel:DWORD src1_sel:WORD_0
    v_lshlrev_b32_sdwa v106, 3, v124 dst_sel:DWORD dst_unused:UNUSED_PAD src0_sel:DWORD src1_sel:WORD_1
    ds_read_b64 v[104:105], v104
    ds_read_b64 v[106:107], v106
    v_lshlrev_b32_sdwa v108, 3, v125 dst_sel:DWORD dst_unused:UNUSED_PAD src0_sel:DWORD src1_sel:WORD_0
    v_lshlrev_b32_sdwa v110, 3, v125 dst_sel:DWORD dst_unused:UNUSED_PAD src0_sel:DWORD src1_sel:WORD_1
    ds_read_b64 v[108:109], v108
    ds_read_b64 v[110:111], v110
    buffer_load_dwordx4 v[124:127], v71, s[12:15], s20 offen offset:0 sc1
    s_waitcnt lgkmcnt(8)
    v_smfmac_f32_16x16x64_bf16 v[62:65], v[66:69], v[88:95], v70
    v_mfma_f32_16x16x32_bf16 v[112:115], v[72:75], v[128:131], 0
    s_waitcnt vmcnt(2)
    v_lshlrev_b32_sdwa v88, 3, v118 dst_sel:DWORD dst_unused:UNUSED_PAD src0_sel:DWORD src1_sel:WORD_0
    v_lshlrev_b32_sdwa v90, 3, v118 dst_sel:DWORD dst_unused:UNUSED_PAD src0_sel:DWORD src1_sel:WORD_1
    ds_read_b64 v[88:89], v88
    ds_read_b64 v[90:91], v90
    v_mfma_f32_16x16x32_bf16 v[112:115], v[76:79], v[132:135], v[112:115]
    v_lshlrev_b32_sdwa v92, 3, v119 dst_sel:DWORD dst_unused:UNUSED_PAD src0_sel:DWORD src1_sel:WORD_0
    v_lshlrev_b32_sdwa v94, 3, v119 dst_sel:DWORD dst_unused:UNUSED_PAD src0_sel:DWORD src1_sel:WORD_1
    v_cvt_pk_bf16_f32 v62, v62, v63
    v_cvt_pk_bf16_f32 v63, v64, v65
    v_mov_b64 v[64:65], v[32:33]
    v_and_b32 v33, s23, v31
    v_lshlrev_b32 v32, 16, v31
    v_and_b32 v31, s23, v30
    v_lshlrev_b32 v30, 16, v30
    ds_read_b64 v[92:93], v92
    ds_read_b64 v[94:95], v94
    s_waitcnt lgkmcnt(8)
    v_smfmac_f32_16x16x64_bf16 v[30:33], v[66:69], v[96:103], v70
    v_mfma_f32_16x16x32_bf16 v[112:115], v[80:83], v[136:139], v[112:115]
    v_lshlrev_b32_sdwa v96, 3, v116 dst_sel:DWORD dst_unused:UNUSED_PAD src0_sel:DWORD src1_sel:WORD_0
    v_lshlrev_b32_sdwa v98, 3, v116 dst_sel:DWORD dst_unused:UNUSED_PAD src0_sel:DWORD src1_sel:WORD_1
    ds_read_b64 v[96:97], v96
    ds_read_b64 v[98:99], v98
    v_mfma_f32_16x16x32_bf16 v[112:115], v[84:87], v[140:143], v[112:115]
    v_lshlrev_b32_sdwa v100, 3, v117 dst_sel:DWORD dst_unused:UNUSED_PAD src0_sel:DWORD src1_sel:WORD_0
    v_lshlrev_b32_sdwa v102, 3, v117 dst_sel:DWORD dst_unused:UNUSED_PAD src0_sel:DWORD src1_sel:WORD_1
    ds_read_b64 v[100:101], v100
    ds_read_b64 v[102:103], v102
    s_add_u32 s20, s20, 0xfffff000
    buffer_load_dwordx4 v[116:119], v71, s[12:15], s20 offen offset:3072 sc1
    s_waitcnt lgkmcnt(8)
    v_smfmac_f32_16x16x64_bf16 v[30:33], v[66:69], v[104:111], v70
    v_cvt_pk_bf16_f32 v112, v112, v113
    v_cvt_pk_bf16_f32 v113, v114, v115
    v_lshlrev_b32_sdwa v114, 3, v70 dst_sel:DWORD dst_unused:UNUSED_PAD src0_sel:DWORD src1_sel:WORD_1
    ds_write_b64 v114, v[112:113] offset:32768
    s_waitcnt vmcnt(2)
    v_lshlrev_b32_sdwa v104, 3, v122 dst_sel:DWORD dst_unused:UNUSED_PAD src0_sel:DWORD src1_sel:WORD_0
    v_lshlrev_b32_sdwa v106, 3, v122 dst_sel:DWORD dst_unused:UNUSED_PAD src0_sel:DWORD src1_sel:WORD_1
    ds_read_b64 v[104:105], v104
    ds_read_b64 v[106:107], v106
    v_lshlrev_b32_sdwa v108, 3, v123 dst_sel:DWORD dst_unused:UNUSED_PAD src0_sel:DWORD src1_sel:WORD_0
    v_lshlrev_b32_sdwa v110, 3, v123 dst_sel:DWORD dst_unused:UNUSED_PAD src0_sel:DWORD src1_sel:WORD_1
    v_cvt_pk_bf16_f32 v33, v32, v33
    v_cvt_pk_bf16_f32 v32, v30, v31
    v_and_b32 v31, s23, v29
    v_lshlrev_b32 v30, 16, v29
    v_and_b32 v29, s23, v28
    v_lshlrev_b32 v28, 16, v28
    ds_read_b64 v[108:109], v108
    ds_read_b64 v[110:111], v110
    s_waitcnt lgkmcnt(9)
    v_smfmac_f32_16x16x64_bf16 v[28:31], v[66:69], v[88:95], v70
    v_mfma_f32_16x16x32_bf16 v[112:115], v[72:75], v[144:147], 0
    v_lshlrev_b32_sdwa v88, 3, v120 dst_sel:DWORD dst_unused:UNUSED_PAD src0_sel:DWORD src1_sel:WORD_0
    v_lshlrev_b32_sdwa v90, 3, v120 dst_sel:DWORD dst_unused:UNUSED_PAD src0_sel:DWORD src1_sel:WORD_1
    ds_read_b64 v[88:89], v88
    ds_read_b64 v[90:91], v90
    v_mfma_f32_16x16x32_bf16 v[112:115], v[76:79], v[148:151], v[112:115]
    v_lshlrev_b32_sdwa v92, 3, v121 dst_sel:DWORD dst_unused:UNUSED_PAD src0_sel:DWORD src1_sel:WORD_0
    v_lshlrev_b32_sdwa v94, 3, v121 dst_sel:DWORD dst_unused:UNUSED_PAD src0_sel:DWORD src1_sel:WORD_1
    ds_read_b64 v[92:93], v92
    ds_read_b64 v[94:95], v94
    buffer_load_dwordx4 v[120:123], v71, s[12:15], s20 offen offset:2048 sc1
    s_waitcnt lgkmcnt(9)
    v_smfmac_f32_16x16x64_bf16 v[28:31], v[66:69], v[96:103], v70
    v_mfma_f32_16x16x32_bf16 v[112:115], v[80:83], v[152:155], v[112:115]
    s_waitcnt vmcnt(2)
    v_lshlrev_b32_sdwa v96, 3, v126 dst_sel:DWORD dst_unused:UNUSED_PAD src0_sel:DWORD src1_sel:WORD_0
    v_lshlrev_b32_sdwa v98, 3, v126 dst_sel:DWORD dst_unused:UNUSED_PAD src0_sel:DWORD src1_sel:WORD_1
    ds_read_b64 v[96:97], v96
    ds_read_b64 v[98:99], v98
    v_mfma_f32_16x16x32_bf16 v[112:115], v[84:87], v[156:159], v[112:115]
    v_lshlrev_b32_sdwa v100, 3, v127 dst_sel:DWORD dst_unused:UNUSED_PAD src0_sel:DWORD src1_sel:WORD_0
    v_lshlrev_b32_sdwa v102, 3, v127 dst_sel:DWORD dst_unused:UNUSED_PAD src0_sel:DWORD src1_sel:WORD_1
    v_cvt_pk_bf16_f32 v31, v30, v31
    v_cvt_pk_bf16_f32 v30, v28, v29
    v_and_b32 v29, s23, v27
    v_lshlrev_b32 v28, 16, v27
    v_and_b32 v27, s23, v26
    v_lshlrev_b32 v26, 16, v26
    ds_read_b64 v[100:101], v100
    ds_read_b64 v[102:103], v102
    s_waitcnt lgkmcnt(8)
    v_smfmac_f32_16x16x64_bf16 v[26:29], v[66:69], v[104:111], v70
    v_cvt_pk_bf16_f32 v112, v112, v113
    v_cvt_pk_bf16_f32 v113, v114, v115
    v_lshlrev_b32_sdwa v114, 3, v70 dst_sel:DWORD dst_unused:UNUSED_PAD src0_sel:DWORD src1_sel:WORD_1
    ds_write_b64 v114, v[112:113] offset:32896
    v_lshlrev_b32_sdwa v104, 3, v124 dst_sel:DWORD dst_unused:UNUSED_PAD src0_sel:DWORD src1_sel:WORD_0
    v_lshlrev_b32_sdwa v106, 3, v124 dst_sel:DWORD dst_unused:UNUSED_PAD src0_sel:DWORD src1_sel:WORD_1
    ds_read_b64 v[104:105], v104
    ds_read_b64 v[106:107], v106
    v_lshlrev_b32_sdwa v108, 3, v125 dst_sel:DWORD dst_unused:UNUSED_PAD src0_sel:DWORD src1_sel:WORD_0
    v_lshlrev_b32_sdwa v110, 3, v125 dst_sel:DWORD dst_unused:UNUSED_PAD src0_sel:DWORD src1_sel:WORD_1
    ds_read_b64 v[108:109], v108
    ds_read_b64 v[110:111], v110
    buffer_load_dwordx4 v[124:127], v71, s[12:15], s20 offen offset:1024 sc1
    s_waitcnt lgkmcnt(9)
    v_smfmac_f32_16x16x64_bf16 v[26:29], v[66:69], v[88:95], v70
    v_mfma_f32_16x16x32_bf16 v[112:115], v[72:75], v[160:163], 0
    s_waitcnt vmcnt(2)
    v_lshlrev_b32_sdwa v88, 3, v118 dst_sel:DWORD dst_unused:UNUSED_PAD src0_sel:DWORD src1_sel:WORD_0
    v_lshlrev_b32_sdwa v90, 3, v118 dst_sel:DWORD dst_unused:UNUSED_PAD src0_sel:DWORD src1_sel:WORD_1
    ds_read_b64 v[88:89], v88
    ds_read_b64 v[90:91], v90
    v_mfma_f32_16x16x32_bf16 v[112:115], v[76:79], v[164:167], v[112:115]
    v_lshlrev_b32_sdwa v92, 3, v119 dst_sel:DWORD dst_unused:UNUSED_PAD src0_sel:DWORD src1_sel:WORD_0
    v_lshlrev_b32_sdwa v94, 3, v119 dst_sel:DWORD dst_unused:UNUSED_PAD src0_sel:DWORD src1_sel:WORD_1
    v_cvt_pk_bf16_f32 v29, v28, v29
    v_cvt_pk_bf16_f32 v28, v26, v27
    v_and_b32 v27, s23, v25
    v_lshlrev_b32 v26, 16, v25
    v_and_b32 v25, s23, v24
    v_lshlrev_b32 v24, 16, v24
    ds_read_b64 v[92:93], v92
    ds_read_b64 v[94:95], v94
    s_waitcnt lgkmcnt(9)
    v_smfmac_f32_16x16x64_bf16 v[24:27], v[66:69], v[96:103], v70
    v_mfma_f32_16x16x32_bf16 v[112:115], v[80:83], v[168:171], v[112:115]
    v_lshlrev_b32_sdwa v96, 3, v116 dst_sel:DWORD dst_unused:UNUSED_PAD src0_sel:DWORD src1_sel:WORD_0
    v_lshlrev_b32_sdwa v98, 3, v116 dst_sel:DWORD dst_unused:UNUSED_PAD src0_sel:DWORD src1_sel:WORD_1
    ds_read_b64 v[96:97], v96
    ds_read_b64 v[98:99], v98
    v_mfma_f32_16x16x32_bf16 v[112:115], v[84:87], v[172:175], v[112:115]
    v_lshlrev_b32_sdwa v100, 3, v117 dst_sel:DWORD dst_unused:UNUSED_PAD src0_sel:DWORD src1_sel:WORD_0
    v_lshlrev_b32_sdwa v102, 3, v117 dst_sel:DWORD dst_unused:UNUSED_PAD src0_sel:DWORD src1_sel:WORD_1
    ds_read_b64 v[100:101], v100
    ds_read_b64 v[102:103], v102
    buffer_load_dwordx4 v[116:119], v71, s[12:15], s20 offen offset:0 sc1
    s_waitcnt lgkmcnt(8)
    v_smfmac_f32_16x16x64_bf16 v[24:27], v[66:69], v[104:111], v70
    s_nop 0
    v_cvt_pk_bf16_f32 v112, v112, v113
    v_cvt_pk_bf16_f32 v113, v114, v115
    v_lshlrev_b32_sdwa v114, 3, v70 dst_sel:DWORD dst_unused:UNUSED_PAD src0_sel:DWORD src1_sel:WORD_1
    ds_write_b64 v114, v[112:113] offset:33024
    s_waitcnt vmcnt(2)
    v_lshlrev_b32_sdwa v104, 3, v122 dst_sel:DWORD dst_unused:UNUSED_PAD src0_sel:DWORD src1_sel:WORD_0
    v_lshlrev_b32_sdwa v106, 3, v122 dst_sel:DWORD dst_unused:UNUSED_PAD src0_sel:DWORD src1_sel:WORD_1
    ds_read_b64 v[104:105], v104
    ds_read_b64 v[106:107], v106
    v_lshlrev_b32_sdwa v108, 3, v123 dst_sel:DWORD dst_unused:UNUSED_PAD src0_sel:DWORD src1_sel:WORD_0
    v_lshlrev_b32_sdwa v110, 3, v123 dst_sel:DWORD dst_unused:UNUSED_PAD src0_sel:DWORD src1_sel:WORD_1
    v_cvt_pk_bf16_f32 v27, v26, v27
    v_cvt_pk_bf16_f32 v26, v24, v25
    v_and_b32 v25, s23, v23
    v_lshlrev_b32 v24, 16, v23
    v_and_b32 v23, s23, v22
    v_lshlrev_b32 v22, 16, v22
    ds_read_b64 v[108:109], v108
    ds_read_b64 v[110:111], v110
    s_waitcnt lgkmcnt(9)
    v_smfmac_f32_16x16x64_bf16 v[22:25], v[66:69], v[88:95], v70
    v_mfma_f32_16x16x32_bf16 v[112:115], v[72:75], v[176:179], 0
    v_lshlrev_b32_sdwa v88, 3, v120 dst_sel:DWORD dst_unused:UNUSED_PAD src0_sel:DWORD src1_sel:WORD_0
    v_lshlrev_b32_sdwa v90, 3, v120 dst_sel:DWORD dst_unused:UNUSED_PAD src0_sel:DWORD src1_sel:WORD_1
    ds_read_b64 v[88:89], v88
    ds_read_b64 v[90:91], v90
    v_mfma_f32_16x16x32_bf16 v[112:115], v[76:79], v[180:183], v[112:115]
    v_lshlrev_b32_sdwa v92, 3, v121 dst_sel:DWORD dst_unused:UNUSED_PAD src0_sel:DWORD src1_sel:WORD_0
    v_lshlrev_b32_sdwa v94, 3, v121 dst_sel:DWORD dst_unused:UNUSED_PAD src0_sel:DWORD src1_sel:WORD_1
    ds_read_b64 v[92:93], v92
    ds_read_b64 v[94:95], v94
    s_add_u32 s20, s20, 0xfffff000
    buffer_load_dwordx4 v[120:123], v71, s[12:15], s20 offen offset:3072 sc1
    s_waitcnt lgkmcnt(9)
    v_smfmac_f32_16x16x64_bf16 v[22:25], v[66:69], v[96:103], v70
    v_mfma_f32_16x16x32_bf16 v[112:115], v[80:83], v[184:187], v[112:115]
    s_waitcnt vmcnt(2)
    v_lshlrev_b32_sdwa v96, 3, v126 dst_sel:DWORD dst_unused:UNUSED_PAD src0_sel:DWORD src1_sel:WORD_0
    v_lshlrev_b32_sdwa v98, 3, v126 dst_sel:DWORD dst_unused:UNUSED_PAD src0_sel:DWORD src1_sel:WORD_1
    ds_read_b64 v[96:97], v96
    ds_read_b64 v[98:99], v98
    v_mfma_f32_16x16x32_bf16 v[112:115], v[84:87], v[188:191], v[112:115]
    v_lshlrev_b32_sdwa v100, 3, v127 dst_sel:DWORD dst_unused:UNUSED_PAD src0_sel:DWORD src1_sel:WORD_0
    v_lshlrev_b32_sdwa v102, 3, v127 dst_sel:DWORD dst_unused:UNUSED_PAD src0_sel:DWORD src1_sel:WORD_1
    v_cvt_pk_bf16_f32 v25, v24, v25
    v_cvt_pk_bf16_f32 v24, v22, v23
    v_and_b32 v23, s23, v21
    v_lshlrev_b32 v22, 16, v21
    v_and_b32 v21, s23, v20
    v_lshlrev_b32 v20, 16, v20
    ds_read_b64 v[100:101], v100
    ds_read_b64 v[102:103], v102
    s_waitcnt lgkmcnt(8)
    v_smfmac_f32_16x16x64_bf16 v[20:23], v[66:69], v[104:111], v70
    v_cvt_pk_bf16_f32 v112, v112, v113
    v_cvt_pk_bf16_f32 v113, v114, v115
    v_lshlrev_b32_sdwa v114, 3, v70 dst_sel:DWORD dst_unused:UNUSED_PAD src0_sel:DWORD src1_sel:WORD_1
    ds_write_b64 v114, v[112:113] offset:33152
    v_lshlrev_b32_sdwa v104, 3, v124 dst_sel:DWORD dst_unused:UNUSED_PAD src0_sel:DWORD src1_sel:WORD_0
    v_lshlrev_b32_sdwa v106, 3, v124 dst_sel:DWORD dst_unused:UNUSED_PAD src0_sel:DWORD src1_sel:WORD_1
    ds_read_b64 v[104:105], v104
    ds_read_b64 v[106:107], v106
    v_lshlrev_b32_sdwa v108, 3, v125 dst_sel:DWORD dst_unused:UNUSED_PAD src0_sel:DWORD src1_sel:WORD_0
    v_lshlrev_b32_sdwa v110, 3, v125 dst_sel:DWORD dst_unused:UNUSED_PAD src0_sel:DWORD src1_sel:WORD_1
    ds_read_b64 v[108:109], v108
    ds_read_b64 v[110:111], v110
    buffer_load_dwordx4 v[124:127], v71, s[12:15], s20 offen offset:2048 sc1
    s_waitcnt lgkmcnt(9)
    v_smfmac_f32_16x16x64_bf16 v[20:23], v[66:69], v[88:95], v70
    v_mfma_f32_16x16x32_bf16 v[112:115], v[72:75], v[192:195], 0
    s_waitcnt vmcnt(2)
    v_lshlrev_b32_sdwa v88, 3, v118 dst_sel:DWORD dst_unused:UNUSED_PAD src0_sel:DWORD src1_sel:WORD_0
    v_lshlrev_b32_sdwa v90, 3, v118 dst_sel:DWORD dst_unused:UNUSED_PAD src0_sel:DWORD src1_sel:WORD_1
    ds_read_b64 v[88:89], v88
    ds_read_b64 v[90:91], v90
    v_mfma_f32_16x16x32_bf16 v[112:115], v[76:79], v[196:199], v[112:115]
    v_lshlrev_b32_sdwa v92, 3, v119 dst_sel:DWORD dst_unused:UNUSED_PAD src0_sel:DWORD src1_sel:WORD_0
    v_lshlrev_b32_sdwa v94, 3, v119 dst_sel:DWORD dst_unused:UNUSED_PAD src0_sel:DWORD src1_sel:WORD_1
    v_cvt_pk_bf16_f32 v23, v22, v23
    v_cvt_pk_bf16_f32 v22, v20, v21
    v_and_b32 v21, s23, v19
    v_lshlrev_b32 v20, 16, v19
    v_and_b32 v19, s23, v18
    v_lshlrev_b32 v18, 16, v18
    ds_read_b64 v[92:93], v92
    ds_read_b64 v[94:95], v94
    s_waitcnt lgkmcnt(9)
    v_smfmac_f32_16x16x64_bf16 v[18:21], v[66:69], v[96:103], v70
    v_mfma_f32_16x16x32_bf16 v[112:115], v[80:83], v[200:203], v[112:115]
    v_lshlrev_b32_sdwa v96, 3, v116 dst_sel:DWORD dst_unused:UNUSED_PAD src0_sel:DWORD src1_sel:WORD_0
    v_lshlrev_b32_sdwa v98, 3, v116 dst_sel:DWORD dst_unused:UNUSED_PAD src0_sel:DWORD src1_sel:WORD_1
    ds_read_b64 v[96:97], v96
    ds_read_b64 v[98:99], v98
    v_mfma_f32_16x16x32_bf16 v[112:115], v[84:87], v[204:207], v[112:115]
    v_lshlrev_b32_sdwa v100, 3, v117 dst_sel:DWORD dst_unused:UNUSED_PAD src0_sel:DWORD src1_sel:WORD_0
    v_lshlrev_b32_sdwa v102, 3, v117 dst_sel:DWORD dst_unused:UNUSED_PAD src0_sel:DWORD src1_sel:WORD_1
    ds_read_b64 v[100:101], v100
    ds_read_b64 v[102:103], v102
    buffer_load_dwordx4 v[116:119], v71, s[12:15], s20 offen offset:1024 sc1
    s_waitcnt lgkmcnt(8)
    v_smfmac_f32_16x16x64_bf16 v[18:21], v[66:69], v[104:111], v70
    s_nop 0
    v_cvt_pk_bf16_f32 v112, v112, v113
    v_cvt_pk_bf16_f32 v113, v114, v115
    v_lshlrev_b32_sdwa v114, 3, v70 dst_sel:DWORD dst_unused:UNUSED_PAD src0_sel:DWORD src1_sel:WORD_1
    ds_write_b64 v114, v[112:113] offset:33280
    s_waitcnt vmcnt(2)
    v_lshlrev_b32_sdwa v104, 3, v122 dst_sel:DWORD dst_unused:UNUSED_PAD src0_sel:DWORD src1_sel:WORD_0
    v_lshlrev_b32_sdwa v106, 3, v122 dst_sel:DWORD dst_unused:UNUSED_PAD src0_sel:DWORD src1_sel:WORD_1
    ds_read_b64 v[104:105], v104
    ds_read_b64 v[106:107], v106
    v_lshlrev_b32_sdwa v108, 3, v123 dst_sel:DWORD dst_unused:UNUSED_PAD src0_sel:DWORD src1_sel:WORD_0
    v_lshlrev_b32_sdwa v110, 3, v123 dst_sel:DWORD dst_unused:UNUSED_PAD src0_sel:DWORD src1_sel:WORD_1
    v_cvt_pk_bf16_f32 v21, v20, v21
    v_cvt_pk_bf16_f32 v20, v18, v19
    v_and_b32 v19, s23, v17
    v_lshlrev_b32 v18, 16, v17
    v_and_b32 v17, s23, v16
    v_lshlrev_b32 v16, 16, v16
    ds_read_b64 v[108:109], v108
    ds_read_b64 v[110:111], v110
    s_waitcnt lgkmcnt(9)
    v_smfmac_f32_16x16x64_bf16 v[16:19], v[66:69], v[88:95], v70
    s_setprio 2
    v_mfma_f32_16x16x32_bf16 v[112:115], v[72:75], v[208:211], 0
    v_lshlrev_b32_sdwa v88, 3, v120 dst_sel:DWORD dst_unused:UNUSED_PAD src0_sel:DWORD src1_sel:WORD_0
    v_lshlrev_b32_sdwa v90, 3, v120 dst_sel:DWORD dst_unused:UNUSED_PAD src0_sel:DWORD src1_sel:WORD_1
    ds_read_b64 v[88:89], v88
    ds_read_b64 v[90:91], v90
    v_mfma_f32_16x16x32_bf16 v[112:115], v[76:79], v[212:215], v[112:115]
    v_lshlrev_b32_sdwa v92, 3, v121 dst_sel:DWORD dst_unused:UNUSED_PAD src0_sel:DWORD src1_sel:WORD_0
    v_lshlrev_b32_sdwa v94, 3, v121 dst_sel:DWORD dst_unused:UNUSED_PAD src0_sel:DWORD src1_sel:WORD_1
    ds_read_b64 v[92:93], v92
    ds_read_b64 v[94:95], v94
    buffer_load_dwordx4 v[120:123], v71, s[12:15], s20 offen offset:0 sc1
    s_waitcnt lgkmcnt(9)
    v_smfmac_f32_16x16x64_bf16 v[16:19], v[66:69], v[96:103], v70
    v_mfma_f32_16x16x32_bf16 v[112:115], v[80:83], v[216:219], v[112:115]
    s_waitcnt vmcnt(2)
    v_lshlrev_b32_sdwa v96, 3, v126 dst_sel:DWORD dst_unused:UNUSED_PAD src0_sel:DWORD src1_sel:WORD_0
    v_lshlrev_b32_sdwa v98, 3, v126 dst_sel:DWORD dst_unused:UNUSED_PAD src0_sel:DWORD src1_sel:WORD_1
    ds_read_b64 v[96:97], v96
    ds_read_b64 v[98:99], v98
    v_mfma_f32_16x16x32_bf16 v[112:115], v[84:87], v[220:223], v[112:115]
    v_lshlrev_b32_sdwa v100, 3, v127 dst_sel:DWORD dst_unused:UNUSED_PAD src0_sel:DWORD src1_sel:WORD_0
    v_lshlrev_b32_sdwa v102, 3, v127 dst_sel:DWORD dst_unused:UNUSED_PAD src0_sel:DWORD src1_sel:WORD_1
    v_cvt_pk_bf16_f32 v19, v18, v19
    v_cvt_pk_bf16_f32 v18, v16, v17
    v_and_b32 v17, s23, v15
    v_lshlrev_b32 v16, 16, v15
    v_and_b32 v15, s23, v14
    v_lshlrev_b32 v14, 16, v14
    ds_read_b64 v[100:101], v100
    ds_read_b64 v[102:103], v102
    s_waitcnt lgkmcnt(8)
    v_smfmac_f32_16x16x64_bf16 v[14:17], v[66:69], v[104:111], v70
    v_cvt_pk_bf16_f32 v112, v112, v113
    v_cvt_pk_bf16_f32 v113, v114, v115
    v_lshlrev_b32_sdwa v114, 3, v70 dst_sel:DWORD dst_unused:UNUSED_PAD src0_sel:DWORD src1_sel:WORD_1
    ds_write_b64 v114, v[112:113] offset:33408
    v_lshlrev_b32_sdwa v104, 3, v124 dst_sel:DWORD dst_unused:UNUSED_PAD src0_sel:DWORD src1_sel:WORD_0
    v_lshlrev_b32_sdwa v106, 3, v124 dst_sel:DWORD dst_unused:UNUSED_PAD src0_sel:DWORD src1_sel:WORD_1
    ds_read_b64 v[104:105], v104
    ds_read_b64 v[106:107], v106
    v_lshlrev_b32_sdwa v108, 3, v125 dst_sel:DWORD dst_unused:UNUSED_PAD src0_sel:DWORD src1_sel:WORD_0
    v_lshlrev_b32_sdwa v110, 3, v125 dst_sel:DWORD dst_unused:UNUSED_PAD src0_sel:DWORD src1_sel:WORD_1
    ds_read_b64 v[108:109], v108
    ds_read_b64 v[110:111], v110
    s_add_u32 s20, s20, 0xfffff000
    buffer_load_dwordx4 v[124:127], v71, s[12:15], s20 offen offset:3072 sc1
    s_waitcnt lgkmcnt(9)
    v_smfmac_f32_16x16x64_bf16 v[14:17], v[66:69], v[88:95], v70
    v_mfma_f32_16x16x32_bf16 v[112:115], v[72:75], v[224:227], 0
    s_waitcnt vmcnt(2)
    v_lshlrev_b32_sdwa v88, 3, v118 dst_sel:DWORD dst_unused:UNUSED_PAD src0_sel:DWORD src1_sel:WORD_0
    v_lshlrev_b32_sdwa v90, 3, v118 dst_sel:DWORD dst_unused:UNUSED_PAD src0_sel:DWORD src1_sel:WORD_1
    ds_read_b64 v[88:89], v88
    ds_read_b64 v[90:91], v90
    v_mfma_f32_16x16x32_bf16 v[112:115], v[76:79], v[228:231], v[112:115]
    v_lshlrev_b32_sdwa v92, 3, v119 dst_sel:DWORD dst_unused:UNUSED_PAD src0_sel:DWORD src1_sel:WORD_0
    v_lshlrev_b32_sdwa v94, 3, v119 dst_sel:DWORD dst_unused:UNUSED_PAD src0_sel:DWORD src1_sel:WORD_1
    v_cvt_pk_bf16_f32 v17, v16, v17
    v_cvt_pk_bf16_f32 v16, v14, v15
    v_and_b32 v15, s23, v13
    v_lshlrev_b32 v14, 16, v13
    v_and_b32 v13, s23, v12
    v_lshlrev_b32 v12, 16, v12
    ds_read_b64 v[92:93], v92
    ds_read_b64 v[94:95], v94
    s_waitcnt lgkmcnt(9)
    v_smfmac_f32_16x16x64_bf16 v[12:15], v[66:69], v[96:103], v70
    v_mfma_f32_16x16x32_bf16 v[112:115], v[80:83], v[232:235], v[112:115]
    v_lshlrev_b32_sdwa v96, 3, v116 dst_sel:DWORD dst_unused:UNUSED_PAD src0_sel:DWORD src1_sel:WORD_0
    v_lshlrev_b32_sdwa v98, 3, v116 dst_sel:DWORD dst_unused:UNUSED_PAD src0_sel:DWORD src1_sel:WORD_1
    ds_read_b64 v[96:97], v96
    ds_read_b64 v[98:99], v98
    v_mfma_f32_16x16x32_bf16 v[112:115], v[84:87], v[236:239], v[112:115]
    v_lshlrev_b32_sdwa v100, 3, v117 dst_sel:DWORD dst_unused:UNUSED_PAD src0_sel:DWORD src1_sel:WORD_0
    v_lshlrev_b32_sdwa v102, 3, v117 dst_sel:DWORD dst_unused:UNUSED_PAD src0_sel:DWORD src1_sel:WORD_1
    ds_read_b64 v[100:101], v100
    ds_read_b64 v[102:103], v102
    buffer_load_dwordx4 v[116:119], v71, s[12:15], s20 offen offset:2048 sc1
    s_waitcnt lgkmcnt(8)
    v_smfmac_f32_16x16x64_bf16 v[12:15], v[66:69], v[104:111], v70
    s_nop 0
    v_cvt_pk_bf16_f32 v112, v112, v113
    v_cvt_pk_bf16_f32 v113, v114, v115
    v_lshlrev_b32_sdwa v114, 3, v70 dst_sel:DWORD dst_unused:UNUSED_PAD src0_sel:DWORD src1_sel:WORD_1
    ds_write_b64 v114, v[112:113] offset:33536
    s_waitcnt vmcnt(2)
    v_lshlrev_b32_sdwa v104, 3, v122 dst_sel:DWORD dst_unused:UNUSED_PAD src0_sel:DWORD src1_sel:WORD_0
    v_lshlrev_b32_sdwa v106, 3, v122 dst_sel:DWORD dst_unused:UNUSED_PAD src0_sel:DWORD src1_sel:WORD_1
    ds_read_b64 v[104:105], v104
    ds_read_b64 v[106:107], v106
    v_lshlrev_b32_sdwa v108, 3, v123 dst_sel:DWORD dst_unused:UNUSED_PAD src0_sel:DWORD src1_sel:WORD_0
    v_lshlrev_b32_sdwa v110, 3, v123 dst_sel:DWORD dst_unused:UNUSED_PAD src0_sel:DWORD src1_sel:WORD_1
    v_cvt_pk_bf16_f32 v15, v14, v15
    v_cvt_pk_bf16_f32 v14, v12, v13
    v_and_b32 v13, s23, v11
    v_lshlrev_b32 v12, 16, v11
    v_and_b32 v11, s23, v10
    v_lshlrev_b32 v10, 16, v10
    ds_read_b64 v[108:109], v108
    ds_read_b64 v[110:111], v110
    s_waitcnt lgkmcnt(9)
    v_smfmac_f32_16x16x64_bf16 v[10:13], v[66:69], v[88:95], v70
    v_mfma_f32_16x16x32_bf16 v[112:115], v[72:75], v[240:243], 0
    buffer_load_dwordx4 v[72:75], v71, s[12:15], s21 offen offset:0
    v_lshlrev_b32_sdwa v88, 3, v120 dst_sel:DWORD dst_unused:UNUSED_PAD src0_sel:DWORD src1_sel:WORD_0
    v_lshlrev_b32_sdwa v90, 3, v120 dst_sel:DWORD dst_unused:UNUSED_PAD src0_sel:DWORD src1_sel:WORD_1
    ds_read_b64 v[88:89], v88
    ds_read_b64 v[90:91], v90
    v_mfma_f32_16x16x32_bf16 v[112:115], v[76:79], v[244:247], v[112:115]
    buffer_load_dwordx4 v[76:79], v71, s[12:15], s21 offen offset:1024
    v_lshlrev_b32_sdwa v92, 3, v121 dst_sel:DWORD dst_unused:UNUSED_PAD src0_sel:DWORD src1_sel:WORD_0
    v_lshlrev_b32_sdwa v94, 3, v121 dst_sel:DWORD dst_unused:UNUSED_PAD src0_sel:DWORD src1_sel:WORD_1
    ds_read_b64 v[92:93], v92
    ds_read_b64 v[94:95], v94
    buffer_load_dwordx4 v[120:123], v71, s[12:15], s20 offen offset:1024 sc1
    s_waitcnt lgkmcnt(9)
    v_smfmac_f32_16x16x64_bf16 v[10:13], v[66:69], v[96:103], v70
    v_mfma_f32_16x16x32_bf16 v[112:115], v[80:83], v[248:251], v[112:115]
    buffer_load_dwordx4 v[80:83], v71, s[12:15], s19 offen offset:0
    s_waitcnt vmcnt(5)
    v_lshlrev_b32_sdwa v96, 3, v126 dst_sel:DWORD dst_unused:UNUSED_PAD src0_sel:DWORD src1_sel:WORD_0
    v_lshlrev_b32_sdwa v98, 3, v126 dst_sel:DWORD dst_unused:UNUSED_PAD src0_sel:DWORD src1_sel:WORD_1
    ds_read_b64 v[96:97], v96
    ds_read_b64 v[98:99], v98
    v_mfma_f32_16x16x32_bf16 v[112:115], v[84:87], v[252:255], v[112:115]
    buffer_load_dwordx4 v[84:87], v71, s[12:15], s19 offen offset:1024
    s_add_u32 s21, s21, 4096
    s_add_u32 s19, s19, 4096
    v_lshlrev_b32_sdwa v100, 3, v127 dst_sel:DWORD dst_unused:UNUSED_PAD src0_sel:DWORD src1_sel:WORD_0
    v_lshlrev_b32_sdwa v102, 3, v127 dst_sel:DWORD dst_unused:UNUSED_PAD src0_sel:DWORD src1_sel:WORD_1
    v_cvt_pk_bf16_f32 v13, v12, v13
    v_cvt_pk_bf16_f32 v12, v10, v11
    v_and_b32 v11, s23, v9
    v_lshlrev_b32 v10, 16, v9
    v_and_b32 v9, s23, v8
    v_lshlrev_b32 v8, 16, v8
    ds_read_b64 v[100:101], v100
    ds_read_b64 v[102:103], v102
    s_waitcnt lgkmcnt(8)
    v_smfmac_f32_16x16x64_bf16 v[8:11], v[66:69], v[104:111], v70
    v_cvt_pk_bf16_f32 v112, v112, v113
    v_cvt_pk_bf16_f32 v113, v114, v115
    v_lshlrev_b32_sdwa v114, 3, v70 dst_sel:DWORD dst_unused:UNUSED_PAD src0_sel:DWORD src1_sel:WORD_1
    ds_write_b64 v114, v[112:113] offset:33664
    s_setprio 1
    v_lshlrev_b32_sdwa v104, 3, v124 dst_sel:DWORD dst_unused:UNUSED_PAD src0_sel:DWORD src1_sel:WORD_0
    v_lshlrev_b32_sdwa v106, 3, v124 dst_sel:DWORD dst_unused:UNUSED_PAD src0_sel:DWORD src1_sel:WORD_1
    ds_read_b64 v[104:105], v104
    ds_read_b64 v[106:107], v106
    v_lshlrev_b32_sdwa v108, 3, v125 dst_sel:DWORD dst_unused:UNUSED_PAD src0_sel:DWORD src1_sel:WORD_0
    v_lshlrev_b32_sdwa v110, 3, v125 dst_sel:DWORD dst_unused:UNUSED_PAD src0_sel:DWORD src1_sel:WORD_1
    ds_read_b64 v[108:109], v108
    ds_read_b64 v[110:111], v110
    s_add_u32 s20, s20, 0x4000
    buffer_load_dwordx4 v[124:127], v71, s[12:15], s20 offen offset:0 sc1
    s_waitcnt lgkmcnt(9)
    v_smfmac_f32_16x16x64_bf16 v[8:11], v[66:69], v[88:95], v70
    s_waitcnt vmcnt(6)
    v_lshlrev_b32_sdwa v88, 3, v118 dst_sel:DWORD dst_unused:UNUSED_PAD src0_sel:DWORD src1_sel:WORD_0
    v_lshlrev_b32_sdwa v90, 3, v118 dst_sel:DWORD dst_unused:UNUSED_PAD src0_sel:DWORD src1_sel:WORD_1
    ds_read_b64 v[88:89], v88
    ds_read_b64 v[90:91], v90
    v_lshlrev_b32_sdwa v92, 3, v119 dst_sel:DWORD dst_unused:UNUSED_PAD src0_sel:DWORD src1_sel:WORD_0
    v_lshlrev_b32_sdwa v94, 3, v119 dst_sel:DWORD dst_unused:UNUSED_PAD src0_sel:DWORD src1_sel:WORD_1
    s_nop 0
    v_cvt_pk_bf16_f32 v11, v10, v11
    v_cvt_pk_bf16_f32 v10, v8, v9
    v_and_b32 v9, s23, v7
    v_lshlrev_b32 v8, 16, v7
    v_and_b32 v7, s23, v6
    v_lshlrev_b32 v6, 16, v6
    ds_read_b64 v[92:93], v92
    ds_read_b64 v[94:95], v94
    s_waitcnt lgkmcnt(9)
    v_smfmac_f32_16x16x64_bf16 v[6:9], v[66:69], v[96:103], v70
    v_lshlrev_b32_sdwa v96, 3, v116 dst_sel:DWORD dst_unused:UNUSED_PAD src0_sel:DWORD src1_sel:WORD_0
    v_lshlrev_b32_sdwa v98, 3, v116 dst_sel:DWORD dst_unused:UNUSED_PAD src0_sel:DWORD src1_sel:WORD_1
    ds_read_b64 v[96:97], v96
    ds_read_b64 v[98:99], v98
    v_lshlrev_b32_sdwa v100, 3, v117 dst_sel:DWORD dst_unused:UNUSED_PAD src0_sel:DWORD src1_sel:WORD_0
    v_lshlrev_b32_sdwa v102, 3, v117 dst_sel:DWORD dst_unused:UNUSED_PAD src0_sel:DWORD src1_sel:WORD_1
    ds_read_b64 v[100:101], v100
    ds_read_b64 v[102:103], v102
    s_add_u32 s20, s20, 0x1f000
    buffer_load_dwordx4 v[116:119], v71, s[12:15], s20 offen offset:3072 sc1
    s_waitcnt lgkmcnt(8)
    v_smfmac_f32_16x16x64_bf16 v[6:9], v[66:69], v[104:111], v70
    s_waitcnt vmcnt(4)
    v_lshlrev_b32_sdwa v104, 3, v122 dst_sel:DWORD dst_unused:UNUSED_PAD src0_sel:DWORD src1_sel:WORD_0
    v_lshlrev_b32_sdwa v106, 3, v122 dst_sel:DWORD dst_unused:UNUSED_PAD src0_sel:DWORD src1_sel:WORD_1
    ds_read_b64 v[104:105], v104
    ds_read_b64 v[106:107], v106
    v_lshlrev_b32_sdwa v108, 3, v123 dst_sel:DWORD dst_unused:UNUSED_PAD src0_sel:DWORD src1_sel:WORD_0
    v_lshlrev_b32_sdwa v110, 3, v123 dst_sel:DWORD dst_unused:UNUSED_PAD src0_sel:DWORD src1_sel:WORD_1
    s_nop 0
    v_cvt_pk_bf16_f32 v9, v8, v9
    v_cvt_pk_bf16_f32 v8, v6, v7
    v_and_b32 v7, s23, v5
    v_lshlrev_b32 v6, 16, v5
    v_and_b32 v5, s23, v4
    v_lshlrev_b32 v4, 16, v4
    ds_read_b64 v[108:109], v108
    ds_read_b64 v[110:111], v110
    s_waitcnt lgkmcnt(8)
    v_smfmac_f32_16x16x64_bf16 v[4:7], v[66:69], v[88:95], v70
    v_lshlrev_b32_sdwa v88, 3, v120 dst_sel:DWORD dst_unused:UNUSED_PAD src0_sel:DWORD src1_sel:WORD_0
    v_lshlrev_b32_sdwa v90, 3, v120 dst_sel:DWORD dst_unused:UNUSED_PAD src0_sel:DWORD src1_sel:WORD_1
    ds_read_b64 v[88:89], v88
    ds_read_b64 v[90:91], v90
    v_lshlrev_b32_sdwa v92, 3, v121 dst_sel:DWORD dst_unused:UNUSED_PAD src0_sel:DWORD src1_sel:WORD_0
    v_lshlrev_b32_sdwa v94, 3, v121 dst_sel:DWORD dst_unused:UNUSED_PAD src0_sel:DWORD src1_sel:WORD_1
    ds_read_b64 v[92:93], v92
    ds_read_b64 v[94:95], v94
    buffer_load_dwordx4 v[120:123], v71, s[12:15], s20 offen offset:2048 sc1
    s_waitcnt lgkmcnt(8)
    v_smfmac_f32_16x16x64_bf16 v[4:7], v[66:69], v[96:103], v70
    s_waitcnt vmcnt(2)
    v_lshlrev_b32_sdwa v96, 3, v126 dst_sel:DWORD dst_unused:UNUSED_PAD src0_sel:DWORD src1_sel:WORD_0
    v_lshlrev_b32_sdwa v98, 3, v126 dst_sel:DWORD dst_unused:UNUSED_PAD src0_sel:DWORD src1_sel:WORD_1
    ds_read_b64 v[96:97], v96
    ds_read_b64 v[98:99], v98
    v_lshlrev_b32_sdwa v100, 3, v127 dst_sel:DWORD dst_unused:UNUSED_PAD src0_sel:DWORD src1_sel:WORD_0
    v_lshlrev_b32_sdwa v102, 3, v127 dst_sel:DWORD dst_unused:UNUSED_PAD src0_sel:DWORD src1_sel:WORD_1
    s_nop 0
    v_cvt_pk_bf16_f32 v7, v6, v7
    v_cvt_pk_bf16_f32 v6, v4, v5
    v_and_b32 v5, s23, v3
    v_lshlrev_b32 v4, 16, v3
    v_and_b32 v3, s23, v2
    v_lshlrev_b32 v2, 16, v2
    ds_read_b64 v[100:101], v100
    ds_read_b64 v[102:103], v102
    s_waitcnt lgkmcnt(8)
    v_smfmac_f32_16x16x64_bf16 v[2:5], v[66:69], v[104:111], v70
    s_setprio 0
    v_lshlrev_b32_sdwa v104, 3, v124 dst_sel:DWORD dst_unused:UNUSED_PAD src0_sel:DWORD src1_sel:WORD_0
    v_lshlrev_b32_sdwa v106, 3, v124 dst_sel:DWORD dst_unused:UNUSED_PAD src0_sel:DWORD src1_sel:WORD_1
    ds_read_b64 v[104:105], v104
    ds_read_b64 v[106:107], v106
    v_lshlrev_b32_sdwa v108, 3, v125 dst_sel:DWORD dst_unused:UNUSED_PAD src0_sel:DWORD src1_sel:WORD_0
    v_lshlrev_b32_sdwa v110, 3, v125 dst_sel:DWORD dst_unused:UNUSED_PAD src0_sel:DWORD src1_sel:WORD_1
    ds_read_b64 v[108:109], v108
    ds_read_b64 v[110:111], v110
    buffer_load_dwordx4 v[124:127], v71, s[12:15], s20 offen offset:1024 sc1
    s_waitcnt lgkmcnt(8)
    v_smfmac_f32_16x16x64_bf16 v[2:5], v[66:69], v[88:95], v70
    s_waitcnt vmcnt(2)
    v_lshlrev_b32_sdwa v88, 3, v116 dst_sel:DWORD dst_unused:UNUSED_PAD src0_sel:DWORD src1_sel:WORD_0
    v_lshlrev_b32_sdwa v90, 3, v116 dst_sel:DWORD dst_unused:UNUSED_PAD src0_sel:DWORD src1_sel:WORD_1
    ds_read_b64 v[88:89], v88
    ds_read_b64 v[90:91], v90
    v_lshlrev_b32_sdwa v92, 3, v117 dst_sel:DWORD dst_unused:UNUSED_PAD src0_sel:DWORD src1_sel:WORD_0
    v_lshlrev_b32_sdwa v94, 3, v117 dst_sel:DWORD dst_unused:UNUSED_PAD src0_sel:DWORD src1_sel:WORD_1
    s_nop 0
    v_cvt_pk_bf16_f32 v5, v4, v5
    v_cvt_pk_bf16_f32 v4, v2, v3
    v_and_b32 v3, s23, v1
    v_lshlrev_b32 v2, 16, v1
    v_and_b32 v1, s23, v0
    v_lshlrev_b32 v0, 16, v0
    ds_read_b64 v[92:93], v92
    ds_read_b64 v[94:95], v94
    s_waitcnt lgkmcnt(8)
    v_smfmac_f32_16x16x64_bf16 v[0:3], v[66:69], v[96:103], v70
    s_barrier
    s_setprio 3
    v_lshlrev_b32_sdwa v96, 3, v118 dst_sel:DWORD dst_unused:UNUSED_PAD src0_sel:DWORD src1_sel:WORD_0
    v_lshlrev_b32_sdwa v98, 3, v118 dst_sel:DWORD dst_unused:UNUSED_PAD src0_sel:DWORD src1_sel:WORD_1
    ds_read_b64 v[96:97], v96
    ds_read_b64 v[98:99], v98
    v_lshlrev_b32_sdwa v100, 3, v119 dst_sel:DWORD dst_unused:UNUSED_PAD src0_sel:DWORD src1_sel:WORD_0
    v_lshlrev_b32_sdwa v102, 3, v119 dst_sel:DWORD dst_unused:UNUSED_PAD src0_sel:DWORD src1_sel:WORD_1
    ds_read_b64 v[100:101], v100
    ds_read_b64 v[102:103], v102
    buffer_load_dwordx4 v[116:119], v71, s[12:15], s20 offen offset:0 sc1
    s_waitcnt lgkmcnt(8)
    v_smfmac_f32_16x16x64_bf16 v[0:3], v[66:69], v[104:111], v70
    v_mfma_f32_16x16x32_bf16 v[112:115], v[72:75], v[128:131], 0
    s_waitcnt vmcnt(2)
    v_lshlrev_b32_sdwa v104, 3, v120 dst_sel:DWORD dst_unused:UNUSED_PAD src0_sel:DWORD src1_sel:WORD_0
    v_lshlrev_b32_sdwa v106, 3, v120 dst_sel:DWORD dst_unused:UNUSED_PAD src0_sel:DWORD src1_sel:WORD_1
    ds_read_b64 v[104:105], v104
    ds_read_b64 v[106:107], v106
    v_mfma_f32_16x16x32_bf16 v[112:115], v[76:79], v[132:135], v[112:115]
    v_add_u32 v70, 0x20000000, v70
    v_lshlrev_b32_sdwa v108, 3, v121 dst_sel:DWORD dst_unused:UNUSED_PAD src0_sel:DWORD src1_sel:WORD_0
    v_lshlrev_b32_sdwa v110, 3, v121 dst_sel:DWORD dst_unused:UNUSED_PAD src0_sel:DWORD src1_sel:WORD_1
    v_cvt_pk_bf16_f32 v3, v2, v3
    v_cvt_pk_bf16_f32 v2, v0, v1
    v_mov_b64 v[0:1], v[32:33]
    v_lshlrev_b32 v32, 16, v34
    v_and_b32 v33, s23, v34
    v_lshlrev_b32 v34, 16, v35
    v_and_b32 v35, s23, v35
    ds_read_b64 v[108:109], v108
    ds_read_b64 v[110:111], v110
    s_waitcnt lgkmcnt(8)
    v_smfmac_f32_16x16x64_bf16 v[32:35], v[66:69], v[88:95], v70
    v_mfma_f32_16x16x32_bf16 v[112:115], v[80:83], v[136:139], v[112:115]
    v_lshlrev_b32_sdwa v88, 3, v122 dst_sel:DWORD dst_unused:UNUSED_PAD src0_sel:DWORD src1_sel:WORD_0
    v_lshlrev_b32_sdwa v90, 3, v122 dst_sel:DWORD dst_unused:UNUSED_PAD src0_sel:DWORD src1_sel:WORD_1
    ds_read_b64 v[88:89], v88
    ds_read_b64 v[90:91], v90
    v_mfma_f32_16x16x32_bf16 v[112:115], v[84:87], v[140:143], v[112:115]
    v_lshlrev_b32_sdwa v92, 3, v123 dst_sel:DWORD dst_unused:UNUSED_PAD src0_sel:DWORD src1_sel:WORD_0
    v_lshlrev_b32_sdwa v94, 3, v123 dst_sel:DWORD dst_unused:UNUSED_PAD src0_sel:DWORD src1_sel:WORD_1
    ds_read_b64 v[92:93], v92
    ds_read_b64 v[94:95], v94
    s_add_u32 s20, s20, 0xfffff000
    buffer_load_dwordx4 v[120:123], v71, s[12:15], s20 offen offset:3072 sc1
    s_waitcnt lgkmcnt(8)
    v_smfmac_f32_16x16x64_bf16 v[32:35], v[66:69], v[96:103], v70
    v_cvt_pk_bf16_f32 v112, v112, v113
    v_cvt_pk_bf16_f32 v113, v114, v115
    v_lshlrev_b32_sdwa v114, 3, v70 dst_sel:DWORD dst_unused:UNUSED_PAD src0_sel:DWORD src1_sel:WORD_1
    ds_write_b64 v114, v[112:113] offset:0
    s_waitcnt vmcnt(2)
    v_lshlrev_b32_sdwa v96, 3, v124 dst_sel:DWORD dst_unused:UNUSED_PAD src0_sel:DWORD src1_sel:WORD_0
    v_lshlrev_b32_sdwa v98, 3, v124 dst_sel:DWORD dst_unused:UNUSED_PAD src0_sel:DWORD src1_sel:WORD_1
    ds_read_b64 v[96:97], v96
    ds_read_b64 v[98:99], v98
    v_lshlrev_b32_sdwa v100, 3, v125 dst_sel:DWORD dst_unused:UNUSED_PAD src0_sel:DWORD src1_sel:WORD_0
    v_lshlrev_b32_sdwa v102, 3, v125 dst_sel:DWORD dst_unused:UNUSED_PAD src0_sel:DWORD src1_sel:WORD_1
    v_cvt_pk_bf16_f32 v32, v32, v33
    v_cvt_pk_bf16_f32 v33, v34, v35
    v_lshlrev_b32 v34, 16, v36
    v_and_b32 v35, s23, v36
    v_lshlrev_b32 v36, 16, v37
    v_and_b32 v37, s23, v37
    ds_read_b64 v[100:101], v100
    ds_read_b64 v[102:103], v102
    s_waitcnt lgkmcnt(9)
    v_smfmac_f32_16x16x64_bf16 v[34:37], v[66:69], v[104:111], v70
    v_mfma_f32_16x16x32_bf16 v[112:115], v[72:75], v[144:147], 0
    v_lshlrev_b32_sdwa v104, 3, v126 dst_sel:DWORD dst_unused:UNUSED_PAD src0_sel:DWORD src1_sel:WORD_0
    v_lshlrev_b32_sdwa v106, 3, v126 dst_sel:DWORD dst_unused:UNUSED_PAD src0_sel:DWORD src1_sel:WORD_1
    ds_read_b64 v[104:105], v104
    ds_read_b64 v[106:107], v106
    v_mfma_f32_16x16x32_bf16 v[112:115], v[76:79], v[148:151], v[112:115]
    v_lshlrev_b32_sdwa v108, 3, v127 dst_sel:DWORD dst_unused:UNUSED_PAD src0_sel:DWORD src1_sel:WORD_0
    v_lshlrev_b32_sdwa v110, 3, v127 dst_sel:DWORD dst_unused:UNUSED_PAD src0_sel:DWORD src1_sel:WORD_1
    ds_read_b64 v[108:109], v108
    ds_read_b64 v[110:111], v110
    buffer_load_dwordx4 v[124:127], v71, s[12:15], s20 offen offset:2048 sc1
    s_waitcnt lgkmcnt(9)
    v_smfmac_f32_16x16x64_bf16 v[34:37], v[66:69], v[88:95], v70
    v_mfma_f32_16x16x32_bf16 v[112:115], v[80:83], v[152:155], v[112:115]
    s_waitcnt vmcnt(2)
    v_lshlrev_b32_sdwa v88, 3, v116 dst_sel:DWORD dst_unused:UNUSED_PAD src0_sel:DWORD src1_sel:WORD_0
    v_lshlrev_b32_sdwa v90, 3, v116 dst_sel:DWORD dst_unused:UNUSED_PAD src0_sel:DWORD src1_sel:WORD_1
    ds_read_b64 v[88:89], v88
    ds_read_b64 v[90:91], v90
    v_mfma_f32_16x16x32_bf16 v[112:115], v[84:87], v[156:159], v[112:115]
    v_lshlrev_b32_sdwa v92, 3, v117 dst_sel:DWORD dst_unused:UNUSED_PAD src0_sel:DWORD src1_sel:WORD_0
    v_lshlrev_b32_sdwa v94, 3, v117 dst_sel:DWORD dst_unused:UNUSED_PAD src0_sel:DWORD src1_sel:WORD_1
    v_cvt_pk_bf16_f32 v34, v34, v35
    v_cvt_pk_bf16_f32 v35, v36, v37
    v_lshlrev_b32 v36, 16, v38
    v_and_b32 v37, s23, v38
    v_lshlrev_b32 v38, 16, v39
    v_and_b32 v39, s23, v39
    ds_read_b64 v[92:93], v92
    ds_read_b64 v[94:95], v94
    s_waitcnt lgkmcnt(8)
    v_smfmac_f32_16x16x64_bf16 v[36:39], v[66:69], v[96:103], v70
    v_cvt_pk_bf16_f32 v112, v112, v113
    v_cvt_pk_bf16_f32 v113, v114, v115
    v_lshlrev_b32_sdwa v114, 3, v70 dst_sel:DWORD dst_unused:UNUSED_PAD src0_sel:DWORD src1_sel:WORD_1
    ds_write_b64 v114, v[112:113] offset:128
    v_lshlrev_b32_sdwa v96, 3, v118 dst_sel:DWORD dst_unused:UNUSED_PAD src0_sel:DWORD src1_sel:WORD_0
    v_lshlrev_b32_sdwa v98, 3, v118 dst_sel:DWORD dst_unused:UNUSED_PAD src0_sel:DWORD src1_sel:WORD_1
    ds_read_b64 v[96:97], v96
    ds_read_b64 v[98:99], v98
    v_lshlrev_b32_sdwa v100, 3, v119 dst_sel:DWORD dst_unused:UNUSED_PAD src0_sel:DWORD src1_sel:WORD_0
    v_lshlrev_b32_sdwa v102, 3, v119 dst_sel:DWORD dst_unused:UNUSED_PAD src0_sel:DWORD src1_sel:WORD_1
    ds_read_b64 v[100:101], v100
    ds_read_b64 v[102:103], v102
    buffer_load_dwordx4 v[116:119], v71, s[12:15], s20 offen offset:1024 sc1
    s_waitcnt lgkmcnt(9)
    v_smfmac_f32_16x16x64_bf16 v[36:39], v[66:69], v[104:111], v70
    v_mfma_f32_16x16x32_bf16 v[112:115], v[72:75], v[160:163], 0
    s_waitcnt vmcnt(2)
    v_lshlrev_b32_sdwa v104, 3, v120 dst_sel:DWORD dst_unused:UNUSED_PAD src0_sel:DWORD src1_sel:WORD_0
    v_lshlrev_b32_sdwa v106, 3, v120 dst_sel:DWORD dst_unused:UNUSED_PAD src0_sel:DWORD src1_sel:WORD_1
    ds_read_b64 v[104:105], v104
    ds_read_b64 v[106:107], v106
    v_mfma_f32_16x16x32_bf16 v[112:115], v[76:79], v[164:167], v[112:115]
    v_lshlrev_b32_sdwa v108, 3, v121 dst_sel:DWORD dst_unused:UNUSED_PAD src0_sel:DWORD src1_sel:WORD_0
    v_lshlrev_b32_sdwa v110, 3, v121 dst_sel:DWORD dst_unused:UNUSED_PAD src0_sel:DWORD src1_sel:WORD_1
    v_cvt_pk_bf16_f32 v36, v36, v37
    v_cvt_pk_bf16_f32 v37, v38, v39
    v_lshlrev_b32 v38, 16, v40
    v_and_b32 v39, s23, v40
    v_lshlrev_b32 v40, 16, v41
    v_and_b32 v41, s23, v41
    ds_read_b64 v[108:109], v108
    ds_read_b64 v[110:111], v110
    s_waitcnt lgkmcnt(9)
    v_smfmac_f32_16x16x64_bf16 v[38:41], v[66:69], v[88:95], v70
    v_mfma_f32_16x16x32_bf16 v[112:115], v[80:83], v[168:171], v[112:115]
    v_lshlrev_b32_sdwa v88, 3, v122 dst_sel:DWORD dst_unused:UNUSED_PAD src0_sel:DWORD src1_sel:WORD_0
    v_lshlrev_b32_sdwa v90, 3, v122 dst_sel:DWORD dst_unused:UNUSED_PAD src0_sel:DWORD src1_sel:WORD_1
    ds_read_b64 v[88:89], v88
    ds_read_b64 v[90:91], v90
    v_mfma_f32_16x16x32_bf16 v[112:115], v[84:87], v[172:175], v[112:115]
    v_lshlrev_b32_sdwa v92, 3, v123 dst_sel:DWORD dst_unused:UNUSED_PAD src0_sel:DWORD src1_sel:WORD_0
    v_lshlrev_b32_sdwa v94, 3, v123 dst_sel:DWORD dst_unused:UNUSED_PAD src0_sel:DWORD src1_sel:WORD_1
    ds_read_b64 v[92:93], v92
    ds_read_b64 v[94:95], v94
    buffer_load_dwordx4 v[120:123], v71, s[12:15], s20 offen offset:0 sc1
    s_waitcnt lgkmcnt(8)
    v_smfmac_f32_16x16x64_bf16 v[38:41], v[66:69], v[96:103], v70
    s_nop 0
    v_cvt_pk_bf16_f32 v112, v112, v113
    v_cvt_pk_bf16_f32 v113, v114, v115
    v_lshlrev_b32_sdwa v114, 3, v70 dst_sel:DWORD dst_unused:UNUSED_PAD src0_sel:DWORD src1_sel:WORD_1
    ds_write_b64 v114, v[112:113] offset:256
    s_waitcnt vmcnt(2)
    v_lshlrev_b32_sdwa v96, 3, v124 dst_sel:DWORD dst_unused:UNUSED_PAD src0_sel:DWORD src1_sel:WORD_0
    v_lshlrev_b32_sdwa v98, 3, v124 dst_sel:DWORD dst_unused:UNUSED_PAD src0_sel:DWORD src1_sel:WORD_1
    ds_read_b64 v[96:97], v96
    ds_read_b64 v[98:99], v98
    v_lshlrev_b32_sdwa v100, 3, v125 dst_sel:DWORD dst_unused:UNUSED_PAD src0_sel:DWORD src1_sel:WORD_0
    v_lshlrev_b32_sdwa v102, 3, v125 dst_sel:DWORD dst_unused:UNUSED_PAD src0_sel:DWORD src1_sel:WORD_1
    v_cvt_pk_bf16_f32 v38, v38, v39
    v_cvt_pk_bf16_f32 v39, v40, v41
    v_lshlrev_b32 v40, 16, v42
    v_and_b32 v41, s23, v42
    v_lshlrev_b32 v42, 16, v43
    v_and_b32 v43, s23, v43
    ds_read_b64 v[100:101], v100
    ds_read_b64 v[102:103], v102
    s_waitcnt lgkmcnt(9)
    v_smfmac_f32_16x16x64_bf16 v[40:43], v[66:69], v[104:111], v70
    v_mfma_f32_16x16x32_bf16 v[112:115], v[72:75], v[176:179], 0
    v_lshlrev_b32_sdwa v104, 3, v126 dst_sel:DWORD dst_unused:UNUSED_PAD src0_sel:DWORD src1_sel:WORD_0
    v_lshlrev_b32_sdwa v106, 3, v126 dst_sel:DWORD dst_unused:UNUSED_PAD src0_sel:DWORD src1_sel:WORD_1
    ds_read_b64 v[104:105], v104
    ds_read_b64 v[106:107], v106
    v_mfma_f32_16x16x32_bf16 v[112:115], v[76:79], v[180:183], v[112:115]
    v_lshlrev_b32_sdwa v108, 3, v127 dst_sel:DWORD dst_unused:UNUSED_PAD src0_sel:DWORD src1_sel:WORD_0
    v_lshlrev_b32_sdwa v110, 3, v127 dst_sel:DWORD dst_unused:UNUSED_PAD src0_sel:DWORD src1_sel:WORD_1
    ds_read_b64 v[108:109], v108
    ds_read_b64 v[110:111], v110
    s_add_u32 s20, s20, 0xfffff000
    buffer_load_dwordx4 v[124:127], v71, s[12:15], s20 offen offset:3072 sc1
    s_waitcnt lgkmcnt(9)
    v_smfmac_f32_16x16x64_bf16 v[40:43], v[66:69], v[88:95], v70
    v_mfma_f32_16x16x32_bf16 v[112:115], v[80:83], v[184:187], v[112:115]
    s_waitcnt vmcnt(2)
    v_lshlrev_b32_sdwa v88, 3, v116 dst_sel:DWORD dst_unused:UNUSED_PAD src0_sel:DWORD src1_sel:WORD_0
    v_lshlrev_b32_sdwa v90, 3, v116 dst_sel:DWORD dst_unused:UNUSED_PAD src0_sel:DWORD src1_sel:WORD_1
    ds_read_b64 v[88:89], v88
    ds_read_b64 v[90:91], v90
    v_mfma_f32_16x16x32_bf16 v[112:115], v[84:87], v[188:191], v[112:115]
    v_lshlrev_b32_sdwa v92, 3, v117 dst_sel:DWORD dst_unused:UNUSED_PAD src0_sel:DWORD src1_sel:WORD_0
    v_lshlrev_b32_sdwa v94, 3, v117 dst_sel:DWORD dst_unused:UNUSED_PAD src0_sel:DWORD src1_sel:WORD_1
    v_cvt_pk_bf16_f32 v40, v40, v41
    v_cvt_pk_bf16_f32 v41, v42, v43
    v_lshlrev_b32 v42, 16, v44
    v_and_b32 v43, s23, v44
    v_lshlrev_b32 v44, 16, v45
    v_and_b32 v45, s23, v45
    ds_read_b64 v[92:93], v92
    ds_read_b64 v[94:95], v94
    s_waitcnt lgkmcnt(8)
    v_smfmac_f32_16x16x64_bf16 v[42:45], v[66:69], v[96:103], v70
    v_cvt_pk_bf16_f32 v112, v112, v113
    v_cvt_pk_bf16_f32 v113, v114, v115
    v_lshlrev_b32_sdwa v114, 3, v70 dst_sel:DWORD dst_unused:UNUSED_PAD src0_sel:DWORD src1_sel:WORD_1
    ds_write_b64 v114, v[112:113] offset:384
    v_lshlrev_b32_sdwa v96, 3, v118 dst_sel:DWORD dst_unused:UNUSED_PAD src0_sel:DWORD src1_sel:WORD_0
    v_lshlrev_b32_sdwa v98, 3, v118 dst_sel:DWORD dst_unused:UNUSED_PAD src0_sel:DWORD src1_sel:WORD_1
    ds_read_b64 v[96:97], v96
    ds_read_b64 v[98:99], v98
    v_lshlrev_b32_sdwa v100, 3, v119 dst_sel:DWORD dst_unused:UNUSED_PAD src0_sel:DWORD src1_sel:WORD_0
    v_lshlrev_b32_sdwa v102, 3, v119 dst_sel:DWORD dst_unused:UNUSED_PAD src0_sel:DWORD src1_sel:WORD_1
    ds_read_b64 v[100:101], v100
    ds_read_b64 v[102:103], v102
    buffer_load_dwordx4 v[116:119], v71, s[12:15], s20 offen offset:2048 sc1
    s_waitcnt lgkmcnt(9)
    v_smfmac_f32_16x16x64_bf16 v[42:45], v[66:69], v[104:111], v70
    v_mfma_f32_16x16x32_bf16 v[112:115], v[72:75], v[192:195], 0
    s_waitcnt vmcnt(2)
    v_lshlrev_b32_sdwa v104, 3, v120 dst_sel:DWORD dst_unused:UNUSED_PAD src0_sel:DWORD src1_sel:WORD_0
    v_lshlrev_b32_sdwa v106, 3, v120 dst_sel:DWORD dst_unused:UNUSED_PAD src0_sel:DWORD src1_sel:WORD_1
    ds_read_b64 v[104:105], v104
    ds_read_b64 v[106:107], v106
    v_mfma_f32_16x16x32_bf16 v[112:115], v[76:79], v[196:199], v[112:115]
    v_lshlrev_b32_sdwa v108, 3, v121 dst_sel:DWORD dst_unused:UNUSED_PAD src0_sel:DWORD src1_sel:WORD_0
    v_lshlrev_b32_sdwa v110, 3, v121 dst_sel:DWORD dst_unused:UNUSED_PAD src0_sel:DWORD src1_sel:WORD_1
    v_cvt_pk_bf16_f32 v42, v42, v43
    v_cvt_pk_bf16_f32 v43, v44, v45
    v_lshlrev_b32 v44, 16, v46
    v_and_b32 v45, s23, v46
    v_lshlrev_b32 v46, 16, v47
    v_and_b32 v47, s23, v47
    ds_read_b64 v[108:109], v108
    ds_read_b64 v[110:111], v110
    s_waitcnt lgkmcnt(9)
    v_smfmac_f32_16x16x64_bf16 v[44:47], v[66:69], v[88:95], v70
    v_mfma_f32_16x16x32_bf16 v[112:115], v[80:83], v[200:203], v[112:115]
    v_lshlrev_b32_sdwa v88, 3, v122 dst_sel:DWORD dst_unused:UNUSED_PAD src0_sel:DWORD src1_sel:WORD_0
    v_lshlrev_b32_sdwa v90, 3, v122 dst_sel:DWORD dst_unused:UNUSED_PAD src0_sel:DWORD src1_sel:WORD_1
    ds_read_b64 v[88:89], v88
    ds_read_b64 v[90:91], v90
    v_mfma_f32_16x16x32_bf16 v[112:115], v[84:87], v[204:207], v[112:115]
    v_lshlrev_b32_sdwa v92, 3, v123 dst_sel:DWORD dst_unused:UNUSED_PAD src0_sel:DWORD src1_sel:WORD_0
    v_lshlrev_b32_sdwa v94, 3, v123 dst_sel:DWORD dst_unused:UNUSED_PAD src0_sel:DWORD src1_sel:WORD_1
    ds_read_b64 v[92:93], v92
    ds_read_b64 v[94:95], v94
    buffer_load_dwordx4 v[120:123], v71, s[12:15], s20 offen offset:1024 sc1
    s_waitcnt lgkmcnt(8)
    v_smfmac_f32_16x16x64_bf16 v[44:47], v[66:69], v[96:103], v70
    s_nop 0
    v_cvt_pk_bf16_f32 v112, v112, v113
    v_cvt_pk_bf16_f32 v113, v114, v115
    v_lshlrev_b32_sdwa v114, 3, v70 dst_sel:DWORD dst_unused:UNUSED_PAD src0_sel:DWORD src1_sel:WORD_1
    ds_write_b64 v114, v[112:113] offset:512
    s_waitcnt vmcnt(2)
    v_lshlrev_b32_sdwa v96, 3, v124 dst_sel:DWORD dst_unused:UNUSED_PAD src0_sel:DWORD src1_sel:WORD_0
    v_lshlrev_b32_sdwa v98, 3, v124 dst_sel:DWORD dst_unused:UNUSED_PAD src0_sel:DWORD src1_sel:WORD_1
    ds_read_b64 v[96:97], v96
    ds_read_b64 v[98:99], v98
    v_lshlrev_b32_sdwa v100, 3, v125 dst_sel:DWORD dst_unused:UNUSED_PAD src0_sel:DWORD src1_sel:WORD_0
    v_lshlrev_b32_sdwa v102, 3, v125 dst_sel:DWORD dst_unused:UNUSED_PAD src0_sel:DWORD src1_sel:WORD_1
    v_cvt_pk_bf16_f32 v44, v44, v45
    v_cvt_pk_bf16_f32 v45, v46, v47
    v_lshlrev_b32 v46, 16, v48
    v_and_b32 v47, s23, v48
    v_lshlrev_b32 v48, 16, v49
    v_and_b32 v49, s23, v49
    ds_read_b64 v[100:101], v100
    ds_read_b64 v[102:103], v102
    s_waitcnt lgkmcnt(9)
    v_smfmac_f32_16x16x64_bf16 v[46:49], v[66:69], v[104:111], v70
    s_setprio 2
    v_mfma_f32_16x16x32_bf16 v[112:115], v[72:75], v[208:211], 0
    v_lshlrev_b32_sdwa v104, 3, v126 dst_sel:DWORD dst_unused:UNUSED_PAD src0_sel:DWORD src1_sel:WORD_0
    v_lshlrev_b32_sdwa v106, 3, v126 dst_sel:DWORD dst_unused:UNUSED_PAD src0_sel:DWORD src1_sel:WORD_1
    ds_read_b64 v[104:105], v104
    ds_read_b64 v[106:107], v106
    v_mfma_f32_16x16x32_bf16 v[112:115], v[76:79], v[212:215], v[112:115]
    v_lshlrev_b32_sdwa v108, 3, v127 dst_sel:DWORD dst_unused:UNUSED_PAD src0_sel:DWORD src1_sel:WORD_0
    v_lshlrev_b32_sdwa v110, 3, v127 dst_sel:DWORD dst_unused:UNUSED_PAD src0_sel:DWORD src1_sel:WORD_1
    ds_read_b64 v[108:109], v108
    ds_read_b64 v[110:111], v110
    buffer_load_dwordx4 v[124:127], v71, s[12:15], s20 offen offset:0 sc1
    s_waitcnt lgkmcnt(9)
    v_smfmac_f32_16x16x64_bf16 v[46:49], v[66:69], v[88:95], v70
    v_mfma_f32_16x16x32_bf16 v[112:115], v[80:83], v[216:219], v[112:115]
    s_waitcnt vmcnt(2)
    v_lshlrev_b32_sdwa v88, 3, v116 dst_sel:DWORD dst_unused:UNUSED_PAD src0_sel:DWORD src1_sel:WORD_0
    v_lshlrev_b32_sdwa v90, 3, v116 dst_sel:DWORD dst_unused:UNUSED_PAD src0_sel:DWORD src1_sel:WORD_1
    ds_read_b64 v[88:89], v88
    ds_read_b64 v[90:91], v90
    v_mfma_f32_16x16x32_bf16 v[112:115], v[84:87], v[220:223], v[112:115]
    v_lshlrev_b32_sdwa v92, 3, v117 dst_sel:DWORD dst_unused:UNUSED_PAD src0_sel:DWORD src1_sel:WORD_0
    v_lshlrev_b32_sdwa v94, 3, v117 dst_sel:DWORD dst_unused:UNUSED_PAD src0_sel:DWORD src1_sel:WORD_1
    v_cvt_pk_bf16_f32 v46, v46, v47
    v_cvt_pk_bf16_f32 v47, v48, v49
    v_lshlrev_b32 v48, 16, v50
    v_and_b32 v49, s23, v50
    v_lshlrev_b32 v50, 16, v51
    v_and_b32 v51, s23, v51
    ds_read_b64 v[92:93], v92
    ds_read_b64 v[94:95], v94
    s_waitcnt lgkmcnt(8)
    v_smfmac_f32_16x16x64_bf16 v[48:51], v[66:69], v[96:103], v70
    v_cvt_pk_bf16_f32 v112, v112, v113
    v_cvt_pk_bf16_f32 v113, v114, v115
    v_lshlrev_b32_sdwa v114, 3, v70 dst_sel:DWORD dst_unused:UNUSED_PAD src0_sel:DWORD src1_sel:WORD_1
    ds_write_b64 v114, v[112:113] offset:640
    v_lshlrev_b32_sdwa v96, 3, v118 dst_sel:DWORD dst_unused:UNUSED_PAD src0_sel:DWORD src1_sel:WORD_0
    v_lshlrev_b32_sdwa v98, 3, v118 dst_sel:DWORD dst_unused:UNUSED_PAD src0_sel:DWORD src1_sel:WORD_1
    ds_read_b64 v[96:97], v96
    ds_read_b64 v[98:99], v98
    v_lshlrev_b32_sdwa v100, 3, v119 dst_sel:DWORD dst_unused:UNUSED_PAD src0_sel:DWORD src1_sel:WORD_0
    v_lshlrev_b32_sdwa v102, 3, v119 dst_sel:DWORD dst_unused:UNUSED_PAD src0_sel:DWORD src1_sel:WORD_1
    ds_read_b64 v[100:101], v100
    ds_read_b64 v[102:103], v102
    s_add_u32 s20, s20, 0xfffff000
    buffer_load_dwordx4 v[116:119], v71, s[12:15], s20 offen offset:3072 sc1
    s_waitcnt lgkmcnt(9)
    v_smfmac_f32_16x16x64_bf16 v[48:51], v[66:69], v[104:111], v70
    v_mfma_f32_16x16x32_bf16 v[112:115], v[72:75], v[224:227], 0
    s_waitcnt vmcnt(2)
    v_lshlrev_b32_sdwa v104, 3, v120 dst_sel:DWORD dst_unused:UNUSED_PAD src0_sel:DWORD src1_sel:WORD_0
    v_lshlrev_b32_sdwa v106, 3, v120 dst_sel:DWORD dst_unused:UNUSED_PAD src0_sel:DWORD src1_sel:WORD_1
    ds_read_b64 v[104:105], v104
    ds_read_b64 v[106:107], v106
    v_mfma_f32_16x16x32_bf16 v[112:115], v[76:79], v[228:231], v[112:115]
    v_lshlrev_b32_sdwa v108, 3, v121 dst_sel:DWORD dst_unused:UNUSED_PAD src0_sel:DWORD src1_sel:WORD_0
    v_lshlrev_b32_sdwa v110, 3, v121 dst_sel:DWORD dst_unused:UNUSED_PAD src0_sel:DWORD src1_sel:WORD_1
    v_cvt_pk_bf16_f32 v48, v48, v49
    v_cvt_pk_bf16_f32 v49, v50, v51
    v_lshlrev_b32 v50, 16, v52
    v_and_b32 v51, s23, v52
    v_lshlrev_b32 v52, 16, v53
    v_and_b32 v53, s23, v53
    ds_read_b64 v[108:109], v108
    ds_read_b64 v[110:111], v110
    s_waitcnt lgkmcnt(9)
    v_smfmac_f32_16x16x64_bf16 v[50:53], v[66:69], v[88:95], v70
    v_mfma_f32_16x16x32_bf16 v[112:115], v[80:83], v[232:235], v[112:115]
    v_lshlrev_b32_sdwa v88, 3, v122 dst_sel:DWORD dst_unused:UNUSED_PAD src0_sel:DWORD src1_sel:WORD_0
    v_lshlrev_b32_sdwa v90, 3, v122 dst_sel:DWORD dst_unused:UNUSED_PAD src0_sel:DWORD src1_sel:WORD_1
    ds_read_b64 v[88:89], v88
    ds_read_b64 v[90:91], v90
    v_mfma_f32_16x16x32_bf16 v[112:115], v[84:87], v[236:239], v[112:115]
    v_lshlrev_b32_sdwa v92, 3, v123 dst_sel:DWORD dst_unused:UNUSED_PAD src0_sel:DWORD src1_sel:WORD_0
    v_lshlrev_b32_sdwa v94, 3, v123 dst_sel:DWORD dst_unused:UNUSED_PAD src0_sel:DWORD src1_sel:WORD_1
    ds_read_b64 v[92:93], v92
    ds_read_b64 v[94:95], v94
    buffer_load_dwordx4 v[120:123], v71, s[12:15], s20 offen offset:2048 sc1
    s_waitcnt lgkmcnt(8)
    v_smfmac_f32_16x16x64_bf16 v[50:53], v[66:69], v[96:103], v70
    s_nop 0
    v_cvt_pk_bf16_f32 v112, v112, v113
    v_cvt_pk_bf16_f32 v113, v114, v115
    v_lshlrev_b32_sdwa v114, 3, v70 dst_sel:DWORD dst_unused:UNUSED_PAD src0_sel:DWORD src1_sel:WORD_1
    ds_write_b64 v114, v[112:113] offset:768
    s_waitcnt vmcnt(2)
    v_lshlrev_b32_sdwa v96, 3, v124 dst_sel:DWORD dst_unused:UNUSED_PAD src0_sel:DWORD src1_sel:WORD_0
    v_lshlrev_b32_sdwa v98, 3, v124 dst_sel:DWORD dst_unused:UNUSED_PAD src0_sel:DWORD src1_sel:WORD_1
    ds_read_b64 v[96:97], v96
    ds_read_b64 v[98:99], v98
    v_lshlrev_b32_sdwa v100, 3, v125 dst_sel:DWORD dst_unused:UNUSED_PAD src0_sel:DWORD src1_sel:WORD_0
    v_lshlrev_b32_sdwa v102, 3, v125 dst_sel:DWORD dst_unused:UNUSED_PAD src0_sel:DWORD src1_sel:WORD_1
    v_cvt_pk_bf16_f32 v50, v50, v51
    v_cvt_pk_bf16_f32 v51, v52, v53
    v_lshlrev_b32 v52, 16, v54
    v_and_b32 v53, s23, v54
    v_lshlrev_b32 v54, 16, v55
    v_and_b32 v55, s23, v55
    ds_read_b64 v[100:101], v100
    ds_read_b64 v[102:103], v102
    s_waitcnt lgkmcnt(9)
    v_smfmac_f32_16x16x64_bf16 v[52:55], v[66:69], v[104:111], v70
    v_mfma_f32_16x16x32_bf16 v[112:115], v[72:75], v[240:243], 0
    buffer_load_dwordx4 v[72:75], v71, s[12:15], s21 offen offset:0
    v_lshlrev_b32_sdwa v104, 3, v126 dst_sel:DWORD dst_unused:UNUSED_PAD src0_sel:DWORD src1_sel:WORD_0
    v_lshlrev_b32_sdwa v106, 3, v126 dst_sel:DWORD dst_unused:UNUSED_PAD src0_sel:DWORD src1_sel:WORD_1
    ds_read_b64 v[104:105], v104
    ds_read_b64 v[106:107], v106
    v_mfma_f32_16x16x32_bf16 v[112:115], v[76:79], v[244:247], v[112:115]
    buffer_load_dwordx4 v[76:79], v71, s[12:15], s21 offen offset:1024
    v_lshlrev_b32_sdwa v108, 3, v127 dst_sel:DWORD dst_unused:UNUSED_PAD src0_sel:DWORD src1_sel:WORD_0
    v_lshlrev_b32_sdwa v110, 3, v127 dst_sel:DWORD dst_unused:UNUSED_PAD src0_sel:DWORD src1_sel:WORD_1
    ds_read_b64 v[108:109], v108
    ds_read_b64 v[110:111], v110
    buffer_load_dwordx4 v[124:127], v71, s[12:15], s20 offen offset:1024 sc1
    s_waitcnt lgkmcnt(9)
    v_smfmac_f32_16x16x64_bf16 v[52:55], v[66:69], v[88:95], v70
    v_mfma_f32_16x16x32_bf16 v[112:115], v[80:83], v[248:251], v[112:115]
    buffer_load_dwordx4 v[80:83], v71, s[12:15], s19 offen offset:0
    s_waitcnt vmcnt(5)
    v_lshlrev_b32_sdwa v88, 3, v116 dst_sel:DWORD dst_unused:UNUSED_PAD src0_sel:DWORD src1_sel:WORD_0
    v_lshlrev_b32_sdwa v90, 3, v116 dst_sel:DWORD dst_unused:UNUSED_PAD src0_sel:DWORD src1_sel:WORD_1
    ds_read_b64 v[88:89], v88
    ds_read_b64 v[90:91], v90
    v_mfma_f32_16x16x32_bf16 v[112:115], v[84:87], v[252:255], v[112:115]
    buffer_load_dwordx4 v[84:87], v71, s[12:15], s19 offen offset:1024
    s_add_u32 s21, s21, 4096
    s_add_u32 s19, s19, 4096
    v_lshlrev_b32_sdwa v92, 3, v117 dst_sel:DWORD dst_unused:UNUSED_PAD src0_sel:DWORD src1_sel:WORD_0
    v_lshlrev_b32_sdwa v94, 3, v117 dst_sel:DWORD dst_unused:UNUSED_PAD src0_sel:DWORD src1_sel:WORD_1
    v_cvt_pk_bf16_f32 v52, v52, v53
    v_cvt_pk_bf16_f32 v53, v54, v55
    v_lshlrev_b32 v54, 16, v56
    v_and_b32 v55, s23, v56
    v_lshlrev_b32 v56, 16, v57
    v_and_b32 v57, s23, v57
    ds_read_b64 v[92:93], v92
    ds_read_b64 v[94:95], v94
    s_waitcnt lgkmcnt(8)
    v_smfmac_f32_16x16x64_bf16 v[54:57], v[66:69], v[96:103], v70
    v_cvt_pk_bf16_f32 v112, v112, v113
    v_cvt_pk_bf16_f32 v113, v114, v115
    v_lshlrev_b32_sdwa v114, 3, v70 dst_sel:DWORD dst_unused:UNUSED_PAD src0_sel:DWORD src1_sel:WORD_1
    ds_write_b64 v114, v[112:113] offset:896
    s_setprio 1
    v_lshlrev_b32_sdwa v96, 3, v118 dst_sel:DWORD dst_unused:UNUSED_PAD src0_sel:DWORD src1_sel:WORD_0
    v_lshlrev_b32_sdwa v98, 3, v118 dst_sel:DWORD dst_unused:UNUSED_PAD src0_sel:DWORD src1_sel:WORD_1
    ds_read_b64 v[96:97], v96
    ds_read_b64 v[98:99], v98
    v_lshlrev_b32_sdwa v100, 3, v119 dst_sel:DWORD dst_unused:UNUSED_PAD src0_sel:DWORD src1_sel:WORD_0
    v_lshlrev_b32_sdwa v102, 3, v119 dst_sel:DWORD dst_unused:UNUSED_PAD src0_sel:DWORD src1_sel:WORD_1
    ds_read_b64 v[100:101], v100
    ds_read_b64 v[102:103], v102
    s_add_u32 s20, s20, 0x4000
    buffer_load_dwordx4 v[116:119], v71, s[12:15], s20 offen offset:0 sc1
    s_waitcnt lgkmcnt(9)
    v_smfmac_f32_16x16x64_bf16 v[54:57], v[66:69], v[104:111], v70
    s_waitcnt vmcnt(6)
    v_lshlrev_b32_sdwa v104, 3, v120 dst_sel:DWORD dst_unused:UNUSED_PAD src0_sel:DWORD src1_sel:WORD_0
    v_lshlrev_b32_sdwa v106, 3, v120 dst_sel:DWORD dst_unused:UNUSED_PAD src0_sel:DWORD src1_sel:WORD_1
    ds_read_b64 v[104:105], v104
    ds_read_b64 v[106:107], v106
    v_lshlrev_b32_sdwa v108, 3, v121 dst_sel:DWORD dst_unused:UNUSED_PAD src0_sel:DWORD src1_sel:WORD_0
    v_lshlrev_b32_sdwa v110, 3, v121 dst_sel:DWORD dst_unused:UNUSED_PAD src0_sel:DWORD src1_sel:WORD_1
    s_nop 0
    v_cvt_pk_bf16_f32 v54, v54, v55
    v_cvt_pk_bf16_f32 v55, v56, v57
    v_lshlrev_b32 v56, 16, v58
    v_and_b32 v57, s23, v58
    v_lshlrev_b32 v58, 16, v59
    v_and_b32 v59, s23, v59
    ds_read_b64 v[108:109], v108
    ds_read_b64 v[110:111], v110
    s_waitcnt lgkmcnt(9)
    v_smfmac_f32_16x16x64_bf16 v[56:59], v[66:69], v[88:95], v70
    v_lshlrev_b32_sdwa v88, 3, v122 dst_sel:DWORD dst_unused:UNUSED_PAD src0_sel:DWORD src1_sel:WORD_0
    v_lshlrev_b32_sdwa v90, 3, v122 dst_sel:DWORD dst_unused:UNUSED_PAD src0_sel:DWORD src1_sel:WORD_1
    ds_read_b64 v[88:89], v88
    ds_read_b64 v[90:91], v90
    v_lshlrev_b32_sdwa v92, 3, v123 dst_sel:DWORD dst_unused:UNUSED_PAD src0_sel:DWORD src1_sel:WORD_0
    v_lshlrev_b32_sdwa v94, 3, v123 dst_sel:DWORD dst_unused:UNUSED_PAD src0_sel:DWORD src1_sel:WORD_1
    ds_read_b64 v[92:93], v92
    ds_read_b64 v[94:95], v94
    s_add_u32 s20, s20, 0x1ec00
    buffer_load_dwordx4 v[120:123], v71, s[12:15], s20 offen offset:3072 sc1
    s_waitcnt lgkmcnt(8)
    v_smfmac_f32_16x16x64_bf16 v[56:59], v[66:69], v[96:103], v70
    s_waitcnt vmcnt(4)
    v_lshlrev_b32_sdwa v96, 3, v124 dst_sel:DWORD dst_unused:UNUSED_PAD src0_sel:DWORD src1_sel:WORD_0
    v_lshlrev_b32_sdwa v98, 3, v124 dst_sel:DWORD dst_unused:UNUSED_PAD src0_sel:DWORD src1_sel:WORD_1
    ds_read_b64 v[96:97], v96
    ds_read_b64 v[98:99], v98
    v_lshlrev_b32_sdwa v100, 3, v125 dst_sel:DWORD dst_unused:UNUSED_PAD src0_sel:DWORD src1_sel:WORD_0
    v_lshlrev_b32_sdwa v102, 3, v125 dst_sel:DWORD dst_unused:UNUSED_PAD src0_sel:DWORD src1_sel:WORD_1
    s_nop 0
    v_cvt_pk_bf16_f32 v56, v56, v57
    v_cvt_pk_bf16_f32 v57, v58, v59
    v_lshlrev_b32 v58, 16, v60
    v_and_b32 v59, s23, v60
    v_lshlrev_b32 v60, 16, v61
    v_and_b32 v61, s23, v61
    ds_read_b64 v[100:101], v100
    ds_read_b64 v[102:103], v102
    s_waitcnt lgkmcnt(8)
    v_smfmac_f32_16x16x64_bf16 v[58:61], v[66:69], v[104:111], v70
    v_lshlrev_b32_sdwa v104, 3, v126 dst_sel:DWORD dst_unused:UNUSED_PAD src0_sel:DWORD src1_sel:WORD_0
    v_lshlrev_b32_sdwa v106, 3, v126 dst_sel:DWORD dst_unused:UNUSED_PAD src0_sel:DWORD src1_sel:WORD_1
    ds_read_b64 v[104:105], v104
    ds_read_b64 v[106:107], v106
    v_lshlrev_b32_sdwa v108, 3, v127 dst_sel:DWORD dst_unused:UNUSED_PAD src0_sel:DWORD src1_sel:WORD_0
    v_lshlrev_b32_sdwa v110, 3, v127 dst_sel:DWORD dst_unused:UNUSED_PAD src0_sel:DWORD src1_sel:WORD_1
    ds_read_b64 v[108:109], v108
    ds_read_b64 v[110:111], v110
    buffer_load_dwordx4 v[124:127], v71, s[12:15], s20 offen offset:2048 sc1
    s_waitcnt lgkmcnt(8)
    v_smfmac_f32_16x16x64_bf16 v[58:61], v[66:69], v[88:95], v70
    s_waitcnt vmcnt(2)
    v_lshlrev_b32_sdwa v88, 3, v116 dst_sel:DWORD dst_unused:UNUSED_PAD src0_sel:DWORD src1_sel:WORD_0
    v_lshlrev_b32_sdwa v90, 3, v116 dst_sel:DWORD dst_unused:UNUSED_PAD src0_sel:DWORD src1_sel:WORD_1
    ds_read_b64 v[88:89], v88
    ds_read_b64 v[90:91], v90
    v_lshlrev_b32_sdwa v92, 3, v117 dst_sel:DWORD dst_unused:UNUSED_PAD src0_sel:DWORD src1_sel:WORD_0
    v_lshlrev_b32_sdwa v94, 3, v117 dst_sel:DWORD dst_unused:UNUSED_PAD src0_sel:DWORD src1_sel:WORD_1
    s_nop 0
    v_cvt_pk_bf16_f32 v58, v58, v59
    v_cvt_pk_bf16_f32 v59, v60, v61
    v_lshlrev_b32 v60, 16, v62
    v_and_b32 v61, s23, v62
    v_lshlrev_b32 v62, 16, v63
    v_and_b32 v63, s23, v63
    ds_read_b64 v[92:93], v92
    ds_read_b64 v[94:95], v94
    s_waitcnt lgkmcnt(8)
    v_smfmac_f32_16x16x64_bf16 v[60:63], v[66:69], v[96:103], v70
    s_setprio 0
    v_lshlrev_b32_sdwa v96, 3, v118 dst_sel:DWORD dst_unused:UNUSED_PAD src0_sel:DWORD src1_sel:WORD_0
    v_lshlrev_b32_sdwa v98, 3, v118 dst_sel:DWORD dst_unused:UNUSED_PAD src0_sel:DWORD src1_sel:WORD_1
    ds_read_b64 v[96:97], v96
    ds_read_b64 v[98:99], v98
    v_lshlrev_b32_sdwa v100, 3, v119 dst_sel:DWORD dst_unused:UNUSED_PAD src0_sel:DWORD src1_sel:WORD_0
    v_lshlrev_b32_sdwa v102, 3, v119 dst_sel:DWORD dst_unused:UNUSED_PAD src0_sel:DWORD src1_sel:WORD_1
    ds_read_b64 v[100:101], v100
    ds_read_b64 v[102:103], v102
    buffer_load_dwordx4 v[116:119], v71, s[12:15], s20 offen offset:1024 sc1
    s_waitcnt lgkmcnt(8)
    v_smfmac_f32_16x16x64_bf16 v[60:63], v[66:69], v[104:111], v70
    s_waitcnt vmcnt(2)
    v_lshlrev_b32_sdwa v104, 3, v122 dst_sel:DWORD dst_unused:UNUSED_PAD src0_sel:DWORD src1_sel:WORD_0
    v_lshlrev_b32_sdwa v106, 3, v122 dst_sel:DWORD dst_unused:UNUSED_PAD src0_sel:DWORD src1_sel:WORD_1
    ds_read_b64 v[104:105], v104
    ds_read_b64 v[106:107], v106
    v_lshlrev_b32_sdwa v108, 3, v123 dst_sel:DWORD dst_unused:UNUSED_PAD src0_sel:DWORD src1_sel:WORD_0
    v_lshlrev_b32_sdwa v110, 3, v123 dst_sel:DWORD dst_unused:UNUSED_PAD src0_sel:DWORD src1_sel:WORD_1
    s_nop 0
    v_cvt_pk_bf16_f32 v60, v60, v61
    v_cvt_pk_bf16_f32 v61, v62, v63
    v_lshlrev_b32 v62, 16, v64
    v_and_b32 v63, s23, v64
    v_lshlrev_b32 v64, 16, v65
    v_and_b32 v65, s23, v65
    ds_read_b64 v[108:109], v108
    ds_read_b64 v[110:111], v110
    s_waitcnt lgkmcnt(8)
    v_smfmac_f32_16x16x64_bf16 v[62:65], v[66:69], v[88:95], v70
    s_barrier
    s_setprio 3
    v_lshlrev_b32_sdwa v88, 3, v120 dst_sel:DWORD dst_unused:UNUSED_PAD src0_sel:DWORD src1_sel:WORD_0
    v_lshlrev_b32_sdwa v90, 3, v120 dst_sel:DWORD dst_unused:UNUSED_PAD src0_sel:DWORD src1_sel:WORD_1
    ds_read_b64 v[88:89], v88
    ds_read_b64 v[90:91], v90
    v_lshlrev_b32_sdwa v92, 3, v121 dst_sel:DWORD dst_unused:UNUSED_PAD src0_sel:DWORD src1_sel:WORD_0
    v_lshlrev_b32_sdwa v94, 3, v121 dst_sel:DWORD dst_unused:UNUSED_PAD src0_sel:DWORD src1_sel:WORD_1
    ds_read_b64 v[92:93], v92
    ds_read_b64 v[94:95], v94
    buffer_load_dwordx4 v[120:123], v71, s[12:15], s20 offen offset:0 sc1
    s_waitcnt lgkmcnt(8)
    v_smfmac_f32_16x16x64_bf16 v[62:65], v[66:69], v[96:103], v70
    v_mfma_f32_16x16x32_bf16 v[112:115], v[72:75], v[128:131], 0
    s_waitcnt vmcnt(2)
    v_lshlrev_b32_sdwa v96, 3, v126 dst_sel:DWORD dst_unused:UNUSED_PAD src0_sel:DWORD src1_sel:WORD_0
    v_lshlrev_b32_sdwa v98, 3, v126 dst_sel:DWORD dst_unused:UNUSED_PAD src0_sel:DWORD src1_sel:WORD_1
    ds_read_b64 v[96:97], v96
    ds_read_b64 v[98:99], v98
    v_mfma_f32_16x16x32_bf16 v[112:115], v[76:79], v[132:135], v[112:115]
    v_lshlrev_b32_sdwa v100, 3, v127 dst_sel:DWORD dst_unused:UNUSED_PAD src0_sel:DWORD src1_sel:WORD_0
    v_lshlrev_b32_sdwa v102, 3, v127 dst_sel:DWORD dst_unused:UNUSED_PAD src0_sel:DWORD src1_sel:WORD_1
    v_cvt_pk_bf16_f32 v62, v62, v63
    v_cvt_pk_bf16_f32 v63, v64, v65
    v_mov_b64 v[64:65], v[32:33]
    v_and_b32 v33, s23, v31
    v_lshlrev_b32 v32, 16, v31
    v_and_b32 v31, s23, v30
    v_lshlrev_b32 v30, 16, v30
    ds_read_b64 v[100:101], v100
    ds_read_b64 v[102:103], v102
    s_waitcnt lgkmcnt(8)
    v_smfmac_f32_16x16x64_bf16 v[30:33], v[66:69], v[104:111], v70
    v_mfma_f32_16x16x32_bf16 v[112:115], v[80:83], v[136:139], v[112:115]
    v_lshlrev_b32_sdwa v104, 3, v124 dst_sel:DWORD dst_unused:UNUSED_PAD src0_sel:DWORD src1_sel:WORD_0
    v_lshlrev_b32_sdwa v106, 3, v124 dst_sel:DWORD dst_unused:UNUSED_PAD src0_sel:DWORD src1_sel:WORD_1
    ds_read_b64 v[104:105], v104
    ds_read_b64 v[106:107], v106
    v_mfma_f32_16x16x32_bf16 v[112:115], v[84:87], v[140:143], v[112:115]
    v_lshlrev_b32_sdwa v108, 3, v125 dst_sel:DWORD dst_unused:UNUSED_PAD src0_sel:DWORD src1_sel:WORD_0
    v_lshlrev_b32_sdwa v110, 3, v125 dst_sel:DWORD dst_unused:UNUSED_PAD src0_sel:DWORD src1_sel:WORD_1
    ds_read_b64 v[108:109], v108
    ds_read_b64 v[110:111], v110
    s_add_u32 s20, s20, 0xfffff000
    buffer_load_dwordx4 v[124:127], v71, s[12:15], s20 offen offset:3072 sc1
    s_waitcnt lgkmcnt(8)
    v_smfmac_f32_16x16x64_bf16 v[30:33], v[66:69], v[88:95], v70
    v_cvt_pk_bf16_f32 v112, v112, v113
    v_cvt_pk_bf16_f32 v113, v114, v115
    v_lshlrev_b32_sdwa v114, 3, v70 dst_sel:DWORD dst_unused:UNUSED_PAD src0_sel:DWORD src1_sel:WORD_1
    ds_write_b64 v114, v[112:113] offset:32768
    s_waitcnt vmcnt(2)
    v_lshlrev_b32_sdwa v88, 3, v118 dst_sel:DWORD dst_unused:UNUSED_PAD src0_sel:DWORD src1_sel:WORD_0
    v_lshlrev_b32_sdwa v90, 3, v118 dst_sel:DWORD dst_unused:UNUSED_PAD src0_sel:DWORD src1_sel:WORD_1
    ds_read_b64 v[88:89], v88
    ds_read_b64 v[90:91], v90
    v_lshlrev_b32_sdwa v92, 3, v119 dst_sel:DWORD dst_unused:UNUSED_PAD src0_sel:DWORD src1_sel:WORD_0
    v_lshlrev_b32_sdwa v94, 3, v119 dst_sel:DWORD dst_unused:UNUSED_PAD src0_sel:DWORD src1_sel:WORD_1
    v_cvt_pk_bf16_f32 v33, v32, v33
    v_cvt_pk_bf16_f32 v32, v30, v31
    v_and_b32 v31, s23, v29
    v_lshlrev_b32 v30, 16, v29
    v_and_b32 v29, s23, v28
    v_lshlrev_b32 v28, 16, v28
    ds_read_b64 v[92:93], v92
    ds_read_b64 v[94:95], v94
    s_waitcnt lgkmcnt(9)
    v_smfmac_f32_16x16x64_bf16 v[28:31], v[66:69], v[96:103], v70
    v_mfma_f32_16x16x32_bf16 v[112:115], v[72:75], v[144:147], 0
    v_lshlrev_b32_sdwa v96, 3, v116 dst_sel:DWORD dst_unused:UNUSED_PAD src0_sel:DWORD src1_sel:WORD_0
    v_lshlrev_b32_sdwa v98, 3, v116 dst_sel:DWORD dst_unused:UNUSED_PAD src0_sel:DWORD src1_sel:WORD_1
    ds_read_b64 v[96:97], v96
    ds_read_b64 v[98:99], v98
    v_mfma_f32_16x16x32_bf16 v[112:115], v[76:79], v[148:151], v[112:115]
    v_lshlrev_b32_sdwa v100, 3, v117 dst_sel:DWORD dst_unused:UNUSED_PAD src0_sel:DWORD src1_sel:WORD_0
    v_lshlrev_b32_sdwa v102, 3, v117 dst_sel:DWORD dst_unused:UNUSED_PAD src0_sel:DWORD src1_sel:WORD_1
    ds_read_b64 v[100:101], v100
    ds_read_b64 v[102:103], v102
    buffer_load_dwordx4 v[116:119], v71, s[12:15], s20 offen offset:2048 sc1
    s_waitcnt lgkmcnt(9)
    v_smfmac_f32_16x16x64_bf16 v[28:31], v[66:69], v[104:111], v70
    v_mfma_f32_16x16x32_bf16 v[112:115], v[80:83], v[152:155], v[112:115]
    s_waitcnt vmcnt(2)
    v_lshlrev_b32_sdwa v104, 3, v122 dst_sel:DWORD dst_unused:UNUSED_PAD src0_sel:DWORD src1_sel:WORD_0
    v_lshlrev_b32_sdwa v106, 3, v122 dst_sel:DWORD dst_unused:UNUSED_PAD src0_sel:DWORD src1_sel:WORD_1
    ds_read_b64 v[104:105], v104
    ds_read_b64 v[106:107], v106
    v_mfma_f32_16x16x32_bf16 v[112:115], v[84:87], v[156:159], v[112:115]
    v_lshlrev_b32_sdwa v108, 3, v123 dst_sel:DWORD dst_unused:UNUSED_PAD src0_sel:DWORD src1_sel:WORD_0
    v_lshlrev_b32_sdwa v110, 3, v123 dst_sel:DWORD dst_unused:UNUSED_PAD src0_sel:DWORD src1_sel:WORD_1
    v_cvt_pk_bf16_f32 v31, v30, v31
    v_cvt_pk_bf16_f32 v30, v28, v29
    v_and_b32 v29, s23, v27
    v_lshlrev_b32 v28, 16, v27
    v_and_b32 v27, s23, v26
    v_lshlrev_b32 v26, 16, v26
    ds_read_b64 v[108:109], v108
    ds_read_b64 v[110:111], v110
    s_waitcnt lgkmcnt(8)
    v_smfmac_f32_16x16x64_bf16 v[26:29], v[66:69], v[88:95], v70
    v_cvt_pk_bf16_f32 v112, v112, v113
    v_cvt_pk_bf16_f32 v113, v114, v115
    v_lshlrev_b32_sdwa v114, 3, v70 dst_sel:DWORD dst_unused:UNUSED_PAD src0_sel:DWORD src1_sel:WORD_1
    ds_write_b64 v114, v[112:113] offset:32896
    v_lshlrev_b32_sdwa v88, 3, v120 dst_sel:DWORD dst_unused:UNUSED_PAD src0_sel:DWORD src1_sel:WORD_0
    v_lshlrev_b32_sdwa v90, 3, v120 dst_sel:DWORD dst_unused:UNUSED_PAD src0_sel:DWORD src1_sel:WORD_1
    ds_read_b64 v[88:89], v88
    ds_read_b64 v[90:91], v90
    v_lshlrev_b32_sdwa v92, 3, v121 dst_sel:DWORD dst_unused:UNUSED_PAD src0_sel:DWORD src1_sel:WORD_0
    v_lshlrev_b32_sdwa v94, 3, v121 dst_sel:DWORD dst_unused:UNUSED_PAD src0_sel:DWORD src1_sel:WORD_1
    ds_read_b64 v[92:93], v92
    ds_read_b64 v[94:95], v94
    buffer_load_dwordx4 v[120:123], v71, s[12:15], s20 offen offset:1024 sc1
    s_waitcnt lgkmcnt(9)
    v_smfmac_f32_16x16x64_bf16 v[26:29], v[66:69], v[96:103], v70
    v_mfma_f32_16x16x32_bf16 v[112:115], v[72:75], v[160:163], 0
    s_waitcnt vmcnt(2)
    v_lshlrev_b32_sdwa v96, 3, v126 dst_sel:DWORD dst_unused:UNUSED_PAD src0_sel:DWORD src1_sel:WORD_0
    v_lshlrev_b32_sdwa v98, 3, v126 dst_sel:DWORD dst_unused:UNUSED_PAD src0_sel:DWORD src1_sel:WORD_1
    ds_read_b64 v[96:97], v96
    ds_read_b64 v[98:99], v98
    v_mfma_f32_16x16x32_bf16 v[112:115], v[76:79], v[164:167], v[112:115]
    v_lshlrev_b32_sdwa v100, 3, v127 dst_sel:DWORD dst_unused:UNUSED_PAD src0_sel:DWORD src1_sel:WORD_0
    v_lshlrev_b32_sdwa v102, 3, v127 dst_sel:DWORD dst_unused:UNUSED_PAD src0_sel:DWORD src1_sel:WORD_1
    v_cvt_pk_bf16_f32 v29, v28, v29
    v_cvt_pk_bf16_f32 v28, v26, v27
    v_and_b32 v27, s23, v25
    v_lshlrev_b32 v26, 16, v25
    v_and_b32 v25, s23, v24
    v_lshlrev_b32 v24, 16, v24
    ds_read_b64 v[100:101], v100
    ds_read_b64 v[102:103], v102
    s_waitcnt lgkmcnt(9)
    v_smfmac_f32_16x16x64_bf16 v[24:27], v[66:69], v[104:111], v70
    v_mfma_f32_16x16x32_bf16 v[112:115], v[80:83], v[168:171], v[112:115]
    v_lshlrev_b32_sdwa v104, 3, v124 dst_sel:DWORD dst_unused:UNUSED_PAD src0_sel:DWORD src1_sel:WORD_0
    v_lshlrev_b32_sdwa v106, 3, v124 dst_sel:DWORD dst_unused:UNUSED_PAD src0_sel:DWORD src1_sel:WORD_1
    ds_read_b64 v[104:105], v104
    ds_read_b64 v[106:107], v106
    v_mfma_f32_16x16x32_bf16 v[112:115], v[84:87], v[172:175], v[112:115]
    v_lshlrev_b32_sdwa v108, 3, v125 dst_sel:DWORD dst_unused:UNUSED_PAD src0_sel:DWORD src1_sel:WORD_0
    v_lshlrev_b32_sdwa v110, 3, v125 dst_sel:DWORD dst_unused:UNUSED_PAD src0_sel:DWORD src1_sel:WORD_1
    ds_read_b64 v[108:109], v108
    ds_read_b64 v[110:111], v110
    buffer_load_dwordx4 v[124:127], v71, s[12:15], s20 offen offset:0 sc1
    s_waitcnt lgkmcnt(8)
    v_smfmac_f32_16x16x64_bf16 v[24:27], v[66:69], v[88:95], v70
    s_nop 0
    v_cvt_pk_bf16_f32 v112, v112, v113
    v_cvt_pk_bf16_f32 v113, v114, v115
    v_lshlrev_b32_sdwa v114, 3, v70 dst_sel:DWORD dst_unused:UNUSED_PAD src0_sel:DWORD src1_sel:WORD_1
    ds_write_b64 v114, v[112:113] offset:33024
    s_waitcnt vmcnt(2)
    v_lshlrev_b32_sdwa v88, 3, v118 dst_sel:DWORD dst_unused:UNUSED_PAD src0_sel:DWORD src1_sel:WORD_0
    v_lshlrev_b32_sdwa v90, 3, v118 dst_sel:DWORD dst_unused:UNUSED_PAD src0_sel:DWORD src1_sel:WORD_1
    ds_read_b64 v[88:89], v88
    ds_read_b64 v[90:91], v90
    v_lshlrev_b32_sdwa v92, 3, v119 dst_sel:DWORD dst_unused:UNUSED_PAD src0_sel:DWORD src1_sel:WORD_0
    v_lshlrev_b32_sdwa v94, 3, v119 dst_sel:DWORD dst_unused:UNUSED_PAD src0_sel:DWORD src1_sel:WORD_1
    v_cvt_pk_bf16_f32 v27, v26, v27
    v_cvt_pk_bf16_f32 v26, v24, v25
    v_and_b32 v25, s23, v23
    v_lshlrev_b32 v24, 16, v23
    v_and_b32 v23, s23, v22
    v_lshlrev_b32 v22, 16, v22
    ds_read_b64 v[92:93], v92
    ds_read_b64 v[94:95], v94
    s_waitcnt lgkmcnt(9)
    v_smfmac_f32_16x16x64_bf16 v[22:25], v[66:69], v[96:103], v70
    v_mfma_f32_16x16x32_bf16 v[112:115], v[72:75], v[176:179], 0
    v_lshlrev_b32_sdwa v96, 3, v116 dst_sel:DWORD dst_unused:UNUSED_PAD src0_sel:DWORD src1_sel:WORD_0
    v_lshlrev_b32_sdwa v98, 3, v116 dst_sel:DWORD dst_unused:UNUSED_PAD src0_sel:DWORD src1_sel:WORD_1
    ds_read_b64 v[96:97], v96
    ds_read_b64 v[98:99], v98
    v_mfma_f32_16x16x32_bf16 v[112:115], v[76:79], v[180:183], v[112:115]
    v_lshlrev_b32_sdwa v100, 3, v117 dst_sel:DWORD dst_unused:UNUSED_PAD src0_sel:DWORD src1_sel:WORD_0
    v_lshlrev_b32_sdwa v102, 3, v117 dst_sel:DWORD dst_unused:UNUSED_PAD src0_sel:DWORD src1_sel:WORD_1
    ds_read_b64 v[100:101], v100
    ds_read_b64 v[102:103], v102
    s_add_u32 s20, s20, 0xfffff000
    buffer_load_dwordx4 v[116:119], v71, s[12:15], s20 offen offset:3072 sc1
    s_waitcnt lgkmcnt(9)
    v_smfmac_f32_16x16x64_bf16 v[22:25], v[66:69], v[104:111], v70
    v_mfma_f32_16x16x32_bf16 v[112:115], v[80:83], v[184:187], v[112:115]
    s_waitcnt vmcnt(2)
    v_lshlrev_b32_sdwa v104, 3, v122 dst_sel:DWORD dst_unused:UNUSED_PAD src0_sel:DWORD src1_sel:WORD_0
    v_lshlrev_b32_sdwa v106, 3, v122 dst_sel:DWORD dst_unused:UNUSED_PAD src0_sel:DWORD src1_sel:WORD_1
    ds_read_b64 v[104:105], v104
    ds_read_b64 v[106:107], v106
    v_mfma_f32_16x16x32_bf16 v[112:115], v[84:87], v[188:191], v[112:115]
    v_lshlrev_b32_sdwa v108, 3, v123 dst_sel:DWORD dst_unused:UNUSED_PAD src0_sel:DWORD src1_sel:WORD_0
    v_lshlrev_b32_sdwa v110, 3, v123 dst_sel:DWORD dst_unused:UNUSED_PAD src0_sel:DWORD src1_sel:WORD_1
    v_cvt_pk_bf16_f32 v25, v24, v25
    v_cvt_pk_bf16_f32 v24, v22, v23
    v_and_b32 v23, s23, v21
    v_lshlrev_b32 v22, 16, v21
    v_and_b32 v21, s23, v20
    v_lshlrev_b32 v20, 16, v20
    ds_read_b64 v[108:109], v108
    ds_read_b64 v[110:111], v110
    s_waitcnt lgkmcnt(8)
    v_smfmac_f32_16x16x64_bf16 v[20:23], v[66:69], v[88:95], v70
    v_cvt_pk_bf16_f32 v112, v112, v113
    v_cvt_pk_bf16_f32 v113, v114, v115
    v_lshlrev_b32_sdwa v114, 3, v70 dst_sel:DWORD dst_unused:UNUSED_PAD src0_sel:DWORD src1_sel:WORD_1
    ds_write_b64 v114, v[112:113] offset:33152
    v_lshlrev_b32_sdwa v88, 3, v120 dst_sel:DWORD dst_unused:UNUSED_PAD src0_sel:DWORD src1_sel:WORD_0
    v_lshlrev_b32_sdwa v90, 3, v120 dst_sel:DWORD dst_unused:UNUSED_PAD src0_sel:DWORD src1_sel:WORD_1
    ds_read_b64 v[88:89], v88
    ds_read_b64 v[90:91], v90
    v_lshlrev_b32_sdwa v92, 3, v121 dst_sel:DWORD dst_unused:UNUSED_PAD src0_sel:DWORD src1_sel:WORD_0
    v_lshlrev_b32_sdwa v94, 3, v121 dst_sel:DWORD dst_unused:UNUSED_PAD src0_sel:DWORD src1_sel:WORD_1
    ds_read_b64 v[92:93], v92
    ds_read_b64 v[94:95], v94
    buffer_load_dwordx4 v[120:123], v71, s[12:15], s20 offen offset:2048 sc1
    s_waitcnt lgkmcnt(9)
    v_smfmac_f32_16x16x64_bf16 v[20:23], v[66:69], v[96:103], v70
    v_mfma_f32_16x16x32_bf16 v[112:115], v[72:75], v[192:195], 0
    s_waitcnt vmcnt(2)
    v_lshlrev_b32_sdwa v96, 3, v126 dst_sel:DWORD dst_unused:UNUSED_PAD src0_sel:DWORD src1_sel:WORD_0
    v_lshlrev_b32_sdwa v98, 3, v126 dst_sel:DWORD dst_unused:UNUSED_PAD src0_sel:DWORD src1_sel:WORD_1
    ds_read_b64 v[96:97], v96
    ds_read_b64 v[98:99], v98
    v_mfma_f32_16x16x32_bf16 v[112:115], v[76:79], v[196:199], v[112:115]
    v_lshlrev_b32_sdwa v100, 3, v127 dst_sel:DWORD dst_unused:UNUSED_PAD src0_sel:DWORD src1_sel:WORD_0
    v_lshlrev_b32_sdwa v102, 3, v127 dst_sel:DWORD dst_unused:UNUSED_PAD src0_sel:DWORD src1_sel:WORD_1
    v_cvt_pk_bf16_f32 v23, v22, v23
    v_cvt_pk_bf16_f32 v22, v20, v21
    v_and_b32 v21, s23, v19
    v_lshlrev_b32 v20, 16, v19
    v_and_b32 v19, s23, v18
    v_lshlrev_b32 v18, 16, v18
    ds_read_b64 v[100:101], v100
    ds_read_b64 v[102:103], v102
    s_waitcnt lgkmcnt(9)
    v_smfmac_f32_16x16x64_bf16 v[18:21], v[66:69], v[104:111], v70
    v_mfma_f32_16x16x32_bf16 v[112:115], v[80:83], v[200:203], v[112:115]
    v_lshlrev_b32_sdwa v104, 3, v124 dst_sel:DWORD dst_unused:UNUSED_PAD src0_sel:DWORD src1_sel:WORD_0
    v_lshlrev_b32_sdwa v106, 3, v124 dst_sel:DWORD dst_unused:UNUSED_PAD src0_sel:DWORD src1_sel:WORD_1
    ds_read_b64 v[104:105], v104
    ds_read_b64 v[106:107], v106
    v_mfma_f32_16x16x32_bf16 v[112:115], v[84:87], v[204:207], v[112:115]
    v_lshlrev_b32_sdwa v108, 3, v125 dst_sel:DWORD dst_unused:UNUSED_PAD src0_sel:DWORD src1_sel:WORD_0
    v_lshlrev_b32_sdwa v110, 3, v125 dst_sel:DWORD dst_unused:UNUSED_PAD src0_sel:DWORD src1_sel:WORD_1
    ds_read_b64 v[108:109], v108
    ds_read_b64 v[110:111], v110
    buffer_load_dwordx4 v[124:127], v71, s[12:15], s20 offen offset:1024 sc1
    s_waitcnt lgkmcnt(8)
    v_smfmac_f32_16x16x64_bf16 v[18:21], v[66:69], v[88:95], v70
    s_nop 0
    v_cvt_pk_bf16_f32 v112, v112, v113
    v_cvt_pk_bf16_f32 v113, v114, v115
    v_lshlrev_b32_sdwa v114, 3, v70 dst_sel:DWORD dst_unused:UNUSED_PAD src0_sel:DWORD src1_sel:WORD_1
    ds_write_b64 v114, v[112:113] offset:33280
    s_waitcnt vmcnt(2)
    v_lshlrev_b32_sdwa v88, 3, v118 dst_sel:DWORD dst_unused:UNUSED_PAD src0_sel:DWORD src1_sel:WORD_0
    v_lshlrev_b32_sdwa v90, 3, v118 dst_sel:DWORD dst_unused:UNUSED_PAD src0_sel:DWORD src1_sel:WORD_1
    ds_read_b64 v[88:89], v88
    ds_read_b64 v[90:91], v90
    v_lshlrev_b32_sdwa v92, 3, v119 dst_sel:DWORD dst_unused:UNUSED_PAD src0_sel:DWORD src1_sel:WORD_0
    v_lshlrev_b32_sdwa v94, 3, v119 dst_sel:DWORD dst_unused:UNUSED_PAD src0_sel:DWORD src1_sel:WORD_1
    v_cvt_pk_bf16_f32 v21, v20, v21
    v_cvt_pk_bf16_f32 v20, v18, v19
    v_and_b32 v19, s23, v17
    v_lshlrev_b32 v18, 16, v17
    v_and_b32 v17, s23, v16
    v_lshlrev_b32 v16, 16, v16
    ds_read_b64 v[92:93], v92
    ds_read_b64 v[94:95], v94
    s_waitcnt lgkmcnt(9)
    v_smfmac_f32_16x16x64_bf16 v[16:19], v[66:69], v[96:103], v70
    s_setprio 2
    v_mfma_f32_16x16x32_bf16 v[112:115], v[72:75], v[208:211], 0
    v_lshlrev_b32_sdwa v96, 3, v116 dst_sel:DWORD dst_unused:UNUSED_PAD src0_sel:DWORD src1_sel:WORD_0
    v_lshlrev_b32_sdwa v98, 3, v116 dst_sel:DWORD dst_unused:UNUSED_PAD src0_sel:DWORD src1_sel:WORD_1
    ds_read_b64 v[96:97], v96
    ds_read_b64 v[98:99], v98
    v_mfma_f32_16x16x32_bf16 v[112:115], v[76:79], v[212:215], v[112:115]
    v_lshlrev_b32_sdwa v100, 3, v117 dst_sel:DWORD dst_unused:UNUSED_PAD src0_sel:DWORD src1_sel:WORD_0
    v_lshlrev_b32_sdwa v102, 3, v117 dst_sel:DWORD dst_unused:UNUSED_PAD src0_sel:DWORD src1_sel:WORD_1
    ds_read_b64 v[100:101], v100
    ds_read_b64 v[102:103], v102
    buffer_load_dwordx4 v[116:119], v71, s[12:15], s20 offen offset:0 sc1
    s_waitcnt lgkmcnt(9)
    v_smfmac_f32_16x16x64_bf16 v[16:19], v[66:69], v[104:111], v70
    v_mfma_f32_16x16x32_bf16 v[112:115], v[80:83], v[216:219], v[112:115]
    s_waitcnt vmcnt(2)
    v_lshlrev_b32_sdwa v104, 3, v122 dst_sel:DWORD dst_unused:UNUSED_PAD src0_sel:DWORD src1_sel:WORD_0
    v_lshlrev_b32_sdwa v106, 3, v122 dst_sel:DWORD dst_unused:UNUSED_PAD src0_sel:DWORD src1_sel:WORD_1
    ds_read_b64 v[104:105], v104
    ds_read_b64 v[106:107], v106
    v_mfma_f32_16x16x32_bf16 v[112:115], v[84:87], v[220:223], v[112:115]
    v_lshlrev_b32_sdwa v108, 3, v123 dst_sel:DWORD dst_unused:UNUSED_PAD src0_sel:DWORD src1_sel:WORD_0
    v_lshlrev_b32_sdwa v110, 3, v123 dst_sel:DWORD dst_unused:UNUSED_PAD src0_sel:DWORD src1_sel:WORD_1
    v_cvt_pk_bf16_f32 v19, v18, v19
    v_cvt_pk_bf16_f32 v18, v16, v17
    v_and_b32 v17, s23, v15
    v_lshlrev_b32 v16, 16, v15
    v_and_b32 v15, s23, v14
    v_lshlrev_b32 v14, 16, v14
    ds_read_b64 v[108:109], v108
    ds_read_b64 v[110:111], v110
    s_waitcnt lgkmcnt(8)
    v_smfmac_f32_16x16x64_bf16 v[14:17], v[66:69], v[88:95], v70
    v_cvt_pk_bf16_f32 v112, v112, v113
    v_cvt_pk_bf16_f32 v113, v114, v115
    v_lshlrev_b32_sdwa v114, 3, v70 dst_sel:DWORD dst_unused:UNUSED_PAD src0_sel:DWORD src1_sel:WORD_1
    ds_write_b64 v114, v[112:113] offset:33408
    v_lshlrev_b32_sdwa v88, 3, v120 dst_sel:DWORD dst_unused:UNUSED_PAD src0_sel:DWORD src1_sel:WORD_0
    v_lshlrev_b32_sdwa v90, 3, v120 dst_sel:DWORD dst_unused:UNUSED_PAD src0_sel:DWORD src1_sel:WORD_1
    ds_read_b64 v[88:89], v88
    ds_read_b64 v[90:91], v90
    v_lshlrev_b32_sdwa v92, 3, v121 dst_sel:DWORD dst_unused:UNUSED_PAD src0_sel:DWORD src1_sel:WORD_0
    v_lshlrev_b32_sdwa v94, 3, v121 dst_sel:DWORD dst_unused:UNUSED_PAD src0_sel:DWORD src1_sel:WORD_1
    ds_read_b64 v[92:93], v92
    ds_read_b64 v[94:95], v94
    s_add_u32 s20, s20, 0xfffffc00
    buffer_load_dwordx4 v[120:123], v71, s[12:15], s20 offen offset:0 sc1
    s_waitcnt lgkmcnt(9)
    v_smfmac_f32_16x16x64_bf16 v[14:17], v[66:69], v[96:103], v70
    v_mfma_f32_16x16x32_bf16 v[112:115], v[72:75], v[224:227], 0
    s_waitcnt vmcnt(2)
    v_lshlrev_b32_sdwa v96, 3, v126 dst_sel:DWORD dst_unused:UNUSED_PAD src0_sel:DWORD src1_sel:WORD_0
    v_lshlrev_b32_sdwa v98, 3, v126 dst_sel:DWORD dst_unused:UNUSED_PAD src0_sel:DWORD src1_sel:WORD_1
    ds_read_b64 v[96:97], v96
    ds_read_b64 v[98:99], v98
    v_mfma_f32_16x16x32_bf16 v[112:115], v[76:79], v[228:231], v[112:115]
    v_lshlrev_b32_sdwa v100, 3, v127 dst_sel:DWORD dst_unused:UNUSED_PAD src0_sel:DWORD src1_sel:WORD_0
    v_lshlrev_b32_sdwa v102, 3, v127 dst_sel:DWORD dst_unused:UNUSED_PAD src0_sel:DWORD src1_sel:WORD_1
    v_cvt_pk_bf16_f32 v17, v16, v17
    v_cvt_pk_bf16_f32 v16, v14, v15
    v_and_b32 v15, s23, v13
    v_lshlrev_b32 v14, 16, v13
    v_and_b32 v13, s23, v12
    v_lshlrev_b32 v12, 16, v12
    ds_read_b64 v[100:101], v100
    ds_read_b64 v[102:103], v102
    s_waitcnt lgkmcnt(9)
    v_smfmac_f32_16x16x64_bf16 v[12:15], v[66:69], v[104:111], v70
    v_mfma_f32_16x16x32_bf16 v[112:115], v[80:83], v[232:235], v[112:115]
    v_lshlrev_b32_sdwa v104, 3, v124 dst_sel:DWORD dst_unused:UNUSED_PAD src0_sel:DWORD src1_sel:WORD_0
    v_lshlrev_b32_sdwa v106, 3, v124 dst_sel:DWORD dst_unused:UNUSED_PAD src0_sel:DWORD src1_sel:WORD_1
    ds_read_b64 v[104:105], v104
    ds_read_b64 v[106:107], v106
    v_mfma_f32_16x16x32_bf16 v[112:115], v[84:87], v[236:239], v[112:115]
    v_lshlrev_b32_sdwa v108, 3, v125 dst_sel:DWORD dst_unused:UNUSED_PAD src0_sel:DWORD src1_sel:WORD_0
    v_lshlrev_b32_sdwa v110, 3, v125 dst_sel:DWORD dst_unused:UNUSED_PAD src0_sel:DWORD src1_sel:WORD_1
    ds_read_b64 v[108:109], v108
    ds_read_b64 v[110:111], v110
    s_add_u32 s20, s20, 0xfffffc00
    buffer_load_dwordx4 v[124:127], v71, s[12:15], s20 offen offset:0 sc1
    s_waitcnt lgkmcnt(8)
    v_smfmac_f32_16x16x64_bf16 v[12:15], v[66:69], v[88:95], v70
    v_cvt_pk_bf16_f32 v112, v112, v113
    v_cvt_pk_bf16_f32 v113, v114, v115
    v_lshlrev_b32_sdwa v114, 3, v70 dst_sel:DWORD dst_unused:UNUSED_PAD src0_sel:DWORD src1_sel:WORD_1
    ds_write_b64 v114, v[112:113] offset:33536
    s_waitcnt vmcnt(2)
    v_lshlrev_b32_sdwa v88, 3, v118 dst_sel:DWORD dst_unused:UNUSED_PAD src0_sel:DWORD src1_sel:WORD_0
    v_lshlrev_b32_sdwa v90, 3, v118 dst_sel:DWORD dst_unused:UNUSED_PAD src0_sel:DWORD src1_sel:WORD_1
    ds_read_b64 v[88:89], v88
    ds_read_b64 v[90:91], v90
    v_lshlrev_b32_sdwa v92, 3, v119 dst_sel:DWORD dst_unused:UNUSED_PAD src0_sel:DWORD src1_sel:WORD_0
    v_lshlrev_b32_sdwa v94, 3, v119 dst_sel:DWORD dst_unused:UNUSED_PAD src0_sel:DWORD src1_sel:WORD_1
    v_cvt_pk_bf16_f32 v15, v14, v15
    v_cvt_pk_bf16_f32 v14, v12, v13
    v_and_b32 v13, s23, v11
    v_lshlrev_b32 v12, 16, v11
    v_and_b32 v11, s23, v10
    v_lshlrev_b32 v10, 16, v10
    ds_read_b64 v[92:93], v92
    ds_read_b64 v[94:95], v94
    s_waitcnt lgkmcnt(9)
    v_smfmac_f32_16x16x64_bf16 v[10:13], v[66:69], v[96:103], v70
    v_mfma_f32_16x16x32_bf16 v[112:115], v[72:75], v[240:243], 0
    buffer_load_dwordx4 v[72:75], v71, s[12:15], s21 offen offset:0
    v_lshlrev_b32_sdwa v96, 3, v116 dst_sel:DWORD dst_unused:UNUSED_PAD src0_sel:DWORD src1_sel:WORD_0
    v_lshlrev_b32_sdwa v98, 3, v116 dst_sel:DWORD dst_unused:UNUSED_PAD src0_sel:DWORD src1_sel:WORD_1
    ds_read_b64 v[96:97], v96
    ds_read_b64 v[98:99], v98
    v_mfma_f32_16x16x32_bf16 v[112:115], v[76:79], v[244:247], v[112:115]
    buffer_load_dwordx4 v[76:79], v71, s[12:15], s21 offen offset:1024
    v_lshlrev_b32_sdwa v100, 3, v117 dst_sel:DWORD dst_unused:UNUSED_PAD src0_sel:DWORD src1_sel:WORD_0
    v_lshlrev_b32_sdwa v102, 3, v117 dst_sel:DWORD dst_unused:UNUSED_PAD src0_sel:DWORD src1_sel:WORD_1
    ds_read_b64 v[100:101], v100
    ds_read_b64 v[102:103], v102
    s_add_u32 s20, s20, 0x3c00
    buffer_load_dwordx4 v[116:119], v71, s[12:15], s20 offen offset:0 sc1
    s_waitcnt lgkmcnt(9)
    v_smfmac_f32_16x16x64_bf16 v[10:13], v[66:69], v[104:111], v70
    v_mfma_f32_16x16x32_bf16 v[112:115], v[80:83], v[248:251], v[112:115]
    buffer_load_dwordx4 v[80:83], v71, s[12:15], s19 offen offset:0
    s_waitcnt vmcnt(5)
    v_lshlrev_b32_sdwa v104, 3, v122 dst_sel:DWORD dst_unused:UNUSED_PAD src0_sel:DWORD src1_sel:WORD_0
    v_lshlrev_b32_sdwa v106, 3, v122 dst_sel:DWORD dst_unused:UNUSED_PAD src0_sel:DWORD src1_sel:WORD_1
    ds_read_b64 v[104:105], v104
    ds_read_b64 v[106:107], v106
    v_mfma_f32_16x16x32_bf16 v[112:115], v[84:87], v[252:255], v[112:115]
    buffer_load_dwordx4 v[84:87], v71, s[12:15], s19 offen offset:1024
    s_add_u32 s21, s21, 4096
    s_add_u32 s19, s19, 4096
    v_lshlrev_b32_sdwa v108, 3, v123 dst_sel:DWORD dst_unused:UNUSED_PAD src0_sel:DWORD src1_sel:WORD_0
    v_lshlrev_b32_sdwa v110, 3, v123 dst_sel:DWORD dst_unused:UNUSED_PAD src0_sel:DWORD src1_sel:WORD_1
    v_cvt_pk_bf16_f32 v13, v12, v13
    v_cvt_pk_bf16_f32 v12, v10, v11
    v_and_b32 v11, s23, v9
    v_lshlrev_b32 v10, 16, v9
    v_and_b32 v9, s23, v8
    v_lshlrev_b32 v8, 16, v8
    ds_read_b64 v[108:109], v108
    ds_read_b64 v[110:111], v110
    s_waitcnt lgkmcnt(8)
    v_smfmac_f32_16x16x64_bf16 v[8:11], v[66:69], v[88:95], v70
    v_cvt_pk_bf16_f32 v112, v112, v113
    v_cvt_pk_bf16_f32 v113, v114, v115
    v_lshlrev_b32_sdwa v114, 3, v70 dst_sel:DWORD dst_unused:UNUSED_PAD src0_sel:DWORD src1_sel:WORD_1
    ds_write_b64 v114, v[112:113] offset:33664
    s_setprio 1
    v_lshlrev_b32_sdwa v88, 3, v120 dst_sel:DWORD dst_unused:UNUSED_PAD src0_sel:DWORD src1_sel:WORD_0
    v_lshlrev_b32_sdwa v90, 3, v120 dst_sel:DWORD dst_unused:UNUSED_PAD src0_sel:DWORD src1_sel:WORD_1
    ds_read_b64 v[88:89], v88
    ds_read_b64 v[90:91], v90
    v_lshlrev_b32_sdwa v92, 3, v121 dst_sel:DWORD dst_unused:UNUSED_PAD src0_sel:DWORD src1_sel:WORD_0
    v_lshlrev_b32_sdwa v94, 3, v121 dst_sel:DWORD dst_unused:UNUSED_PAD src0_sel:DWORD src1_sel:WORD_1
    ds_read_b64 v[92:93], v92
    ds_read_b64 v[94:95], v94
    s_add_u32 s20, s20, 0xfffffc00
    buffer_load_dwordx4 v[120:123], v71, s[12:15], s20 offen offset:0 sc1
    s_waitcnt lgkmcnt(9)
    v_smfmac_f32_16x16x64_bf16 v[8:11], v[66:69], v[96:103], v70
    s_waitcnt vmcnt(6)
    v_lshlrev_b32_sdwa v96, 3, v126 dst_sel:DWORD dst_unused:UNUSED_PAD src0_sel:DWORD src1_sel:WORD_0
    v_lshlrev_b32_sdwa v98, 3, v126 dst_sel:DWORD dst_unused:UNUSED_PAD src0_sel:DWORD src1_sel:WORD_1
    ds_read_b64 v[96:97], v96
    ds_read_b64 v[98:99], v98
    v_lshlrev_b32_sdwa v100, 3, v127 dst_sel:DWORD dst_unused:UNUSED_PAD src0_sel:DWORD src1_sel:WORD_0
    v_lshlrev_b32_sdwa v102, 3, v127 dst_sel:DWORD dst_unused:UNUSED_PAD src0_sel:DWORD src1_sel:WORD_1
    s_nop 0
    v_cvt_pk_bf16_f32 v11, v10, v11
    v_cvt_pk_bf16_f32 v10, v8, v9
    v_and_b32 v9, s23, v7
    v_lshlrev_b32 v8, 16, v7
    v_and_b32 v7, s23, v6
    v_lshlrev_b32 v6, 16, v6
    ds_read_b64 v[100:101], v100
    ds_read_b64 v[102:103], v102
    s_waitcnt lgkmcnt(9)
    v_smfmac_f32_16x16x64_bf16 v[6:9], v[66:69], v[104:111], v70
    v_lshlrev_b32_sdwa v104, 3, v124 dst_sel:DWORD dst_unused:UNUSED_PAD src0_sel:DWORD src1_sel:WORD_0
    v_lshlrev_b32_sdwa v106, 3, v124 dst_sel:DWORD dst_unused:UNUSED_PAD src0_sel:DWORD src1_sel:WORD_1
    ds_read_b64 v[104:105], v104
    ds_read_b64 v[106:107], v106
    v_lshlrev_b32_sdwa v108, 3, v125 dst_sel:DWORD dst_unused:UNUSED_PAD src0_sel:DWORD src1_sel:WORD_0
    v_lshlrev_b32_sdwa v110, 3, v125 dst_sel:DWORD dst_unused:UNUSED_PAD src0_sel:DWORD src1_sel:WORD_1
    ds_read_b64 v[108:109], v108
    ds_read_b64 v[110:111], v110
    s_add_u32 s20, s20, 0x1f000
    buffer_load_dwordx4 v[124:127], v71, s[12:15], s20 offen offset:3072 sc1
    s_waitcnt lgkmcnt(8)
    v_smfmac_f32_16x16x64_bf16 v[6:9], v[66:69], v[88:95], v70
    s_waitcnt vmcnt(4)
    v_lshlrev_b32_sdwa v88, 3, v118 dst_sel:DWORD dst_unused:UNUSED_PAD src0_sel:DWORD src1_sel:WORD_0
    v_lshlrev_b32_sdwa v90, 3, v118 dst_sel:DWORD dst_unused:UNUSED_PAD src0_sel:DWORD src1_sel:WORD_1
    ds_read_b64 v[88:89], v88
    ds_read_b64 v[90:91], v90
    v_lshlrev_b32_sdwa v92, 3, v119 dst_sel:DWORD dst_unused:UNUSED_PAD src0_sel:DWORD src1_sel:WORD_0
    v_lshlrev_b32_sdwa v94, 3, v119 dst_sel:DWORD dst_unused:UNUSED_PAD src0_sel:DWORD src1_sel:WORD_1
    s_nop 0
    v_cvt_pk_bf16_f32 v9, v8, v9
    v_cvt_pk_bf16_f32 v8, v6, v7
    v_and_b32 v7, s23, v5
    v_lshlrev_b32 v6, 16, v5
    v_and_b32 v5, s23, v4
    v_lshlrev_b32 v4, 16, v4
    ds_read_b64 v[92:93], v92
    ds_read_b64 v[94:95], v94
    s_waitcnt lgkmcnt(8)
    v_smfmac_f32_16x16x64_bf16 v[4:7], v[66:69], v[96:103], v70
    v_lshlrev_b32_sdwa v96, 3, v116 dst_sel:DWORD dst_unused:UNUSED_PAD src0_sel:DWORD src1_sel:WORD_0
    v_lshlrev_b32_sdwa v98, 3, v116 dst_sel:DWORD dst_unused:UNUSED_PAD src0_sel:DWORD src1_sel:WORD_1
    ds_read_b64 v[96:97], v96
    ds_read_b64 v[98:99], v98
    v_lshlrev_b32_sdwa v100, 3, v117 dst_sel:DWORD dst_unused:UNUSED_PAD src0_sel:DWORD src1_sel:WORD_0
    v_lshlrev_b32_sdwa v102, 3, v117 dst_sel:DWORD dst_unused:UNUSED_PAD src0_sel:DWORD src1_sel:WORD_1
    ds_read_b64 v[100:101], v100
    ds_read_b64 v[102:103], v102
    buffer_load_dwordx4 v[116:119], v71, s[12:15], s20 offen offset:2048 sc1
    s_waitcnt lgkmcnt(8)
    v_smfmac_f32_16x16x64_bf16 v[4:7], v[66:69], v[104:111], v70
    s_waitcnt vmcnt(2)
    v_lshlrev_b32_sdwa v104, 3, v122 dst_sel:DWORD dst_unused:UNUSED_PAD src0_sel:DWORD src1_sel:WORD_0
    v_lshlrev_b32_sdwa v106, 3, v122 dst_sel:DWORD dst_unused:UNUSED_PAD src0_sel:DWORD src1_sel:WORD_1
    ds_read_b64 v[104:105], v104
    ds_read_b64 v[106:107], v106
    v_lshlrev_b32_sdwa v108, 3, v123 dst_sel:DWORD dst_unused:UNUSED_PAD src0_sel:DWORD src1_sel:WORD_0
    v_lshlrev_b32_sdwa v110, 3, v123 dst_sel:DWORD dst_unused:UNUSED_PAD src0_sel:DWORD src1_sel:WORD_1
    s_nop 0
    v_cvt_pk_bf16_f32 v7, v6, v7
    v_cvt_pk_bf16_f32 v6, v4, v5
    v_and_b32 v5, s23, v3
    v_lshlrev_b32 v4, 16, v3
    v_and_b32 v3, s23, v2
    v_lshlrev_b32 v2, 16, v2
    ds_read_b64 v[108:109], v108
    ds_read_b64 v[110:111], v110
    s_waitcnt lgkmcnt(8)
    v_smfmac_f32_16x16x64_bf16 v[2:5], v[66:69], v[88:95], v70
    s_setprio 0
    v_lshlrev_b32_sdwa v88, 3, v120 dst_sel:DWORD dst_unused:UNUSED_PAD src0_sel:DWORD src1_sel:WORD_0
    v_lshlrev_b32_sdwa v90, 3, v120 dst_sel:DWORD dst_unused:UNUSED_PAD src0_sel:DWORD src1_sel:WORD_1
    ds_read_b64 v[88:89], v88
    ds_read_b64 v[90:91], v90
    v_lshlrev_b32_sdwa v92, 3, v121 dst_sel:DWORD dst_unused:UNUSED_PAD src0_sel:DWORD src1_sel:WORD_0
    v_lshlrev_b32_sdwa v94, 3, v121 dst_sel:DWORD dst_unused:UNUSED_PAD src0_sel:DWORD src1_sel:WORD_1
    ds_read_b64 v[92:93], v92
    ds_read_b64 v[94:95], v94
    buffer_load_dwordx4 v[120:123], v71, s[12:15], s20 offen offset:1024 sc1
    s_waitcnt lgkmcnt(8)
    v_smfmac_f32_16x16x64_bf16 v[2:5], v[66:69], v[96:103], v70
    s_waitcnt vmcnt(2)
    v_lshlrev_b32_sdwa v96, 3, v124 dst_sel:DWORD dst_unused:UNUSED_PAD src0_sel:DWORD src1_sel:WORD_0
    v_lshlrev_b32_sdwa v98, 3, v124 dst_sel:DWORD dst_unused:UNUSED_PAD src0_sel:DWORD src1_sel:WORD_1
    ds_read_b64 v[96:97], v96
    ds_read_b64 v[98:99], v98
    v_lshlrev_b32_sdwa v100, 3, v125 dst_sel:DWORD dst_unused:UNUSED_PAD src0_sel:DWORD src1_sel:WORD_0
    v_lshlrev_b32_sdwa v102, 3, v125 dst_sel:DWORD dst_unused:UNUSED_PAD src0_sel:DWORD src1_sel:WORD_1
    s_nop 0
    v_cvt_pk_bf16_f32 v5, v4, v5
    v_cvt_pk_bf16_f32 v4, v2, v3
    v_and_b32 v3, s23, v1
    v_lshlrev_b32 v2, 16, v1
    v_and_b32 v1, s23, v0
    v_lshlrev_b32 v0, 16, v0
    ds_read_b64 v[100:101], v100
    ds_read_b64 v[102:103], v102
    s_waitcnt lgkmcnt(8)
    v_smfmac_f32_16x16x64_bf16 v[0:3], v[66:69], v[104:111], v70
    s_waitcnt lgkmcnt(4)
    s_barrier
    s_setprio 3
    v_lshlrev_b32_sdwa v104, 3, v126 dst_sel:DWORD dst_unused:UNUSED_PAD src0_sel:DWORD src1_sel:WORD_0
    v_lshlrev_b32_sdwa v106, 3, v126 dst_sel:DWORD dst_unused:UNUSED_PAD src0_sel:DWORD src1_sel:WORD_1
    ds_read_b64 v[104:105], v104
    ds_read_b64 v[106:107], v106
    v_lshlrev_b32_sdwa v108, 3, v127 dst_sel:DWORD dst_unused:UNUSED_PAD src0_sel:DWORD src1_sel:WORD_0
    v_lshlrev_b32_sdwa v110, 3, v127 dst_sel:DWORD dst_unused:UNUSED_PAD src0_sel:DWORD src1_sel:WORD_1
    ds_read_b64 v[108:109], v108
    ds_read_b64 v[110:111], v110
    buffer_load_dwordx4 v[124:127], v71, s[12:15], s20 offen offset:0 sc1
    v_smfmac_f32_16x16x64_bf16 v[0:3], v[66:69], v[88:95], v70
    v_mfma_f32_16x16x32_bf16 v[112:115], v[72:75], v[128:131], 0
    v_mfma_f32_16x16x32_bf16 v[112:115], v[76:79], v[132:135], v[112:115]
    s_nop 0
    v_add_u32 v70, 0x20000000, v70
    s_waitcnt vmcnt(2)
    v_lshlrev_b32_sdwa v88, 3, v116 dst_sel:DWORD dst_unused:UNUSED_PAD src0_sel:DWORD src1_sel:WORD_0
    v_lshlrev_b32_sdwa v90, 3, v116 dst_sel:DWORD dst_unused:UNUSED_PAD src0_sel:DWORD src1_sel:WORD_1
    ds_read_b64 v[88:89], v88
    ds_read_b64 v[90:91], v90
    v_mfma_f32_16x16x32_bf16 v[112:115], v[80:83], v[136:139], v[112:115]
    v_mfma_f32_16x16x32_bf16 v[112:115], v[84:87], v[140:143], v[112:115]
    v_lshlrev_b32_sdwa v92, 3, v117 dst_sel:DWORD dst_unused:UNUSED_PAD src0_sel:DWORD src1_sel:WORD_0
    v_lshlrev_b32_sdwa v94, 3, v117 dst_sel:DWORD dst_unused:UNUSED_PAD src0_sel:DWORD src1_sel:WORD_1
    v_cvt_pk_bf16_f32 v3, v2, v3
    v_cvt_pk_bf16_f32 v2, v0, v1
    v_mov_b64 v[0:1], v[32:33]
    v_lshlrev_b32 v32, 16, v34
    v_and_b32 v33, s23, v34
    v_lshlrev_b32 v34, 16, v35
    v_and_b32 v35, s23, v35
    ds_read_b64 v[92:93], v92
    ds_read_b64 v[94:95], v94
    s_waitcnt lgkmcnt(8)
    v_smfmac_f32_16x16x64_bf16 v[32:35], v[66:69], v[96:103], v70
    v_cvt_pk_bf16_f32 v112, v112, v113
    v_cvt_pk_bf16_f32 v113, v114, v115
    v_lshlrev_b32_sdwa v114, 3, v70 dst_sel:DWORD dst_unused:UNUSED_PAD src0_sel:DWORD src1_sel:WORD_1
    ds_write_b64 v114, v[112:113] offset:0
    v_mfma_f32_16x16x32_bf16 v[112:115], v[72:75], v[144:147], 0
    v_mfma_f32_16x16x32_bf16 v[112:115], v[76:79], v[148:151], v[112:115]
    v_lshlrev_b32_sdwa v96, 3, v118 dst_sel:DWORD dst_unused:UNUSED_PAD src0_sel:DWORD src1_sel:WORD_0
    v_lshlrev_b32_sdwa v98, 3, v118 dst_sel:DWORD dst_unused:UNUSED_PAD src0_sel:DWORD src1_sel:WORD_1
    ds_read_b64 v[96:97], v96
    ds_read_b64 v[98:99], v98
    v_mfma_f32_16x16x32_bf16 v[112:115], v[80:83], v[152:155], v[112:115]
    v_mfma_f32_16x16x32_bf16 v[112:115], v[84:87], v[156:159], v[112:115]
    v_lshlrev_b32_sdwa v100, 3, v119 dst_sel:DWORD dst_unused:UNUSED_PAD src0_sel:DWORD src1_sel:WORD_0
    v_lshlrev_b32_sdwa v102, 3, v119 dst_sel:DWORD dst_unused:UNUSED_PAD src0_sel:DWORD src1_sel:WORD_1
    ds_read_b64 v[100:101], v100
    ds_read_b64 v[102:103], v102
    s_add_u32 s20, s20, 0xfffff000
    buffer_load_dwordx4 v[116:119], v71, s[12:15], s20 offen offset:3072 sc1
    s_waitcnt lgkmcnt(9)
    v_smfmac_f32_16x16x64_bf16 v[32:35], v[66:69], v[104:111], v70
    v_cvt_pk_bf16_f32 v112, v112, v113
    v_cvt_pk_bf16_f32 v113, v114, v115
    v_lshlrev_b32_sdwa v114, 3, v70 dst_sel:DWORD dst_unused:UNUSED_PAD src0_sel:DWORD src1_sel:WORD_1
    ds_write_b64 v114, v[112:113] offset:128
    v_mfma_f32_16x16x32_bf16 v[112:115], v[72:75], v[160:163], 0
    v_mfma_f32_16x16x32_bf16 v[112:115], v[76:79], v[164:167], v[112:115]
    s_waitcnt vmcnt(2)
    v_lshlrev_b32_sdwa v104, 3, v120 dst_sel:DWORD dst_unused:UNUSED_PAD src0_sel:DWORD src1_sel:WORD_0
    v_lshlrev_b32_sdwa v106, 3, v120 dst_sel:DWORD dst_unused:UNUSED_PAD src0_sel:DWORD src1_sel:WORD_1
    ds_read_b64 v[104:105], v104
    ds_read_b64 v[106:107], v106
    v_mfma_f32_16x16x32_bf16 v[112:115], v[80:83], v[168:171], v[112:115]
    v_mfma_f32_16x16x32_bf16 v[112:115], v[84:87], v[172:175], v[112:115]
    v_lshlrev_b32_sdwa v108, 3, v121 dst_sel:DWORD dst_unused:UNUSED_PAD src0_sel:DWORD src1_sel:WORD_0
    v_lshlrev_b32_sdwa v110, 3, v121 dst_sel:DWORD dst_unused:UNUSED_PAD src0_sel:DWORD src1_sel:WORD_1
    v_cvt_pk_bf16_f32 v32, v32, v33
    v_cvt_pk_bf16_f32 v33, v34, v35
    v_lshlrev_b32 v34, 16, v36
    v_and_b32 v35, s23, v36
    v_lshlrev_b32 v36, 16, v37
    v_and_b32 v37, s23, v37
    ds_read_b64 v[108:109], v108
    ds_read_b64 v[110:111], v110
    s_waitcnt lgkmcnt(10)
    v_smfmac_f32_16x16x64_bf16 v[34:37], v[66:69], v[88:95], v70
    v_cvt_pk_bf16_f32 v112, v112, v113
    v_cvt_pk_bf16_f32 v113, v114, v115
    v_lshlrev_b32_sdwa v114, 3, v70 dst_sel:DWORD dst_unused:UNUSED_PAD src0_sel:DWORD src1_sel:WORD_1
    ds_write_b64 v114, v[112:113] offset:256
    v_mfma_f32_16x16x32_bf16 v[112:115], v[72:75], v[176:179], 0
    v_mfma_f32_16x16x32_bf16 v[112:115], v[76:79], v[180:183], v[112:115]
    v_lshlrev_b32_sdwa v88, 3, v122 dst_sel:DWORD dst_unused:UNUSED_PAD src0_sel:DWORD src1_sel:WORD_0
    v_lshlrev_b32_sdwa v90, 3, v122 dst_sel:DWORD dst_unused:UNUSED_PAD src0_sel:DWORD src1_sel:WORD_1
    ds_read_b64 v[88:89], v88
    ds_read_b64 v[90:91], v90
    v_mfma_f32_16x16x32_bf16 v[112:115], v[80:83], v[184:187], v[112:115]
    v_mfma_f32_16x16x32_bf16 v[112:115], v[84:87], v[188:191], v[112:115]
    v_lshlrev_b32_sdwa v92, 3, v123 dst_sel:DWORD dst_unused:UNUSED_PAD src0_sel:DWORD src1_sel:WORD_0
    v_lshlrev_b32_sdwa v94, 3, v123 dst_sel:DWORD dst_unused:UNUSED_PAD src0_sel:DWORD src1_sel:WORD_1
    ds_read_b64 v[92:93], v92
    ds_read_b64 v[94:95], v94
    buffer_load_dwordx4 v[120:123], v71, s[12:15], s20 offen offset:2048 sc1
    s_waitcnt lgkmcnt(10)
    v_smfmac_f32_16x16x64_bf16 v[34:37], v[66:69], v[96:103], v70
    s_nop 0
    v_cvt_pk_bf16_f32 v112, v112, v113
    v_cvt_pk_bf16_f32 v113, v114, v115
    v_lshlrev_b32_sdwa v114, 3, v70 dst_sel:DWORD dst_unused:UNUSED_PAD src0_sel:DWORD src1_sel:WORD_1
    ds_write_b64 v114, v[112:113] offset:384
    v_mfma_f32_16x16x32_bf16 v[112:115], v[72:75], v[192:195], 0
    v_mfma_f32_16x16x32_bf16 v[112:115], v[76:79], v[196:199], v[112:115]
    s_waitcnt vmcnt(2)
    v_lshlrev_b32_sdwa v96, 3, v124 dst_sel:DWORD dst_unused:UNUSED_PAD src0_sel:DWORD src1_sel:WORD_0
    v_lshlrev_b32_sdwa v98, 3, v124 dst_sel:DWORD dst_unused:UNUSED_PAD src0_sel:DWORD src1_sel:WORD_1
    ds_read_b64 v[96:97], v96
    ds_read_b64 v[98:99], v98
    v_mfma_f32_16x16x32_bf16 v[112:115], v[80:83], v[200:203], v[112:115]
    v_mfma_f32_16x16x32_bf16 v[112:115], v[84:87], v[204:207], v[112:115]
    v_lshlrev_b32_sdwa v100, 3, v125 dst_sel:DWORD dst_unused:UNUSED_PAD src0_sel:DWORD src1_sel:WORD_0
    v_lshlrev_b32_sdwa v102, 3, v125 dst_sel:DWORD dst_unused:UNUSED_PAD src0_sel:DWORD src1_sel:WORD_1
    v_cvt_pk_bf16_f32 v34, v34, v35
    v_cvt_pk_bf16_f32 v35, v36, v37
    v_lshlrev_b32 v36, 16, v38
    v_and_b32 v37, s23, v38
    v_lshlrev_b32 v38, 16, v39
    v_and_b32 v39, s23, v39
    ds_read_b64 v[100:101], v100
    ds_read_b64 v[102:103], v102
    s_waitcnt lgkmcnt(10)
    v_smfmac_f32_16x16x64_bf16 v[36:39], v[66:69], v[104:111], v70
    v_cvt_pk_bf16_f32 v112, v112, v113
    v_cvt_pk_bf16_f32 v113, v114, v115
    v_lshlrev_b32_sdwa v114, 3, v70 dst_sel:DWORD dst_unused:UNUSED_PAD src0_sel:DWORD src1_sel:WORD_1
    ds_write_b64 v114, v[112:113] offset:512
    v_mfma_f32_16x16x32_bf16 v[112:115], v[72:75], v[208:211], 0
    v_mfma_f32_16x16x32_bf16 v[112:115], v[76:79], v[212:215], v[112:115]
    v_lshlrev_b32_sdwa v104, 3, v126 dst_sel:DWORD dst_unused:UNUSED_PAD src0_sel:DWORD src1_sel:WORD_0
    v_lshlrev_b32_sdwa v106, 3, v126 dst_sel:DWORD dst_unused:UNUSED_PAD src0_sel:DWORD src1_sel:WORD_1
    ds_read_b64 v[104:105], v104
    ds_read_b64 v[106:107], v106
    v_mfma_f32_16x16x32_bf16 v[112:115], v[80:83], v[216:219], v[112:115]
    v_mfma_f32_16x16x32_bf16 v[112:115], v[84:87], v[220:223], v[112:115]
    v_lshlrev_b32_sdwa v108, 3, v127 dst_sel:DWORD dst_unused:UNUSED_PAD src0_sel:DWORD src1_sel:WORD_0
    v_lshlrev_b32_sdwa v110, 3, v127 dst_sel:DWORD dst_unused:UNUSED_PAD src0_sel:DWORD src1_sel:WORD_1
    ds_read_b64 v[108:109], v108
    ds_read_b64 v[110:111], v110
    buffer_load_dwordx4 v[124:127], v71, s[12:15], s20 offen offset:1024 sc1
    s_waitcnt lgkmcnt(10)
    v_smfmac_f32_16x16x64_bf16 v[36:39], v[66:69], v[88:95], v70
    s_nop 0
    v_cvt_pk_bf16_f32 v112, v112, v113
    v_cvt_pk_bf16_f32 v113, v114, v115
    v_lshlrev_b32_sdwa v114, 3, v70 dst_sel:DWORD dst_unused:UNUSED_PAD src0_sel:DWORD src1_sel:WORD_1
    ds_write_b64 v114, v[112:113] offset:640
    v_mfma_f32_16x16x32_bf16 v[112:115], v[72:75], v[224:227], 0
    v_mfma_f32_16x16x32_bf16 v[112:115], v[76:79], v[228:231], v[112:115]
    s_waitcnt vmcnt(2)
    v_lshlrev_b32_sdwa v88, 3, v116 dst_sel:DWORD dst_unused:UNUSED_PAD src0_sel:DWORD src1_sel:WORD_0
    v_lshlrev_b32_sdwa v90, 3, v116 dst_sel:DWORD dst_unused:UNUSED_PAD src0_sel:DWORD src1_sel:WORD_1
    ds_read_b64 v[88:89], v88
    ds_read_b64 v[90:91], v90
    v_mfma_f32_16x16x32_bf16 v[112:115], v[80:83], v[232:235], v[112:115]
    v_mfma_f32_16x16x32_bf16 v[112:115], v[84:87], v[236:239], v[112:115]
    v_lshlrev_b32_sdwa v92, 3, v117 dst_sel:DWORD dst_unused:UNUSED_PAD src0_sel:DWORD src1_sel:WORD_0
    v_lshlrev_b32_sdwa v94, 3, v117 dst_sel:DWORD dst_unused:UNUSED_PAD src0_sel:DWORD src1_sel:WORD_1
    v_cvt_pk_bf16_f32 v36, v36, v37
    v_cvt_pk_bf16_f32 v37, v38, v39
    v_lshlrev_b32 v38, 16, v40
    v_and_b32 v39, s23, v40
    v_lshlrev_b32 v40, 16, v41
    v_and_b32 v41, s23, v41
    ds_read_b64 v[92:93], v92
    ds_read_b64 v[94:95], v94
    s_waitcnt lgkmcnt(10)
    v_smfmac_f32_16x16x64_bf16 v[38:41], v[66:69], v[96:103], v70
    v_cvt_pk_bf16_f32 v112, v112, v113
    v_cvt_pk_bf16_f32 v113, v114, v115
    v_lshlrev_b32_sdwa v114, 3, v70 dst_sel:DWORD dst_unused:UNUSED_PAD src0_sel:DWORD src1_sel:WORD_1
    ds_write_b64 v114, v[112:113] offset:768
    v_mfma_f32_16x16x32_bf16 v[112:115], v[72:75], v[240:243], 0
    buffer_load_dwordx4 v[72:75], v71, s[12:15], s21 offen offset:0
    v_mfma_f32_16x16x32_bf16 v[112:115], v[76:79], v[244:247], v[112:115]
    buffer_load_dwordx4 v[76:79], v71, s[12:15], s21 offen offset:1024
    v_lshlrev_b32_sdwa v96, 3, v118 dst_sel:DWORD dst_unused:UNUSED_PAD src0_sel:DWORD src1_sel:WORD_0
    v_lshlrev_b32_sdwa v98, 3, v118 dst_sel:DWORD dst_unused:UNUSED_PAD src0_sel:DWORD src1_sel:WORD_1
    ds_read_b64 v[96:97], v96
    ds_read_b64 v[98:99], v98
    v_mfma_f32_16x16x32_bf16 v[112:115], v[80:83], v[248:251], v[112:115]
    buffer_load_dwordx4 v[80:83], v71, s[12:15], s19 offen offset:0
    v_mfma_f32_16x16x32_bf16 v[112:115], v[84:87], v[252:255], v[112:115]
    buffer_load_dwordx4 v[84:87], v71, s[12:15], s19 offen offset:1024
    s_add_u32 s21, s21, 4096
    s_add_u32 s19, s19, 4096
    v_lshlrev_b32_sdwa v100, 3, v119 dst_sel:DWORD dst_unused:UNUSED_PAD src0_sel:DWORD src1_sel:WORD_0
    v_lshlrev_b32_sdwa v102, 3, v119 dst_sel:DWORD dst_unused:UNUSED_PAD src0_sel:DWORD src1_sel:WORD_1
    ds_read_b64 v[100:101], v100
    ds_read_b64 v[102:103], v102
    buffer_load_dwordx4 v[116:119], v71, s[12:15], s20 offen offset:0 sc1
    s_waitcnt lgkmcnt(10)
    v_smfmac_f32_16x16x64_bf16 v[38:41], v[66:69], v[104:111], v70
    v_cvt_pk_bf16_f32 v112, v112, v113
    v_cvt_pk_bf16_f32 v113, v114, v115
    v_lshlrev_b32_sdwa v114, 3, v70 dst_sel:DWORD dst_unused:UNUSED_PAD src0_sel:DWORD src1_sel:WORD_1
    ds_write_b64 v114, v[112:113] offset:896
    s_waitcnt vmcnt(6)
    v_lshlrev_b32_sdwa v104, 3, v120 dst_sel:DWORD dst_unused:UNUSED_PAD src0_sel:DWORD src1_sel:WORD_0
    v_lshlrev_b32_sdwa v106, 3, v120 dst_sel:DWORD dst_unused:UNUSED_PAD src0_sel:DWORD src1_sel:WORD_1
    ds_read_b64 v[104:105], v104
    ds_read_b64 v[106:107], v106
    v_lshlrev_b32_sdwa v108, 3, v121 dst_sel:DWORD dst_unused:UNUSED_PAD src0_sel:DWORD src1_sel:WORD_0
    v_lshlrev_b32_sdwa v110, 3, v121 dst_sel:DWORD dst_unused:UNUSED_PAD src0_sel:DWORD src1_sel:WORD_1
    v_cvt_pk_bf16_f32 v38, v38, v39
    v_cvt_pk_bf16_f32 v39, v40, v41
    v_lshlrev_b32 v40, 16, v42
    v_and_b32 v41, s23, v42
    v_lshlrev_b32 v42, 16, v43
    v_and_b32 v43, s23, v43
    ds_read_b64 v[108:109], v108
    ds_read_b64 v[110:111], v110
    s_waitcnt lgkmcnt(10)
    v_smfmac_f32_16x16x64_bf16 v[40:43], v[66:69], v[88:95], v70
    v_lshlrev_b32_sdwa v88, 3, v122 dst_sel:DWORD dst_unused:UNUSED_PAD src0_sel:DWORD src1_sel:WORD_0
    v_lshlrev_b32_sdwa v90, 3, v122 dst_sel:DWORD dst_unused:UNUSED_PAD src0_sel:DWORD src1_sel:WORD_1
    ds_read_b64 v[88:89], v88
    ds_read_b64 v[90:91], v90
    v_lshlrev_b32_sdwa v92, 3, v123 dst_sel:DWORD dst_unused:UNUSED_PAD src0_sel:DWORD src1_sel:WORD_0
    v_lshlrev_b32_sdwa v94, 3, v123 dst_sel:DWORD dst_unused:UNUSED_PAD src0_sel:DWORD src1_sel:WORD_1
    ds_read_b64 v[92:93], v92
    ds_read_b64 v[94:95], v94
    s_add_u32 s20, s20, 0xfffff000
    buffer_load_dwordx4 v[120:123], v71, s[12:15], s20 offen offset:3072 sc1
    s_waitcnt lgkmcnt(9)
    v_smfmac_f32_16x16x64_bf16 v[40:43], v[66:69], v[96:103], v70
    s_waitcnt vmcnt(6)
    v_lshlrev_b32_sdwa v96, 3, v124 dst_sel:DWORD dst_unused:UNUSED_PAD src0_sel:DWORD src1_sel:WORD_0
    v_lshlrev_b32_sdwa v98, 3, v124 dst_sel:DWORD dst_unused:UNUSED_PAD src0_sel:DWORD src1_sel:WORD_1
    ds_read_b64 v[96:97], v96
    ds_read_b64 v[98:99], v98
    v_lshlrev_b32_sdwa v100, 3, v125 dst_sel:DWORD dst_unused:UNUSED_PAD src0_sel:DWORD src1_sel:WORD_0
    v_lshlrev_b32_sdwa v102, 3, v125 dst_sel:DWORD dst_unused:UNUSED_PAD src0_sel:DWORD src1_sel:WORD_1
    s_nop 0
    v_cvt_pk_bf16_f32 v40, v40, v41
    v_cvt_pk_bf16_f32 v41, v42, v43
    v_lshlrev_b32 v42, 16, v44
    v_and_b32 v43, s23, v44
    v_lshlrev_b32 v44, 16, v45
    v_and_b32 v45, s23, v45
    ds_read_b64 v[100:101], v100
    ds_read_b64 v[102:103], v102
    s_waitcnt lgkmcnt(8)
    v_smfmac_f32_16x16x64_bf16 v[42:45], v[66:69], v[104:111], v70
    v_lshlrev_b32_sdwa v104, 3, v126 dst_sel:DWORD dst_unused:UNUSED_PAD src0_sel:DWORD src1_sel:WORD_0
    v_lshlrev_b32_sdwa v106, 3, v126 dst_sel:DWORD dst_unused:UNUSED_PAD src0_sel:DWORD src1_sel:WORD_1
    ds_read_b64 v[104:105], v104
    ds_read_b64 v[106:107], v106
    v_lshlrev_b32_sdwa v108, 3, v127 dst_sel:DWORD dst_unused:UNUSED_PAD src0_sel:DWORD src1_sel:WORD_0
    v_lshlrev_b32_sdwa v110, 3, v127 dst_sel:DWORD dst_unused:UNUSED_PAD src0_sel:DWORD src1_sel:WORD_1
    ds_read_b64 v[108:109], v108
    ds_read_b64 v[110:111], v110
    buffer_load_dwordx4 v[124:127], v71, s[12:15], s20 offen offset:2048 sc1
    s_waitcnt lgkmcnt(8)
    v_smfmac_f32_16x16x64_bf16 v[42:45], v[66:69], v[88:95], v70
    s_waitcnt vmcnt(2)
    v_lshlrev_b32_sdwa v88, 3, v116 dst_sel:DWORD dst_unused:UNUSED_PAD src0_sel:DWORD src1_sel:WORD_0
    v_lshlrev_b32_sdwa v90, 3, v116 dst_sel:DWORD dst_unused:UNUSED_PAD src0_sel:DWORD src1_sel:WORD_1
    ds_read_b64 v[88:89], v88
    ds_read_b64 v[90:91], v90
    v_lshlrev_b32_sdwa v92, 3, v117 dst_sel:DWORD dst_unused:UNUSED_PAD src0_sel:DWORD src1_sel:WORD_0
    v_lshlrev_b32_sdwa v94, 3, v117 dst_sel:DWORD dst_unused:UNUSED_PAD src0_sel:DWORD src1_sel:WORD_1
    s_nop 0
    v_cvt_pk_bf16_f32 v42, v42, v43
    v_cvt_pk_bf16_f32 v43, v44, v45
    v_lshlrev_b32 v44, 16, v46
    v_and_b32 v45, s23, v46
    v_lshlrev_b32 v46, 16, v47
    v_and_b32 v47, s23, v47
    ds_read_b64 v[92:93], v92
    ds_read_b64 v[94:95], v94
    s_waitcnt lgkmcnt(8)
    v_smfmac_f32_16x16x64_bf16 v[44:47], v[66:69], v[96:103], v70
    v_lshlrev_b32_sdwa v96, 3, v118 dst_sel:DWORD dst_unused:UNUSED_PAD src0_sel:DWORD src1_sel:WORD_0
    v_lshlrev_b32_sdwa v98, 3, v118 dst_sel:DWORD dst_unused:UNUSED_PAD src0_sel:DWORD src1_sel:WORD_1
    ds_read_b64 v[96:97], v96
    ds_read_b64 v[98:99], v98
    v_lshlrev_b32_sdwa v100, 3, v119 dst_sel:DWORD dst_unused:UNUSED_PAD src0_sel:DWORD src1_sel:WORD_0
    v_lshlrev_b32_sdwa v102, 3, v119 dst_sel:DWORD dst_unused:UNUSED_PAD src0_sel:DWORD src1_sel:WORD_1
    ds_read_b64 v[100:101], v100
    ds_read_b64 v[102:103], v102
    buffer_load_dwordx4 v[116:119], v71, s[12:15], s20 offen offset:1024 sc1
    s_waitcnt lgkmcnt(8)
    v_smfmac_f32_16x16x64_bf16 v[44:47], v[66:69], v[104:111], v70
    s_setprio 2
    s_waitcnt vmcnt(2)
    v_lshlrev_b32_sdwa v104, 3, v120 dst_sel:DWORD dst_unused:UNUSED_PAD src0_sel:DWORD src1_sel:WORD_0
    v_lshlrev_b32_sdwa v106, 3, v120 dst_sel:DWORD dst_unused:UNUSED_PAD src0_sel:DWORD src1_sel:WORD_1
    ds_read_b64 v[104:105], v104
    ds_read_b64 v[106:107], v106
    v_lshlrev_b32_sdwa v108, 3, v121 dst_sel:DWORD dst_unused:UNUSED_PAD src0_sel:DWORD src1_sel:WORD_0
    v_lshlrev_b32_sdwa v110, 3, v121 dst_sel:DWORD dst_unused:UNUSED_PAD src0_sel:DWORD src1_sel:WORD_1
    v_cvt_pk_bf16_f32 v44, v44, v45
    v_cvt_pk_bf16_f32 v45, v46, v47
    v_lshlrev_b32 v46, 16, v48
    v_and_b32 v47, s23, v48
    v_lshlrev_b32 v48, 16, v49
    v_and_b32 v49, s23, v49
    ds_read_b64 v[108:109], v108
    ds_read_b64 v[110:111], v110
    s_waitcnt lgkmcnt(8)
    v_smfmac_f32_16x16x64_bf16 v[46:49], v[66:69], v[88:95], v70
    v_lshlrev_b32_sdwa v88, 3, v122 dst_sel:DWORD dst_unused:UNUSED_PAD src0_sel:DWORD src1_sel:WORD_0
    v_lshlrev_b32_sdwa v90, 3, v122 dst_sel:DWORD dst_unused:UNUSED_PAD src0_sel:DWORD src1_sel:WORD_1
    ds_read_b64 v[88:89], v88
    ds_read_b64 v[90:91], v90
    v_lshlrev_b32_sdwa v92, 3, v123 dst_sel:DWORD dst_unused:UNUSED_PAD src0_sel:DWORD src1_sel:WORD_0
    v_lshlrev_b32_sdwa v94, 3, v123 dst_sel:DWORD dst_unused:UNUSED_PAD src0_sel:DWORD src1_sel:WORD_1
    ds_read_b64 v[92:93], v92
    ds_read_b64 v[94:95], v94
    buffer_load_dwordx4 v[120:123], v71, s[12:15], s20 offen offset:0 sc1
    s_waitcnt lgkmcnt(8)
    v_smfmac_f32_16x16x64_bf16 v[46:49], v[66:69], v[96:103], v70
    s_waitcnt vmcnt(2)
    v_lshlrev_b32_sdwa v96, 3, v124 dst_sel:DWORD dst_unused:UNUSED_PAD src0_sel:DWORD src1_sel:WORD_0
    v_lshlrev_b32_sdwa v98, 3, v124 dst_sel:DWORD dst_unused:UNUSED_PAD src0_sel:DWORD src1_sel:WORD_1
    ds_read_b64 v[96:97], v96
    ds_read_b64 v[98:99], v98
    v_lshlrev_b32_sdwa v100, 3, v125 dst_sel:DWORD dst_unused:UNUSED_PAD src0_sel:DWORD src1_sel:WORD_0
    v_lshlrev_b32_sdwa v102, 3, v125 dst_sel:DWORD dst_unused:UNUSED_PAD src0_sel:DWORD src1_sel:WORD_1
    s_nop 0
    v_cvt_pk_bf16_f32 v46, v46, v47
    v_cvt_pk_bf16_f32 v47, v48, v49
    v_lshlrev_b32 v48, 16, v50
    v_and_b32 v49, s23, v50
    v_lshlrev_b32 v50, 16, v51
    v_and_b32 v51, s23, v51
    ds_read_b64 v[100:101], v100
    ds_read_b64 v[102:103], v102
    s_waitcnt lgkmcnt(8)
    v_smfmac_f32_16x16x64_bf16 v[48:51], v[66:69], v[104:111], v70
    v_lshlrev_b32_sdwa v104, 3, v126 dst_sel:DWORD dst_unused:UNUSED_PAD src0_sel:DWORD src1_sel:WORD_0
    v_lshlrev_b32_sdwa v106, 3, v126 dst_sel:DWORD dst_unused:UNUSED_PAD src0_sel:DWORD src1_sel:WORD_1
    ds_read_b64 v[104:105], v104
    ds_read_b64 v[106:107], v106
    v_lshlrev_b32_sdwa v108, 3, v127 dst_sel:DWORD dst_unused:UNUSED_PAD src0_sel:DWORD src1_sel:WORD_0
    v_lshlrev_b32_sdwa v110, 3, v127 dst_sel:DWORD dst_unused:UNUSED_PAD src0_sel:DWORD src1_sel:WORD_1
    ds_read_b64 v[108:109], v108
    ds_read_b64 v[110:111], v110
    s_add_u32 s20, s20, 0xfffffc00
    buffer_load_dwordx4 v[124:127], v71, s[12:15], s20 offen offset:0 sc1
    s_waitcnt lgkmcnt(8)
    v_smfmac_f32_16x16x64_bf16 v[48:51], v[66:69], v[88:95], v70
    s_waitcnt vmcnt(2)
    v_lshlrev_b32_sdwa v88, 3, v116 dst_sel:DWORD dst_unused:UNUSED_PAD src0_sel:DWORD src1_sel:WORD_0
    v_lshlrev_b32_sdwa v90, 3, v116 dst_sel:DWORD dst_unused:UNUSED_PAD src0_sel:DWORD src1_sel:WORD_1
    ds_read_b64 v[88:89], v88
    ds_read_b64 v[90:91], v90
    v_lshlrev_b32_sdwa v92, 3, v117 dst_sel:DWORD dst_unused:UNUSED_PAD src0_sel:DWORD src1_sel:WORD_0
    v_lshlrev_b32_sdwa v94, 3, v117 dst_sel:DWORD dst_unused:UNUSED_PAD src0_sel:DWORD src1_sel:WORD_1
    s_nop 0
    v_cvt_pk_bf16_f32 v48, v48, v49
    v_cvt_pk_bf16_f32 v49, v50, v51
    v_lshlrev_b32 v50, 16, v52
    v_and_b32 v51, s23, v52
    v_lshlrev_b32 v52, 16, v53
    v_and_b32 v53, s23, v53
    ds_read_b64 v[92:93], v92
    ds_read_b64 v[94:95], v94
    s_waitcnt lgkmcnt(8)
    v_smfmac_f32_16x16x64_bf16 v[50:53], v[66:69], v[96:103], v70
    v_lshlrev_b32_sdwa v96, 3, v118 dst_sel:DWORD dst_unused:UNUSED_PAD src0_sel:DWORD src1_sel:WORD_0
    v_lshlrev_b32_sdwa v98, 3, v118 dst_sel:DWORD dst_unused:UNUSED_PAD src0_sel:DWORD src1_sel:WORD_1
    ds_read_b64 v[96:97], v96
    ds_read_b64 v[98:99], v98
    v_lshlrev_b32_sdwa v100, 3, v119 dst_sel:DWORD dst_unused:UNUSED_PAD src0_sel:DWORD src1_sel:WORD_0
    v_lshlrev_b32_sdwa v102, 3, v119 dst_sel:DWORD dst_unused:UNUSED_PAD src0_sel:DWORD src1_sel:WORD_1
    ds_read_b64 v[100:101], v100
    ds_read_b64 v[102:103], v102
    s_add_u32 s20, s20, 0xfffffc00
    buffer_load_dwordx4 v[116:119], v71, s[12:15], s20 offen offset:0 sc1
    s_waitcnt lgkmcnt(8)
    v_smfmac_f32_16x16x64_bf16 v[50:53], v[66:69], v[104:111], v70
    v_mfma_f32_16x16x32_bf16 v[112:115], v[72:75], v[128:131], 0
    v_mfma_f32_16x16x32_bf16 v[112:115], v[76:79], v[132:135], v[112:115]
    s_nop 0
    v_add_u32 v70, 0xc0000000, v70
    s_waitcnt vmcnt(2)
    v_lshlrev_b32_sdwa v104, 3, v120 dst_sel:DWORD dst_unused:UNUSED_PAD src0_sel:DWORD src1_sel:WORD_0
    v_lshlrev_b32_sdwa v106, 3, v120 dst_sel:DWORD dst_unused:UNUSED_PAD src0_sel:DWORD src1_sel:WORD_1
    ds_read_b64 v[104:105], v104
    ds_read_b64 v[106:107], v106
    v_mfma_f32_16x16x32_bf16 v[112:115], v[80:83], v[136:139], v[112:115]
    v_mfma_f32_16x16x32_bf16 v[112:115], v[84:87], v[140:143], v[112:115]
    v_lshlrev_b32_sdwa v108, 3, v121 dst_sel:DWORD dst_unused:UNUSED_PAD src0_sel:DWORD src1_sel:WORD_0
    v_lshlrev_b32_sdwa v110, 3, v121 dst_sel:DWORD dst_unused:UNUSED_PAD src0_sel:DWORD src1_sel:WORD_1
    v_cvt_pk_bf16_f32 v50, v50, v51
    v_cvt_pk_bf16_f32 v51, v52, v53
    v_lshlrev_b32 v52, 16, v54
    v_and_b32 v53, s23, v54
    v_lshlrev_b32 v54, 16, v55
    v_and_b32 v55, s23, v55
    ds_read_b64 v[108:109], v108
    ds_read_b64 v[110:111], v110
    s_waitcnt lgkmcnt(8)
    v_smfmac_f32_16x16x64_bf16 v[52:55], v[66:69], v[88:95], v70
    v_cvt_pk_bf16_f32 v112, v112, v113
    v_cvt_pk_bf16_f32 v113, v114, v115
    v_lshlrev_b32_sdwa v114, 3, v70 dst_sel:DWORD dst_unused:UNUSED_PAD src0_sel:DWORD src1_sel:WORD_1
    ds_write_b64 v114, v[112:113] offset:0
    v_mfma_f32_16x16x32_bf16 v[112:115], v[72:75], v[144:147], 0
    v_mfma_f32_16x16x32_bf16 v[112:115], v[76:79], v[148:151], v[112:115]
    v_lshlrev_b32_sdwa v88, 3, v122 dst_sel:DWORD dst_unused:UNUSED_PAD src0_sel:DWORD src1_sel:WORD_0
    v_lshlrev_b32_sdwa v90, 3, v122 dst_sel:DWORD dst_unused:UNUSED_PAD src0_sel:DWORD src1_sel:WORD_1
    ds_read_b64 v[88:89], v88
    ds_read_b64 v[90:91], v90
    v_mfma_f32_16x16x32_bf16 v[112:115], v[80:83], v[152:155], v[112:115]
    v_mfma_f32_16x16x32_bf16 v[112:115], v[84:87], v[156:159], v[112:115]
    v_lshlrev_b32_sdwa v92, 3, v123 dst_sel:DWORD dst_unused:UNUSED_PAD src0_sel:DWORD src1_sel:WORD_0
    v_lshlrev_b32_sdwa v94, 3, v123 dst_sel:DWORD dst_unused:UNUSED_PAD src0_sel:DWORD src1_sel:WORD_1
    ds_read_b64 v[92:93], v92
    ds_read_b64 v[94:95], v94
    s_add_u32 s20, s20, 0x3c00
    buffer_load_dwordx4 v[120:123], v71, s[12:15], s20 offen offset:0 sc1
    s_waitcnt lgkmcnt(9)
    v_smfmac_f32_16x16x64_bf16 v[52:55], v[66:69], v[96:103], v70
    v_cvt_pk_bf16_f32 v112, v112, v113
    v_cvt_pk_bf16_f32 v113, v114, v115
    v_lshlrev_b32_sdwa v114, 3, v70 dst_sel:DWORD dst_unused:UNUSED_PAD src0_sel:DWORD src1_sel:WORD_1
    ds_write_b64 v114, v[112:113] offset:128
    s_setprio 1
    v_mfma_f32_16x16x32_bf16 v[112:115], v[72:75], v[160:163], 0
    v_mfma_f32_16x16x32_bf16 v[112:115], v[76:79], v[164:167], v[112:115]
    s_waitcnt vmcnt(2)
    v_lshlrev_b32_sdwa v96, 3, v124 dst_sel:DWORD dst_unused:UNUSED_PAD src0_sel:DWORD src1_sel:WORD_0
    v_lshlrev_b32_sdwa v98, 3, v124 dst_sel:DWORD dst_unused:UNUSED_PAD src0_sel:DWORD src1_sel:WORD_1
    ds_read_b64 v[96:97], v96
    ds_read_b64 v[98:99], v98
    v_mfma_f32_16x16x32_bf16 v[112:115], v[80:83], v[168:171], v[112:115]
    v_mfma_f32_16x16x32_bf16 v[112:115], v[84:87], v[172:175], v[112:115]
    v_lshlrev_b32_sdwa v100, 3, v125 dst_sel:DWORD dst_unused:UNUSED_PAD src0_sel:DWORD src1_sel:WORD_0
    v_lshlrev_b32_sdwa v102, 3, v125 dst_sel:DWORD dst_unused:UNUSED_PAD src0_sel:DWORD src1_sel:WORD_1
    v_cvt_pk_bf16_f32 v52, v52, v53
    v_cvt_pk_bf16_f32 v53, v54, v55
    v_lshlrev_b32 v54, 16, v56
    v_and_b32 v55, s23, v56
    v_lshlrev_b32 v56, 16, v57
    v_and_b32 v57, s23, v57
    ds_read_b64 v[100:101], v100
    ds_read_b64 v[102:103], v102
    s_waitcnt lgkmcnt(10)
    v_smfmac_f32_16x16x64_bf16 v[54:57], v[66:69], v[104:111], v70
    v_cvt_pk_bf16_f32 v112, v112, v113
    v_cvt_pk_bf16_f32 v113, v114, v115
    v_lshlrev_b32_sdwa v114, 3, v70 dst_sel:DWORD dst_unused:UNUSED_PAD src0_sel:DWORD src1_sel:WORD_1
    ds_write_b64 v114, v[112:113] offset:256
    v_mfma_f32_16x16x32_bf16 v[112:115], v[72:75], v[176:179], 0
    v_mfma_f32_16x16x32_bf16 v[112:115], v[76:79], v[180:183], v[112:115]
    v_lshlrev_b32_sdwa v104, 3, v126 dst_sel:DWORD dst_unused:UNUSED_PAD src0_sel:DWORD src1_sel:WORD_0
    v_lshlrev_b32_sdwa v106, 3, v126 dst_sel:DWORD dst_unused:UNUSED_PAD src0_sel:DWORD src1_sel:WORD_1
    ds_read_b64 v[104:105], v104
    ds_read_b64 v[106:107], v106
    v_mfma_f32_16x16x32_bf16 v[112:115], v[80:83], v[184:187], v[112:115]
    v_mfma_f32_16x16x32_bf16 v[112:115], v[84:87], v[188:191], v[112:115]
    v_lshlrev_b32_sdwa v108, 3, v127 dst_sel:DWORD dst_unused:UNUSED_PAD src0_sel:DWORD src1_sel:WORD_0
    v_lshlrev_b32_sdwa v110, 3, v127 dst_sel:DWORD dst_unused:UNUSED_PAD src0_sel:DWORD src1_sel:WORD_1
    ds_read_b64 v[108:109], v108
    ds_read_b64 v[110:111], v110
    s_add_u32 s20, s20, 0xfffffc00
    buffer_load_dwordx4 v[124:127], v71, s[12:15], s20 offen offset:0 sc1
    s_waitcnt lgkmcnt(10)
    v_smfmac_f32_16x16x64_bf16 v[54:57], v[66:69], v[88:95], v70
    v_cvt_pk_bf16_f32 v112, v112, v113
    v_cvt_pk_bf16_f32 v113, v114, v115
    v_lshlrev_b32_sdwa v114, 3, v70 dst_sel:DWORD dst_unused:UNUSED_PAD src0_sel:DWORD src1_sel:WORD_1
    ds_write_b64 v114, v[112:113] offset:384
    v_mfma_f32_16x16x32_bf16 v[112:115], v[72:75], v[192:195], 0
    v_mfma_f32_16x16x32_bf16 v[112:115], v[76:79], v[196:199], v[112:115]
    s_waitcnt vmcnt(2)
    v_lshlrev_b32_sdwa v88, 3, v116 dst_sel:DWORD dst_unused:UNUSED_PAD src0_sel:DWORD src1_sel:WORD_0
    v_lshlrev_b32_sdwa v90, 3, v116 dst_sel:DWORD dst_unused:UNUSED_PAD src0_sel:DWORD src1_sel:WORD_1
    ds_read_b64 v[88:89], v88
    ds_read_b64 v[90:91], v90
    v_mfma_f32_16x16x32_bf16 v[112:115], v[80:83], v[200:203], v[112:115]
    v_mfma_f32_16x16x32_bf16 v[112:115], v[84:87], v[204:207], v[112:115]
    v_lshlrev_b32_sdwa v92, 3, v117 dst_sel:DWORD dst_unused:UNUSED_PAD src0_sel:DWORD src1_sel:WORD_0
    v_lshlrev_b32_sdwa v94, 3, v117 dst_sel:DWORD dst_unused:UNUSED_PAD src0_sel:DWORD src1_sel:WORD_1
    v_cvt_pk_bf16_f32 v54, v54, v55
    v_cvt_pk_bf16_f32 v55, v56, v57
    v_lshlrev_b32 v56, 16, v58
    v_and_b32 v57, s23, v58
    v_lshlrev_b32 v58, 16, v59
    v_and_b32 v59, s23, v59
    ds_read_b64 v[92:93], v92
    ds_read_b64 v[94:95], v94
    s_waitcnt lgkmcnt(10)
    v_smfmac_f32_16x16x64_bf16 v[56:59], v[66:69], v[96:103], v70
    v_cvt_pk_bf16_f32 v112, v112, v113
    v_cvt_pk_bf16_f32 v113, v114, v115
    v_lshlrev_b32_sdwa v114, 3, v70 dst_sel:DWORD dst_unused:UNUSED_PAD src0_sel:DWORD src1_sel:WORD_1
    ds_write_b64 v114, v[112:113] offset:512
    v_mfma_f32_16x16x32_bf16 v[112:115], v[72:75], v[208:211], 0
    v_mfma_f32_16x16x32_bf16 v[112:115], v[76:79], v[212:215], v[112:115]
    v_lshlrev_b32_sdwa v96, 3, v118 dst_sel:DWORD dst_unused:UNUSED_PAD src0_sel:DWORD src1_sel:WORD_0
    v_lshlrev_b32_sdwa v98, 3, v118 dst_sel:DWORD dst_unused:UNUSED_PAD src0_sel:DWORD src1_sel:WORD_1
    ds_read_b64 v[96:97], v96
    ds_read_b64 v[98:99], v98
    v_mfma_f32_16x16x32_bf16 v[112:115], v[80:83], v[216:219], v[112:115]
    v_mfma_f32_16x16x32_bf16 v[112:115], v[84:87], v[220:223], v[112:115]
    v_lshlrev_b32_sdwa v100, 3, v119 dst_sel:DWORD dst_unused:UNUSED_PAD src0_sel:DWORD src1_sel:WORD_0
    v_lshlrev_b32_sdwa v102, 3, v119 dst_sel:DWORD dst_unused:UNUSED_PAD src0_sel:DWORD src1_sel:WORD_1
    ds_read_b64 v[100:101], v100
    ds_read_b64 v[102:103], v102
    s_add_u32 s20, s20, 0x3f400
    buffer_load_dwordx4 v[116:119], v71, s[12:15], s20 offen offset:3072 sc1
    s_waitcnt lgkmcnt(10)
    v_smfmac_f32_16x16x64_bf16 v[56:59], v[66:69], v[104:111], v70
    v_cvt_pk_bf16_f32 v112, v112, v113
    v_cvt_pk_bf16_f32 v113, v114, v115
    v_lshlrev_b32_sdwa v114, 3, v70 dst_sel:DWORD dst_unused:UNUSED_PAD src0_sel:DWORD src1_sel:WORD_1
    ds_write_b64 v114, v[112:113] offset:640
    v_mfma_f32_16x16x32_bf16 v[112:115], v[72:75], v[224:227], 0
    v_mfma_f32_16x16x32_bf16 v[112:115], v[76:79], v[228:231], v[112:115]
    s_waitcnt vmcnt(2)
    v_lshlrev_b32_sdwa v104, 3, v120 dst_sel:DWORD dst_unused:UNUSED_PAD src0_sel:DWORD src1_sel:WORD_0
    v_lshlrev_b32_sdwa v106, 3, v120 dst_sel:DWORD dst_unused:UNUSED_PAD src0_sel:DWORD src1_sel:WORD_1
    ds_read_b64 v[104:105], v104
    ds_read_b64 v[106:107], v106
    v_mfma_f32_16x16x32_bf16 v[112:115], v[80:83], v[232:235], v[112:115]
    v_mfma_f32_16x16x32_bf16 v[112:115], v[84:87], v[236:239], v[112:115]
    v_lshlrev_b32_sdwa v108, 3, v121 dst_sel:DWORD dst_unused:UNUSED_PAD src0_sel:DWORD src1_sel:WORD_0
    v_lshlrev_b32_sdwa v110, 3, v121 dst_sel:DWORD dst_unused:UNUSED_PAD src0_sel:DWORD src1_sel:WORD_1
    v_cvt_pk_bf16_f32 v56, v56, v57
    v_cvt_pk_bf16_f32 v57, v58, v59
    v_lshlrev_b32 v58, 16, v60
    v_and_b32 v59, s23, v60
    v_lshlrev_b32 v60, 16, v61
    v_and_b32 v61, s23, v61
    ds_read_b64 v[108:109], v108
    ds_read_b64 v[110:111], v110
    s_waitcnt lgkmcnt(10)
    v_smfmac_f32_16x16x64_bf16 v[58:61], v[66:69], v[88:95], v70
    v_cvt_pk_bf16_f32 v112, v112, v113
    v_cvt_pk_bf16_f32 v113, v114, v115
    v_lshlrev_b32_sdwa v114, 3, v70 dst_sel:DWORD dst_unused:UNUSED_PAD src0_sel:DWORD src1_sel:WORD_1
    ds_write_b64 v114, v[112:113] offset:768
    v_mfma_f32_16x16x32_bf16 v[112:115], v[72:75], v[240:243], 0
    buffer_load_dwordx4 v[72:75], v71, s[12:15], s21 offen offset:0
    v_mfma_f32_16x16x32_bf16 v[112:115], v[76:79], v[244:247], v[112:115]
    buffer_load_dwordx4 v[76:79], v71, s[12:15], s21 offen offset:1024
    v_lshlrev_b32_sdwa v88, 3, v122 dst_sel:DWORD dst_unused:UNUSED_PAD src0_sel:DWORD src1_sel:WORD_0
    v_lshlrev_b32_sdwa v90, 3, v122 dst_sel:DWORD dst_unused:UNUSED_PAD src0_sel:DWORD src1_sel:WORD_1
    ds_read_b64 v[88:89], v88
    ds_read_b64 v[90:91], v90
    v_mfma_f32_16x16x32_bf16 v[112:115], v[80:83], v[248:251], v[112:115]
    buffer_load_dwordx4 v[80:83], v71, s[12:15], s19 offen offset:0
    v_mfma_f32_16x16x32_bf16 v[112:115], v[84:87], v[252:255], v[112:115]
    buffer_load_dwordx4 v[84:87], v71, s[12:15], s19 offen offset:1024
    s_add_u32 s21, s21, s22
    s_add_u32 s19, s19, s22
    v_lshlrev_b32_sdwa v92, 3, v123 dst_sel:DWORD dst_unused:UNUSED_PAD src0_sel:DWORD src1_sel:WORD_0
    v_lshlrev_b32_sdwa v94, 3, v123 dst_sel:DWORD dst_unused:UNUSED_PAD src0_sel:DWORD src1_sel:WORD_1
    ds_read_b64 v[92:93], v92
    ds_read_b64 v[94:95], v94
    s_add_u32 s20, s20, 0x400
    buffer_load_dwordx4 v[120:123], v71, s[12:15], s20 offen offset:3072 sc1
    s_waitcnt lgkmcnt(10)
    v_smfmac_f32_16x16x64_bf16 v[58:61], v[66:69], v[96:103], v70
    v_cvt_pk_bf16_f32 v112, v112, v113
    v_cvt_pk_bf16_f32 v113, v114, v115
    v_lshlrev_b32_sdwa v114, 3, v70 dst_sel:DWORD dst_unused:UNUSED_PAD src0_sel:DWORD src1_sel:WORD_1
    ds_write_b64 v114, v[112:113] offset:896
    s_setprio 0
    s_waitcnt vmcnt(6)
    v_lshlrev_b32_sdwa v96, 3, v124 dst_sel:DWORD dst_unused:UNUSED_PAD src0_sel:DWORD src1_sel:WORD_0
    v_lshlrev_b32_sdwa v98, 3, v124 dst_sel:DWORD dst_unused:UNUSED_PAD src0_sel:DWORD src1_sel:WORD_1
    ds_read_b64 v[96:97], v96
    ds_read_b64 v[98:99], v98
    v_lshlrev_b32_sdwa v100, 3, v125 dst_sel:DWORD dst_unused:UNUSED_PAD src0_sel:DWORD src1_sel:WORD_0
    v_lshlrev_b32_sdwa v102, 3, v125 dst_sel:DWORD dst_unused:UNUSED_PAD src0_sel:DWORD src1_sel:WORD_1
    v_cvt_pk_bf16_f32 v58, v58, v59
    v_cvt_pk_bf16_f32 v59, v60, v61
    v_lshlrev_b32 v60, 16, v62
    v_and_b32 v61, s23, v62
    v_lshlrev_b32 v62, 16, v63
    v_and_b32 v63, s23, v63
    ds_read_b64 v[100:101], v100
    ds_read_b64 v[102:103], v102
    s_waitcnt lgkmcnt(10)
    v_smfmac_f32_16x16x64_bf16 v[60:63], v[66:69], v[104:111], v70
    v_lshlrev_b32_sdwa v104, 3, v126 dst_sel:DWORD dst_unused:UNUSED_PAD src0_sel:DWORD src1_sel:WORD_0
    v_lshlrev_b32_sdwa v106, 3, v126 dst_sel:DWORD dst_unused:UNUSED_PAD src0_sel:DWORD src1_sel:WORD_1
    ds_read_b64 v[104:105], v104
    ds_read_b64 v[106:107], v106
    v_lshlrev_b32_sdwa v108, 3, v127 dst_sel:DWORD dst_unused:UNUSED_PAD src0_sel:DWORD src1_sel:WORD_0
    v_lshlrev_b32_sdwa v110, 3, v127 dst_sel:DWORD dst_unused:UNUSED_PAD src0_sel:DWORD src1_sel:WORD_1
    ds_read_b64 v[108:109], v108
    ds_read_b64 v[110:111], v110
    s_add_u32 s20, s20, 0xffffd000
    buffer_load_dwordx4 v[124:127], v71, s[12:15], s20 offen offset:0 sc1
    s_waitcnt lgkmcnt(9)
    v_smfmac_f32_16x16x64_bf16 v[60:63], v[66:69], v[88:95], v70
    s_waitcnt lgkmcnt(0)
    s_barrier
    s_setprio 3
    s_waitcnt vmcnt(6)
    v_lshlrev_b32_sdwa v88, 3, v116 dst_sel:DWORD dst_unused:UNUSED_PAD src0_sel:DWORD src1_sel:WORD_0
    v_lshlrev_b32_sdwa v90, 3, v116 dst_sel:DWORD dst_unused:UNUSED_PAD src0_sel:DWORD src1_sel:WORD_1
    ds_read_b64 v[88:89], v88
    ds_read_b64 v[90:91], v90
    v_lshlrev_b32_sdwa v92, 3, v117 dst_sel:DWORD dst_unused:UNUSED_PAD src0_sel:DWORD src1_sel:WORD_0
    v_lshlrev_b32_sdwa v94, 3, v117 dst_sel:DWORD dst_unused:UNUSED_PAD src0_sel:DWORD src1_sel:WORD_1
    v_cvt_pk_bf16_f32 v60, v60, v61
    v_cvt_pk_bf16_f32 v61, v62, v63
    v_lshlrev_b32 v62, 16, v64
    v_and_b32 v63, s23, v64
    v_lshlrev_b32 v64, 16, v65
    v_and_b32 v65, s23, v65
    ds_read_b64 v[92:93], v92
    ds_read_b64 v[94:95], v94
    v_smfmac_f32_16x16x64_bf16 v[62:65], v[66:69], v[96:103], v70
    v_lshlrev_b32_sdwa v96, 3, v118 dst_sel:DWORD dst_unused:UNUSED_PAD src0_sel:DWORD src1_sel:WORD_0
    v_lshlrev_b32_sdwa v98, 3, v118 dst_sel:DWORD dst_unused:UNUSED_PAD src0_sel:DWORD src1_sel:WORD_1
    ds_read_b64 v[96:97], v96
    ds_read_b64 v[98:99], v98
    v_lshlrev_b32_sdwa v100, 3, v119 dst_sel:DWORD dst_unused:UNUSED_PAD src0_sel:DWORD src1_sel:WORD_0
    v_lshlrev_b32_sdwa v102, 3, v119 dst_sel:DWORD dst_unused:UNUSED_PAD src0_sel:DWORD src1_sel:WORD_1
    ds_read_b64 v[100:101], v100
    ds_read_b64 v[102:103], v102
    buffer_load_dwordx4 v[116:119], v71, s[12:15], s20 offen offset:1024 sc1
    v_smfmac_f32_16x16x64_bf16 v[62:65], v[66:69], v[104:111], v70
    s_waitcnt vmcnt(2)
    v_lshlrev_b32_sdwa v104, 3, v120 dst_sel:DWORD dst_unused:UNUSED_PAD src0_sel:DWORD src1_sel:WORD_0
    v_lshlrev_b32_sdwa v106, 3, v120 dst_sel:DWORD dst_unused:UNUSED_PAD src0_sel:DWORD src1_sel:WORD_1
    ds_read_b64 v[104:105], v104
    ds_read_b64 v[106:107], v106
    v_lshlrev_b32_sdwa v108, 3, v121 dst_sel:DWORD dst_unused:UNUSED_PAD src0_sel:DWORD src1_sel:WORD_0
    v_lshlrev_b32_sdwa v110, 3, v121 dst_sel:DWORD dst_unused:UNUSED_PAD src0_sel:DWORD src1_sel:WORD_1
    s_nop 0
    v_cvt_pk_bf16_f32 v62, v62, v63
    v_cvt_pk_bf16_f32 v63, v64, v65
    v_and_b32 v65, s23, v63
    v_lshlrev_b32 v64, 16, v63
    v_and_b32 v63, s23, v62
    v_lshlrev_b32 v62, 16, v62
    ds_read_b64 v[108:109], v108
    ds_read_b64 v[110:111], v110
    s_waitcnt lgkmcnt(8)
    v_smfmac_f32_16x16x64_bf16 v[62:65], v[66:69], v[88:95], v70
    v_lshlrev_b32_sdwa v88, 3, v122 dst_sel:DWORD dst_unused:UNUSED_PAD src0_sel:DWORD src1_sel:WORD_0
    v_lshlrev_b32_sdwa v90, 3, v122 dst_sel:DWORD dst_unused:UNUSED_PAD src0_sel:DWORD src1_sel:WORD_1
    ds_read_b64 v[88:89], v88
    ds_read_b64 v[90:91], v90
    v_lshlrev_b32_sdwa v92, 3, v123 dst_sel:DWORD dst_unused:UNUSED_PAD src0_sel:DWORD src1_sel:WORD_0
    v_lshlrev_b32_sdwa v94, 3, v123 dst_sel:DWORD dst_unused:UNUSED_PAD src0_sel:DWORD src1_sel:WORD_1
    ds_read_b64 v[92:93], v92
    ds_read_b64 v[94:95], v94
    buffer_load_dwordx4 v[120:123], v71, s[12:15], s20 offen offset:2048 sc1
    s_waitcnt lgkmcnt(8)
    v_smfmac_f32_16x16x64_bf16 v[62:65], v[66:69], v[96:103], v70
    s_waitcnt vmcnt(2)
    v_lshlrev_b32_sdwa v96, 3, v124 dst_sel:DWORD dst_unused:UNUSED_PAD src0_sel:DWORD src1_sel:WORD_0
    v_lshlrev_b32_sdwa v98, 3, v124 dst_sel:DWORD dst_unused:UNUSED_PAD src0_sel:DWORD src1_sel:WORD_1
    ds_read_b64 v[96:97], v96
    ds_read_b64 v[98:99], v98
    v_lshlrev_b32_sdwa v100, 3, v125 dst_sel:DWORD dst_unused:UNUSED_PAD src0_sel:DWORD src1_sel:WORD_0
    v_lshlrev_b32_sdwa v102, 3, v125 dst_sel:DWORD dst_unused:UNUSED_PAD src0_sel:DWORD src1_sel:WORD_1
    s_nop 0
    v_cvt_pk_bf16_f32 v65, v64, v65
    v_cvt_pk_bf16_f32 v64, v62, v63
    v_and_b32 v63, s23, v61
    v_lshlrev_b32 v62, 16, v61
    v_and_b32 v61, s23, v60
    v_lshlrev_b32 v60, 16, v60
    ds_read_b64 v[100:101], v100
    ds_read_b64 v[102:103], v102
    s_waitcnt lgkmcnt(8)
    v_smfmac_f32_16x16x64_bf16 v[60:63], v[66:69], v[104:111], v70
    v_lshlrev_b32_sdwa v104, 3, v126 dst_sel:DWORD dst_unused:UNUSED_PAD src0_sel:DWORD src1_sel:WORD_0
    v_lshlrev_b32_sdwa v106, 3, v126 dst_sel:DWORD dst_unused:UNUSED_PAD src0_sel:DWORD src1_sel:WORD_1
    ds_read_b64 v[104:105], v104
    ds_read_b64 v[106:107], v106
    v_lshlrev_b32_sdwa v108, 3, v127 dst_sel:DWORD dst_unused:UNUSED_PAD src0_sel:DWORD src1_sel:WORD_0
    v_lshlrev_b32_sdwa v110, 3, v127 dst_sel:DWORD dst_unused:UNUSED_PAD src0_sel:DWORD src1_sel:WORD_1
    ds_read_b64 v[108:109], v108
    ds_read_b64 v[110:111], v110
    buffer_load_dwordx4 v[124:127], v71, s[12:15], s20 offen offset:3072 sc1
    s_waitcnt lgkmcnt(8)
    v_smfmac_f32_16x16x64_bf16 v[60:63], v[66:69], v[88:95], v70
    s_waitcnt vmcnt(2)
    v_lshlrev_b32_sdwa v88, 3, v116 dst_sel:DWORD dst_unused:UNUSED_PAD src0_sel:DWORD src1_sel:WORD_0
    v_lshlrev_b32_sdwa v90, 3, v116 dst_sel:DWORD dst_unused:UNUSED_PAD src0_sel:DWORD src1_sel:WORD_1
    ds_read_b64 v[88:89], v88
    ds_read_b64 v[90:91], v90
    v_lshlrev_b32_sdwa v92, 3, v117 dst_sel:DWORD dst_unused:UNUSED_PAD src0_sel:DWORD src1_sel:WORD_0
    v_lshlrev_b32_sdwa v94, 3, v117 dst_sel:DWORD dst_unused:UNUSED_PAD src0_sel:DWORD src1_sel:WORD_1
    s_nop 0
    v_cvt_pk_bf16_f32 v63, v62, v63
    v_cvt_pk_bf16_f32 v62, v60, v61
    v_and_b32 v61, s23, v59
    v_lshlrev_b32 v60, 16, v59
    v_and_b32 v59, s23, v58
    v_lshlrev_b32 v58, 16, v58
    ds_read_b64 v[92:93], v92
    ds_read_b64 v[94:95], v94
    s_waitcnt lgkmcnt(8)
    v_smfmac_f32_16x16x64_bf16 v[58:61], v[66:69], v[96:103], v70
    v_lshlrev_b32_sdwa v96, 3, v118 dst_sel:DWORD dst_unused:UNUSED_PAD src0_sel:DWORD src1_sel:WORD_0
    v_lshlrev_b32_sdwa v98, 3, v118 dst_sel:DWORD dst_unused:UNUSED_PAD src0_sel:DWORD src1_sel:WORD_1
    ds_read_b64 v[96:97], v96
    ds_read_b64 v[98:99], v98
    v_lshlrev_b32_sdwa v100, 3, v119 dst_sel:DWORD dst_unused:UNUSED_PAD src0_sel:DWORD src1_sel:WORD_0
    v_lshlrev_b32_sdwa v102, 3, v119 dst_sel:DWORD dst_unused:UNUSED_PAD src0_sel:DWORD src1_sel:WORD_1
    ds_read_b64 v[100:101], v100
    ds_read_b64 v[102:103], v102
    s_add_u32 s20, s20, 0x1000
    buffer_load_dwordx4 v[116:119], v71, s[12:15], s20 offen offset:0 sc1
    s_waitcnt lgkmcnt(8)
    v_smfmac_f32_16x16x64_bf16 v[58:61], v[66:69], v[104:111], v70
    v_mfma_f32_16x16x32_bf16 v[112:115], v[72:75], v[128:131], 0
    s_waitcnt vmcnt(2)
    v_lshlrev_b32_sdwa v104, 3, v120 dst_sel:DWORD dst_unused:UNUSED_PAD src0_sel:DWORD src1_sel:WORD_0
    v_lshlrev_b32_sdwa v106, 3, v120 dst_sel:DWORD dst_unused:UNUSED_PAD src0_sel:DWORD src1_sel:WORD_1
    ds_read_b64 v[104:105], v104
    ds_read_b64 v[106:107], v106
    v_mfma_f32_16x16x32_bf16 v[112:115], v[76:79], v[132:135], v[112:115]
    v_lshlrev_b32_sdwa v108, 3, v121 dst_sel:DWORD dst_unused:UNUSED_PAD src0_sel:DWORD src1_sel:WORD_0
    v_lshlrev_b32_sdwa v110, 3, v121 dst_sel:DWORD dst_unused:UNUSED_PAD src0_sel:DWORD src1_sel:WORD_1
    v_cvt_pk_bf16_f32 v61, v60, v61
    v_cvt_pk_bf16_f32 v60, v58, v59
    v_and_b32 v59, s23, v57
    v_lshlrev_b32 v58, 16, v57
    v_and_b32 v57, s23, v56
    v_lshlrev_b32 v56, 16, v56
    ds_read_b64 v[108:109], v108
    ds_read_b64 v[110:111], v110
    s_waitcnt lgkmcnt(8)
    v_smfmac_f32_16x16x64_bf16 v[56:59], v[66:69], v[88:95], v70
    v_mfma_f32_16x16x32_bf16 v[112:115], v[80:83], v[136:139], v[112:115]
    v_lshlrev_b32_sdwa v88, 3, v122 dst_sel:DWORD dst_unused:UNUSED_PAD src0_sel:DWORD src1_sel:WORD_0
    v_lshlrev_b32_sdwa v90, 3, v122 dst_sel:DWORD dst_unused:UNUSED_PAD src0_sel:DWORD src1_sel:WORD_1
    ds_read_b64 v[88:89], v88
    ds_read_b64 v[90:91], v90
    v_mfma_f32_16x16x32_bf16 v[112:115], v[84:87], v[140:143], v[112:115]
    v_lshlrev_b32_sdwa v92, 3, v123 dst_sel:DWORD dst_unused:UNUSED_PAD src0_sel:DWORD src1_sel:WORD_0
    v_lshlrev_b32_sdwa v94, 3, v123 dst_sel:DWORD dst_unused:UNUSED_PAD src0_sel:DWORD src1_sel:WORD_1
    ds_read_b64 v[92:93], v92
    ds_read_b64 v[94:95], v94
    buffer_load_dwordx4 v[120:123], v71, s[12:15], s20 offen offset:1024 sc1
    s_waitcnt lgkmcnt(8)
    v_smfmac_f32_16x16x64_bf16 v[56:59], v[66:69], v[96:103], v70
    s_nop 0
    v_cvt_pk_bf16_f32 v112, v112, v113
    v_cvt_pk_bf16_f32 v113, v114, v115
    v_lshlrev_b32_sdwa v114, 3, v70 dst_sel:DWORD dst_unused:UNUSED_PAD src0_sel:DWORD src1_sel:WORD_1
    ds_write_b64 v114, v[112:113] offset:32768
    s_waitcnt vmcnt(2)
    v_lshlrev_b32_sdwa v96, 3, v124 dst_sel:DWORD dst_unused:UNUSED_PAD src0_sel:DWORD src1_sel:WORD_0
    v_lshlrev_b32_sdwa v98, 3, v124 dst_sel:DWORD dst_unused:UNUSED_PAD src0_sel:DWORD src1_sel:WORD_1
    ds_read_b64 v[96:97], v96
    ds_read_b64 v[98:99], v98
    v_lshlrev_b32_sdwa v100, 3, v125 dst_sel:DWORD dst_unused:UNUSED_PAD src0_sel:DWORD src1_sel:WORD_0
    v_lshlrev_b32_sdwa v102, 3, v125 dst_sel:DWORD dst_unused:UNUSED_PAD src0_sel:DWORD src1_sel:WORD_1
    v_cvt_pk_bf16_f32 v59, v58, v59
    v_cvt_pk_bf16_f32 v58, v56, v57
    v_and_b32 v57, s23, v55
    v_lshlrev_b32 v56, 16, v55
    v_and_b32 v55, s23, v54
    v_lshlrev_b32 v54, 16, v54
    ds_read_b64 v[100:101], v100
    ds_read_b64 v[102:103], v102
    s_waitcnt lgkmcnt(9)
    v_smfmac_f32_16x16x64_bf16 v[54:57], v[66:69], v[104:111], v70
    v_mfma_f32_16x16x32_bf16 v[112:115], v[72:75], v[144:147], 0
    v_lshlrev_b32_sdwa v104, 3, v126 dst_sel:DWORD dst_unused:UNUSED_PAD src0_sel:DWORD src1_sel:WORD_0
    v_lshlrev_b32_sdwa v106, 3, v126 dst_sel:DWORD dst_unused:UNUSED_PAD src0_sel:DWORD src1_sel:WORD_1
    ds_read_b64 v[104:105], v104
    ds_read_b64 v[106:107], v106
    v_mfma_f32_16x16x32_bf16 v[112:115], v[76:79], v[148:151], v[112:115]
    v_lshlrev_b32_sdwa v108, 3, v127 dst_sel:DWORD dst_unused:UNUSED_PAD src0_sel:DWORD src1_sel:WORD_0
    v_lshlrev_b32_sdwa v110, 3, v127 dst_sel:DWORD dst_unused:UNUSED_PAD src0_sel:DWORD src1_sel:WORD_1
    ds_read_b64 v[108:109], v108
    ds_read_b64 v[110:111], v110
    buffer_load_dwordx4 v[124:127], v71, s[12:15], s20 offen offset:2048 sc1
    s_waitcnt lgkmcnt(9)
    v_smfmac_f32_16x16x64_bf16 v[54:57], v[66:69], v[88:95], v70
    v_mfma_f32_16x16x32_bf16 v[112:115], v[80:83], v[152:155], v[112:115]
    s_waitcnt vmcnt(2)
    v_lshlrev_b32_sdwa v88, 3, v116 dst_sel:DWORD dst_unused:UNUSED_PAD src0_sel:DWORD src1_sel:WORD_0
    v_lshlrev_b32_sdwa v90, 3, v116 dst_sel:DWORD dst_unused:UNUSED_PAD src0_sel:DWORD src1_sel:WORD_1
    ds_read_b64 v[88:89], v88
    ds_read_b64 v[90:91], v90
    v_mfma_f32_16x16x32_bf16 v[112:115], v[84:87], v[156:159], v[112:115]
    v_lshlrev_b32_sdwa v92, 3, v117 dst_sel:DWORD dst_unused:UNUSED_PAD src0_sel:DWORD src1_sel:WORD_0
    v_lshlrev_b32_sdwa v94, 3, v117 dst_sel:DWORD dst_unused:UNUSED_PAD src0_sel:DWORD src1_sel:WORD_1
    v_cvt_pk_bf16_f32 v57, v56, v57
    v_cvt_pk_bf16_f32 v56, v54, v55
    v_and_b32 v55, s23, v53
    v_lshlrev_b32 v54, 16, v53
    v_and_b32 v53, s23, v52
    v_lshlrev_b32 v52, 16, v52
    ds_read_b64 v[92:93], v92
    ds_read_b64 v[94:95], v94
    s_waitcnt lgkmcnt(8)
    v_smfmac_f32_16x16x64_bf16 v[52:55], v[66:69], v[96:103], v70
    v_cvt_pk_bf16_f32 v112, v112, v113
    v_cvt_pk_bf16_f32 v113, v114, v115
    v_lshlrev_b32_sdwa v114, 3, v70 dst_sel:DWORD dst_unused:UNUSED_PAD src0_sel:DWORD src1_sel:WORD_1
    ds_write_b64 v114, v[112:113] offset:32896
    v_lshlrev_b32_sdwa v96, 3, v118 dst_sel:DWORD dst_unused:UNUSED_PAD src0_sel:DWORD src1_sel:WORD_0
    v_lshlrev_b32_sdwa v98, 3, v118 dst_sel:DWORD dst_unused:UNUSED_PAD src0_sel:DWORD src1_sel:WORD_1
    ds_read_b64 v[96:97], v96
    ds_read_b64 v[98:99], v98
    v_lshlrev_b32_sdwa v100, 3, v119 dst_sel:DWORD dst_unused:UNUSED_PAD src0_sel:DWORD src1_sel:WORD_0
    v_lshlrev_b32_sdwa v102, 3, v119 dst_sel:DWORD dst_unused:UNUSED_PAD src0_sel:DWORD src1_sel:WORD_1
    ds_read_b64 v[100:101], v100
    ds_read_b64 v[102:103], v102
    buffer_load_dwordx4 v[116:119], v71, s[12:15], s20 offen offset:3072 sc1
    s_waitcnt lgkmcnt(9)
    v_smfmac_f32_16x16x64_bf16 v[52:55], v[66:69], v[104:111], v70
    v_mfma_f32_16x16x32_bf16 v[112:115], v[72:75], v[160:163], 0
    s_waitcnt vmcnt(2)
    v_lshlrev_b32_sdwa v104, 3, v120 dst_sel:DWORD dst_unused:UNUSED_PAD src0_sel:DWORD src1_sel:WORD_0
    v_lshlrev_b32_sdwa v106, 3, v120 dst_sel:DWORD dst_unused:UNUSED_PAD src0_sel:DWORD src1_sel:WORD_1
    ds_read_b64 v[104:105], v104
    ds_read_b64 v[106:107], v106
    v_mfma_f32_16x16x32_bf16 v[112:115], v[76:79], v[164:167], v[112:115]
    v_lshlrev_b32_sdwa v108, 3, v121 dst_sel:DWORD dst_unused:UNUSED_PAD src0_sel:DWORD src1_sel:WORD_0
    v_lshlrev_b32_sdwa v110, 3, v121 dst_sel:DWORD dst_unused:UNUSED_PAD src0_sel:DWORD src1_sel:WORD_1
    v_cvt_pk_bf16_f32 v55, v54, v55
    v_cvt_pk_bf16_f32 v54, v52, v53
    v_and_b32 v53, s23, v51
    v_lshlrev_b32 v52, 16, v51
    v_and_b32 v51, s23, v50
    v_lshlrev_b32 v50, 16, v50
    ds_read_b64 v[108:109], v108
    ds_read_b64 v[110:111], v110
    s_waitcnt lgkmcnt(9)
    v_smfmac_f32_16x16x64_bf16 v[50:53], v[66:69], v[88:95], v70
    v_mfma_f32_16x16x32_bf16 v[112:115], v[80:83], v[168:171], v[112:115]
    v_lshlrev_b32_sdwa v88, 3, v122 dst_sel:DWORD dst_unused:UNUSED_PAD src0_sel:DWORD src1_sel:WORD_0
    v_lshlrev_b32_sdwa v90, 3, v122 dst_sel:DWORD dst_unused:UNUSED_PAD src0_sel:DWORD src1_sel:WORD_1
    ds_read_b64 v[88:89], v88
    ds_read_b64 v[90:91], v90
    v_mfma_f32_16x16x32_bf16 v[112:115], v[84:87], v[172:175], v[112:115]
    v_lshlrev_b32_sdwa v92, 3, v123 dst_sel:DWORD dst_unused:UNUSED_PAD src0_sel:DWORD src1_sel:WORD_0
    v_lshlrev_b32_sdwa v94, 3, v123 dst_sel:DWORD dst_unused:UNUSED_PAD src0_sel:DWORD src1_sel:WORD_1
    ds_read_b64 v[92:93], v92
    ds_read_b64 v[94:95], v94
    s_add_u32 s20, s20, 0x1000
    buffer_load_dwordx4 v[120:123], v71, s[12:15], s20 offen offset:0 sc1
    s_waitcnt lgkmcnt(8)
    v_smfmac_f32_16x16x64_bf16 v[50:53], v[66:69], v[96:103], v70
    v_cvt_pk_bf16_f32 v112, v112, v113
    v_cvt_pk_bf16_f32 v113, v114, v115
    v_lshlrev_b32_sdwa v114, 3, v70 dst_sel:DWORD dst_unused:UNUSED_PAD src0_sel:DWORD src1_sel:WORD_1
    ds_write_b64 v114, v[112:113] offset:33024
    s_setprio 2
    s_waitcnt vmcnt(2)
    v_lshlrev_b32_sdwa v96, 3, v124 dst_sel:DWORD dst_unused:UNUSED_PAD src0_sel:DWORD src1_sel:WORD_0
    v_lshlrev_b32_sdwa v98, 3, v124 dst_sel:DWORD dst_unused:UNUSED_PAD src0_sel:DWORD src1_sel:WORD_1
    ds_read_b64 v[96:97], v96
    ds_read_b64 v[98:99], v98
    v_lshlrev_b32_sdwa v100, 3, v125 dst_sel:DWORD dst_unused:UNUSED_PAD src0_sel:DWORD src1_sel:WORD_0
    v_lshlrev_b32_sdwa v102, 3, v125 dst_sel:DWORD dst_unused:UNUSED_PAD src0_sel:DWORD src1_sel:WORD_1
    v_cvt_pk_bf16_f32 v53, v52, v53
    v_cvt_pk_bf16_f32 v52, v50, v51
    v_and_b32 v51, s23, v49
    v_lshlrev_b32 v50, 16, v49
    v_and_b32 v49, s23, v48
    v_lshlrev_b32 v48, 16, v48
    ds_read_b64 v[100:101], v100
    ds_read_b64 v[102:103], v102
    s_waitcnt lgkmcnt(9)
    v_smfmac_f32_16x16x64_bf16 v[48:51], v[66:69], v[104:111], v70
    s_lshl_b32 s28, s38, 16
    s_and_b32 s29, s38, 0xffff0000
    v_mfma_f32_16x16x32_bf16 v[112:115], v[72:75], v[176:179], 0
    v_lshlrev_b32_sdwa v104, 3, v126 dst_sel:DWORD dst_unused:UNUSED_PAD src0_sel:DWORD src1_sel:WORD_0
    v_lshlrev_b32_sdwa v106, 3, v126 dst_sel:DWORD dst_unused:UNUSED_PAD src0_sel:DWORD src1_sel:WORD_1
    ds_read_b64 v[104:105], v104
    ds_read_b64 v[106:107], v106
    v_mfma_f32_16x16x32_bf16 v[112:115], v[76:79], v[180:183], v[112:115]
    v_lshlrev_b32_sdwa v108, 3, v127 dst_sel:DWORD dst_unused:UNUSED_PAD src0_sel:DWORD src1_sel:WORD_0
    v_lshlrev_b32_sdwa v110, 3, v127 dst_sel:DWORD dst_unused:UNUSED_PAD src0_sel:DWORD src1_sel:WORD_1
    ds_read_b64 v[108:109], v108
    ds_read_b64 v[110:111], v110
    buffer_load_dwordx4 v[124:127], v71, s[12:15], s20 offen offset:1024 sc1
    s_waitcnt lgkmcnt(9)
    v_smfmac_f32_16x16x64_bf16 v[48:51], v[66:69], v[88:95], v70
    s_lshl_b32 s30, s39, 16
    s_and_b32 s31, s39, 0xffff0000
    v_mfma_f32_16x16x32_bf16 v[112:115], v[80:83], v[184:187], v[112:115]
    s_waitcnt vmcnt(2)
    v_lshlrev_b32_sdwa v88, 3, v116 dst_sel:DWORD dst_unused:UNUSED_PAD src0_sel:DWORD src1_sel:WORD_0
    v_lshlrev_b32_sdwa v90, 3, v116 dst_sel:DWORD dst_unused:UNUSED_PAD src0_sel:DWORD src1_sel:WORD_1
    ds_read_b64 v[88:89], v88
    ds_read_b64 v[90:91], v90
    v_mfma_f32_16x16x32_bf16 v[112:115], v[84:87], v[188:191], v[112:115]
    v_lshlrev_b32_sdwa v92, 3, v117 dst_sel:DWORD dst_unused:UNUSED_PAD src0_sel:DWORD src1_sel:WORD_0
    v_lshlrev_b32_sdwa v94, 3, v117 dst_sel:DWORD dst_unused:UNUSED_PAD src0_sel:DWORD src1_sel:WORD_1
    v_cvt_pk_bf16_f32 v51, v50, v51
    v_cvt_pk_bf16_f32 v50, v48, v49
    v_and_b32 v49, s23, v47
    v_lshlrev_b32 v48, 16, v47
    v_and_b32 v47, s23, v46
    v_lshlrev_b32 v46, 16, v46
    ds_read_b64 v[92:93], v92
    ds_read_b64 v[94:95], v94
    s_waitcnt lgkmcnt(8)
    v_smfmac_f32_16x16x64_bf16 v[46:49], v[66:69], v[96:103], v70
    v_cvt_pk_bf16_f32 v112, v112, v113
    v_cvt_pk_bf16_f32 v113, v114, v115
    v_lshlrev_b32_sdwa v114, 3, v70 dst_sel:DWORD dst_unused:UNUSED_PAD src0_sel:DWORD src1_sel:WORD_1
    ds_write_b64 v114, v[112:113] offset:33152
    s_lshl1_add_u32 s35, s33, s34
    s_lshl3_add_u32 s35, s35, s3
    v_lshlrev_b32_sdwa v96, 3, v118 dst_sel:DWORD dst_unused:UNUSED_PAD src0_sel:DWORD src1_sel:WORD_0
    v_lshlrev_b32_sdwa v98, 3, v118 dst_sel:DWORD dst_unused:UNUSED_PAD src0_sel:DWORD src1_sel:WORD_1
    ds_read_b64 v[96:97], v96
    ds_read_b64 v[98:99], v98
    v_lshlrev_b32_sdwa v100, 3, v119 dst_sel:DWORD dst_unused:UNUSED_PAD src0_sel:DWORD src1_sel:WORD_0
    v_lshlrev_b32_sdwa v102, 3, v119 dst_sel:DWORD dst_unused:UNUSED_PAD src0_sel:DWORD src1_sel:WORD_1
    ds_read_b64 v[100:101], v100
    ds_read_b64 v[102:103], v102
    buffer_load_dwordx4 v[116:119], v71, s[12:15], s20 offen offset:2048 sc1
    s_waitcnt lgkmcnt(9)
    v_smfmac_f32_16x16x64_bf16 v[46:49], v[66:69], v[104:111], v70
    s_lshl_b32 s35, s35, 12
    s_add_u32 s35, s35, 20971520
    v_mfma_f32_16x16x32_bf16 v[112:115], v[72:75], v[192:195], 0
    s_waitcnt vmcnt(2)
    v_lshlrev_b32_sdwa v104, 3, v120 dst_sel:DWORD dst_unused:UNUSED_PAD src0_sel:DWORD src1_sel:WORD_0
    v_lshlrev_b32_sdwa v106, 3, v120 dst_sel:DWORD dst_unused:UNUSED_PAD src0_sel:DWORD src1_sel:WORD_1
    ds_read_b64 v[104:105], v104
    ds_read_b64 v[106:107], v106
    v_mfma_f32_16x16x32_bf16 v[112:115], v[76:79], v[196:199], v[112:115]
    v_lshlrev_b32_sdwa v108, 3, v121 dst_sel:DWORD dst_unused:UNUSED_PAD src0_sel:DWORD src1_sel:WORD_0
    v_lshlrev_b32_sdwa v110, 3, v121 dst_sel:DWORD dst_unused:UNUSED_PAD src0_sel:DWORD src1_sel:WORD_1
    v_cvt_pk_bf16_f32 v49, v48, v49
    v_cvt_pk_bf16_f32 v48, v46, v47
    v_and_b32 v47, s23, v45
    v_lshlrev_b32 v46, 16, v45
    v_and_b32 v45, s23, v44
    v_lshlrev_b32 v44, 16, v44
    ds_read_b64 v[108:109], v108
    ds_read_b64 v[110:111], v110
    s_waitcnt lgkmcnt(9)
    v_smfmac_f32_16x16x64_bf16 v[44:47], v[66:69], v[88:95], v70
    s_and_b32 s57, s57, 0xffff
    s_mov_b32 s58, 2
    v_mfma_f32_16x16x32_bf16 v[112:115], v[80:83], v[200:203], v[112:115]
    v_lshlrev_b32_sdwa v88, 3, v122 dst_sel:DWORD dst_unused:UNUSED_PAD src0_sel:DWORD src1_sel:WORD_0
    v_lshlrev_b32_sdwa v90, 3, v122 dst_sel:DWORD dst_unused:UNUSED_PAD src0_sel:DWORD src1_sel:WORD_1
    ds_read_b64 v[88:89], v88
    ds_read_b64 v[90:91], v90
    v_mfma_f32_16x16x32_bf16 v[112:115], v[84:87], v[204:207], v[112:115]
    v_lshlrev_b32_sdwa v92, 3, v123 dst_sel:DWORD dst_unused:UNUSED_PAD src0_sel:DWORD src1_sel:WORD_0
    v_lshlrev_b32_sdwa v94, 3, v123 dst_sel:DWORD dst_unused:UNUSED_PAD src0_sel:DWORD src1_sel:WORD_1
    ds_read_b64 v[92:93], v92
    ds_read_b64 v[94:95], v94
    buffer_load_dwordx4 v[120:123], v71, s[12:15], s20 offen offset:3072 sc1
    s_waitcnt lgkmcnt(8)
    v_smfmac_f32_16x16x64_bf16 v[44:47], v[66:69], v[96:103], v70
    s_nop 0
    v_cvt_pk_bf16_f32 v112, v112, v113
    v_cvt_pk_bf16_f32 v113, v114, v115
    v_lshlrev_b32_sdwa v114, 3, v70 dst_sel:DWORD dst_unused:UNUSED_PAD src0_sel:DWORD src1_sel:WORD_1
    ds_write_b64 v114, v[112:113] offset:33280
    s_mov_b32 s59, 0x00020000
    s_and_b32 s61, s61, 0xffff
    s_waitcnt vmcnt(2)
    v_lshlrev_b32_sdwa v96, 3, v124 dst_sel:DWORD dst_unused:UNUSED_PAD src0_sel:DWORD src1_sel:WORD_0
    v_lshlrev_b32_sdwa v98, 3, v124 dst_sel:DWORD dst_unused:UNUSED_PAD src0_sel:DWORD src1_sel:WORD_1
    ds_read_b64 v[96:97], v96
    ds_read_b64 v[98:99], v98
    v_lshlrev_b32_sdwa v100, 3, v125 dst_sel:DWORD dst_unused:UNUSED_PAD src0_sel:DWORD src1_sel:WORD_0
    v_lshlrev_b32_sdwa v102, 3, v125 dst_sel:DWORD dst_unused:UNUSED_PAD src0_sel:DWORD src1_sel:WORD_1
    v_cvt_pk_bf16_f32 v47, v46, v47
    v_cvt_pk_bf16_f32 v46, v44, v45
    v_and_b32 v45, s23, v43
    v_lshlrev_b32 v44, 16, v43
    v_and_b32 v43, s23, v42
    v_lshlrev_b32 v42, 16, v42
    ds_read_b64 v[100:101], v100
    ds_read_b64 v[102:103], v102
    s_waitcnt lgkmcnt(9)
    v_smfmac_f32_16x16x64_bf16 v[42:45], v[66:69], v[104:111], v70
    s_mov_b32 s62, 32768
    s_mov_b32 s63, 0x00020000
    v_mfma_f32_16x16x32_bf16 v[112:115], v[72:75], v[208:211], 0
    v_lshlrev_b32_sdwa v104, 3, v126 dst_sel:DWORD dst_unused:UNUSED_PAD src0_sel:DWORD src1_sel:WORD_0
    v_lshlrev_b32_sdwa v106, 3, v126 dst_sel:DWORD dst_unused:UNUSED_PAD src0_sel:DWORD src1_sel:WORD_1
    ds_read_b64 v[104:105], v104
    ds_read_b64 v[106:107], v106
    v_mfma_f32_16x16x32_bf16 v[112:115], v[76:79], v[212:215], v[112:115]
    v_lshlrev_b32_sdwa v108, 3, v127 dst_sel:DWORD dst_unused:UNUSED_PAD src0_sel:DWORD src1_sel:WORD_0
    v_lshlrev_b32_sdwa v110, 3, v127 dst_sel:DWORD dst_unused:UNUSED_PAD src0_sel:DWORD src1_sel:WORD_1
    ds_read_b64 v[108:109], v108
    ds_read_b64 v[110:111], v110
    s_add_u32 s20, s20, 0x1000
    buffer_load_dwordx4 v[124:127], v71, s[12:15], s20 offen offset:0 sc1
    s_waitcnt lgkmcnt(9)
    v_smfmac_f32_16x16x64_bf16 v[42:45], v[66:69], v[88:95], v70
    s_setprio 1
    s_xor_b32 s64, s34, 1
    s_lshl_b32 s64, s64, 7
    v_mfma_f32_16x16x32_bf16 v[112:115], v[80:83], v[216:219], v[112:115]
    s_waitcnt vmcnt(2)
    v_lshlrev_b32_sdwa v88, 3, v116 dst_sel:DWORD dst_unused:UNUSED_PAD src0_sel:DWORD src1_sel:WORD_0
    v_lshlrev_b32_sdwa v90, 3, v116 dst_sel:DWORD dst_unused:UNUSED_PAD src0_sel:DWORD src1_sel:WORD_1
    ds_read_b64 v[88:89], v88
    ds_read_b64 v[90:91], v90
    v_mfma_f32_16x16x32_bf16 v[112:115], v[84:87], v[220:223], v[112:115]
    v_lshlrev_b32_sdwa v92, 3, v117 dst_sel:DWORD dst_unused:UNUSED_PAD src0_sel:DWORD src1_sel:WORD_0
    v_lshlrev_b32_sdwa v94, 3, v117 dst_sel:DWORD dst_unused:UNUSED_PAD src0_sel:DWORD src1_sel:WORD_1
    v_cvt_pk_bf16_f32 v45, v44, v45
    v_cvt_pk_bf16_f32 v44, v42, v43
    v_and_b32 v43, s23, v41
    v_lshlrev_b32 v42, 16, v41
    v_and_b32 v41, s23, v40
    v_lshlrev_b32 v40, 16, v40
    ds_read_b64 v[92:93], v92
    ds_read_b64 v[94:95], v94
    s_waitcnt lgkmcnt(8)
    v_smfmac_f32_16x16x64_bf16 v[40:43], v[66:69], v[96:103], v70
    v_cvt_pk_bf16_f32 v112, v112, v113
    v_cvt_pk_bf16_f32 v113, v114, v115
    v_lshlrev_b32_sdwa v114, 3, v70 dst_sel:DWORD dst_unused:UNUSED_PAD src0_sel:DWORD src1_sel:WORD_1
    ds_write_b64 v114, v[112:113] offset:33408
    s_add_u32 s64, s64, s33
    s_lshl_b32 s65, s3, 20
    v_lshlrev_b32_sdwa v96, 3, v118 dst_sel:DWORD dst_unused:UNUSED_PAD src0_sel:DWORD src1_sel:WORD_0
    v_lshlrev_b32_sdwa v98, 3, v118 dst_sel:DWORD dst_unused:UNUSED_PAD src0_sel:DWORD src1_sel:WORD_1
    ds_read_b64 v[96:97], v96
    ds_read_b64 v[98:99], v98
    v_lshlrev_b32_sdwa v100, 3, v119 dst_sel:DWORD dst_unused:UNUSED_PAD src0_sel:DWORD src1_sel:WORD_0
    v_lshlrev_b32_sdwa v102, 3, v119 dst_sel:DWORD dst_unused:UNUSED_PAD src0_sel:DWORD src1_sel:WORD_1
    ds_read_b64 v[100:101], v100
    ds_read_b64 v[102:103], v102
    buffer_load_dwordx4 v[116:119], v71, s[12:15], s20 offen offset:1024 sc1
    s_waitcnt lgkmcnt(9)
    v_smfmac_f32_16x16x64_bf16 v[40:43], v[66:69], v[104:111], v70
    s_add_u32 s66, s65, 1048576
    s_lshl_b32 s67, s3, 14
    v_mfma_f32_16x16x32_bf16 v[112:115], v[72:75], v[224:227], 0
    s_waitcnt vmcnt(2)
    v_lshlrev_b32_sdwa v104, 3, v120 dst_sel:DWORD dst_unused:UNUSED_PAD src0_sel:DWORD src1_sel:WORD_0
    v_lshlrev_b32_sdwa v106, 3, v120 dst_sel:DWORD dst_unused:UNUSED_PAD src0_sel:DWORD src1_sel:WORD_1
    ds_read_b64 v[104:105], v104
    ds_read_b64 v[106:107], v106
    v_mfma_f32_16x16x32_bf16 v[112:115], v[76:79], v[228:231], v[112:115]
    v_lshlrev_b32_sdwa v108, 3, v121 dst_sel:DWORD dst_unused:UNUSED_PAD src0_sel:DWORD src1_sel:WORD_0
    v_lshlrev_b32_sdwa v110, 3, v121 dst_sel:DWORD dst_unused:UNUSED_PAD src0_sel:DWORD src1_sel:WORD_1
    v_cvt_pk_bf16_f32 v43, v42, v43
    v_cvt_pk_bf16_f32 v42, v40, v41
    v_and_b32 v41, s23, v39
    v_lshlrev_b32 v40, 16, v39
    v_and_b32 v39, s23, v38
    v_lshlrev_b32 v38, 16, v38
    ds_read_b64 v[108:109], v108
    ds_read_b64 v[110:111], v110
    s_waitcnt lgkmcnt(9)
    v_smfmac_f32_16x16x64_bf16 v[38:41], v[66:69], v[88:95], v70
    s_add_u32 s67, s67, 8000
    s_lshl_b32 s68, s64, 7
    v_mfma_f32_16x16x32_bf16 v[112:115], v[80:83], v[232:235], v[112:115]
    v_lshlrev_b32_sdwa v88, 3, v122 dst_sel:DWORD dst_unused:UNUSED_PAD src0_sel:DWORD src1_sel:WORD_0
    v_lshlrev_b32_sdwa v90, 3, v122 dst_sel:DWORD dst_unused:UNUSED_PAD src0_sel:DWORD src1_sel:WORD_1
    ds_read_b64 v[88:89], v88
    ds_read_b64 v[90:91], v90
    v_mfma_f32_16x16x32_bf16 v[112:115], v[84:87], v[236:239], v[112:115]
    v_lshlrev_b32_sdwa v92, 3, v123 dst_sel:DWORD dst_unused:UNUSED_PAD src0_sel:DWORD src1_sel:WORD_0
    v_lshlrev_b32_sdwa v94, 3, v123 dst_sel:DWORD dst_unused:UNUSED_PAD src0_sel:DWORD src1_sel:WORD_1
    ds_read_b64 v[92:93], v92
    ds_read_b64 v[94:95], v94
    s_add_u32 s20, s20, 0x3f800
    buffer_load_dwordx4 v[120:123], v71, s[12:15], s20 offen offset:3072 sc1
    s_waitcnt lgkmcnt(8)
    v_smfmac_f32_16x16x64_bf16 v[38:41], v[66:69], v[96:103], v70
    v_cvt_pk_bf16_f32 v112, v112, v113
    v_cvt_pk_bf16_f32 v113, v114, v115
    v_lshlrev_b32_sdwa v114, 3, v70 dst_sel:DWORD dst_unused:UNUSED_PAD src0_sel:DWORD src1_sel:WORD_1
    ds_write_b64 v114, v[112:113] offset:33536
    s_lshl_b32 s69, s64, 8
    s_add_u32 s69, s69, s65
    s_waitcnt vmcnt(2)
    v_lshlrev_b32_sdwa v96, 3, v124 dst_sel:DWORD dst_unused:UNUSED_PAD src0_sel:DWORD src1_sel:WORD_0
    v_lshlrev_b32_sdwa v98, 3, v124 dst_sel:DWORD dst_unused:UNUSED_PAD src0_sel:DWORD src1_sel:WORD_1
    ds_read_b64 v[96:97], v96
    ds_read_b64 v[98:99], v98
    v_lshlrev_b32_sdwa v100, 3, v125 dst_sel:DWORD dst_unused:UNUSED_PAD src0_sel:DWORD src1_sel:WORD_0
    v_lshlrev_b32_sdwa v102, 3, v125 dst_sel:DWORD dst_unused:UNUSED_PAD src0_sel:DWORD src1_sel:WORD_1
    v_cvt_pk_bf16_f32 v41, v40, v41
    v_cvt_pk_bf16_f32 v40, v38, v39
    v_and_b32 v39, s23, v37
    v_lshlrev_b32 v38, 16, v37
    v_and_b32 v37, s23, v36
    v_lshlrev_b32 v36, 16, v36
    ds_read_b64 v[100:101], v100
    ds_read_b64 v[102:103], v102
    s_waitcnt lgkmcnt(9)
    v_smfmac_f32_16x16x64_bf16 v[36:39], v[66:69], v[104:111], v70
    s_add_u32 s69, s69, 20971520
    s_mov_b32 s42, 0
    v_mfma_f32_16x16x32_bf16 v[112:115], v[72:75], v[240:243], 0
    v_lshlrev_b32_sdwa v104, 3, v126 dst_sel:DWORD dst_unused:UNUSED_PAD src0_sel:DWORD src1_sel:WORD_0
    v_lshlrev_b32_sdwa v106, 3, v126 dst_sel:DWORD dst_unused:UNUSED_PAD src0_sel:DWORD src1_sel:WORD_1
    ds_read_b64 v[104:105], v104
    ds_read_b64 v[106:107], v106
    v_mfma_f32_16x16x32_bf16 v[112:115], v[76:79], v[244:247], v[112:115]
    v_lshlrev_b32_sdwa v108, 3, v127 dst_sel:DWORD dst_unused:UNUSED_PAD src0_sel:DWORD src1_sel:WORD_0
    v_lshlrev_b32_sdwa v110, 3, v127 dst_sel:DWORD dst_unused:UNUSED_PAD src0_sel:DWORD src1_sel:WORD_1
    ds_read_b64 v[108:109], v108
    ds_read_b64 v[110:111], v110
    buffer_load_dwordx4 v[72:75], v71, s[12:15], s20 offen offset:2048 sc1
    s_waitcnt lgkmcnt(9)
    v_smfmac_f32_16x16x64_bf16 v[36:39], v[66:69], v[88:95], v70
    s_setprio 0
    s_mov_b32 s43, 0
    s_add_u32 s17, s16, 4096
    v_mfma_f32_16x16x32_bf16 v[112:115], v[80:83], v[248:251], v[112:115]
    s_waitcnt vmcnt(2)
    v_lshlrev_b32_sdwa v88, 3, v116 dst_sel:DWORD dst_unused:UNUSED_PAD src0_sel:DWORD src1_sel:WORD_0
    v_lshlrev_b32_sdwa v90, 3, v116 dst_sel:DWORD dst_unused:UNUSED_PAD src0_sel:DWORD src1_sel:WORD_1
    ds_read_b64 v[88:89], v88
    ds_read_b64 v[90:91], v90
    v_mfma_f32_16x16x32_bf16 v[112:115], v[84:87], v[252:255], v[112:115]
    v_lshlrev_b32_sdwa v92, 3, v117 dst_sel:DWORD dst_unused:UNUSED_PAD src0_sel:DWORD src1_sel:WORD_0
    v_lshlrev_b32_sdwa v94, 3, v117 dst_sel:DWORD dst_unused:UNUSED_PAD src0_sel:DWORD src1_sel:WORD_1
    v_cvt_pk_bf16_f32 v39, v38, v39
    v_cvt_pk_bf16_f32 v38, v36, v37
    v_and_b32 v37, s23, v35
    v_lshlrev_b32 v36, 16, v35
    v_and_b32 v35, s23, v34
    v_lshlrev_b32 v34, 16, v34
    ds_read_b64 v[92:93], v92
    ds_read_b64 v[94:95], v94
    buffer_load_dwordx4 v[76:79], v71, s[12:15], s20 offen offset:1024 sc1
    s_waitcnt lgkmcnt(8)
    v_smfmac_f32_16x16x64_bf16 v[34:37], v[66:69], v[96:103], v70
    v_cvt_pk_bf16_f32 v112, v112, v113
    v_cvt_pk_bf16_f32 v113, v114, v115
    v_lshlrev_b32_sdwa v114, 3, v70 dst_sel:DWORD dst_unused:UNUSED_PAD src0_sel:DWORD src1_sel:WORD_1
    ds_write_b64 v114, v[112:113] offset:33664
    s_add_u32 s32, s18, 4096
    v_lshlrev_b32_sdwa v96, 3, v118 dst_sel:DWORD dst_unused:UNUSED_PAD src0_sel:DWORD src1_sel:WORD_0
    v_lshlrev_b32_sdwa v98, 3, v118 dst_sel:DWORD dst_unused:UNUSED_PAD src0_sel:DWORD src1_sel:WORD_1
    ds_read_b64 v[96:97], v96
    ds_read_b64 v[98:99], v98
    v_lshlrev_b32_sdwa v100, 3, v119 dst_sel:DWORD dst_unused:UNUSED_PAD src0_sel:DWORD src1_sel:WORD_0
    v_lshlrev_b32_sdwa v102, 3, v119 dst_sel:DWORD dst_unused:UNUSED_PAD src0_sel:DWORD src1_sel:WORD_1
    ds_read_b64 v[100:101], v100
    ds_read_b64 v[102:103], v102
    buffer_load_dwordx4 v[124:127], v71, s[12:15], s20 offen offset:0 sc1
    s_waitcnt lgkmcnt(9)
    v_smfmac_f32_16x16x64_bf16 v[34:37], v[66:69], v[104:111], v70
    s_waitcnt lgkmcnt(4)
    s_barrier
    s_setprio 3
    s_waitcnt vmcnt(3)
    v_lshlrev_b32_sdwa v104, 3, v120 dst_sel:DWORD dst_unused:UNUSED_PAD src0_sel:DWORD src1_sel:WORD_0
    v_lshlrev_b32_sdwa v106, 3, v120 dst_sel:DWORD dst_unused:UNUSED_PAD src0_sel:DWORD src1_sel:WORD_1
    ds_read_b64 v[104:105], v104
    ds_read_b64 v[106:107], v106
    v_lshlrev_b32_sdwa v108, 3, v121 dst_sel:DWORD dst_unused:UNUSED_PAD src0_sel:DWORD src1_sel:WORD_0
    v_lshlrev_b32_sdwa v110, 3, v121 dst_sel:DWORD dst_unused:UNUSED_PAD src0_sel:DWORD src1_sel:WORD_1
    v_cvt_pk_bf16_f32 v37, v36, v37
    v_cvt_pk_bf16_f32 v36, v34, v35
    v_and_b32 v35, s23, v33
    v_lshlrev_b32 v34, 16, v33
    v_and_b32 v33, s23, v32
    v_lshlrev_b32 v32, 16, v32
    ds_read_b64 v[108:109], v108
    ds_read_b64 v[110:111], v110
    s_add_u32 s20, s20, 0xfffff000
    buffer_load_dwordx4 v[80:83], v71, s[12:15], s20 offen offset:3072 sc1
    v_smfmac_f32_16x16x64_bf16 v[32:35], v[66:69], v[88:95], v70
    v_lshlrev_b32_sdwa v88, 3, v122 dst_sel:DWORD dst_unused:UNUSED_PAD src0_sel:DWORD src1_sel:WORD_0
    v_lshlrev_b32_sdwa v90, 3, v122 dst_sel:DWORD dst_unused:UNUSED_PAD src0_sel:DWORD src1_sel:WORD_1
    ds_read_b64 v[88:89], v88
    ds_read_b64 v[90:91], v90
    v_lshlrev_b32_sdwa v92, 3, v123 dst_sel:DWORD dst_unused:UNUSED_PAD src0_sel:DWORD src1_sel:WORD_0
    v_lshlrev_b32_sdwa v94, 3, v123 dst_sel:DWORD dst_unused:UNUSED_PAD src0_sel:DWORD src1_sel:WORD_1
    ds_read_b64 v[92:93], v92
    ds_read_b64 v[94:95], v94
    buffer_load_dwordx4 v[84:87], v71, s[12:15], s20 offen offset:2048 sc1
    s_waitcnt lgkmcnt(8)
    v_smfmac_f32_16x16x64_bf16 v[32:35], v[66:69], v[96:103], v70
    s_waitcnt vmcnt(4)
    v_lshlrev_b32_sdwa v96, 3, v72 dst_sel:DWORD dst_unused:UNUSED_PAD src0_sel:DWORD src1_sel:WORD_0
    v_lshlrev_b32_sdwa v98, 3, v72 dst_sel:DWORD dst_unused:UNUSED_PAD src0_sel:DWORD src1_sel:WORD_1
    ds_read_b64 v[96:97], v96
    ds_read_b64 v[98:99], v98
    v_lshlrev_b32_sdwa v100, 3, v73 dst_sel:DWORD dst_unused:UNUSED_PAD src0_sel:DWORD src1_sel:WORD_0
    v_lshlrev_b32_sdwa v102, 3, v73 dst_sel:DWORD dst_unused:UNUSED_PAD src0_sel:DWORD src1_sel:WORD_1
    s_nop 0
    v_cvt_pk_bf16_f32 v35, v34, v35
    v_cvt_pk_bf16_f32 v34, v32, v33
    v_lshlrev_b32 v32, 16, v34
    v_and_b32 v33, s23, v34
    v_lshlrev_b32 v34, 16, v35
    v_and_b32 v35, s23, v35
    ds_read_b64 v[100:101], v100
    ds_read_b64 v[102:103], v102
    buffer_load_dwordx4 v[116:119], v71, s[12:15], s20 offen offset:1024 sc1
    s_waitcnt lgkmcnt(8)
    v_smfmac_f32_16x16x64_bf16 v[32:35], v[66:69], v[104:111], v70
    v_lshlrev_b32_sdwa v104, 3, v74 dst_sel:DWORD dst_unused:UNUSED_PAD src0_sel:DWORD src1_sel:WORD_0
    v_lshlrev_b32_sdwa v106, 3, v74 dst_sel:DWORD dst_unused:UNUSED_PAD src0_sel:DWORD src1_sel:WORD_1
    ds_read_b64 v[104:105], v104
    ds_read_b64 v[106:107], v106
    v_lshlrev_b32_sdwa v108, 3, v75 dst_sel:DWORD dst_unused:UNUSED_PAD src0_sel:DWORD src1_sel:WORD_0
    v_lshlrev_b32_sdwa v110, 3, v75 dst_sel:DWORD dst_unused:UNUSED_PAD src0_sel:DWORD src1_sel:WORD_1
    ds_read_b64 v[108:109], v108
    ds_read_b64 v[110:111], v110
    buffer_load_dwordx4 v[120:123], v71, s[12:15], s20 offen offset:0 sc1
    s_waitcnt lgkmcnt(8)
    v_smfmac_f32_16x16x64_bf16 v[32:35], v[66:69], v[88:95], v70
    s_waitcnt vmcnt(5)
    v_lshlrev_b32_sdwa v88, 3, v76 dst_sel:DWORD dst_unused:UNUSED_PAD src0_sel:DWORD src1_sel:WORD_0
    v_lshlrev_b32_sdwa v90, 3, v76 dst_sel:DWORD dst_unused:UNUSED_PAD src0_sel:DWORD src1_sel:WORD_1
    ds_read_b64 v[88:89], v88
    ds_read_b64 v[90:91], v90
    v_lshlrev_b32_sdwa v92, 3, v77 dst_sel:DWORD dst_unused:UNUSED_PAD src0_sel:DWORD src1_sel:WORD_0
    v_lshlrev_b32_sdwa v94, 3, v77 dst_sel:DWORD dst_unused:UNUSED_PAD src0_sel:DWORD src1_sel:WORD_1
    s_nop 0
    v_cvt_pk_bf16_f32 v32, v32, v33
    v_cvt_pk_bf16_f32 v33, v34, v35
    v_lshlrev_b32 v34, 16, v36
    v_and_b32 v35, s23, v36
    v_lshlrev_b32 v36, 16, v37
    v_and_b32 v37, s23, v37
    ds_read_b64 v[92:93], v92
    ds_read_b64 v[94:95], v94
    s_add_u32 s20, s20, 0xfffff000
    buffer_load_dwordx4 v[72:75], v71, s[12:15], s20 offen offset:3072 sc1
    s_waitcnt lgkmcnt(8)
    v_smfmac_f32_16x16x64_bf16 v[34:37], v[66:69], v[96:103], v70
    v_lshlrev_b32_sdwa v96, 3, v78 dst_sel:DWORD dst_unused:UNUSED_PAD src0_sel:DWORD src1_sel:WORD_0
    v_lshlrev_b32_sdwa v98, 3, v78 dst_sel:DWORD dst_unused:UNUSED_PAD src0_sel:DWORD src1_sel:WORD_1
    ds_read_b64 v[96:97], v96
    ds_read_b64 v[98:99], v98
    v_lshlrev_b32_sdwa v100, 3, v79 dst_sel:DWORD dst_unused:UNUSED_PAD src0_sel:DWORD src1_sel:WORD_0
    v_lshlrev_b32_sdwa v102, 3, v79 dst_sel:DWORD dst_unused:UNUSED_PAD src0_sel:DWORD src1_sel:WORD_1
    ds_read_b64 v[100:101], v100
    ds_read_b64 v[102:103], v102
    buffer_load_dwordx4 v[76:79], v71, s[12:15], s20 offen offset:2048 sc1
    s_waitcnt lgkmcnt(8)
    v_smfmac_f32_16x16x64_bf16 v[34:37], v[66:69], v[104:111], v70
    s_waitcnt vmcnt(6)
    v_lshlrev_b32_sdwa v104, 3, v124 dst_sel:DWORD dst_unused:UNUSED_PAD src0_sel:DWORD src1_sel:WORD_0
    v_lshlrev_b32_sdwa v106, 3, v124 dst_sel:DWORD dst_unused:UNUSED_PAD src0_sel:DWORD src1_sel:WORD_1
    ds_read_b64 v[104:105], v104
    ds_read_b64 v[106:107], v106
    v_lshlrev_b32_sdwa v108, 3, v125 dst_sel:DWORD dst_unused:UNUSED_PAD src0_sel:DWORD src1_sel:WORD_0
    v_lshlrev_b32_sdwa v110, 3, v125 dst_sel:DWORD dst_unused:UNUSED_PAD src0_sel:DWORD src1_sel:WORD_1
    s_nop 0
    v_cvt_pk_bf16_f32 v34, v34, v35
    v_cvt_pk_bf16_f32 v35, v36, v37
    v_lshlrev_b32 v36, 16, v38
    v_and_b32 v37, s23, v38
    v_lshlrev_b32 v38, 16, v39
    v_and_b32 v39, s23, v39
    ds_read_b64 v[108:109], v108
    ds_read_b64 v[110:111], v110
    buffer_store_dwordx4 v[32:35], v71, s[12:15], s16 offen offset:0 sc1
    s_waitcnt lgkmcnt(8)
    v_smfmac_f32_16x16x64_bf16 v[36:39], v[66:69], v[88:95], v70
    v_lshlrev_b32_sdwa v88, 3, v126 dst_sel:DWORD dst_unused:UNUSED_PAD src0_sel:DWORD src1_sel:WORD_0
    v_lshlrev_b32_sdwa v90, 3, v126 dst_sel:DWORD dst_unused:UNUSED_PAD src0_sel:DWORD src1_sel:WORD_1
    ds_read_b64 v[88:89], v88
    ds_read_b64 v[90:91], v90
    v_lshlrev_b32_sdwa v92, 3, v127 dst_sel:DWORD dst_unused:UNUSED_PAD src0_sel:DWORD src1_sel:WORD_0
    v_lshlrev_b32_sdwa v94, 3, v127 dst_sel:DWORD dst_unused:UNUSED_PAD src0_sel:DWORD src1_sel:WORD_1
    ds_read_b64 v[92:93], v92
    ds_read_b64 v[94:95], v94
    buffer_load_dwordx4 v[124:127], v71, s[12:15], s20 offen offset:1024 sc1
    s_waitcnt lgkmcnt(8)
    v_smfmac_f32_16x16x64_bf16 v[36:39], v[66:69], v[96:103], v70
    s_waitcnt vmcnt(7)
    v_lshlrev_b32_sdwa v96, 3, v80 dst_sel:DWORD dst_unused:UNUSED_PAD src0_sel:DWORD src1_sel:WORD_0
    v_lshlrev_b32_sdwa v98, 3, v80 dst_sel:DWORD dst_unused:UNUSED_PAD src0_sel:DWORD src1_sel:WORD_1
    ds_read_b64 v[96:97], v96
    ds_read_b64 v[98:99], v98
    v_lshlrev_b32_sdwa v100, 3, v81 dst_sel:DWORD dst_unused:UNUSED_PAD src0_sel:DWORD src1_sel:WORD_0
    v_lshlrev_b32_sdwa v102, 3, v81 dst_sel:DWORD dst_unused:UNUSED_PAD src0_sel:DWORD src1_sel:WORD_1
    s_nop 0
    v_cvt_pk_bf16_f32 v36, v36, v37
    v_cvt_pk_bf16_f32 v37, v38, v39
    v_lshlrev_b32 v38, 16, v40
    v_and_b32 v39, s23, v40
    v_lshlrev_b32 v40, 16, v41
    v_and_b32 v41, s23, v41
    ds_read_b64 v[100:101], v100
    ds_read_b64 v[102:103], v102
    s_waitcnt lgkmcnt(8)
    v_smfmac_f32_16x16x64_bf16 v[38:41], v[66:69], v[104:111], v70
    v_lshlrev_b32_sdwa v104, 3, v82 dst_sel:DWORD dst_unused:UNUSED_PAD src0_sel:DWORD src1_sel:WORD_0
    v_lshlrev_b32_sdwa v106, 3, v82 dst_sel:DWORD dst_unused:UNUSED_PAD src0_sel:DWORD src1_sel:WORD_1
    ds_read_b64 v[104:105], v104
    ds_read_b64 v[106:107], v106
    v_lshlrev_b32_sdwa v108, 3, v83 dst_sel:DWORD dst_unused:UNUSED_PAD src0_sel:DWORD src1_sel:WORD_0
    v_lshlrev_b32_sdwa v110, 3, v83 dst_sel:DWORD dst_unused:UNUSED_PAD src0_sel:DWORD src1_sel:WORD_1
    ds_read_b64 v[108:109], v108
    ds_read_b64 v[110:111], v110
    buffer_load_dwordx4 v[80:83], v71, s[12:15], s20 offen offset:0 sc1
    s_waitcnt lgkmcnt(8)
    v_smfmac_f32_16x16x64_bf16 v[38:41], v[66:69], v[88:95], v70
    s_waitcnt vmcnt(7)
    v_lshlrev_b32_sdwa v88, 3, v84 dst_sel:DWORD dst_unused:UNUSED_PAD src0_sel:DWORD src1_sel:WORD_0
    v_lshlrev_b32_sdwa v90, 3, v84 dst_sel:DWORD dst_unused:UNUSED_PAD src0_sel:DWORD src1_sel:WORD_1
    ds_read_b64 v[88:89], v88
    ds_read_b64 v[90:91], v90
    v_lshlrev_b32_sdwa v92, 3, v85 dst_sel:DWORD dst_unused:UNUSED_PAD src0_sel:DWORD src1_sel:WORD_0
    v_lshlrev_b32_sdwa v94, 3, v85 dst_sel:DWORD dst_unused:UNUSED_PAD src0_sel:DWORD src1_sel:WORD_1
    s_nop 0
    v_cvt_pk_bf16_f32 v38, v38, v39
    v_cvt_pk_bf16_f32 v39, v40, v41
    v_lshlrev_b32 v40, 16, v42
    v_and_b32 v41, s23, v42
    v_lshlrev_b32 v42, 16, v43
    v_and_b32 v43, s23, v43
    ds_read_b64 v[92:93], v92
    ds_read_b64 v[94:95], v94
    s_waitcnt lgkmcnt(8)
    v_smfmac_f32_16x16x64_bf16 v[40:43], v[66:69], v[96:103], v70
    v_lshlrev_b32_sdwa v96, 3, v86 dst_sel:DWORD dst_unused:UNUSED_PAD src0_sel:DWORD src1_sel:WORD_0
    v_lshlrev_b32_sdwa v98, 3, v86 dst_sel:DWORD dst_unused:UNUSED_PAD src0_sel:DWORD src1_sel:WORD_1
    ds_read_b64 v[96:97], v96
    ds_read_b64 v[98:99], v98
    v_lshlrev_b32_sdwa v100, 3, v87 dst_sel:DWORD dst_unused:UNUSED_PAD src0_sel:DWORD src1_sel:WORD_0
    v_lshlrev_b32_sdwa v102, 3, v87 dst_sel:DWORD dst_unused:UNUSED_PAD src0_sel:DWORD src1_sel:WORD_1
    ds_read_b64 v[100:101], v100
    ds_read_b64 v[102:103], v102
    s_add_u32 s20, s20, 0xfffffc00
    buffer_load_dwordx4 v[84:87], v71, s[12:15], s20 offen offset:0 sc1
    s_waitcnt lgkmcnt(8)
    v_smfmac_f32_16x16x64_bf16 v[40:43], v[66:69], v[104:111], v70
    s_waitcnt vmcnt(7)
    v_lshlrev_b32_sdwa v104, 3, v116 dst_sel:DWORD dst_unused:UNUSED_PAD src0_sel:DWORD src1_sel:WORD_0
    v_lshlrev_b32_sdwa v106, 3, v116 dst_sel:DWORD dst_unused:UNUSED_PAD src0_sel:DWORD src1_sel:WORD_1
    ds_read_b64 v[104:105], v104
    ds_read_b64 v[106:107], v106
    v_lshlrev_b32_sdwa v108, 3, v117 dst_sel:DWORD dst_unused:UNUSED_PAD src0_sel:DWORD src1_sel:WORD_0
    v_lshlrev_b32_sdwa v110, 3, v117 dst_sel:DWORD dst_unused:UNUSED_PAD src0_sel:DWORD src1_sel:WORD_1
    s_nop 0
    v_cvt_pk_bf16_f32 v40, v40, v41
    v_cvt_pk_bf16_f32 v41, v42, v43
    v_lshlrev_b32 v42, 16, v44
    v_and_b32 v43, s23, v44
    v_lshlrev_b32 v44, 16, v45
    v_and_b32 v45, s23, v45
    ds_read_b64 v[108:109], v108
    ds_read_b64 v[110:111], v110
    s_waitcnt lgkmcnt(8)
    v_smfmac_f32_16x16x64_bf16 v[42:45], v[66:69], v[88:95], v70
    v_lshlrev_b32_sdwa v88, 3, v118 dst_sel:DWORD dst_unused:UNUSED_PAD src0_sel:DWORD src1_sel:WORD_0
    v_lshlrev_b32_sdwa v90, 3, v118 dst_sel:DWORD dst_unused:UNUSED_PAD src0_sel:DWORD src1_sel:WORD_1
    ds_read_b64 v[88:89], v88
    ds_read_b64 v[90:91], v90
    v_lshlrev_b32_sdwa v92, 3, v119 dst_sel:DWORD dst_unused:UNUSED_PAD src0_sel:DWORD src1_sel:WORD_0
    v_lshlrev_b32_sdwa v94, 3, v119 dst_sel:DWORD dst_unused:UNUSED_PAD src0_sel:DWORD src1_sel:WORD_1
    ds_read_b64 v[92:93], v92
    ds_read_b64 v[94:95], v94
    s_add_u32 s20, s20, 0xfffffc00
    buffer_load_dwordx4 v[116:119], v71, s[12:15], s20 offen offset:0 sc1
    s_waitcnt lgkmcnt(8)
    v_smfmac_f32_16x16x64_bf16 v[42:45], v[66:69], v[96:103], v70
    s_waitcnt vmcnt(7)
    v_lshlrev_b32_sdwa v96, 3, v120 dst_sel:DWORD dst_unused:UNUSED_PAD src0_sel:DWORD src1_sel:WORD_0
    v_lshlrev_b32_sdwa v98, 3, v120 dst_sel:DWORD dst_unused:UNUSED_PAD src0_sel:DWORD src1_sel:WORD_1
    ds_read_b64 v[96:97], v96
    ds_read_b64 v[98:99], v98
    v_lshlrev_b32_sdwa v100, 3, v121 dst_sel:DWORD dst_unused:UNUSED_PAD src0_sel:DWORD src1_sel:WORD_0
    v_lshlrev_b32_sdwa v102, 3, v121 dst_sel:DWORD dst_unused:UNUSED_PAD src0_sel:DWORD src1_sel:WORD_1
    s_nop 0
    v_cvt_pk_bf16_f32 v42, v42, v43
    v_cvt_pk_bf16_f32 v43, v44, v45
    v_lshlrev_b32 v44, 16, v46
    v_and_b32 v45, s23, v46
    v_lshlrev_b32 v46, 16, v47
    v_and_b32 v47, s23, v47
    ds_read_b64 v[100:101], v100
    ds_read_b64 v[102:103], v102
    buffer_store_dwordx4 v[36:39], v71, s[12:15], s16 offen offset:1024 sc1
    s_waitcnt lgkmcnt(8)
    v_smfmac_f32_16x16x64_bf16 v[44:47], v[66:69], v[104:111], v70
    v_lshlrev_b32_sdwa v104, 3, v122 dst_sel:DWORD dst_unused:UNUSED_PAD src0_sel:DWORD src1_sel:WORD_0
    v_lshlrev_b32_sdwa v106, 3, v122 dst_sel:DWORD dst_unused:UNUSED_PAD src0_sel:DWORD src1_sel:WORD_1
    ds_read_b64 v[104:105], v104
    ds_read_b64 v[106:107], v106
    v_lshlrev_b32_sdwa v108, 3, v123 dst_sel:DWORD dst_unused:UNUSED_PAD src0_sel:DWORD src1_sel:WORD_0
    v_lshlrev_b32_sdwa v110, 3, v123 dst_sel:DWORD dst_unused:UNUSED_PAD src0_sel:DWORD src1_sel:WORD_1
    ds_read_b64 v[108:109], v108
    ds_read_b64 v[110:111], v110
    s_add_u32 s20, s20, 0x3c00
    buffer_load_dwordx4 v[36:39], v71, s[12:15], s20 offen offset:0 sc1
    s_waitcnt lgkmcnt(8)
    v_smfmac_f32_16x16x64_bf16 v[44:47], v[66:69], v[88:95], v70
    s_waitcnt vmcnt(8)
    v_lshlrev_b32_sdwa v88, 3, v72 dst_sel:DWORD dst_unused:UNUSED_PAD src0_sel:DWORD src1_sel:WORD_0
    v_lshlrev_b32_sdwa v90, 3, v72 dst_sel:DWORD dst_unused:UNUSED_PAD src0_sel:DWORD src1_sel:WORD_1
    ds_read_b64 v[88:89], v88
    ds_read_b64 v[90:91], v90
    v_lshlrev_b32_sdwa v92, 3, v73 dst_sel:DWORD dst_unused:UNUSED_PAD src0_sel:DWORD src1_sel:WORD_0
    v_lshlrev_b32_sdwa v94, 3, v73 dst_sel:DWORD dst_unused:UNUSED_PAD src0_sel:DWORD src1_sel:WORD_1
    s_nop 0
    v_cvt_pk_bf16_f32 v44, v44, v45
    v_cvt_pk_bf16_f32 v45, v46, v47
    v_lshlrev_b32 v46, 16, v48
    v_and_b32 v47, s23, v48
    v_lshlrev_b32 v48, 16, v49
    v_and_b32 v49, s23, v49
    ds_read_b64 v[92:93], v92
    ds_read_b64 v[94:95], v94
    s_add_u32 s20, s20, 0xfffffc00
    buffer_load_dwordx4 v[120:123], v71, s[12:15], s20 offen offset:0 sc1
    s_waitcnt lgkmcnt(8)
    v_smfmac_f32_16x16x64_bf16 v[46:49], v[66:69], v[96:103], v70
    v_lshlrev_b32_sdwa v96, 3, v74 dst_sel:DWORD dst_unused:UNUSED_PAD src0_sel:DWORD src1_sel:WORD_0
    v_lshlrev_b32_sdwa v98, 3, v74 dst_sel:DWORD dst_unused:UNUSED_PAD src0_sel:DWORD src1_sel:WORD_1
    ds_read_b64 v[96:97], v96
    ds_read_b64 v[98:99], v98
    v_lshlrev_b32_sdwa v100, 3, v75 dst_sel:DWORD dst_unused:UNUSED_PAD src0_sel:DWORD src1_sel:WORD_0
    v_lshlrev_b32_sdwa v102, 3, v75 dst_sel:DWORD dst_unused:UNUSED_PAD src0_sel:DWORD src1_sel:WORD_1
    ds_read_b64 v[100:101], v100
    ds_read_b64 v[102:103], v102
    s_waitcnt lgkmcnt(8)
    v_smfmac_f32_16x16x64_bf16 v[46:49], v[66:69], v[104:111], v70
    s_waitcnt vmcnt(8)
    v_lshlrev_b32_sdwa v104, 3, v76 dst_sel:DWORD dst_unused:UNUSED_PAD src0_sel:DWORD src1_sel:WORD_0
    v_lshlrev_b32_sdwa v106, 3, v76 dst_sel:DWORD dst_unused:UNUSED_PAD src0_sel:DWORD src1_sel:WORD_1
    ds_read_b64 v[104:105], v104
    ds_read_b64 v[106:107], v106
    v_lshlrev_b32_sdwa v108, 3, v77 dst_sel:DWORD dst_unused:UNUSED_PAD src0_sel:DWORD src1_sel:WORD_0
    v_lshlrev_b32_sdwa v110, 3, v77 dst_sel:DWORD dst_unused:UNUSED_PAD src0_sel:DWORD src1_sel:WORD_1
    s_nop 0
    v_cvt_pk_bf16_f32 v46, v46, v47
    v_cvt_pk_bf16_f32 v47, v48, v49
    v_lshlrev_b32 v48, 16, v50
    v_and_b32 v49, s23, v50
    v_lshlrev_b32 v50, 16, v51
    v_and_b32 v51, s23, v51
    ds_read_b64 v[108:109], v108
    ds_read_b64 v[110:111], v110
    s_add_u32 s20, s20, 0xfff9ec00
    buffer_load_dwordx4 v[72:75], v71, s[12:15], s20 offen offset:3072 sc1
    s_waitcnt lgkmcnt(8)
    v_smfmac_f32_16x16x64_bf16 v[48:51], v[66:69], v[88:95], v70
    v_lshlrev_b32_sdwa v88, 3, v78 dst_sel:DWORD dst_unused:UNUSED_PAD src0_sel:DWORD src1_sel:WORD_0
    v_lshlrev_b32_sdwa v90, 3, v78 dst_sel:DWORD dst_unused:UNUSED_PAD src0_sel:DWORD src1_sel:WORD_1
    ds_read_b64 v[88:89], v88
    ds_read_b64 v[90:91], v90
    v_lshlrev_b32_sdwa v92, 3, v79 dst_sel:DWORD dst_unused:UNUSED_PAD src0_sel:DWORD src1_sel:WORD_0
    v_lshlrev_b32_sdwa v94, 3, v79 dst_sel:DWORD dst_unused:UNUSED_PAD src0_sel:DWORD src1_sel:WORD_1
    ds_read_b64 v[92:93], v92
    ds_read_b64 v[94:95], v94
    s_waitcnt lgkmcnt(8)
    v_smfmac_f32_16x16x64_bf16 v[48:51], v[66:69], v[96:103], v70
    s_waitcnt vmcnt(7)
    v_lshlrev_b32_sdwa v96, 3, v124 dst_sel:DWORD dst_unused:UNUSED_PAD src0_sel:DWORD src1_sel:WORD_0
    v_lshlrev_b32_sdwa v98, 3, v124 dst_sel:DWORD dst_unused:UNUSED_PAD src0_sel:DWORD src1_sel:WORD_1
    ds_read_b64 v[96:97], v96
    ds_read_b64 v[98:99], v98
    v_lshlrev_b32_sdwa v100, 3, v125 dst_sel:DWORD dst_unused:UNUSED_PAD src0_sel:DWORD src1_sel:WORD_0
    v_lshlrev_b32_sdwa v102, 3, v125 dst_sel:DWORD dst_unused:UNUSED_PAD src0_sel:DWORD src1_sel:WORD_1
    s_nop 0
    v_cvt_pk_bf16_f32 v48, v48, v49
    v_cvt_pk_bf16_f32 v49, v50, v51
    v_lshlrev_b32 v50, 16, v52
    v_and_b32 v51, s23, v52
    v_lshlrev_b32 v52, 16, v53
    v_and_b32 v53, s23, v53
    ds_read_b64 v[100:101], v100
    ds_read_b64 v[102:103], v102
    buffer_load_dwordx4 v[76:79], v71, s[12:15], s20 offen offset:2048 sc1
    s_waitcnt lgkmcnt(8)
    v_smfmac_f32_16x16x64_bf16 v[50:53], v[66:69], v[104:111], v70
    v_lshlrev_b32_sdwa v104, 3, v126 dst_sel:DWORD dst_unused:UNUSED_PAD src0_sel:DWORD src1_sel:WORD_0
    v_lshlrev_b32_sdwa v106, 3, v126 dst_sel:DWORD dst_unused:UNUSED_PAD src0_sel:DWORD src1_sel:WORD_1
    ds_read_b64 v[104:105], v104
    ds_read_b64 v[106:107], v106
    v_lshlrev_b32_sdwa v108, 3, v127 dst_sel:DWORD dst_unused:UNUSED_PAD src0_sel:DWORD src1_sel:WORD_0
    v_lshlrev_b32_sdwa v110, 3, v127 dst_sel:DWORD dst_unused:UNUSED_PAD src0_sel:DWORD src1_sel:WORD_1
    ds_read_b64 v[108:109], v108
    ds_read_b64 v[110:111], v110
    s_waitcnt lgkmcnt(8)
    v_smfmac_f32_16x16x64_bf16 v[50:53], v[66:69], v[88:95], v70
    s_waitcnt vmcnt(7)
    v_lshlrev_b32_sdwa v88, 3, v80 dst_sel:DWORD dst_unused:UNUSED_PAD src0_sel:DWORD src1_sel:WORD_0
    v_lshlrev_b32_sdwa v90, 3, v80 dst_sel:DWORD dst_unused:UNUSED_PAD src0_sel:DWORD src1_sel:WORD_1
    ds_read_b64 v[88:89], v88
    ds_read_b64 v[90:91], v90
    v_lshlrev_b32_sdwa v92, 3, v81 dst_sel:DWORD dst_unused:UNUSED_PAD src0_sel:DWORD src1_sel:WORD_0
    v_lshlrev_b32_sdwa v94, 3, v81 dst_sel:DWORD dst_unused:UNUSED_PAD src0_sel:DWORD src1_sel:WORD_1
    s_nop 0
    v_cvt_pk_bf16_f32 v50, v50, v51
    v_cvt_pk_bf16_f32 v51, v52, v53
    v_lshlrev_b32 v52, 16, v54
    v_and_b32 v53, s23, v54
    v_lshlrev_b32 v54, 16, v55
    v_and_b32 v55, s23, v55
    ds_read_b64 v[92:93], v92
    ds_read_b64 v[94:95], v94
    buffer_load_dwordx4 v[124:127], v71, s[12:15], s20 offen offset:1024 sc1
    buffer_store_dwordx4 v[40:43], v71, s[12:15], s16 offen offset:2048 sc1
    s_waitcnt lgkmcnt(8)
    v_smfmac_f32_16x16x64_bf16 v[52:55], v[66:69], v[96:103], v70
    v_lshlrev_b32_sdwa v96, 3, v82 dst_sel:DWORD dst_unused:UNUSED_PAD src0_sel:DWORD src1_sel:WORD_0
    v_lshlrev_b32_sdwa v98, 3, v82 dst_sel:DWORD dst_unused:UNUSED_PAD src0_sel:DWORD src1_sel:WORD_1
    ds_read_b64 v[96:97], v96
    ds_read_b64 v[98:99], v98
    v_lshlrev_b32_sdwa v100, 3, v83 dst_sel:DWORD dst_unused:UNUSED_PAD src0_sel:DWORD src1_sel:WORD_0
    v_lshlrev_b32_sdwa v102, 3, v83 dst_sel:DWORD dst_unused:UNUSED_PAD src0_sel:DWORD src1_sel:WORD_1
    ds_read_b64 v[100:101], v100
    ds_read_b64 v[102:103], v102
    s_waitcnt lgkmcnt(8)
    v_smfmac_f32_16x16x64_bf16 v[52:55], v[66:69], v[104:111], v70
    s_waitcnt vmcnt(8)
    v_lshlrev_b32_sdwa v104, 3, v84 dst_sel:DWORD dst_unused:UNUSED_PAD src0_sel:DWORD src1_sel:WORD_0
    v_lshlrev_b32_sdwa v106, 3, v84 dst_sel:DWORD dst_unused:UNUSED_PAD src0_sel:DWORD src1_sel:WORD_1
    ds_read_b64 v[104:105], v104
    ds_read_b64 v[106:107], v106
    v_lshlrev_b32_sdwa v108, 3, v85 dst_sel:DWORD dst_unused:UNUSED_PAD src0_sel:DWORD src1_sel:WORD_0
    v_lshlrev_b32_sdwa v110, 3, v85 dst_sel:DWORD dst_unused:UNUSED_PAD src0_sel:DWORD src1_sel:WORD_1
    s_nop 0
    v_cvt_pk_bf16_f32 v52, v52, v53
    v_cvt_pk_bf16_f32 v53, v54, v55
    v_lshlrev_b32 v54, 16, v56
    v_and_b32 v55, s23, v56
    v_lshlrev_b32 v56, 16, v57
    v_and_b32 v57, s23, v57
    ds_read_b64 v[108:109], v108
    ds_read_b64 v[110:111], v110
    buffer_load_dwordx4 v[80:83], v71, s[12:15], s19 offen offset:0
    buffer_load_dwordx4 v[40:43], v71, s[12:15], s20 offen offset:0 sc1
    s_waitcnt lgkmcnt(8)
    v_smfmac_f32_16x16x64_bf16 v[54:57], v[66:69], v[88:95], v70
    v_lshlrev_b32_sdwa v88, 3, v86 dst_sel:DWORD dst_unused:UNUSED_PAD src0_sel:DWORD src1_sel:WORD_0
    v_lshlrev_b32_sdwa v90, 3, v86 dst_sel:DWORD dst_unused:UNUSED_PAD src0_sel:DWORD src1_sel:WORD_1
    ds_read_b64 v[88:89], v88
    ds_read_b64 v[90:91], v90
    v_lshlrev_b32_sdwa v92, 3, v87 dst_sel:DWORD dst_unused:UNUSED_PAD src0_sel:DWORD src1_sel:WORD_0
    v_lshlrev_b32_sdwa v94, 3, v87 dst_sel:DWORD dst_unused:UNUSED_PAD src0_sel:DWORD src1_sel:WORD_1
    ds_read_b64 v[92:93], v92
    ds_read_b64 v[94:95], v94
    buffer_load_dwordx4 v[84:87], v71, s[12:15], s19 offen offset:1024
    s_waitcnt lgkmcnt(8)
    v_smfmac_f32_16x16x64_bf16 v[54:57], v[66:69], v[96:103], v70
    s_waitcnt vmcnt(10)
    v_lshlrev_b32_sdwa v96, 3, v116 dst_sel:DWORD dst_unused:UNUSED_PAD src0_sel:DWORD src1_sel:WORD_0
    v_lshlrev_b32_sdwa v98, 3, v116 dst_sel:DWORD dst_unused:UNUSED_PAD src0_sel:DWORD src1_sel:WORD_1
    ds_read_b64 v[96:97], v96
    ds_read_b64 v[98:99], v98
    v_lshlrev_b32_sdwa v100, 3, v117 dst_sel:DWORD dst_unused:UNUSED_PAD src0_sel:DWORD src1_sel:WORD_0
    v_lshlrev_b32_sdwa v102, 3, v117 dst_sel:DWORD dst_unused:UNUSED_PAD src0_sel:DWORD src1_sel:WORD_1
    s_nop 0
    v_cvt_pk_bf16_f32 v54, v54, v55
    v_cvt_pk_bf16_f32 v55, v56, v57
    v_lshlrev_b32 v56, 16, v58
    v_and_b32 v57, s23, v58
    v_lshlrev_b32 v58, 16, v59
    v_and_b32 v59, s23, v59
    ds_read_b64 v[100:101], v100
    ds_read_b64 v[102:103], v102
    s_waitcnt lgkmcnt(8)
    v_smfmac_f32_16x16x64_bf16 v[56:59], v[66:69], v[104:111], v70
    v_lshlrev_b32_sdwa v104, 3, v118 dst_sel:DWORD dst_unused:UNUSED_PAD src0_sel:DWORD src1_sel:WORD_0
    v_lshlrev_b32_sdwa v106, 3, v118 dst_sel:DWORD dst_unused:UNUSED_PAD src0_sel:DWORD src1_sel:WORD_1
    ds_read_b64 v[104:105], v104
    ds_read_b64 v[106:107], v106
    v_lshlrev_b32_sdwa v108, 3, v119 dst_sel:DWORD dst_unused:UNUSED_PAD src0_sel:DWORD src1_sel:WORD_0
    v_lshlrev_b32_sdwa v110, 3, v119 dst_sel:DWORD dst_unused:UNUSED_PAD src0_sel:DWORD src1_sel:WORD_1
    ds_read_b64 v[108:109], v108
    ds_read_b64 v[110:111], v110
    s_add_u32 s20, s20, 0xfffff000
    buffer_load_dwordx4 v[116:119], v71, s[12:15], s20 offen offset:3072 sc1
    s_waitcnt lgkmcnt(8)
    v_smfmac_f32_16x16x64_bf16 v[56:59], v[66:69], v[88:95], v70
    s_waitcnt vmcnt(9)
    v_lshlrev_b32_sdwa v88, 3, v36 dst_sel:DWORD dst_unused:UNUSED_PAD src0_sel:DWORD src1_sel:WORD_0
    v_lshlrev_b32_sdwa v90, 3, v36 dst_sel:DWORD dst_unused:UNUSED_PAD src0_sel:DWORD src1_sel:WORD_1
    ds_read_b64 v[88:89], v88
    ds_read_b64 v[90:91], v90
    v_lshlrev_b32_sdwa v92, 3, v37 dst_sel:DWORD dst_unused:UNUSED_PAD src0_sel:DWORD src1_sel:WORD_0
    v_lshlrev_b32_sdwa v94, 3, v37 dst_sel:DWORD dst_unused:UNUSED_PAD src0_sel:DWORD src1_sel:WORD_1
    s_nop 0
    v_cvt_pk_bf16_f32 v56, v56, v57
    v_cvt_pk_bf16_f32 v57, v58, v59
    v_lshlrev_b32 v58, 16, v60
    v_and_b32 v59, s23, v60
    v_lshlrev_b32 v60, 16, v61
    v_and_b32 v61, s23, v61
    ds_read_b64 v[92:93], v92
    ds_read_b64 v[94:95], v94
    s_waitcnt lgkmcnt(8)
    v_smfmac_f32_16x16x64_bf16 v[58:61], v[66:69], v[96:103], v70
    v_lshlrev_b32_sdwa v96, 3, v38 dst_sel:DWORD dst_unused:UNUSED_PAD src0_sel:DWORD src1_sel:WORD_0
    v_lshlrev_b32_sdwa v98, 3, v38 dst_sel:DWORD dst_unused:UNUSED_PAD src0_sel:DWORD src1_sel:WORD_1
    ds_read_b64 v[96:97], v96
    ds_read_b64 v[98:99], v98
    v_lshlrev_b32_sdwa v100, 3, v39 dst_sel:DWORD dst_unused:UNUSED_PAD src0_sel:DWORD src1_sel:WORD_0
    v_lshlrev_b32_sdwa v102, 3, v39 dst_sel:DWORD dst_unused:UNUSED_PAD src0_sel:DWORD src1_sel:WORD_1
    ds_read_b64 v[100:101], v100
    ds_read_b64 v[102:103], v102
    buffer_load_dwordx4 v[36:39], v71, s[12:15], s20 offen offset:2048 sc1
    s_waitcnt lgkmcnt(8)
    v_smfmac_f32_16x16x64_bf16 v[58:61], v[66:69], v[104:111], v70
    s_waitcnt vmcnt(9)
    v_lshlrev_b32_sdwa v104, 3, v120 dst_sel:DWORD dst_unused:UNUSED_PAD src0_sel:DWORD src1_sel:WORD_0
    v_lshlrev_b32_sdwa v106, 3, v120 dst_sel:DWORD dst_unused:UNUSED_PAD src0_sel:DWORD src1_sel:WORD_1
    ds_read_b64 v[104:105], v104
    ds_read_b64 v[106:107], v106
    v_lshlrev_b32_sdwa v108, 3, v121 dst_sel:DWORD dst_unused:UNUSED_PAD src0_sel:DWORD src1_sel:WORD_0
    v_lshlrev_b32_sdwa v110, 3, v121 dst_sel:DWORD dst_unused:UNUSED_PAD src0_sel:DWORD src1_sel:WORD_1
    s_nop 0
    v_cvt_pk_bf16_f32 v58, v58, v59
    v_cvt_pk_bf16_f32 v59, v60, v61
    v_lshlrev_b32 v60, 16, v62
    v_and_b32 v61, s23, v62
    v_lshlrev_b32 v62, 16, v63
    v_and_b32 v63, s23, v63
    ds_read_b64 v[108:109], v108
    ds_read_b64 v[110:111], v110
    buffer_store_dwordx4 v[44:47], v71, s[12:15], s16 offen offset:3072 sc1
    s_waitcnt lgkmcnt(8)
    v_smfmac_f32_16x16x64_bf16 v[60:63], v[66:69], v[88:95], v70
    v_lshlrev_b32_sdwa v88, 3, v122 dst_sel:DWORD dst_unused:UNUSED_PAD src0_sel:DWORD src1_sel:WORD_0
    v_lshlrev_b32_sdwa v90, 3, v122 dst_sel:DWORD dst_unused:UNUSED_PAD src0_sel:DWORD src1_sel:WORD_1
    ds_read_b64 v[88:89], v88
    ds_read_b64 v[90:91], v90
    v_lshlrev_b32_sdwa v92, 3, v123 dst_sel:DWORD dst_unused:UNUSED_PAD src0_sel:DWORD src1_sel:WORD_0
    v_lshlrev_b32_sdwa v94, 3, v123 dst_sel:DWORD dst_unused:UNUSED_PAD src0_sel:DWORD src1_sel:WORD_1
    ds_read_b64 v[92:93], v92
    ds_read_b64 v[94:95], v94
    buffer_load_dwordx4 v[44:47], v71, s[12:15], s20 offen offset:1024 sc1
    s_waitcnt lgkmcnt(8)
    v_smfmac_f32_16x16x64_bf16 v[60:63], v[66:69], v[96:103], v70
    s_waitcnt vmcnt(10)
    v_lshlrev_b32_sdwa v96, 3, v72 dst_sel:DWORD dst_unused:UNUSED_PAD src0_sel:DWORD src1_sel:WORD_0
    v_lshlrev_b32_sdwa v98, 3, v72 dst_sel:DWORD dst_unused:UNUSED_PAD src0_sel:DWORD src1_sel:WORD_1
    ds_read_b64 v[96:97], v96
    ds_read_b64 v[98:99], v98
    v_lshlrev_b32_sdwa v100, 3, v73 dst_sel:DWORD dst_unused:UNUSED_PAD src0_sel:DWORD src1_sel:WORD_0
    v_lshlrev_b32_sdwa v102, 3, v73 dst_sel:DWORD dst_unused:UNUSED_PAD src0_sel:DWORD src1_sel:WORD_1
    s_nop 0
    v_cvt_pk_bf16_f32 v60, v60, v61
    v_cvt_pk_bf16_f32 v61, v62, v63
    v_lshlrev_b32 v62, 16, v64
    v_and_b32 v63, s23, v64
    v_lshlrev_b32 v64, 16, v65
    v_and_b32 v65, s23, v65
    ds_read_b64 v[100:101], v100
    ds_read_b64 v[102:103], v102
    buffer_load_dwordx4 v[120:123], v71, s[12:15], s20 offen offset:0 sc1
    s_waitcnt lgkmcnt(8)
    v_smfmac_f32_16x16x64_bf16 v[62:65], v[66:69], v[104:111], v70
    v_lshlrev_b32_sdwa v104, 3, v74 dst_sel:DWORD dst_unused:UNUSED_PAD src0_sel:DWORD src1_sel:WORD_0
    v_lshlrev_b32_sdwa v106, 3, v74 dst_sel:DWORD dst_unused:UNUSED_PAD src0_sel:DWORD src1_sel:WORD_1
    ds_read_b64 v[104:105], v104
    ds_read_b64 v[106:107], v106
    v_lshlrev_b32_sdwa v108, 3, v75 dst_sel:DWORD dst_unused:UNUSED_PAD src0_sel:DWORD src1_sel:WORD_0
    v_lshlrev_b32_sdwa v110, 3, v75 dst_sel:DWORD dst_unused:UNUSED_PAD src0_sel:DWORD src1_sel:WORD_1
    ds_read_b64 v[108:109], v108
    ds_read_b64 v[110:111], v110
    buffer_load_dwordx4 v[72:75], v71, s[12:15], s21 offen offset:0
    s_waitcnt lgkmcnt(8)
    v_smfmac_f32_16x16x64_bf16 v[62:65], v[66:69], v[88:95], v70
    s_waitcnt vmcnt(11)
    v_lshlrev_b32_sdwa v88, 3, v76 dst_sel:DWORD dst_unused:UNUSED_PAD src0_sel:DWORD src1_sel:WORD_0
    v_lshlrev_b32_sdwa v90, 3, v76 dst_sel:DWORD dst_unused:UNUSED_PAD src0_sel:DWORD src1_sel:WORD_1
    ds_read_b64 v[88:89], v88
    ds_read_b64 v[90:91], v90
    v_lshlrev_b32_sdwa v92, 3, v77 dst_sel:DWORD dst_unused:UNUSED_PAD src0_sel:DWORD src1_sel:WORD_0
    v_lshlrev_b32_sdwa v94, 3, v77 dst_sel:DWORD dst_unused:UNUSED_PAD src0_sel:DWORD src1_sel:WORD_1
    s_nop 0
    v_cvt_pk_bf16_f32 v62, v62, v63
    v_cvt_pk_bf16_f32 v63, v64, v65
    v_and_b32 v33, s23, v31
    v_lshlrev_b32 v32, 16, v31
    v_and_b32 v31, s23, v30
    v_lshlrev_b32 v30, 16, v30
    ds_read_b64 v[92:93], v92
    ds_read_b64 v[94:95], v94
    s_waitcnt lgkmcnt(8)
    v_smfmac_f32_16x16x64_bf16 v[30:33], v[66:69], v[96:103], v70
    v_lshlrev_b32_sdwa v96, 3, v78 dst_sel:DWORD dst_unused:UNUSED_PAD src0_sel:DWORD src1_sel:WORD_0
    v_lshlrev_b32_sdwa v98, 3, v78 dst_sel:DWORD dst_unused:UNUSED_PAD src0_sel:DWORD src1_sel:WORD_1
    ds_read_b64 v[96:97], v96
    ds_read_b64 v[98:99], v98
    v_lshlrev_b32_sdwa v100, 3, v79 dst_sel:DWORD dst_unused:UNUSED_PAD src0_sel:DWORD src1_sel:WORD_0
    v_lshlrev_b32_sdwa v102, 3, v79 dst_sel:DWORD dst_unused:UNUSED_PAD src0_sel:DWORD src1_sel:WORD_1
    ds_read_b64 v[100:101], v100
    ds_read_b64 v[102:103], v102
    buffer_load_dwordx4 v[76:79], v71, s[12:15], s21 offen offset:1024
    s_waitcnt lgkmcnt(8)
    v_smfmac_f32_16x16x64_bf16 v[30:33], v[66:69], v[104:111], v70
    s_waitcnt vmcnt(11)
    v_lshlrev_b32_sdwa v104, 3, v124 dst_sel:DWORD dst_unused:UNUSED_PAD src0_sel:DWORD src1_sel:WORD_0
    v_lshlrev_b32_sdwa v106, 3, v124 dst_sel:DWORD dst_unused:UNUSED_PAD src0_sel:DWORD src1_sel:WORD_1
    ds_read_b64 v[104:105], v104
    ds_read_b64 v[106:107], v106
    v_lshlrev_b32_sdwa v108, 3, v125 dst_sel:DWORD dst_unused:UNUSED_PAD src0_sel:DWORD src1_sel:WORD_0
    v_lshlrev_b32_sdwa v110, 3, v125 dst_sel:DWORD dst_unused:UNUSED_PAD src0_sel:DWORD src1_sel:WORD_1
    s_nop 0
    v_cvt_pk_bf16_f32 v33, v32, v33
    v_cvt_pk_bf16_f32 v32, v30, v31
    v_and_b32 v31, s23, v29
    v_lshlrev_b32 v30, 16, v29
    v_and_b32 v29, s23, v28
    v_lshlrev_b32 v28, 16, v28
    ds_read_b64 v[108:109], v108
    ds_read_b64 v[110:111], v110
    s_waitcnt lgkmcnt(8)
    v_smfmac_f32_16x16x64_bf16 v[28:31], v[66:69], v[88:95], v70
    v_lshlrev_b32_sdwa v88, 3, v126 dst_sel:DWORD dst_unused:UNUSED_PAD src0_sel:DWORD src1_sel:WORD_0
    v_lshlrev_b32_sdwa v90, 3, v126 dst_sel:DWORD dst_unused:UNUSED_PAD src0_sel:DWORD src1_sel:WORD_1
    ds_read_b64 v[88:89], v88
    ds_read_b64 v[90:91], v90
    v_lshlrev_b32_sdwa v92, 3, v127 dst_sel:DWORD dst_unused:UNUSED_PAD src0_sel:DWORD src1_sel:WORD_0
    v_lshlrev_b32_sdwa v94, 3, v127 dst_sel:DWORD dst_unused:UNUSED_PAD src0_sel:DWORD src1_sel:WORD_1
    ds_read_b64 v[92:93], v92
    ds_read_b64 v[94:95], v94
    s_add_u32 s20, s20, 0xfffff000
    buffer_load_dwordx4 v[124:127], v71, s[12:15], s20 offen offset:3072 sc1
    s_waitcnt lgkmcnt(8)
    v_smfmac_f32_16x16x64_bf16 v[28:31], v[66:69], v[96:103], v70
    s_waitcnt vmcnt(9)
    v_lshlrev_b32_sdwa v96, 3, v40 dst_sel:DWORD dst_unused:UNUSED_PAD src0_sel:DWORD src1_sel:WORD_0
    v_lshlrev_b32_sdwa v98, 3, v40 dst_sel:DWORD dst_unused:UNUSED_PAD src0_sel:DWORD src1_sel:WORD_1
    ds_read_b64 v[96:97], v96
    ds_read_b64 v[98:99], v98
    v_lshlrev_b32_sdwa v100, 3, v41 dst_sel:DWORD dst_unused:UNUSED_PAD src0_sel:DWORD src1_sel:WORD_0
    v_lshlrev_b32_sdwa v102, 3, v41 dst_sel:DWORD dst_unused:UNUSED_PAD src0_sel:DWORD src1_sel:WORD_1
    s_nop 0
    v_cvt_pk_bf16_f32 v31, v30, v31
    v_cvt_pk_bf16_f32 v30, v28, v29
    v_and_b32 v29, s23, v27
    v_lshlrev_b32 v28, 16, v27
    v_and_b32 v27, s23, v26
    v_lshlrev_b32 v26, 16, v26
    ds_read_b64 v[100:101], v100
    ds_read_b64 v[102:103], v102
    buffer_store_dwordx4 v[48:51], v71, s[12:15], s17 offen offset:0 sc1
    s_waitcnt lgkmcnt(8)
    v_smfmac_f32_16x16x64_bf16 v[26:29], v[66:69], v[104:111], v70
    v_lshlrev_b32_sdwa v104, 3, v42 dst_sel:DWORD dst_unused:UNUSED_PAD src0_sel:DWORD src1_sel:WORD_0
    v_lshlrev_b32_sdwa v106, 3, v42 dst_sel:DWORD dst_unused:UNUSED_PAD src0_sel:DWORD src1_sel:WORD_1
    ds_read_b64 v[104:105], v104
    ds_read_b64 v[106:107], v106
    v_lshlrev_b32_sdwa v108, 3, v43 dst_sel:DWORD dst_unused:UNUSED_PAD src0_sel:DWORD src1_sel:WORD_0
    v_lshlrev_b32_sdwa v110, 3, v43 dst_sel:DWORD dst_unused:UNUSED_PAD src0_sel:DWORD src1_sel:WORD_1
    ds_read_b64 v[108:109], v108
    ds_read_b64 v[110:111], v110
    buffer_load_dwordx4 v[48:51], v71, s[12:15], s20 offen offset:2048 sc1
    s_waitcnt lgkmcnt(8)
    v_smfmac_f32_16x16x64_bf16 v[26:29], v[66:69], v[88:95], v70
    s_waitcnt vmcnt(9)
    v_lshlrev_b32_sdwa v88, 3, v116 dst_sel:DWORD dst_unused:UNUSED_PAD src0_sel:DWORD src1_sel:WORD_0
    v_lshlrev_b32_sdwa v90, 3, v116 dst_sel:DWORD dst_unused:UNUSED_PAD src0_sel:DWORD src1_sel:WORD_1
    ds_read_b64 v[88:89], v88
    ds_read_b64 v[90:91], v90
    v_lshlrev_b32_sdwa v92, 3, v117 dst_sel:DWORD dst_unused:UNUSED_PAD src0_sel:DWORD src1_sel:WORD_0
    v_lshlrev_b32_sdwa v94, 3, v117 dst_sel:DWORD dst_unused:UNUSED_PAD src0_sel:DWORD src1_sel:WORD_1
    s_nop 0
    v_cvt_pk_bf16_f32 v29, v28, v29
    v_cvt_pk_bf16_f32 v28, v26, v27
    v_and_b32 v27, s23, v25
    v_lshlrev_b32 v26, 16, v25
    v_and_b32 v25, s23, v24
    v_lshlrev_b32 v24, 16, v24
    ds_read_b64 v[92:93], v92
    ds_read_b64 v[94:95], v94
    buffer_load_dwordx4 v[40:43], v71, s[12:15], s20 offen offset:1024 sc1
    s_waitcnt lgkmcnt(8)
    v_smfmac_f32_16x16x64_bf16 v[24:27], v[66:69], v[96:103], v70
    v_lshlrev_b32_sdwa v96, 3, v118 dst_sel:DWORD dst_unused:UNUSED_PAD src0_sel:DWORD src1_sel:WORD_0
    v_lshlrev_b32_sdwa v98, 3, v118 dst_sel:DWORD dst_unused:UNUSED_PAD src0_sel:DWORD src1_sel:WORD_1
    ds_read_b64 v[96:97], v96
    ds_read_b64 v[98:99], v98
    v_lshlrev_b32_sdwa v100, 3, v119 dst_sel:DWORD dst_unused:UNUSED_PAD src0_sel:DWORD src1_sel:WORD_0
    v_lshlrev_b32_sdwa v102, 3, v119 dst_sel:DWORD dst_unused:UNUSED_PAD src0_sel:DWORD src1_sel:WORD_1
    ds_read_b64 v[100:101], v100
    ds_read_b64 v[102:103], v102
    buffer_load_dwordx4 v[116:119], v71, s[12:15], s20 offen offset:0 sc1
    s_waitcnt lgkmcnt(8)
    v_smfmac_f32_16x16x64_bf16 v[24:27], v[66:69], v[104:111], v70
    s_waitcnt vmcnt(10)
    v_lshlrev_b32_sdwa v104, 3, v36 dst_sel:DWORD dst_unused:UNUSED_PAD src0_sel:DWORD src1_sel:WORD_0
    v_lshlrev_b32_sdwa v106, 3, v36 dst_sel:DWORD dst_unused:UNUSED_PAD src0_sel:DWORD src1_sel:WORD_1
    ds_read_b64 v[104:105], v104
    ds_read_b64 v[106:107], v106
    v_lshlrev_b32_sdwa v108, 3, v37 dst_sel:DWORD dst_unused:UNUSED_PAD src0_sel:DWORD src1_sel:WORD_0
    v_lshlrev_b32_sdwa v110, 3, v37 dst_sel:DWORD dst_unused:UNUSED_PAD src0_sel:DWORD src1_sel:WORD_1
    s_nop 0
    v_cvt_pk_bf16_f32 v27, v26, v27
    v_cvt_pk_bf16_f32 v26, v24, v25
    v_and_b32 v25, s23, v23
    v_lshlrev_b32 v24, 16, v23
    v_and_b32 v23, s23, v22
    v_lshlrev_b32 v22, 16, v22
    ds_read_b64 v[108:109], v108
    ds_read_b64 v[110:111], v110
    s_waitcnt lgkmcnt(8)
    v_smfmac_f32_16x16x64_bf16 v[22:25], v[66:69], v[88:95], v70
    v_lshlrev_b32_sdwa v88, 3, v38 dst_sel:DWORD dst_unused:UNUSED_PAD src0_sel:DWORD src1_sel:WORD_0
    v_lshlrev_b32_sdwa v90, 3, v38 dst_sel:DWORD dst_unused:UNUSED_PAD src0_sel:DWORD src1_sel:WORD_1
    ds_read_b64 v[88:89], v88
    ds_read_b64 v[90:91], v90
    v_lshlrev_b32_sdwa v92, 3, v39 dst_sel:DWORD dst_unused:UNUSED_PAD src0_sel:DWORD src1_sel:WORD_0
    v_lshlrev_b32_sdwa v94, 3, v39 dst_sel:DWORD dst_unused:UNUSED_PAD src0_sel:DWORD src1_sel:WORD_1
    ds_read_b64 v[92:93], v92
    ds_read_b64 v[94:95], v94
    s_add_u32 s20, s20, 0xfffffc00
    buffer_load_dwordx4 v[36:39], v71, s[12:15], s20 offen offset:0 sc1
    s_waitcnt lgkmcnt(8)
    v_smfmac_f32_16x16x64_bf16 v[22:25], v[66:69], v[96:103], v70
    s_waitcnt vmcnt(9)
    v_lshlrev_b32_sdwa v96, 3, v44 dst_sel:DWORD dst_unused:UNUSED_PAD src0_sel:DWORD src1_sel:WORD_0
    v_lshlrev_b32_sdwa v98, 3, v44 dst_sel:DWORD dst_unused:UNUSED_PAD src0_sel:DWORD src1_sel:WORD_1
    ds_read_b64 v[96:97], v96
    ds_read_b64 v[98:99], v98
    v_lshlrev_b32_sdwa v100, 3, v45 dst_sel:DWORD dst_unused:UNUSED_PAD src0_sel:DWORD src1_sel:WORD_0
    v_lshlrev_b32_sdwa v102, 3, v45 dst_sel:DWORD dst_unused:UNUSED_PAD src0_sel:DWORD src1_sel:WORD_1
    s_nop 0
    v_cvt_pk_bf16_f32 v25, v24, v25
    v_cvt_pk_bf16_f32 v24, v22, v23
    v_and_b32 v23, s23, v21
    v_lshlrev_b32 v22, 16, v21
    v_and_b32 v21, s23, v20
    v_lshlrev_b32 v20, 16, v20
    ds_read_b64 v[100:101], v100
    ds_read_b64 v[102:103], v102
    v_mov_b32 v34, 1
    s_mov_b64 exec, 1
    buffer_store_dword v34, off, s[12:15], s46 sc1
    s_mov_b64 exec, -1
    s_waitcnt lgkmcnt(8)
    v_smfmac_f32_16x16x64_bf16 v[20:23], v[66:69], v[104:111], v70
    v_lshlrev_b32_sdwa v104, 3, v46 dst_sel:DWORD dst_unused:UNUSED_PAD src0_sel:DWORD src1_sel:WORD_0
    v_lshlrev_b32_sdwa v106, 3, v46 dst_sel:DWORD dst_unused:UNUSED_PAD src0_sel:DWORD src1_sel:WORD_1
    ds_read_b64 v[104:105], v104
    ds_read_b64 v[106:107], v106
    v_lshlrev_b32_sdwa v108, 3, v47 dst_sel:DWORD dst_unused:UNUSED_PAD src0_sel:DWORD src1_sel:WORD_0
    v_lshlrev_b32_sdwa v110, 3, v47 dst_sel:DWORD dst_unused:UNUSED_PAD src0_sel:DWORD src1_sel:WORD_1
    ds_read_b64 v[108:109], v108
    ds_read_b64 v[110:111], v110
    s_add_u32 s20, s20, 0x3000
    buffer_load_dwordx4 v[44:47], v71, s[12:15], s20 offen offset:3072 sc1
    s_waitcnt lgkmcnt(8)
    v_smfmac_f32_16x16x64_bf16 v[20:23], v[66:69], v[88:95], v70
    s_waitcnt vmcnt(10)
    v_lshlrev_b32_sdwa v88, 3, v120 dst_sel:DWORD dst_unused:UNUSED_PAD src0_sel:DWORD src1_sel:WORD_0
    v_lshlrev_b32_sdwa v90, 3, v120 dst_sel:DWORD dst_unused:UNUSED_PAD src0_sel:DWORD src1_sel:WORD_1
    ds_read_b64 v[88:89], v88
    ds_read_b64 v[90:91], v90
    v_lshlrev_b32_sdwa v92, 3, v121 dst_sel:DWORD dst_unused:UNUSED_PAD src0_sel:DWORD src1_sel:WORD_0
    v_lshlrev_b32_sdwa v94, 3, v121 dst_sel:DWORD dst_unused:UNUSED_PAD src0_sel:DWORD src1_sel:WORD_1
    s_nop 0
    v_cvt_pk_bf16_f32 v23, v22, v23
    v_cvt_pk_bf16_f32 v22, v20, v21
    v_and_b32 v21, s23, v19
    v_lshlrev_b32 v20, 16, v19
    v_and_b32 v19, s23, v18
    v_lshlrev_b32 v18, 16, v18
    ds_read_b64 v[92:93], v92
    ds_read_b64 v[94:95], v94
    buffer_store_dwordx4 v[52:55], v71, s[12:15], s17 offen offset:1024 sc1
    s_waitcnt lgkmcnt(8)
    v_smfmac_f32_16x16x64_bf16 v[18:21], v[66:69], v[96:103], v70
    v_lshlrev_b32_sdwa v96, 3, v122 dst_sel:DWORD dst_unused:UNUSED_PAD src0_sel:DWORD src1_sel:WORD_0
    v_lshlrev_b32_sdwa v98, 3, v122 dst_sel:DWORD dst_unused:UNUSED_PAD src0_sel:DWORD src1_sel:WORD_1
    ds_read_b64 v[96:97], v96
    ds_read_b64 v[98:99], v98
    v_lshlrev_b32_sdwa v100, 3, v123 dst_sel:DWORD dst_unused:UNUSED_PAD src0_sel:DWORD src1_sel:WORD_0
    v_lshlrev_b32_sdwa v102, 3, v123 dst_sel:DWORD dst_unused:UNUSED_PAD src0_sel:DWORD src1_sel:WORD_1
    ds_read_b64 v[100:101], v100
    ds_read_b64 v[102:103], v102
    buffer_load_dwordx4 v[120:123], v71, s[12:15], s20 offen offset:2048 sc1
    s_waitcnt lgkmcnt(8)
    v_smfmac_f32_16x16x64_bf16 v[18:21], v[66:69], v[104:111], v70
    s_waitcnt vmcnt(9)
    v_lshlrev_b32_sdwa v104, 3, v124 dst_sel:DWORD dst_unused:UNUSED_PAD src0_sel:DWORD src1_sel:WORD_0
    v_lshlrev_b32_sdwa v106, 3, v124 dst_sel:DWORD dst_unused:UNUSED_PAD src0_sel:DWORD src1_sel:WORD_1
    ds_read_b64 v[104:105], v104
    ds_read_b64 v[106:107], v106
    v_lshlrev_b32_sdwa v108, 3, v125 dst_sel:DWORD dst_unused:UNUSED_PAD src0_sel:DWORD src1_sel:WORD_0
    v_lshlrev_b32_sdwa v110, 3, v125 dst_sel:DWORD dst_unused:UNUSED_PAD src0_sel:DWORD src1_sel:WORD_1
    s_nop 0
    v_cvt_pk_bf16_f32 v21, v20, v21
    v_cvt_pk_bf16_f32 v20, v18, v19
    v_and_b32 v19, s23, v17
    v_lshlrev_b32 v18, 16, v17
    v_and_b32 v17, s23, v16
    v_lshlrev_b32 v16, 16, v16
    ds_read_b64 v[108:109], v108
    ds_read_b64 v[110:111], v110
    s_waitcnt lgkmcnt(8)
    v_smfmac_f32_16x16x64_bf16 v[16:19], v[66:69], v[88:95], v70
    s_setprio 2
    v_lshlrev_b32_sdwa v88, 3, v126 dst_sel:DWORD dst_unused:UNUSED_PAD src0_sel:DWORD src1_sel:WORD_0
    v_lshlrev_b32_sdwa v90, 3, v126 dst_sel:DWORD dst_unused:UNUSED_PAD src0_sel:DWORD src1_sel:WORD_1
    ds_read_b64 v[88:89], v88
    ds_read_b64 v[90:91], v90
    v_lshlrev_b32_sdwa v92, 3, v127 dst_sel:DWORD dst_unused:UNUSED_PAD src0_sel:DWORD src1_sel:WORD_0
    v_lshlrev_b32_sdwa v94, 3, v127 dst_sel:DWORD dst_unused:UNUSED_PAD src0_sel:DWORD src1_sel:WORD_1
    ds_read_b64 v[92:93], v92
    ds_read_b64 v[94:95], v94
    buffer_load_dwordx4 v[124:127], v71, s[12:15], s20 offen offset:1024 sc1
    s_waitcnt lgkmcnt(8)
    v_smfmac_f32_16x16x64_bf16 v[16:19], v[66:69], v[96:103], v70
    s_waitcnt vmcnt(8)
    v_lshlrev_b32_sdwa v96, 3, v48 dst_sel:DWORD dst_unused:UNUSED_PAD src0_sel:DWORD src1_sel:WORD_0
    v_lshlrev_b32_sdwa v98, 3, v48 dst_sel:DWORD dst_unused:UNUSED_PAD src0_sel:DWORD src1_sel:WORD_1
    ds_read_b64 v[96:97], v96
    ds_read_b64 v[98:99], v98
    v_lshlrev_b32_sdwa v100, 3, v49 dst_sel:DWORD dst_unused:UNUSED_PAD src0_sel:DWORD src1_sel:WORD_0
    v_lshlrev_b32_sdwa v102, 3, v49 dst_sel:DWORD dst_unused:UNUSED_PAD src0_sel:DWORD src1_sel:WORD_1
    s_nop 0
    v_cvt_pk_bf16_f32 v19, v18, v19
    v_cvt_pk_bf16_f32 v18, v16, v17
    v_and_b32 v17, s23, v15
    v_lshlrev_b32 v16, 16, v15
    v_and_b32 v15, s23, v14
    v_lshlrev_b32 v14, 16, v14
    ds_read_b64 v[100:101], v100
    ds_read_b64 v[102:103], v102
    s_waitcnt lgkmcnt(8)
    v_smfmac_f32_16x16x64_bf16 v[14:17], v[66:69], v[104:111], v70
    v_lshlrev_b32_sdwa v104, 3, v50 dst_sel:DWORD dst_unused:UNUSED_PAD src0_sel:DWORD src1_sel:WORD_0
    v_lshlrev_b32_sdwa v106, 3, v50 dst_sel:DWORD dst_unused:UNUSED_PAD src0_sel:DWORD src1_sel:WORD_1
    ds_read_b64 v[104:105], v104
    ds_read_b64 v[106:107], v106
    v_lshlrev_b32_sdwa v108, 3, v51 dst_sel:DWORD dst_unused:UNUSED_PAD src0_sel:DWORD src1_sel:WORD_0
    v_lshlrev_b32_sdwa v110, 3, v51 dst_sel:DWORD dst_unused:UNUSED_PAD src0_sel:DWORD src1_sel:WORD_1
    ds_read_b64 v[108:109], v108
    ds_read_b64 v[110:111], v110
    s_add_u32 s20, s20, 0x3f800
    buffer_load_dwordx4 v[48:51], v71, s[12:15], s20 offen offset:3072 sc1
    s_waitcnt lgkmcnt(8)
    v_smfmac_f32_16x16x64_bf16 v[14:17], v[66:69], v[88:95], v70
    s_waitcnt vmcnt(8)
    v_lshlrev_b32_sdwa v88, 3, v40 dst_sel:DWORD dst_unused:UNUSED_PAD src0_sel:DWORD src1_sel:WORD_0
    v_lshlrev_b32_sdwa v90, 3, v40 dst_sel:DWORD dst_unused:UNUSED_PAD src0_sel:DWORD src1_sel:WORD_1
    ds_read_b64 v[88:89], v88
    ds_read_b64 v[90:91], v90
    v_lshlrev_b32_sdwa v92, 3, v41 dst_sel:DWORD dst_unused:UNUSED_PAD src0_sel:DWORD src1_sel:WORD_0
    v_lshlrev_b32_sdwa v94, 3, v41 dst_sel:DWORD dst_unused:UNUSED_PAD src0_sel:DWORD src1_sel:WORD_1
    s_nop 0
    v_cvt_pk_bf16_f32 v17, v16, v17
    v_cvt_pk_bf16_f32 v16, v14, v15
    v_and_b32 v15, s23, v13
    v_lshlrev_b32 v14, 16, v13
    v_and_b32 v13, s23, v12
    v_lshlrev_b32 v12, 16, v12
    ds_read_b64 v[92:93], v92
    ds_read_b64 v[94:95], v94
    s_waitcnt lgkmcnt(8)
    v_smfmac_f32_16x16x64_bf16 v[12:15], v[66:69], v[96:103], v70
    v_lshlrev_b32_sdwa v96, 3, v42 dst_sel:DWORD dst_unused:UNUSED_PAD src0_sel:DWORD src1_sel:WORD_0
    v_lshlrev_b32_sdwa v98, 3, v42 dst_sel:DWORD dst_unused:UNUSED_PAD src0_sel:DWORD src1_sel:WORD_1
    ds_read_b64 v[96:97], v96
    ds_read_b64 v[98:99], v98
    v_lshlrev_b32_sdwa v100, 3, v43 dst_sel:DWORD dst_unused:UNUSED_PAD src0_sel:DWORD src1_sel:WORD_0
    v_lshlrev_b32_sdwa v102, 3, v43 dst_sel:DWORD dst_unused:UNUSED_PAD src0_sel:DWORD src1_sel:WORD_1
    ds_read_b64 v[100:101], v100
    ds_read_b64 v[102:103], v102
    buffer_load_dwordx4 v[40:43], v71, s[12:15], s20 offen offset:1024 sc1
    s_waitcnt lgkmcnt(8)
    v_smfmac_f32_16x16x64_bf16 v[12:15], v[66:69], v[104:111], v70
    s_waitcnt vmcnt(8)
    v_lshlrev_b32_sdwa v104, 3, v116 dst_sel:DWORD dst_unused:UNUSED_PAD src0_sel:DWORD src1_sel:WORD_0
    v_lshlrev_b32_sdwa v106, 3, v116 dst_sel:DWORD dst_unused:UNUSED_PAD src0_sel:DWORD src1_sel:WORD_1
    ds_read_b64 v[104:105], v104
    ds_read_b64 v[106:107], v106
    v_lshlrev_b32_sdwa v108, 3, v117 dst_sel:DWORD dst_unused:UNUSED_PAD src0_sel:DWORD src1_sel:WORD_0
    v_lshlrev_b32_sdwa v110, 3, v117 dst_sel:DWORD dst_unused:UNUSED_PAD src0_sel:DWORD src1_sel:WORD_1
    s_nop 0
    v_cvt_pk_bf16_f32 v15, v14, v15
    v_cvt_pk_bf16_f32 v14, v12, v13
    v_and_b32 v13, s23, v11
    v_lshlrev_b32 v12, 16, v11
    v_and_b32 v11, s23, v10
    v_lshlrev_b32 v10, 16, v10
    ds_read_b64 v[108:109], v108
    ds_read_b64 v[110:111], v110
    buffer_store_dwordx4 v[56:59], v71, s[12:15], s17 offen offset:2048 sc1
    s_waitcnt lgkmcnt(8)
    v_smfmac_f32_16x16x64_bf16 v[10:13], v[66:69], v[88:95], v70
    v_lshlrev_b32_sdwa v88, 3, v118 dst_sel:DWORD dst_unused:UNUSED_PAD src0_sel:DWORD src1_sel:WORD_0
    v_lshlrev_b32_sdwa v90, 3, v118 dst_sel:DWORD dst_unused:UNUSED_PAD src0_sel:DWORD src1_sel:WORD_1
    ds_read_b64 v[88:89], v88
    ds_read_b64 v[90:91], v90
    v_lshlrev_b32_sdwa v92, 3, v119 dst_sel:DWORD dst_unused:UNUSED_PAD src0_sel:DWORD src1_sel:WORD_0
    v_lshlrev_b32_sdwa v94, 3, v119 dst_sel:DWORD dst_unused:UNUSED_PAD src0_sel:DWORD src1_sel:WORD_1
    ds_read_b64 v[92:93], v92
    ds_read_b64 v[94:95], v94
    s_add_u32 s20, s20, 0xfffff000
    buffer_load_dwordx4 v[116:119], v71, s[12:15], s20 offen offset:3072 sc1
    s_waitcnt lgkmcnt(8)
    v_smfmac_f32_16x16x64_bf16 v[10:13], v[66:69], v[96:103], v70
    s_waitcnt vmcnt(9)
    v_lshlrev_b32_sdwa v96, 3, v36 dst_sel:DWORD dst_unused:UNUSED_PAD src0_sel:DWORD src1_sel:WORD_0
    v_lshlrev_b32_sdwa v98, 3, v36 dst_sel:DWORD dst_unused:UNUSED_PAD src0_sel:DWORD src1_sel:WORD_1
    ds_read_b64 v[96:97], v96
    ds_read_b64 v[98:99], v98
    v_lshlrev_b32_sdwa v100, 3, v37 dst_sel:DWORD dst_unused:UNUSED_PAD src0_sel:DWORD src1_sel:WORD_0
    v_lshlrev_b32_sdwa v102, 3, v37 dst_sel:DWORD dst_unused:UNUSED_PAD src0_sel:DWORD src1_sel:WORD_1
    s_nop 0
    v_cvt_pk_bf16_f32 v13, v12, v13
    v_cvt_pk_bf16_f32 v12, v10, v11
    v_and_b32 v11, s23, v9
    v_lshlrev_b32 v10, 16, v9
    v_and_b32 v9, s23, v8
    v_lshlrev_b32 v8, 16, v8
    ds_read_b64 v[100:101], v100
    ds_read_b64 v[102:103], v102
    s_waitcnt lgkmcnt(8)
    v_smfmac_f32_16x16x64_bf16 v[8:11], v[66:69], v[104:111], v70
    s_setprio 1
    v_lshlrev_b32_sdwa v104, 3, v38 dst_sel:DWORD dst_unused:UNUSED_PAD src0_sel:DWORD src1_sel:WORD_0
    v_lshlrev_b32_sdwa v106, 3, v38 dst_sel:DWORD dst_unused:UNUSED_PAD src0_sel:DWORD src1_sel:WORD_1
    ds_read_b64 v[104:105], v104
    ds_read_b64 v[106:107], v106
    v_lshlrev_b32_sdwa v108, 3, v39 dst_sel:DWORD dst_unused:UNUSED_PAD src0_sel:DWORD src1_sel:WORD_0
    v_lshlrev_b32_sdwa v110, 3, v39 dst_sel:DWORD dst_unused:UNUSED_PAD src0_sel:DWORD src1_sel:WORD_1
    ds_read_b64 v[108:109], v108
    ds_read_b64 v[110:111], v110
    buffer_load_dwordx4 v[36:39], v71, s[12:15], s20 offen offset:1024 sc1
    s_waitcnt lgkmcnt(8)
    v_smfmac_f32_16x16x64_bf16 v[8:11], v[66:69], v[88:95], v70
    s_waitcnt vmcnt(8)
    v_lshlrev_b32_sdwa v88, 3, v44 dst_sel:DWORD dst_unused:UNUSED_PAD src0_sel:DWORD src1_sel:WORD_0
    v_lshlrev_b32_sdwa v90, 3, v44 dst_sel:DWORD dst_unused:UNUSED_PAD src0_sel:DWORD src1_sel:WORD_1
    ds_read_b64 v[88:89], v88
    ds_read_b64 v[90:91], v90
    v_lshlrev_b32_sdwa v92, 3, v45 dst_sel:DWORD dst_unused:UNUSED_PAD src0_sel:DWORD src1_sel:WORD_0
    v_lshlrev_b32_sdwa v94, 3, v45 dst_sel:DWORD dst_unused:UNUSED_PAD src0_sel:DWORD src1_sel:WORD_1
    s_nop 0
    v_cvt_pk_bf16_f32 v11, v10, v11
    v_cvt_pk_bf16_f32 v10, v8, v9
    v_and_b32 v9, s23, v7
    v_lshlrev_b32 v8, 16, v7
    v_and_b32 v7, s23, v6
    v_lshlrev_b32 v6, 16, v6
    ds_read_b64 v[92:93], v92
    ds_read_b64 v[94:95], v94
    s_waitcnt lgkmcnt(8)
    v_smfmac_f32_16x16x64_bf16 v[6:9], v[66:69], v[96:103], v70
    v_lshlrev_b32_sdwa v96, 3, v46 dst_sel:DWORD dst_unused:UNUSED_PAD src0_sel:DWORD src1_sel:WORD_0
    v_lshlrev_b32_sdwa v98, 3, v46 dst_sel:DWORD dst_unused:UNUSED_PAD src0_sel:DWORD src1_sel:WORD_1
    ds_read_b64 v[96:97], v96
    ds_read_b64 v[98:99], v98
    v_lshlrev_b32_sdwa v100, 3, v47 dst_sel:DWORD dst_unused:UNUSED_PAD src0_sel:DWORD src1_sel:WORD_0
    v_lshlrev_b32_sdwa v102, 3, v47 dst_sel:DWORD dst_unused:UNUSED_PAD src0_sel:DWORD src1_sel:WORD_1
    ds_read_b64 v[100:101], v100
    ds_read_b64 v[102:103], v102
    s_add_u32 s20, s20, 0xfffff000
    buffer_load_dwordx4 v[44:47], v71, s[12:15], s20 offen offset:3072 sc1
    s_waitcnt lgkmcnt(8)
    v_smfmac_f32_16x16x64_bf16 v[6:9], v[66:69], v[104:111], v70
    s_waitcnt vmcnt(7)
    v_lshlrev_b32_sdwa v104, 3, v120 dst_sel:DWORD dst_unused:UNUSED_PAD src0_sel:DWORD src1_sel:WORD_0
    v_lshlrev_b32_sdwa v106, 3, v120 dst_sel:DWORD dst_unused:UNUSED_PAD src0_sel:DWORD src1_sel:WORD_1
    ds_read_b64 v[104:105], v104
    ds_read_b64 v[106:107], v106
    v_lshlrev_b32_sdwa v108, 3, v121 dst_sel:DWORD dst_unused:UNUSED_PAD src0_sel:DWORD src1_sel:WORD_0
    v_lshlrev_b32_sdwa v110, 3, v121 dst_sel:DWORD dst_unused:UNUSED_PAD src0_sel:DWORD src1_sel:WORD_1
    s_nop 0
    v_cvt_pk_bf16_f32 v9, v8, v9
    v_cvt_pk_bf16_f32 v8, v6, v7
    v_and_b32 v7, s23, v5
    v_lshlrev_b32 v6, 16, v5
    v_and_b32 v5, s23, v4
    v_lshlrev_b32 v4, 16, v4
    ds_read_b64 v[108:109], v108
    ds_read_b64 v[110:111], v110
    s_mov_b64 exec, 1
    buffer_load_dword v35, off, s[12:15], s47 sc1
    s_mov_b64 exec, -1
    s_waitcnt lgkmcnt(8)
    v_smfmac_f32_16x16x64_bf16 v[4:7], v[66:69], v[88:95], v70
    v_lshlrev_b32_sdwa v88, 3, v122 dst_sel:DWORD dst_unused:UNUSED_PAD src0_sel:DWORD src1_sel:WORD_0
    v_lshlrev_b32_sdwa v90, 3, v122 dst_sel:DWORD dst_unused:UNUSED_PAD src0_sel:DWORD src1_sel:WORD_1
    ds_read_b64 v[88:89], v88
    ds_read_b64 v[90:91], v90
    v_lshlrev_b32_sdwa v92, 3, v123 dst_sel:DWORD dst_unused:UNUSED_PAD src0_sel:DWORD src1_sel:WORD_0
    v_lshlrev_b32_sdwa v94, 3, v123 dst_sel:DWORD dst_unused:UNUSED_PAD src0_sel:DWORD src1_sel:WORD_1
    ds_read_b64 v[92:93], v92
    ds_read_b64 v[94:95], v94
    buffer_load_dwordx4 v[120:123], v71, s[12:15], s20 offen offset:1024 sc1
    s_waitcnt lgkmcnt(8)
    v_smfmac_f32_16x16x64_bf16 v[4:7], v[66:69], v[96:103], v70
    s_waitcnt vmcnt(8)
    v_lshlrev_b32_sdwa v96, 3, v124 dst_sel:DWORD dst_unused:UNUSED_PAD src0_sel:DWORD src1_sel:WORD_0
    v_lshlrev_b32_sdwa v98, 3, v124 dst_sel:DWORD dst_unused:UNUSED_PAD src0_sel:DWORD src1_sel:WORD_1
    ds_read_b64 v[96:97], v96
    ds_read_b64 v[98:99], v98
    v_lshlrev_b32_sdwa v100, 3, v125 dst_sel:DWORD dst_unused:UNUSED_PAD src0_sel:DWORD src1_sel:WORD_0
    v_lshlrev_b32_sdwa v102, 3, v125 dst_sel:DWORD dst_unused:UNUSED_PAD src0_sel:DWORD src1_sel:WORD_1
    s_nop 0
    v_cvt_pk_bf16_f32 v7, v6, v7
    v_cvt_pk_bf16_f32 v6, v4, v5
    v_and_b32 v5, s23, v3
    v_lshlrev_b32 v4, 16, v3
    v_and_b32 v3, s23, v2
    v_lshlrev_b32 v2, 16, v2
    ds_read_b64 v[100:101], v100
    ds_read_b64 v[102:103], v102
    buffer_store_dwordx4 v[60:63], v71, s[12:15], s17 offen offset:3072 sc1
    s_cmp_eq_u32 s48, 1
    s_cbranch_scc1 k1_kernel_solo2
    s_waitcnt lgkmcnt(8)
    v_smfmac_f32_16x16x64_bf16 v[2:5], v[66:69], v[104:111], v70
    s_setprio 0
    v_lshlrev_b32_sdwa v104, 3, v126 dst_sel:DWORD dst_unused:UNUSED_PAD src0_sel:DWORD src1_sel:WORD_0
    v_lshlrev_b32_sdwa v106, 3, v126 dst_sel:DWORD dst_unused:UNUSED_PAD src0_sel:DWORD src1_sel:WORD_1
    ds_read_b64 v[104:105], v104
    ds_read_b64 v[106:107], v106
    v_lshlrev_b32_sdwa v108, 3, v127 dst_sel:DWORD dst_unused:UNUSED_PAD src0_sel:DWORD src1_sel:WORD_0
    v_lshlrev_b32_sdwa v110, 3, v127 dst_sel:DWORD dst_unused:UNUSED_PAD src0_sel:DWORD src1_sel:WORD_1
    ds_read_b64 v[108:109], v108
    ds_read_b64 v[110:111], v110
    s_add_u32 s20, s20, 0xfffffc00
    buffer_load_dwordx4 v[124:127], v71, s[12:15], s20 offen offset:0 sc1
    s_waitcnt lgkmcnt(8)
    v_smfmac_f32_16x16x64_bf16 v[2:5], v[66:69], v[88:95], v70
    v_mfma_f32_16x16x32_bf16 v[112:115], v[72:75], v[128:131], 0
    s_waitcnt vmcnt(9)
    v_lshlrev_b32_sdwa v88, 3, v48 dst_sel:DWORD dst_unused:UNUSED_PAD src0_sel:DWORD src1_sel:WORD_0
    v_lshlrev_b32_sdwa v90, 3, v48 dst_sel:DWORD dst_unused:UNUSED_PAD src0_sel:DWORD src1_sel:WORD_1
    ds_read_b64 v[88:89], v88
    ds_read_b64 v[90:91], v90
    v_mfma_f32_16x16x32_bf16 v[112:115], v[76:79], v[132:135], v[112:115]
    v_add_u32 v70, 0x20000000, v70
    v_lshlrev_b32_sdwa v92, 3, v49 dst_sel:DWORD dst_unused:UNUSED_PAD src0_sel:DWORD src1_sel:WORD_0
    v_lshlrev_b32_sdwa v94, 3, v49 dst_sel:DWORD dst_unused:UNUSED_PAD src0_sel:DWORD src1_sel:WORD_1
    v_cvt_pk_bf16_f32 v5, v4, v5
    v_cvt_pk_bf16_f32 v4, v2, v3
    v_and_b32 v3, s23, v1
    v_lshlrev_b32 v2, 16, v1
    v_and_b32 v1, s23, v0
    v_lshlrev_b32 v0, 16, v0
    ds_read_b64 v[92:93], v92
    ds_read_b64 v[94:95], v94
    s_waitcnt lgkmcnt(8)
    v_smfmac_f32_16x16x64_bf16 v[0:3], v[66:69], v[96:103], v70
    s_waitcnt lgkmcnt(4)
    s_barrier
    s_setprio 3
    v_mfma_f32_16x16x32_bf16 v[112:115], v[80:83], v[136:139], v[112:115]
    v_lshlrev_b32_sdwa v96, 3, v50 dst_sel:DWORD dst_unused:UNUSED_PAD src0_sel:DWORD src1_sel:WORD_0
    v_lshlrev_b32_sdwa v98, 3, v50 dst_sel:DWORD dst_unused:UNUSED_PAD src0_sel:DWORD src1_sel:WORD_1
    ds_read_b64 v[96:97], v96
    ds_read_b64 v[98:99], v98
    v_mfma_f32_16x16x32_bf16 v[112:115], v[84:87], v[140:143], v[112:115]
    v_lshlrev_b32_sdwa v100, 3, v51 dst_sel:DWORD dst_unused:UNUSED_PAD src0_sel:DWORD src1_sel:WORD_0
    v_lshlrev_b32_sdwa v102, 3, v51 dst_sel:DWORD dst_unused:UNUSED_PAD src0_sel:DWORD src1_sel:WORD_1
    ds_read_b64 v[100:101], v100
    ds_read_b64 v[102:103], v102
    s_add_u32 s20, s20, 0x2c00
    buffer_load_dwordx4 v[48:51], v71, s[12:15], s20 offen offset:3072 sc1
    v_smfmac_f32_16x16x64_bf16 v[0:3], v[66:69], v[104:111], v70
    s_nop 0
    v_cvt_pk_bf16_f32 v112, v112, v113
    v_cvt_pk_bf16_f32 v113, v114, v115
    v_lshlrev_b32_sdwa v114, 3, v70 dst_sel:DWORD dst_unused:UNUSED_PAD src0_sel:DWORD src1_sel:WORD_1
    ds_write_b64 v114, v[112:113] offset:0
    v_mfma_f32_16x16x32_bf16 v[112:115], v[72:75], v[144:147], 0
    s_waitcnt vmcnt(9)
    v_lshlrev_b32_sdwa v104, 3, v40 dst_sel:DWORD dst_unused:UNUSED_PAD src0_sel:DWORD src1_sel:WORD_0
    v_lshlrev_b32_sdwa v106, 3, v40 dst_sel:DWORD dst_unused:UNUSED_PAD src0_sel:DWORD src1_sel:WORD_1
    ds_read_b64 v[104:105], v104
    ds_read_b64 v[106:107], v106
    v_mfma_f32_16x16x32_bf16 v[112:115], v[76:79], v[148:151], v[112:115]
    v_lshlrev_b32_sdwa v108, 3, v41 dst_sel:DWORD dst_unused:UNUSED_PAD src0_sel:DWORD src1_sel:WORD_0
    v_lshlrev_b32_sdwa v110, 3, v41 dst_sel:DWORD dst_unused:UNUSED_PAD src0_sel:DWORD src1_sel:WORD_1
    v_cvt_pk_bf16_f32 v3, v2, v3
    v_cvt_pk_bf16_f32 v2, v0, v1
    v_lshlrev_b32 v52, 16, v2
    v_and_b32 v53, s23, v2
    v_lshlrev_b32 v54, 16, v3
    v_and_b32 v55, s23, v3
    ds_read_b64 v[108:109], v108
    ds_read_b64 v[110:111], v110
    s_waitcnt lgkmcnt(9)
    v_smfmac_f32_16x16x64_bf16 v[52:55], v[66:69], v[88:95], v70
    v_mfma_f32_16x16x32_bf16 v[112:115], v[80:83], v[152:155], v[112:115]
    v_lshlrev_b32_sdwa v88, 3, v42 dst_sel:DWORD dst_unused:UNUSED_PAD src0_sel:DWORD src1_sel:WORD_0
    v_lshlrev_b32_sdwa v90, 3, v42 dst_sel:DWORD dst_unused:UNUSED_PAD src0_sel:DWORD src1_sel:WORD_1
    ds_read_b64 v[88:89], v88
    ds_read_b64 v[90:91], v90
    v_mfma_f32_16x16x32_bf16 v[112:115], v[84:87], v[156:159], v[112:115]
    v_lshlrev_b32_sdwa v92, 3, v43 dst_sel:DWORD dst_unused:UNUSED_PAD src0_sel:DWORD src1_sel:WORD_0
    v_lshlrev_b32_sdwa v94, 3, v43 dst_sel:DWORD dst_unused:UNUSED_PAD src0_sel:DWORD src1_sel:WORD_1
    ds_read_b64 v[92:93], v92
    ds_read_b64 v[94:95], v94
    s_add_u32 s20, s20, 0x3f800
    buffer_load_dwordx4 v[40:43], v71, s[12:15], s20 offen offset:3072 sc1
    s_waitcnt lgkmcnt(9)
    v_smfmac_f32_16x16x64_bf16 v[52:55], v[66:69], v[96:103], v70
    v_cvt_pk_bf16_f32 v112, v112, v113
    v_cvt_pk_bf16_f32 v113, v114, v115
    v_lshlrev_b32_sdwa v114, 3, v70 dst_sel:DWORD dst_unused:UNUSED_PAD src0_sel:DWORD src1_sel:WORD_1
    ds_write_b64 v114, v[112:113] offset:128
    v_mfma_f32_16x16x32_bf16 v[112:115], v[72:75], v[160:163], 0
    s_waitcnt vmcnt(8)
    v_lshlrev_b32_sdwa v96, 3, v116 dst_sel:DWORD dst_unused:UNUSED_PAD src0_sel:DWORD src1_sel:WORD_0
    v_lshlrev_b32_sdwa v98, 3, v116 dst_sel:DWORD dst_unused:UNUSED_PAD src0_sel:DWORD src1_sel:WORD_1
    ds_read_b64 v[96:97], v96
    ds_read_b64 v[98:99], v98
    v_mfma_f32_16x16x32_bf16 v[112:115], v[76:79], v[164:167], v[112:115]
    v_lshlrev_b32_sdwa v100, 3, v117 dst_sel:DWORD dst_unused:UNUSED_PAD src0_sel:DWORD src1_sel:WORD_0
    v_lshlrev_b32_sdwa v102, 3, v117 dst_sel:DWORD dst_unused:UNUSED_PAD src0_sel:DWORD src1_sel:WORD_1
    v_lshlrev_b32 v56, 16, v30
    v_and_b32 v57, s23, v30
    v_lshlrev_b32 v58, 16, v31
    v_and_b32 v59, s23, v31
    ds_read_b64 v[100:101], v100
    ds_read_b64 v[102:103], v102
    s_waitcnt vmcnt(5)
    v_readfirstlane_b32 s44, v35
    s_cmp_le_u32 s44, 0
    s_cbranch_scc1 k1_kernel_xw0
k1_kernel_xb0:
    buffer_load_dwordx4 v[128:131], v71, s[12:15], s18 offen offset:0 sc1
    s_waitcnt lgkmcnt(9)
    v_smfmac_f32_16x16x64_bf16 v[56:59], v[66:69], v[104:111], v70
    v_mfma_f32_16x16x32_bf16 v[112:115], v[80:83], v[168:171], v[112:115]
    v_lshlrev_b32_sdwa v104, 3, v118 dst_sel:DWORD dst_unused:UNUSED_PAD src0_sel:DWORD src1_sel:WORD_0
    v_lshlrev_b32_sdwa v106, 3, v118 dst_sel:DWORD dst_unused:UNUSED_PAD src0_sel:DWORD src1_sel:WORD_1
    ds_read_b64 v[104:105], v104
    ds_read_b64 v[106:107], v106
    v_mfma_f32_16x16x32_bf16 v[112:115], v[84:87], v[172:175], v[112:115]
    v_lshlrev_b32_sdwa v108, 3, v119 dst_sel:DWORD dst_unused:UNUSED_PAD src0_sel:DWORD src1_sel:WORD_0
    v_lshlrev_b32_sdwa v110, 3, v119 dst_sel:DWORD dst_unused:UNUSED_PAD src0_sel:DWORD src1_sel:WORD_1
    ds_read_b64 v[108:109], v108
    ds_read_b64 v[110:111], v110
    s_add_u32 s20, s20, 0xfffc0800
    buffer_load_dwordx4 v[116:119], v71, s[12:15], s20 offen offset:0 sc1
    s_waitcnt lgkmcnt(9)
    v_smfmac_f32_16x16x64_bf16 v[56:59], v[66:69], v[88:95], v70
    v_cvt_pk_bf16_f32 v112, v112, v113
    v_cvt_pk_bf16_f32 v113, v114, v115
    v_lshlrev_b32_sdwa v114, 3, v70 dst_sel:DWORD dst_unused:UNUSED_PAD src0_sel:DWORD src1_sel:WORD_1
    ds_write_b64 v114, v[112:113] offset:256
    v_mfma_f32_16x16x32_bf16 v[112:115], v[72:75], v[176:179], 0
    v_lshlrev_b32_sdwa v88, 3, v36 dst_sel:DWORD dst_unused:UNUSED_PAD src0_sel:DWORD src1_sel:WORD_0
    v_lshlrev_b32_sdwa v90, 3, v36 dst_sel:DWORD dst_unused:UNUSED_PAD src0_sel:DWORD src1_sel:WORD_1
    ds_read_b64 v[88:89], v88
    ds_read_b64 v[90:91], v90
    v_mfma_f32_16x16x32_bf16 v[112:115], v[76:79], v[180:183], v[112:115]
    v_lshlrev_b32_sdwa v92, 3, v37 dst_sel:DWORD dst_unused:UNUSED_PAD src0_sel:DWORD src1_sel:WORD_0
    v_lshlrev_b32_sdwa v94, 3, v37 dst_sel:DWORD dst_unused:UNUSED_PAD src0_sel:DWORD src1_sel:WORD_1
    v_lshlrev_b32 v60, 16, v26
    v_and_b32 v61, s23, v26
    v_lshlrev_b32 v62, 16, v27
    v_and_b32 v63, s23, v27
    ds_read_b64 v[92:93], v92
    ds_read_b64 v[94:95], v94
    s_waitcnt lgkmcnt(9)
    v_smfmac_f32_16x16x64_bf16 v[60:63], v[66:69], v[96:103], v70
    v_mfma_f32_16x16x32_bf16 v[112:115], v[80:83], v[184:187], v[112:115]
    v_lshlrev_b32_sdwa v96, 3, v38 dst_sel:DWORD dst_unused:UNUSED_PAD src0_sel:DWORD src1_sel:WORD_0
    v_lshlrev_b32_sdwa v98, 3, v38 dst_sel:DWORD dst_unused:UNUSED_PAD src0_sel:DWORD src1_sel:WORD_1
    ds_read_b64 v[96:97], v96
    ds_read_b64 v[98:99], v98
    v_mfma_f32_16x16x32_bf16 v[112:115], v[84:87], v[188:191], v[112:115]
    v_lshlrev_b32_sdwa v100, 3, v39 dst_sel:DWORD dst_unused:UNUSED_PAD src0_sel:DWORD src1_sel:WORD_0
    v_lshlrev_b32_sdwa v102, 3, v39 dst_sel:DWORD dst_unused:UNUSED_PAD src0_sel:DWORD src1_sel:WORD_1
    ds_read_b64 v[100:101], v100
    ds_read_b64 v[102:103], v102
    s_add_u32 s20, s20, 0x40000
    buffer_load_dwordx4 v[36:39], v71, s[12:15], s20 offen offset:0 sc1
    s_waitcnt lgkmcnt(9)
    v_smfmac_f32_16x16x64_bf16 v[60:63], v[66:69], v[104:111], v70
    v_cvt_pk_bf16_f32 v112, v112, v113
    v_cvt_pk_bf16_f32 v113, v114, v115
    v_lshlrev_b32_sdwa v114, 3, v70 dst_sel:DWORD dst_unused:UNUSED_PAD src0_sel:DWORD src1_sel:WORD_1
    ds_write_b64 v114, v[112:113] offset:384
    s_setprio 1
    v_mfma_f32_16x16x32_bf16 v[112:115], v[72:75], v[192:195], 0
    v_lshlrev_b32_sdwa v104, 3, v44 dst_sel:DWORD dst_unused:UNUSED_PAD src0_sel:DWORD src1_sel:WORD_0
    v_lshlrev_b32_sdwa v106, 3, v44 dst_sel:DWORD dst_unused:UNUSED_PAD src0_sel:DWORD src1_sel:WORD_1
    ds_read_b64 v[104:105], v104
    ds_read_b64 v[106:107], v106
    v_mfma_f32_16x16x32_bf16 v[112:115], v[76:79], v[196:199], v[112:115]
    v_lshlrev_b32_sdwa v108, 3, v45 dst_sel:DWORD dst_unused:UNUSED_PAD src0_sel:DWORD src1_sel:WORD_0
    v_lshlrev_b32_sdwa v110, 3, v45 dst_sel:DWORD dst_unused:UNUSED_PAD src0_sel:DWORD src1_sel:WORD_1
    v_lshlrev_b32 v160, 16, v22
    v_and_b32 v161, s23, v22
    v_lshlrev_b32 v162, 16, v23
    v_and_b32 v163, s23, v23
    ds_read_b64 v[108:109], v108
    ds_read_b64 v[110:111], v110
    s_waitcnt lgkmcnt(9)
    v_smfmac_f32_16x16x64_bf16 v[160:163], v[66:69], v[88:95], v70
    v_mfma_f32_16x16x32_bf16 v[112:115], v[80:83], v[200:203], v[112:115]
    v_lshlrev_b32_sdwa v88, 3, v46 dst_sel:DWORD dst_unused:UNUSED_PAD src0_sel:DWORD src1_sel:WORD_0
    v_lshlrev_b32_sdwa v90, 3, v46 dst_sel:DWORD dst_unused:UNUSED_PAD src0_sel:DWORD src1_sel:WORD_1
    ds_read_b64 v[88:89], v88
    ds_read_b64 v[90:91], v90
    v_mfma_f32_16x16x32_bf16 v[112:115], v[84:87], v[204:207], v[112:115]
    v_lshlrev_b32_sdwa v92, 3, v47 dst_sel:DWORD dst_unused:UNUSED_PAD src0_sel:DWORD src1_sel:WORD_0
    v_lshlrev_b32_sdwa v94, 3, v47 dst_sel:DWORD dst_unused:UNUSED_PAD src0_sel:DWORD src1_sel:WORD_1
    ds_read_b64 v[92:93], v92
    ds_read_b64 v[94:95], v94
    s_add_u32 s20, s20, 0xfffff000
    buffer_load_dwordx4 v[44:47], v71, s[12:15], s20 offen offset:3072 sc1
    s_waitcnt lgkmcnt(9)
    v_smfmac_f32_16x16x64_bf16 v[160:163], v[66:69], v[96:103], v70
    v_cvt_pk_bf16_f32 v112, v112, v113
    v_cvt_pk_bf16_f32 v113, v114, v115
    v_lshlrev_b32_sdwa v114, 3, v70 dst_sel:DWORD dst_unused:UNUSED_PAD src0_sel:DWORD src1_sel:WORD_1
    ds_write_b64 v114, v[112:113] offset:512
    v_mfma_f32_16x16x32_bf16 v[112:115], v[72:75], v[208:211], 0
    s_waitcnt vmcnt(8)
    v_lshlrev_b32_sdwa v96, 3, v120 dst_sel:DWORD dst_unused:UNUSED_PAD src0_sel:DWORD src1_sel:WORD_0
    v_lshlrev_b32_sdwa v98, 3, v120 dst_sel:DWORD dst_unused:UNUSED_PAD src0_sel:DWORD src1_sel:WORD_1
    ds_read_b64 v[96:97], v96
    ds_read_b64 v[98:99], v98
    v_mfma_f32_16x16x32_bf16 v[112:115], v[76:79], v[212:215], v[112:115]
    v_lshlrev_b32_sdwa v100, 3, v121 dst_sel:DWORD dst_unused:UNUSED_PAD src0_sel:DWORD src1_sel:WORD_0
    v_lshlrev_b32_sdwa v102, 3, v121 dst_sel:DWORD dst_unused:UNUSED_PAD src0_sel:DWORD src1_sel:WORD_1
    v_lshlrev_b32 v164, 16, v18
    v_and_b32 v165, s23, v18
    v_lshlrev_b32 v166, 16, v19
    v_and_b32 v167, s23, v19
    ds_read_b64 v[100:101], v100
    ds_read_b64 v[102:103], v102
    buffer_load_dwordx4 v[132:135], v71, s[12:15], s18 offen offset:1024 sc1
    s_waitcnt lgkmcnt(9)
    v_smfmac_f32_16x16x64_bf16 v[164:167], v[66:69], v[104:111], v70
    v_mfma_f32_16x16x32_bf16 v[112:115], v[80:83], v[216:219], v[112:115]
    v_lshlrev_b32_sdwa v104, 3, v122 dst_sel:DWORD dst_unused:UNUSED_PAD src0_sel:DWORD src1_sel:WORD_0
    v_lshlrev_b32_sdwa v106, 3, v122 dst_sel:DWORD dst_unused:UNUSED_PAD src0_sel:DWORD src1_sel:WORD_1
    ds_read_b64 v[104:105], v104
    ds_read_b64 v[106:107], v106
    v_mfma_f32_16x16x32_bf16 v[112:115], v[84:87], v[220:223], v[112:115]
    v_lshlrev_b32_sdwa v108, 3, v123 dst_sel:DWORD dst_unused:UNUSED_PAD src0_sel:DWORD src1_sel:WORD_0
    v_lshlrev_b32_sdwa v110, 3, v123 dst_sel:DWORD dst_unused:UNUSED_PAD src0_sel:DWORD src1_sel:WORD_1
    ds_read_b64 v[108:109], v108
    ds_read_b64 v[110:111], v110
    s_add_u32 s20, s20, 0xfffc0800
    buffer_load_dwordx4 v[120:123], v71, s[12:15], s20 offen offset:0 sc1
    s_waitcnt lgkmcnt(9)
    v_smfmac_f32_16x16x64_bf16 v[164:167], v[66:69], v[88:95], v70
    v_cvt_pk_bf16_f32 v112, v112, v113
    v_cvt_pk_bf16_f32 v113, v114, v115
    v_lshlrev_b32_sdwa v114, 3, v70 dst_sel:DWORD dst_unused:UNUSED_PAD src0_sel:DWORD src1_sel:WORD_1
    ds_write_b64 v114, v[112:113] offset:640
    v_mfma_f32_16x16x32_bf16 v[112:115], v[72:75], v[224:227], 0
    s_waitcnt vmcnt(8)
    v_lshlrev_b32_sdwa v88, 3, v124 dst_sel:DWORD dst_unused:UNUSED_PAD src0_sel:DWORD src1_sel:WORD_0
    v_lshlrev_b32_sdwa v90, 3, v124 dst_sel:DWORD dst_unused:UNUSED_PAD src0_sel:DWORD src1_sel:WORD_1
    ds_read_b64 v[88:89], v88
    ds_read_b64 v[90:91], v90
    v_mfma_f32_16x16x32_bf16 v[112:115], v[76:79], v[228:231], v[112:115]
    v_lshlrev_b32_sdwa v92, 3, v125 dst_sel:DWORD dst_unused:UNUSED_PAD src0_sel:DWORD src1_sel:WORD_0
    v_lshlrev_b32_sdwa v94, 3, v125 dst_sel:DWORD dst_unused:UNUSED_PAD src0_sel:DWORD src1_sel:WORD_1
    v_lshlrev_b32 v168, 16, v14
    v_and_b32 v169, s23, v14
    v_lshlrev_b32 v170, 16, v15
    v_and_b32 v171, s23, v15
    ds_read_b64 v[92:93], v92
    ds_read_b64 v[94:95], v94
    v_mov_b32 v34, 2
    s_mov_b64 exec, 1
    buffer_store_dword v34, off, s[12:15], s46 sc1
    s_mov_b64 exec, -1
    s_waitcnt lgkmcnt(9)
    v_smfmac_f32_16x16x64_bf16 v[168:171], v[66:69], v[96:103], v70
    v_mfma_f32_16x16x32_bf16 v[112:115], v[80:83], v[232:235], v[112:115]
    v_lshlrev_b32_sdwa v96, 3, v126 dst_sel:DWORD dst_unused:UNUSED_PAD src0_sel:DWORD src1_sel:WORD_0
    v_lshlrev_b32_sdwa v98, 3, v126 dst_sel:DWORD dst_unused:UNUSED_PAD src0_sel:DWORD src1_sel:WORD_1
    ds_read_b64 v[96:97], v96
    ds_read_b64 v[98:99], v98
    v_mfma_f32_16x16x32_bf16 v[112:115], v[84:87], v[236:239], v[112:115]
    v_lshlrev_b32_sdwa v100, 3, v127 dst_sel:DWORD dst_unused:UNUSED_PAD src0_sel:DWORD src1_sel:WORD_0
    v_lshlrev_b32_sdwa v102, 3, v127 dst_sel:DWORD dst_unused:UNUSED_PAD src0_sel:DWORD src1_sel:WORD_1
    ds_read_b64 v[100:101], v100
    ds_read_b64 v[102:103], v102
    s_add_u32 s20, s20, 0x40000
    buffer_load_dwordx4 v[124:127], v71, s[12:15], s20 offen offset:0 sc1
    s_waitcnt lgkmcnt(9)
    v_smfmac_f32_16x16x64_bf16 v[168:171], v[66:69], v[104:111], v70
    v_cvt_pk_bf16_f32 v112, v112, v113
    v_cvt_pk_bf16_f32 v113, v114, v115
    v_lshlrev_b32_sdwa v114, 3, v70 dst_sel:DWORD dst_unused:UNUSED_PAD src0_sel:DWORD src1_sel:WORD_1
    ds_write_b64 v114, v[112:113] offset:768
    s_setprio 0
    v_mfma_f32_16x16x32_bf16 v[112:115], v[72:75], v[240:243], 0
    s_waitcnt vmcnt(9)
    v_lshlrev_b32_sdwa v104, 3, v48 dst_sel:DWORD dst_unused:UNUSED_PAD src0_sel:DWORD src1_sel:WORD_0
    v_lshlrev_b32_sdwa v106, 3, v48 dst_sel:DWORD dst_unused:UNUSED_PAD src0_sel:DWORD src1_sel:WORD_1
    ds_read_b64 v[104:105], v104
    ds_read_b64 v[106:107], v106
    v_mfma_f32_16x16x32_bf16 v[112:115], v[76:79], v[244:247], v[112:115]
    v_lshlrev_b32_sdwa v108, 3, v49 dst_sel:DWORD dst_unused:UNUSED_PAD src0_sel:DWORD src1_sel:WORD_0
    v_lshlrev_b32_sdwa v110, 3, v49 dst_sel:DWORD dst_unused:UNUSED_PAD src0_sel:DWORD src1_sel:WORD_1
    v_lshlrev_b32 v172, 16, v10
    v_and_b32 v173, s23, v10
    v_lshlrev_b32 v174, 16, v11
    v_and_b32 v175, s23, v11
    ds_read_b64 v[108:109], v108
    ds_read_b64 v[110:111], v110
    s_waitcnt lgkmcnt(9)
    v_smfmac_f32_16x16x64_bf16 v[172:175], v[66:69], v[88:95], v70
    v_mfma_f32_16x16x32_bf16 v[112:115], v[80:83], v[248:251], v[112:115]
    v_lshlrev_b32_sdwa v88, 3, v50 dst_sel:DWORD dst_unused:UNUSED_PAD src0_sel:DWORD src1_sel:WORD_0
    v_lshlrev_b32_sdwa v90, 3, v50 dst_sel:DWORD dst_unused:UNUSED_PAD src0_sel:DWORD src1_sel:WORD_1
    ds_read_b64 v[88:89], v88
    ds_read_b64 v[90:91], v90
    v_mfma_f32_16x16x32_bf16 v[112:115], v[84:87], v[252:255], v[112:115]
    v_lshlrev_b32_sdwa v92, 3, v51 dst_sel:DWORD dst_unused:UNUSED_PAD src0_sel:DWORD src1_sel:WORD_0
    v_lshlrev_b32_sdwa v94, 3, v51 dst_sel:DWORD dst_unused:UNUSED_PAD src0_sel:DWORD src1_sel:WORD_1
    ds_read_b64 v[92:93], v92
    ds_read_b64 v[94:95], v94
    s_add_u32 s20, s20, 0xfffff000
    buffer_load_dwordx4 v[48:51], v71, s[12:15], s20 offen offset:3072 sc1
    s_waitcnt lgkmcnt(9)
    v_smfmac_f32_16x16x64_bf16 v[172:175], v[66:69], v[96:103], v70
    v_cvt_pk_bf16_f32 v112, v112, v113
    v_cvt_pk_bf16_f32 v113, v114, v115
    v_lshlrev_b32_sdwa v114, 3, v70 dst_sel:DWORD dst_unused:UNUSED_PAD src0_sel:DWORD src1_sel:WORD_1
    ds_write_b64 v114, v[112:113] offset:896
    s_waitcnt lgkmcnt(0)
    s_barrier
    s_setprio 3
    v_mov_b32 v212, 0xbdd2d3e8
    v_mov_b32 v213, 0xbdd2d3e8
    v_mov_b32 v214, 0xc0135761
    v_mov_b32 v215, 0xc0135761
    v_bfe_u32 v216, v71, 4, 2
    v_mov_b32 v222, 0x3f80
    v_lshlrev_b32 v216, 4, v216
    v_mov_b32 v223, 0
    s_waitcnt vmcnt(9)
    v_lshlrev_b32_sdwa v96, 3, v40 dst_sel:DWORD dst_unused:UNUSED_PAD src0_sel:DWORD src1_sel:WORD_0
    v_lshlrev_b32_sdwa v98, 3, v40 dst_sel:DWORD dst_unused:UNUSED_PAD src0_sel:DWORD src1_sel:WORD_1
    ds_read_b64 v[96:97], v96
    ds_read_b64 v[98:99], v98
    v_lshlrev_b32_sdwa v100, 3, v41 dst_sel:DWORD dst_unused:UNUSED_PAD src0_sel:DWORD src1_sel:WORD_0
    v_lshlrev_b32_sdwa v102, 3, v41 dst_sel:DWORD dst_unused:UNUSED_PAD src0_sel:DWORD src1_sel:WORD_1
    v_lshlrev_b32 v176, 16, v6
    v_and_b32 v177, s23, v6
    v_lshlrev_b32 v178, 16, v7
    v_and_b32 v179, s23, v7
    ds_read_b64 v[100:101], v100
    ds_read_b64 v[102:103], v102
    buffer_load_dwordx4 v[136:139], v71, s[12:15], s18 offen offset:2048 sc1
    v_smfmac_f32_16x16x64_bf16 v[176:179], v[66:69], v[104:111], v70
    v_lshlrev_b64 v[222:223], v216, v[222:223]
    v_mov_b32 v218, s28
    v_mov_b32 v219, s29
    v_mov_b32 v220, s30
    v_mov_b32 v221, s31
    v_rcp_f32 v218, v218
    v_rcp_f32 v219, v219
    v_rcp_f32 v220, v220
    v_lshlrev_b32_sdwa v104, 3, v42 dst_sel:DWORD dst_unused:UNUSED_PAD src0_sel:DWORD src1_sel:WORD_0
    v_lshlrev_b32_sdwa v106, 3, v42 dst_sel:DWORD dst_unused:UNUSED_PAD src0_sel:DWORD src1_sel:WORD_1
    ds_read_b64 v[104:105], v104
    ds_read_b64 v[106:107], v106
    v_lshlrev_b32_sdwa v108, 3, v43 dst_sel:DWORD dst_unused:UNUSED_PAD src0_sel:DWORD src1_sel:WORD_0
    v_lshlrev_b32_sdwa v110, 3, v43 dst_sel:DWORD dst_unused:UNUSED_PAD src0_sel:DWORD src1_sel:WORD_1
    ds_read_b64 v[108:109], v108
    ds_read_b64 v[110:111], v110
    s_add_u32 s20, s20, 0xfffc0800
    buffer_load_dwordx4 v[40:43], v71, s[12:15], s20 offen offset:0 sc1
    v_smfmac_f32_16x16x64_bf16 v[176:179], v[66:69], v[88:95], v70
    v_rcp_f32 v221, v221
    v_mov_b32 v216, 0x7f7fffff
    v_mov_b32 v217, 0xff7fffff
    v_med3_f32 v218, v218, v216, v217
    v_med3_f32 v219, v219, v216, v217
    v_med3_f32 v220, v220, v216, v217
    v_med3_f32 v221, v221, v216, v217
    v_mov_b32 v73, 0
    s_waitcnt vmcnt(9)
    v_lshlrev_b32_sdwa v88, 3, v116 dst_sel:DWORD dst_unused:UNUSED_PAD src0_sel:DWORD src1_sel:WORD_0
    v_lshlrev_b32_sdwa v90, 3, v116 dst_sel:DWORD dst_unused:UNUSED_PAD src0_sel:DWORD src1_sel:WORD_1
    ds_read_b64 v[88:89], v88
    ds_read_b64 v[90:91], v90
    v_lshlrev_b32_sdwa v92, 3, v117 dst_sel:DWORD dst_unused:UNUSED_PAD src0_sel:DWORD src1_sel:WORD_0
    v_lshlrev_b32_sdwa v94, 3, v117 dst_sel:DWORD dst_unused:UNUSED_PAD src0_sel:DWORD src1_sel:WORD_1
    ds_read_b64 v[92:93], v92
    ds_read_b64 v[94:95], v94
    s_waitcnt lgkmcnt(8)
    v_smfmac_f32_16x16x64_bf16 v[52:55], v[66:69], v[96:103], v70
    v_lshrrev_b32 v76, 2, v71
    v_mov_b32 v79, 0
    v_and_b32 v75, 0xf0, v71
    v_lshrrev_b32 v80, 8, v71
    v_lshl_add_u32 v74, v80, 16, v75
    v_lshl_add_u32 v75, v80, 2, v75
    v_lshrrev_b32 v77, 9, v71
    v_mul_u32_u24 v77, 8064, v77
    v_lshlrev_b32_sdwa v96, 3, v118 dst_sel:DWORD dst_unused:UNUSED_PAD src0_sel:DWORD src1_sel:WORD_0
    v_lshlrev_b32_sdwa v98, 3, v118 dst_sel:DWORD dst_unused:UNUSED_PAD src0_sel:DWORD src1_sel:WORD_1
    ds_read_b64 v[96:97], v96
    ds_read_b64 v[98:99], v98
    v_lshlrev_b32_sdwa v100, 3, v119 dst_sel:DWORD dst_unused:UNUSED_PAD src0_sel:DWORD src1_sel:WORD_0
    v_lshlrev_b32_sdwa v102, 3, v119 dst_sel:DWORD dst_unused:UNUSED_PAD src0_sel:DWORD src1_sel:WORD_1
    ds_read_b64 v[100:101], v100
    ds_read_b64 v[102:103], v102
    s_add_u32 s20, s20, 0x40000
    buffer_load_dwordx4 v[116:119], v71, s[12:15], s20 offen offset:0 sc1
    s_waitcnt lgkmcnt(8)
    v_smfmac_f32_16x16x64_bf16 v[52:55], v[66:69], v[104:111], v70
    v_add3_u32 v77, v77, v76, s67
    v_lshrrev_b32 v78, 1, v75
    s_waitcnt vmcnt(9)
    v_lshlrev_b32_sdwa v104, 3, v36 dst_sel:DWORD dst_unused:UNUSED_PAD src0_sel:DWORD src1_sel:WORD_0
    v_lshlrev_b32_sdwa v106, 3, v36 dst_sel:DWORD dst_unused:UNUSED_PAD src0_sel:DWORD src1_sel:WORD_1
    ds_read_b64 v[104:105], v104
    ds_read_b64 v[106:107], v106
    v_lshlrev_b32_sdwa v108, 3, v37 dst_sel:DWORD dst_unused:UNUSED_PAD src0_sel:DWORD src1_sel:WORD_0
    v_lshlrev_b32_sdwa v110, 3, v37 dst_sel:DWORD dst_unused:UNUSED_PAD src0_sel:DWORD src1_sel:WORD_1
    v_lshlrev_b32 v180, 16, v32
    v_and_b32 v181, s23, v32
    v_lshlrev_b32 v182, 16, v33
    v_and_b32 v183, s23, v33
    ds_read_b64 v[108:109], v108
    ds_read_b64 v[110:111], v110
    s_mov_b64 exec, 1
    buffer_load_dword v35, off, s[12:15], s47 sc1
    s_mov_b64 exec, -1
    s_waitcnt lgkmcnt(8)
    v_smfmac_f32_16x16x64_bf16 v[180:183], v[66:69], v[88:95], v70
    v_mfma_f32_4x4x4_16b_bf16 v[52:55], v[222:223], v[128:129], v[52:55]
    v_lshlrev_b32_sdwa v88, 3, v38 dst_sel:DWORD dst_unused:UNUSED_PAD src0_sel:DWORD src1_sel:WORD_0
    v_lshlrev_b32_sdwa v90, 3, v38 dst_sel:DWORD dst_unused:UNUSED_PAD src0_sel:DWORD src1_sel:WORD_1
    ds_read_b64 v[88:89], v88
    ds_read_b64 v[90:91], v90
    v_lshlrev_b32_sdwa v92, 3, v39 dst_sel:DWORD dst_unused:UNUSED_PAD src0_sel:DWORD src1_sel:WORD_0
    v_lshlrev_b32_sdwa v94, 3, v39 dst_sel:DWORD dst_unused:UNUSED_PAD src0_sel:DWORD src1_sel:WORD_1
    ds_read_b64 v[92:93], v92
    ds_read_b64 v[94:95], v94
    s_add_u32 s20, s20, 0xfffff000
    buffer_load_dwordx4 v[36:39], v71, s[12:15], s20 offen offset:3072 sc1
    s_waitcnt lgkmcnt(8)
    v_smfmac_f32_16x16x64_bf16 v[180:183], v[66:69], v[96:103], v70
    v_pk_mul_f32 v[224:225], v[52:53], v[52:53]
    v_pk_mul_f32 v[226:227], v[54:55], v[54:55]
    v_pk_fma_f32 v[224:225], v[224:225], v[212:213], v[214:215]
    v_pk_fma_f32 v[226:227], v[226:227], v[212:213], v[214:215]
    v_pk_mul_f32 v[224:225], v[224:225], v[52:53]
    v_pk_mul_f32 v[226:227], v[226:227], v[54:55]
    v_exp_f32 v224, v224
    v_exp_f32 v225, v225
    s_waitcnt vmcnt(10)
    v_lshlrev_b32_sdwa v96, 3, v44 dst_sel:DWORD dst_unused:UNUSED_PAD src0_sel:DWORD src1_sel:WORD_0
    v_lshlrev_b32_sdwa v98, 3, v44 dst_sel:DWORD dst_unused:UNUSED_PAD src0_sel:DWORD src1_sel:WORD_1
    ds_read_b64 v[96:97], v96
    ds_read_b64 v[98:99], v98
    v_lshlrev_b32_sdwa v100, 3, v45 dst_sel:DWORD dst_unused:UNUSED_PAD src0_sel:DWORD src1_sel:WORD_0
    v_lshlrev_b32_sdwa v102, 3, v45 dst_sel:DWORD dst_unused:UNUSED_PAD src0_sel:DWORD src1_sel:WORD_1
    ds_read_b64 v[100:101], v100
    ds_read_b64 v[102:103], v102
    buffer_load_dwordx4 v[140:143], v71, s[12:15], s18 offen offset:3072 sc1
    s_waitcnt lgkmcnt(8)
    v_smfmac_f32_16x16x64_bf16 v[180:183], v[66:69], v[104:111], v70
    v_exp_f32 v226, v226
    v_pk_fma_f32 v[224:225], v[224:225], v[218:219], v[218:219]
    v_exp_f32 v227, v227
    v_rcp_f32 v224, v224
    v_rcp_f32 v225, v225
    v_pk_fma_f32 v[226:227], v[226:227], v[220:221], v[220:221]
    v_lshlrev_b32_sdwa v104, 3, v46 dst_sel:DWORD dst_unused:UNUSED_PAD src0_sel:DWORD src1_sel:WORD_0
    v_lshlrev_b32_sdwa v106, 3, v46 dst_sel:DWORD dst_unused:UNUSED_PAD src0_sel:DWORD src1_sel:WORD_1
    ds_read_b64 v[104:105], v104
    ds_read_b64 v[106:107], v106
    v_lshlrev_b32_sdwa v108, 3, v47 dst_sel:DWORD dst_unused:UNUSED_PAD src0_sel:DWORD src1_sel:WORD_0
    v_lshlrev_b32_sdwa v110, 3, v47 dst_sel:DWORD dst_unused:UNUSED_PAD src0_sel:DWORD src1_sel:WORD_1
    ds_read_b64 v[108:109], v108
    ds_read_b64 v[110:111], v110
    s_add_u32 s20, s20, 0xfffc0800
    buffer_load_dwordx4 v[44:47], v71, s[12:15], s20 offen offset:0 sc1
    s_waitcnt lgkmcnt(8)
    v_smfmac_f32_16x16x64_bf16 v[180:183], v[66:69], v[88:95], v70
    v_rcp_f32 v226, v226
    v_pk_mul_f32 v[228:229], v[52:53], v[224:225]
    v_rcp_f32 v227, v227
    s_waitcnt vmcnt(10)
    v_lshlrev_b32_sdwa v88, 3, v120 dst_sel:DWORD dst_unused:UNUSED_PAD src0_sel:DWORD src1_sel:WORD_0
    v_lshlrev_b32_sdwa v90, 3, v120 dst_sel:DWORD dst_unused:UNUSED_PAD src0_sel:DWORD src1_sel:WORD_1
    ds_read_b64 v[88:89], v88
    ds_read_b64 v[90:91], v90
    v_lshlrev_b32_sdwa v92, 3, v121 dst_sel:DWORD dst_unused:UNUSED_PAD src0_sel:DWORD src1_sel:WORD_0
    v_lshlrev_b32_sdwa v94, 3, v121 dst_sel:DWORD dst_unused:UNUSED_PAD src0_sel:DWORD src1_sel:WORD_1
    ds_read_b64 v[92:93], v92
    ds_read_b64 v[94:95], v94
    s_waitcnt lgkmcnt(8)
    v_smfmac_f32_16x16x64_bf16 v[56:59], v[66:69], v[96:103], v70
    v_pk_fma_f32 v[228:229], v[54:55], v[226:227], v[228:229]
    v_mfma_f32_4x4x4_16b_bf16 v[180:183], v[222:223], v[130:131], v[180:183]
    v_add_f32 v228, v228, v229
    v_lshlrev_b32_sdwa v96, 3, v122 dst_sel:DWORD dst_unused:UNUSED_PAD src0_sel:DWORD src1_sel:WORD_0
    v_lshlrev_b32_sdwa v98, 3, v122 dst_sel:DWORD dst_unused:UNUSED_PAD src0_sel:DWORD src1_sel:WORD_1
    ds_read_b64 v[96:97], v96
    ds_read_b64 v[98:99], v98
    v_lshlrev_b32_sdwa v100, 3, v123 dst_sel:DWORD dst_unused:UNUSED_PAD src0_sel:DWORD src1_sel:WORD_0
    v_lshlrev_b32_sdwa v102, 3, v123 dst_sel:DWORD dst_unused:UNUSED_PAD src0_sel:DWORD src1_sel:WORD_1
    ds_read_b64 v[100:101], v100
    ds_read_b64 v[102:103], v102
    s_add_u32 s20, s20, 0x40000
    buffer_load_dwordx4 v[120:123], v71, s[12:15], s20 offen offset:0 sc1
    s_waitcnt lgkmcnt(8)
    v_smfmac_f32_16x16x64_bf16 v[56:59], v[66:69], v[104:111], v70
    v_min_u32 v228, -2, v228
    v_pk_mul_f32 v[230:231], v[180:181], v[180:181]
    buffer_store_dword v228, v76, s[12:15], s35 offen offset:3328 sc1
    v_pk_fma_f32 v[230:231], v[230:231], v[212:213], v[214:215]
    v_pk_mul_f32 v[232:233], v[182:183], v[182:183]
    v_pk_mul_f32 v[230:231], v[230:231], v[180:181]
    v_pk_fma_f32 v[232:233], v[232:233], v[212:213], v[214:215]
    v_exp_f32 v230, v230
    s_waitcnt vmcnt(10)
    v_lshlrev_b32_sdwa v104, 3, v124 dst_sel:DWORD dst_unused:UNUSED_PAD src0_sel:DWORD src1_sel:WORD_0
    v_lshlrev_b32_sdwa v106, 3, v124 dst_sel:DWORD dst_unused:UNUSED_PAD src0_sel:DWORD src1_sel:WORD_1
    ds_read_b64 v[104:105], v104
    ds_read_b64 v[106:107], v106
    v_lshlrev_b32_sdwa v108, 3, v125 dst_sel:DWORD dst_unused:UNUSED_PAD src0_sel:DWORD src1_sel:WORD_0
    v_lshlrev_b32_sdwa v110, 3, v125 dst_sel:DWORD dst_unused:UNUSED_PAD src0_sel:DWORD src1_sel:WORD_1
    v_lshlrev_b32 v184, 16, v28
    v_and_b32 v185, s23, v28
    v_lshlrev_b32 v186, 16, v29
    v_and_b32 v187, s23, v29
    ds_read_b64 v[108:109], v108
    ds_read_b64 v[110:111], v110
    s_waitcnt lgkmcnt(8)
    v_smfmac_f32_16x16x64_bf16 v[184:187], v[66:69], v[88:95], v70
    v_exp_f32 v231, v231
    v_pk_mul_f32 v[232:233], v[232:233], v[182:183]
    v_mfma_f32_4x4x4_16b_bf16 v[56:59], v[222:223], v[132:133], v[56:59]
    v_exp_f32 v232, v232
    v_pk_fma_f32 v[230:231], v[230:231], v[218:219], v[218:219]
    v_exp_f32 v233, v233
    v_rcp_f32 v230, v230
    v_rcp_f32 v231, v231
    v_lshlrev_b32_sdwa v88, 3, v126 dst_sel:DWORD dst_unused:UNUSED_PAD src0_sel:DWORD src1_sel:WORD_0
    v_lshlrev_b32_sdwa v90, 3, v126 dst_sel:DWORD dst_unused:UNUSED_PAD src0_sel:DWORD src1_sel:WORD_1
    ds_read_b64 v[88:89], v88
    ds_read_b64 v[90:91], v90
    v_lshlrev_b32_sdwa v92, 3, v127 dst_sel:DWORD dst_unused:UNUSED_PAD src0_sel:DWORD src1_sel:WORD_0
    v_lshlrev_b32_sdwa v94, 3, v127 dst_sel:DWORD dst_unused:UNUSED_PAD src0_sel:DWORD src1_sel:WORD_1
    ds_read_b64 v[92:93], v92
    ds_read_b64 v[94:95], v94
    s_add_u32 s20, s20, 0xfffff000
    buffer_load_dwordx4 v[124:127], v71, s[12:15], s20 offen offset:3072 sc1
    s_waitcnt lgkmcnt(8)
    v_smfmac_f32_16x16x64_bf16 v[184:187], v[66:69], v[96:103], v70
    v_pk_fma_f32 v[232:233], v[232:233], v[220:221], v[220:221]
    v_pk_mul_f32 v[234:235], v[180:181], v[230:231]
    v_rcp_f32 v232, v232
    v_pk_mul_f32 v[236:237], v[56:57], v[56:57]
    v_pk_mul_f32 v[238:239], v[58:59], v[58:59]
    v_rcp_f32 v233, v233
    v_pk_fma_f32 v[236:237], v[236:237], v[212:213], v[214:215]
    v_pk_fma_f32 v[238:239], v[238:239], v[212:213], v[214:215]
    s_waitcnt vmcnt(10)
    v_lshlrev_b32_sdwa v96, 3, v48 dst_sel:DWORD dst_unused:UNUSED_PAD src0_sel:DWORD src1_sel:WORD_0
    v_lshlrev_b32_sdwa v98, 3, v48 dst_sel:DWORD dst_unused:UNUSED_PAD src0_sel:DWORD src1_sel:WORD_1
    ds_read_b64 v[96:97], v96
    ds_read_b64 v[98:99], v98
    v_lshlrev_b32_sdwa v100, 3, v49 dst_sel:DWORD dst_unused:UNUSED_PAD src0_sel:DWORD src1_sel:WORD_0
    v_lshlrev_b32_sdwa v102, 3, v49 dst_sel:DWORD dst_unused:UNUSED_PAD src0_sel:DWORD src1_sel:WORD_1
    ds_read_b64 v[100:101], v100
    ds_read_b64 v[102:103], v102
    s_waitcnt vmcnt(6)
    v_readfirstlane_b32 s44, v35
    s_cmp_le_u32 s44, 1
    s_cbranch_scc1 k1_kernel_xw1
k1_kernel_xb1:
    buffer_load_dwordx4 v[144:147], v71, s[12:15], s32 offen offset:0 sc1
    s_waitcnt lgkmcnt(8)
    v_smfmac_f32_16x16x64_bf16 v[184:187], v[66:69], v[104:111], v70
    v_pk_fma_f32 v[234:235], v[182:183], v[232:233], v[234:235]
    v_pk_mul_f32 v[236:237], v[236:237], v[56:57]
    v_add_f32 v234, v234, v235
    v_exp_f32 v236, v236
    v_min_u32 v234, -2, v234
    v_pk_mul_f32 v[238:239], v[238:239], v[58:59]
    v_exp_f32 v237, v237
    buffer_store_dword v234, v76, s[12:15], s35 offen offset:3072 sc1
    v_lshlrev_b32_sdwa v104, 3, v50 dst_sel:DWORD dst_unused:UNUSED_PAD src0_sel:DWORD src1_sel:WORD_0
    v_lshlrev_b32_sdwa v106, 3, v50 dst_sel:DWORD dst_unused:UNUSED_PAD src0_sel:DWORD src1_sel:WORD_1
    ds_read_b64 v[104:105], v104
    ds_read_b64 v[106:107], v106
    v_lshlrev_b32_sdwa v108, 3, v51 dst_sel:DWORD dst_unused:UNUSED_PAD src0_sel:DWORD src1_sel:WORD_0
    v_lshlrev_b32_sdwa v110, 3, v51 dst_sel:DWORD dst_unused:UNUSED_PAD src0_sel:DWORD src1_sel:WORD_1
    ds_read_b64 v[108:109], v108
    ds_read_b64 v[110:111], v110
    s_add_u32 s20, s20, 0xfffc0800
    buffer_load_dwordx4 v[48:51], v71, s[12:15], s20 offen offset:0 sc1
    s_waitcnt lgkmcnt(8)
    v_smfmac_f32_16x16x64_bf16 v[184:187], v[66:69], v[88:95], v70
    v_exp_f32 v238, v238
    v_pk_fma_f32 v[236:237], v[236:237], v[218:219], v[218:219]
    v_exp_f32 v239, v239
    v_rcp_f32 v236, v236
    v_rcp_f32 v237, v237
    v_pk_fma_f32 v[238:239], v[238:239], v[220:221], v[220:221]
    v_lshlrev_b32_sdwa v88, 3, v40 dst_sel:DWORD dst_unused:UNUSED_PAD src0_sel:DWORD src1_sel:WORD_0
    v_lshlrev_b32_sdwa v90, 3, v40 dst_sel:DWORD dst_unused:UNUSED_PAD src0_sel:DWORD src1_sel:WORD_1
    ds_read_b64 v[88:89], v88
    ds_read_b64 v[90:91], v90
    v_lshlrev_b32_sdwa v92, 3, v41 dst_sel:DWORD dst_unused:UNUSED_PAD src0_sel:DWORD src1_sel:WORD_0
    v_lshlrev_b32_sdwa v94, 3, v41 dst_sel:DWORD dst_unused:UNUSED_PAD src0_sel:DWORD src1_sel:WORD_1
    ds_read_b64 v[92:93], v92
    ds_read_b64 v[94:95], v94
    s_waitcnt lgkmcnt(8)
    v_smfmac_f32_16x16x64_bf16 v[60:63], v[66:69], v[96:103], v70
    v_rcp_f32 v238, v238
    v_pk_mul_f32 v[240:241], v[56:57], v[236:237]
    v_mfma_f32_4x4x4_16b_bf16 v[184:187], v[222:223], v[134:135], v[184:187]
    v_rcp_f32 v239, v239
    v_lshlrev_b32_sdwa v96, 3, v42 dst_sel:DWORD dst_unused:UNUSED_PAD src0_sel:DWORD src1_sel:WORD_0
    v_lshlrev_b32_sdwa v98, 3, v42 dst_sel:DWORD dst_unused:UNUSED_PAD src0_sel:DWORD src1_sel:WORD_1
    ds_read_b64 v[96:97], v96
    ds_read_b64 v[98:99], v98
    v_lshlrev_b32_sdwa v100, 3, v43 dst_sel:DWORD dst_unused:UNUSED_PAD src0_sel:DWORD src1_sel:WORD_0
    v_lshlrev_b32_sdwa v102, 3, v43 dst_sel:DWORD dst_unused:UNUSED_PAD src0_sel:DWORD src1_sel:WORD_1
    ds_read_b64 v[100:101], v100
    ds_read_b64 v[102:103], v102
    s_add_u32 s20, s20, 0x40000
    buffer_load_dwordx4 v[40:43], v71, s[12:15], s20 offen offset:0 sc1
    s_waitcnt lgkmcnt(8)
    v_smfmac_f32_16x16x64_bf16 v[60:63], v[66:69], v[104:111], v70
    v_pk_fma_f32 v[240:241], v[58:59], v[238:239], v[240:241]
    v_pk_mul_f32 v[242:243], v[184:185], v[184:185]
    v_add_f32 v240, v240, v241
    v_pk_fma_f32 v[242:243], v[242:243], v[212:213], v[214:215]
    v_min_u32 v240, -2, v240
    v_pk_mul_f32 v[242:243], v[242:243], v[184:185]
    buffer_store_dword v240, v76, s[12:15], s35 offen offset:2816 sc1
    v_exp_f32 v242, v242
    v_lshlrev_b32_sdwa v104, 3, v116 dst_sel:DWORD dst_unused:UNUSED_PAD src0_sel:DWORD src1_sel:WORD_0
    v_lshlrev_b32_sdwa v106, 3, v116 dst_sel:DWORD dst_unused:UNUSED_PAD src0_sel:DWORD src1_sel:WORD_1
    ds_read_b64 v[104:105], v104
    ds_read_b64 v[106:107], v106
    v_lshlrev_b32_sdwa v108, 3, v117 dst_sel:DWORD dst_unused:UNUSED_PAD src0_sel:DWORD src1_sel:WORD_0
    v_lshlrev_b32_sdwa v110, 3, v117 dst_sel:DWORD dst_unused:UNUSED_PAD src0_sel:DWORD src1_sel:WORD_1
    v_lshlrev_b32 v188, 16, v24
    v_and_b32 v189, s23, v24
    v_lshlrev_b32 v190, 16, v25
    v_and_b32 v191, s23, v25
    ds_read_b64 v[108:109], v108
    ds_read_b64 v[110:111], v110
    s_waitcnt lgkmcnt(8)
    v_smfmac_f32_16x16x64_bf16 v[188:191], v[66:69], v[88:95], v70
    v_exp_f32 v243, v243
    v_pk_mul_f32 v[244:245], v[186:187], v[186:187]
    v_mfma_f32_4x4x4_16b_bf16 v[60:63], v[222:223], v[136:137], v[60:63]
    v_pk_fma_f32 v[242:243], v[242:243], v[218:219], v[218:219]
    v_pk_fma_f32 v[244:245], v[244:245], v[212:213], v[214:215]
    v_rcp_f32 v242, v242
    v_pk_mul_f32 v[244:245], v[244:245], v[186:187]
    v_rcp_f32 v243, v243
    v_lshlrev_b32_sdwa v88, 3, v118 dst_sel:DWORD dst_unused:UNUSED_PAD src0_sel:DWORD src1_sel:WORD_0
    v_lshlrev_b32_sdwa v90, 3, v118 dst_sel:DWORD dst_unused:UNUSED_PAD src0_sel:DWORD src1_sel:WORD_1
    ds_read_b64 v[88:89], v88
    ds_read_b64 v[90:91], v90
    v_lshlrev_b32_sdwa v92, 3, v119 dst_sel:DWORD dst_unused:UNUSED_PAD src0_sel:DWORD src1_sel:WORD_0
    v_lshlrev_b32_sdwa v94, 3, v119 dst_sel:DWORD dst_unused:UNUSED_PAD src0_sel:DWORD src1_sel:WORD_1
    ds_read_b64 v[92:93], v92
    ds_read_b64 v[94:95], v94
    s_add_u32 s20, s20, 0xfffff000
    buffer_load_dwordx4 v[116:119], v71, s[12:15], s20 offen offset:3072 sc1
    s_waitcnt lgkmcnt(8)
    v_smfmac_f32_16x16x64_bf16 v[188:191], v[66:69], v[96:103], v70
    v_exp_f32 v244, v244
    v_pk_mul_f32 v[246:247], v[184:185], v[242:243]
    v_pk_mul_f32 v[248:249], v[60:61], v[60:61]
    v_exp_f32 v245, v245
    v_pk_fma_f32 v[248:249], v[248:249], v[212:213], v[214:215]
    v_pk_mul_f32 v[250:251], v[62:63], v[62:63]
    v_pk_fma_f32 v[244:245], v[244:245], v[220:221], v[220:221]
    v_pk_mul_f32 v[248:249], v[248:249], v[60:61]
    s_waitcnt vmcnt(11)
    v_lshlrev_b32_sdwa v96, 3, v36 dst_sel:DWORD dst_unused:UNUSED_PAD src0_sel:DWORD src1_sel:WORD_0
    v_lshlrev_b32_sdwa v98, 3, v36 dst_sel:DWORD dst_unused:UNUSED_PAD src0_sel:DWORD src1_sel:WORD_1
    ds_read_b64 v[96:97], v96
    ds_read_b64 v[98:99], v98
    v_lshlrev_b32_sdwa v100, 3, v37 dst_sel:DWORD dst_unused:UNUSED_PAD src0_sel:DWORD src1_sel:WORD_0
    v_lshlrev_b32_sdwa v102, 3, v37 dst_sel:DWORD dst_unused:UNUSED_PAD src0_sel:DWORD src1_sel:WORD_1
    ds_read_b64 v[100:101], v100
    ds_read_b64 v[102:103], v102
    buffer_load_dwordx4 v[148:151], v71, s[12:15], s32 offen offset:1024 sc1
    s_waitcnt lgkmcnt(8)
    v_smfmac_f32_16x16x64_bf16 v[188:191], v[66:69], v[104:111], v70
    v_rcp_f32 v244, v244
    v_pk_fma_f32 v[250:251], v[250:251], v[212:213], v[214:215]
    v_rcp_f32 v245, v245
    v_pk_mul_f32 v[250:251], v[250:251], v[62:63]
    v_exp_f32 v248, v248
    v_pk_fma_f32 v[246:247], v[186:187], v[244:245], v[246:247]
    v_exp_f32 v249, v249
    v_add_f32 v246, v246, v247
    v_lshlrev_b32_sdwa v104, 3, v38 dst_sel:DWORD dst_unused:UNUSED_PAD src0_sel:DWORD src1_sel:WORD_0
    v_lshlrev_b32_sdwa v106, 3, v38 dst_sel:DWORD dst_unused:UNUSED_PAD src0_sel:DWORD src1_sel:WORD_1
    ds_read_b64 v[104:105], v104
    ds_read_b64 v[106:107], v106
    v_lshlrev_b32_sdwa v108, 3, v39 dst_sel:DWORD dst_unused:UNUSED_PAD src0_sel:DWORD src1_sel:WORD_0
    v_lshlrev_b32_sdwa v110, 3, v39 dst_sel:DWORD dst_unused:UNUSED_PAD src0_sel:DWORD src1_sel:WORD_1
    ds_read_b64 v[108:109], v108
    ds_read_b64 v[110:111], v110
    s_add_u32 s20, s20, 0xfffc0800
    buffer_load_dwordx4 v[36:39], v71, s[12:15], s20 offen offset:0 sc1
    s_waitcnt lgkmcnt(8)
    v_smfmac_f32_16x16x64_bf16 v[188:191], v[66:69], v[88:95], v70
    v_exp_f32 v250, v250
    v_min_u32 v246, -2, v246
    v_pk_fma_f32 v[248:249], v[248:249], v[218:219], v[218:219]
    v_exp_f32 v251, v251
    buffer_store_dword v246, v76, s[12:15], s35 offen offset:2560 sc1
    v_rcp_f32 v248, v248
    v_pk_fma_f32 v[250:251], v[250:251], v[220:221], v[220:221]
    v_rcp_f32 v249, v249
    s_waitcnt vmcnt(12)
    v_lshlrev_b32_sdwa v88, 3, v44 dst_sel:DWORD dst_unused:UNUSED_PAD src0_sel:DWORD src1_sel:WORD_0
    v_lshlrev_b32_sdwa v90, 3, v44 dst_sel:DWORD dst_unused:UNUSED_PAD src0_sel:DWORD src1_sel:WORD_1
    ds_read_b64 v[88:89], v88
    ds_read_b64 v[90:91], v90
    v_lshlrev_b32_sdwa v92, 3, v45 dst_sel:DWORD dst_unused:UNUSED_PAD src0_sel:DWORD src1_sel:WORD_0
    v_lshlrev_b32_sdwa v94, 3, v45 dst_sel:DWORD dst_unused:UNUSED_PAD src0_sel:DWORD src1_sel:WORD_1
    ds_read_b64 v[92:93], v92
    ds_read_b64 v[94:95], v94
    s_waitcnt lgkmcnt(8)
    v_smfmac_f32_16x16x64_bf16 v[160:163], v[66:69], v[96:103], v70
    v_rcp_f32 v250, v250
    v_pk_mul_f32 v[252:253], v[60:61], v[248:249]
    v_mfma_f32_4x4x4_16b_bf16 v[188:191], v[222:223], v[138:139], v[188:191]
    v_rcp_f32 v251, v251
    v_lshlrev_b32_sdwa v96, 3, v46 dst_sel:DWORD dst_unused:UNUSED_PAD src0_sel:DWORD src1_sel:WORD_0
    v_lshlrev_b32_sdwa v98, 3, v46 dst_sel:DWORD dst_unused:UNUSED_PAD src0_sel:DWORD src1_sel:WORD_1
    ds_read_b64 v[96:97], v96
    ds_read_b64 v[98:99], v98
    v_lshlrev_b32_sdwa v100, 3, v47 dst_sel:DWORD dst_unused:UNUSED_PAD src0_sel:DWORD src1_sel:WORD_0
    v_lshlrev_b32_sdwa v102, 3, v47 dst_sel:DWORD dst_unused:UNUSED_PAD src0_sel:DWORD src1_sel:WORD_1
    ds_read_b64 v[100:101], v100
    ds_read_b64 v[102:103], v102
    s_add_u32 s20, s20, 0x40000
    buffer_load_dwordx4 v[44:47], v71, s[12:15], s20 offen offset:0 sc1
    s_waitcnt lgkmcnt(8)
    v_smfmac_f32_16x16x64_bf16 v[160:163], v[66:69], v[104:111], v70
    v_pk_fma_f32 v[252:253], v[62:63], v[250:251], v[252:253]
    v_pk_mul_f32 v[224:225], v[188:189], v[188:189]
    v_add_f32 v252, v252, v253
    v_pk_fma_f32 v[224:225], v[224:225], v[212:213], v[214:215]
    v_min_u32 v252, -2, v252
    v_pk_mul_f32 v[224:225], v[224:225], v[188:189]
    buffer_store_dword v252, v76, s[12:15], s35 offen offset:2304 sc1
    v_exp_f32 v224, v224
    s_waitcnt vmcnt(13)
    v_lshlrev_b32_sdwa v104, 3, v120 dst_sel:DWORD dst_unused:UNUSED_PAD src0_sel:DWORD src1_sel:WORD_0
    v_lshlrev_b32_sdwa v106, 3, v120 dst_sel:DWORD dst_unused:UNUSED_PAD src0_sel:DWORD src1_sel:WORD_1
    ds_read_b64 v[104:105], v104
    ds_read_b64 v[106:107], v106
    v_lshlrev_b32_sdwa v108, 3, v121 dst_sel:DWORD dst_unused:UNUSED_PAD src0_sel:DWORD src1_sel:WORD_0
    v_lshlrev_b32_sdwa v110, 3, v121 dst_sel:DWORD dst_unused:UNUSED_PAD src0_sel:DWORD src1_sel:WORD_1
    v_lshlrev_b32 v192, 16, v20
    v_and_b32 v193, s23, v20
    v_lshlrev_b32 v194, 16, v21
    v_and_b32 v195, s23, v21
    ds_read_b64 v[108:109], v108
    ds_read_b64 v[110:111], v110
    s_waitcnt lgkmcnt(8)
    v_smfmac_f32_16x16x64_bf16 v[192:195], v[66:69], v[88:95], v70
    s_setprio 2
    v_exp_f32 v225, v225
    v_pk_mul_f32 v[226:227], v[190:191], v[190:191]
    v_mfma_f32_4x4x4_16b_bf16 v[160:163], v[222:223], v[140:141], v[160:163]
    v_pk_fma_f32 v[224:225], v[224:225], v[218:219], v[218:219]
    v_pk_fma_f32 v[226:227], v[226:227], v[212:213], v[214:215]
    v_rcp_f32 v224, v224
    v_pk_mul_f32 v[226:227], v[226:227], v[190:191]
    v_rcp_f32 v225, v225
    v_lshlrev_b32_sdwa v88, 3, v122 dst_sel:DWORD dst_unused:UNUSED_PAD src0_sel:DWORD src1_sel:WORD_0
    v_lshlrev_b32_sdwa v90, 3, v122 dst_sel:DWORD dst_unused:UNUSED_PAD src0_sel:DWORD src1_sel:WORD_1
    ds_read_b64 v[88:89], v88
    ds_read_b64 v[90:91], v90
    v_lshlrev_b32_sdwa v92, 3, v123 dst_sel:DWORD dst_unused:UNUSED_PAD src0_sel:DWORD src1_sel:WORD_0
    v_lshlrev_b32_sdwa v94, 3, v123 dst_sel:DWORD dst_unused:UNUSED_PAD src0_sel:DWORD src1_sel:WORD_1
    ds_read_b64 v[92:93], v92
    ds_read_b64 v[94:95], v94
    s_add_u32 s20, s20, 0xfffff000
    buffer_load_dwordx4 v[120:123], v71, s[12:15], s20 offen offset:3072 sc1
    s_waitcnt lgkmcnt(8)
    v_smfmac_f32_16x16x64_bf16 v[192:195], v[66:69], v[96:103], v70
    v_exp_f32 v226, v226
    v_pk_mul_f32 v[228:229], v[188:189], v[224:225]
    v_pk_mul_f32 v[230:231], v[160:161], v[160:161]
    v_exp_f32 v227, v227
    v_pk_fma_f32 v[230:231], v[230:231], v[212:213], v[214:215]
    v_pk_mul_f32 v[232:233], v[162:163], v[162:163]
    v_pk_fma_f32 v[226:227], v[226:227], v[220:221], v[220:221]
    v_pk_mul_f32 v[230:231], v[230:231], v[160:161]
    s_waitcnt vmcnt(12)
    v_lshlrev_b32_sdwa v96, 3, v124 dst_sel:DWORD dst_unused:UNUSED_PAD src0_sel:DWORD src1_sel:WORD_0
    v_lshlrev_b32_sdwa v98, 3, v124 dst_sel:DWORD dst_unused:UNUSED_PAD src0_sel:DWORD src1_sel:WORD_1
    ds_read_b64 v[96:97], v96
    ds_read_b64 v[98:99], v98
    v_lshlrev_b32_sdwa v100, 3, v125 dst_sel:DWORD dst_unused:UNUSED_PAD src0_sel:DWORD src1_sel:WORD_0
    v_lshlrev_b32_sdwa v102, 3, v125 dst_sel:DWORD dst_unused:UNUSED_PAD src0_sel:DWORD src1_sel:WORD_1
    ds_read_b64 v[100:101], v100
    ds_read_b64 v[102:103], v102
    buffer_load_dwordx4 v[152:155], v71, s[12:15], s32 offen offset:2048 sc1
    s_waitcnt lgkmcnt(8)
    v_smfmac_f32_16x16x64_bf16 v[192:195], v[66:69], v[104:111], v70
    v_rcp_f32 v226, v226
    v_pk_fma_f32 v[232:233], v[232:233], v[212:213], v[214:215]
    v_rcp_f32 v227, v227
    v_pk_mul_f32 v[232:233], v[232:233], v[162:163]
    v_exp_f32 v230, v230
    v_pk_fma_f32 v[228:229], v[190:191], v[226:227], v[228:229]
    v_exp_f32 v231, v231
    v_add_f32 v228, v228, v229
    v_lshlrev_b32_sdwa v104, 3, v126 dst_sel:DWORD dst_unused:UNUSED_PAD src0_sel:DWORD src1_sel:WORD_0
    v_lshlrev_b32_sdwa v106, 3, v126 dst_sel:DWORD dst_unused:UNUSED_PAD src0_sel:DWORD src1_sel:WORD_1
    ds_read_b64 v[104:105], v104
    ds_read_b64 v[106:107], v106
    v_lshlrev_b32_sdwa v108, 3, v127 dst_sel:DWORD dst_unused:UNUSED_PAD src0_sel:DWORD src1_sel:WORD_0
    v_lshlrev_b32_sdwa v110, 3, v127 dst_sel:DWORD dst_unused:UNUSED_PAD src0_sel:DWORD src1_sel:WORD_1
    ds_read_b64 v[108:109], v108
    ds_read_b64 v[110:111], v110
    s_add_u32 s20, s20, 0xfffc0800
    buffer_load_dwordx4 v[124:127], v71, s[12:15], s20 offen offset:0 sc1
    s_waitcnt lgkmcnt(8)
    v_smfmac_f32_16x16x64_bf16 v[192:195], v[66:69], v[88:95], v70
    v_exp_f32 v232, v232
    v_min_u32 v228, -2, v228
    v_pk_fma_f32 v[230:231], v[230:231], v[218:219], v[218:219]
    v_exp_f32 v233, v233
    buffer_store_dword v228, v76, s[12:15], s35 offen offset:2048 sc1
    v_rcp_f32 v230, v230
    v_pk_fma_f32 v[232:233], v[232:233], v[220:221], v[220:221]
    v_rcp_f32 v231, v231
    s_waitcnt vmcnt(12)
    v_lshlrev_b32_sdwa v88, 3, v48 dst_sel:DWORD dst_unused:UNUSED_PAD src0_sel:DWORD src1_sel:WORD_0
    v_lshlrev_b32_sdwa v90, 3, v48 dst_sel:DWORD dst_unused:UNUSED_PAD src0_sel:DWORD src1_sel:WORD_1
    ds_read_b64 v[88:89], v88
    ds_read_b64 v[90:91], v90
    v_lshlrev_b32_sdwa v92, 3, v49 dst_sel:DWORD dst_unused:UNUSED_PAD src0_sel:DWORD src1_sel:WORD_0
    v_lshlrev_b32_sdwa v94, 3, v49 dst_sel:DWORD dst_unused:UNUSED_PAD src0_sel:DWORD src1_sel:WORD_1
    ds_read_b64 v[92:93], v92
    ds_read_b64 v[94:95], v94
    s_waitcnt lgkmcnt(8)
    v_smfmac_f32_16x16x64_bf16 v[164:167], v[66:69], v[96:103], v70
    v_rcp_f32 v232, v232
    v_pk_mul_f32 v[234:235], v[160:161], v[230:231]
    v_mfma_f32_4x4x4_16b_bf16 v[192:195], v[222:223], v[142:143], v[192:195]
    v_rcp_f32 v233, v233
    v_lshlrev_b32_sdwa v96, 3, v50 dst_sel:DWORD dst_unused:UNUSED_PAD src0_sel:DWORD src1_sel:WORD_0
    v_lshlrev_b32_sdwa v98, 3, v50 dst_sel:DWORD dst_unused:UNUSED_PAD src0_sel:DWORD src1_sel:WORD_1
    ds_read_b64 v[96:97], v96
    ds_read_b64 v[98:99], v98
    v_lshlrev_b32_sdwa v100, 3, v51 dst_sel:DWORD dst_unused:UNUSED_PAD src0_sel:DWORD src1_sel:WORD_0
    v_lshlrev_b32_sdwa v102, 3, v51 dst_sel:DWORD dst_unused:UNUSED_PAD src0_sel:DWORD src1_sel:WORD_1
    ds_read_b64 v[100:101], v100
    ds_read_b64 v[102:103], v102
    s_add_u32 s20, s20, 0x40000
    buffer_load_dwordx4 v[48:51], v71, s[12:15], s20 offen offset:0 sc1
    s_waitcnt lgkmcnt(8)
    v_smfmac_f32_16x16x64_bf16 v[164:167], v[66:69], v[104:111], v70
    v_pk_fma_f32 v[234:235], v[162:163], v[232:233], v[234:235]
    v_pk_mul_f32 v[236:237], v[192:193], v[192:193]
    v_add_f32 v234, v234, v235
    v_pk_fma_f32 v[236:237], v[236:237], v[212:213], v[214:215]
    v_min_u32 v234, -2, v234
    v_pk_mul_f32 v[236:237], v[236:237], v[192:193]
    buffer_store_dword v234, v76, s[12:15], s35 offen offset:1792 sc1
    v_exp_f32 v236, v236
    s_waitcnt vmcnt(13)
    v_lshlrev_b32_sdwa v104, 3, v40 dst_sel:DWORD dst_unused:UNUSED_PAD src0_sel:DWORD src1_sel:WORD_0
    v_lshlrev_b32_sdwa v106, 3, v40 dst_sel:DWORD dst_unused:UNUSED_PAD src0_sel:DWORD src1_sel:WORD_1
    ds_read_b64 v[104:105], v104
    ds_read_b64 v[106:107], v106
    v_lshlrev_b32_sdwa v108, 3, v41 dst_sel:DWORD dst_unused:UNUSED_PAD src0_sel:DWORD src1_sel:WORD_0
    v_lshlrev_b32_sdwa v110, 3, v41 dst_sel:DWORD dst_unused:UNUSED_PAD src0_sel:DWORD src1_sel:WORD_1
    v_lshlrev_b32 v196, 16, v16
    v_and_b32 v197, s23, v16
    v_lshlrev_b32 v198, 16, v17
    v_and_b32 v199, s23, v17
    ds_read_b64 v[108:109], v108
    ds_read_b64 v[110:111], v110
    s_waitcnt lgkmcnt(8)
    v_smfmac_f32_16x16x64_bf16 v[196:199], v[66:69], v[88:95], v70
    v_exp_f32 v237, v237
    v_pk_mul_f32 v[238:239], v[194:195], v[194:195]
    v_mfma_f32_4x4x4_16b_bf16 v[164:167], v[222:223], v[144:145], v[164:167]
    v_pk_fma_f32 v[236:237], v[236:237], v[218:219], v[218:219]
    v_pk_fma_f32 v[238:239], v[238:239], v[212:213], v[214:215]
    v_rcp_f32 v236, v236
    v_pk_mul_f32 v[238:239], v[238:239], v[194:195]
    v_rcp_f32 v237, v237
    v_lshlrev_b32_sdwa v88, 3, v42 dst_sel:DWORD dst_unused:UNUSED_PAD src0_sel:DWORD src1_sel:WORD_0
    v_lshlrev_b32_sdwa v90, 3, v42 dst_sel:DWORD dst_unused:UNUSED_PAD src0_sel:DWORD src1_sel:WORD_1
    ds_read_b64 v[88:89], v88
    ds_read_b64 v[90:91], v90
    v_lshlrev_b32_sdwa v92, 3, v43 dst_sel:DWORD dst_unused:UNUSED_PAD src0_sel:DWORD src1_sel:WORD_0
    v_lshlrev_b32_sdwa v94, 3, v43 dst_sel:DWORD dst_unused:UNUSED_PAD src0_sel:DWORD src1_sel:WORD_1
    ds_read_b64 v[92:93], v92
    ds_read_b64 v[94:95], v94
    s_add_u32 s20, s20, 0x3000
    buffer_load_dwordx4 v[40:43], v71, s[12:15], s20 offen offset:3072 sc1
    s_waitcnt lgkmcnt(8)
    v_smfmac_f32_16x16x64_bf16 v[196:199], v[66:69], v[96:103], v70
    v_exp_f32 v238, v238
    v_pk_mul_f32 v[240:241], v[192:193], v[236:237]
    v_pk_mul_f32 v[242:243], v[164:165], v[164:165]
    v_exp_f32 v239, v239
    v_pk_fma_f32 v[242:243], v[242:243], v[212:213], v[214:215]
    v_pk_mul_f32 v[244:245], v[166:167], v[166:167]
    v_pk_fma_f32 v[238:239], v[238:239], v[220:221], v[220:221]
    v_pk_mul_f32 v[242:243], v[242:243], v[164:165]
    s_waitcnt vmcnt(12)
    v_lshlrev_b32_sdwa v96, 3, v116 dst_sel:DWORD dst_unused:UNUSED_PAD src0_sel:DWORD src1_sel:WORD_0
    v_lshlrev_b32_sdwa v98, 3, v116 dst_sel:DWORD dst_unused:UNUSED_PAD src0_sel:DWORD src1_sel:WORD_1
    ds_read_b64 v[96:97], v96
    ds_read_b64 v[98:99], v98
    v_lshlrev_b32_sdwa v100, 3, v117 dst_sel:DWORD dst_unused:UNUSED_PAD src0_sel:DWORD src1_sel:WORD_0
    v_lshlrev_b32_sdwa v102, 3, v117 dst_sel:DWORD dst_unused:UNUSED_PAD src0_sel:DWORD src1_sel:WORD_1
    ds_read_b64 v[100:101], v100
    ds_read_b64 v[102:103], v102
    buffer_load_dwordx4 v[156:159], v71, s[12:15], s32 offen offset:3072 sc1
    s_waitcnt lgkmcnt(8)
    v_smfmac_f32_16x16x64_bf16 v[196:199], v[66:69], v[104:111], v70
    v_rcp_f32 v238, v238
    v_pk_fma_f32 v[244:245], v[244:245], v[212:213], v[214:215]
    v_rcp_f32 v239, v239
    v_pk_mul_f32 v[244:245], v[244:245], v[166:167]
    v_exp_f32 v242, v242
    v_pk_fma_f32 v[240:241], v[194:195], v[238:239], v[240:241]
    v_exp_f32 v243, v243
    v_add_f32 v240, v240, v241
    v_lshlrev_b32_sdwa v104, 3, v118 dst_sel:DWORD dst_unused:UNUSED_PAD src0_sel:DWORD src1_sel:WORD_0
    v_lshlrev_b32_sdwa v106, 3, v118 dst_sel:DWORD dst_unused:UNUSED_PAD src0_sel:DWORD src1_sel:WORD_1
    ds_read_b64 v[104:105], v104
    ds_read_b64 v[106:107], v106
    v_lshlrev_b32_sdwa v108, 3, v119 dst_sel:DWORD dst_unused:UNUSED_PAD src0_sel:DWORD src1_sel:WORD_0
    v_lshlrev_b32_sdwa v110, 3, v119 dst_sel:DWORD dst_unused:UNUSED_PAD src0_sel:DWORD src1_sel:WORD_1
    ds_read_b64 v[108:109], v108
    ds_read_b64 v[110:111], v110
    s_add_u32 s20, s20, 0xfffc0800
    buffer_load_dwordx4 v[116:119], v71, s[12:15], s20 offen offset:0 sc1
    s_waitcnt lgkmcnt(8)
    v_smfmac_f32_16x16x64_bf16 v[196:199], v[66:69], v[88:95], v70
    v_exp_f32 v244, v244
    v_min_u32 v240, -2, v240
    v_pk_fma_f32 v[242:243], v[242:243], v[218:219], v[218:219]
    v_exp_f32 v245, v245
    buffer_store_dword v240, v76, s[12:15], s35 offen offset:1536 sc1
    v_rcp_f32 v242, v242
    v_pk_fma_f32 v[244:245], v[244:245], v[220:221], v[220:221]
    v_rcp_f32 v243, v243
    s_waitcnt vmcnt(13)
    v_lshlrev_b32_sdwa v88, 3, v36 dst_sel:DWORD dst_unused:UNUSED_PAD src0_sel:DWORD src1_sel:WORD_0
    v_lshlrev_b32_sdwa v90, 3, v36 dst_sel:DWORD dst_unused:UNUSED_PAD src0_sel:DWORD src1_sel:WORD_1
    ds_read_b64 v[88:89], v88
    ds_read_b64 v[90:91], v90
    v_lshlrev_b32_sdwa v92, 3, v37 dst_sel:DWORD dst_unused:UNUSED_PAD src0_sel:DWORD src1_sel:WORD_0
    v_lshlrev_b32_sdwa v94, 3, v37 dst_sel:DWORD dst_unused:UNUSED_PAD src0_sel:DWORD src1_sel:WORD_1
    ds_read_b64 v[92:93], v92
    ds_read_b64 v[94:95], v94
    s_waitcnt lgkmcnt(8)
    v_smfmac_f32_16x16x64_bf16 v[168:171], v[66:69], v[96:103], v70
    v_rcp_f32 v244, v244
    v_pk_mul_f32 v[246:247], v[164:165], v[242:243]
    v_mfma_f32_4x4x4_16b_bf16 v[196:199], v[222:223], v[146:147], v[196:199]
    v_rcp_f32 v245, v245
    v_lshlrev_b32_sdwa v96, 3, v38 dst_sel:DWORD dst_unused:UNUSED_PAD src0_sel:DWORD src1_sel:WORD_0
    v_lshlrev_b32_sdwa v98, 3, v38 dst_sel:DWORD dst_unused:UNUSED_PAD src0_sel:DWORD src1_sel:WORD_1
    ds_read_b64 v[96:97], v96
    ds_read_b64 v[98:99], v98
    v_lshlrev_b32_sdwa v100, 3, v39 dst_sel:DWORD dst_unused:UNUSED_PAD src0_sel:DWORD src1_sel:WORD_0
    v_lshlrev_b32_sdwa v102, 3, v39 dst_sel:DWORD dst_unused:UNUSED_PAD src0_sel:DWORD src1_sel:WORD_1
    ds_read_b64 v[100:101], v100
    ds_read_b64 v[102:103], v102
    s_add_u32 s20, s20, 0x40000
    buffer_load_dwordx4 v[36:39], v71, s[12:15], s20 offen offset:0 sc1
    s_waitcnt lgkmcnt(8)
    v_smfmac_f32_16x16x64_bf16 v[168:171], v[66:69], v[104:111], v70
    v_pk_fma_f32 v[246:247], v[166:167], v[244:245], v[246:247]
    v_pk_mul_f32 v[248:249], v[196:197], v[196:197]
    v_add_f32 v246, v246, v247
    v_pk_fma_f32 v[248:249], v[248:249], v[212:213], v[214:215]
    v_min_u32 v246, -2, v246
    v_pk_mul_f32 v[248:249], v[248:249], v[196:197]
    buffer_store_dword v246, v76, s[12:15], s35 offen offset:1280 sc1
    v_exp_f32 v248, v248
    s_waitcnt vmcnt(13)
    v_lshlrev_b32_sdwa v104, 3, v44 dst_sel:DWORD dst_unused:UNUSED_PAD src0_sel:DWORD src1_sel:WORD_0
    v_lshlrev_b32_sdwa v106, 3, v44 dst_sel:DWORD dst_unused:UNUSED_PAD src0_sel:DWORD src1_sel:WORD_1
    ds_read_b64 v[104:105], v104
    ds_read_b64 v[106:107], v106
    v_lshlrev_b32_sdwa v108, 3, v45 dst_sel:DWORD dst_unused:UNUSED_PAD src0_sel:DWORD src1_sel:WORD_0
    v_lshlrev_b32_sdwa v110, 3, v45 dst_sel:DWORD dst_unused:UNUSED_PAD src0_sel:DWORD src1_sel:WORD_1
    v_lshlrev_b32 v200, 16, v12
    v_and_b32 v201, s23, v12
    v_lshlrev_b32 v202, 16, v13
    v_and_b32 v203, s23, v13
    ds_read_b64 v[108:109], v108
    ds_read_b64 v[110:111], v110
    s_waitcnt lgkmcnt(8)
    v_smfmac_f32_16x16x64_bf16 v[200:203], v[66:69], v[88:95], v70
    v_exp_f32 v249, v249
    v_pk_mul_f32 v[250:251], v[198:199], v[198:199]
    v_mfma_f32_4x4x4_16b_bf16 v[168:171], v[222:223], v[148:149], v[168:171]
    v_pk_fma_f32 v[248:249], v[248:249], v[218:219], v[218:219]
    v_pk_fma_f32 v[250:251], v[250:251], v[212:213], v[214:215]
    v_rcp_f32 v248, v248
    v_pk_mul_f32 v[250:251], v[250:251], v[198:199]
    v_rcp_f32 v249, v249
    v_lshlrev_b32_sdwa v88, 3, v46 dst_sel:DWORD dst_unused:UNUSED_PAD src0_sel:DWORD src1_sel:WORD_0
    v_lshlrev_b32_sdwa v90, 3, v46 dst_sel:DWORD dst_unused:UNUSED_PAD src0_sel:DWORD src1_sel:WORD_1
    ds_read_b64 v[88:89], v88
    ds_read_b64 v[90:91], v90
    v_lshlrev_b32_sdwa v92, 3, v47 dst_sel:DWORD dst_unused:UNUSED_PAD src0_sel:DWORD src1_sel:WORD_0
    v_lshlrev_b32_sdwa v94, 3, v47 dst_sel:DWORD dst_unused:UNUSED_PAD src0_sel:DWORD src1_sel:WORD_1
    ds_read_b64 v[92:93], v92
    ds_read_b64 v[94:95], v94
    s_waitcnt lgkmcnt(8)
    v_smfmac_f32_16x16x64_bf16 v[200:203], v[66:69], v[96:103], v70
    v_exp_f32 v250, v250
    v_pk_mul_f32 v[252:253], v[196:197], v[248:249]
    v_pk_mul_f32 v[224:225], v[168:169], v[168:169]
    v_exp_f32 v251, v251
    v_pk_fma_f32 v[224:225], v[224:225], v[212:213], v[214:215]
    v_pk_mul_f32 v[226:227], v[170:171], v[170:171]
    v_pk_fma_f32 v[250:251], v[250:251], v[220:221], v[220:221]
    v_pk_mul_f32 v[224:225], v[224:225], v[168:169]
    s_waitcnt vmcnt(11)
    v_lshlrev_b32_sdwa v96, 3, v120 dst_sel:DWORD dst_unused:UNUSED_PAD src0_sel:DWORD src1_sel:WORD_0
    v_lshlrev_b32_sdwa v98, 3, v120 dst_sel:DWORD dst_unused:UNUSED_PAD src0_sel:DWORD src1_sel:WORD_1
    ds_read_b64 v[96:97], v96
    ds_read_b64 v[98:99], v98
    v_lshlrev_b32_sdwa v100, 3, v121 dst_sel:DWORD dst_unused:UNUSED_PAD src0_sel:DWORD src1_sel:WORD_0
    v_lshlrev_b32_sdwa v102, 3, v121 dst_sel:DWORD dst_unused:UNUSED_PAD src0_sel:DWORD src1_sel:WORD_1
    ds_read_b64 v[100:101], v100
    ds_read_b64 v[102:103], v102
    s_waitcnt lgkmcnt(8)
    v_smfmac_f32_16x16x64_bf16 v[200:203], v[66:69], v[104:111], v70
    v_rcp_f32 v250, v250
    v_pk_fma_f32 v[226:227], v[226:227], v[212:213], v[214:215]
    v_rcp_f32 v251, v251
    v_pk_mul_f32 v[226:227], v[226:227], v[170:171]
    v_exp_f32 v224, v224
    v_pk_fma_f32 v[252:253], v[198:199], v[250:251], v[252:253]
    v_exp_f32 v225, v225
    v_add_f32 v252, v252, v253
    v_lshlrev_b32_sdwa v104, 3, v122 dst_sel:DWORD dst_unused:UNUSED_PAD src0_sel:DWORD src1_sel:WORD_0
    v_lshlrev_b32_sdwa v106, 3, v122 dst_sel:DWORD dst_unused:UNUSED_PAD src0_sel:DWORD src1_sel:WORD_1
    ds_read_b64 v[104:105], v104
    ds_read_b64 v[106:107], v106
    v_lshlrev_b32_sdwa v108, 3, v123 dst_sel:DWORD dst_unused:UNUSED_PAD src0_sel:DWORD src1_sel:WORD_0
    v_lshlrev_b32_sdwa v110, 3, v123 dst_sel:DWORD dst_unused:UNUSED_PAD src0_sel:DWORD src1_sel:WORD_1
    ds_read_b64 v[108:109], v108
    ds_read_b64 v[110:111], v110
    s_waitcnt lgkmcnt(8)
    v_smfmac_f32_16x16x64_bf16 v[200:203], v[66:69], v[88:95], v70
    v_exp_f32 v226, v226
    v_min_u32 v252, -2, v252
    v_pk_fma_f32 v[224:225], v[224:225], v[218:219], v[218:219]
    v_exp_f32 v227, v227
    buffer_store_dword v252, v76, s[12:15], s35 offen offset:1024 sc1
    v_rcp_f32 v224, v224
    v_pk_fma_f32 v[226:227], v[226:227], v[220:221], v[220:221]
    v_rcp_f32 v225, v225
    s_waitcnt vmcnt(10)
    v_lshlrev_b32_sdwa v88, 3, v124 dst_sel:DWORD dst_unused:UNUSED_PAD src0_sel:DWORD src1_sel:WORD_0
    v_lshlrev_b32_sdwa v90, 3, v124 dst_sel:DWORD dst_unused:UNUSED_PAD src0_sel:DWORD src1_sel:WORD_1
    ds_read_b64 v[88:89], v88
    ds_read_b64 v[90:91], v90
    v_lshlrev_b32_sdwa v92, 3, v125 dst_sel:DWORD dst_unused:UNUSED_PAD src0_sel:DWORD src1_sel:WORD_0
    v_lshlrev_b32_sdwa v94, 3, v125 dst_sel:DWORD dst_unused:UNUSED_PAD src0_sel:DWORD src1_sel:WORD_1
    ds_read_b64 v[92:93], v92
    ds_read_b64 v[94:95], v94
    s_waitcnt lgkmcnt(8)
    v_smfmac_f32_16x16x64_bf16 v[172:175], v[66:69], v[96:103], v70
    s_setprio 1
    v_rcp_f32 v226, v226
    v_pk_mul_f32 v[228:229], v[168:169], v[224:225]
    v_mfma_f32_4x4x4_16b_bf16 v[200:203], v[222:223], v[150:151], v[200:203]
    v_rcp_f32 v227, v227
    v_lshlrev_b32_sdwa v96, 3, v126 dst_sel:DWORD dst_unused:UNUSED_PAD src0_sel:DWORD src1_sel:WORD_0
    v_lshlrev_b32_sdwa v98, 3, v126 dst_sel:DWORD dst_unused:UNUSED_PAD src0_sel:DWORD src1_sel:WORD_1
    ds_read_b64 v[96:97], v96
    ds_read_b64 v[98:99], v98
    v_lshlrev_b32_sdwa v100, 3, v127 dst_sel:DWORD dst_unused:UNUSED_PAD src0_sel:DWORD src1_sel:WORD_0
    v_lshlrev_b32_sdwa v102, 3, v127 dst_sel:DWORD dst_unused:UNUSED_PAD src0_sel:DWORD src1_sel:WORD_1
    ds_read_b64 v[100:101], v100
    ds_read_b64 v[102:103], v102
    s_waitcnt lgkmcnt(8)
    v_smfmac_f32_16x16x64_bf16 v[172:175], v[66:69], v[104:111], v70
    v_pk_fma_f32 v[228:229], v[170:171], v[226:227], v[228:229]
    v_pk_mul_f32 v[230:231], v[200:201], v[200:201]
    v_add_f32 v228, v228, v229
    v_pk_fma_f32 v[230:231], v[230:231], v[212:213], v[214:215]
    v_min_u32 v228, -2, v228
    v_pk_mul_f32 v[230:231], v[230:231], v[200:201]
    buffer_store_dword v228, v76, s[12:15], s35 offen offset:768 sc1
    v_exp_f32 v230, v230
    s_waitcnt vmcnt(9)
    v_lshlrev_b32_sdwa v104, 3, v48 dst_sel:DWORD dst_unused:UNUSED_PAD src0_sel:DWORD src1_sel:WORD_0
    v_lshlrev_b32_sdwa v106, 3, v48 dst_sel:DWORD dst_unused:UNUSED_PAD src0_sel:DWORD src1_sel:WORD_1
    ds_read_b64 v[104:105], v104
    ds_read_b64 v[106:107], v106
    v_lshlrev_b32_sdwa v108, 3, v49 dst_sel:DWORD dst_unused:UNUSED_PAD src0_sel:DWORD src1_sel:WORD_0
    v_lshlrev_b32_sdwa v110, 3, v49 dst_sel:DWORD dst_unused:UNUSED_PAD src0_sel:DWORD src1_sel:WORD_1
    v_lshlrev_b32 v204, 16, v8
    v_and_b32 v205, s23, v8
    v_lshlrev_b32 v206, 16, v9
    v_and_b32 v207, s23, v9
    ds_read_b64 v[108:109], v108
    ds_read_b64 v[110:111], v110
    s_waitcnt lgkmcnt(8)
    v_smfmac_f32_16x16x64_bf16 v[204:207], v[66:69], v[88:95], v70
    v_exp_f32 v231, v231
    v_pk_mul_f32 v[232:233], v[202:203], v[202:203]
    v_mfma_f32_4x4x4_16b_bf16 v[172:175], v[222:223], v[152:153], v[172:175]
    v_pk_fma_f32 v[230:231], v[230:231], v[218:219], v[218:219]
    v_pk_fma_f32 v[232:233], v[232:233], v[212:213], v[214:215]
    v_rcp_f32 v230, v230
    v_pk_mul_f32 v[232:233], v[232:233], v[202:203]
    v_rcp_f32 v231, v231
    v_lshlrev_b32_sdwa v88, 3, v50 dst_sel:DWORD dst_unused:UNUSED_PAD src0_sel:DWORD src1_sel:WORD_0
    v_lshlrev_b32_sdwa v90, 3, v50 dst_sel:DWORD dst_unused:UNUSED_PAD src0_sel:DWORD src1_sel:WORD_1
    ds_read_b64 v[88:89], v88
    ds_read_b64 v[90:91], v90
    v_lshlrev_b32_sdwa v92, 3, v51 dst_sel:DWORD dst_unused:UNUSED_PAD src0_sel:DWORD src1_sel:WORD_0
    v_lshlrev_b32_sdwa v94, 3, v51 dst_sel:DWORD dst_unused:UNUSED_PAD src0_sel:DWORD src1_sel:WORD_1
    ds_read_b64 v[92:93], v92
    ds_read_b64 v[94:95], v94
    s_waitcnt lgkmcnt(8)
    v_smfmac_f32_16x16x64_bf16 v[204:207], v[66:69], v[96:103], v70
    v_exp_f32 v232, v232
    v_pk_mul_f32 v[234:235], v[200:201], v[230:231]
    v_pk_mul_f32 v[236:237], v[172:173], v[172:173]
    v_exp_f32 v233, v233
    v_pk_fma_f32 v[236:237], v[236:237], v[212:213], v[214:215]
    v_pk_mul_f32 v[238:239], v[174:175], v[174:175]
    v_pk_fma_f32 v[232:233], v[232:233], v[220:221], v[220:221]
    v_pk_mul_f32 v[236:237], v[236:237], v[172:173]
    s_waitcnt vmcnt(7)
    v_lshlrev_b32_sdwa v96, 3, v40 dst_sel:DWORD dst_unused:UNUSED_PAD src0_sel:DWORD src1_sel:WORD_0
    v_lshlrev_b32_sdwa v98, 3, v40 dst_sel:DWORD dst_unused:UNUSED_PAD src0_sel:DWORD src1_sel:WORD_1
    ds_read_b64 v[96:97], v96
    ds_read_b64 v[98:99], v98
    v_lshlrev_b32_sdwa v100, 3, v41 dst_sel:DWORD dst_unused:UNUSED_PAD src0_sel:DWORD src1_sel:WORD_0
    v_lshlrev_b32_sdwa v102, 3, v41 dst_sel:DWORD dst_unused:UNUSED_PAD src0_sel:DWORD src1_sel:WORD_1
    ds_read_b64 v[100:101], v100
    ds_read_b64 v[102:103], v102
    s_waitcnt lgkmcnt(8)
    v_smfmac_f32_16x16x64_bf16 v[204:207], v[66:69], v[104:111], v70
    buffer_load_dword v72, v76, s[52:55], 0 offen offset:32 sc1
    buffer_load_short_d16_hi v73, v79, s[56:59], 0 offen
    buffer_load_ushort v81, v78, s[60:63], s68 offen
    buffer_load_dword v82, v79, s[12:15], s69 offen sc1
    v_rcp_f32 v232, v232
    v_pk_fma_f32 v[238:239], v[238:239], v[212:213], v[214:215]
    v_rcp_f32 v233, v233
    v_pk_mul_f32 v[238:239], v[238:239], v[174:175]
    v_lshlrev_b32_sdwa v104, 3, v42 dst_sel:DWORD dst_unused:UNUSED_PAD src0_sel:DWORD src1_sel:WORD_0
    v_lshlrev_b32_sdwa v106, 3, v42 dst_sel:DWORD dst_unused:UNUSED_PAD src0_sel:DWORD src1_sel:WORD_1
    ds_read_b64 v[104:105], v104
    ds_read_b64 v[106:107], v106
    v_lshlrev_b32_sdwa v108, 3, v43 dst_sel:DWORD dst_unused:UNUSED_PAD src0_sel:DWORD src1_sel:WORD_0
    v_lshlrev_b32_sdwa v110, 3, v43 dst_sel:DWORD dst_unused:UNUSED_PAD src0_sel:DWORD src1_sel:WORD_1
    ds_read_b64 v[108:109], v108
    ds_read_b64 v[110:111], v110
    s_waitcnt lgkmcnt(8)
    v_smfmac_f32_16x16x64_bf16 v[204:207], v[66:69], v[88:95], v70
    v_exp_f32 v236, v236
    v_pk_fma_f32 v[234:235], v[202:203], v[232:233], v[234:235]
    v_exp_f32 v237, v237
    v_add_f32 v234, v234, v235
    v_exp_f32 v238, v238
    v_min_u32 v234, -2, v234
    v_pk_fma_f32 v[236:237], v[236:237], v[218:219], v[218:219]
    v_exp_f32 v239, v239
    s_waitcnt vmcnt(9)
    v_lshlrev_b32_sdwa v88, 3, v116 dst_sel:DWORD dst_unused:UNUSED_PAD src0_sel:DWORD src1_sel:WORD_0
    v_lshlrev_b32_sdwa v90, 3, v116 dst_sel:DWORD dst_unused:UNUSED_PAD src0_sel:DWORD src1_sel:WORD_1
    ds_read_b64 v[88:89], v88
    ds_read_b64 v[90:91], v90
    v_lshlrev_b32_sdwa v92, 3, v117 dst_sel:DWORD dst_unused:UNUSED_PAD src0_sel:DWORD src1_sel:WORD_0
    v_lshlrev_b32_sdwa v94, 3, v117 dst_sel:DWORD dst_unused:UNUSED_PAD src0_sel:DWORD src1_sel:WORD_1
    ds_read_b64 v[92:93], v92
    ds_read_b64 v[94:95], v94
    s_waitcnt lgkmcnt(8)
    v_smfmac_f32_16x16x64_bf16 v[176:179], v[66:69], v[96:103], v70
    v_rcp_f32 v236, v236
    buffer_store_dword v234, v76, s[12:15], s35 offen offset:512 sc1
    v_pk_fma_f32 v[238:239], v[238:239], v[220:221], v[220:221]
    v_rcp_f32 v237, v237
    v_mfma_f32_4x4x4_16b_bf16 v[204:207], v[222:223], v[154:155], v[204:207]
    v_rcp_f32 v238, v238
    v_pk_mul_f32 v[240:241], v[172:173], v[236:237]
    v_rcp_f32 v239, v239
    v_lshlrev_b32_sdwa v96, 3, v118 dst_sel:DWORD dst_unused:UNUSED_PAD src0_sel:DWORD src1_sel:WORD_0
    v_lshlrev_b32_sdwa v98, 3, v118 dst_sel:DWORD dst_unused:UNUSED_PAD src0_sel:DWORD src1_sel:WORD_1
    ds_read_b64 v[96:97], v96
    ds_read_b64 v[98:99], v98
    v_lshlrev_b32_sdwa v100, 3, v119 dst_sel:DWORD dst_unused:UNUSED_PAD src0_sel:DWORD src1_sel:WORD_0
    v_lshlrev_b32_sdwa v102, 3, v119 dst_sel:DWORD dst_unused:UNUSED_PAD src0_sel:DWORD src1_sel:WORD_1
    ds_read_b64 v[100:101], v100
    ds_read_b64 v[102:103], v102
    s_waitcnt lgkmcnt(8)
    v_smfmac_f32_16x16x64_bf16 v[176:179], v[66:69], v[104:111], v70
    v_pk_fma_f32 v[240:241], v[174:175], v[238:239], v[240:241]
    v_pk_mul_f32 v[242:243], v[204:205], v[204:205]
    v_add_f32 v240, v240, v241
    v_pk_fma_f32 v[242:243], v[242:243], v[212:213], v[214:215]
    v_min_u32 v240, -2, v240
    v_pk_mul_f32 v[242:243], v[242:243], v[204:205]
    buffer_store_dword v240, v76, s[12:15], s35 offen offset:256 sc1
    v_exp_f32 v242, v242
    s_waitcnt vmcnt(9)
    v_lshlrev_b32_sdwa v104, 3, v36 dst_sel:DWORD dst_unused:UNUSED_PAD src0_sel:DWORD src1_sel:WORD_0
    v_lshlrev_b32_sdwa v106, 3, v36 dst_sel:DWORD dst_unused:UNUSED_PAD src0_sel:DWORD src1_sel:WORD_1
    ds_read_b64 v[104:105], v104
    ds_read_b64 v[106:107], v106
    v_lshlrev_b32_sdwa v108, 3, v37 dst_sel:DWORD dst_unused:UNUSED_PAD src0_sel:DWORD src1_sel:WORD_0
    v_lshlrev_b32_sdwa v110, 3, v37 dst_sel:DWORD dst_unused:UNUSED_PAD src0_sel:DWORD src1_sel:WORD_1
    v_lshlrev_b32 v208, 16, v4
    v_and_b32 v209, s23, v4
    v_lshlrev_b32 v210, 16, v5
    v_and_b32 v211, s23, v5
    ds_read_b64 v[108:109], v108
    ds_read_b64 v[110:111], v110
    s_waitcnt lgkmcnt(8)
    v_smfmac_f32_16x16x64_bf16 v[208:211], v[66:69], v[88:95], v70
    s_setprio 0
    v_exp_f32 v243, v243
    v_pk_mul_f32 v[244:245], v[206:207], v[206:207]
    v_mfma_f32_4x4x4_16b_bf16 v[176:179], v[222:223], v[156:157], v[176:179]
    v_pk_fma_f32 v[242:243], v[242:243], v[218:219], v[218:219]
    v_pk_fma_f32 v[244:245], v[244:245], v[212:213], v[214:215]
    v_rcp_f32 v242, v242
    v_pk_mul_f32 v[244:245], v[244:245], v[206:207]
    v_rcp_f32 v243, v243
    v_lshlrev_b32_sdwa v88, 3, v38 dst_sel:DWORD dst_unused:UNUSED_PAD src0_sel:DWORD src1_sel:WORD_0
    v_lshlrev_b32_sdwa v90, 3, v38 dst_sel:DWORD dst_unused:UNUSED_PAD src0_sel:DWORD src1_sel:WORD_1
    ds_read_b64 v[88:89], v88
    ds_read_b64 v[90:91], v90
    v_lshlrev_b32_sdwa v92, 3, v39 dst_sel:DWORD dst_unused:UNUSED_PAD src0_sel:DWORD src1_sel:WORD_0
    v_lshlrev_b32_sdwa v94, 3, v39 dst_sel:DWORD dst_unused:UNUSED_PAD src0_sel:DWORD src1_sel:WORD_1
    ds_read_b64 v[92:93], v92
    ds_read_b64 v[94:95], v94
    s_waitcnt lgkmcnt(8)
    v_smfmac_f32_16x16x64_bf16 v[208:211], v[66:69], v[96:103], v70
    v_exp_f32 v244, v244
    v_pk_mul_f32 v[246:247], v[204:205], v[242:243]
    v_pk_mul_f32 v[248:249], v[176:177], v[176:177]
    v_exp_f32 v245, v245
    v_pk_fma_f32 v[248:249], v[248:249], v[212:213], v[214:215]
    v_pk_mul_f32 v[250:251], v[178:179], v[178:179]
    v_pk_fma_f32 v[244:245], v[244:245], v[220:221], v[220:221]
    v_pk_mul_f32 v[248:249], v[248:249], v[176:177]
    s_waitcnt lgkmcnt(4)
    v_smfmac_f32_16x16x64_bf16 v[208:211], v[66:69], v[104:111], v70
    v_rcp_f32 v244, v244
    v_pk_fma_f32 v[250:251], v[250:251], v[212:213], v[214:215]
    v_rcp_f32 v245, v245
    v_pk_mul_f32 v[250:251], v[250:251], v[178:179]
    v_exp_f32 v248, v248
    v_pk_fma_f32 v[246:247], v[206:207], v[244:245], v[246:247]
    v_exp_f32 v249, v249
    v_add_f32 v246, v246, v247
    s_waitcnt lgkmcnt(0)
    v_smfmac_f32_16x16x64_bf16 v[208:211], v[66:69], v[88:95], v70
    v_exp_f32 v250, v250
    v_min_u32 v246, -2, v246
    v_pk_fma_f32 v[248:249], v[248:249], v[218:219], v[218:219]
    v_exp_f32 v251, v251
    buffer_store_dword v246, v76, s[12:15], s35 offen offset:0 sc1
    v_rcp_f32 v248, v248
    v_pk_fma_f32 v[250:251], v[250:251], v[220:221], v[220:221]
    v_rcp_f32 v249, v249
    v_mfma_f32_4x4x4_16b_bf16 v[208:211], v[222:223], v[158:159], v[208:211]
    v_rcp_f32 v250, v250
    v_pk_mul_f32 v[252:253], v[176:177], v[248:249]
    v_rcp_f32 v251, v251
    s_nop 0
    s_nop 0
    v_pk_fma_f32 v[252:253], v[178:179], v[250:251], v[252:253]
    v_pk_mul_f32 v[224:225], v[208:209], v[208:209]
    v_add_f32 v252, v252, v253
    v_pk_fma_f32 v[224:225], v[224:225], v[212:213], v[214:215]
    v_min_u32 v252, -2, v252
    v_pk_mul_f32 v[224:225], v[224:225], v[208:209]
    buffer_store_dword v252, v76, s[12:15], s35 offen offset:3840 sc1
    v_exp_f32 v224, v224
    v_pk_mul_f32 v[226:227], v[210:211], v[210:211]
    v_exp_f32 v225, v225
    v_pk_fma_f32 v[226:227], v[226:227], v[212:213], v[214:215]
    s_nop 0
    v_pk_fma_f32 v[224:225], v[224:225], v[218:219], v[218:219]
    v_pk_mul_f32 v[226:227], v[226:227], v[210:211]
    v_rcp_f32 v224, v224
    v_rcp_f32 v225, v225
    v_exp_f32 v226, v226
    v_exp_f32 v227, v227
    v_pk_mul_f32 v[228:229], v[208:209], v[224:225]
    s_nop 0
    v_pk_fma_f32 v[226:227], v[226:227], v[220:221], v[220:221]
    s_nop 0
    v_rcp_f32 v226, v226
    v_rcp_f32 v227, v227
    s_nop 0
    s_nop 0
    v_pk_fma_f32 v[228:229], v[210:211], v[226:227], v[228:229]
    s_nop 0
    v_add_f32 v228, v228, v229
    s_nop 0
    v_min_u32 v228, -2, v228
    s_nop 0
    buffer_store_dword v228, v76, s[12:15], s35 offen offset:3584 sc1
    s_waitcnt vmcnt(5)

    v_cmp_ne_u32 vcc, 128, v72
    s_and_b32 s44, vcc_hi, 0x1
    s_and_b32 s45, vcc_lo, 0x1
    s_or_b32 s45, s45, s44
    s_cbranch_scc1 k1_kernel_rslow

k1_kernel_rjob:

    s_lshl_b32 s67, s64, 8
    s_add_u32 s68, s67, 29360128
    s_add_u32 s69, s68, 65536
    s_add_u32 s67, s67, 20971520

k1_kernel_rgrp:

    s_add_u32 s70, s67, s65
    s_add_u32 s71, s70, 262144
    s_add_u32 s72, s70, 524288
    s_add_u32 s73, s70, 786432
    s_add_u32 s65, s65, 1048576

    buffer_load_dwordx4 v[0:3], v74, s[12:15], s70 offen sc1
    buffer_load_dwordx4 v[4:7], v74, s[12:15], s71 offen sc1
    buffer_load_dwordx4 v[8:11], v74, s[12:15], s72 offen sc1
    buffer_load_dwordx4 v[12:15], v74, s[12:15], s73 offen sc1
    buffer_load_dword v16, v75, s[12:15], s68 offen sc1
    buffer_load_dword v17, v75, s[12:15], s69 offen sc1
    s_branch k1_kernel_rchk
k1_kernel_rpoll:
    s_mov_b64 exec, s[74:75]
    s_cbranch_execz k1_kernel_rsk0
    buffer_load_dwordx4 v[0:3], v74, s[12:15], s70 offen sc1
k1_kernel_rsk0:
    s_mov_b64 exec, s[76:77]
    s_cbranch_execz k1_kernel_rsk1
    buffer_load_dwordx4 v[4:7], v74, s[12:15], s71 offen sc1
k1_kernel_rsk1:
    s_mov_b64 exec, s[78:79]
    s_cbranch_execz k1_kernel_rsk2
    buffer_load_dwordx4 v[8:11], v74, s[12:15], s72 offen sc1
k1_kernel_rsk2:
    s_mov_b64 exec, s[80:81]
    s_cbranch_execz k1_kernel_rsk3
    buffer_load_dwordx4 v[12:15], v74, s[12:15], s73 offen sc1
k1_kernel_rsk3:
    s_mov_b64 exec, -1
k1_kernel_rchk:
    s_waitcnt vmcnt(0)
k1_kernel_rchk0:
    v_max3_u32 v20, v0, v1, v2
    v_max3_u32 v21, v4, v5, v6
    v_max3_u32 v22, v8, v9, v10
    v_max3_u32 v23, v12, v13, v14
    v_max_u32 v20, v20, v3
    v_max_u32 v21, v21, v7
    v_max_u32 v22, v22, v11
    v_max_u32 v23, v23, v15
    v_cmp_eq_u32 s[74:75], -1, v20
    v_cmp_eq_u32 s[76:77], -1, v21
    v_cmp_eq_u32 s[78:79], -1, v22
    v_cmp_eq_u32 s[80:81], -1, v23

    v_pk_add_f32 v[26:27], v[0:1], v[4:5]
    v_pk_add_f32 v[28:29], v[2:3], v[6:7]
    v_pk_add_f32 v[30:31], v[8:9], v[12:13]
    v_pk_add_f32 v[32:33], v[10:11], v[14:15]
    s_or_b64 s[82:83], s[74:75], s[76:77]
    s_or_b64 s[84:85], s[78:79], s[80:81]
    v_pk_add_f32 v[26:27], v[26:27], v[30:31]
    v_pk_add_f32 v[28:29], v[28:29], v[32:33]
    s_or_b64 s[82:83], s[82:83], s[84:85]
    s_cbranch_scc1 k1_kernel_rpoll
    v_permlane32_swap_b32 v26, v28
    v_permlane32_swap_b32 v27, v29
    s_cmp_lt_u32 s65, s66
    s_nop 0
    v_pk_add_f32 v[26:27], v[26:27], v[28:29]
    s_nop 1
    v_permlane16_swap_b32 v26, v27
    s_nop 1
    v_add_f32 v26, v26, v27
    v_add_f32 v79, v79, v26
    s_cbranch_scc1 k1_kernel_rgrp
    s_cmp_lg_u32 s43, 0
    s_cbranch_scc1 k1_kernel_rpn
    ds_write_b32 v77, v79
    v_add_u32 v21, 0x10000, v77
    s_cmp_lg_u32 s3, 0
    s_waitcnt lgkmcnt(0)
    s_barrier
    s_cbranch_scc1 k1_kernel_rend

    ds_read2st64_b32 v[40:41], v77 offset0:0 offset1:64
    ds_read2st64_b32 v[42:43], v77 offset0:128 offset1:192
    ds_read2st64_b32 v[44:45], v21 offset0:0 offset1:64
    ds_read2st64_b32 v[46:47], v21 offset0:128 offset1:192

    s_waitcnt lgkmcnt(2)
    v_pk_add_f32 v[26:27], v[40:41], v[42:43]
    v_max3_u32 v20, v41, v42, v43
    s_waitcnt lgkmcnt(0)
    v_pk_add_f32 v[28:29], v[44:45], v[46:47]
    v_max3_u32 v20, v20, v44, v45
    v_pk_add_f32 v[26:27], v[26:27], v[28:29]
    v_max3_u32 v20, v20, v46, v47
    v_add_f32 v79, v26, v27
    v_cmp_eq_u32 vcc, -1, v20
    s_cbranch_vccnz k1_kernel_rnext

k1_kernel_rpn:

    v_max_u32 v20, v16, v17
    v_add_f32 v21, v16, v17
    v_cmp_eq_u32 vcc, -1, v20
    v_cvt_pk_bf16_f32 v21, v79, v21
    s_cbranch_vccnz k1_kernel_rpn2
    v_lshlrev_b32 v22, 16, v21
    v_and_b32 v21, 0xffff0000, v21
    v_add_f32 v22, v22, v73
    v_cvt_pk_bf16_f32 v22, v22, v22
    v_lshlrev_b32 v22, 16, v22
    v_add_f32 v22, v22, v21
    s_lshl_b32 s45, s64, 7
    v_cvt_pk_bf16_f32 v22, v22, v22
    buffer_store_short v22, v78, s[60:63], s45 offen

k1_kernel_rnext:

    v_cmp_ne_u32 vcc, 0, v72
    s_and_b32 s45, vcc_lo, 0xff00
    s_cbranch_scc1 k1_kernel_rmore

k1_kernel_rend:
    s_endpgm
k1_kernel_rpn2:
    buffer_load_dword v16, v75, s[12:15], s68 offen sc1
    buffer_load_dword v17, v75, s[12:15], s69 offen sc1
    s_waitcnt vmcnt(0)
    s_branch k1_kernel_rpn
k1_kernel_rmore:

    s_ff1_i32_b32 s45, s45
    s_mov_b32 s43, 1
    s_mov_b32 s65, 0
    s_mov_b32 s66, 8388608
    v_readlane_b32 s44, v72, s45
    v_mov_b32 v79, 0
    s_mov_b32 m0, s45
    s_ff1_i32_b32 s64, s44
    s_bitset0_b32 s44, s64
    s_sub_u32 s45, s45, 8
    s_lshl_b32 s45, s45, 5
    s_add_u32 s64, s64, s45
    v_writelane_b32 v72, s44, m0
    s_branch k1_kernel_rjob

k1_kernel_rslow:
    s_lshl_b32 s65, s3, 20
    buffer_load_dword v72, v76, s[52:55], 0 offen offset:32 sc1
    s_waitcnt vmcnt(0)

    v_cmp_ne_u32 vcc, 128, v72
    s_and_b32 s44, vcc_hi, 0x1
    s_and_b32 s45, vcc_lo, 0x1
    s_or_b32 s45, s45, s44
    s_cbranch_scc0 k1_kernel_rjob

    s_add_u32 s42, s42, 1
    s_cmp_lt_u32 s42, 200
    s_cbranch_scc1 k1_kernel_rslow
    s_lshl_b32 s44, 1, s64
    s_lshr_b32 s45, s64, 5
    s_lshl_b32 s45, s45, 2
    v_mov_b32 v20, s44
    s_mov_b64 exec, 1
    buffer_atomic_or v20, v76, s[52:55], s45 offen offset:64 sc0
    s_mov_b64 exec, -1
    s_waitcnt vmcnt(0)
    buffer_load_dword v72, v76, s[52:55], 0 offen offset:32 sc1
    s_waitcnt vmcnt(0)

    v_cmp_ne_u32 vcc, 128, v72
    s_and_b32 s44, vcc_hi, 0x1
    s_and_b32 s45, vcc_lo, 0x1
    s_or_b32 s45, s45, s44
    s_cbranch_scc0 k1_kernel_rjob

    v_mov_b32 v20, -1
    ds_write_b32 v77, v20
    s_waitcnt lgkmcnt(0)
    s_endpgm

k1_kernel_xw0:

    buffer_load_dword v35, off, s[12:15], s47 sc1
    s_waitcnt vmcnt(0)
    v_readfirstlane_b32 s44, v35
    s_cmp_le_u32 s44, 0
    s_cbranch_scc1 k1_kernel_xw0
    s_branch k1_kernel_xb0

k1_kernel_xw1:

    buffer_load_dword v35, off, s[12:15], s47 sc1
    s_waitcnt vmcnt(0)
    v_readfirstlane_b32 s44, v35
    s_cmp_le_u32 s44, 1
    s_cbranch_scc1 k1_kernel_xw1
    s_branch k1_kernel_xb1

k1_kernel_solo1:
    s_mov_b32 s48, 1
    s_add_u32 s16, s16, 33554432
    s_add_u32 s46, s46, 33554432
    s_mov_b32 s18, s16
    s_mov_b32 s47, s46
    s_xor_b32 s49, s34, 1
    s_branch k1_kernel_solo3
k1_kernel_solo2:
    s_mov_b32 s48, 2
    s_waitcnt vmcnt(0)
    v_mov_b32 v0, 2
    buffer_store_dword v0, off, s[12:15], s46 sc1

    s_lshl_b32 s16, s2, 3
    s_add_u32 s16, s16, s3
    s_lshl_b32 s46, s16, 7
    s_mul_i32 s16, s16, 8448
    s_add_u32 s46, s46, 30408704
    s_add_u32 s16, s16, 67108864

    s_mov_b32 s49, s34
k1_kernel_solo3:
    s_load_dwordx2 s[4:5], s[0:1], 8
    s_mov_b32 s6, 256000
    s_mov_b32 s7, 0x00020000

    s_mul_i32 s21, s33, 102656
    s_mul_i32 s35, s49, 49152
    s_sub_u32 s22, 53248, s35
    s_add_u32 s21, s21, s35
    s_lshl_b32 s35, s50, 11
    s_xor_b32 s19, s35, 2048
    s_add_u32 s19, s19, s21
    s_add_u32 s21, s21, s35
    s_mul_i32 s20, s49, 1703936
    s_add_u32 s20, s20, 16777216
    s_lshl_b32 s35, s3, 14
    s_add_u32 s20, s20, s35

    s_waitcnt vmcnt(0) lgkmcnt(0)
    s_and_b32 s5, s5, 0xffff
    s_barrier
    v_bfe_u32 v1, v71, 4, 4
    v_lshrrev_b32 v2, 8, v71
    v_lshlrev_b32 v65, 8, v1
    v_lshl_add_u32 v65, v2, 4, v65
    v_and_b32 v70, 0x0fffffff, v70
    v_lshrrev_b32 v64, 16, v70
    v_lshlrev_b32 v64, 3, v64
    s_lshl_b32 s44, s3, 15
    s_lshl_b32 s45, s50, 7
    s_add_u32 s44, s44, s45
    s_xor_b32 s45, s44, 128

    buffer_load_dwordx4 v[128:131], v65, s[4:7], s44 offen offset:0
    buffer_load_dwordx4 v[132:135], v65, s[4:7], s44 offen offset:64
    buffer_load_dwordx4 v[136:139], v65, s[4:7], s45 offen offset:0
    buffer_load_dwordx4 v[140:143], v65, s[4:7], s45 offen offset:64
    s_add_u32 s44, s44, 4096
    s_add_u32 s45, s45, 4096
    buffer_load_dwordx4 v[144:147], v65, s[4:7], s44 offen offset:0
    buffer_load_dwordx4 v[148:151], v65, s[4:7], s44 offen offset:64
    buffer_load_dwordx4 v[152:155], v65, s[4:7], s45 offen offset:0
    buffer_load_dwordx4 v[156:159], v65, s[4:7], s45 offen offset:64
    s_add_u32 s44, s44, 4096
    s_add_u32 s45, s45, 4096
    buffer_load_dwordx4 v[160:163], v65, s[4:7], s44 offen offset:0
    buffer_load_dwordx4 v[164:167], v65, s[4:7], s44 offen offset:64
    buffer_load_dwordx4 v[168:171], v65, s[4:7], s45 offen offset:0
    buffer_load_dwordx4 v[172:175], v65, s[4:7], s45 offen offset:64
    s_add_u32 s44, s44, 4096
    s_add_u32 s45, s45, 4096
    buffer_load_dwordx4 v[176:179], v65, s[4:7], s44 offen offset:0
    buffer_load_dwordx4 v[180:183], v65, s[4:7], s44 offen offset:64
    buffer_load_dwordx4 v[184:187], v65, s[4:7], s45 offen offset:0
    buffer_load_dwordx4 v[188:191], v65, s[4:7], s45 offen offset:64
    s_add_u32 s44, s44, 4096
    s_add_u32 s45, s45, 4096
    buffer_load_dwordx4 v[192:195], v65, s[4:7], s44 offen offset:0
    buffer_load_dwordx4 v[196:199], v65, s[4:7], s44 offen offset:64
    buffer_load_dwordx4 v[200:203], v65, s[4:7], s45 offen offset:0
    buffer_load_dwordx4 v[204:207], v65, s[4:7], s45 offen offset:64
    s_add_u32 s44, s44, 4096
    s_add_u32 s45, s45, 4096
    buffer_load_dwordx4 v[208:211], v65, s[4:7], s44 offen offset:0
    buffer_load_dwordx4 v[212:215], v65, s[4:7], s44 offen offset:64
    buffer_load_dwordx4 v[216:219], v65, s[4:7], s45 offen offset:0
    buffer_load_dwordx4 v[220:223], v65, s[4:7], s45 offen offset:64
    s_add_u32 s44, s44, 4096
    s_add_u32 s45, s45, 4096
    buffer_load_dwordx4 v[224:227], v65, s[4:7], s44 offen offset:0
    buffer_load_dwordx4 v[228:231], v65, s[4:7], s44 offen offset:64
    buffer_load_dwordx4 v[232:235], v65, s[4:7], s45 offen offset:0
    buffer_load_dwordx4 v[236:239], v65, s[4:7], s45 offen offset:64
    s_add_u32 s44, s44, 4096
    s_add_u32 s45, s45, 4096
    buffer_load_dwordx4 v[240:243], v65, s[4:7], s44 offen offset:0
    buffer_load_dwordx4 v[244:247], v65, s[4:7], s44 offen offset:64
    buffer_load_dwordx4 v[248:251], v65, s[4:7], s45 offen offset:0
    buffer_load_dwordx4 v[252:255], v65, s[4:7], s45 offen offset:64
    s_add_u32 s44, s44, 4096
    s_add_u32 s45, s45, 4096
    buffer_load_dwordx4 v[0:3], v71, s[12:15], s21 offen offset:0
    buffer_load_dwordx4 v[4:7], v71, s[12:15], s21 offen offset:1024
    buffer_load_dwordx4 v[8:11], v71, s[12:15], s19 offen offset:0
    buffer_load_dwordx4 v[12:15], v71, s[12:15], s19 offen offset:1024
    s_add_u32 s21, s21, 4096
    s_add_u32 s19, s19, 4096
    buffer_load_dwordx4 v[16:19], v71, s[12:15], s21 offen offset:0
    buffer_load_dwordx4 v[20:23], v71, s[12:15], s21 offen offset:1024
    buffer_load_dwordx4 v[24:27], v71, s[12:15], s19 offen offset:0
    buffer_load_dwordx4 v[28:31], v71, s[12:15], s19 offen offset:1024
    s_add_u32 s21, s21, 4096
    s_add_u32 s19, s19, 4096
    buffer_load_dwordx4 v[32:35], v71, s[12:15], s21 offen offset:0
    buffer_load_dwordx4 v[36:39], v71, s[12:15], s21 offen offset:1024
    buffer_load_dwordx4 v[40:43], v71, s[12:15], s19 offen offset:0
    buffer_load_dwordx4 v[44:47], v71, s[12:15], s19 offen offset:1024
    s_add_u32 s21, s21, 4096
    s_add_u32 s19, s19, 4096
    buffer_load_dwordx4 v[72:75], v71, s[12:15], s21 offen offset:0
    buffer_load_dwordx4 v[76:79], v71, s[12:15], s21 offen offset:1024
    buffer_load_dwordx4 v[80:83], v71, s[12:15], s19 offen offset:0
    buffer_load_dwordx4 v[84:87], v71, s[12:15], s19 offen offset:1024
    s_add_u32 s21, s21, 4096
    s_add_u32 s19, s19, 4096
    buffer_load_dwordx2 v[116:117], v71, s[12:15], s20 offen offset:0 sc1
    buffer_load_dwordx2 v[118:119], v71, s[12:15], s20 offen offset:1024 sc1
    buffer_load_dwordx2 v[120:121], v71, s[12:15], s20 offen offset:2048 sc1
    buffer_load_dwordx2 v[122:123], v71, s[12:15], s20 offen offset:3072 sc1
    s_add_u32 s20, s20, 4096
    buffer_load_dwordx2 v[124:125], v71, s[12:15], s20 offen offset:0 sc1
    buffer_load_dwordx2 v[126:127], v71, s[12:15], s20 offen offset:1024 sc1
    s_waitcnt vmcnt(0)
    v_mfma_f32_16x16x32_bf16 v[96:99], v[0:3], v[128:131], 0
    v_mfma_f32_16x16x32_bf16 v[100:103], v[0:3], v[144:147], 0
    v_mfma_f32_16x16x32_bf16 v[96:99], v[4:7], v[132:135], v[96:99]
    v_mfma_f32_16x16x32_bf16 v[100:103], v[4:7], v[148:151], v[100:103]
    v_mfma_f32_16x16x32_bf16 v[96:99], v[8:11], v[136:139], v[96:99]
    v_mfma_f32_16x16x32_bf16 v[100:103], v[8:11], v[152:155], v[100:103]
    v_mfma_f32_16x16x32_bf16 v[96:99], v[12:15], v[140:143], v[96:99]
    v_mfma_f32_16x16x32_bf16 v[100:103], v[12:15], v[156:159], v[100:103]
    v_mfma_f32_16x16x32_bf16 v[104:107], v[0:3], v[160:163], 0
    v_mfma_f32_16x16x32_bf16 v[108:111], v[0:3], v[176:179], 0
    v_mfma_f32_16x16x32_bf16 v[104:107], v[4:7], v[164:167], v[104:107]
    v_cvt_pk_bf16_f32 v96, v96, v97
    v_mfma_f32_16x16x32_bf16 v[108:111], v[4:7], v[180:183], v[108:111]
    v_cvt_pk_bf16_f32 v97, v98, v99
    v_mfma_f32_16x16x32_bf16 v[104:107], v[8:11], v[168:171], v[104:107]
    ds_write_b64 v64, v[96:97] offset:0
    v_mfma_f32_16x16x32_bf16 v[108:111], v[8:11], v[184:187], v[108:111]
    v_cvt_pk_bf16_f32 v100, v100, v101
    v_mfma_f32_16x16x32_bf16 v[104:107], v[12:15], v[172:175], v[104:107]
    v_cvt_pk_bf16_f32 v101, v102, v103
    v_mfma_f32_16x16x32_bf16 v[108:111], v[12:15], v[188:191], v[108:111]
    ds_write_b64 v64, v[100:101] offset:128
    v_mfma_f32_16x16x32_bf16 v[88:91], v[0:3], v[192:195], 0
    v_mfma_f32_16x16x32_bf16 v[92:95], v[0:3], v[208:211], 0
    v_mfma_f32_16x16x32_bf16 v[88:91], v[4:7], v[196:199], v[88:91]
    v_cvt_pk_bf16_f32 v104, v104, v105
    v_mfma_f32_16x16x32_bf16 v[92:95], v[4:7], v[212:215], v[92:95]
    v_cvt_pk_bf16_f32 v105, v106, v107
    v_mfma_f32_16x16x32_bf16 v[88:91], v[8:11], v[200:203], v[88:91]
    ds_write_b64 v64, v[104:105] offset:256
    v_mfma_f32_16x16x32_bf16 v[92:95], v[8:11], v[216:219], v[92:95]
    v_cvt_pk_bf16_f32 v108, v108, v109
    v_mfma_f32_16x16x32_bf16 v[88:91], v[12:15], v[204:207], v[88:91]
    v_cvt_pk_bf16_f32 v109, v110, v111
    v_mfma_f32_16x16x32_bf16 v[92:95], v[12:15], v[220:223], v[92:95]
    ds_write_b64 v64, v[108:109] offset:384
    v_mfma_f32_16x16x32_bf16 v[96:99], v[0:3], v[224:227], 0
    v_mfma_f32_16x16x32_bf16 v[100:103], v[0:3], v[240:243], 0
    v_mfma_f32_16x16x32_bf16 v[96:99], v[4:7], v[228:231], v[96:99]
    v_cvt_pk_bf16_f32 v88, v88, v89
    v_mfma_f32_16x16x32_bf16 v[100:103], v[4:7], v[244:247], v[100:103]
    v_cvt_pk_bf16_f32 v89, v90, v91
    v_mfma_f32_16x16x32_bf16 v[96:99], v[8:11], v[232:235], v[96:99]
    ds_write_b64 v64, v[88:89] offset:512
    v_mfma_f32_16x16x32_bf16 v[100:103], v[8:11], v[248:251], v[100:103]
    v_cvt_pk_bf16_f32 v92, v92, v93
    v_mfma_f32_16x16x32_bf16 v[96:99], v[12:15], v[236:239], v[96:99]
    v_cvt_pk_bf16_f32 v93, v94, v95
    v_mfma_f32_16x16x32_bf16 v[100:103], v[12:15], v[252:255], v[100:103]
    ds_write_b64 v64, v[92:93] offset:640
    s_nop 7
    v_cvt_pk_bf16_f32 v96, v96, v97
    v_cvt_pk_bf16_f32 v97, v98, v99
    ds_write_b64 v64, v[96:97] offset:768
    v_cvt_pk_bf16_f32 v100, v100, v101
    v_cvt_pk_bf16_f32 v101, v102, v103
    ds_write_b64 v64, v[100:101] offset:896
    v_add_u32 v64, 0x8000, v64
    v_mfma_f32_16x16x32_bf16 v[104:107], v[16:19], v[128:131], 0
    v_mfma_f32_16x16x32_bf16 v[108:111], v[16:19], v[144:147], 0
    v_mfma_f32_16x16x32_bf16 v[104:107], v[20:23], v[132:135], v[104:107]
    v_mfma_f32_16x16x32_bf16 v[108:111], v[20:23], v[148:151], v[108:111]
    v_mfma_f32_16x16x32_bf16 v[104:107], v[24:27], v[136:139], v[104:107]
    v_mfma_f32_16x16x32_bf16 v[108:111], v[24:27], v[152:155], v[108:111]
    v_mfma_f32_16x16x32_bf16 v[104:107], v[28:31], v[140:143], v[104:107]
    v_mfma_f32_16x16x32_bf16 v[108:111], v[28:31], v[156:159], v[108:111]
    v_mfma_f32_16x16x32_bf16 v[88:91], v[16:19], v[160:163], 0
    v_mfma_f32_16x16x32_bf16 v[92:95], v[16:19], v[176:179], 0
    v_mfma_f32_16x16x32_bf16 v[88:91], v[20:23], v[164:167], v[88:91]
    v_cvt_pk_bf16_f32 v104, v104, v105
    v_mfma_f32_16x16x32_bf16 v[92:95], v[20:23], v[180:183], v[92:95]
    v_cvt_pk_bf16_f32 v105, v106, v107
    v_mfma_f32_16x16x32_bf16 v[88:91], v[24:27], v[168:171], v[88:91]
    ds_write_b64 v64, v[104:105] offset:0
    v_mfma_f32_16x16x32_bf16 v[92:95], v[24:27], v[184:187], v[92:95]
    v_cvt_pk_bf16_f32 v108, v108, v109
    v_mfma_f32_16x16x32_bf16 v[88:91], v[28:31], v[172:175], v[88:91]
    v_cvt_pk_bf16_f32 v109, v110, v111
    v_mfma_f32_16x16x32_bf16 v[92:95], v[28:31], v[188:191], v[92:95]
    ds_write_b64 v64, v[108:109] offset:128
    v_mfma_f32_16x16x32_bf16 v[96:99], v[16:19], v[192:195], 0
    v_mfma_f32_16x16x32_bf16 v[100:103], v[16:19], v[208:211], 0
    v_mfma_f32_16x16x32_bf16 v[96:99], v[20:23], v[196:199], v[96:99]
    v_cvt_pk_bf16_f32 v88, v88, v89
    v_mfma_f32_16x16x32_bf16 v[100:103], v[20:23], v[212:215], v[100:103]
    v_cvt_pk_bf16_f32 v89, v90, v91
    v_mfma_f32_16x16x32_bf16 v[96:99], v[24:27], v[200:203], v[96:99]
    ds_write_b64 v64, v[88:89] offset:256
    v_mfma_f32_16x16x32_bf16 v[100:103], v[24:27], v[216:219], v[100:103]
    v_cvt_pk_bf16_f32 v92, v92, v93
    v_mfma_f32_16x16x32_bf16 v[96:99], v[28:31], v[204:207], v[96:99]
    v_cvt_pk_bf16_f32 v93, v94, v95
    v_mfma_f32_16x16x32_bf16 v[100:103], v[28:31], v[220:223], v[100:103]
    ds_write_b64 v64, v[92:93] offset:384
    v_mfma_f32_16x16x32_bf16 v[104:107], v[16:19], v[224:227], 0
    v_mfma_f32_16x16x32_bf16 v[108:111], v[16:19], v[240:243], 0
    v_mfma_f32_16x16x32_bf16 v[104:107], v[20:23], v[228:231], v[104:107]
    v_cvt_pk_bf16_f32 v96, v96, v97
    v_mfma_f32_16x16x32_bf16 v[108:111], v[20:23], v[244:247], v[108:111]
    v_cvt_pk_bf16_f32 v97, v98, v99
    v_mfma_f32_16x16x32_bf16 v[104:107], v[24:27], v[232:235], v[104:107]
    ds_write_b64 v64, v[96:97] offset:512
    v_mfma_f32_16x16x32_bf16 v[108:111], v[24:27], v[248:251], v[108:111]
    v_cvt_pk_bf16_f32 v100, v100, v101
    v_mfma_f32_16x16x32_bf16 v[104:107], v[28:31], v[236:239], v[104:107]
    v_cvt_pk_bf16_f32 v101, v102, v103
    v_mfma_f32_16x16x32_bf16 v[108:111], v[28:31], v[252:255], v[108:111]
    ds_write_b64 v64, v[100:101] offset:640
    s_nop 7
    v_cvt_pk_bf16_f32 v104, v104, v105
    v_cvt_pk_bf16_f32 v105, v106, v107
    ds_write_b64 v64, v[104:105] offset:768
    v_cvt_pk_bf16_f32 v108, v108, v109
    v_cvt_pk_bf16_f32 v109, v110, v111
    ds_write_b64 v64, v[108:109] offset:896
    v_add_u32 v64, 0x8000, v64
    v_mfma_f32_16x16x32_bf16 v[88:91], v[32:35], v[128:131], 0
    v_mfma_f32_16x16x32_bf16 v[92:95], v[32:35], v[144:147], 0
    v_mfma_f32_16x16x32_bf16 v[88:91], v[36:39], v[132:135], v[88:91]
    v_mfma_f32_16x16x32_bf16 v[92:95], v[36:39], v[148:151], v[92:95]
    v_mfma_f32_16x16x32_bf16 v[88:91], v[40:43], v[136:139], v[88:91]
    v_mfma_f32_16x16x32_bf16 v[92:95], v[40:43], v[152:155], v[92:95]
    v_mfma_f32_16x16x32_bf16 v[88:91], v[44:47], v[140:143], v[88:91]
    v_mfma_f32_16x16x32_bf16 v[92:95], v[44:47], v[156:159], v[92:95]
    v_mfma_f32_16x16x32_bf16 v[96:99], v[32:35], v[160:163], 0
    v_mfma_f32_16x16x32_bf16 v[100:103], v[32:35], v[176:179], 0
    v_mfma_f32_16x16x32_bf16 v[96:99], v[36:39], v[164:167], v[96:99]
    v_cvt_pk_bf16_f32 v88, v88, v89
    v_mfma_f32_16x16x32_bf16 v[100:103], v[36:39], v[180:183], v[100:103]
    v_cvt_pk_bf16_f32 v89, v90, v91
    v_mfma_f32_16x16x32_bf16 v[96:99], v[40:43], v[168:171], v[96:99]
    ds_write_b64 v64, v[88:89] offset:0
    v_mfma_f32_16x16x32_bf16 v[100:103], v[40:43], v[184:187], v[100:103]
    v_cvt_pk_bf16_f32 v92, v92, v93
    v_mfma_f32_16x16x32_bf16 v[96:99], v[44:47], v[172:175], v[96:99]
    v_cvt_pk_bf16_f32 v93, v94, v95
    v_mfma_f32_16x16x32_bf16 v[100:103], v[44:47], v[188:191], v[100:103]
    ds_write_b64 v64, v[92:93] offset:128
    v_mfma_f32_16x16x32_bf16 v[104:107], v[32:35], v[192:195], 0
    v_mfma_f32_16x16x32_bf16 v[108:111], v[32:35], v[208:211], 0
    v_mfma_f32_16x16x32_bf16 v[104:107], v[36:39], v[196:199], v[104:107]
    v_cvt_pk_bf16_f32 v96, v96, v97
    v_mfma_f32_16x16x32_bf16 v[108:111], v[36:39], v[212:215], v[108:111]
    v_cvt_pk_bf16_f32 v97, v98, v99
    v_mfma_f32_16x16x32_bf16 v[104:107], v[40:43], v[200:203], v[104:107]
    ds_write_b64 v64, v[96:97] offset:256
    v_mfma_f32_16x16x32_bf16 v[108:111], v[40:43], v[216:219], v[108:111]
    v_cvt_pk_bf16_f32 v100, v100, v101
    v_mfma_f32_16x16x32_bf16 v[104:107], v[44:47], v[204:207], v[104:107]
    v_cvt_pk_bf16_f32 v101, v102, v103
    v_mfma_f32_16x16x32_bf16 v[108:111], v[44:47], v[220:223], v[108:111]
    ds_write_b64 v64, v[100:101] offset:384
    v_mfma_f32_16x16x32_bf16 v[88:91], v[32:35], v[224:227], 0
    v_mfma_f32_16x16x32_bf16 v[92:95], v[32:35], v[240:243], 0
    v_mfma_f32_16x16x32_bf16 v[88:91], v[36:39], v[228:231], v[88:91]
    v_cvt_pk_bf16_f32 v104, v104, v105
    v_mfma_f32_16x16x32_bf16 v[92:95], v[36:39], v[244:247], v[92:95]
    v_cvt_pk_bf16_f32 v105, v106, v107
    v_mfma_f32_16x16x32_bf16 v[88:91], v[40:43], v[232:235], v[88:91]
    ds_write_b64 v64, v[104:105] offset:512
    v_mfma_f32_16x16x32_bf16 v[92:95], v[40:43], v[248:251], v[92:95]
    v_cvt_pk_bf16_f32 v108, v108, v109
    v_mfma_f32_16x16x32_bf16 v[88:91], v[44:47], v[236:239], v[88:91]
    v_cvt_pk_bf16_f32 v109, v110, v111
    v_mfma_f32_16x16x32_bf16 v[92:95], v[44:47], v[252:255], v[92:95]
    ds_write_b64 v64, v[108:109] offset:640
    s_nop 7
    v_cvt_pk_bf16_f32 v88, v88, v89
    v_cvt_pk_bf16_f32 v89, v90, v91
    ds_write_b64 v64, v[88:89] offset:768
    v_cvt_pk_bf16_f32 v92, v92, v93
    v_cvt_pk_bf16_f32 v93, v94, v95
    ds_write_b64 v64, v[92:93] offset:896
    v_add_u32 v64, 0x8000, v64

    s_mov_b32 s64, 0
    s_cmp_eq_u32 s3, 7
    s_cbranch_scc1 k1_kernel_k2w
    s_branch k1_kernel_k2j

k1_kernel_end:
    s_endpgm
k1_kernel_main:
    s_setprio 3
    s_mov_b32 s16, s4
    s_and_b32 s17, s5, 0xffff
    s_mov_b32 s20, s6
    s_and_b32 s21, s7, 0xffff
    s_mov_b32 s28, s10
    s_and_b32 s29, s11, 0xffff
    s_mov_b32 s32, s12
    s_and_b32 s33, s13, 0xffff
    s_and_b32 s13, s13, 0xffff
    s_and_b32 s53, s53, 0xffff

    v_and_b32 v5, 15, v255
    v_lshrrev_b32 v6, 4, v255
    v_and_b32 v7, 3, v255
    v_bfe_u32 v8, v255, 2, 2
    v_lshl_add_u32 v9, v7, 2, v8
    v_cmp_eq_u32 s[46:47], 0, v7
    s_movk_i32 s45, 200
    v_mov_b32 v10, 144384
    v_mad_u32_u24 v11, v9, s45, v10
    v_and_b32 v213, 48, v255
    v_add_u32 v128, v11, v213
    v_mul_u32_u24 v12, 6400, v6
    v_add_u32 v132, v11, v12
    v_and_b32 v12, 16, v255
    v_add_u32 v10, v10, v12
    v_add_u32 v11, v11, v12
    v_and_b32 v12, 32, v255
    v_mul_u32_u24 v12, 100, v12
    v_add_u32 v131, v11, v12
    v_and_b32 v12, 8, v255
    v_lshl_add_u32 v13, v7, 1, v12
    v_and_b32 v14, 1, v8
    v_add_u32 v13, v13, v14
    v_lshrrev_b32 v14, 5, v255
    v_lshl_add_u32 v14, v13, 1, v14
    v_mad_u32_u24 v129, v14, s45, v10
    v_lshl_add_u32 v130, v12, 2, v129
    v_lshlrev_b32 v15, 2, v6
    v_sub_u32 v13, v13, v15
    v_lshrrev_b32 v14, 1, v9
    v_sub_u32 v14, v14, v15
    v_sub_u32 v15, v5, v15
    v_and_b32 v12, 1, v9
    v_lshlrev_b32 v12, 4, v12
    v_mov_b32 v16, 0x3f80
    v_lshlrev_b32 v12, v12, v16
    v_mov_b32 v17, 0x3f800000

    v_cmp_eq_u32 vcc, 0, v13
    v_cndmask_b32 v120, 0, v16, vcc
    v_cmp_eq_u32 vcc, 0, v14
    v_cndmask_b32 v112, 0, v12, vcc
    v_cmp_eq_u32 vcc, -8, v14
    v_cndmask_b32 v116, 0, v12, vcc
    v_cmp_eq_u32 vcc, 0, v15
    v_cndmask_b32 v200, 0, v17, vcc
    v_lshlrev_b32 v124, 16, v120

    v_cmp_eq_u32 vcc, 1, v13
    v_cndmask_b32 v121, 0, v16, vcc
    v_cmp_eq_u32 vcc, 1, v14
    v_cndmask_b32 v113, 0, v12, vcc
    v_cmp_eq_u32 vcc, -7, v14
    v_cndmask_b32 v117, 0, v12, vcc
    v_cmp_eq_u32 vcc, 1, v15
    v_cndmask_b32 v201, 0, v17, vcc
    v_lshlrev_b32 v125, 16, v121

    v_cmp_eq_u32 vcc, 2, v13
    v_cndmask_b32 v122, 0, v16, vcc
    v_cmp_eq_u32 vcc, 2, v14
    v_cndmask_b32 v114, 0, v12, vcc
    v_cmp_eq_u32 vcc, -6, v14
    v_cndmask_b32 v118, 0, v12, vcc
    v_cmp_eq_u32 vcc, 2, v15
    v_cndmask_b32 v202, 0, v17, vcc
    v_lshlrev_b32 v126, 16, v122

    v_cmp_eq_u32 vcc, 3, v13
    v_cndmask_b32 v123, 0, v16, vcc
    v_cmp_eq_u32 vcc, 3, v14
    v_cndmask_b32 v115, 0, v12, vcc
    v_cmp_eq_u32 vcc, -5, v14
    v_cndmask_b32 v119, 0, v12, vcc
    v_cmp_eq_u32 vcc, 3, v15
    v_cndmask_b32 v203, 0, v17, vcc
    v_lshlrev_b32 v127, 16, v123

    s_mul_i32 s45, s3, 36864
    s_add_u32 s45, s45, 128
    s_movk_i32 s57, 144
    v_mov_b32 v10, s45
    v_mad_u32_u24 v214, v5, s57, v10
    v_mad_u32_u24 v218, v255, s57, v10
    v_add_u32 v218, 12, v218
    v_cmp_lt_u32 vcc, 25, v255
    v_subrev_u32 v11, 26, v255
    v_cndmask_b32 v11, v255, v11, vcc
    v_add_u32 v12, 2304, v10
    v_cndmask_b32 v10, v10, v12, vcc
    v_and_b32 v12, 3, v11
    v_mad_u32_u24 v10, v12, s57, v10
    v_lshrrev_b32 v11, 2, v11
    v_lshl_add_u32 v215, v11, 1, v10
    v_cmp_gt_u32 vcc, 52, v255
    v_add_u32 v11, 2304, v218
    v_cndmask_b32 v215, v11, v215, vcc
    v_mov_b32 v216, 0xdddddddd
    v_mov_b32 v219, 1000
    s_mov_b32 s60, 0xff00ff00
    s_mov_b32 s61, 0xff00ff00
    s_mov_b32 s62, -1
    s_mov_b32 s63, 0xffff

    s_waitcnt vmcnt(3)

    s_mov_b64 exec, 1
    ds_add_u32 v252, v253 offset:0
    s_mov_b64 exec, -1

k1_kernel_wf1:

    ds_read_b32 v251, v252 offset:0
    s_waitcnt lgkmcnt(0)
    v_readfirstlane_b32 s45, v251
    s_cmp_lt_u32 s45, 4
    s_cbranch_scc1 k1_kernel_wf1

    v_mov_b32 v72, 0
    v_mov_b32 v73, 0
    v_mov_b32 v74, 0
    v_mov_b32 v75, 0
    s_mov_b64 exec, s[62:63]
    ds_read_b64 v[72:73], v132 offset:192
    ds_read_b64 v[74:75], v132 offset:3392
    s_mov_b64 exec, -1
    ds_read_b64 v[76:77], v128 offset:16160
    ds_read_b64 v[78:79], v128 offset:16168
    ds_read_b64 v[80:81], v128 offset:0
    ds_read_b64 v[82:83], v128 offset:8
    ds_read_b64 v[84:85], v131 offset:0
    ds_read_b64 v[86:87], v131 offset:8
    s_waitcnt vmcnt(2)
    s_waitcnt lgkmcnt(4)
    v_mfma_f32_16x16x32_bf16 v[64:67], v[112:115], v[72:75], 0
    ds_read_b64 v[88:89], v128 offset:3232
    ds_read_b64 v[90:91], v128 offset:3240
    v_mfma_f32_16x16x32_bf16 v[68:71], v[116:119], v[72:75], 0
    v_mfma_f32_16x16x32_bf16 v[60:63], v[112:115], v[76:79], 0
    v_mfma_f32_16x16x32_bf16 v[64:67], v[232:235], v[112:115], v[64:67]
    v_mov_b32 v92, 0
    v_mov_b32 v93, 0
    v_mov_b32 v94, 0
    v_mov_b32 v95, 0
    s_mov_b64 exec, s[60:61]
    ds_read_b64 v[92:93], v129 offset:3232
    ds_read_b64 v[94:95], v129 offset:3240
    s_mov_b64 exec, -1
    v_mfma_f32_16x16x32_bf16 v[68:71], v[232:235], v[116:119], v[68:71]
    s_waitcnt lgkmcnt(4)
    v_mfma_f32_16x16x32_bf16 v[0:3], v[112:115], v[80:83], 0
    ds_read_b64 v[72:73], v128 offset:64
    ds_read_b64 v[74:75], v128 offset:72
    v_mfma_f32_16x16x32_bf16 v[4:7], v[116:119], v[80:83], 0
    v_mfma_f32_16x16x32_bf16 v[4:7], v[84:87], v[116:119], v[4:7]
    v_cndmask_b32 v70, 0, v70, s[46:47]
    ds_read_b64 v[76:77], v131 offset:6400
    ds_read_b64 v[78:79], v131 offset:6408
    s_waitcnt lgkmcnt(4)
    v_mfma_f32_16x16x32_bf16 v[96:99], v[120:123], v[88:91], 0
    ds_read_b64 v[80:81], v128 offset:9632
    ds_read_b64 v[82:83], v128 offset:9640
    v_mfma_f32_16x16x32_bf16 v[100:103], v[124:127], v[88:91], 0
    v_mfma_f32_16x16x32_bf16 v[96:99], v[92:95], v[112:115], v[96:99]
    v_mfma_f32_16x16x32_bf16 v[100:103], v[92:95], v[116:119], v[100:103]
    ds_read_b64 v[84:85], v129 offset:3296
    ds_read_b64 v[86:87], v129 offset:3304
    s_waitcnt lgkmcnt(4)
    v_mfma_f32_16x16x32_bf16 v[12:15], v[112:115], v[72:75], 0
    ds_read_b64 v[88:89], v128 offset:6464
    ds_read_b64 v[90:91], v128 offset:6472
    v_mfma_f32_16x16x32_bf16 v[16:19], v[116:119], v[72:75], 0
    v_cvt_pk_bf16_f32 v8, v96, v97
    v_cvt_pk_bf16_f32 v9, v98, v99
    v_mfma_f32_16x16x32_bf16 v[12:15], v[76:79], v[112:115], v[12:15]
    v_cvt_pk_bf16_f32 v10, v100, v101
    v_cvt_pk_bf16_f32 v11, v102, v103
    v_mfma_f32_16x16x32_bf16 v[16:19], v[76:79], v[116:119], v[16:19]
    ds_read_b64 v[92:93], v128 offset:9696
    ds_read_b64 v[94:95], v128 offset:9704
    s_waitcnt lgkmcnt(4)
    v_mfma_f32_16x16x32_bf16 v[96:99], v[120:123], v[80:83], 0
    ds_read_b64 v[72:73], v128 offset:128
    ds_read_b64 v[74:75], v128 offset:136
    v_mfma_f32_16x16x32_bf16 v[100:103], v[124:127], v[80:83], 0
    v_mfma_f32_16x16x32_bf16 v[96:99], v[84:87], v[112:115], v[96:99]
    v_mfma_f32_16x16x32_bf16 v[100:103], v[84:87], v[116:119], v[100:103]
    ds_read_b64 v[76:77], v129 offset:12800
    ds_read_b64 v[78:79], v129 offset:12808
    s_waitcnt lgkmcnt(4)
    v_mfma_f32_16x16x32_bf16 v[24:27], v[112:115], v[88:91], 0
    ds_read_b64 v[80:81], v128 offset:3328
    ds_read_b64 v[82:83], v128 offset:3336
    v_mfma_f32_16x16x32_bf16 v[28:31], v[112:115], v[92:95], 0
    v_cvt_pk_bf16_f32 v20, v96, v97
    v_cvt_pk_bf16_f32 v21, v98, v99
    s_nop 3
    v_cvt_pk_bf16_f32 v22, v100, v101
    v_cvt_pk_bf16_f32 v23, v102, v103
    ds_read_b64 v[84:85], v131 offset:12832
    ds_read_b64 v[86:87], v131 offset:12840
    s_waitcnt lgkmcnt(4)
    v_mfma_f32_16x16x32_bf16 v[96:99], v[120:123], v[72:75], 0
    ds_read_b64 v[88:89], v128 offset:6528
    ds_read_b64 v[90:91], v128 offset:6536
    v_mfma_f32_16x16x32_bf16 v[100:103], v[124:127], v[72:75], 0
    v_mfma_f32_16x16x32_bf16 v[96:99], v[76:79], v[112:115], v[96:99]
    v_mfma_f32_16x16x32_bf16 v[100:103], v[76:79], v[116:119], v[100:103]
    ds_read_b64 v[92:93], v129 offset:12864
    ds_read_b64 v[94:95], v129 offset:12872
    s_waitcnt lgkmcnt(4)
    v_mfma_f32_16x16x32_bf16 v[36:39], v[112:115], v[80:83], 0
    ds_read_b64 v[72:73], v128 offset:9728
    ds_read_b64 v[74:75], v128 offset:9736
    v_mfma_f32_16x16x32_bf16 v[40:43], v[116:119], v[80:83], 0
    v_cvt_pk_bf16_f32 v32, v96, v97
    v_cvt_pk_bf16_f32 v33, v98, v99
    v_mfma_f32_16x16x32_bf16 v[36:39], v[84:87], v[112:115], v[36:39]
    v_cvt_pk_bf16_f32 v34, v100, v101
    v_cvt_pk_bf16_f32 v35, v102, v103
    v_mfma_f32_16x16x32_bf16 v[40:43], v[84:87], v[116:119], v[40:43]
    ds_read_b64 v[76:77], v131 offset:12896
    ds_read_b64 v[78:79], v131 offset:12904
    s_waitcnt lgkmcnt(4)
    v_mfma_f32_16x16x32_bf16 v[96:99], v[120:123], v[88:91], 0
    ds_read_b64 v[80:81], v128 offset:12928
    ds_read_b64 v[82:83], v128 offset:12936
    v_mfma_f32_16x16x32_bf16 v[100:103], v[124:127], v[88:91], 0
    v_mfma_f32_16x16x32_bf16 v[96:99], v[92:95], v[112:115], v[96:99]
    v_mfma_f32_16x16x32_bf16 v[100:103], v[92:95], v[116:119], v[100:103]
    v_mov_b32 v84, 0
    v_mov_b32 v85, 0
    v_mov_b32 v86, 0
    v_mov_b32 v87, 0
    s_mov_b64 exec, s[60:61]
    ds_read_b64 v[84:85], v129 offset:12928
    ds_read_b64 v[86:87], v129 offset:12936
    s_mov_b64 exec, -1
    s_waitcnt lgkmcnt(4)
    v_mfma_f32_16x16x32_bf16 v[48:51], v[112:115], v[72:75], 0
    v_mfma_f32_16x16x32_bf16 v[52:55], v[116:119], v[72:75], 0
    v_cvt_pk_bf16_f32 v44, v96, v97
    v_cvt_pk_bf16_f32 v45, v98, v99
    v_mfma_f32_16x16x32_bf16 v[48:51], v[76:79], v[112:115], v[48:51]
    v_cvt_pk_bf16_f32 v46, v100, v101
    v_cvt_pk_bf16_f32 v47, v102, v103
    v_mfma_f32_16x16x32_bf16 v[52:55], v[76:79], v[116:119], v[52:55]
    s_waitcnt lgkmcnt(0)

    s_mov_b64 exec, 1
    ds_add_u32 v252, v253 offset:12
    s_mov_b64 exec, -1

    v_mfma_f32_16x16x32_bf16 v[96:99], v[120:123], v[80:83], 0
    v_mfma_f32_16x16x32_bf16 v[100:103], v[124:127], v[80:83], 0
    v_mfma_f32_16x16x32_bf16 v[96:99], v[84:87], v[112:115], v[96:99]
    v_mfma_f32_16x16x32_bf16 v[100:103], v[84:87], v[116:119], v[100:103]
    s_nop 7
    v_cvt_pk_bf16_f32 v56, v96, v97
    v_cvt_pk_bf16_f32 v57, v98, v99
    v_cvt_pk_bf16_f32 v58, v100, v101
    v_cvt_pk_bf16_f32 v59, v102, v103

    v_mov_b32_dpp v71, v70 row_shr:1 row_mask:0xf bank_mask:0xf bound_ctrl:0
    ds_write_b32 v218, v219
    v_and_b32 v217, 1, v255
    v_lshlrev_b32 v248, 1, v213
    v_lshl_add_u32 v248, v217, 2, v248
    v_mul_u32_u24 v208, 0xaaaa, v217
    v_mov_b32 v217, 0
    s_mov_b32 vcc_lo, 0x01010101
    s_mov_b32 vcc_hi, 0x01010101
    s_movk_i32 s58, 7

    v_mov_b64 v[172:173], 0
    v_mov_b64 v[176:177], 0
    v_mov_b64 v[180:181], 0
    v_mov_b64 v[184:185], 0
    v_mov_b64 v[188:189], 0
    v_mov_b64 v[192:193], 0
    v_mov_b64 v[196:197], 0
    v_mov_b64 v[198:199], 0
    s_waitcnt vmcnt(1)
    ds_write_b16 v215, v240 offset:0
    ds_write_b16 v215, v241 offset:576
    ds_write_b16 v215, v242 offset:1152
    ds_write_b16 v215, v243 offset:1728
    v_add_u32 v250, 0x4444, v208
    ds_read_b128 v[204:207], v214 offset:0
k1_kernel_wf2:

    ds_read_b32 v251, v252 offset:16
    s_waitcnt lgkmcnt(0)
    v_readfirstlane_b32 s45, v251
    s_cmp_lt_u32 s45, 4
    s_cbranch_scc1 k1_kernel_wf2

    s_setprio 2
    v_mad_u32_u16 v76, v204, s57, v213 op_sel:[0,0,0,0]
    ds_read_b128 v[72:75], v76 offset:0
    ds_read_b128 v[76:79], v76 offset:64
    v_mad_u32_u16 v84, v204, s57, v213 op_sel:[1,0,0,0]
    ds_read_b128 v[80:83], v84 offset:0
    ds_read_b128 v[84:87], v84 offset:64
    v_mad_u32_u16 v92, v205, s57, v213 op_sel:[0,0,0,0]
    ds_read_b128 v[88:91], v92 offset:0
    ds_read_b128 v[92:95], v92 offset:64
    v_mad_u32_u16 v100, v205, s57, v213 op_sel:[1,0,0,0]
    ds_read_b128 v[96:99], v100 offset:0
    ds_read_b128 v[100:103], v100 offset:64
    v_mad_u32_u16 v108, v206, s57, v213 op_sel:[0,0,0,0]
    ds_read_b128 v[104:107], v108 offset:0
    ds_read_b128 v[108:111], v108 offset:64
    buffer_load_dwordx4 v[240:243], v249, s[16:19], s74 offen offset:0
    s_waitcnt lgkmcnt(4)
    v_mad_u32_u16 v116, v206, s57, v213 op_sel:[1,0,0,0]
    ds_read_b128 v[112:115], v116 offset:0
k1_kernel_loop:
    v_mfma_f32_16x16x32_bf16 v[124:127], v[72:75], v[72:75], 0
    ds_read_b128 v[116:119], v116 offset:64
    v_mad_u32_u16 v122, v207, s57, v248 op_sel:[0,0,0,0]
    ds_read2_b32 v[120:121], v122 offset0:0 offset1:2
    v_mfma_f32_16x16x32_bf16 v[124:127], v[76:79], v[76:79], v[124:127]
    ds_read2_b32 v[122:123], v122 offset0:4 offset1:6
    ds_read_b128 v[204:207], v214 offset:2304
    v_mfma_f32_16x16x32_bf16 v[128:131], v[80:83], v[72:75], 0
    v_fmac_f32 v217, v189, v68
    v_fmac_f32 v217, v196, v200
    v_mfma_f32_16x16x32_bf16 v[128:131], v[84:87], v[76:79], v[128:131]
    v_fmac_f32 v217, v192, v69
    v_fmac_f32 v217, v197, v201
    v_mfma_f32_16x16x32_bf16 v[132:135], v[80:83], v[80:83], 0
    v_fmac_f32 v217, v193, v69
    v_fmac_f32 v217, v198, v202
    v_mfma_f32_16x16x32_bf16 v[132:135], v[84:87], v[84:87], v[132:135]
    v_fmac_f32 v217, v199, v203
    v_fmac_f32 v209, v153, v53
    v_mfma_f32_16x16x32_bf16 v[136:139], v[88:91], v[80:83], 0
    v_fmac_f32 v208, v154, v54
    v_fmac_f32 v209, v155, v55
    v_mfma_f32_16x16x32_bf16 v[136:139], v[92:95], v[84:87], v[136:139]
    v_fmac_f32 v208, v164, v60
    v_fmac_f32 v209, v165, v61
    v_mfma_f32_16x16x32_bf16 v[140:143], v[88:91], v[72:75], 0
    v_fmac_f32 v208, v166, v62
    v_fmac_f32 v209, v167, v63
    v_mfma_f32_16x16x32_bf16 v[140:143], v[92:95], v[76:79], v[140:143]
    s_waitcnt lgkmcnt(7)
    v_add_f32 v209, v209, v217
    v_smfmac_f32_16x16x64_bf16 v[196:199], v[8:11], v[132:139], v216
    v_fmac_f32 v208, v168, v70
    v_mfma_f32_16x16x32_bf16 v[144:147], v[96:99], v[72:75], 0
    v_fmac_f32 v208, v169, v71
    v_add_f32 v211, v208, v209
    v_mfma_f32_16x16x32_bf16 v[144:147], v[100:103], v[76:79], v[144:147]
    v_fma_f32 v208, v124, v0, -v217
    v_mul_f32 v209, v125, v1
    v_mfma_f32_16x16x32_bf16 v[148:151], v[80:83], v[96:99], 0
    v_fmac_f32 v208, v126, v2
    v_fmac_f32 v209, v127, v3
    v_mfma_f32_16x16x32_bf16 v[148:151], v[84:87], v[100:103], v[148:151]
    v_fmac_f32 v208, v128, v4
    v_fmac_f32 v209, v129, v5
    v_mfma_f32_16x16x32_bf16 v[152:155], v[88:91], v[96:99], 0
    v_fmac_f32 v208, v130, v6
    v_fmac_f32 v209, v131, v7
    v_mfma_f32_16x16x32_bf16 v[152:155], v[92:95], v[100:103], v[152:155]
    v_fmac_f32 v208, v140, v12
    v_fmac_f32 v209, v141, v13
    v_mfma_f32_16x16x32_bf16 v[156:159], v[88:91], v[88:91], 0
    v_fmac_f32 v208, v142, v14
    v_fmac_f32 v209, v143, v15
    v_mfma_f32_16x16x32_bf16 v[156:159], v[92:95], v[92:95], v[156:159]
    v_fmac_f32 v208, v144, v16
    v_fmac_f32 v209, v145, v17
    v_smfmac_f32_16x16x64_bf16 v[196:199], v[20:23], v[148:155], v216
    v_fmac_f32 v208, v146, v18
    v_mfma_f32_16x16x32_bf16 v[160:163], v[96:99], v[96:99], 0
    s_waitcnt lgkmcnt(0)
    v_fmac_f32 v209, v147, v19
    v_mfma_f32_16x16x32_bf16 v[160:163], v[100:103], v[100:103], v[160:163]
    v_fmac_f32 v208, v156, v24
    v_fmac_f32 v209, v157, v25
    v_mfma_f32_16x16x32_bf16 v[124:127], v[104:107], v[72:75], 0
    v_fmac_f32 v208, v158, v26
    v_fmac_f32 v209, v159, v27
    v_mfma_f32_16x16x32_bf16 v[124:127], v[108:111], v[76:79], v[124:127]
    v_permlane32_swap_b32 v210, v211
    s_waitcnt vmcnt(1)
    v_mfma_f32_16x16x32_bf16 v[128:131], v[112:115], v[72:75], 0
    v_fmac_f32 v208, v160, v28
    v_fmac_f32 v209, v161, v29
    v_mfma_f32_16x16x32_bf16 v[128:131], v[116:119], v[76:79], v[128:131]
    v_fmac_f32 v208, v162, v30
    v_fmac_f32 v209, v163, v31
    v_smfmac_f32_16x16x64_bf16 v[172:175], v[120:123], v[72:79], v250
    v_mad_u32_u16 v76, v204, s57, v213 op_sel:[0,0,0,0]
    v_mfma_f32_16x16x32_bf16 v[132:135], v[104:107], v[80:83], 0
    ds_read_b128 v[72:75], v76 offset:0
    ds_read_b128 v[76:79], v76 offset:64
    v_smfmac_f32_16x16x64_bf16 v[196:199], v[32:35], v[124:131], v216
    v_add_f32 v219, v210, v211
    v_mfma_f32_16x16x32_bf16 v[132:135], v[108:111], v[84:87], v[132:135]
    v_mul_f32 v217, v172, v64
    ds_write_b16 v215, v244 offset:4608
    v_mfma_f32_16x16x32_bf16 v[136:139], v[112:115], v[80:83], 0
    v_fmac_f32 v217, v173, v64
    ds_write_b16 v215, v245 offset:5184
    v_mfma_f32_16x16x32_bf16 v[136:139], v[116:119], v[84:87], v[136:139]
    ds_write_b16 v215, v246 offset:5760
    ds_write_b16 v215, v247 offset:6336
    v_smfmac_f32_16x16x64_bf16 v[176:179], v[120:123], v[80:87], v250
    v_mad_u32_u16 v84, v204, s57, v213 op_sel:[1,0,0,0]
    v_mfma_f32_16x16x32_bf16 v[140:143], v[104:107], v[88:91], 0
    ds_read_b128 v[80:83], v84 offset:0
    ds_read_b128 v[84:87], v84 offset:64
    v_mfma_f32_16x16x32_bf16 v[140:143], v[108:111], v[92:95], v[140:143]
    v_fmac_f32 v208, v132, v36
    v_fmac_f32 v209, v133, v37
    v_mfma_f32_16x16x32_bf16 v[144:147], v[112:115], v[88:91], 0
    v_fmac_f32 v217, v176, v65
    v_fmac_f32 v208, v134, v38
    v_mfma_f32_16x16x32_bf16 v[144:147], v[116:119], v[92:95], v[144:147]
    v_fmac_f32 v217, v177, v65
    v_fmac_f32 v209, v135, v39
    v_smfmac_f32_16x16x64_bf16 v[180:183], v[120:123], v[88:95], v250
    v_mad_u32_u16 v92, v205, s57, v213 op_sel:[0,0,0,0]
    v_mfma_f32_16x16x32_bf16 v[148:151], v[104:107], v[96:99], 0
    ds_read_b128 v[88:91], v92 offset:0
    ds_read_b128 v[92:95], v92 offset:64
    v_smfmac_f32_16x16x64_bf16 v[196:199], v[44:47], v[140:147], v216
    v_fmac_f32 v208, v136, v40
    v_mfma_f32_16x16x32_bf16 v[148:151], v[108:111], v[100:103], v[148:151]
    v_fmac_f32 v217, v180, v66
    v_fmac_f32 v209, v137, v41
    v_mfma_f32_16x16x32_bf16 v[152:155], v[112:115], v[96:99], 0
    v_fmac_f32 v217, v181, v66
    v_fmac_f32 v208, v138, v42
    v_mfma_f32_16x16x32_bf16 v[152:155], v[116:119], v[100:103], v[152:155]
    v_fmac_f32 v209, v139, v43
    buffer_load_dwordx4 v[244:247], v249, s[16:19], s74 offen offset:800
    v_smfmac_f32_16x16x64_bf16 v[184:187], v[120:123], v[96:103], v250
    v_mad_u32_u16 v100, v205, s57, v213 op_sel:[1,0,0,0]
    v_mfma_f32_16x16x32_bf16 v[156:159], v[104:107], v[104:107], 0
    ds_read_b128 v[96:99], v100 offset:0
    ds_read_b128 v[100:103], v100 offset:64
    v_mfma_f32_16x16x32_bf16 v[156:159], v[108:111], v[108:111], v[156:159]
    v_fmac_f32 v208, v148, v48
    v_fmac_f32 v209, v149, v49
    v_mfma_f32_16x16x32_bf16 v[160:163], v[112:115], v[104:107], 0
    v_fmac_f32 v217, v184, v67
    v_fmac_f32 v208, v150, v50
    v_mfma_f32_16x16x32_bf16 v[160:163], v[116:119], v[108:111], v[160:163]
    v_fmac_f32 v217, v185, v67
    v_fmac_f32 v209, v151, v51
    v_smfmac_f32_16x16x64_bf16 v[188:191], v[120:123], v[104:111], v250
    v_mad_u32_u16 v108, v206, s57, v213 op_sel:[0,0,0,0]
    v_mfma_f32_16x16x32_bf16 v[164:167], v[112:115], v[112:115], 0
    ds_read_b128 v[104:107], v108 offset:0
    ds_read_b128 v[108:111], v108 offset:64
    v_smfmac_f32_16x16x64_bf16 v[196:199], v[56:59], v[156:163], v216
    s_waitcnt lgkmcnt(4)
    v_mfma_f32_16x16x32_bf16 v[164:167], v[116:119], v[116:119], v[164:167]
    v_fmac_f32 v217, v188, v68
    v_fmac_f32 v208, v152, v52
    v_smfmac_f32_16x16x64_bf16 v[192:195], v[120:123], v[112:119], v250
    v_mad_u32_u16 v116, v206, s57, v213 op_sel:[1,0,0,0]
    v_mfma_f32_16x16x32_bf16 v[168:171], v[120:123], v[120:123], 0
    ds_read_b128 v[112:115], v116 offset:0
    v_mfma_f32_16x16x32_bf16 v[124:127], v[72:75], v[72:75], 0
    ds_read_b128 v[116:119], v116 offset:64
    v_mad_u32_u16 v122, v207, s57, v248 op_sel:[0,0,0,0]
    ds_read2_b32 v[120:121], v122 offset0:0 offset1:2
    v_mfma_f32_16x16x32_bf16 v[124:127], v[76:79], v[76:79], v[124:127]
    ds_read2_b32 v[122:123], v122 offset0:4 offset1:6
    ds_read_b128 v[204:207], v214 offset:4608
    v_mfma_f32_16x16x32_bf16 v[128:131], v[80:83], v[72:75], 0
    v_fmac_f32 v217, v189, v68
    v_fmac_f32 v217, v196, v200
    v_mfma_f32_16x16x32_bf16 v[128:131], v[84:87], v[76:79], v[128:131]
    v_fmac_f32 v217, v192, v69
    v_fmac_f32 v217, v197, v201
    v_mfma_f32_16x16x32_bf16 v[132:135], v[80:83], v[80:83], 0
    v_fmac_f32 v217, v193, v69
    v_fmac_f32 v217, v198, v202
    v_mfma_f32_16x16x32_bf16 v[132:135], v[84:87], v[84:87], v[132:135]
    v_fmac_f32 v217, v199, v203
    v_fmac_f32 v209, v153, v53
    v_mfma_f32_16x16x32_bf16 v[136:139], v[88:91], v[80:83], 0
    v_fmac_f32 v208, v154, v54
    v_fmac_f32 v209, v155, v55
    v_mfma_f32_16x16x32_bf16 v[136:139], v[92:95], v[84:87], v[136:139]
    v_fmac_f32 v208, v164, v60
    v_fmac_f32 v209, v165, v61
    v_mfma_f32_16x16x32_bf16 v[140:143], v[88:91], v[72:75], 0
    v_fmac_f32 v208, v166, v62
    v_fmac_f32 v209, v167, v63
    v_mfma_f32_16x16x32_bf16 v[140:143], v[92:95], v[76:79], v[140:143]
    s_waitcnt lgkmcnt(7)
    v_add_f32 v209, v209, v217
    v_smfmac_f32_16x16x64_bf16 v[196:199], v[8:11], v[132:139], v216
    v_fmac_f32 v208, v168, v70
    v_mfma_f32_16x16x32_bf16 v[144:147], v[96:99], v[72:75], 0
    v_fmac_f32 v208, v169, v71
    v_add_f32 v210, v208, v209
    v_mfma_f32_16x16x32_bf16 v[144:147], v[100:103], v[76:79], v[144:147]
    v_fma_f32 v208, v124, v0, -v217
    v_mul_f32 v209, v125, v1
    v_mfma_f32_16x16x32_bf16 v[148:151], v[80:83], v[96:99], 0
    v_fmac_f32 v208, v126, v2
    v_fmac_f32 v209, v127, v3
    v_mfma_f32_16x16x32_bf16 v[148:151], v[84:87], v[100:103], v[148:151]
    v_fmac_f32 v208, v128, v4
    v_fmac_f32 v209, v129, v5
    v_mfma_f32_16x16x32_bf16 v[152:155], v[88:91], v[96:99], 0
    v_fmac_f32 v208, v130, v6
    v_fmac_f32 v209, v131, v7
    v_mfma_f32_16x16x32_bf16 v[152:155], v[92:95], v[100:103], v[152:155]
    v_fmac_f32 v208, v140, v12
    v_fmac_f32 v209, v141, v13
    v_mfma_f32_16x16x32_bf16 v[156:159], v[88:91], v[88:91], 0
    v_fmac_f32 v208, v142, v14
    v_fmac_f32 v209, v143, v15
    v_mfma_f32_16x16x32_bf16 v[156:159], v[92:95], v[92:95], v[156:159]
    v_fmac_f32 v208, v144, v16
    v_fmac_f32 v209, v145, v17
    v_smfmac_f32_16x16x64_bf16 v[196:199], v[20:23], v[148:155], v216
    v_fmac_f32 v208, v146, v18
    v_mfma_f32_16x16x32_bf16 v[160:163], v[96:99], v[96:99], 0
    s_waitcnt lgkmcnt(0)
    v_fmac_f32 v209, v147, v19
    v_mfma_f32_16x16x32_bf16 v[160:163], v[100:103], v[100:103], v[160:163]
    v_fmac_f32 v208, v156, v24
    v_fmac_f32 v209, v157, v25
    v_mfma_f32_16x16x32_bf16 v[124:127], v[104:107], v[72:75], 0
    v_fmac_f32 v208, v158, v26
    v_fmac_f32 v209, v159, v27
    v_mfma_f32_16x16x32_bf16 v[124:127], v[108:111], v[76:79], v[124:127]
    v_permlane16_swap_b32 v218, v219
    s_add_u32 s74, s74, s77
    v_mfma_f32_16x16x32_bf16 v[128:131], v[112:115], v[72:75], 0
    v_fmac_f32 v208, v160, v28
    v_fmac_f32 v209, v161, v29
    v_mfma_f32_16x16x32_bf16 v[128:131], v[116:119], v[76:79], v[128:131]
    v_fmac_f32 v208, v162, v30
    v_fmac_f32 v209, v163, v31
    v_smfmac_f32_16x16x64_bf16 v[172:175], v[120:123], v[72:79], v250
    v_mad_u32_u16 v76, v204, s57, v213 op_sel:[0,0,0,0]
    v_mfma_f32_16x16x32_bf16 v[132:135], v[104:107], v[80:83], 0
    ds_read_b128 v[72:75], v76 offset:0
    ds_read_b128 v[76:79], v76 offset:64
    v_smfmac_f32_16x16x64_bf16 v[196:199], v[32:35], v[124:131], v216
    v_add_f32 v220, v218, v219
    v_mfma_f32_16x16x32_bf16 v[132:135], v[108:111], v[84:87], v[132:135]
    v_mul_f32 v217, v172, v64
    s_min_i32 s74, s74, s79
    v_mfma_f32_16x16x32_bf16 v[136:139], v[112:115], v[80:83], 0
    v_fmac_f32 v217, v173, v64
    s_max_i32 s74, s74, s78
    v_mfma_f32_16x16x32_bf16 v[136:139], v[116:119], v[84:87], v[136:139]
    v_smfmac_f32_16x16x64_bf16 v[176:179], v[120:123], v[80:87], v250
    v_mad_u32_u16 v84, v204, s57, v213 op_sel:[1,0,0,0]
    v_mfma_f32_16x16x32_bf16 v[140:143], v[104:107], v[88:91], 0
    ds_read_b128 v[80:83], v84 offset:0
    ds_read_b128 v[84:87], v84 offset:64
    v_mfma_f32_16x16x32_bf16 v[140:143], v[108:111], v[92:95], v[140:143]
    v_fmac_f32 v208, v132, v36
    v_fmac_f32 v209, v133, v37
    v_mfma_f32_16x16x32_bf16 v[144:147], v[112:115], v[88:91], 0
    v_fmac_f32 v217, v176, v65
    v_fmac_f32 v208, v134, v38
    v_mfma_f32_16x16x32_bf16 v[144:147], v[116:119], v[92:95], v[144:147]
    v_fmac_f32 v217, v177, v65
    v_fmac_f32 v209, v135, v39
    v_smfmac_f32_16x16x64_bf16 v[180:183], v[120:123], v[88:95], v250
    v_mad_u32_u16 v92, v205, s57, v213 op_sel:[0,0,0,0]
    v_mfma_f32_16x16x32_bf16 v[148:151], v[104:107], v[96:99], 0
    ds_read_b128 v[88:91], v92 offset:0
    ds_read_b128 v[92:95], v92 offset:64
    v_smfmac_f32_16x16x64_bf16 v[196:199], v[44:47], v[140:147], v216
    v_fmac_f32 v208, v136, v40
    v_mfma_f32_16x16x32_bf16 v[148:151], v[108:111], v[100:103], v[148:151]
    v_fmac_f32 v217, v180, v66
    v_fmac_f32 v209, v137, v41
    v_mfma_f32_16x16x32_bf16 v[152:155], v[112:115], v[96:99], 0
    v_fmac_f32 v217, v181, v66
    v_fmac_f32 v208, v138, v42
    v_mfma_f32_16x16x32_bf16 v[152:155], v[116:119], v[100:103], v[152:155]
    v_fmac_f32 v209, v139, v43
    v_smfmac_f32_16x16x64_bf16 v[184:187], v[120:123], v[96:103], v250
    v_mad_u32_u16 v100, v205, s57, v213 op_sel:[1,0,0,0]
    v_mfma_f32_16x16x32_bf16 v[156:159], v[104:107], v[104:107], 0
    ds_read_b128 v[96:99], v100 offset:0
    ds_read_b128 v[100:103], v100 offset:64
    v_mfma_f32_16x16x32_bf16 v[156:159], v[108:111], v[108:111], v[156:159]
    v_fmac_f32 v208, v148, v48
    v_fmac_f32 v209, v149, v49
    v_mfma_f32_16x16x32_bf16 v[160:163], v[112:115], v[104:107], 0
    v_fmac_f32 v217, v184, v67
    v_fmac_f32 v208, v150, v50
    v_mfma_f32_16x16x32_bf16 v[160:163], v[116:119], v[108:111], v[160:163]
    v_fmac_f32 v217, v185, v67
    v_fmac_f32 v209, v151, v51
    v_smfmac_f32_16x16x64_bf16 v[188:191], v[120:123], v[104:111], v250
    v_mad_u32_u16 v108, v206, s57, v213 op_sel:[0,0,0,0]
    v_mfma_f32_16x16x32_bf16 v[164:167], v[112:115], v[112:115], 0
    ds_read_b128 v[104:107], v108 offset:0
    ds_read_b128 v[108:111], v108 offset:64
    v_smfmac_f32_16x16x64_bf16 v[196:199], v[56:59], v[156:163], v216
    s_waitcnt lgkmcnt(4)
    v_mfma_f32_16x16x32_bf16 v[164:167], v[116:119], v[116:119], v[164:167]
    v_fmac_f32 v217, v188, v68
    v_fmac_f32 v208, v152, v52
    v_smfmac_f32_16x16x64_bf16 v[192:195], v[120:123], v[112:119], v250
    v_mad_u32_u16 v116, v206, s57, v213 op_sel:[1,0,0,0]
    v_mfma_f32_16x16x32_bf16 v[168:171], v[120:123], v[120:123], 0
    ds_read_b128 v[112:115], v116 offset:0
    v_mfma_f32_16x16x32_bf16 v[124:127], v[72:75], v[72:75], 0
    ds_read_b128 v[116:119], v116 offset:64
    v_mad_u32_u16 v122, v207, s57, v248 op_sel:[0,0,0,0]
    ds_read2_b32 v[120:121], v122 offset0:0 offset1:2
    v_mfma_f32_16x16x32_bf16 v[124:127], v[76:79], v[76:79], v[124:127]
    ds_read2_b32 v[122:123], v122 offset0:4 offset1:6
    ds_read_b128 v[204:207], v214 offset:6912
    v_mfma_f32_16x16x32_bf16 v[128:131], v[80:83], v[72:75], 0
    v_fmac_f32 v217, v189, v68
    v_fmac_f32 v217, v196, v200
    v_mfma_f32_16x16x32_bf16 v[128:131], v[84:87], v[76:79], v[128:131]
    v_fmac_f32 v217, v192, v69
    v_fmac_f32 v217, v197, v201
    v_mfma_f32_16x16x32_bf16 v[132:135], v[80:83], v[80:83], 0
    v_fmac_f32 v217, v193, v69
    v_fmac_f32 v217, v198, v202
    v_mfma_f32_16x16x32_bf16 v[132:135], v[84:87], v[84:87], v[132:135]
    v_fmac_f32 v217, v199, v203
    v_fmac_f32 v209, v153, v53
    v_mfma_f32_16x16x32_bf16 v[136:139], v[88:91], v[80:83], 0
    v_fmac_f32 v208, v154, v54
    v_fmac_f32 v209, v155, v55
    v_mfma_f32_16x16x32_bf16 v[136:139], v[92:95], v[84:87], v[136:139]
    v_fmac_f32 v208, v164, v60
    v_fmac_f32 v209, v165, v61
    v_mfma_f32_16x16x32_bf16 v[140:143], v[88:91], v[72:75], 0
    v_fmac_f32 v208, v166, v62
    v_fmac_f32 v209, v167, v63
    v_mfma_f32_16x16x32_bf16 v[140:143], v[92:95], v[76:79], v[140:143]
    s_waitcnt lgkmcnt(7)
    v_add_f32 v209, v209, v217
    v_smfmac_f32_16x16x64_bf16 v[196:199], v[8:11], v[132:139], v216
    v_fmac_f32 v208, v168, v70
    v_mfma_f32_16x16x32_bf16 v[144:147], v[96:99], v[72:75], 0
    v_fmac_f32 v208, v169, v71
    v_add_f32 v211, v208, v209
    v_mfma_f32_16x16x32_bf16 v[144:147], v[100:103], v[76:79], v[144:147]
    v_fma_f32 v208, v124, v0, -v217
    v_mul_f32 v209, v125, v1
    v_mfma_f32_16x16x32_bf16 v[148:151], v[80:83], v[96:99], 0
    v_fmac_f32 v208, v126, v2
    v_fmac_f32 v209, v127, v3
    v_mfma_f32_16x16x32_bf16 v[148:151], v[84:87], v[100:103], v[148:151]
    v_fmac_f32 v208, v128, v4
    v_fmac_f32 v209, v129, v5
    v_mfma_f32_16x16x32_bf16 v[152:155], v[88:91], v[96:99], 0
    v_fmac_f32 v208, v130, v6
    v_fmac_f32 v209, v131, v7
    v_mfma_f32_16x16x32_bf16 v[152:155], v[92:95], v[100:103], v[152:155]
    v_fmac_f32 v208, v140, v12
    v_fmac_f32 v209, v141, v13
    v_mfma_f32_16x16x32_bf16 v[156:159], v[88:91], v[88:91], 0
    v_fmac_f32 v208, v142, v14
    v_fmac_f32 v209, v143, v15
    v_mfma_f32_16x16x32_bf16 v[156:159], v[92:95], v[92:95], v[156:159]
    v_fmac_f32 v208, v144, v16
    v_fmac_f32 v209, v145, v17
    v_smfmac_f32_16x16x64_bf16 v[196:199], v[20:23], v[148:155], v216
    v_fmac_f32 v208, v146, v18
    v_mfma_f32_16x16x32_bf16 v[160:163], v[96:99], v[96:99], 0
    s_waitcnt lgkmcnt(0)
    v_fmac_f32 v209, v147, v19
    v_mfma_f32_16x16x32_bf16 v[160:163], v[100:103], v[100:103], v[160:163]
    v_fmac_f32 v208, v156, v24
    v_fmac_f32 v209, v157, v25
    v_mfma_f32_16x16x32_bf16 v[124:127], v[104:107], v[72:75], 0
    v_fmac_f32 v208, v158, v26
    v_fmac_f32 v209, v159, v27
    v_mfma_f32_16x16x32_bf16 v[124:127], v[108:111], v[76:79], v[124:127]
    v_permlane32_swap_b32 v210, v211
    s_waitcnt vmcnt(1)
    v_mfma_f32_16x16x32_bf16 v[128:131], v[112:115], v[72:75], 0
    v_fmac_f32 v208, v160, v28
    v_fmac_f32 v209, v161, v29
    v_mfma_f32_16x16x32_bf16 v[128:131], v[116:119], v[76:79], v[128:131]
    v_fmac_f32 v208, v162, v30
    v_fmac_f32 v209, v163, v31
    v_smfmac_f32_16x16x64_bf16 v[172:175], v[120:123], v[72:79], v250
    v_mad_u32_u16 v76, v204, s57, v213 op_sel:[0,0,0,0]
    v_mfma_f32_16x16x32_bf16 v[132:135], v[104:107], v[80:83], 0
    ds_read_b128 v[72:75], v76 offset:0
    ds_read_b128 v[76:79], v76 offset:64
    v_smfmac_f32_16x16x64_bf16 v[196:199], v[32:35], v[124:131], v216
    v_add_f32 v218, v210, v211
    v_mfma_f32_16x16x32_bf16 v[132:135], v[108:111], v[84:87], v[132:135]
    v_mul_f32 v217, v172, v64
    ds_write_b16 v215, v240 offset:0
    v_mfma_f32_16x16x32_bf16 v[136:139], v[112:115], v[80:83], 0
    v_fmac_f32 v217, v173, v64
    ds_write_b16 v215, v241 offset:576
    v_mfma_f32_16x16x32_bf16 v[136:139], v[116:119], v[84:87], v[136:139]
    ds_write_b16 v215, v242 offset:1152
    ds_write_b16 v215, v243 offset:1728
    v_smfmac_f32_16x16x64_bf16 v[176:179], v[120:123], v[80:87], v250
    v_mad_u32_u16 v84, v204, s57, v213 op_sel:[1,0,0,0]
    v_mfma_f32_16x16x32_bf16 v[140:143], v[104:107], v[88:91], 0
    ds_read_b128 v[80:83], v84 offset:0
    ds_read_b128 v[84:87], v84 offset:64
    v_mfma_f32_16x16x32_bf16 v[140:143], v[108:111], v[92:95], v[140:143]
    v_fmac_f32 v208, v132, v36
    v_fmac_f32 v209, v133, v37
    v_mfma_f32_16x16x32_bf16 v[144:147], v[112:115], v[88:91], 0
    v_fmac_f32 v217, v176, v65
    v_fmac_f32 v208, v134, v38
    v_mfma_f32_16x16x32_bf16 v[144:147], v[116:119], v[92:95], v[144:147]
    v_fmac_f32 v217, v177, v65
    v_fmac_f32 v209, v135, v39
    v_smfmac_f32_16x16x64_bf16 v[180:183], v[120:123], v[88:95], v250
    v_mad_u32_u16 v92, v205, s57, v213 op_sel:[0,0,0,0]
    v_mfma_f32_16x16x32_bf16 v[148:151], v[104:107], v[96:99], 0
    ds_read_b128 v[88:91], v92 offset:0
    ds_read_b128 v[92:95], v92 offset:64
    v_smfmac_f32_16x16x64_bf16 v[196:199], v[44:47], v[140:147], v216
    v_fmac_f32 v208, v136, v40
    v_mfma_f32_16x16x32_bf16 v[148:151], v[108:111], v[100:103], v[148:151]
    v_fmac_f32 v217, v180, v66
    v_fmac_f32 v209, v137, v41
    v_mfma_f32_16x16x32_bf16 v[152:155], v[112:115], v[96:99], 0
    v_fmac_f32 v217, v181, v66
    v_fmac_f32 v208, v138, v42
    v_mfma_f32_16x16x32_bf16 v[152:155], v[116:119], v[100:103], v[152:155]
    v_fmac_f32 v209, v139, v43
    buffer_load_dwordx4 v[240:243], v249, s[16:19], s74 offen offset:0
    v_smfmac_f32_16x16x64_bf16 v[184:187], v[120:123], v[96:103], v250
    v_mad_u32_u16 v100, v205, s57, v213 op_sel:[1,0,0,0]
    v_mfma_f32_16x16x32_bf16 v[156:159], v[104:107], v[104:107], 0
    ds_read_b128 v[96:99], v100 offset:0
    ds_read_b128 v[100:103], v100 offset:64
    v_mfma_f32_16x16x32_bf16 v[156:159], v[108:111], v[108:111], v[156:159]
    v_fmac_f32 v208, v148, v48
    v_fmac_f32 v209, v149, v49
    v_mfma_f32_16x16x32_bf16 v[160:163], v[112:115], v[104:107], 0
    v_fmac_f32 v217, v184, v67
    v_fmac_f32 v208, v150, v50
    v_mfma_f32_16x16x32_bf16 v[160:163], v[116:119], v[108:111], v[160:163]
    v_fmac_f32 v217, v185, v67
    v_fmac_f32 v209, v151, v51
    v_smfmac_f32_16x16x64_bf16 v[188:191], v[120:123], v[104:111], v250
    v_mad_u32_u16 v108, v206, s57, v213 op_sel:[0,0,0,0]
    v_mfma_f32_16x16x32_bf16 v[164:167], v[112:115], v[112:115], 0
    ds_read_b128 v[104:107], v108 offset:0
    ds_read_b128 v[108:111], v108 offset:64
    v_smfmac_f32_16x16x64_bf16 v[196:199], v[56:59], v[156:163], v216
    s_waitcnt lgkmcnt(4)
    v_mfma_f32_16x16x32_bf16 v[164:167], v[116:119], v[116:119], v[164:167]
    v_fmac_f32 v217, v188, v68
    v_fmac_f32 v208, v152, v52
    v_smfmac_f32_16x16x64_bf16 v[192:195], v[120:123], v[112:119], v250
    v_mad_u32_u16 v116, v206, s57, v213 op_sel:[1,0,0,0]
    v_mfma_f32_16x16x32_bf16 v[168:171], v[120:123], v[120:123], 0
    ds_read_b128 v[112:115], v116 offset:0
    v_mfma_f32_16x16x32_bf16 v[124:127], v[72:75], v[72:75], 0
    ds_read_b128 v[116:119], v116 offset:64
    v_mad_u32_u16 v122, v207, s57, v248 op_sel:[0,0,0,0]
    ds_read2_b32 v[120:121], v122 offset0:0 offset1:2
    v_mfma_f32_16x16x32_bf16 v[124:127], v[76:79], v[76:79], v[124:127]
    ds_read2_b32 v[122:123], v122 offset0:4 offset1:6
    ds_read_b128 v[204:207], v214 offset:0
    v_mfma_f32_16x16x32_bf16 v[128:131], v[80:83], v[72:75], 0
    v_fmac_f32 v217, v189, v68
    v_fmac_f32 v217, v196, v200
    v_mfma_f32_16x16x32_bf16 v[128:131], v[84:87], v[76:79], v[128:131]
    v_fmac_f32 v217, v192, v69
    v_fmac_f32 v217, v197, v201
    v_mfma_f32_16x16x32_bf16 v[132:135], v[80:83], v[80:83], 0
    v_fmac_f32 v217, v193, v69
    v_fmac_f32 v217, v198, v202
    v_mfma_f32_16x16x32_bf16 v[132:135], v[84:87], v[84:87], v[132:135]
    v_fmac_f32 v217, v199, v203
    v_fmac_f32 v209, v153, v53
    v_mfma_f32_16x16x32_bf16 v[136:139], v[88:91], v[80:83], 0
    v_fmac_f32 v208, v154, v54
    v_fmac_f32 v209, v155, v55
    v_mfma_f32_16x16x32_bf16 v[136:139], v[92:95], v[84:87], v[136:139]
    v_fmac_f32 v208, v164, v60
    v_fmac_f32 v209, v165, v61
    v_mfma_f32_16x16x32_bf16 v[140:143], v[88:91], v[72:75], 0
    v_fmac_f32 v208, v166, v62
    v_fmac_f32 v209, v167, v63
    v_mfma_f32_16x16x32_bf16 v[140:143], v[92:95], v[76:79], v[140:143]
    s_waitcnt lgkmcnt(7)
    v_add_f32 v209, v209, v217
    v_smfmac_f32_16x16x64_bf16 v[196:199], v[8:11], v[132:139], v216
    v_fmac_f32 v208, v168, v70
    v_mfma_f32_16x16x32_bf16 v[144:147], v[96:99], v[72:75], 0
    v_fmac_f32 v208, v169, v71
    v_add_f32 v210, v208, v209
    v_mfma_f32_16x16x32_bf16 v[144:147], v[100:103], v[76:79], v[144:147]
    v_fma_f32 v208, v124, v0, -v217
    v_mul_f32 v209, v125, v1
    v_mfma_f32_16x16x32_bf16 v[148:151], v[80:83], v[96:99], 0
    v_fmac_f32 v208, v126, v2
    v_fmac_f32 v209, v127, v3
    v_mfma_f32_16x16x32_bf16 v[148:151], v[84:87], v[100:103], v[148:151]
    v_fmac_f32 v208, v128, v4
    v_fmac_f32 v209, v129, v5
    v_mfma_f32_16x16x32_bf16 v[152:155], v[88:91], v[96:99], 0
    v_fmac_f32 v208, v130, v6
    v_fmac_f32 v209, v131, v7
    v_mfma_f32_16x16x32_bf16 v[152:155], v[92:95], v[100:103], v[152:155]
    v_fmac_f32 v208, v140, v12
    v_fmac_f32 v209, v141, v13
    v_mfma_f32_16x16x32_bf16 v[156:159], v[88:91], v[88:91], 0
    v_fmac_f32 v208, v142, v14
    v_fmac_f32 v209, v143, v15
    v_mfma_f32_16x16x32_bf16 v[156:159], v[92:95], v[92:95], v[156:159]
    v_fmac_f32 v208, v144, v16
    v_fmac_f32 v209, v145, v17
    v_smfmac_f32_16x16x64_bf16 v[196:199], v[20:23], v[148:155], v216
    v_fmac_f32 v208, v146, v18
    v_mfma_f32_16x16x32_bf16 v[160:163], v[96:99], v[96:99], 0
    s_waitcnt lgkmcnt(0)
    v_fmac_f32 v209, v147, v19
    v_mfma_f32_16x16x32_bf16 v[160:163], v[100:103], v[100:103], v[160:163]
    v_fmac_f32 v208, v156, v24
    v_fmac_f32 v209, v157, v25
    v_mfma_f32_16x16x32_bf16 v[124:127], v[104:107], v[72:75], 0
    v_fmac_f32 v208, v158, v26
    v_fmac_f32 v209, v159, v27
    v_mfma_f32_16x16x32_bf16 v[124:127], v[108:111], v[76:79], v[124:127]
    v_add_f32_dpp v220, v220, v220 quad_perm:[1,0,3,2] row_mask:0xf bank_mask:0xf
    s_sub_u32 s58, s58, 1
    v_mfma_f32_16x16x32_bf16 v[128:131], v[112:115], v[72:75], 0
    v_fmac_f32 v208, v160, v28
    v_fmac_f32 v209, v161, v29
    v_mfma_f32_16x16x32_bf16 v[128:131], v[116:119], v[76:79], v[128:131]
    v_fmac_f32 v208, v162, v30
    v_fmac_f32 v209, v163, v31
    v_smfmac_f32_16x16x64_bf16 v[172:175], v[120:123], v[72:79], v250
    v_mad_u32_u16 v76, v204, s57, v213 op_sel:[0,0,0,0]
    v_mfma_f32_16x16x32_bf16 v[132:135], v[104:107], v[80:83], 0
    ds_read_b128 v[72:75], v76 offset:0
    ds_read_b128 v[76:79], v76 offset:64
    v_smfmac_f32_16x16x64_bf16 v[196:199], v[32:35], v[124:131], v216
    v_add_f32_dpp v220, v220, v220 quad_perm:[2,3,0,1] row_mask:0xf bank_mask:0xf
    v_mfma_f32_16x16x32_bf16 v[132:135], v[108:111], v[84:87], v[132:135]
    v_mul_f32 v217, v172, v64
    v_mfma_f32_16x16x32_bf16 v[136:139], v[112:115], v[80:83], 0
    v_fmac_f32 v217, v173, v64
    v_add_f32_dpp v220, v220, v220 row_half_mirror row_mask:0xf bank_mask:0xf
    v_mfma_f32_16x16x32_bf16 v[136:139], v[116:119], v[84:87], v[136:139]
    v_smfmac_f32_16x16x64_bf16 v[176:179], v[120:123], v[80:87], v250
    v_mad_u32_u16 v84, v204, s57, v213 op_sel:[1,0,0,0]
    v_mfma_f32_16x16x32_bf16 v[140:143], v[104:107], v[88:91], 0
    ds_read_b128 v[80:83], v84 offset:0
    ds_read_b128 v[84:87], v84 offset:64
    v_mfma_f32_16x16x32_bf16 v[140:143], v[108:111], v[92:95], v[140:143]
    v_fmac_f32 v208, v132, v36
    v_fmac_f32 v209, v133, v37
    v_mfma_f32_16x16x32_bf16 v[144:147], v[112:115], v[88:91], 0
    v_fmac_f32 v217, v176, v65
    v_fmac_f32 v208, v134, v38
    v_mfma_f32_16x16x32_bf16 v[144:147], v[116:119], v[92:95], v[144:147]
    v_fmac_f32 v217, v177, v65
    v_fmac_f32 v209, v135, v39
    v_smfmac_f32_16x16x64_bf16 v[180:183], v[120:123], v[88:95], v250
    v_mad_u32_u16 v92, v205, s57, v213 op_sel:[0,0,0,0]
    v_mfma_f32_16x16x32_bf16 v[148:151], v[104:107], v[96:99], 0
    ds_read_b128 v[88:91], v92 offset:0
    ds_read_b128 v[92:95], v92 offset:64
    v_smfmac_f32_16x16x64_bf16 v[196:199], v[44:47], v[140:147], v216
    v_fmac_f32 v208, v136, v40
    v_mfma_f32_16x16x32_bf16 v[148:151], v[108:111], v[100:103], v[148:151]
    v_fmac_f32 v217, v180, v66
    v_fmac_f32 v209, v137, v41
    v_mfma_f32_16x16x32_bf16 v[152:155], v[112:115], v[96:99], 0
    v_fmac_f32 v217, v181, v66
    v_fmac_f32 v208, v138, v42
    v_mfma_f32_16x16x32_bf16 v[152:155], v[116:119], v[100:103], v[152:155]
    v_fmac_f32 v209, v139, v43
    v_cndmask_b32_dpp v212, v212, v220, vcc row_shr:1 row_mask:0xf bank_mask:0xf bound_ctrl:0
    v_smfmac_f32_16x16x64_bf16 v[184:187], v[120:123], v[96:103], v250
    v_mad_u32_u16 v100, v205, s57, v213 op_sel:[1,0,0,0]
    v_mfma_f32_16x16x32_bf16 v[156:159], v[104:107], v[104:107], 0
    ds_read_b128 v[96:99], v100 offset:0
    ds_read_b128 v[100:103], v100 offset:64
    v_mfma_f32_16x16x32_bf16 v[156:159], v[108:111], v[108:111], v[156:159]
    v_fmac_f32 v208, v148, v48
    v_fmac_f32 v209, v149, v49
    v_mfma_f32_16x16x32_bf16 v[160:163], v[112:115], v[104:107], 0
    v_fmac_f32 v217, v184, v67
    v_fmac_f32 v208, v150, v50
    v_mfma_f32_16x16x32_bf16 v[160:163], v[116:119], v[108:111], v[160:163]
    v_fmac_f32 v217, v185, v67
    v_fmac_f32 v209, v151, v51
    v_smfmac_f32_16x16x64_bf16 v[188:191], v[120:123], v[104:111], v250
    v_mad_u32_u16 v108, v206, s57, v213 op_sel:[0,0,0,0]
    v_mfma_f32_16x16x32_bf16 v[164:167], v[112:115], v[112:115], 0
    ds_read_b128 v[104:107], v108 offset:0
    ds_read_b128 v[108:111], v108 offset:64
    v_smfmac_f32_16x16x64_bf16 v[196:199], v[56:59], v[156:163], v216
    s_waitcnt lgkmcnt(4)
    v_mfma_f32_16x16x32_bf16 v[164:167], v[116:119], v[116:119], v[164:167]
    v_fmac_f32 v217, v188, v68
    v_fmac_f32 v208, v152, v52
    v_smfmac_f32_16x16x64_bf16 v[192:195], v[120:123], v[112:119], v250
    v_mad_u32_u16 v116, v206, s57, v213 op_sel:[1,0,0,0]
    v_mfma_f32_16x16x32_bf16 v[168:171], v[120:123], v[120:123], 0
    ds_read_b128 v[112:115], v116 offset:0
    s_cbranch_scc0 k1_kernel_loop
    ds_read_b32 v43, v252 offset:24
    s_nop 7
    v_fmac_f32 v217, v189, v68
    v_fmac_f32 v217, v196, v200
    v_fmac_f32 v217, v192, v69
    v_fmac_f32 v217, v197, v201
    v_fmac_f32 v217, v193, v69
    v_fmac_f32 v217, v198, v202
    v_fmac_f32 v217, v199, v203
    v_fmac_f32 v209, v153, v53
    v_fmac_f32 v208, v154, v54
    v_fmac_f32 v209, v155, v55
    v_fmac_f32 v208, v164, v60
    v_fmac_f32 v209, v165, v61
    v_fmac_f32 v208, v166, v62
    v_fmac_f32 v209, v167, v63
    v_add_f32 v209, v209, v217
    v_fmac_f32 v208, v168, v70
    v_fmac_f32 v208, v169, v71
    v_add_f32 v211, v208, v209
    v_and_b32 v40, 7, v255
    s_mul_i32 s76, s36, 7
    v_permlane32_swap_b32 v210, v211
    v_add_f32 v219, v210, v211
    s_waitcnt lgkmcnt(0)
    v_lshrrev_b32 v41, 5, v255
    v_permlane16_swap_b32 v218, v219
    v_add_f32 v220, v218, v219
    s_xor_b32 s76, s76, 7
    v_bfe_u32 v42, v255, 4, 1
    v_add_f32_dpp v220, v220, v220 quad_perm:[1,0,3,2] row_mask:0xf bank_mask:0xf
    v_xor_b32 v40, s76, v40
    v_lshl_add_u32 v41, v42, 1, v41
    v_add_f32_dpp v220, v220, v220 quad_perm:[2,3,0,1] row_mask:0xf bank_mask:0xf
    s_lshl_b32 s74, s72, 2
    v_lshl_add_u32 v40, v40, 2, v41
    v_add_f32_dpp v220, v220, v220 row_half_mirror row_mask:0xf bank_mask:0xf
    v_cndmask_b32_dpp v212, v212, v220, vcc row_shr:1 row_mask:0xf bank_mask:0xf bound_ctrl:0
    s_lshl_b32 s76, s36, 16
    v_lshlrev_b32 v113, 2, v40
    v_add_f32_dpp v112, v212, v212 row_ror:8 row_mask:0xf bank_mask:0xf
    s_add_u32 s74, s74, s76
    s_add_u32 s74, s74, 29360128
    v_readfirstlane_b32 s64, v43
    s_waitcnt vmcnt(0)
    v_min_u32 v112, -2, v112
    s_branch k1_kernel_k2
k1_kernel_last:
    s_endpgm
.section .rodata,"a"
.p2align 6
.amdhsa_kernel standalone__deep_cross_pnn__recsys_kernel
  .amdhsa_next_free_vgpr 256
  .amdhsa_next_free_sgpr 102
  .amdhsa_accum_offset 256
  .amdhsa_group_segment_fixed_size 0
  .amdhsa_kernarg_size 80
  .amdhsa_user_sgpr_count 2
  .amdhsa_user_sgpr_kernarg_segment_ptr 1
  .amdhsa_system_sgpr_workgroup_id_x 1
.end_amdhsa_kernel
```

```asm
; @launch grid=(256,1,1) block=(512,1,1) lds=163840
.amdgcn_target "amdgcn-amd-amdhsa--gfx950"
.text
.globl standalone__deep_cross_pnn__recsys_kernel
.p2align 8
.type standalone__deep_cross_pnn__recsys_kernel,@function
standalone__deep_cross_pnn__recsys_kernel:

    s_cmp_ge_u32 s2, 256
    s_cbranch_scc1 k1_kernel_end

    s_load_dwordx8 s[4:11], s[0:1], 0
    s_load_dwordx2 s[12:13], s[0:1], 72
    s_load_dwordx2 s[52:53], s[0:1], 64

    v_cmp_gt_u32 vcc, 40, v0
    s_and_saveexec_b64 s[48:49], vcc
    s_cbranch_execz k1_kernel_ncp
    s_getpc_b64 s[46:47]
k1_kernel_pc:
    s_bfe_u32 s38, s2, 0x40003
    s_lshl_b32 s38, s38, 7
    v_lshl_add_u32 v2, v0, 11, s38
    v_min_u32 v2, k1_kernel_last-k1_kernel_pc, v2
    global_load_dword v250, v2, s[46:47]
k1_kernel_ncp:
    s_mov_b64 exec, s[48:49]

    v_lshrrev_b32 v1, 6, v0
    v_and_b32 v255, 63, v0
    s_bfe_u32 s36, s2, 0x10003
    v_readfirstlane_b32 s3, v1
    s_lshr_b32 s37, s2, 4
    s_lshl_b32 s37, s37, 3
    s_and_b32 s38, s2, 7
    s_or_b32 s37, s37, s38
    v_lshlrev_b32 v254, 4, v255
    v_mov_b32 v252, 144144
    v_mov_b32 v253, 1
    v_mov_b32 v40, 0
    v_lshl_add_u32 v41, v0, 2, v252
    v_cmp_gt_u32 vcc, 8, v0
    s_and_saveexec_b64 s[46:47], vcc
    ds_write_b32 v41, v40
    s_mov_b64 exec, s[46:47]
    v_mul_u32_u24 v6, 57, v255
    v_lshrrev_b32 v6, 9, v6
    v_mul_u32_u24 v5, 9, v6
    v_sub_u32 v5, v255, v5
    v_cmp_gt_u32 s[40:41], 8, v5
    s_lshl_b32 s38, s36, 7
    v_lshl_add_u32 v5, v5, 4, s38
    v_lshl_add_u32 v83, v6, 8, v5
    s_and_b32 s56, s3, 3
    s_bitset0_b32 s41, 31
    s_lshr_b32 s42, s2, 3
    s_mul_i32 s42, s42, 36
    s_lshr_b32 s42, s42, 5
    s_lshl_b32 s42, s42, 2
    s_add_u32 s42, s42, s56
    s_mov_b32 s43, s42
    s_mov_b32 s50, s36
    s_lshl_b32 s72, s37, 7
    s_lshl_b32 s73, s3, 5
    s_add_u32 s72, s72, s73
    s_mul_i32 s74, s72, 400
    s_mul_i32 s45, s36, 11200
    s_add_u32 s74, s74, s45
    s_lshl_b32 s38, s3, 10
    s_add_u32 m0, s38, 144384

    s_mov_b32 s18, 6553600
    s_mov_b32 s19, 0x00020000
    s_mov_b32 s22, 256000
    s_mov_b32 s23, 0x00020000
    s_mov_b32 s26, 20000
    s_mov_b32 s27, 0x00020000
    s_mov_b32 s30, 13107200
    s_mov_b32 s31, 0x00020000
    s_mov_b32 s34, 268435456
    s_mov_b32 s35, 0x00020000
    s_mov_b32 s14, 268435456
    s_mov_b32 s15, 0x00020000
    s_mov_b32 s54, 256
    s_mov_b32 s55, 0x00020000

    v_bfe_u32 v5, v255, 2, 2
    v_mul_u32_u24 v5, 200, v5
    v_and_b32 v6, 3, v255
    v_lshl_add_u32 v5, v6, 5, v5
    v_and_b32 v6, 32, v255
    v_lshl_add_u32 v5, v6, 2, v5
    v_and_b32 v6, 16, v255
    v_add_u32 v5, v5, v6
    s_movk_i32 s39, 19200
    s_cmp_ge_u32 s3, 4
    s_waitcnt lgkmcnt(0)
    s_barrier
    s_cbranch_scc1 k1_kernel_dma

    s_mov_b32 s24, s8
    s_and_b32 s25, s9, 0xffff
    buffer_load_dwordx4 v254, s[24:27], s38 offen lds
    s_add_u32 s38, s38, 4096
    s_add_u32 m0, s38, 144384
    s_mov_b32 s16, s4
    s_and_b32 s17, s5, 0xffff
    buffer_load_dwordx4 v254, s[24:27], s38 offen lds
    s_add_u32 s38, s38, 4096
    s_add_u32 m0, s38, 144384
    v_cmp_lt_u32 vcc, 24, v255
    buffer_load_dwordx4 v254, s[24:27], s38 offen lds
    s_add_u32 s38, s38, 4096
    s_add_u32 m0, s38, 144384
    v_subbrev_co_u32 v249, vcc, 0, v255, vcc
    buffer_load_dwordx4 v254, s[24:27], s38 offen lds
    s_add_u32 s38, s38, 4096
    s_min_u32 s38, s38, 18432
    s_add_u32 m0, s38, 144384
    v_min_u32 v249, 49, v249
    v_lshlrev_b32 v249, 4, v249
    buffer_load_dwordx4 v254, s[24:27], s38 offen lds
    buffer_load_dwordx4 v[232:235], v5, s[24:27], s39 offen
    buffer_load_dwordx4 v[240:243], v249, s[16:19], s74 offen offset:0
    buffer_load_dwordx4 v[244:247], v249, s[16:19], s74 offen offset:800

    s_mul_i32 s77, s36, -3200
    s_mul_i32 s78, s72, 400
    s_addk_i32 s77, 1600
    s_add_u32 s79, s78, 11200
    s_add_u32 s74, s74, s77

    s_branch k1_kernel_main
k1_kernel_dma:
    s_mov_b32 s20, s6
    s_and_b32 s21, s7, 0xffff
    s_mov_b64 exec, s[40:41]
k1_kernel_dml:

    s_min_u32 s38, s42, 142
    s_mul_i32 m0, s38, 1008
    s_mul_i32 s39, s38, 1792
    s_add_u32 s42, s42, 4
    buffer_load_dwordx4 v83, s[20:23], s39 offen lds
    s_cmp_ge_u32 s42, 144
    s_cselect_b32 s38, 144, 0
    s_sub_u32 s42, s42, s38
    s_cmp_lg_u32 s42, s43
    s_cbranch_scc1 k1_kernel_dml
    s_mov_b64 exec, -1

    s_mov_b32 s16, s4
    s_and_b32 s17, s5, 0xffff
    s_mov_b32 s20, s6
    s_and_b32 s21, s7, 0xffff
    s_mov_b32 s28, s10
    s_and_b32 s29, s11, 0xffff
    s_mov_b32 s32, s12
    s_and_b32 s33, s13, 0xffff
    s_and_b32 s13, s13, 0xffff
    s_and_b32 s53, s53, 0xffff
k1_kernel_aux:

    s_setprio 0
    v_mov_b32 v8, v255
    v_mov_b32 v9, v254
    v_mov_b32 v10, v253
    v_mov_b32 v11, v252
    s_mov_b32 s51, s2
    s_mov_b32 s64, 0
    s_mov_b32 s65, 0

k1_kernel_unit:

    s_bfe_u32 s60, s51, 0x10003
    s_lshr_b32 s38, s51, 7
    s_xnor_b32 s36, s60, s38
    s_and_b32 s36, s36, 1

    s_lshr_b32 s38, s51, 4
    s_and_b32 s39, s51, 7
    s_sub_u32 s57, 2, s36
    s_lshl_b32 s57, s39, s57
    s_lshl_b32 s37, s36, 5
    s_add_u32 s57, s57, s37
    s_add_u32 s57, s57, s56
    s_mul_i32 s37, s38, 48
    s_add_u32 s37, s37, s57
    s_lshl_b32 s38, s38, 1
    s_lshr_b32 s39, s39, 2
    s_add_u32 s38, s38, s39
    s_add_u32 s38, s38, 768
    s_and_b32 s57, s57, 7
    s_cmp_eq_u32 s57, 2
    s_cselect_b32 s38, s38, 1000
    s_lshl_b32 s39, s36, 1
    s_and_b32 s39, s39, s56
    s_cselect_b32 s57, s38, s37

    s_mov_b32 s63, s36
    s_mov_b32 s36, s60
    s_lshr_b32 s37, s51, 4
    s_lshl_b32 s37, s37, 3
    s_and_b32 s38, s51, 7
    s_or_b32 s37, s37, s38
    s_and_b32 s58, s56, 1
    s_lshl_b32 s59, s37, 1
    s_add_u32 s58, s58, s59
    s_lshr_b32 s59, s56, 1
    s_xor_b32 s62, s59, 1
    s_and_b32 s59, s59, s63
    s_add_u32 s61, s63, 6
    s_mul_i32 s61, s61, s62
    s_mul_i32 s60, s36, 12
    s_add_u32 s61, s61, s60
    s_mul_i32 s60, s58, 25600
    s_lshl4_add_u32 s60, s61, s60
    s_cmp_eq_u32 s61, 7
    s_cselect_b32 s38, 5, 99
    s_movk_i32 s61, 400
    v_lshrrev_b32 v1, 3, v8
    v_and_b32 v2, 7, v8
    v_cmp_ne_u32 vcc, s38, v2
    v_mul_u32_u24 v0, s61, v1
    v_cmp_gt_u32 s[48:49], 7, v2
    v_cndmask_b32 v5, 17, v2, vcc
    v_lshl_add_u32 v0, v5, 4, v0
    v_and_b32 v5, 15, v8
    v_and_b32 v6, 48, v8
    v_lshl_add_u32 v7, v5, 8, v6
    s_lshl_b32 s44, s56, 15
    s_xor_b32 s38, s50, 1
    s_lshl_b32 s38, s38, 7
    s_add_u32 s44, s44, s38

    s_mov_b64 exec, s[48:49]
    buffer_load_dwordx4 v[224:227], v0, s[16:19], s60 offen
    s_add_u32 s60, s60, 3200
    buffer_load_dwordx4 v[228:231], v0, s[16:19], s60 offen
    s_add_u32 s60, s60, 3200
    buffer_load_dwordx4 v[232:235], v0, s[16:19], s60 offen
    s_add_u32 s60, s60, 3200
    buffer_load_dwordx4 v[236:239], v0, s[16:19], s60 offen
    s_add_u32 s60, s60, 3200
    buffer_load_dwordx4 v[240:243], v0, s[16:19], s60 offen
    s_add_u32 s60, s60, 3200
    buffer_load_dwordx4 v[244:247], v0, s[16:19], s60 offen
    s_add_u32 s60, s60, 3200
    buffer_load_dwordx4 v[248:251], v0, s[16:19], s60 offen
    s_add_u32 s60, s60, 3200
    buffer_load_dwordx4 v[252:255], v0, s[16:19], s60 offen
    s_add_u32 s60, s60, 3200
    s_mov_b64 exec, -1

    s_lshr_b32 s78, s57, 5
    s_bfe_u32 s79, s57, 0x20003
    s_bfe_u32 s80, s57, 0x20001
    s_and_b32 s81, s57, 1
    s_lshl_b32 s77, s78, 2
    s_lshl_b32 s83, s81, 1
    s_add_u32 s77, s77, s83
    s_lshl_b32 s77, s77, 7
    s_lshl_b32 s83, s79, 5
    s_add_u32 s77, s77, s83
    s_lshl_b32 s83, s80, 3
    s_add_u32 s77, s77, s83
    s_lshl_b32 s77, s77, 10
    s_lshl_b32 s82, s78, 12
    s_lshl_b32 s83, s79, 10
    s_add_u32 s82, s82, s83
    s_lshl_b32 s83, s80, 8
    s_add_u32 s82, s82, s83
    s_lshl_b32 s83, s81, 7
    s_add_u32 s82, s82, s83
    s_mov_b32 s84, 205312
    v_lshrrev_b32 v3, 2, v8
    v_and_b32 v4, 3, v8
    v_mul_lo_u32 v14, v3, s84
    v_lshl_add_u32 v14, v4, 4, v14
    s_lshl_b32 s61, s56, 12
    s_add_u32 s61, s61, 147456
    v_and_b32 v3, 3, v3
    v_lshlrev_b32 v36, 6, v8
    v_lshl_add_u32 v36, v3, 4, v36
    v_add_u32 v36, s61, v36
    v_xor_b32 v37, 16, v36
    v_xor_b32 v38, 32, v36
    v_xor_b32 v39, 48, v36
    v_and_b32 v3, 48, v8
    v_xor_b32 v15, v3, v9
    v_add_u32 v15, s61, v15
    s_mov_b32 s84, 0x05040100
    s_mov_b32 s85, 0x07060302
    s_cmp_eq_u32 s64, 0
    s_cbranch_scc1 k1_kernel_nsig0
    s_waitcnt vmcnt(0)

k1_kernel_nsig0:

    s_waitcnt vmcnt(8)
    s_cmp_lg_u32 s64, 0
    s_cbranch_scc1 k1_kernel_nsig

    s_mov_b64 exec, 1
    ds_add_u32 v11, v10 offset:16
    s_mov_b64 exec, -1

k1_kernel_nsig:
    s_setprio 3

    s_lshl_b32 s61, s56, 12
    s_add_u32 s61, s61, 147456
    v_lshlrev_b32 v86, 2, v8
    v_add_u32 v86, s61, v86
    v_and_b32 v85, 0xffffff80, v86
    v_and_b32 v123, 32, v8
    s_add_u32 s61, s61, 256
    v_mul_u32_u24 v31, 56, v8
    v_add_u32 v31, s61, v31
    v_mul_u32_u24 v34, 56, v1
    v_lshl_add_u32 v34, v2, 3, v34
    v_add_u32 v34, s61, v34
    s_lshl_b32 s61, s62, s63
    v_add_u32 v2, s61, v2
    v_subrev_u32 v3, 5, v2
    v_min_u32 v2, v2, v3
    v_mov_b32 v13, 0
    v_mul_u32_u24 v2, 0x10001, v2
    v_lshlrev_b32 v2, 12, v2
    v_add_u32 v32, 67108864, v2
    v_add_u32 v33, 201328640, v2
    v_mov_b32 v71, 0xf00
    s_add_u32 s61, s63, 7
    s_xor_b32 s63, s63, 1
    s_cmp_eq_u32 s62, 1
    s_cselect_b32 s62, s61, s63
    s_mul_i32 s63, s36, 13
    s_add_u32 s62, s62, s63
    s_lshl_b32 s62, s62, 7
    s_and_b32 s63, s58, 127
    s_add_u32 s62, s62, s63
    s_lshl_b32 s62, s62, 10
    s_add_u32 s62, s62, 16777216
    s_cmp_eq_u32 s59, 1
    s_cselect_b32 s63, -16, 0x0ffffff0
    s_movk_i32 s66, 0x7c
    s_mov_b32 s67, 0x001f001f
    s_mov_b32 s75, 0x06040200
    v_mov_b32 v54, 0x08040201
    v_mov_b32 v55, 0x80402010

    s_lshl_b32 s72, s2, 15
    s_lshl_b32 s73, s56, 13
    s_add_u32 s72, s72, s73
    s_add_u32 s72, s72, 20971520
    s_lshl_b32 s73, s36, 9
    s_lshl2_add_u32 s73, s37, s73
    s_add_u32 s73, s73, s56
    s_lshl_b32 s73, s73, 7
    s_add_u32 s73, s73, 29360128

k1_kernel_wf3:

    ds_read_b32 v12, v11 offset:12
    s_waitcnt lgkmcnt(0)
    v_readfirstlane_b32 s45, v12
    s_cmp_lt_u32 s45, 4
    s_cbranch_scc1 k1_kernel_wf3

    s_mov_b64 exec, s[48:49]

    s_waitcnt vmcnt(7)
    v_lshl_or_b32 v224, v225, 16, v224
    v_lshl_or_b32 v225, v227, 16, v226
    v_add_u32 v224, v32, v224
    v_add_u32 v225, v33, v225
    ds_write_b64 v34, v[224:225] offset:0

    s_waitcnt vmcnt(6)
    v_lshl_or_b32 v228, v229, 16, v228
    v_lshl_or_b32 v229, v231, 16, v230
    v_add_u32 v228, v32, v228
    v_add_u32 v229, v33, v229
    ds_write_b64 v34, v[228:229] offset:448

    s_waitcnt vmcnt(5)
    v_lshl_or_b32 v232, v233, 16, v232
    v_lshl_or_b32 v233, v235, 16, v234
    v_add_u32 v232, v32, v232
    v_add_u32 v233, v33, v233
    ds_write_b64 v34, v[232:233] offset:896

    s_waitcnt vmcnt(4)
    v_lshl_or_b32 v236, v237, 16, v236
    v_lshl_or_b32 v237, v239, 16, v238
    v_add_u32 v236, v32, v236
    v_add_u32 v237, v33, v237
    ds_write_b64 v34, v[236:237] offset:1344

    s_waitcnt vmcnt(3)
    v_lshl_or_b32 v240, v241, 16, v240
    v_lshl_or_b32 v241, v243, 16, v242
    v_add_u32 v240, v32, v240
    v_add_u32 v241, v33, v241
    ds_write_b64 v34, v[240:241] offset:1792

    s_waitcnt vmcnt(2)
    v_lshl_or_b32 v244, v245, 16, v244
    v_lshl_or_b32 v245, v247, 16, v246
    v_add_u32 v244, v32, v244
    v_add_u32 v245, v33, v245
    ds_write_b64 v34, v[244:245] offset:2240

    s_waitcnt vmcnt(1)
    v_lshl_or_b32 v248, v249, 16, v248
    v_lshl_or_b32 v249, v251, 16, v250
    v_add_u32 v248, v32, v248
    v_add_u32 v249, v33, v249
    ds_write_b64 v34, v[248:249] offset:2688

    s_waitcnt vmcnt(0)
    v_lshl_or_b32 v252, v253, 16, v252
    v_lshl_or_b32 v253, v255, 16, v254
    v_add_u32 v252, v32, v252
    v_add_u32 v253, v33, v253
    ds_write_b64 v34, v[252:253] offset:3136

    s_mov_b64 exec, -1
    ds_read_b64 v[40:41], v31 offset:0
    ds_read_b64 v[42:43], v31 offset:8
    ds_read_b64 v[44:45], v31 offset:16
    ds_read_b64 v[46:47], v31 offset:24
    ds_read_b64 v[48:49], v31 offset:32
    ds_read_b64 v[50:51], v31 offset:40
    ds_read_b64 v[52:53], v31 offset:48

    s_waitcnt lgkmcnt(6)
    v_perm_b32 v72, v41, v40, s75
    v_lshrrev_b32 v73, 3, v72
    v_lshlrev_b32 v64, 2, v72
    v_and_b32 v72, 0x07070707, v72
    v_and_b32 v0, 0x03030303, v73
    v_perm_b32 v16, v55, v54, v72
    v_xor_b32 v23, v55, v16

    s_waitcnt lgkmcnt(5)
    v_perm_b32 v72, v43, v42, s75
    v_lshrrev_b32 v73, 3, v72
    v_lshlrev_b32 v65, 2, v72
    v_and_b32 v72, 0x07070707, v72
    v_and_b32 v1, 0x03030303, v73
    v_perm_b32 v17, v55, v54, v72
    v_xor_b32 v24, v55, v17

    s_waitcnt lgkmcnt(4)
    v_perm_b32 v72, v45, v44, s75
    v_lshrrev_b32 v73, 3, v72
    v_lshlrev_b32 v66, 2, v72
    v_and_b32 v72, 0x07070707, v72
    v_and_b32 v2, 0x03030303, v73
    v_perm_b32 v18, v55, v54, v72
    v_xor_b32 v25, v55, v18

    s_waitcnt lgkmcnt(3)
    v_perm_b32 v72, v47, v46, s75
    v_lshrrev_b32 v73, 3, v72
    v_lshlrev_b32 v67, 2, v72
    v_and_b32 v72, 0x07070707, v72
    v_and_b32 v3, 0x03030303, v73
    v_perm_b32 v19, v55, v54, v72
    v_xor_b32 v26, v55, v19

    s_waitcnt lgkmcnt(2)
    v_perm_b32 v72, v49, v48, s75
    v_lshrrev_b32 v73, 3, v72
    v_lshlrev_b32 v68, 2, v72
    v_and_b32 v72, 0x07070707, v72
    v_and_b32 v4, 0x03030303, v73
    v_perm_b32 v20, v55, v54, v72
    v_xor_b32 v27, v55, v20

    s_waitcnt lgkmcnt(1)
    v_perm_b32 v72, v51, v50, s75
    v_lshrrev_b32 v73, 3, v72
    v_lshlrev_b32 v69, 2, v72
    v_and_b32 v72, 0x07070707, v72
    v_and_b32 v5, 0x03030303, v73
    v_perm_b32 v21, v55, v54, v72
    v_xor_b32 v28, v55, v21

    s_waitcnt lgkmcnt(0)
    v_perm_b32 v72, v53, v52, s75
    v_lshrrev_b32 v73, 3, v72
    v_lshlrev_b32 v70, 2, v72
    v_and_b32 v72, 0x07070707, v72
    v_and_b32 v6, 0x03030303, v73
    v_perm_b32 v22, v55, v54, v72
    v_xor_b32 v29, v55, v22

    ds_write_b32 v86, v13
    v_mov_b32 v71, s63
    v_subrev_u32 v30, 8, v31
    s_setprio 0
    v_ffbl_b32 v84, v71

    v_perm_b32 v72, v64, v64, v84
    v_and_or_b32 v72, v72, s66, v85
    ds_add_rtn_u32 v87, v72, v10
    ds_wrxchg_rtn_b32 v116, v86, v13

    s_waitcnt lgkmcnt(0)
    v_cmp_gt_u32 s[68:69], 2, v116

    v_cmpx_lt_u32 vcc, 1, v87
    s_nop 0
    v_lshrrev_b64 v[74:75], v123, s[68:69]
    v_perm_b32 v121, v74, v74, v1
    v_perm_b32 v122, v74, v74, v0
    v_and_b32 v121, v121, v17
    v_and_b32 v122, v122, v16
    v_msad_u8 v120, v24, v121, 0
    v_lshlrev_b32 v120, 4, v120
    v_msad_u8 v120, v23, v122, v120
    v_and_b32 v120, v120, v71

    v_ffbl_b32 v120, v120
    v_max_i32 v84, v120, v84
    s_mov_b64 exec, -1

    v_lshl_add_u32 v73, v84, 1, v30
    v_lshl_add_u32 v71, -1, v84, v71
    ds_read_u16 v80, v73 offset:0
    v_ffbl_b32 v84, v71

    v_perm_b32 v72, v64, v64, v84
    v_and_or_b32 v72, v72, s66, v85
    ds_add_rtn_u32 v87, v72, v10
    ds_wrxchg_rtn_b32 v116, v86, v13

    s_lshl_b32 s45, s2, 8
    s_add_u32 s45, s45, 14680064
    s_mov_b64 exec, 3
    buffer_store_dword v13, v9, s[12:15], s45 offen sc1
    s_mov_b64 exec, -1
    buffer_load_dwordx4 v[128:131], v9, s[28:31], s77 offen offset:0

    s_waitcnt lgkmcnt(0)
    v_cmp_gt_u32 s[68:69], 2, v116

    v_cmpx_lt_u32 vcc, 1, v87
    s_nop 0
    v_lshrrev_b64 v[74:75], v123, s[68:69]
    v_perm_b32 v121, v74, v74, v1
    v_perm_b32 v122, v74, v74, v0
    v_and_b32 v121, v121, v17
    v_and_b32 v122, v122, v16
    v_msad_u8 v120, v24, v121, 0
    v_lshlrev_b32 v120, 4, v120
    v_msad_u8 v120, v23, v122, v120
    v_and_b32 v120, v120, v71

    v_ffbl_b32 v120, v120
    v_max_i32 v84, v120, v84
    s_mov_b64 exec, -1

    v_lshl_add_u32 v73, v84, 1, v30
    v_lshl_add_u32 v71, -1, v84, v71
    ds_read_u16 v81, v73 offset:0
    v_ffbl_b32 v84, v71

    v_perm_b32 v72, v64, v64, v84
    v_and_or_b32 v72, v72, s66, v85
    ds_add_rtn_u32 v87, v72, v10
    ds_wrxchg_rtn_b32 v116, v86, v13

    s_lshl_b32 s45, s2, 10
    s_add_u32 s45, s45, 30408704
    s_mov_b32 exec_lo, 0x01010101
    s_mov_b32 exec_hi, 0x01010101
    buffer_store_dword v13, v9, s[12:15], s45 offen sc1
    s_mul_i32 s45, s2, 67584
    s_add_u32 s45, s45, 67108864
    s_mov_b64 exec, 1
    buffer_load_dword v117, v13, s[12:15], s45 offen
    s_mov_b64 exec, -1
    buffer_load_dwordx4 v[132:135], v9, s[28:31], s77 offen offset:1024

    s_waitcnt lgkmcnt(0)
    v_cmp_gt_u32 s[68:69], 2, v116

    v_cmpx_lt_u32 vcc, 1, v87
    s_nop 0
    v_lshrrev_b64 v[74:75], v123, s[68:69]
    v_perm_b32 v121, v74, v74, v1
    v_perm_b32 v122, v74, v74, v0
    v_and_b32 v121, v121, v17
    v_and_b32 v122, v122, v16
    v_msad_u8 v120, v24, v121, 0
    v_lshlrev_b32 v120, 4, v120
    v_msad_u8 v120, v23, v122, v120
    v_and_b32 v120, v120, v71

    v_ffbl_b32 v120, v120
    v_max_i32 v84, v120, v84
    s_mov_b64 exec, -1

    v_lshl_add_u32 v73, v84, 1, v30
    v_lshl_add_u32 v71, -1, v84, v71
    ds_read_u16 v82, v73 offset:0
    v_ffbl_b32 v84, v71

    v_perm_b32 v72, v64, v64, v84
    v_and_or_b32 v72, v72, s66, v85
    ds_add_rtn_u32 v87, v72, v10
    ds_wrxchg_rtn_b32 v116, v86, v13

    buffer_load_dwordx4 v[144:147], v9, s[28:31], s77 offen offset:2048

    s_waitcnt lgkmcnt(0)
    v_cmp_gt_u32 s[68:69], 2, v116

    v_cmpx_lt_u32 vcc, 1, v87
    s_nop 0
    v_lshrrev_b64 v[74:75], v123, s[68:69]
    v_perm_b32 v121, v74, v74, v1
    v_and_b32 v121, v121, v17
    v_msad_u8 v120, v24, v121, 0
    v_lshlrev_b32 v120, 4, v120
    v_and_b32 v120, v120, v71

    v_ffbl_b32 v120, v120
    v_max_i32 v84, v120, v84
    s_mov_b64 exec, -1

    v_lshl_add_u32 v73, v84, 1, v30
    v_lshl_add_u32 v71, -1, v84, v71
    ds_read_u16 v83, v73 offset:0
    v_lshrrev_b32 v71, 4, v71
    v_ffbl_b32 v84, v71

    v_perm_b32 v72, v65, v64, v84
    v_and_or_b32 v72, v72, s66, v85
    ds_add_rtn_u32 v87, v72, v10
    ds_wrxchg_rtn_b32 v116, v86, v13

    buffer_load_dwordx4 v[148:151], v9, s[28:31], s77 offen offset:3072
    s_add_u32 s77, s77, 4096
    s_mov_b32 s70, 0x7fff7fff

    s_waitcnt lgkmcnt(0)
    v_cmp_gt_u32 s[68:69], 2, v116

    s_cmp_eq_u32 s59, 0
    v_lshl_or_b32 v76, v81, 16, v80
    v_lshl_or_b32 v77, v83, 16, v82
    s_cbranch_scc1 k1_kernel_nf0
    buffer_store_dwordx4 v[76:79], v9, s[32:35], s62 offen sc1
    s_add_u32 s62, s62, 262144
k1_kernel_nf0:
    v_cmpx_lt_u32 vcc, 1, v87
    v_bfe_i32 v119, s70, v71, 1
    v_lshrrev_b64 v[74:75], v123, s[68:69]
    v_perm_b32 v121, v74, v74, v2
    v_perm_b32 v122, v74, v74, v1
    v_and_b32 v121, v121, v18
    v_and_b32 v122, v122, v17
    v_msad_u8 v120, v25, v121, 0
    v_lshlrev_b32 v120, 4, v120
    v_msad_u8 v120, v24, v122, v120
    v_bitop3_b32 v120, v120, v71, v119 bitop3:0x80

    v_ffbl_b32 v120, v120
    v_max_i32 v84, v120, v84
    s_mov_b64 exec, -1

    v_lshl_add_u32 v73, v84, 1, v30
    v_lshl_add_u32 v71, -1, v84, v71
    ds_read_u16 v80, v73 offset:8
    v_ffbl_b32 v84, v71

    v_perm_b32 v72, v65, v64, v84
    v_and_or_b32 v72, v72, s66, v85
    ds_add_rtn_u32 v87, v72, v10
    ds_wrxchg_rtn_b32 v116, v86, v13

    buffer_load_dwordx4 v[160:163], v9, s[28:31], s77 offen offset:0
    s_mov_b32 s70, 0x977f977f

    s_waitcnt lgkmcnt(0)
    v_cmp_gt_u32 s[68:69], 2, v116

    v_cmpx_lt_u32 vcc, 1, v87
    v_bfe_i32 v119, s70, v71, 1
    v_lshrrev_b64 v[74:75], v123, s[68:69]
    v_perm_b32 v121, v74, v74, v2
    v_perm_b32 v122, v74, v74, v1
    v_and_b32 v121, v121, v18
    v_and_b32 v122, v122, v17
    v_msad_u8 v120, v25, v121, 0
    v_lshlrev_b32 v120, 4, v120
    v_msad_u8 v120, v24, v122, v120
    v_bitop3_b32 v120, v120, v71, v119 bitop3:0x80

    v_ffbl_b32 v120, v120
    v_max_i32 v84, v120, v84
    s_mov_b64 exec, -1

    v_lshl_add_u32 v73, v84, 1, v30
    v_lshl_add_u32 v71, -1, v84, v71
    ds_read_u16 v81, v73 offset:8
    v_ffbl_b32 v84, v71

    v_perm_b32 v72, v65, v64, v84
    v_and_or_b32 v72, v72, s66, v85
    ds_add_rtn_u32 v87, v72, v10
    ds_wrxchg_rtn_b32 v116, v86, v13

    buffer_load_dwordx4 v[164:167], v9, s[28:31], s77 offen offset:1024
    s_mov_b32 s70, 0xe997e997

    s_waitcnt lgkmcnt(0)
    v_cmp_gt_u32 s[68:69], 2, v116

    v_cmpx_lt_u32 vcc, 1, v87
    v_bfe_i32 v119, s70, v71, 1
    v_lshrrev_b64 v[74:75], v123, s[68:69]
    v_perm_b32 v121, v74, v74, v2
    v_perm_b32 v122, v74, v74, v1
    v_and_b32 v121, v121, v18
    v_and_b32 v122, v122, v17
    v_msad_u8 v120, v25, v121, 0
    v_lshlrev_b32 v120, 4, v120
    v_msad_u8 v120, v24, v122, v120
    v_bitop3_b32 v120, v120, v71, v119 bitop3:0x80

    v_ffbl_b32 v120, v120
    v_max_i32 v84, v120, v84
    s_mov_b64 exec, -1

    v_lshl_add_u32 v73, v84, 1, v30
    v_lshl_add_u32 v71, -1, v84, v71
    ds_read_u16 v82, v73 offset:8
    v_ffbl_b32 v84, v71

    v_perm_b32 v72, v65, v64, v84
    v_and_or_b32 v72, v72, s66, v85
    ds_add_rtn_u32 v87, v72, v10
    ds_wrxchg_rtn_b32 v116, v86, v13

    buffer_load_dwordx4 v[176:179], v9, s[28:31], s77 offen offset:2048
    s_add_u32 s47, s44, 12288
    buffer_load_dwordx4 v[56:59], v7, s[20:23], s47 offen offset:0
    buffer_load_dwordx4 v[60:63], v7, s[20:23], s47 offen offset:64
    s_mov_b32 s70, 0xfee9fee9

    s_waitcnt lgkmcnt(0)
    v_cmp_gt_u32 s[68:69], 2, v116

    v_cmpx_lt_u32 vcc, 1, v87
    v_bfe_i32 v119, s70, v71, 1
    v_lshrrev_b64 v[74:75], v123, s[68:69]
    v_perm_b32 v121, v74, v74, v2
    v_and_b32 v121, v121, v18
    v_msad_u8 v120, v25, v121, 0
    v_lshlrev_b32 v120, 4, v120
    v_bitop3_b32 v120, v120, v71, v119 bitop3:0x80

    v_ffbl_b32 v120, v120
    v_max_i32 v84, v120, v84
    s_mov_b64 exec, -1

    v_lshl_add_u32 v73, v84, 1, v30
    v_lshl_add_u32 v71, -1, v84, v71
    ds_read_u16 v83, v73 offset:8
    v_lshrrev_b32 v71, 4, v71
    v_ffbl_b32 v84, v71

    v_perm_b32 v72, v66, v65, v84
    v_and_or_b32 v72, v72, s66, v85
    ds_add_rtn_u32 v87, v72, v10
    ds_wrxchg_rtn_b32 v116, v86, v13

    buffer_load_dwordx4 v[180:183], v9, s[28:31], s77 offen offset:3072
    s_add_u32 s77, s77, 126976
    s_cmp_lg_u32 s64, 0
    s_cbranch_scc1 k1_kernel_nc8
    v_mov_b32 v121, -1
    v_lshlrev_b32 v122, 1, v8
    buffer_store_short v121, v122, s[12:15], s73 offen sc1
k1_kernel_nc8:
    s_add_u32 s47, s44, 16384
    buffer_load_dwordx4 v[88:91], v7, s[20:23], s47 offen offset:0
    buffer_load_dwordx4 v[92:95], v7, s[20:23], s47 offen offset:64
    s_mov_b32 s70, 0x7fff7fff

    s_waitcnt lgkmcnt(0)
    v_cmp_gt_u32 s[68:69], 2, v116

    s_cmp_eq_u32 s59, 1
    v_lshl_or_b32 v78, v81, 16, v80
    v_lshl_or_b32 v79, v83, 16, v82
    s_cbranch_scc1 k1_kernel_nf1
    buffer_store_dwordx4 v[76:79], v9, s[32:35], s62 offen sc1
    s_add_u32 s62, s62, 262144
k1_kernel_nf1:
    v_cmpx_lt_u32 vcc, 1, v87
    v_bfe_i32 v119, s70, v71, 1
    v_lshrrev_b64 v[74:75], v123, s[68:69]
    v_perm_b32 v121, v74, v74, v3
    v_perm_b32 v122, v74, v74, v2
    v_and_b32 v121, v121, v19
    v_and_b32 v122, v122, v18
    v_msad_u8 v120, v26, v121, 0
    v_lshlrev_b32 v120, 4, v120
    v_msad_u8 v120, v25, v122, v120
    v_bitop3_b32 v120, v120, v71, v119 bitop3:0x80

    v_ffbl_b32 v120, v120
    v_max_i32 v84, v120, v84
    s_mov_b64 exec, -1

    v_lshl_add_u32 v73, v84, 1, v30
    v_lshl_add_u32 v71, -1, v84, v71
    ds_read_u16 v80, v73 offset:16
    v_ffbl_b32 v84, v71

    v_perm_b32 v72, v66, v65, v84
    v_and_or_b32 v72, v72, s66, v85
    ds_add_rtn_u32 v87, v72, v10
    ds_wrxchg_rtn_b32 v116, v86, v13

    buffer_load_dwordx4 v[192:195], v9, s[28:31], s77 offen offset:0
    s_add_u32 s47, s44, 20480
    buffer_load_dwordx4 v[96:99], v7, s[20:23], s47 offen offset:0
    buffer_load_dwordx4 v[100:103], v7, s[20:23], s47 offen offset:64
    s_mov_b32 s70, 0x977f977f

    s_waitcnt lgkmcnt(0)
    v_cmp_gt_u32 s[68:69], 2, v116

    v_cmpx_lt_u32 vcc, 1, v87
    v_bfe_i32 v119, s70, v71, 1
    v_lshrrev_b64 v[74:75], v123, s[68:69]
    v_perm_b32 v121, v74, v74, v3
    v_perm_b32 v122, v74, v74, v2
    v_and_b32 v121, v121, v19
    v_and_b32 v122, v122, v18
    v_msad_u8 v120, v26, v121, 0
    v_lshlrev_b32 v120, 4, v120
    v_msad_u8 v120, v25, v122, v120
    v_bitop3_b32 v120, v120, v71, v119 bitop3:0x80

    v_ffbl_b32 v120, v120
    v_max_i32 v84, v120, v84
    s_mov_b64 exec, -1

    v_lshl_add_u32 v73, v84, 1, v30
    v_lshl_add_u32 v71, -1, v84, v71
    ds_read_u16 v81, v73 offset:16
    v_ffbl_b32 v84, v71

    v_perm_b32 v72, v66, v65, v84
    v_and_or_b32 v72, v72, s66, v85
    ds_add_rtn_u32 v87, v72, v10
    ds_wrxchg_rtn_b32 v116, v86, v13

    buffer_load_dwordx4 v[196:199], v9, s[28:31], s77 offen offset:1024
    s_add_u32 s47, s44, 24576
    buffer_load_dwordx4 v[104:107], v7, s[20:23], s47 offen offset:0
    buffer_load_dwordx4 v[108:111], v7, s[20:23], s47 offen offset:64
    s_mov_b32 s70, 0xe997e997

    s_waitcnt lgkmcnt(0)
    v_cmp_gt_u32 s[68:69], 2, v116

    v_cmpx_lt_u32 vcc, 1, v87
    v_bfe_i32 v119, s70, v71, 1
    v_lshrrev_b64 v[74:75], v123, s[68:69]
    v_perm_b32 v121, v74, v74, v3
    v_perm_b32 v122, v74, v74, v2
    v_and_b32 v121, v121, v19
    v_and_b32 v122, v122, v18
    v_msad_u8 v120, v26, v121, 0
    v_lshlrev_b32 v120, 4, v120
    v_msad_u8 v120, v25, v122, v120
    v_bitop3_b32 v120, v120, v71, v119 bitop3:0x80

    v_ffbl_b32 v120, v120
    v_max_i32 v84, v120, v84
    s_mov_b64 exec, -1

    v_lshl_add_u32 v73, v84, 1, v30
    v_lshl_add_u32 v71, -1, v84, v71
    ds_read_u16 v82, v73 offset:16
    v_ffbl_b32 v84, v71

    v_perm_b32 v72, v66, v65, v84
    v_and_or_b32 v72, v72, s66, v85
    ds_add_rtn_u32 v87, v72, v10
    ds_wrxchg_rtn_b32 v116, v86, v13

    buffer_load_dwordx4 v[208:211], v9, s[28:31], s77 offen offset:2048
    s_add_u32 s47, s44, 28672
    buffer_load_dwordx4 v[112:115], v7, s[20:23], s47 offen offset:0
    buffer_load_dwordx4 v[124:127], v7, s[20:23], s47 offen offset:64
    s_mov_b32 s70, 0xfee9fee9

    s_waitcnt lgkmcnt(0)
    v_cmp_gt_u32 s[68:69], 2, v116

    v_cmpx_lt_u32 vcc, 1, v87
    v_bfe_i32 v119, s70, v71, 1
    v_lshrrev_b64 v[74:75], v123, s[68:69]
    v_perm_b32 v121, v74, v74, v3
    v_and_b32 v121, v121, v19
    v_msad_u8 v120, v26, v121, 0
    v_lshlrev_b32 v120, 4, v120
    v_bitop3_b32 v120, v120, v71, v119 bitop3:0x80

    v_ffbl_b32 v120, v120
    v_max_i32 v84, v120, v84
    s_mov_b64 exec, -1

    v_lshl_add_u32 v73, v84, 1, v30
    v_lshl_add_u32 v71, -1, v84, v71
    ds_read_u16 v83, v73 offset:16
    v_lshrrev_b32 v71, 4, v71
    v_ffbl_b32 v84, v71

    v_perm_b32 v72, v67, v66, v84
    v_and_or_b32 v72, v72, s66, v85
    ds_add_rtn_u32 v87, v72, v10
    ds_wrxchg_rtn_b32 v116, v86, v13

    buffer_load_dwordx4 v[212:215], v9, s[28:31], s77 offen offset:3072
    s_add_u32 s77, s77, 4096
    s_add_u32 s47, s44, 131072
    buffer_load_dwordx4 v[136:139], v7, s[20:23], s47 offen offset:0
    buffer_load_dwordx4 v[140:143], v7, s[20:23], s47 offen offset:64
    s_mov_b32 s70, 0x7fff7fff

    s_waitcnt lgkmcnt(0)
    v_cmp_gt_u32 s[68:69], 2, v116

    s_cmp_eq_u32 s59, 0
    v_lshl_or_b32 v76, v81, 16, v80
    v_lshl_or_b32 v77, v83, 16, v82
    s_cbranch_scc1 k1_kernel_nf2
    buffer_store_dwordx4 v[76:79], v9, s[32:35], s62 offen sc1
    s_add_u32 s62, s62, 262144
k1_kernel_nf2:
    v_cmpx_lt_u32 vcc, 1, v87
    v_bfe_i32 v119, s70, v71, 1
    v_lshrrev_b64 v[74:75], v123, s[68:69]
    v_perm_b32 v121, v74, v74, v4
    v_perm_b32 v122, v74, v74, v3
    v_and_b32 v121, v121, v20
    v_and_b32 v122, v122, v19
    v_msad_u8 v120, v27, v121, 0
    v_lshlrev_b32 v120, 4, v120
    v_msad_u8 v120, v26, v122, v120
    v_bitop3_b32 v120, v120, v71, v119 bitop3:0x80

    v_ffbl_b32 v120, v120
    v_max_i32 v84, v120, v84
    s_mov_b64 exec, -1

    v_lshl_add_u32 v73, v84, 1, v30
    v_lshl_add_u32 v71, -1, v84, v71
    ds_read_u16 v80, v73 offset:24
    v_ffbl_b32 v84, v71

    v_perm_b32 v72, v67, v66, v84
    v_and_or_b32 v72, v72, s66, v85
    ds_add_rtn_u32 v87, v72, v10
    ds_wrxchg_rtn_b32 v116, v86, v13

    buffer_load_dwordx4 v[224:227], v9, s[28:31], s77 offen offset:0
    s_add_u32 s47, s44, 135168
    buffer_load_dwordx4 v[152:155], v7, s[20:23], s47 offen offset:0
    buffer_load_dwordx4 v[156:159], v7, s[20:23], s47 offen offset:64
    s_mov_b32 s70, 0x977f977f

    s_waitcnt lgkmcnt(0)
    v_cmp_gt_u32 s[68:69], 2, v116

    v_cmpx_lt_u32 vcc, 1, v87
    v_bfe_i32 v119, s70, v71, 1
    v_lshrrev_b64 v[74:75], v123, s[68:69]
    v_perm_b32 v121, v74, v74, v4
    v_perm_b32 v122, v74, v74, v3
    v_and_b32 v121, v121, v20
    v_and_b32 v122, v122, v19
    v_msad_u8 v120, v27, v121, 0
    v_lshlrev_b32 v120, 4, v120
    v_msad_u8 v120, v26, v122, v120
    v_bitop3_b32 v120, v120, v71, v119 bitop3:0x80

    v_ffbl_b32 v120, v120
    v_max_i32 v84, v120, v84
    s_mov_b64 exec, -1

    v_lshl_add_u32 v73, v84, 1, v30
    v_lshl_add_u32 v71, -1, v84, v71
    ds_read_u16 v81, v73 offset:24
    v_ffbl_b32 v84, v71

    v_perm_b32 v72, v67, v66, v84
    v_and_or_b32 v72, v72, s66, v85
    ds_add_rtn_u32 v87, v72, v10
    ds_wrxchg_rtn_b32 v116, v86, v13

    buffer_load_dwordx4 v[228:231], v9, s[28:31], s77 offen offset:1024
    s_add_u32 s47, s44, 139264
    buffer_load_dwordx4 v[168:171], v7, s[20:23], s47 offen offset:0
    buffer_load_dwordx4 v[172:175], v7, s[20:23], s47 offen offset:64
    s_mov_b32 s70, 0xe997e997

    s_waitcnt lgkmcnt(0)
    v_cmp_gt_u32 s[68:69], 2, v116

    v_cmpx_lt_u32 vcc, 1, v87
    v_bfe_i32 v119, s70, v71, 1
    v_lshrrev_b64 v[74:75], v123, s[68:69]
    v_perm_b32 v121, v74, v74, v4
    v_perm_b32 v122, v74, v74, v3
    v_and_b32 v121, v121, v20
    v_and_b32 v122, v122, v19
    v_msad_u8 v120, v27, v121, 0
    v_lshlrev_b32 v120, 4, v120
    v_msad_u8 v120, v26, v122, v120
    v_bitop3_b32 v120, v120, v71, v119 bitop3:0x80

    v_ffbl_b32 v120, v120
    v_max_i32 v84, v120, v84
    s_mov_b64 exec, -1

    v_lshl_add_u32 v73, v84, 1, v30
    v_lshl_add_u32 v71, -1, v84, v71
    ds_read_u16 v82, v73 offset:24
    v_ffbl_b32 v84, v71

    v_perm_b32 v72, v67, v66, v84
    v_and_or_b32 v72, v72, s66, v85
    ds_add_rtn_u32 v87, v72, v10
    ds_wrxchg_rtn_b32 v116, v86, v13

    buffer_load_dwordx4 v[240:243], v9, s[28:31], s77 offen offset:2048
    s_add_u32 s47, s44, 143360
    buffer_load_dwordx4 v[184:187], v7, s[20:23], s47 offen offset:0
    buffer_load_dwordx4 v[188:191], v7, s[20:23], s47 offen offset:64
    s_mov_b32 s70, 0xfee9fee9

    s_waitcnt lgkmcnt(0)
    v_cmp_gt_u32 s[68:69], 2, v116

    v_cmpx_lt_u32 vcc, 1, v87
    v_bfe_i32 v119, s70, v71, 1
    v_lshrrev_b64 v[74:75], v123, s[68:69]
    v_perm_b32 v121, v74, v74, v4
    v_and_b32 v121, v121, v20
    v_msad_u8 v120, v27, v121, 0
    v_lshlrev_b32 v120, 4, v120
    v_bitop3_b32 v120, v120, v71, v119 bitop3:0x80

    v_ffbl_b32 v120, v120
    v_max_i32 v84, v120, v84
    s_mov_b64 exec, -1

    v_lshl_add_u32 v73, v84, 1, v30
    v_lshl_add_u32 v71, -1, v84, v71
    ds_read_u16 v83, v73 offset:24
    v_lshrrev_b32 v71, 4, v71
    v_ffbl_b32 v84, v71

    v_perm_b32 v72, v68, v67, v84
    v_and_or_b32 v72, v72, s66, v85
    ds_add_rtn_u32 v87, v72, v10
    ds_wrxchg_rtn_b32 v116, v86, v13

    buffer_load_dwordx4 v[244:247], v9, s[28:31], s77 offen offset:3072
    s_add_u32 s47, s44, 147456
    buffer_load_dwordx4 v[200:203], v7, s[20:23], s47 offen offset:0
    buffer_load_dwordx4 v[204:207], v7, s[20:23], s47 offen offset:64
    s_mov_b32 s70, 0x7fff7fff

    s_waitcnt lgkmcnt(0)
    v_cmp_gt_u32 s[68:69], 2, v116

    s_cmp_eq_u32 s59, 1
    v_lshl_or_b32 v78, v81, 16, v80
    v_lshl_or_b32 v79, v83, 16, v82
    s_cbranch_scc1 k1_kernel_nf3
    buffer_store_dwordx4 v[76:79], v9, s[32:35], s62 offen sc1
    s_add_u32 s62, s62, 262144
k1_kernel_nf3:
    v_cmpx_lt_u32 vcc, 1, v87
    v_bfe_i32 v119, s70, v71, 1
    v_lshrrev_b64 v[74:75], v123, s[68:69]
    v_perm_b32 v121, v74, v74, v5
    v_perm_b32 v122, v74, v74, v4
    v_and_b32 v121, v121, v21
    v_and_b32 v122, v122, v20
    v_msad_u8 v120, v28, v121, 0
    v_lshlrev_b32 v120, 4, v120
    v_msad_u8 v120, v27, v122, v120
    v_bitop3_b32 v120, v120, v71, v119 bitop3:0x80

    v_ffbl_b32 v120, v120
    v_max_i32 v84, v120, v84
    s_mov_b64 exec, -1

    v_lshl_add_u32 v73, v84, 1, v30
    v_lshl_add_u32 v71, -1, v84, v71
    ds_read_u16 v80, v73 offset:32
    v_ffbl_b32 v84, v71

    v_perm_b32 v72, v68, v67, v84
    v_and_or_b32 v72, v72, s66, v85
    ds_add_rtn_u32 v87, v72, v10
    ds_wrxchg_rtn_b32 v116, v86, v13

    s_add_u32 s47, s44, 151552
    buffer_load_dwordx4 v[216:219], v7, s[20:23], s47 offen offset:0
    buffer_load_dwordx4 v[220:223], v7, s[20:23], s47 offen offset:64
    s_mov_b32 s70, 0x977f977f

    s_waitcnt lgkmcnt(0)
    v_cmp_gt_u32 s[68:69], 2, v116

    v_cmpx_lt_u32 vcc, 1, v87
    v_bfe_i32 v119, s70, v71, 1
    v_lshrrev_b64 v[74:75], v123, s[68:69]
    v_perm_b32 v121, v74, v74, v5
    v_perm_b32 v122, v74, v74, v4
    v_and_b32 v121, v121, v21
    v_and_b32 v122, v122, v20
    v_msad_u8 v120, v28, v121, 0
    v_lshlrev_b32 v120, 4, v120
    v_msad_u8 v120, v27, v122, v120
    v_bitop3_b32 v120, v120, v71, v119 bitop3:0x80

    v_ffbl_b32 v120, v120
    v_max_i32 v84, v120, v84
    s_mov_b64 exec, -1

    v_lshl_add_u32 v73, v84, 1, v30
    v_lshl_add_u32 v71, -1, v84, v71
    ds_read_u16 v81, v73 offset:32
    v_ffbl_b32 v84, v71

    v_perm_b32 v72, v68, v67, v84
    v_and_or_b32 v72, v72, s66, v85
    ds_add_rtn_u32 v87, v72, v10
    ds_wrxchg_rtn_b32 v116, v86, v13

    s_add_u32 s47, s44, 155648
    buffer_load_dwordx4 v[232:235], v7, s[20:23], s47 offen offset:0
    buffer_load_dwordx4 v[236:239], v7, s[20:23], s47 offen offset:64
    s_mov_b32 s70, 0xe997e997

    s_waitcnt lgkmcnt(0)
    v_cmp_gt_u32 s[68:69], 2, v116

    v_cmpx_lt_u32 vcc, 1, v87
    v_bfe_i32 v119, s70, v71, 1
    v_lshrrev_b64 v[74:75], v123, s[68:69]
    v_perm_b32 v121, v74, v74, v5
    v_perm_b32 v122, v74, v74, v4
    v_and_b32 v121, v121, v21
    v_and_b32 v122, v122, v20
    v_msad_u8 v120, v28, v121, 0
    v_lshlrev_b32 v120, 4, v120
    v_msad_u8 v120, v27, v122, v120
    v_bitop3_b32 v120, v120, v71, v119 bitop3:0x80

    v_ffbl_b32 v120, v120
    v_max_i32 v84, v120, v84
    s_mov_b64 exec, -1

    v_lshl_add_u32 v73, v84, 1, v30
    v_lshl_add_u32 v71, -1, v84, v71
    ds_read_u16 v82, v73 offset:32
    v_ffbl_b32 v84, v71

    v_perm_b32 v72, v68, v67, v84
    v_and_or_b32 v72, v72, s66, v85
    ds_add_rtn_u32 v87, v72, v10
    ds_wrxchg_rtn_b32 v116, v86, v13

    s_add_u32 s47, s44, 159744
    buffer_load_dwordx4 v[248:251], v7, s[20:23], s47 offen offset:0
    buffer_load_dwordx4 v[252:255], v7, s[20:23], s47 offen offset:64
    s_mov_b32 s70, 0xfee9fee9

    s_waitcnt lgkmcnt(0)
    v_cmp_gt_u32 s[68:69], 2, v116

    v_cmpx_lt_u32 vcc, 1, v87
    v_bfe_i32 v119, s70, v71, 1
    v_lshrrev_b64 v[74:75], v123, s[68:69]
    v_perm_b32 v121, v74, v74, v5
    v_and_b32 v121, v121, v21
    v_msad_u8 v120, v28, v121, 0
    v_lshlrev_b32 v120, 4, v120
    v_bitop3_b32 v120, v120, v71, v119 bitop3:0x80

    v_ffbl_b32 v120, v120
    v_max_i32 v84, v120, v84
    s_mov_b64 exec, -1

    v_lshl_add_u32 v73, v84, 1, v30
    v_lshl_add_u32 v71, -1, v84, v71
    ds_read_u16 v83, v73 offset:32
    v_lshrrev_b32 v71, 4, v71

    s_cmp_ge_u32 s57, 800
    s_cbranch_scc1 k1_kernel_norl
    s_waitcnt vmcnt(0)

    s_lshr_b32 s78, s57, 7
    s_lshl_b32 s78, s78, 8
    s_and_b32 s79, s57, 127
    s_add_u32 s78, s78, s79
    s_cmp_ge_u32 s57, 384
    s_cselect_b32 s79, 640, 0
    s_sub_u32 s78, s78, s79
    s_lshl_b32 s79, s78, 10
    buffer_load_dwordx4 v[24:27], v9, s[20:23], s79 offen
    s_lshl2_add_u32 s78, s78, 15466496
    v_mov_b32 v4, -1
    s_mov_b64 exec, 1
    buffer_store_dword v4, off, s[32:35], s78 sc1
    s_mov_b64 exec, -1

    v_perm_b32 v0, v132, v128, s84
    v_perm_b32 v1, v148, v144, s84
    v_perm_b32 v2, v164, v160, s84
    v_perm_b32 v3, v180, v176, s84
    v_perm_b32 v16, v132, v128, s85
    v_perm_b32 v17, v148, v144, s85
    v_perm_b32 v18, v164, v160, s85
    v_perm_b32 v19, v180, v176, s85
    v_perm_b32 v32, v133, v129, s84
    v_perm_b32 v33, v149, v145, s84
    v_perm_b32 v34, v165, v161, s84
    v_perm_b32 v35, v181, v177, s84
    v_perm_b32 v64, v133, v129, s85
    v_perm_b32 v65, v149, v145, s85
    v_perm_b32 v66, v165, v161, s85
    v_perm_b32 v67, v181, v177, s85
    ds_write_b128 v36, v[0:3]
    ds_write_b128 v37, v[16:19]
    ds_write_b128 v38, v[32:35]
    ds_write_b128 v39, v[64:67]
    ds_read_b128 v[40:43], v15 offset:0
    ds_read_b128 v[44:47], v15 offset:1024
    ds_read_b128 v[72:75], v15 offset:2048
    ds_read_b128 v[116:119], v15 offset:3072
    v_perm_b32 v0, v196, v192, s84
    v_perm_b32 v1, v212, v208, s84
    v_perm_b32 v2, v228, v224, s84
    v_perm_b32 v3, v244, v240, s84
    v_perm_b32 v16, v196, v192, s85
    v_perm_b32 v17, v212, v208, s85
    v_perm_b32 v18, v228, v224, s85
    v_perm_b32 v19, v244, v240, s85
    v_perm_b32 v32, v197, v193, s84
    v_perm_b32 v33, v213, v209, s84
    v_perm_b32 v34, v229, v225, s84
    v_perm_b32 v35, v245, v241, s84
    v_perm_b32 v64, v197, v193, s85
    v_perm_b32 v65, v213, v209, s85
    v_perm_b32 v66, v229, v225, s85
    v_perm_b32 v67, v245, v241, s85
    s_waitcnt lgkmcnt(0)
    s_add_u32 s83, s82, 0
    buffer_store_dwordx4 v[40:43], v14, s[32:35], s83 offen sc1
    s_add_u32 s83, s82, 3284992
    buffer_store_dwordx4 v[44:47], v14, s[32:35], s83 offen sc1
    s_add_u32 s83, s82, 6569984
    buffer_store_dwordx4 v[72:75], v14, s[32:35], s83 offen sc1
    s_add_u32 s83, s82, 9854976
    buffer_store_dwordx4 v[116:119], v14, s[32:35], s83 offen sc1
    ds_write_b128 v36, v[0:3]
    ds_write_b128 v37, v[16:19]
    ds_write_b128 v38, v[32:35]
    ds_write_b128 v39, v[64:67]
    ds_read_b128 v[40:43], v15 offset:0
    ds_read_b128 v[44:47], v15 offset:1024
    ds_read_b128 v[72:75], v15 offset:2048
    ds_read_b128 v[116:119], v15 offset:3072
    v_perm_b32 v0, v134, v130, s84
    v_perm_b32 v1, v150, v146, s84
    v_perm_b32 v2, v166, v162, s84
    v_perm_b32 v3, v182, v178, s84
    v_perm_b32 v16, v134, v130, s85
    v_perm_b32 v17, v150, v146, s85
    v_perm_b32 v18, v166, v162, s85
    v_perm_b32 v19, v182, v178, s85
    v_perm_b32 v32, v135, v131, s84
    v_perm_b32 v33, v151, v147, s84
    v_perm_b32 v34, v167, v163, s84
    v_perm_b32 v35, v183, v179, s84
    v_perm_b32 v64, v135, v131, s85
    v_perm_b32 v65, v151, v147, s85
    v_perm_b32 v66, v167, v163, s85
    v_perm_b32 v67, v183, v179, s85
    s_waitcnt lgkmcnt(0)
    s_add_u32 s83, s82, 64
    buffer_store_dwordx4 v[40:43], v14, s[32:35], s83 offen sc1
    s_add_u32 s83, s82, 3285056
    buffer_store_dwordx4 v[44:47], v14, s[32:35], s83 offen sc1
    s_add_u32 s83, s82, 6570048
    buffer_store_dwordx4 v[72:75], v14, s[32:35], s83 offen sc1
    s_add_u32 s83, s82, 9855040
    buffer_store_dwordx4 v[116:119], v14, s[32:35], s83 offen sc1
    ds_write_b128 v36, v[0:3]
    ds_write_b128 v37, v[16:19]
    ds_write_b128 v38, v[32:35]
    ds_write_b128 v39, v[64:67]
    ds_read_b128 v[40:43], v15 offset:0
    ds_read_b128 v[44:47], v15 offset:1024
    ds_read_b128 v[72:75], v15 offset:2048
    ds_read_b128 v[116:119], v15 offset:3072
    v_perm_b32 v0, v198, v194, s84
    v_perm_b32 v1, v214, v210, s84
    v_perm_b32 v2, v230, v226, s84
    v_perm_b32 v3, v246, v242, s84
    v_perm_b32 v16, v198, v194, s85
    v_perm_b32 v17, v214, v210, s85
    v_perm_b32 v18, v230, v226, s85
    v_perm_b32 v19, v246, v242, s85
    v_perm_b32 v32, v199, v195, s84
    v_perm_b32 v33, v215, v211, s84
    v_perm_b32 v34, v231, v227, s84
    v_perm_b32 v35, v247, v243, s84
    v_perm_b32 v64, v199, v195, s85
    v_perm_b32 v65, v215, v211, s85
    v_perm_b32 v66, v231, v227, s85
    v_perm_b32 v67, v247, v243, s85
    s_waitcnt lgkmcnt(0)
    s_add_u32 s83, s82, 102656
    buffer_store_dwordx4 v[40:43], v14, s[32:35], s83 offen sc1
    s_add_u32 s83, s82, 3387648
    buffer_store_dwordx4 v[44:47], v14, s[32:35], s83 offen sc1
    s_add_u32 s83, s82, 6672640
    buffer_store_dwordx4 v[72:75], v14, s[32:35], s83 offen sc1
    s_add_u32 s83, s82, 9957632
    buffer_store_dwordx4 v[116:119], v14, s[32:35], s83 offen sc1
    ds_write_b128 v36, v[0:3]
    ds_write_b128 v37, v[16:19]
    ds_write_b128 v38, v[32:35]
    ds_write_b128 v39, v[64:67]
    ds_read_b128 v[40:43], v15 offset:0
    ds_read_b128 v[44:47], v15 offset:1024
    ds_read_b128 v[72:75], v15 offset:2048
    ds_read_b128 v[116:119], v15 offset:3072
    ds_write_b64 v31, v[48:49] offset:32
    ds_write_b64 v31, v[50:51] offset:40
    ds_write_b64 v31, v[52:53] offset:48
    s_waitcnt lgkmcnt(3)
    s_add_u32 s83, s82, 102720
    buffer_store_dwordx4 v[40:43], v14, s[32:35], s83 offen sc1
    s_add_u32 s83, s82, 3387712
    buffer_store_dwordx4 v[44:47], v14, s[32:35], s83 offen sc1
    s_add_u32 s83, s82, 6672704
    buffer_store_dwordx4 v[72:75], v14, s[32:35], s83 offen sc1
    s_add_u32 s83, s82, 9957696
    buffer_store_dwordx4 v[116:119], v14, s[32:35], s83 offen sc1
k1_kernel_norl:
k1_kernel_rld:
    ds_write_b32 v86, v13
    v_ffbl_b32 v84, v71

    v_perm_b32 v72, v69, v68, v84
    v_and_or_b32 v72, v72, s66, v85
    ds_add_rtn_u32 v87, v72, v10
    ds_wrxchg_rtn_b32 v116, v86, v13

    s_mov_b32 s70, 0x7fff7fff

    s_waitcnt lgkmcnt(0)
    v_cmp_gt_u32 s[68:69], 2, v116

    s_cmp_eq_u32 s59, 0
    v_lshl_or_b32 v76, v81, 16, v80
    v_lshl_or_b32 v77, v83, 16, v82
    s_cbranch_scc1 k1_kernel_nf4
    buffer_store_dwordx4 v[76:79], v9, s[32:35], s62 offen sc1
    s_add_u32 s62, s62, 262144
k1_kernel_nf4:
    v_cmpx_lt_u32 vcc, 1, v87
    v_bfe_i32 v119, s70, v71, 1
    v_lshrrev_b64 v[74:75], v123, s[68:69]
    v_perm_b32 v121, v74, v74, v6
    v_perm_b32 v122, v74, v74, v5
    v_and_b32 v121, v121, v22
    v_and_b32 v122, v122, v21
    v_msad_u8 v120, v29, v121, 0
    v_lshlrev_b32 v120, 4, v120
    v_msad_u8 v120, v28, v122, v120
    v_bitop3_b32 v120, v120, v71, v119 bitop3:0x80

    v_ffbl_b32 v120, v120
    v_max_i32 v84, v120, v84
    s_mov_b64 exec, -1

    v_lshl_add_u32 v73, v84, 1, v30
    v_lshl_add_u32 v71, -1, v84, v71
    ds_read_u16 v80, v73 offset:40
    v_ffbl_b32 v84, v71

    v_perm_b32 v72, v69, v68, v84
    v_and_or_b32 v72, v72, s66, v85
    ds_add_rtn_u32 v87, v72, v10
    ds_wrxchg_rtn_b32 v116, v86, v13

    s_mov_b32 s70, 0x977f977f

    s_waitcnt lgkmcnt(0)
    v_cmp_gt_u32 s[68:69], 2, v116

    v_cmpx_lt_u32 vcc, 1, v87
    v_bfe_i32 v119, s70, v71, 1
    v_lshrrev_b64 v[74:75], v123, s[68:69]
    v_perm_b32 v121, v74, v74, v6
    v_perm_b32 v122, v74, v74, v5
    v_and_b32 v121, v121, v22
    v_and_b32 v122, v122, v21
    v_msad_u8 v120, v29, v121, 0
    v_lshlrev_b32 v120, 4, v120
    v_msad_u8 v120, v28, v122, v120
    v_bitop3_b32 v120, v120, v71, v119 bitop3:0x80

    v_ffbl_b32 v120, v120
    v_max_i32 v84, v120, v84
    s_mov_b64 exec, -1

    v_lshl_add_u32 v73, v84, 1, v30
    v_lshl_add_u32 v71, -1, v84, v71
    ds_read_u16 v81, v73 offset:40
    v_ffbl_b32 v84, v71

    v_perm_b32 v72, v69, v68, v84
    v_and_or_b32 v72, v72, s66, v85
    ds_add_rtn_u32 v87, v72, v10
    ds_wrxchg_rtn_b32 v116, v86, v13

    s_mov_b32 s70, 0xe997e997

    s_waitcnt lgkmcnt(0)
    v_cmp_gt_u32 s[68:69], 2, v116

    v_cmpx_lt_u32 vcc, 1, v87
    v_bfe_i32 v119, s70, v71, 1
    v_lshrrev_b64 v[74:75], v123, s[68:69]
    v_perm_b32 v121, v74, v74, v6
    v_perm_b32 v122, v74, v74, v5
    v_and_b32 v121, v121, v22
    v_and_b32 v122, v122, v21
    v_msad_u8 v120, v29, v121, 0
    v_lshlrev_b32 v120, 4, v120
    v_msad_u8 v120, v28, v122, v120
    v_bitop3_b32 v120, v120, v71, v119 bitop3:0x80

    v_ffbl_b32 v120, v120
    v_max_i32 v84, v120, v84
    s_mov_b64 exec, -1

    v_lshl_add_u32 v73, v84, 1, v30
    v_lshl_add_u32 v71, -1, v84, v71
    ds_read_u16 v82, v73 offset:40
    v_ffbl_b32 v84, v71

    v_perm_b32 v72, v69, v68, v84
    v_and_or_b32 v72, v72, s66, v85
    ds_add_rtn_u32 v87, v72, v10
    ds_wrxchg_rtn_b32 v116, v86, v13

    s_mov_b32 s70, 0xfee9fee9

    s_waitcnt lgkmcnt(0)
    v_cmp_gt_u32 s[68:69], 2, v116

    v_cmpx_lt_u32 vcc, 1, v87
    v_bfe_i32 v119, s70, v71, 1
    v_lshrrev_b64 v[74:75], v123, s[68:69]
    v_perm_b32 v121, v74, v74, v6
    v_and_b32 v121, v121, v22
    v_msad_u8 v120, v29, v121, 0
    v_lshlrev_b32 v120, 4, v120
    v_bitop3_b32 v120, v120, v71, v119 bitop3:0x80

    v_ffbl_b32 v120, v120
    v_max_i32 v84, v120, v84
    s_mov_b64 exec, -1

    v_lshl_add_u32 v73, v84, 1, v30
    v_lshl_add_u32 v71, -1, v84, v71
    ds_read_u16 v83, v73 offset:40
    s_cmp_lg_u32 s59, 1
    s_cbranch_scc1 k1_kernel_sdone
    v_lshrrev_b32 v71, 4, v71
    v_ffbl_b32 v84, v71

    v_perm_b32 v72, v70, v69, v84
    v_and_or_b32 v72, v72, s66, v85
    ds_add_rtn_u32 v87, v72, v10
    ds_wrxchg_rtn_b32 v116, v86, v13

    s_waitcnt lgkmcnt(0)
    v_cmp_gt_u32 s[68:69], 2, v116

    v_lshl_or_b32 v78, v81, 16, v80
    v_lshl_or_b32 v79, v83, 16, v82
    v_cmpx_lt_u32 vcc, 1, v87
    v_lshrrev_b64 v[74:75], v123, s[68:69]
    v_perm_b32 v121, v74, v74, v6
    v_and_b32 v121, v121, v22
    v_msad_u8 v120, v29, v121, 0
    v_and_b32 v120, v120, v71

    v_ffbl_b32 v120, v120
    v_max_i32 v84, v120, v84
    s_mov_b64 exec, -1

    v_lshl_add_u32 v73, v84, 1, v30
    v_lshl_add_u32 v71, -1, v84, v71
    ds_read_u16 v80, v73 offset:48
    v_ffbl_b32 v84, v71

    v_perm_b32 v72, v70, v69, v84
    v_and_or_b32 v72, v72, s66, v85
    ds_add_rtn_u32 v87, v72, v10
    ds_wrxchg_rtn_b32 v116, v86, v13

    s_waitcnt lgkmcnt(0)
    v_cmp_gt_u32 s[68:69], 2, v116

    v_cmpx_lt_u32 vcc, 1, v87
    s_nop 0
    v_lshrrev_b64 v[74:75], v123, s[68:69]
    v_perm_b32 v121, v74, v74, v6
    v_and_b32 v121, v121, v22
    v_msad_u8 v120, v29, v121, 0
    v_and_b32 v120, v120, v71

    v_ffbl_b32 v120, v120
    v_max_i32 v84, v120, v84
    s_mov_b64 exec, -1

    v_lshl_add_u32 v73, v84, 1, v30
    v_lshl_add_u32 v71, -1, v84, v71
    ds_read_u16 v81, v73 offset:48
    v_ffbl_b32 v84, v71

    v_perm_b32 v72, v70, v69, v84
    v_and_or_b32 v72, v72, s66, v85
    ds_add_rtn_u32 v87, v72, v10
    ds_wrxchg_rtn_b32 v116, v86, v13

    s_waitcnt lgkmcnt(0)
    v_cmp_gt_u32 s[68:69], 2, v116

    v_cmpx_lt_u32 vcc, 1, v87
    s_nop 0
    v_lshrrev_b64 v[74:75], v123, s[68:69]
    v_perm_b32 v121, v74, v74, v6
    v_and_b32 v121, v121, v22
    v_msad_u8 v120, v29, v121, 0
    v_and_b32 v120, v120, v71

    v_ffbl_b32 v120, v120
    v_max_i32 v84, v120, v84
    s_mov_b64 exec, -1

    v_lshl_add_u32 v73, v84, 1, v30
    v_lshl_add_u32 v71, -1, v84, v71
    ds_read_u16 v82, v73 offset:48
    v_ffbl_b32 v84, v71
    v_lshl_add_u32 v73, v84, 1, v30
    ds_read_u16 v83, v73 offset:48
    s_waitcnt lgkmcnt(0)
    v_lshl_or_b32 v76, v81, 16, v80
    v_lshl_or_b32 v77, v83, 16, v82
    s_branch k1_kernel_sst
k1_kernel_sdone:
    s_waitcnt lgkmcnt(0)
    v_lshl_or_b32 v78, v81, 16, v80
    v_lshl_or_b32 v79, v83, 16, v82
k1_kernel_sst:
    buffer_store_dwordx4 v[76:79], v9, s[32:35], s62 offen sc1
    s_add_u32 s62, s62, 262144
k1_kernel_udone:
    s_setprio 3

    s_mov_b64 exec, 1
    ds_add_rtn_u32 v12, v11, v10 offset:28
    s_waitcnt lgkmcnt(0)
    v_readfirstlane_b32 s45, v12
    s_cmp_ge_u32 s45, 2
    s_cbranch_scc1 k1_kernel_ncl
    s_mov_b64 exec, -1
    s_mul_i32 s45, s45, 16384
    s_min_u32 s45, s45, 16384
    s_lshl_b32 s72, s2, 15
    s_add_u32 s72, s72, s45
    s_add_u32 s72, s72, 20971520
    v_mov_b32 v40, -1
    v_mov_b32 v41, -1
    v_mov_b32 v42, -1
    v_mov_b32 v43, -1
    buffer_store_dwordx4 v[40:43], v9, s[12:15], s72 offen offset:0 sc1
    buffer_store_dwordx4 v[40:43], v9, s[12:15], s72 offen offset:1024 sc1
    buffer_store_dwordx4 v[40:43], v9, s[12:15], s72 offen offset:2048 sc1
    buffer_store_dwordx4 v[40:43], v9, s[12:15], s72 offen offset:3072 sc1
    s_add_u32 s72, s72, 4096
    buffer_store_dwordx4 v[40:43], v9, s[12:15], s72 offen offset:0 sc1
    buffer_store_dwordx4 v[40:43], v9, s[12:15], s72 offen offset:1024 sc1
    buffer_store_dwordx4 v[40:43], v9, s[12:15], s72 offen offset:2048 sc1
    buffer_store_dwordx4 v[40:43], v9, s[12:15], s72 offen offset:3072 sc1
    s_add_u32 s72, s72, 4096
    buffer_store_dwordx4 v[40:43], v9, s[12:15], s72 offen offset:0 sc1
    buffer_store_dwordx4 v[40:43], v9, s[12:15], s72 offen offset:1024 sc1
    buffer_store_dwordx4 v[40:43], v9, s[12:15], s72 offen offset:2048 sc1
    buffer_store_dwordx4 v[40:43], v9, s[12:15], s72 offen offset:3072 sc1
    s_add_u32 s72, s72, 4096
    buffer_store_dwordx4 v[40:43], v9, s[12:15], s72 offen offset:0 sc1
    buffer_store_dwordx4 v[40:43], v9, s[12:15], s72 offen offset:1024 sc1
    buffer_store_dwordx4 v[40:43], v9, s[12:15], s72 offen offset:2048 sc1
    buffer_store_dwordx4 v[40:43], v9, s[12:15], s72 offen offset:3072 sc1
    s_add_u32 s72, s72, 4096
k1_kernel_ncl:

    s_waitcnt vmcnt(0)

    s_mov_b64 exec, 1
    ds_add_rtn_u32 v12, v11, v10 offset:20
    v_mov_b32 v3, 1
    s_bfe_u32 s39, s2, 0x10004
    s_mul_i32 s38, s39, 128
    s_waitcnt lgkmcnt(0)
    v_readfirstlane_b32 s45, v12
    s_cmp_eq_u32 s45, 3
    s_cbranch_scc0 k1_kernel_tld0
    buffer_atomic_add v3, v13, s[52:55], s38 offen offset:32 sc0
k1_kernel_tld0:
    s_and_b32 s45, s45, 3
k1_kernel_tld:
    s_mov_b64 exec, -1
    s_add_u32 s47, s44, 0
    buffer_load_dwordx4 v[32:35], v7, s[20:23], s47 offen offset:0
    buffer_load_dwordx4 v[36:39], v7, s[20:23], s47 offen offset:64
    s_add_u32 s47, s44, 4096
    buffer_load_dwordx4 v[40:43], v7, s[20:23], s47 offen offset:0
    buffer_load_dwordx4 v[44:47], v7, s[20:23], s47 offen offset:64
    s_add_u32 s47, s44, 8192
    buffer_load_dwordx4 v[48:51], v7, s[20:23], s47 offen offset:0
    buffer_load_dwordx4 v[52:55], v7, s[20:23], s47 offen offset:64
    s_cmp_ge_u32 s57, 800
    s_cbranch_scc1 k1_kernel_nsq
    v_mov_b32 v72, 0x0d800000
    v_mov_b32 v73, 0x0d800000
    v_fma_f32 v64, v128, v128, v72
    v_fma_f32 v65, v129, v129, v73
    v_fma_f32 v66, v130, v130, v72
    v_fma_f32 v67, v131, v131, v73
    v_lshlrev_b64 v[128:129], 16, v[128:129]
    v_lshlrev_b64 v[130:131], 16, v[130:131]
    v_fmac_f32 v64, v132, v132
    v_fmac_f32 v65, v133, v133
    v_fmac_f32 v66, v134, v134
    v_fmac_f32 v67, v135, v135
    v_lshlrev_b64 v[132:133], 16, v[132:133]
    v_lshlrev_b64 v[134:135], 16, v[134:135]
    v_fma_f32 v68, v128, v128, v72
    v_fma_f32 v69, v129, v129, v73
    v_fma_f32 v70, v130, v130, v72
    v_fma_f32 v71, v131, v131, v73
    v_fmac_f32 v64, v144, v144
    v_fmac_f32 v65, v145, v145
    v_fmac_f32 v66, v146, v146
    v_fmac_f32 v67, v147, v147
    v_lshlrev_b64 v[144:145], 16, v[144:145]
    v_lshlrev_b64 v[146:147], 16, v[146:147]
    v_fmac_f32 v68, v132, v132
    v_fmac_f32 v69, v133, v133
    v_fmac_f32 v70, v134, v134
    v_fmac_f32 v71, v135, v135
    v_fmac_f32 v64, v148, v148
    v_fmac_f32 v65, v149, v149
    v_fmac_f32 v66, v150, v150
    v_fmac_f32 v67, v151, v151
    v_lshlrev_b64 v[148:149], 16, v[148:149]
    v_lshlrev_b64 v[150:151], 16, v[150:151]
    v_fmac_f32 v68, v144, v144
    v_fmac_f32 v69, v145, v145
    v_fmac_f32 v70, v146, v146
    v_fmac_f32 v71, v147, v147
    v_fmac_f32 v64, v160, v160
    v_fmac_f32 v65, v161, v161
    v_fmac_f32 v66, v162, v162
    v_fmac_f32 v67, v163, v163
    v_lshlrev_b64 v[160:161], 16, v[160:161]
    v_lshlrev_b64 v[162:163], 16, v[162:163]
    v_fmac_f32 v68, v148, v148
    v_fmac_f32 v69, v149, v149
    v_fmac_f32 v70, v150, v150
    v_fmac_f32 v71, v151, v151
    v_fmac_f32 v64, v164, v164
    v_fmac_f32 v65, v165, v165
    v_fmac_f32 v66, v166, v166
    v_fmac_f32 v67, v167, v167
    v_lshlrev_b64 v[164:165], 16, v[164:165]
    v_lshlrev_b64 v[166:167], 16, v[166:167]
    v_fmac_f32 v68, v160, v160
    v_fmac_f32 v69, v161, v161
    v_fmac_f32 v70, v162, v162
    v_fmac_f32 v71, v163, v163
    v_fmac_f32 v64, v176, v176
    v_fmac_f32 v65, v177, v177
    v_fmac_f32 v66, v178, v178
    v_fmac_f32 v67, v179, v179
    v_lshlrev_b64 v[176:177], 16, v[176:177]
    v_lshlrev_b64 v[178:179], 16, v[178:179]
    v_fmac_f32 v68, v164, v164
    v_fmac_f32 v69, v165, v165
    v_fmac_f32 v70, v166, v166
    v_fmac_f32 v71, v167, v167
    v_fmac_f32 v64, v180, v180
    v_fmac_f32 v65, v181, v181
    v_fmac_f32 v66, v182, v182
    v_fmac_f32 v67, v183, v183
    v_lshlrev_b64 v[180:181], 16, v[180:181]
    v_lshlrev_b64 v[182:183], 16, v[182:183]
    v_fmac_f32 v68, v176, v176
    v_fmac_f32 v69, v177, v177
    v_fmac_f32 v70, v178, v178
    v_fmac_f32 v71, v179, v179
    v_fmac_f32 v64, v192, v192
    v_fmac_f32 v65, v193, v193
    v_fmac_f32 v66, v194, v194
    v_fmac_f32 v67, v195, v195
    v_lshlrev_b64 v[192:193], 16, v[192:193]
    v_lshlrev_b64 v[194:195], 16, v[194:195]
    v_fmac_f32 v68, v180, v180
    v_fmac_f32 v69, v181, v181
    v_fmac_f32 v70, v182, v182
    v_fmac_f32 v71, v183, v183
    v_fmac_f32 v64, v196, v196
    v_fmac_f32 v65, v197, v197
    v_fmac_f32 v66, v198, v198
    v_fmac_f32 v67, v199, v199
    v_lshlrev_b64 v[196:197], 16, v[196:197]
    v_lshlrev_b64 v[198:199], 16, v[198:199]
    v_fmac_f32 v68, v192, v192
    v_fmac_f32 v69, v193, v193
    v_fmac_f32 v70, v194, v194
    v_fmac_f32 v71, v195, v195
    v_fmac_f32 v64, v208, v208
    v_fmac_f32 v65, v209, v209
    v_fmac_f32 v66, v210, v210
    v_fmac_f32 v67, v211, v211
    v_lshlrev_b64 v[208:209], 16, v[208:209]
    v_lshlrev_b64 v[210:211], 16, v[210:211]
    v_fmac_f32 v68, v196, v196
    v_fmac_f32 v69, v197, v197
    v_fmac_f32 v70, v198, v198
    v_fmac_f32 v71, v199, v199
    v_fmac_f32 v64, v212, v212
    v_fmac_f32 v65, v213, v213
    v_fmac_f32 v66, v214, v214
    v_fmac_f32 v67, v215, v215
    v_lshlrev_b64 v[212:213], 16, v[212:213]
    v_lshlrev_b64 v[214:215], 16, v[214:215]
    v_fmac_f32 v68, v208, v208
    v_fmac_f32 v69, v209, v209
    v_fmac_f32 v70, v210, v210
    v_fmac_f32 v71, v211, v211
    v_fmac_f32 v64, v224, v224
    v_fmac_f32 v65, v225, v225
    v_fmac_f32 v66, v226, v226
    v_fmac_f32 v67, v227, v227
    v_lshlrev_b64 v[224:225], 16, v[224:225]
    v_lshlrev_b64 v[226:227], 16, v[226:227]
    v_fmac_f32 v68, v212, v212
    v_fmac_f32 v69, v213, v213
    v_fmac_f32 v70, v214, v214
    v_fmac_f32 v71, v215, v215
    v_fmac_f32 v64, v228, v228
    v_fmac_f32 v65, v229, v229
    v_fmac_f32 v66, v230, v230
    v_fmac_f32 v67, v231, v231
    v_lshlrev_b64 v[228:229], 16, v[228:229]
    v_lshlrev_b64 v[230:231], 16, v[230:231]
    v_fmac_f32 v68, v224, v224
    v_fmac_f32 v69, v225, v225
    v_fmac_f32 v70, v226, v226
    v_fmac_f32 v71, v227, v227
    v_fmac_f32 v64, v240, v240
    v_fmac_f32 v65, v241, v241
    v_fmac_f32 v66, v242, v242
    v_fmac_f32 v67, v243, v243
    v_lshlrev_b64 v[240:241], 16, v[240:241]
    v_lshlrev_b64 v[242:243], 16, v[242:243]
    v_fmac_f32 v68, v228, v228
    v_fmac_f32 v69, v229, v229
    v_fmac_f32 v70, v230, v230
    v_fmac_f32 v71, v231, v231
    v_fmac_f32 v64, v244, v244
    v_fmac_f32 v65, v245, v245
    v_fmac_f32 v66, v246, v246
    v_fmac_f32 v67, v247, v247
    v_lshlrev_b64 v[244:245], 16, v[244:245]
    v_lshlrev_b64 v[246:247], 16, v[246:247]
    v_fmac_f32 v68, v240, v240
    v_fmac_f32 v69, v241, v241
    v_fmac_f32 v70, v242, v242
    v_fmac_f32 v71, v243, v243
    v_fmac_f32 v72, v24, v24
    v_fmac_f32 v73, v25, v25
    v_lshlrev_b64 v[24:25], 16, v[24:25]
    v_fmac_f32 v72, v26, v26
    v_fmac_f32 v73, v27, v27
    v_lshlrev_b64 v[26:27], 16, v[26:27]
    v_fmac_f32 v68, v244, v244
    v_fmac_f32 v69, v245, v245
    v_fmac_f32 v70, v246, v246
    v_fmac_f32 v71, v247, v247

    v_fmac_f32 v72, v24, v24
    v_fmac_f32 v73, v25, v25
    v_max3_u32 v64, v64, v65, v66
    v_max3_u32 v67, v67, v68, v69
    v_fmac_f32 v72, v26, v26
    v_fmac_f32 v73, v27, v27
    v_max3_u32 v64, v64, v70, v71
    v_max_u32 v64, v64, v67
    v_add_f32 v72, v72, v73

    s_nop 0
    v_max_u32_dpp v64, v64, v64 row_ror:8 row_mask:0xf bank_mask:0xf
    v_add_f32_dpp v72, v72, v72 row_ror:8 row_mask:0xf bank_mask:0xf
    s_nop 0
    v_max_u32_dpp v64, v64, v64 row_ror:4 row_mask:0xf bank_mask:0xf
    v_add_f32_dpp v72, v72, v72 row_ror:4 row_mask:0xf bank_mask:0xf
    s_nop 0
    v_max_u32_dpp v64, v64, v64 row_ror:2 row_mask:0xf bank_mask:0xf
    v_add_f32_dpp v72, v72, v72 row_ror:2 row_mask:0xf bank_mask:0xf
    s_nop 0
    v_max_u32_dpp v64, v64, v64 row_ror:1 row_mask:0xf bank_mask:0xf
    v_add_f32_dpp v72, v72, v72 row_ror:1 row_mask:0xf bank_mask:0xf
    s_nop 0
    v_max_u32_dpp v64, v64, v64 row_bcast:15 row_mask:0xa bank_mask:0xf
    v_max_u32_dpp v72, v72, v72 row_bcast:15 row_mask:0xa bank_mask:0xf
    s_nop 0
    v_max_u32_dpp v64, v64, v64 row_bcast:31 row_mask:0xc bank_mask:0xf
    v_max_u32_dpp v72, v72, v72 row_bcast:31 row_mask:0xc bank_mask:0xf

    s_mov_b32 exec_lo, 0
    s_brev_b32 exec_hi, 1
    v_min_u32 v64, 0x7f000000, v64
    v_min_u32 v72, 0x7f000000, v72
    v_perm_b32 v64, v64, v72, s85
    v_add_u32 v64, 0x10001, v64
    buffer_store_dword v64, off, s[32:35], s78 sc1
    s_mov_b64 exec, -1
k1_kernel_nsq:

    s_cmp_eq_u32 s45, 3
    s_cbranch_scc0 k1_kernel_wdec
    s_lshl_b32 s45, s2, 8
    s_add_u32 s45, s45, 14680064
    v_lshlrev_b32 v0, 8, v8
    v_mov_b32 v116, 0
    s_lshl4_add_u32 s38, s39, 14680064
    s_cmp_lg_u32 s64, 0
    s_cbranch_scc1 k1_kernel_bits
    s_waitcnt vmcnt(6)
    v_readfirstlane_b32 s39, v3

    s_cmp_eq_u32 s39, 127
    s_cbranch_scc0 k1_kernel_poll0

    buffer_store_dword v10, v0, s[12:15], s38 offen sc1
    s_add_u32 s38, s38, 16384
    buffer_store_dword v10, v0, s[12:15], s38 offen sc1
    s_add_u32 s38, s38, 16384
    buffer_store_dword v10, v0, s[12:15], s38 offen sc1
    s_add_u32 s38, s38, 16384
    buffer_store_dword v10, v0, s[12:15], s38 offen sc1

k1_kernel_poll0:
    s_mov_b64 exec, 3
k1_kernel_poll:
    buffer_load_dword v116, v9, s[12:15], s45 offen sc1
    s_add_u32 s65, s65, 1
    s_waitcnt vmcnt(0)
    v_cmp_ne_u32 vcc, 1, v116
    s_cbranch_vccz k1_kernel_go

    s_cmp_lt_u32 s65, 200
    s_cbranch_scc1 k1_kernel_poll
k1_kernel_bits:
    s_mov_b64 exec, -1
    s_lshr_b32 s38, s51, 5
    s_lshl_b32 s39, 1, s51
    v_cmp_eq_u32 vcc, s38, v8
    v_mov_b32 v2, s39
    v_lshlrev_b32 v0, 2, v8
    v_cndmask_b32 v2, 0, v2, vcc
    v_mov_b32 v1, v2
    buffer_atomic_or v1, v0, s[52:55], 0 offen sc0
    s_waitcnt vmcnt(0)
    v_cmp_ne_u32 vcc, 128, v1
    v_or_b32 v1, v1, v2
    s_and_b32 s38, vcc_lo, 0x100
    s_and_b32 s39, vcc_hi, 0x100
    v_cmp_ne_u32 vcc, -1, v1
    s_or_b32 s38, s38, s39
    s_cbranch_scc0 k1_kernel_go
    s_and_b32 s39, vcc_lo, 0xff
    s_mov_b32 s38, 0xc0000000
    s_cbranch_scc0 k1_kernel_dec
    s_ff1_i32_b32 s38, s39
    s_nop 3
    v_readlane_b32 s39, v1, s38
    s_ff0_i32_b32 s39, s39
    s_lshl_b32 s38, s38, 5
    s_add_u32 s38, s38, s39
    s_andn2_b32 s39, s64, 255
    s_add_u32 s39, s39, 256
    s_or_b32 s38, s38, s39
    s_branch k1_kernel_dec

k1_kernel_go:

    s_mov_b32 s38, 0x80000000

k1_kernel_dec:

    v_mov_b32 v1, s38
    s_mov_b64 exec, 1
    ds_write_b32 v11, v1 offset:24

k1_kernel_wdec:

    s_mov_b64 exec, -1
    ds_read_b32 v12, v11 offset:24
    s_waitcnt lgkmcnt(0)
    v_readfirstlane_b32 s45, v12
    s_cmp_lg_u32 s45, s64
    s_cbranch_scc1 k1_kernel_gotd
    s_sleep 2
    s_branch k1_kernel_wdec
k1_kernel_redo:
    s_waitcnt vmcnt(0) lgkmcnt(0)
    s_branch k1_kernel_unit

k1_kernel_gotd:

    s_mov_b32 s64, s45
    s_and_b32 s51, s45, 255
    s_mov_b32 s65, 0x10000
    s_bitcmp0_b32 s45, 31
    s_cbranch_scc1 k1_kernel_redo

k1_kernel_k2:

    s_setprio 0
    s_load_dwordx4 s[8:11], s[0:1], 32
    s_load_dwordx2 s[56:57], s[0:1], 48
    s_load_dwordx2 s[60:61], s[0:1], 56
    v_mbcnt_lo_u32_b32 v0, -1, 0
    v_mbcnt_hi_u32_b32 v0, -1, v0
    s_mul_i32 s35, s3, 18432
    v_and_b32 v1, 15, v0
    v_lshrrev_b32 v2, 4, v0
    v_mul_u32_u24 v65, 144, v1
    v_lshl_add_u32 v65, v2, 4, v65
    v_add_u32 v65, s35, v65

    ds_read_b128 v[128:131], v65 offset:0
    ds_read_b128 v[132:135], v65 offset:64
    ds_read_b128 v[144:147], v65 offset:2304
    ds_read_b128 v[148:151], v65 offset:2368
    ds_read_b128 v[160:163], v65 offset:4608
    ds_read_b128 v[164:167], v65 offset:4672
    ds_read_b128 v[176:179], v65 offset:6912
    ds_read_b128 v[180:183], v65 offset:6976
    ds_read_b128 v[192:195], v65 offset:9216
    ds_read_b128 v[196:199], v65 offset:9280
    ds_read_b128 v[208:211], v65 offset:11520
    ds_read_b128 v[212:215], v65 offset:11584
    ds_read_b128 v[224:227], v65 offset:13824
    ds_read_b128 v[228:231], v65 offset:13888
    ds_read_b128 v[240:243], v65 offset:16128
    ds_read_b128 v[244:247], v65 offset:16192

    s_lshr_b32 s33, s2, 1
    s_and_b32 s34, s2, 1
    v_lshlrev_b32 v71, 4, v0

    s_mul_i32 s21, s33, 102656
    s_mul_i32 s35, s34, 49152
    s_sub_u32 s22, 53248, s35
    s_add_u32 s21, s21, s35
    s_lshl_b32 s35, s50, 11
    s_xor_b32 s19, s35, 2048
    s_add_u32 s19, s19, s21
    s_add_u32 s21, s21, s35
    s_mul_i32 s20, s34, 1703936
    s_add_u32 s20, s20, 16777216
    s_lshl_b32 s35, s3, 14
    s_add_u32 s20, s20, s35

    v_lshlrev_b32 v64, 13, v2
    v_lshl_add_u32 v64, v1, 3, v64
    s_lshl_b32 s35, s3, 10
    v_add_u32 v64, s35, v64
    v_mov_b32 v70, v64
    s_mov_b32 s23, 0x06050201

    s_bitcmp0_b32 s64, 31
    s_cbranch_scc1 k1_kernel_k2n
    s_cmp_lt_u32 s3, 4
    s_cbranch_scc1 k1_kernel_k2s
    v_bfe_u32 v84, v71, 2, 7
    s_mov_b32 s35, 15466496
    buffer_load_dwordx4 v[72:75], v71, s[12:15], s35 offen offset:0 sc1
    buffer_load_dwordx4 v[76:79], v71, s[12:15], s35 offen offset:1024 sc1
    buffer_load_dwordx4 v[80:83], v71, s[12:15], s35 offen offset:2048 sc1
    buffer_load_dword v84, v84, s[12:15], s35 offen offset:3584 sc1
k1_kernel_k2s:
    buffer_load_dwordx4 v[0:3], v71, s[12:15], s21 offen offset:0
    buffer_load_dwordx4 v[4:7], v71, s[12:15], s21 offen offset:1024
    buffer_load_dwordx4 v[8:11], v71, s[12:15], s19 offen offset:0
    buffer_load_dwordx4 v[12:15], v71, s[12:15], s19 offen offset:1024
    s_add_u32 s21, s21, 4096
    s_add_u32 s19, s19, 4096
    buffer_load_dwordx4 v[16:19], v71, s[12:15], s21 offen offset:0
    buffer_load_dwordx4 v[20:23], v71, s[12:15], s21 offen offset:1024
    buffer_load_dwordx4 v[24:27], v71, s[12:15], s19 offen offset:0
    buffer_load_dwordx4 v[28:31], v71, s[12:15], s19 offen offset:1024
    s_add_u32 s21, s21, 4096
    s_add_u32 s19, s19, 4096
    s_cmp_lt_u32 s3, 4
    s_cbranch_scc1 k1_kernel_k2n
    s_mov_b32 s44, s21
    s_mov_b32 s45, s19
    s_add_u32 s21, s21, 4096
    s_add_u32 s19, s19, 4096
    buffer_load_dwordx2 v[116:117], v71, s[12:15], s20 offen offset:0 sc1
    buffer_load_dwordx2 v[118:119], v71, s[12:15], s20 offen offset:1024 sc1
    buffer_load_dwordx2 v[120:121], v71, s[12:15], s20 offen offset:2048 sc1
    buffer_load_dwordx2 v[122:123], v71, s[12:15], s20 offen offset:3072 sc1
    s_waitcnt vmcnt(12)

k1_kernel_scb0:
    v_max3_u16 v85, v72, v73, v74
    v_add_f32 v76, v76, v80
    v_add_f32 v77, v77, v81
    v_max_u16_sdwa v85, v85, v75 dst_sel:WORD_1 dst_unused:UNUSED_PAD src0_sel:WORD_0 src1_sel:WORD_0
    v_add_f32 v78, v78, v82
    v_add_f32 v79, v79, v83
    v_add_f32 v72, v72, v74
    v_add_f32 v73, v73, v75
    v_add_f32 v76, v76, v78
    v_add_f32 v77, v77, v79
    v_max_u32_dpp v85, v85, v85 row_ror:8 row_mask:0xf bank_mask:0xf
    v_add_f32 v76, v76, v72
    v_add_f32 v77, v77, v73
    v_max_u32_dpp v85, v85, v85 row_ror:4 row_mask:0xf bank_mask:0xf
    v_add_f32 v76, v76, v77
    v_add_f32 v76, v76, v84
    v_max_u32_dpp v85, v85, v85 row_ror:2 row_mask:0xf bank_mask:0xf
    s_nop 0
    v_add_f32_dpp v76, v76, v76 row_ror:8 row_mask:0xf bank_mask:0xf
    v_max_u32_dpp v85, v85, v85 row_ror:1 row_mask:0xf bank_mask:0xf
    s_nop 0
    v_add_f32_dpp v76, v76, v76 row_ror:4 row_mask:0xf bank_mask:0xf
    v_max_u32_dpp v85, v85, v85 row_bcast:15 row_mask:0xa bank_mask:0xf
    s_nop 0
    v_add_f32_dpp v76, v76, v76 row_ror:2 row_mask:0xf bank_mask:0xf
    v_max_u32_dpp v85, v85, v85 row_bcast:31 row_mask:0xc bank_mask:0xf
    s_nop 0
    v_add_f32_dpp v76, v76, v76 row_ror:1 row_mask:0xf bank_mask:0xf
    v_mul_f32 v85, 0x425428f6, v85
    s_nop 0
    v_add_f32_dpp v76, v76, v76 row_bcast:15 row_mask:0xa bank_mask:0xf
    s_nop 1
    v_max_u32_dpp v76, v76, v76 row_bcast:31 row_mask:0xc bank_mask:0xf
    v_mul_f32 v76, v76, v85
    s_nop 0
    v_readlane_b32 s26, v76, 63
    s_cmp_gt_u32 s26, 0x7f800000
    s_cbranch_scc1 k1_kernel_scr0
    s_add_u32 s26, s26, 0x40800000
    s_lshr_b32 s26, s26, 24
    s_lshl_b32 s26, s26, 23
    s_add_u32 s26, s26, 0x400080
    v_mov_b32 v66, s26
    v_mov_b32 v67, s26
    v_mov_b32 v68, s26
    v_mov_b32 v69, s26
    buffer_load_dwordx4 v[72:75], v71, s[12:15], s21 offen offset:0
    buffer_load_dwordx4 v[76:79], v71, s[12:15], s21 offen offset:1024
    buffer_load_dwordx4 v[80:83], v71, s[12:15], s19 offen offset:0
    buffer_load_dwordx4 v[84:87], v71, s[12:15], s19 offen offset:1024
    s_add_u32 s21, s21, 4096
    s_add_u32 s19, s19, 4096
    v_mov_b32 v65, 0
    ds_write_b128 v65, v[66:69] offset:28928
k1_kernel_k2n:

    s_and_b32 s35, s3, 3
    s_lshl_b32 s35, s35, 14
    s_add_u32 s35, s35, 98304
    v_add_u32 v65, s35, v71

    s_lshl_b32 s16, s2, 3
    s_add_u32 s16, s16, s3
    s_lshl_b32 s46, s16, 7
    s_mul_i32 s16, s16, 8448
    s_add_u32 s46, s46, 30408704
    s_add_u32 s16, s16, 67108864

    s_xor_b32 s47, s46, 1024
    s_mul_i32 s35, s34, 135168
    s_add_u32 s18, s16, 67584
    s_sub_u32 s18, s18, s35
    s_mov_b32 s48, 0
    s_lshl_b32 s35, s33, 3
    s_waitcnt lgkmcnt(0)
    s_add_u32 s8, s8, s35
    s_addc_u32 s9, s9, 0
    s_add_u32 s10, s10, s35
    s_addc_u32 s11, s11, 0
    s_load_dwordx2 s[36:37], s[8:9], 0
    s_load_dwordx2 s[38:39], s[10:11], 0
    s_barrier

    s_cmp_lt_u32 s3, 4
    s_cbranch_scc1 k1_kernel_k2m

    s_waitcnt vmcnt(12)
    s_setprio 1
    ds_write_b128 v65, v[32:35] offset:0
    ds_write_b128 v65, v[36:39] offset:1024
    ds_write_b128 v65, v[40:43] offset:2048
    ds_write_b128 v65, v[44:47] offset:3072
    v_mfma_f32_16x16x32_bf16 v[32:35], v[0:3], v[128:131], v[66:69]
    v_mfma_f32_16x16x32_bf16 v[36:39], v[0:3], v[144:147], v[66:69]
    ds_write_b128 v65, v[48:51] offset:4096
    v_mfma_f32_16x16x32_bf16 v[40:43], v[0:3], v[160:163], v[66:69]
    v_mfma_f32_16x16x32_bf16 v[44:47], v[0:3], v[176:179], v[66:69]
    ds_write_b128 v65, v[52:55] offset:5120
    v_mfma_f32_16x16x32_bf16 v[32:35], v[4:7], v[132:135], v[32:35]
    v_mfma_f32_16x16x32_bf16 v[36:39], v[4:7], v[148:151], v[36:39]
    ds_write_b128 v65, v[56:59] offset:6144
    v_mfma_f32_16x16x32_bf16 v[40:43], v[4:7], v[164:167], v[40:43]
    v_mfma_f32_16x16x32_bf16 v[44:47], v[4:7], v[180:183], v[44:47]
    ds_write_b128 v65, v[60:63] offset:7168
    v_mfma_f32_16x16x32_bf16 v[32:35], v[8:11], v[136:139], v[32:35]
    v_mfma_f32_16x16x32_bf16 v[36:39], v[8:11], v[152:155], v[36:39]
    ds_write_b128 v65, v[88:91] offset:8192
    v_mfma_f32_16x16x32_bf16 v[40:43], v[8:11], v[168:171], v[40:43]
    v_mfma_f32_16x16x32_bf16 v[44:47], v[8:11], v[184:187], v[44:47]
    ds_write_b128 v65, v[92:95] offset:9216
    v_mfma_f32_16x16x32_bf16 v[32:35], v[12:15], v[140:143], v[32:35]
    v_mfma_f32_16x16x32_bf16 v[36:39], v[12:15], v[156:159], v[36:39]
    ds_write_b128 v65, v[96:99] offset:10240
    v_mfma_f32_16x16x32_bf16 v[40:43], v[12:15], v[172:175], v[40:43]
    v_mfma_f32_16x16x32_bf16 v[44:47], v[12:15], v[188:191], v[44:47]
    ds_write_b128 v65, v[100:103] offset:11264
    v_mfma_f32_16x16x32_bf16 v[48:51], v[0:3], v[192:195], v[66:69]
    v_mfma_f32_16x16x32_bf16 v[52:55], v[0:3], v[208:211], v[66:69]
    ds_write_b128 v65, v[104:107] offset:12288
    v_mfma_f32_16x16x32_bf16 v[56:59], v[0:3], v[224:227], v[66:69]
    v_mfma_f32_16x16x32_bf16 v[60:63], v[0:3], v[240:243], v[66:69]
    ds_write_b128 v65, v[108:111] offset:13312
    v_mfma_f32_16x16x32_bf16 v[48:51], v[4:7], v[196:199], v[48:51]
    v_mfma_f32_16x16x32_bf16 v[52:55], v[4:7], v[212:215], v[52:55]
    ds_write_b128 v65, v[112:115] offset:14336
    v_mfma_f32_16x16x32_bf16 v[56:59], v[4:7], v[228:231], v[56:59]
    v_mfma_f32_16x16x32_bf16 v[60:63], v[4:7], v[244:247], v[60:63]
    ds_write_b128 v65, v[124:127] offset:15360
    v_mfma_f32_16x16x32_bf16 v[48:51], v[8:11], v[200:203], v[48:51]
    v_mfma_f32_16x16x32_bf16 v[52:55], v[8:11], v[216:219], v[52:55]
    v_mfma_f32_16x16x32_bf16 v[56:59], v[8:11], v[232:235], v[56:59]
    v_mfma_f32_16x16x32_bf16 v[60:63], v[8:11], v[248:251], v[60:63]
    s_waitcnt lgkmcnt(0)
    s_barrier
    s_setprio 0
    v_mfma_f32_16x16x32_bf16 v[48:51], v[12:15], v[204:207], v[48:51]
    v_mfma_f32_16x16x32_bf16 v[52:55], v[12:15], v[220:223], v[52:55]
    v_mfma_f32_16x16x32_bf16 v[56:59], v[12:15], v[236:239], v[56:59]
    v_mfma_f32_16x16x32_bf16 v[60:63], v[12:15], v[252:255], v[60:63]
    s_add_u32 s20, s20, 4096
    buffer_load_dwordx2 v[124:125], v71, s[12:15], s20 offen offset:0 sc1
    buffer_load_dwordx2 v[126:127], v71, s[12:15], s20 offen offset:1024 sc1
    buffer_load_dwordx4 v[0:3], v71, s[12:15], s44 offen offset:0
    buffer_load_dwordx4 v[4:7], v71, s[12:15], s44 offen offset:1024
    buffer_load_dwordx4 v[8:11], v71, s[12:15], s45 offen offset:0
    buffer_load_dwordx4 v[12:15], v71, s[12:15], s45 offen offset:1024
    s_waitcnt vmcnt(14)
    v_readfirstlane_b32 s26, v66
    s_bfe_u32 s25, s26, 0x10017
    s_lshl1_add_u32 s25, s25, 1
    s_mul_i32 s24, s25, 0xfff30000
    s_mul_i32 s25, s25, 0xfff40000
    s_and_b32 s26, s26, 0x7f800000
    s_add_u32 s24, s24, 0x80008000
    s_add_u32 s25, s25, 0x80008000
    s_sub_u32 s26, s26, 0x7800000
    s_mov_b32 s27, 0x4b000000

    v_mfma_f32_16x16x32_bf16 v[88:91], v[16:19], v[128:131], v[66:69]
    v_mfma_f32_16x16x32_bf16 v[92:95], v[16:19], v[144:147], v[66:69]
    v_mfma_f32_16x16x32_bf16 v[88:91], v[20:23], v[132:135], v[88:91]
    v_mfma_f32_16x16x32_bf16 v[92:95], v[20:23], v[148:151], v[92:95]
    v_mfma_f32_16x16x32_bf16 v[88:91], v[24:27], v[136:139], v[88:91]
    v_perm_b32 v32, v33, v32, s23
    v_mfma_f32_16x16x32_bf16 v[92:95], v[24:27], v[152:155], v[92:95]
    v_perm_b32 v33, v35, v34, s23
    v_mfma_f32_16x16x32_bf16 v[88:91], v[28:31], v[140:143], v[88:91]
    ds_write_b64 v64, v[32:33] offset:0
    v_mfma_f32_16x16x32_bf16 v[92:95], v[28:31], v[156:159], v[92:95]
    v_perm_b32 v36, v37, v36, s23
    v_mfma_f32_16x16x32_bf16 v[96:99], v[16:19], v[160:163], v[66:69]
    v_perm_b32 v37, v39, v38, s23
    v_mfma_f32_16x16x32_bf16 v[100:103], v[16:19], v[176:179], v[66:69]
    ds_write_b64 v64, v[36:37] offset:128
    v_mfma_f32_16x16x32_bf16 v[96:99], v[20:23], v[164:167], v[96:99]
    v_perm_b32 v88, v89, v88, s23
    v_perm_b32 v40, v41, v40, s23
    v_mfma_f32_16x16x32_bf16 v[100:103], v[20:23], v[180:183], v[100:103]
    v_perm_b32 v89, v91, v90, s23
    v_perm_b32 v41, v43, v42, s23
    v_mfma_f32_16x16x32_bf16 v[96:99], v[24:27], v[168:171], v[96:99]
    ds_write_b64 v64, v[88:89] offset:32768
    ds_write_b64 v64, v[40:41] offset:256
    v_mfma_f32_16x16x32_bf16 v[100:103], v[24:27], v[184:187], v[100:103]
    v_perm_b32 v92, v93, v92, s23
    v_perm_b32 v44, v45, v44, s23
    v_mfma_f32_16x16x32_bf16 v[96:99], v[28:31], v[172:175], v[96:99]
    v_perm_b32 v93, v95, v94, s23
    v_perm_b32 v45, v47, v46, s23
    v_mfma_f32_16x16x32_bf16 v[100:103], v[28:31], v[188:191], v[100:103]
    ds_write_b64 v64, v[92:93] offset:32896
    ds_write_b64 v64, v[44:45] offset:384
    v_mfma_f32_16x16x32_bf16 v[104:107], v[16:19], v[192:195], v[66:69]
    v_perm_b32 v48, v49, v48, s23
    v_mfma_f32_16x16x32_bf16 v[108:111], v[16:19], v[208:211], v[66:69]
    v_perm_b32 v49, v51, v50, s23
    v_mfma_f32_16x16x32_bf16 v[104:107], v[20:23], v[196:199], v[104:107]
    v_perm_b32 v96, v97, v96, s23
    ds_write_b64 v64, v[48:49] offset:512
    v_mfma_f32_16x16x32_bf16 v[108:111], v[20:23], v[212:215], v[108:111]
    v_perm_b32 v97, v99, v98, s23
    v_perm_b32 v52, v53, v52, s23
    v_mfma_f32_16x16x32_bf16 v[104:107], v[24:27], v[200:203], v[104:107]
    ds_write_b64 v64, v[96:97] offset:33024
    v_perm_b32 v53, v55, v54, s23
    v_mfma_f32_16x16x32_bf16 v[108:111], v[24:27], v[216:219], v[108:111]
    v_perm_b32 v100, v101, v100, s23
    ds_write_b64 v64, v[52:53] offset:640
    v_mfma_f32_16x16x32_bf16 v[104:107], v[28:31], v[204:207], v[104:107]
    v_perm_b32 v101, v103, v102, s23
    v_perm_b32 v56, v57, v56, s23
    v_mfma_f32_16x16x32_bf16 v[108:111], v[28:31], v[220:223], v[108:111]
    ds_write_b64 v64, v[100:101] offset:33152
    v_perm_b32 v57, v59, v58, s23
    v_mfma_f32_16x16x32_bf16 v[88:91], v[16:19], v[224:227], v[66:69]
    ds_write_b64 v64, v[56:57] offset:768
    v_mfma_f32_16x16x32_bf16 v[92:95], v[16:19], v[240:243], v[66:69]
    v_perm_b32 v60, v61, v60, s23
    v_mfma_f32_16x16x32_bf16 v[88:91], v[20:23], v[228:231], v[88:91]
    v_perm_b32 v104, v105, v104, s23
    v_perm_b32 v61, v63, v62, s23
    v_mfma_f32_16x16x32_bf16 v[92:95], v[20:23], v[244:247], v[92:95]
    v_perm_b32 v105, v107, v106, s23
    ds_write_b64 v64, v[60:61] offset:896
    v_mfma_f32_16x16x32_bf16 v[88:91], v[24:27], v[232:235], v[88:91]
    ds_write_b64 v64, v[104:105] offset:33280
    v_mfma_f32_16x16x32_bf16 v[92:95], v[24:27], v[248:251], v[92:95]
    v_perm_b32 v108, v109, v108, s23
    v_mfma_f32_16x16x32_bf16 v[88:91], v[28:31], v[236:239], v[88:91]
    v_perm_b32 v109, v111, v110, s23
    v_mfma_f32_16x16x32_bf16 v[92:95], v[28:31], v[252:255], v[92:95]
    ds_write_b64 v64, v[108:109] offset:33408
    v_add_u32 v64, 0x8000, v64
    s_waitcnt vmcnt(0)
    v_mfma_f32_16x16x32_bf16 v[96:99], v[0:3], v[128:131], v[66:69]
    v_mfma_f32_16x16x32_bf16 v[100:103], v[0:3], v[144:147], v[66:69]
    v_mfma_f32_16x16x32_bf16 v[96:99], v[4:7], v[132:135], v[96:99]
    v_perm_b32 v88, v89, v88, s23
    v_mfma_f32_16x16x32_bf16 v[100:103], v[4:7], v[148:151], v[100:103]
    v_perm_b32 v89, v91, v90, s23
    v_mfma_f32_16x16x32_bf16 v[96:99], v[8:11], v[136:139], v[96:99]
    ds_write_b64 v64, v[88:89] offset:768
    v_mfma_f32_16x16x32_bf16 v[100:103], v[8:11], v[152:155], v[100:103]
    v_perm_b32 v92, v93, v92, s23
    v_mfma_f32_16x16x32_bf16 v[96:99], v[12:15], v[140:143], v[96:99]
    v_perm_b32 v93, v95, v94, s23
    v_mfma_f32_16x16x32_bf16 v[100:103], v[12:15], v[156:159], v[100:103]
    ds_write_b64 v64, v[92:93] offset:896
    v_mfma_f32_16x16x32_bf16 v[104:107], v[0:3], v[160:163], v[66:69]
    v_mfma_f32_16x16x32_bf16 v[108:111], v[0:3], v[176:179], v[66:69]
    v_mfma_f32_16x16x32_bf16 v[104:107], v[4:7], v[164:167], v[104:107]
    v_perm_b32 v96, v97, v96, s23
    v_mfma_f32_16x16x32_bf16 v[108:111], v[4:7], v[180:183], v[108:111]
    v_perm_b32 v97, v99, v98, s23
    v_mfma_f32_16x16x32_bf16 v[104:107], v[8:11], v[168:171], v[104:107]
    ds_write_b64 v64, v[96:97] offset:32768
    v_mfma_f32_16x16x32_bf16 v[108:111], v[8:11], v[184:187], v[108:111]
    v_perm_b32 v100, v101, v100, s23
    v_mfma_f32_16x16x32_bf16 v[104:107], v[12:15], v[172:175], v[104:107]
    v_perm_b32 v101, v103, v102, s23
    v_mfma_f32_16x16x32_bf16 v[108:111], v[12:15], v[188:191], v[108:111]
    ds_write_b64 v64, v[100:101] offset:32896
    v_mfma_f32_16x16x32_bf16 v[88:91], v[0:3], v[192:195], v[66:69]
    v_mfma_f32_16x16x32_bf16 v[92:95], v[0:3], v[208:211], v[66:69]
    v_mfma_f32_16x16x32_bf16 v[88:91], v[4:7], v[196:199], v[88:91]
    v_perm_b32 v104, v105, v104, s23
    v_mfma_f32_16x16x32_bf16 v[92:95], v[4:7], v[212:215], v[92:95]
    v_perm_b32 v105, v107, v106, s23
    v_mfma_f32_16x16x32_bf16 v[88:91], v[8:11], v[200:203], v[88:91]
    ds_write_b64 v64, v[104:105] offset:33024
    v_mfma_f32_16x16x32_bf16 v[92:95], v[8:11], v[216:219], v[92:95]
    v_perm_b32 v108, v109, v108, s23
    v_mfma_f32_16x16x32_bf16 v[88:91], v[12:15], v[204:207], v[88:91]
    v_perm_b32 v109, v111, v110, s23
    v_mfma_f32_16x16x32_bf16 v[92:95], v[12:15], v[220:223], v[92:95]
    ds_write_b64 v64, v[108:109] offset:33152
    v_mfma_f32_16x16x32_bf16 v[96:99], v[0:3], v[224:227], v[66:69]
    v_mfma_f32_16x16x32_bf16 v[100:103], v[0:3], v[240:243], v[66:69]
    v_mfma_f32_16x16x32_bf16 v[96:99], v[4:7], v[228:231], v[96:99]
    v_perm_b32 v88, v89, v88, s23
    v_mfma_f32_16x16x32_bf16 v[100:103], v[4:7], v[244:247], v[100:103]
    v_perm_b32 v89, v91, v90, s23
    v_mfma_f32_16x16x32_bf16 v[96:99], v[8:11], v[232:235], v[96:99]
    ds_write_b64 v64, v[88:89] offset:33280
    v_mfma_f32_16x16x32_bf16 v[100:103], v[8:11], v[248:251], v[100:103]
    v_perm_b32 v92, v93, v92, s23
    v_mfma_f32_16x16x32_bf16 v[96:99], v[12:15], v[236:239], v[96:99]
    v_perm_b32 v93, v95, v94, s23
    v_mfma_f32_16x16x32_bf16 v[100:103], v[12:15], v[252:255], v[100:103]
    ds_write_b64 v64, v[92:93] offset:33408
    s_nop 7
    v_perm_b32 v96, v97, v96, s23
    v_perm_b32 v97, v99, v98, s23
    ds_write_b64 v64, v[96:97] offset:33536
    v_perm_b32 v100, v101, v100, s23
    v_perm_b32 v101, v103, v102, s23
    ds_write_b64 v64, v[100:101] offset:33664

    s_cmp_lg_u32 s3, 7
    s_cbranch_scc1 k1_kernel_k2j
k1_kernel_k2w:
    s_bfe_u32 s35, s64, 0x1001e
    v_mov_b32 v65, 0
    v_mov_b32 v64, s35
    ds_write_b32 v65, v64 offset:8184
    s_branch k1_kernel_k2j

k1_kernel_k2m:
    s_bitcmp1_b32 s64, 31
    s_cbranch_scc1 k1_kernel_k2e
    buffer_load_dwordx4 v[0:3], v71, s[12:15], s21 offen offset:0
    buffer_load_dwordx4 v[4:7], v71, s[12:15], s21 offen offset:1024
    buffer_load_dwordx4 v[8:11], v71, s[12:15], s19 offen offset:0
    buffer_load_dwordx4 v[12:15], v71, s[12:15], s19 offen offset:1024
    s_add_u32 s21, s21, 4096
    s_add_u32 s19, s19, 4096
    buffer_load_dwordx4 v[16:19], v71, s[12:15], s21 offen offset:0
    buffer_load_dwordx4 v[20:23], v71, s[12:15], s21 offen offset:1024
    buffer_load_dwordx4 v[24:27], v71, s[12:15], s19 offen offset:0
    buffer_load_dwordx4 v[28:31], v71, s[12:15], s19 offen offset:1024
    s_add_u32 s21, s21, 4096
    s_add_u32 s19, s19, 4096
k1_kernel_k2e:
    v_mov_b32 v66, 0
    ds_read_b128 v[66:69], v66 offset:28928
    s_mov_b32 s44, s21
    s_mov_b32 s45, s19
    s_add_u32 s21, s21, 4096
    s_add_u32 s19, s19, 4096
    s_waitcnt vmcnt(4) lgkmcnt(0)
    v_mfma_f32_16x16x32_bf16 v[48:51], v[0:3], v[128:131], v[66:69]
    v_mfma_f32_16x16x32_bf16 v[52:55], v[0:3], v[144:147], v[66:69]
    v_mfma_f32_16x16x32_bf16 v[56:59], v[0:3], v[160:163], v[66:69]
    v_mfma_f32_16x16x32_bf16 v[60:63], v[0:3], v[176:179], v[66:69]
    v_mfma_f32_16x16x32_bf16 v[88:91], v[0:3], v[192:195], v[66:69]
    v_mfma_f32_16x16x32_bf16 v[92:95], v[0:3], v[208:211], v[66:69]
    v_mfma_f32_16x16x32_bf16 v[96:99], v[0:3], v[224:227], v[66:69]
    v_mfma_f32_16x16x32_bf16 v[100:103], v[0:3], v[240:243], v[66:69]
    v_mfma_f32_16x16x32_bf16 v[48:51], v[4:7], v[132:135], v[48:51]
    v_mfma_f32_16x16x32_bf16 v[52:55], v[4:7], v[148:151], v[52:55]
    v_mfma_f32_16x16x32_bf16 v[56:59], v[4:7], v[164:167], v[56:59]
    v_mfma_f32_16x16x32_bf16 v[60:63], v[4:7], v[180:183], v[60:63]
    v_mfma_f32_16x16x32_bf16 v[88:91], v[4:7], v[196:199], v[88:91]
    v_mfma_f32_16x16x32_bf16 v[92:95], v[4:7], v[212:215], v[92:95]
    v_mfma_f32_16x16x32_bf16 v[96:99], v[4:7], v[228:231], v[96:99]
    v_mfma_f32_16x16x32_bf16 v[100:103], v[4:7], v[244:247], v[100:103]
    s_waitcnt vmcnt(0)
    v_mfma_f32_16x16x32_bf16 v[116:119], v[16:19], v[128:131], v[66:69]
    v_mfma_f32_16x16x32_bf16 v[120:123], v[16:19], v[144:147], v[66:69]
    buffer_load_dwordx4 v[32:35], v71, s[12:15], s44 offen offset:0

    v_mfma_f32_16x16x32_bf16 v[72:75], v[16:19], v[160:163], v[66:69]
    v_mfma_f32_16x16x32_bf16 v[76:79], v[16:19], v[176:179], v[66:69]
    v_mfma_f32_16x16x32_bf16 v[80:83], v[16:19], v[192:195], v[66:69]
    v_mfma_f32_16x16x32_bf16 v[84:87], v[16:19], v[208:211], v[66:69]
    buffer_load_dwordx4 v[36:39], v71, s[12:15], s44 offen offset:1024

    v_mfma_f32_16x16x32_bf16 v[104:107], v[16:19], v[224:227], v[66:69]
    v_mfma_f32_16x16x32_bf16 v[108:111], v[16:19], v[240:243], v[66:69]
    v_mfma_f32_16x16x32_bf16 v[116:119], v[20:23], v[132:135], v[116:119]
    v_mfma_f32_16x16x32_bf16 v[120:123], v[20:23], v[148:151], v[120:123]
    buffer_load_dwordx4 v[40:43], v71, s[12:15], s45 offen offset:0

    v_mfma_f32_16x16x32_bf16 v[72:75], v[20:23], v[164:167], v[72:75]
    v_mfma_f32_16x16x32_bf16 v[76:79], v[20:23], v[180:183], v[76:79]
    v_mfma_f32_16x16x32_bf16 v[80:83], v[20:23], v[196:199], v[80:83]
    v_mfma_f32_16x16x32_bf16 v[84:87], v[20:23], v[212:215], v[84:87]
    buffer_load_dwordx4 v[44:47], v71, s[12:15], s45 offen offset:1024

    v_mfma_f32_16x16x32_bf16 v[104:107], v[20:23], v[228:231], v[104:107]
    v_mfma_f32_16x16x32_bf16 v[108:111], v[20:23], v[244:247], v[108:111]
    s_waitcnt lgkmcnt(0)
    s_barrier
    ds_read_b128 v[136:139], v65 offset:0
    ds_read_b128 v[140:143], v65 offset:1024
    ds_read_b128 v[152:155], v65 offset:2048
    ds_read_b128 v[156:159], v65 offset:3072
    ds_read_b128 v[168:171], v65 offset:4096
    ds_read_b128 v[172:175], v65 offset:5120
    ds_read_b128 v[184:187], v65 offset:6144
    ds_read_b128 v[188:191], v65 offset:7168
    ds_read_b128 v[200:203], v65 offset:8192
    ds_read_b128 v[204:207], v65 offset:9216
    ds_read_b128 v[216:219], v65 offset:10240
    ds_read_b128 v[220:223], v65 offset:11264
    ds_read_b128 v[232:235], v65 offset:12288
    ds_read_b128 v[236:239], v65 offset:13312
    ds_read_b128 v[248:251], v65 offset:14336
    ds_read_b128 v[252:255], v65 offset:15360

    v_readfirstlane_b32 s26, v66
    s_bfe_u32 s25, s26, 0x10017
    s_lshl1_add_u32 s25, s25, 1
    s_mul_i32 s24, s25, 0xfff30000
    s_mul_i32 s25, s25, 0xfff40000
    s_and_b32 s26, s26, 0x7f800000
    s_add_u32 s24, s24, 0x80008000
    s_add_u32 s25, s25, 0x80008000
    s_sub_u32 s26, s26, 0x7800000
    s_mov_b32 s27, 0x4b000000

    s_waitcnt lgkmcnt(12)
    v_mfma_f32_16x16x32_bf16 v[116:119], v[24:27], v[136:139], v[116:119]
    v_mfma_f32_16x16x32_bf16 v[120:123], v[24:27], v[152:155], v[120:123]
    v_mfma_f32_16x16x32_bf16 v[48:51], v[8:11], v[136:139], v[48:51]
    v_mfma_f32_16x16x32_bf16 v[52:55], v[8:11], v[152:155], v[52:55]
    v_mfma_f32_16x16x32_bf16 v[116:119], v[28:31], v[140:143], v[116:119]
    v_mfma_f32_16x16x32_bf16 v[120:123], v[28:31], v[156:159], v[120:123]
    v_mfma_f32_16x16x32_bf16 v[48:51], v[12:15], v[140:143], v[48:51]
    v_mfma_f32_16x16x32_bf16 v[52:55], v[12:15], v[156:159], v[52:55]
    s_waitcnt lgkmcnt(8)
    v_mfma_f32_16x16x32_bf16 v[72:75], v[24:27], v[168:171], v[72:75]
    v_mfma_f32_16x16x32_bf16 v[76:79], v[24:27], v[184:187], v[76:79]
    v_mfma_f32_16x16x32_bf16 v[56:59], v[8:11], v[168:171], v[56:59]
    v_perm_b32 v116, v117, v116, s23
    v_perm_b32 v117, v119, v118, s23
    v_mfma_f32_16x16x32_bf16 v[60:63], v[8:11], v[184:187], v[60:63]
    ds_write_b64 v64, v[116:117] offset:32768
    v_perm_b32 v120, v121, v120, s23
    v_mfma_f32_16x16x32_bf16 v[72:75], v[28:31], v[172:175], v[72:75]
    v_perm_b32 v121, v123, v122, s23
    ds_write_b64 v64, v[120:121] offset:32896
    v_mfma_f32_16x16x32_bf16 v[76:79], v[28:31], v[188:191], v[76:79]
    v_perm_b32 v48, v49, v48, s23
    v_perm_b32 v49, v51, v50, s23
    v_mfma_f32_16x16x32_bf16 v[56:59], v[12:15], v[172:175], v[56:59]
    ds_write_b64 v64, v[48:49] offset:0
    v_perm_b32 v52, v53, v52, s23
    v_mfma_f32_16x16x32_bf16 v[60:63], v[12:15], v[188:191], v[60:63]
    v_perm_b32 v53, v55, v54, s23
    ds_write_b64 v64, v[52:53] offset:128
    s_waitcnt lgkmcnt(8)
    v_mfma_f32_16x16x32_bf16 v[80:83], v[24:27], v[200:203], v[80:83]
    buffer_load_dwordx2 v[116:117], v71, s[12:15], s20 offen offset:0 sc1

    v_mfma_f32_16x16x32_bf16 v[84:87], v[24:27], v[216:219], v[84:87]
    v_mfma_f32_16x16x32_bf16 v[88:91], v[8:11], v[200:203], v[88:91]
    v_perm_b32 v72, v73, v72, s23
    v_perm_b32 v73, v75, v74, s23
    buffer_load_dwordx2 v[118:119], v71, s[12:15], s20 offen offset:1024 sc1

    v_mfma_f32_16x16x32_bf16 v[92:95], v[8:11], v[216:219], v[92:95]
    ds_write_b64 v64, v[72:73] offset:33024
    v_perm_b32 v76, v77, v76, s23
    v_mfma_f32_16x16x32_bf16 v[80:83], v[28:31], v[204:207], v[80:83]
    v_perm_b32 v77, v79, v78, s23
    ds_write_b64 v64, v[76:77] offset:33152
    buffer_load_dwordx2 v[120:121], v71, s[12:15], s20 offen offset:2048 sc1

    v_mfma_f32_16x16x32_bf16 v[84:87], v[28:31], v[220:223], v[84:87]
    v_perm_b32 v56, v57, v56, s23
    v_perm_b32 v57, v59, v58, s23
    v_mfma_f32_16x16x32_bf16 v[88:91], v[12:15], v[204:207], v[88:91]
    ds_write_b64 v64, v[56:57] offset:256
    v_perm_b32 v60, v61, v60, s23
    buffer_load_dwordx2 v[122:123], v71, s[12:15], s20 offen offset:3072 sc1

    v_mfma_f32_16x16x32_bf16 v[92:95], v[12:15], v[220:223], v[92:95]
    v_perm_b32 v61, v63, v62, s23
    ds_write_b64 v64, v[60:61] offset:384
    s_waitcnt lgkmcnt(8)
    v_mfma_f32_16x16x32_bf16 v[104:107], v[24:27], v[232:235], v[104:107]
    s_add_u32 s20, s20, 4096
    buffer_load_dwordx2 v[124:125], v71, s[12:15], s20 offen offset:0 sc1

    v_mfma_f32_16x16x32_bf16 v[108:111], v[24:27], v[248:251], v[108:111]
    v_mfma_f32_16x16x32_bf16 v[96:99], v[8:11], v[232:235], v[96:99]
    v_perm_b32 v80, v81, v80, s23
    v_perm_b32 v81, v83, v82, s23
    buffer_load_dwordx2 v[126:127], v71, s[12:15], s20 offen offset:1024 sc1

    v_mfma_f32_16x16x32_bf16 v[100:103], v[8:11], v[248:251], v[100:103]
    ds_write_b64 v64, v[80:81] offset:33280
    v_perm_b32 v84, v85, v84, s23
    v_mfma_f32_16x16x32_bf16 v[104:107], v[28:31], v[236:239], v[104:107]
    v_perm_b32 v85, v87, v86, s23
    ds_write_b64 v64, v[84:85] offset:33408
    v_mfma_f32_16x16x32_bf16 v[108:111], v[28:31], v[252:255], v[108:111]
    v_perm_b32 v88, v89, v88, s23
    v_perm_b32 v89, v91, v90, s23
    v_mfma_f32_16x16x32_bf16 v[96:99], v[12:15], v[236:239], v[96:99]
    ds_write_b64 v64, v[88:89] offset:512
    v_perm_b32 v92, v93, v92, s23
    v_mfma_f32_16x16x32_bf16 v[100:103], v[12:15], v[252:255], v[100:103]
    v_perm_b32 v93, v95, v94, s23
    ds_write_b64 v64, v[92:93] offset:640
    s_waitcnt vmcnt(6)
    v_mfma_f32_16x16x32_bf16 v[48:51], v[32:35], v[128:131], v[66:69]
    v_mfma_f32_16x16x32_bf16 v[52:55], v[32:35], v[144:147], v[66:69]
    v_mfma_f32_16x16x32_bf16 v[48:51], v[36:39], v[132:135], v[48:51]
    v_perm_b32 v104, v105, v104, s23
    v_mfma_f32_16x16x32_bf16 v[52:55], v[36:39], v[148:151], v[52:55]
    v_perm_b32 v105, v107, v106, s23
    v_mfma_f32_16x16x32_bf16 v[48:51], v[40:43], v[136:139], v[48:51]
    ds_write_b64 v64, v[104:105] offset:33536
    v_perm_b32 v96, v97, v96, s23
    v_perm_b32 v97, v99, v98, s23
    v_mfma_f32_16x16x32_bf16 v[52:55], v[40:43], v[152:155], v[52:55]
    v_perm_b32 v108, v109, v108, s23
    ds_write_b64 v64, v[96:97] offset:768
    v_perm_b32 v100, v101, v100, s23
    v_mfma_f32_16x16x32_bf16 v[48:51], v[44:47], v[140:143], v[48:51]
    v_perm_b32 v109, v111, v110, s23
    v_perm_b32 v101, v103, v102, s23
    ds_write_b64 v64, v[100:101] offset:896
    v_mfma_f32_16x16x32_bf16 v[52:55], v[44:47], v[156:159], v[52:55]
    ds_write_b64 v64, v[108:109] offset:33664
    v_add_u32 v64, 0x8000, v64
    v_mfma_f32_16x16x32_bf16 v[56:59], v[32:35], v[160:163], v[66:69]

    v_mfma_f32_16x16x32_bf16 v[60:63], v[32:35], v[176:179], v[66:69]
    buffer_load_dwordx4 v[72:75], v71, s[12:15], s21 offen offset:0

    v_mfma_f32_16x16x32_bf16 v[56:59], v[36:39], v[164:167], v[56:59]
    v_perm_b32 v48, v49, v48, s23

    v_mfma_f32_16x16x32_bf16 v[60:63], v[36:39], v[180:183], v[60:63]
    v_perm_b32 v49, v51, v50, s23

    v_mfma_f32_16x16x32_bf16 v[56:59], v[40:43], v[168:171], v[56:59]
    ds_write_b64 v64, v[48:49] offset:32768
    buffer_load_dwordx4 v[76:79], v71, s[12:15], s21 offen offset:1024

    v_mfma_f32_16x16x32_bf16 v[60:63], v[40:43], v[184:187], v[60:63]
    v_perm_b32 v52, v53, v52, s23

    v_mfma_f32_16x16x32_bf16 v[56:59], v[44:47], v[172:175], v[56:59]
    v_perm_b32 v53, v55, v54, s23

    v_mfma_f32_16x16x32_bf16 v[60:63], v[44:47], v[188:191], v[60:63]
    ds_write_b64 v64, v[52:53] offset:32896
    buffer_load_dwordx4 v[80:83], v71, s[12:15], s19 offen offset:0

    v_mfma_f32_16x16x32_bf16 v[88:91], v[32:35], v[192:195], v[66:69]

    v_mfma_f32_16x16x32_bf16 v[92:95], v[32:35], v[208:211], v[66:69]

    v_mfma_f32_16x16x32_bf16 v[88:91], v[36:39], v[196:199], v[88:91]
    v_perm_b32 v56, v57, v56, s23
    buffer_load_dwordx4 v[84:87], v71, s[12:15], s19 offen offset:1024
    s_add_u32 s21, s21, 4096
    s_add_u32 s19, s19, 4096

    v_mfma_f32_16x16x32_bf16 v[92:95], v[36:39], v[212:215], v[92:95]
    v_perm_b32 v57, v59, v58, s23

    v_mfma_f32_16x16x32_bf16 v[88:91], v[40:43], v[200:203], v[88:91]
    ds_write_b64 v64, v[56:57] offset:33024

    v_mfma_f32_16x16x32_bf16 v[92:95], v[40:43], v[216:219], v[92:95]
    v_perm_b32 v60, v61, v60, s23
    s_mov_b32 exec_lo, 0x00ff00ff
    s_mov_b32 exec_hi, 0x00ff00ff
    buffer_store_dword v112, v113, s[12:15], s74 offen sc1
    s_mov_b64 exec, -1
    v_mfma_f32_16x16x32_bf16 v[88:91], v[44:47], v[204:207], v[88:91]
    v_perm_b32 v61, v63, v62, s23

    v_mfma_f32_16x16x32_bf16 v[92:95], v[44:47], v[220:223], v[92:95]
    ds_write_b64 v64, v[60:61] offset:33152

    v_mfma_f32_16x16x32_bf16 v[48:51], v[32:35], v[224:227], v[66:69]

    v_mfma_f32_16x16x32_bf16 v[52:55], v[32:35], v[240:243], v[66:69]

    v_mfma_f32_16x16x32_bf16 v[48:51], v[36:39], v[228:231], v[48:51]
    v_perm_b32 v88, v89, v88, s23

    v_mfma_f32_16x16x32_bf16 v[52:55], v[36:39], v[244:247], v[52:55]
    v_perm_b32 v89, v91, v90, s23

    v_mfma_f32_16x16x32_bf16 v[48:51], v[40:43], v[232:235], v[48:51]
    ds_write_b64 v64, v[88:89] offset:33280

    v_mfma_f32_16x16x32_bf16 v[52:55], v[40:43], v[248:251], v[52:55]
    v_perm_b32 v92, v93, v92, s23

    v_mfma_f32_16x16x32_bf16 v[48:51], v[44:47], v[236:239], v[48:51]
    v_perm_b32 v93, v95, v94, s23

    v_mfma_f32_16x16x32_bf16 v[52:55], v[44:47], v[252:255], v[52:55]
    ds_write_b64 v64, v[92:93] offset:33408

    s_nop 7
    v_perm_b32 v48, v49, v48, s23
    v_perm_b32 v49, v51, v50, s23
    ds_write_b64 v64, v[48:49] offset:33536
    v_perm_b32 v52, v53, v52, s23
    v_perm_b32 v53, v55, v54, s23
    ds_write_b64 v64, v[52:53] offset:33664
    s_waitcnt vmcnt(5)
k1_kernel_k2j:

    v_mov_b32 v65, 0
    s_waitcnt lgkmcnt(0)
    s_barrier
    ds_read_b32 v65, v65 offset:8184

    s_setprio 3
    v_lshlrev_b32_sdwa v88, 3, v116 dst_sel:DWORD dst_unused:UNUSED_PAD src0_sel:DWORD src1_sel:WORD_0
    v_lshlrev_b32_sdwa v90, 3, v116 dst_sel:DWORD dst_unused:UNUSED_PAD src0_sel:DWORD src1_sel:WORD_1
    ds_read_b64 v[88:89], v88
    ds_read_b64 v[90:91], v90
    v_lshlrev_b32_sdwa v92, 3, v117 dst_sel:DWORD dst_unused:UNUSED_PAD src0_sel:DWORD src1_sel:WORD_0
    v_lshlrev_b32_sdwa v94, 3, v117 dst_sel:DWORD dst_unused:UNUSED_PAD src0_sel:DWORD src1_sel:WORD_1
    ds_read_b64 v[92:93], v92
    ds_read_b64 v[94:95], v94
    v_lshlrev_b32_sdwa v96, 3, v118 dst_sel:DWORD dst_unused:UNUSED_PAD src0_sel:DWORD src1_sel:WORD_0
    v_lshlrev_b32_sdwa v98, 3, v118 dst_sel:DWORD dst_unused:UNUSED_PAD src0_sel:DWORD src1_sel:WORD_1
    ds_read_b64 v[96:97], v96
    ds_read_b64 v[98:99], v98
    v_lshlrev_b32_sdwa v100, 3, v119 dst_sel:DWORD dst_unused:UNUSED_PAD src0_sel:DWORD src1_sel:WORD_0
    v_lshlrev_b32_sdwa v102, 3, v119 dst_sel:DWORD dst_unused:UNUSED_PAD src0_sel:DWORD src1_sel:WORD_1
    ds_read_b64 v[100:101], v100
    ds_read_b64 v[102:103], v102
    buffer_load_dwordx2 v[116:117], v71, s[12:15], s20 offen offset:2048 sc1
    buffer_load_dwordx2 v[118:119], v71, s[12:15], s20 offen offset:3072 sc1
    s_waitcnt lgkmcnt(8)
    v_readfirstlane_b32 s44, v65
    s_cmp_lg_u32 s44, 0
    s_cbranch_scc1 k1_kernel_solo1
    v_lshlrev_b32_sdwa v104, 3, v120 dst_sel:DWORD dst_unused:UNUSED_PAD src0_sel:DWORD src1_sel:WORD_0
    v_lshlrev_b32_sdwa v106, 3, v120 dst_sel:DWORD dst_unused:UNUSED_PAD src0_sel:DWORD src1_sel:WORD_1
    ds_read_b64 v[104:105], v104
    ds_read_b64 v[106:107], v106
    v_lshlrev_b32_sdwa v108, 3, v121 dst_sel:DWORD dst_unused:UNUSED_PAD src0_sel:DWORD src1_sel:WORD_0
    v_lshlrev_b32_sdwa v110, 3, v121 dst_sel:DWORD dst_unused:UNUSED_PAD src0_sel:DWORD src1_sel:WORD_1
    ds_read_b64 v[108:109], v108
    ds_read_b64 v[110:111], v110
    s_waitcnt lgkmcnt(8)
    v_add3_u32 v0, s24, v88, v90
    v_add3_u32 v1, s24, v89, v91
    v_add3_u32 v0, v0, v92, v94
    v_add3_u32 v1, v1, v93, v95
    v_lshlrev_b32_sdwa v88, 3, v122 dst_sel:DWORD dst_unused:UNUSED_PAD src0_sel:DWORD src1_sel:WORD_0
    v_lshlrev_b32_sdwa v90, 3, v122 dst_sel:DWORD dst_unused:UNUSED_PAD src0_sel:DWORD src1_sel:WORD_1
    ds_read_b64 v[88:89], v88
    ds_read_b64 v[90:91], v90
    v_lshlrev_b32_sdwa v92, 3, v123 dst_sel:DWORD dst_unused:UNUSED_PAD src0_sel:DWORD src1_sel:WORD_0
    v_lshlrev_b32_sdwa v94, 3, v123 dst_sel:DWORD dst_unused:UNUSED_PAD src0_sel:DWORD src1_sel:WORD_1
    ds_read_b64 v[92:93], v92
    ds_read_b64 v[94:95], v94
    s_add_u32 s20, s20, 0x1000
    buffer_load_dwordx2 v[120:121], v71, s[12:15], s20 offen offset:0 sc1
    buffer_load_dwordx2 v[122:123], v71, s[12:15], s20 offen offset:1024 sc1
    s_waitcnt lgkmcnt(8)
    v_add3_u32 v2, s24, v96, v98
    v_add3_u32 v3, s24, v97, v99
    v_add3_u32 v2, v2, v100, v102
    v_add3_u32 v3, v3, v101, v103
    v_lshlrev_b32_sdwa v96, 3, v124 dst_sel:DWORD dst_unused:UNUSED_PAD src0_sel:DWORD src1_sel:WORD_0
    v_lshlrev_b32_sdwa v98, 3, v124 dst_sel:DWORD dst_unused:UNUSED_PAD src0_sel:DWORD src1_sel:WORD_1
    ds_read_b64 v[96:97], v96
    ds_read_b64 v[98:99], v98
    v_lshlrev_b32_sdwa v100, 3, v125 dst_sel:DWORD dst_unused:UNUSED_PAD src0_sel:DWORD src1_sel:WORD_0
    v_lshlrev_b32_sdwa v102, 3, v125 dst_sel:DWORD dst_unused:UNUSED_PAD src0_sel:DWORD src1_sel:WORD_1
    ds_read_b64 v[100:101], v100
    ds_read_b64 v[102:103], v102
    s_waitcnt lgkmcnt(8)
    v_add3_u32 v4, s24, v104, v106
    v_add3_u32 v5, s24, v105, v107
    v_add3_u32 v4, v4, v108, v110
    v_add3_u32 v5, v5, v109, v111
    v_lshlrev_b32_sdwa v104, 3, v126 dst_sel:DWORD dst_unused:UNUSED_PAD src0_sel:DWORD src1_sel:WORD_0
    v_lshlrev_b32_sdwa v106, 3, v126 dst_sel:DWORD dst_unused:UNUSED_PAD src0_sel:DWORD src1_sel:WORD_1
    ds_read_b64 v[104:105], v104
    ds_read_b64 v[106:107], v106
    v_lshlrev_b32_sdwa v108, 3, v127 dst_sel:DWORD dst_unused:UNUSED_PAD src0_sel:DWORD src1_sel:WORD_0
    v_lshlrev_b32_sdwa v110, 3, v127 dst_sel:DWORD dst_unused:UNUSED_PAD src0_sel:DWORD src1_sel:WORD_1
    ds_read_b64 v[108:109], v108
    ds_read_b64 v[110:111], v110
    buffer_load_dwordx2 v[124:125], v71, s[12:15], s20 offen offset:2048 sc1
    buffer_load_dwordx2 v[126:127], v71, s[12:15], s20 offen offset:3072 sc1
    s_waitcnt lgkmcnt(8)
    v_add3_u32 v6, s24, v88, v90
    v_add3_u32 v7, s24, v89, v91
    v_add3_u32 v6, v6, v92, v94
    v_add3_u32 v7, v7, v93, v95
    s_waitcnt vmcnt(10)
    v_mfma_f32_16x16x32_bf16 v[112:115], v[72:75], v[128:131], v[66:69]
    s_waitcnt vmcnt(4)
    v_lshlrev_b32_sdwa v88, 3, v116 dst_sel:DWORD dst_unused:UNUSED_PAD src0_sel:DWORD src1_sel:WORD_0
    v_lshlrev_b32_sdwa v90, 3, v116 dst_sel:DWORD dst_unused:UNUSED_PAD src0_sel:DWORD src1_sel:WORD_1
    ds_read_b64 v[88:89], v88
    ds_read_b64 v[90:91], v90
    v_mfma_f32_16x16x32_bf16 v[112:115], v[76:79], v[132:135], v[112:115]
    v_add_u32 v70, 0x10000, v70
    v_lshlrev_b32_sdwa v92, 3, v117 dst_sel:DWORD dst_unused:UNUSED_PAD src0_sel:DWORD src1_sel:WORD_0
    v_lshlrev_b32_sdwa v94, 3, v117 dst_sel:DWORD dst_unused:UNUSED_PAD src0_sel:DWORD src1_sel:WORD_1
    ds_read_b64 v[92:93], v92
    ds_read_b64 v[94:95], v94
    s_waitcnt lgkmcnt(8)
    v_add3_u32 v8, s24, v96, v98
    v_add3_u32 v9, s24, v97, v99
    v_add3_u32 v8, v8, v100, v102
    v_add3_u32 v9, v9, v101, v103
    v_mfma_f32_16x16x32_bf16 v[112:115], v[80:83], v[136:139], v[112:115]
    v_lshlrev_b32_sdwa v96, 3, v118 dst_sel:DWORD dst_unused:UNUSED_PAD src0_sel:DWORD src1_sel:WORD_0
    v_lshlrev_b32_sdwa v98, 3, v118 dst_sel:DWORD dst_unused:UNUSED_PAD src0_sel:DWORD src1_sel:WORD_1
    ds_read_b64 v[96:97], v96
    ds_read_b64 v[98:99], v98
    v_mfma_f32_16x16x32_bf16 v[112:115], v[84:87], v[140:143], v[112:115]
    v_lshlrev_b32_sdwa v100, 3, v119 dst_sel:DWORD dst_unused:UNUSED_PAD src0_sel:DWORD src1_sel:WORD_0
    v_lshlrev_b32_sdwa v102, 3, v119 dst_sel:DWORD dst_unused:UNUSED_PAD src0_sel:DWORD src1_sel:WORD_1
    ds_read_b64 v[100:101], v100
    ds_read_b64 v[102:103], v102
    s_add_u32 s20, s20, 0x1000
    buffer_load_dwordx2 v[116:117], v71, s[12:15], s20 offen offset:0 sc1
    buffer_load_dwordx2 v[118:119], v71, s[12:15], s20 offen offset:1024 sc1
    s_waitcnt lgkmcnt(8)
    v_add3_u32 v10, s24, v104, v106
    v_add3_u32 v11, s24, v105, v107
    v_add3_u32 v10, v10, v108, v110
    v_add3_u32 v11, v11, v109, v111
    v_perm_b32 v112, v113, v112, s23
    v_perm_b32 v113, v115, v114, s23
    ds_write_b64 v70, v[112:113] offset:32768
    s_waitcnt vmcnt(4)
    v_lshlrev_b32_sdwa v104, 3, v120 dst_sel:DWORD dst_unused:UNUSED_PAD src0_sel:DWORD src1_sel:WORD_0
    v_lshlrev_b32_sdwa v106, 3, v120 dst_sel:DWORD dst_unused:UNUSED_PAD src0_sel:DWORD src1_sel:WORD_1
    ds_read_b64 v[104:105], v104
    ds_read_b64 v[106:107], v106
    v_lshlrev_b32_sdwa v108, 3, v121 dst_sel:DWORD dst_unused:UNUSED_PAD src0_sel:DWORD src1_sel:WORD_0
    v_lshlrev_b32_sdwa v110, 3, v121 dst_sel:DWORD dst_unused:UNUSED_PAD src0_sel:DWORD src1_sel:WORD_1
    ds_read_b64 v[108:109], v108
    ds_read_b64 v[110:111], v110
    s_waitcnt lgkmcnt(9)
    v_add3_u32 v12, s24, v88, v90
    v_add3_u32 v13, s24, v89, v91
    v_add3_u32 v12, v12, v92, v94
    v_add3_u32 v13, v13, v93, v95
    v_lshlrev_b32_sdwa v88, 3, v122 dst_sel:DWORD dst_unused:UNUSED_PAD src0_sel:DWORD src1_sel:WORD_0
    v_lshlrev_b32_sdwa v90, 3, v122 dst_sel:DWORD dst_unused:UNUSED_PAD src0_sel:DWORD src1_sel:WORD_1
    ds_read_b64 v[88:89], v88
    ds_read_b64 v[90:91], v90
    v_lshlrev_b32_sdwa v92, 3, v123 dst_sel:DWORD dst_unused:UNUSED_PAD src0_sel:DWORD src1_sel:WORD_0
    v_lshlrev_b32_sdwa v94, 3, v123 dst_sel:DWORD dst_unused:UNUSED_PAD src0_sel:DWORD src1_sel:WORD_1
    ds_read_b64 v[92:93], v92
    ds_read_b64 v[94:95], v94
    buffer_load_dwordx2 v[120:121], v71, s[12:15], s20 offen offset:2048 sc1
    buffer_load_dwordx2 v[122:123], v71, s[12:15], s20 offen offset:3072 sc1
    s_waitcnt lgkmcnt(9)
    v_add3_u32 v14, s24, v96, v98
    v_add3_u32 v15, s24, v97, v99
    v_add3_u32 v14, v14, v100, v102
    v_add3_u32 v15, v15, v101, v103
    s_waitcnt vmcnt(4)
    v_lshlrev_b32_sdwa v96, 3, v124 dst_sel:DWORD dst_unused:UNUSED_PAD src0_sel:DWORD src1_sel:WORD_0
    v_lshlrev_b32_sdwa v98, 3, v124 dst_sel:DWORD dst_unused:UNUSED_PAD src0_sel:DWORD src1_sel:WORD_1
    ds_read_b64 v[96:97], v96
    ds_read_b64 v[98:99], v98
    v_lshlrev_b32_sdwa v100, 3, v125 dst_sel:DWORD dst_unused:UNUSED_PAD src0_sel:DWORD src1_sel:WORD_0
    v_lshlrev_b32_sdwa v102, 3, v125 dst_sel:DWORD dst_unused:UNUSED_PAD src0_sel:DWORD src1_sel:WORD_1
    ds_read_b64 v[100:101], v100
    ds_read_b64 v[102:103], v102
    s_waitcnt lgkmcnt(8)
    v_add3_u32 v16, s24, v104, v106
    v_add3_u32 v17, s24, v105, v107
    v_add3_u32 v16, v16, v108, v110
    v_add3_u32 v17, v17, v109, v111
    v_mfma_f32_16x16x32_bf16 v[112:115], v[72:75], v[144:147], v[66:69]
    v_lshlrev_b32_sdwa v104, 3, v126 dst_sel:DWORD dst_unused:UNUSED_PAD src0_sel:DWORD src1_sel:WORD_0
    v_lshlrev_b32_sdwa v106, 3, v126 dst_sel:DWORD dst_unused:UNUSED_PAD src0_sel:DWORD src1_sel:WORD_1
    ds_read_b64 v[104:105], v104
    ds_read_b64 v[106:107], v106
    v_mfma_f32_16x16x32_bf16 v[112:115], v[76:79], v[148:151], v[112:115]
    v_lshlrev_b32_sdwa v108, 3, v127 dst_sel:DWORD dst_unused:UNUSED_PAD src0_sel:DWORD src1_sel:WORD_0
    v_lshlrev_b32_sdwa v110, 3, v127 dst_sel:DWORD dst_unused:UNUSED_PAD src0_sel:DWORD src1_sel:WORD_1
    ds_read_b64 v[108:109], v108
    ds_read_b64 v[110:111], v110
    s_add_u32 s20, s20, 0x1d000
    buffer_load_dwordx4 v[124:127], v71, s[12:15], s20 offen offset:0 sc1
    s_waitcnt lgkmcnt(8)
    v_add3_u32 v18, s24, v88, v90
    v_add3_u32 v19, s24, v89, v91
    v_add3_u32 v18, v18, v92, v94
    v_add3_u32 v19, v19, v93, v95
    v_mfma_f32_16x16x32_bf16 v[112:115], v[80:83], v[152:155], v[112:115]
    s_waitcnt vmcnt(3)
    v_lshlrev_b32_sdwa v88, 3, v116 dst_sel:DWORD dst_unused:UNUSED_PAD src0_sel:DWORD src1_sel:WORD_0
    v_lshlrev_b32_sdwa v90, 3, v116 dst_sel:DWORD dst_unused:UNUSED_PAD src0_sel:DWORD src1_sel:WORD_1
    ds_read_b64 v[88:89], v88
    ds_read_b64 v[90:91], v90
    v_mfma_f32_16x16x32_bf16 v[112:115], v[84:87], v[156:159], v[112:115]
    v_lshlrev_b32_sdwa v92, 3, v117 dst_sel:DWORD dst_unused:UNUSED_PAD src0_sel:DWORD src1_sel:WORD_0
    v_lshlrev_b32_sdwa v94, 3, v117 dst_sel:DWORD dst_unused:UNUSED_PAD src0_sel:DWORD src1_sel:WORD_1
    ds_read_b64 v[92:93], v92
    ds_read_b64 v[94:95], v94
    s_waitcnt lgkmcnt(8)
    v_add3_u32 v20, s24, v96, v98
    v_add3_u32 v21, s24, v97, v99
    v_add3_u32 v20, v20, v100, v102
    v_add3_u32 v21, v21, v101, v103
    v_perm_b32 v112, v113, v112, s23
    v_perm_b32 v113, v115, v114, s23
    ds_write_b64 v70, v[112:113] offset:32896
    v_lshlrev_b32_sdwa v96, 3, v118 dst_sel:DWORD dst_unused:UNUSED_PAD src0_sel:DWORD src1_sel:WORD_0
    v_lshlrev_b32_sdwa v98, 3, v118 dst_sel:DWORD dst_unused:UNUSED_PAD src0_sel:DWORD src1_sel:WORD_1
    ds_read_b64 v[96:97], v96
    ds_read_b64 v[98:99], v98
    v_lshlrev_b32_sdwa v100, 3, v119 dst_sel:DWORD dst_unused:UNUSED_PAD src0_sel:DWORD src1_sel:WORD_0
    v_lshlrev_b32_sdwa v102, 3, v119 dst_sel:DWORD dst_unused:UNUSED_PAD src0_sel:DWORD src1_sel:WORD_1
    ds_read_b64 v[100:101], v100
    ds_read_b64 v[102:103], v102
    buffer_load_dwordx4 v[116:119], v71, s[12:15], s20 offen offset:1024 sc1
    s_waitcnt lgkmcnt(9)
    v_add3_u32 v22, s24, v104, v106
    v_add3_u32 v23, s24, v105, v107
    v_add3_u32 v22, v22, v108, v110
    v_add3_u32 v23, v23, v109, v111
    s_waitcnt vmcnt(2)
    v_lshlrev_b32_sdwa v104, 3, v120 dst_sel:DWORD dst_unused:UNUSED_PAD src0_sel:DWORD src1_sel:WORD_0
    v_lshlrev_b32_sdwa v106, 3, v120 dst_sel:DWORD dst_unused:UNUSED_PAD src0_sel:DWORD src1_sel:WORD_1
    ds_read_b64 v[104:105], v104
    ds_read_b64 v[106:107], v106
    v_lshlrev_b32_sdwa v108, 3, v121 dst_sel:DWORD dst_unused:UNUSED_PAD src0_sel:DWORD src1_sel:WORD_0
    v_lshlrev_b32_sdwa v110, 3, v121 dst_sel:DWORD dst_unused:UNUSED_PAD src0_sel:DWORD src1_sel:WORD_1
    ds_read_b64 v[108:109], v108
    ds_read_b64 v[110:111], v110
    s_waitcnt lgkmcnt(9)
    v_add3_u32 v24, s24, v88, v90
    v_add3_u32 v25, s24, v89, v91
    v_add3_u32 v24, v24, v92, v94
    v_add3_u32 v25, v25, v93, v95
    v_lshlrev_b32_sdwa v88, 3, v122 dst_sel:DWORD dst_unused:UNUSED_PAD src0_sel:DWORD src1_sel:WORD_0
    v_lshlrev_b32_sdwa v90, 3, v122 dst_sel:DWORD dst_unused:UNUSED_PAD src0_sel:DWORD src1_sel:WORD_1
    ds_read_b64 v[88:89], v88
    ds_read_b64 v[90:91], v90
    v_lshlrev_b32_sdwa v92, 3, v123 dst_sel:DWORD dst_unused:UNUSED_PAD src0_sel:DWORD src1_sel:WORD_0
    v_lshlrev_b32_sdwa v94, 3, v123 dst_sel:DWORD dst_unused:UNUSED_PAD src0_sel:DWORD src1_sel:WORD_1
    ds_read_b64 v[92:93], v92
    ds_read_b64 v[94:95], v94
    buffer_load_dwordx4 v[120:123], v71, s[12:15], s20 offen offset:2048 sc1
    s_waitcnt lgkmcnt(8)
    v_add3_u32 v26, s24, v96, v98
    v_add3_u32 v27, s24, v97, v99
    v_add3_u32 v26, v26, v100, v102
    v_add3_u32 v27, v27, v101, v103
    v_mfma_f32_16x16x32_bf16 v[112:115], v[72:75], v[160:163], v[66:69]
    s_waitcnt vmcnt(2)
    v_lshlrev_b32_sdwa v96, 3, v124 dst_sel:DWORD dst_unused:UNUSED_PAD src0_sel:DWORD src1_sel:WORD_0
    v_lshlrev_b32_sdwa v98, 3, v124 dst_sel:DWORD dst_unused:UNUSED_PAD src0_sel:DWORD src1_sel:WORD_1
    ds_read_b64 v[96:97], v96
    ds_read_b64 v[98:99], v98
    v_mfma_f32_16x16x32_bf16 v[112:115], v[76:79], v[164:167], v[112:115]
    v_lshlrev_b32_sdwa v100, 3, v125 dst_sel:DWORD dst_unused:UNUSED_PAD src0_sel:DWORD src1_sel:WORD_0
    v_lshlrev_b32_sdwa v102, 3, v125 dst_sel:DWORD dst_unused:UNUSED_PAD src0_sel:DWORD src1_sel:WORD_1
    ds_read_b64 v[100:101], v100
    ds_read_b64 v[102:103], v102
    s_waitcnt lgkmcnt(8)
    v_add3_u32 v28, s24, v104, v106
    v_add3_u32 v29, s24, v105, v107
    v_add3_u32 v28, v28, v108, v110
    v_add3_u32 v29, v29, v109, v111
    v_mfma_f32_16x16x32_bf16 v[112:115], v[80:83], v[168:171], v[112:115]
    v_lshlrev_b32_sdwa v104, 3, v126 dst_sel:DWORD dst_unused:UNUSED_PAD src0_sel:DWORD src1_sel:WORD_0
    v_lshlrev_b32_sdwa v106, 3, v126 dst_sel:DWORD dst_unused:UNUSED_PAD src0_sel:DWORD src1_sel:WORD_1
    ds_read_b64 v[104:105], v104
    ds_read_b64 v[106:107], v106
    v_mfma_f32_16x16x32_bf16 v[112:115], v[84:87], v[172:175], v[112:115]
    v_lshlrev_b32_sdwa v108, 3, v127 dst_sel:DWORD dst_unused:UNUSED_PAD src0_sel:DWORD src1_sel:WORD_0
    v_lshlrev_b32_sdwa v110, 3, v127 dst_sel:DWORD dst_unused:UNUSED_PAD src0_sel:DWORD src1_sel:WORD_1
    ds_read_b64 v[108:109], v108
    ds_read_b64 v[110:111], v110
    buffer_load_dwordx4 v[124:127], v71, s[12:15], s20 offen offset:3072 sc1
    s_waitcnt lgkmcnt(8)
    v_add3_u32 v30, s24, v88, v90
    v_add3_u32 v31, s24, v89, v91
    v_add3_u32 v30, v30, v92, v94
    v_add3_u32 v31, v31, v93, v95
    v_perm_b32 v112, v113, v112, s23
    v_perm_b32 v113, v115, v114, s23
    ds_write_b64 v70, v[112:113] offset:33024
    s_waitcnt vmcnt(2)
    v_lshlrev_b32_sdwa v88, 3, v116 dst_sel:DWORD dst_unused:UNUSED_PAD src0_sel:DWORD src1_sel:WORD_0
    v_lshlrev_b32_sdwa v90, 3, v116 dst_sel:DWORD dst_unused:UNUSED_PAD src0_sel:DWORD src1_sel:WORD_1
    ds_read_b64 v[88:89], v88
    ds_read_b64 v[90:91], v90
    v_lshlrev_b32_sdwa v92, 3, v117 dst_sel:DWORD dst_unused:UNUSED_PAD src0_sel:DWORD src1_sel:WORD_0
    v_lshlrev_b32_sdwa v94, 3, v117 dst_sel:DWORD dst_unused:UNUSED_PAD src0_sel:DWORD src1_sel:WORD_1
    ds_read_b64 v[92:93], v92
    ds_read_b64 v[94:95], v94
    s_waitcnt lgkmcnt(9)
    v_add3_u32 v32, s25, v96, v98
    v_add3_u32 v33, s25, v97, v99
    v_add3_u32 v32, v32, v100, v102
    v_add3_u32 v33, v33, v101, v103
    v_lshlrev_b32_sdwa v96, 3, v118 dst_sel:DWORD dst_unused:UNUSED_PAD src0_sel:DWORD src1_sel:WORD_0
    v_lshlrev_b32_sdwa v98, 3, v118 dst_sel:DWORD dst_unused:UNUSED_PAD src0_sel:DWORD src1_sel:WORD_1
    ds_read_b64 v[96:97], v96
    ds_read_b64 v[98:99], v98
    v_lshlrev_b32_sdwa v100, 3, v119 dst_sel:DWORD dst_unused:UNUSED_PAD src0_sel:DWORD src1_sel:WORD_0
    v_lshlrev_b32_sdwa v102, 3, v119 dst_sel:DWORD dst_unused:UNUSED_PAD src0_sel:DWORD src1_sel:WORD_1
    ds_read_b64 v[100:101], v100
    ds_read_b64 v[102:103], v102
    s_add_u32 s20, s20, 0x1000
    buffer_load_dwordx4 v[116:119], v71, s[12:15], s20 offen offset:0 sc1
    s_waitcnt lgkmcnt(9)
    v_add3_u32 v32, v32, v104, v106
    v_add3_u32 v33, v33, v105, v107
    v_add3_u32 v32, v32, v108, v110
    v_add3_u32 v33, v33, v109, v111
    s_waitcnt vmcnt(2)
    v_lshlrev_b32_sdwa v104, 3, v120 dst_sel:DWORD dst_unused:UNUSED_PAD src0_sel:DWORD src1_sel:WORD_0
    v_lshlrev_b32_sdwa v106, 3, v120 dst_sel:DWORD dst_unused:UNUSED_PAD src0_sel:DWORD src1_sel:WORD_1
    ds_read_b64 v[104:105], v104
    ds_read_b64 v[106:107], v106
    v_lshlrev_b32_sdwa v108, 3, v121 dst_sel:DWORD dst_unused:UNUSED_PAD src0_sel:DWORD src1_sel:WORD_0
    v_lshlrev_b32_sdwa v110, 3, v121 dst_sel:DWORD dst_unused:UNUSED_PAD src0_sel:DWORD src1_sel:WORD_1
    ds_read_b64 v[108:109], v108
    ds_read_b64 v[110:111], v110
    s_waitcnt lgkmcnt(8)
    v_add3_u32 v34, s25, v88, v90
    v_add3_u32 v35, s25, v89, v91
    v_add3_u32 v34, v34, v92, v94
    v_add3_u32 v35, v35, v93, v95
    v_mfma_f32_16x16x32_bf16 v[112:115], v[72:75], v[176:179], v[66:69]
    v_lshlrev_b32_sdwa v88, 3, v122 dst_sel:DWORD dst_unused:UNUSED_PAD src0_sel:DWORD src1_sel:WORD_0
    v_lshlrev_b32_sdwa v90, 3, v122 dst_sel:DWORD dst_unused:UNUSED_PAD src0_sel:DWORD src1_sel:WORD_1
    ds_read_b64 v[88:89], v88
    ds_read_b64 v[90:91], v90
    v_mfma_f32_16x16x32_bf16 v[112:115], v[76:79], v[180:183], v[112:115]
    v_lshlrev_b32_sdwa v92, 3, v123 dst_sel:DWORD dst_unused:UNUSED_PAD src0_sel:DWORD src1_sel:WORD_0
    v_lshlrev_b32_sdwa v94, 3, v123 dst_sel:DWORD dst_unused:UNUSED_PAD src0_sel:DWORD src1_sel:WORD_1
    ds_read_b64 v[92:93], v92
    ds_read_b64 v[94:95], v94
    buffer_load_dwordx4 v[120:123], v71, s[12:15], s20 offen offset:1024 sc1
    s_waitcnt lgkmcnt(8)
    v_add3_u32 v34, v34, v96, v98
    v_add3_u32 v35, v35, v97, v99
    v_add3_u32 v34, v34, v100, v102
    v_add3_u32 v35, v35, v101, v103
    v_mfma_f32_16x16x32_bf16 v[112:115], v[80:83], v[184:187], v[112:115]
    s_waitcnt vmcnt(2)
    v_lshlrev_b32_sdwa v96, 3, v124 dst_sel:DWORD dst_unused:UNUSED_PAD src0_sel:DWORD src1_sel:WORD_0
    v_lshlrev_b32_sdwa v98, 3, v124 dst_sel:DWORD dst_unused:UNUSED_PAD src0_sel:DWORD src1_sel:WORD_1
    ds_read_b64 v[96:97], v96
    ds_read_b64 v[98:99], v98
    v_mfma_f32_16x16x32_bf16 v[112:115], v[84:87], v[188:191], v[112:115]
    v_lshlrev_b32_sdwa v100, 3, v125 dst_sel:DWORD dst_unused:UNUSED_PAD src0_sel:DWORD src1_sel:WORD_0
    v_lshlrev_b32_sdwa v102, 3, v125 dst_sel:DWORD dst_unused:UNUSED_PAD src0_sel:DWORD src1_sel:WORD_1
    ds_read_b64 v[100:101], v100
    ds_read_b64 v[102:103], v102
    s_waitcnt lgkmcnt(8)
    v_add3_u32 v36, s25, v104, v106
    v_add3_u32 v37, s25, v105, v107
    v_add3_u32 v36, v36, v108, v110
    v_add3_u32 v37, v37, v109, v111
    v_perm_b32 v112, v113, v112, s23
    v_perm_b32 v113, v115, v114, s23
    ds_write_b64 v70, v[112:113] offset:33152
    v_lshlrev_b32_sdwa v104, 3, v126 dst_sel:DWORD dst_unused:UNUSED_PAD src0_sel:DWORD src1_sel:WORD_0
    v_lshlrev_b32_sdwa v106, 3, v126 dst_sel:DWORD dst_unused:UNUSED_PAD src0_sel:DWORD src1_sel:WORD_1
    ds_read_b64 v[104:105], v104
    ds_read_b64 v[106:107], v106
    v_lshlrev_b32_sdwa v108, 3, v127 dst_sel:DWORD dst_unused:UNUSED_PAD src0_sel:DWORD src1_sel:WORD_0
    v_lshlrev_b32_sdwa v110, 3, v127 dst_sel:DWORD dst_unused:UNUSED_PAD src0_sel:DWORD src1_sel:WORD_1
    ds_read_b64 v[108:109], v108
    ds_read_b64 v[110:111], v110
    buffer_load_dwordx4 v[124:127], v71, s[12:15], s20 offen offset:2048 sc1
    s_waitcnt lgkmcnt(9)
    v_add3_u32 v36, v36, v88, v90
    v_add3_u32 v37, v37, v89, v91
    v_add3_u32 v36, v36, v92, v94
    v_add3_u32 v37, v37, v93, v95
    s_waitcnt vmcnt(2)
    v_lshlrev_b32_sdwa v88, 3, v116 dst_sel:DWORD dst_unused:UNUSED_PAD src0_sel:DWORD src1_sel:WORD_0
    v_lshlrev_b32_sdwa v90, 3, v116 dst_sel:DWORD dst_unused:UNUSED_PAD src0_sel:DWORD src1_sel:WORD_1
    ds_read_b64 v[88:89], v88
    ds_read_b64 v[90:91], v90
    v_lshlrev_b32_sdwa v92, 3, v117 dst_sel:DWORD dst_unused:UNUSED_PAD src0_sel:DWORD src1_sel:WORD_0
    v_lshlrev_b32_sdwa v94, 3, v117 dst_sel:DWORD dst_unused:UNUSED_PAD src0_sel:DWORD src1_sel:WORD_1
    ds_read_b64 v[92:93], v92
    ds_read_b64 v[94:95], v94
    s_waitcnt lgkmcnt(9)
    v_add3_u32 v38, s25, v96, v98
    v_add3_u32 v39, s25, v97, v99
    v_add3_u32 v38, v38, v100, v102
    v_add3_u32 v39, v39, v101, v103
    v_lshlrev_b32_sdwa v96, 3, v118 dst_sel:DWORD dst_unused:UNUSED_PAD src0_sel:DWORD src1_sel:WORD_0
    v_lshlrev_b32_sdwa v98, 3, v118 dst_sel:DWORD dst_unused:UNUSED_PAD src0_sel:DWORD src1_sel:WORD_1
    ds_read_b64 v[96:97], v96
    ds_read_b64 v[98:99], v98
    v_lshlrev_b32_sdwa v100, 3, v119 dst_sel:DWORD dst_unused:UNUSED_PAD src0_sel:DWORD src1_sel:WORD_0
    v_lshlrev_b32_sdwa v102, 3, v119 dst_sel:DWORD dst_unused:UNUSED_PAD src0_sel:DWORD src1_sel:WORD_1
    ds_read_b64 v[100:101], v100
    ds_read_b64 v[102:103], v102
    buffer_load_dwordx4 v[116:119], v71, s[12:15], s20 offen offset:3072 sc1
    s_waitcnt lgkmcnt(8)
    v_add3_u32 v38, v38, v104, v106
    v_add3_u32 v39, v39, v105, v107
    v_add3_u32 v38, v38, v108, v110
    v_add3_u32 v39, v39, v109, v111
    v_mfma_f32_16x16x32_bf16 v[112:115], v[72:75], v[192:195], v[66:69]
    s_waitcnt vmcnt(2)
    v_lshlrev_b32_sdwa v104, 3, v120 dst_sel:DWORD dst_unused:UNUSED_PAD src0_sel:DWORD src1_sel:WORD_0
    v_lshlrev_b32_sdwa v106, 3, v120 dst_sel:DWORD dst_unused:UNUSED_PAD src0_sel:DWORD src1_sel:WORD_1
    ds_read_b64 v[104:105], v104
    ds_read_b64 v[106:107], v106
    v_mfma_f32_16x16x32_bf16 v[112:115], v[76:79], v[196:199], v[112:115]
    v_lshlrev_b32_sdwa v108, 3, v121 dst_sel:DWORD dst_unused:UNUSED_PAD src0_sel:DWORD src1_sel:WORD_0
    v_lshlrev_b32_sdwa v110, 3, v121 dst_sel:DWORD dst_unused:UNUSED_PAD src0_sel:DWORD src1_sel:WORD_1
    ds_read_b64 v[108:109], v108
    ds_read_b64 v[110:111], v110
    s_waitcnt lgkmcnt(8)
    v_add3_u32 v40, s25, v88, v90
    v_add3_u32 v41, s25, v89, v91
    v_add3_u32 v40, v40, v92, v94
    v_add3_u32 v41, v41, v93, v95
    v_mfma_f32_16x16x32_bf16 v[112:115], v[80:83], v[200:203], v[112:115]
    v_lshlrev_b32_sdwa v88, 3, v122 dst_sel:DWORD dst_unused:UNUSED_PAD src0_sel:DWORD src1_sel:WORD_0
    v_lshlrev_b32_sdwa v90, 3, v122 dst_sel:DWORD dst_unused:UNUSED_PAD src0_sel:DWORD src1_sel:WORD_1
    ds_read_b64 v[88:89], v88
    ds_read_b64 v[90:91], v90
    v_mfma_f32_16x16x32_bf16 v[112:115], v[84:87], v[204:207], v[112:115]
    v_lshlrev_b32_sdwa v92, 3, v123 dst_sel:DWORD dst_unused:UNUSED_PAD src0_sel:DWORD src1_sel:WORD_0
    v_lshlrev_b32_sdwa v94, 3, v123 dst_sel:DWORD dst_unused:UNUSED_PAD src0_sel:DWORD src1_sel:WORD_1
    ds_read_b64 v[92:93], v92
    ds_read_b64 v[94:95], v94
    s_add_u32 s20, s20, 0x1000
    buffer_load_dwordx4 v[120:123], v71, s[12:15], s20 offen offset:0 sc1
    s_waitcnt lgkmcnt(8)
    v_add3_u32 v40, v40, v96, v98
    v_add3_u32 v41, v41, v97, v99
    v_add3_u32 v40, v40, v100, v102
    v_add3_u32 v41, v41, v101, v103
    v_perm_b32 v112, v113, v112, s23
    v_perm_b32 v113, v115, v114, s23
    ds_write_b64 v70, v[112:113] offset:33280
    s_waitcnt vmcnt(2)
    v_lshlrev_b32_sdwa v96, 3, v124 dst_sel:DWORD dst_unused:UNUSED_PAD src0_sel:DWORD src1_sel:WORD_0
    v_lshlrev_b32_sdwa v98, 3, v124 dst_sel:DWORD dst_unused:UNUSED_PAD src0_sel:DWORD src1_sel:WORD_1
    ds_read_b64 v[96:97], v96
    ds_read_b64 v[98:99], v98
    v_lshlrev_b32_sdwa v100, 3, v125 dst_sel:DWORD dst_unused:UNUSED_PAD src0_sel:DWORD src1_sel:WORD_0
    v_lshlrev_b32_sdwa v102, 3, v125 dst_sel:DWORD dst_unused:UNUSED_PAD src0_sel:DWORD src1_sel:WORD_1
    ds_read_b64 v[100:101], v100
    ds_read_b64 v[102:103], v102
    s_waitcnt lgkmcnt(9)
    v_add3_u32 v42, s25, v104, v106
    v_add3_u32 v43, s25, v105, v107
    v_add3_u32 v42, v42, v108, v110
    v_add3_u32 v43, v43, v109, v111
    v_lshlrev_b32_sdwa v104, 3, v126 dst_sel:DWORD dst_unused:UNUSED_PAD src0_sel:DWORD src1_sel:WORD_0
    v_lshlrev_b32_sdwa v106, 3, v126 dst_sel:DWORD dst_unused:UNUSED_PAD src0_sel:DWORD src1_sel:WORD_1
    ds_read_b64 v[104:105], v104
    ds_read_b64 v[106:107], v106
    v_lshlrev_b32_sdwa v108, 3, v127 dst_sel:DWORD dst_unused:UNUSED_PAD src0_sel:DWORD src1_sel:WORD_0
    v_lshlrev_b32_sdwa v110, 3, v127 dst_sel:DWORD dst_unused:UNUSED_PAD src0_sel:DWORD src1_sel:WORD_1
    ds_read_b64 v[108:109], v108
    ds_read_b64 v[110:111], v110
    buffer_load_dwordx4 v[124:127], v71, s[12:15], s20 offen offset:1024 sc1
    s_waitcnt lgkmcnt(9)
    v_add3_u32 v42, v42, v88, v90
    v_add3_u32 v43, v43, v89, v91
    v_add3_u32 v42, v42, v92, v94
    v_add3_u32 v43, v43, v93, v95
    s_waitcnt vmcnt(2)
    v_lshlrev_b32_sdwa v88, 3, v116 dst_sel:DWORD dst_unused:UNUSED_PAD src0_sel:DWORD src1_sel:WORD_0
    v_lshlrev_b32_sdwa v90, 3, v116 dst_sel:DWORD dst_unused:UNUSED_PAD src0_sel:DWORD src1_sel:WORD_1
    ds_read_b64 v[88:89], v88
    ds_read_b64 v[90:91], v90
    v_lshlrev_b32_sdwa v92, 3, v117 dst_sel:DWORD dst_unused:UNUSED_PAD src0_sel:DWORD src1_sel:WORD_0
    v_lshlrev_b32_sdwa v94, 3, v117 dst_sel:DWORD dst_unused:UNUSED_PAD src0_sel:DWORD src1_sel:WORD_1
    ds_read_b64 v[92:93], v92
    ds_read_b64 v[94:95], v94
    s_waitcnt lgkmcnt(8)
    v_add3_u32 v44, s25, v96, v98
    v_add3_u32 v45, s25, v97, v99
    v_add3_u32 v44, v44, v100, v102
    v_add3_u32 v45, v45, v101, v103
    v_mfma_f32_16x16x32_bf16 v[112:115], v[72:75], v[208:211], v[66:69]
    v_lshlrev_b32_sdwa v96, 3, v118 dst_sel:DWORD dst_unused:UNUSED_PAD src0_sel:DWORD src1_sel:WORD_0
    v_lshlrev_b32_sdwa v98, 3, v118 dst_sel:DWORD dst_unused:UNUSED_PAD src0_sel:DWORD src1_sel:WORD_1
    ds_read_b64 v[96:97], v96
    ds_read_b64 v[98:99], v98
    v_mfma_f32_16x16x32_bf16 v[112:115], v[76:79], v[212:215], v[112:115]
    v_lshlrev_b32_sdwa v100, 3, v119 dst_sel:DWORD dst_unused:UNUSED_PAD src0_sel:DWORD src1_sel:WORD_0
    v_lshlrev_b32_sdwa v102, 3, v119 dst_sel:DWORD dst_unused:UNUSED_PAD src0_sel:DWORD src1_sel:WORD_1
    ds_read_b64 v[100:101], v100
    ds_read_b64 v[102:103], v102
    buffer_load_dwordx4 v[116:119], v71, s[12:15], s20 offen offset:2048 sc1
    s_waitcnt lgkmcnt(8)
    v_add3_u32 v44, v44, v104, v106
    v_add3_u32 v45, v45, v105, v107
    v_add3_u32 v44, v44, v108, v110
    v_add3_u32 v45, v45, v109, v111
    v_mfma_f32_16x16x32_bf16 v[112:115], v[80:83], v[216:219], v[112:115]
    s_waitcnt vmcnt(2)
    v_lshlrev_b32_sdwa v104, 3, v120 dst_sel:DWORD dst_unused:UNUSED_PAD src0_sel:DWORD src1_sel:WORD_0
    v_lshlrev_b32_sdwa v106, 3, v120 dst_sel:DWORD dst_unused:UNUSED_PAD src0_sel:DWORD src1_sel:WORD_1
    ds_read_b64 v[104:105], v104
    ds_read_b64 v[106:107], v106
    v_mfma_f32_16x16x32_bf16 v[112:115], v[84:87], v[220:223], v[112:115]
    v_lshlrev_b32_sdwa v108, 3, v121 dst_sel:DWORD dst_unused:UNUSED_PAD src0_sel:DWORD src1_sel:WORD_0
    v_lshlrev_b32_sdwa v110, 3, v121 dst_sel:DWORD dst_unused:UNUSED_PAD src0_sel:DWORD src1_sel:WORD_1
    ds_read_b64 v[108:109], v108
    ds_read_b64 v[110:111], v110
    s_waitcnt lgkmcnt(8)
    v_add3_u32 v46, s25, v88, v90
    v_add3_u32 v47, s25, v89, v91
    v_add3_u32 v46, v46, v92, v94
    v_add3_u32 v47, v47, v93, v95
    v_perm_b32 v112, v113, v112, s23
    v_perm_b32 v113, v115, v114, s23
    ds_write_b64 v70, v[112:113] offset:33408
    s_setprio 2
    v_lshlrev_b32_sdwa v88, 3, v122 dst_sel:DWORD dst_unused:UNUSED_PAD src0_sel:DWORD src1_sel:WORD_0
    v_lshlrev_b32_sdwa v90, 3, v122 dst_sel:DWORD dst_unused:UNUSED_PAD src0_sel:DWORD src1_sel:WORD_1
    ds_read_b64 v[88:89], v88
    ds_read_b64 v[90:91], v90
    v_lshlrev_b32_sdwa v92, 3, v123 dst_sel:DWORD dst_unused:UNUSED_PAD src0_sel:DWORD src1_sel:WORD_0
    v_lshlrev_b32_sdwa v94, 3, v123 dst_sel:DWORD dst_unused:UNUSED_PAD src0_sel:DWORD src1_sel:WORD_1
    ds_read_b64 v[92:93], v92
    ds_read_b64 v[94:95], v94
    buffer_load_dwordx4 v[120:123], v71, s[12:15], s20 offen offset:3072 sc1
    s_waitcnt lgkmcnt(9)
    v_add3_u32 v46, v46, v96, v98
    v_add3_u32 v47, v47, v97, v99
    v_add3_u32 v46, v46, v100, v102
    v_add3_u32 v47, v47, v101, v103
    s_waitcnt vmcnt(2)
    v_lshlrev_b32_sdwa v96, 3, v124 dst_sel:DWORD dst_unused:UNUSED_PAD src0_sel:DWORD src1_sel:WORD_0
    v_lshlrev_b32_sdwa v98, 3, v124 dst_sel:DWORD dst_unused:UNUSED_PAD src0_sel:DWORD src1_sel:WORD_1
    ds_read_b64 v[96:97], v96
    ds_read_b64 v[98:99], v98
    v_lshlrev_b32_sdwa v100, 3, v125 dst_sel:DWORD dst_unused:UNUSED_PAD src0_sel:DWORD src1_sel:WORD_0
    v_lshlrev_b32_sdwa v102, 3, v125 dst_sel:DWORD dst_unused:UNUSED_PAD src0_sel:DWORD src1_sel:WORD_1
    ds_read_b64 v[100:101], v100
    ds_read_b64 v[102:103], v102
    s_waitcnt lgkmcnt(9)
    v_add3_u32 v48, s25, v104, v106
    v_add3_u32 v49, s25, v105, v107
    v_add3_u32 v48, v48, v108, v110
    v_add3_u32 v49, v49, v109, v111
    v_lshlrev_b32_sdwa v104, 3, v126 dst_sel:DWORD dst_unused:UNUSED_PAD src0_sel:DWORD src1_sel:WORD_0
    v_lshlrev_b32_sdwa v106, 3, v126 dst_sel:DWORD dst_unused:UNUSED_PAD src0_sel:DWORD src1_sel:WORD_1
    ds_read_b64 v[104:105], v104
    ds_read_b64 v[106:107], v106
    v_lshlrev_b32_sdwa v108, 3, v127 dst_sel:DWORD dst_unused:UNUSED_PAD src0_sel:DWORD src1_sel:WORD_0
    v_lshlrev_b32_sdwa v110, 3, v127 dst_sel:DWORD dst_unused:UNUSED_PAD src0_sel:DWORD src1_sel:WORD_1
    ds_read_b64 v[108:109], v108
    ds_read_b64 v[110:111], v110
    s_add_u32 s20, s20, 0x1000
    buffer_load_dwordx4 v[124:127], v71, s[12:15], s20 offen offset:0 sc1
    s_waitcnt lgkmcnt(8)
    v_add3_u32 v48, v48, v88, v90
    v_add3_u32 v49, v49, v89, v91
    v_add3_u32 v48, v48, v92, v94
    v_add3_u32 v49, v49, v93, v95
    v_mfma_f32_16x16x32_bf16 v[112:115], v[72:75], v[224:227], v[66:69]
    s_waitcnt vmcnt(2)
    v_lshlrev_b32_sdwa v88, 3, v116 dst_sel:DWORD dst_unused:UNUSED_PAD src0_sel:DWORD src1_sel:WORD_0
    v_lshlrev_b32_sdwa v90, 3, v116 dst_sel:DWORD dst_unused:UNUSED_PAD src0_sel:DWORD src1_sel:WORD_1
    ds_read_b64 v[88:89], v88
    ds_read_b64 v[90:91], v90
    v_mfma_f32_16x16x32_bf16 v[112:115], v[76:79], v[228:231], v[112:115]
    v_lshlrev_b32_sdwa v92, 3, v117 dst_sel:DWORD dst_unused:UNUSED_PAD src0_sel:DWORD src1_sel:WORD_0
    v_lshlrev_b32_sdwa v94, 3, v117 dst_sel:DWORD dst_unused:UNUSED_PAD src0_sel:DWORD src1_sel:WORD_1
    ds_read_b64 v[92:93], v92
    ds_read_b64 v[94:95], v94
    s_waitcnt lgkmcnt(8)
    v_add3_u32 v50, s25, v96, v98
    v_add3_u32 v51, s25, v97, v99
    v_add3_u32 v50, v50, v100, v102
    v_add3_u32 v51, v51, v101, v103
    v_mfma_f32_16x16x32_bf16 v[112:115], v[80:83], v[232:235], v[112:115]
    v_lshlrev_b32_sdwa v96, 3, v118 dst_sel:DWORD dst_unused:UNUSED_PAD src0_sel:DWORD src1_sel:WORD_0
    v_lshlrev_b32_sdwa v98, 3, v118 dst_sel:DWORD dst_unused:UNUSED_PAD src0_sel:DWORD src1_sel:WORD_1
    ds_read_b64 v[96:97], v96
    ds_read_b64 v[98:99], v98
    v_mfma_f32_16x16x32_bf16 v[112:115], v[84:87], v[236:239], v[112:115]
    v_lshlrev_b32_sdwa v100, 3, v119 dst_sel:DWORD dst_unused:UNUSED_PAD src0_sel:DWORD src1_sel:WORD_0
    v_lshlrev_b32_sdwa v102, 3, v119 dst_sel:DWORD dst_unused:UNUSED_PAD src0_sel:DWORD src1_sel:WORD_1
    ds_read_b64 v[100:101], v100
    ds_read_b64 v[102:103], v102
    buffer_load_dwordx4 v[116:119], v71, s[12:15], s20 offen offset:1024 sc1
    s_waitcnt lgkmcnt(8)
    v_add3_u32 v50, v50, v104, v106
    v_add3_u32 v51, v51, v105, v107
    v_add3_u32 v50, v50, v108, v110
    v_add3_u32 v51, v51, v109, v111
    v_perm_b32 v112, v113, v112, s23
    v_perm_b32 v113, v115, v114, s23
    ds_write_b64 v70, v[112:113] offset:33536
    s_waitcnt vmcnt(2)
    v_lshlrev_b32_sdwa v104, 3, v120 dst_sel:DWORD dst_unused:UNUSED_PAD src0_sel:DWORD src1_sel:WORD_0
    v_lshlrev_b32_sdwa v106, 3, v120 dst_sel:DWORD dst_unused:UNUSED_PAD src0_sel:DWORD src1_sel:WORD_1
    ds_read_b64 v[104:105], v104
    ds_read_b64 v[106:107], v106
    v_lshlrev_b32_sdwa v108, 3, v121 dst_sel:DWORD dst_unused:UNUSED_PAD src0_sel:DWORD src1_sel:WORD_0
    v_lshlrev_b32_sdwa v110, 3, v121 dst_sel:DWORD dst_unused:UNUSED_PAD src0_sel:DWORD src1_sel:WORD_1
    ds_read_b64 v[108:109], v108
    ds_read_b64 v[110:111], v110
    s_waitcnt lgkmcnt(9)
    v_add3_u32 v52, s25, v88, v90
    v_add3_u32 v53, s25, v89, v91
    v_add3_u32 v52, v52, v92, v94
    v_add3_u32 v53, v53, v93, v95
    v_lshlrev_b32_sdwa v88, 3, v122 dst_sel:DWORD dst_unused:UNUSED_PAD src0_sel:DWORD src1_sel:WORD_0
    v_lshlrev_b32_sdwa v90, 3, v122 dst_sel:DWORD dst_unused:UNUSED_PAD src0_sel:DWORD src1_sel:WORD_1
    ds_read_b64 v[88:89], v88
    ds_read_b64 v[90:91], v90
    v_lshlrev_b32_sdwa v92, 3, v123 dst_sel:DWORD dst_unused:UNUSED_PAD src0_sel:DWORD src1_sel:WORD_0
    v_lshlrev_b32_sdwa v94, 3, v123 dst_sel:DWORD dst_unused:UNUSED_PAD src0_sel:DWORD src1_sel:WORD_1
    ds_read_b64 v[92:93], v92
    ds_read_b64 v[94:95], v94
    buffer_load_dwordx4 v[120:123], v71, s[12:15], s20 offen offset:2048 sc1
    s_waitcnt lgkmcnt(9)
    v_add3_u32 v52, v52, v96, v98
    v_add3_u32 v53, v53, v97, v99
    v_add3_u32 v52, v52, v100, v102
    v_add3_u32 v53, v53, v101, v103
    s_waitcnt vmcnt(2)
    v_lshlrev_b32_sdwa v96, 3, v124 dst_sel:DWORD dst_unused:UNUSED_PAD src0_sel:DWORD src1_sel:WORD_0
    v_lshlrev_b32_sdwa v98, 3, v124 dst_sel:DWORD dst_unused:UNUSED_PAD src0_sel:DWORD src1_sel:WORD_1
    ds_read_b64 v[96:97], v96
    ds_read_b64 v[98:99], v98
    v_lshlrev_b32_sdwa v100, 3, v125 dst_sel:DWORD dst_unused:UNUSED_PAD src0_sel:DWORD src1_sel:WORD_0
    v_lshlrev_b32_sdwa v102, 3, v125 dst_sel:DWORD dst_unused:UNUSED_PAD src0_sel:DWORD src1_sel:WORD_1
    ds_read_b64 v[100:101], v100
    ds_read_b64 v[102:103], v102
    s_waitcnt lgkmcnt(8)
    v_add3_u32 v54, s25, v104, v106
    v_add3_u32 v55, s25, v105, v107
    v_add3_u32 v54, v54, v108, v110
    v_add3_u32 v55, v55, v109, v111
    s_setprio 1
    v_mfma_f32_16x16x32_bf16 v[112:115], v[72:75], v[240:243], v[66:69]
    buffer_load_dwordx4 v[72:75], v71, s[12:15], s21 offen offset:0
    v_lshlrev_b32_sdwa v104, 3, v126 dst_sel:DWORD dst_unused:UNUSED_PAD src0_sel:DWORD src1_sel:WORD_0
    v_lshlrev_b32_sdwa v106, 3, v126 dst_sel:DWORD dst_unused:UNUSED_PAD src0_sel:DWORD src1_sel:WORD_1
    ds_read_b64 v[104:105], v104
    ds_read_b64 v[106:107], v106
    v_mfma_f32_16x16x32_bf16 v[112:115], v[76:79], v[244:247], v[112:115]
    buffer_load_dwordx4 v[76:79], v71, s[12:15], s21 offen offset:1024
    v_lshlrev_b32_sdwa v108, 3, v127 dst_sel:DWORD dst_unused:UNUSED_PAD src0_sel:DWORD src1_sel:WORD_0
    v_lshlrev_b32_sdwa v110, 3, v127 dst_sel:DWORD dst_unused:UNUSED_PAD src0_sel:DWORD src1_sel:WORD_1
    ds_read_b64 v[108:109], v108
    ds_read_b64 v[110:111], v110
    buffer_load_dwordx4 v[124:127], v71, s[12:15], s20 offen offset:3072 sc1
    s_waitcnt lgkmcnt(8)
    v_add3_u32 v54, v54, v88, v90
    v_add3_u32 v55, v55, v89, v91
    v_add3_u32 v54, v54, v92, v94
    v_add3_u32 v55, v55, v93, v95
    v_mfma_f32_16x16x32_bf16 v[112:115], v[80:83], v[248:251], v[112:115]
    buffer_load_dwordx4 v[80:83], v71, s[12:15], s19 offen offset:0
    s_waitcnt vmcnt(5)
    v_lshlrev_b32_sdwa v88, 3, v116 dst_sel:DWORD dst_unused:UNUSED_PAD src0_sel:DWORD src1_sel:WORD_0
    v_lshlrev_b32_sdwa v90, 3, v116 dst_sel:DWORD dst_unused:UNUSED_PAD src0_sel:DWORD src1_sel:WORD_1
    ds_read_b64 v[88:89], v88
    ds_read_b64 v[90:91], v90
    v_mfma_f32_16x16x32_bf16 v[112:115], v[84:87], v[252:255], v[112:115]
    buffer_load_dwordx4 v[84:87], v71, s[12:15], s19 offen offset:1024
    s_add_u32 s21, s21, 4096
    s_add_u32 s19, s19, 4096
    v_lshlrev_b32_sdwa v92, 3, v117 dst_sel:DWORD dst_unused:UNUSED_PAD src0_sel:DWORD src1_sel:WORD_0
    v_lshlrev_b32_sdwa v94, 3, v117 dst_sel:DWORD dst_unused:UNUSED_PAD src0_sel:DWORD src1_sel:WORD_1
    ds_read_b64 v[92:93], v92
    ds_read_b64 v[94:95], v94
    s_waitcnt lgkmcnt(8)
    v_add3_u32 v56, s25, v96, v98
    v_add3_u32 v57, s25, v97, v99
    v_add3_u32 v56, v56, v100, v102
    v_add3_u32 v57, v57, v101, v103
    v_perm_b32 v112, v113, v112, s23
    v_perm_b32 v113, v115, v114, s23
    ds_write_b64 v70, v[112:113] offset:33664
    v_lshlrev_b32_sdwa v96, 3, v118 dst_sel:DWORD dst_unused:UNUSED_PAD src0_sel:DWORD src1_sel:WORD_0
    v_lshlrev_b32_sdwa v98, 3, v118 dst_sel:DWORD dst_unused:UNUSED_PAD src0_sel:DWORD src1_sel:WORD_1
    ds_read_b64 v[96:97], v96
    ds_read_b64 v[98:99], v98
    v_lshlrev_b32_sdwa v100, 3, v119 dst_sel:DWORD dst_unused:UNUSED_PAD src0_sel:DWORD src1_sel:WORD_0
    v_lshlrev_b32_sdwa v102, 3, v119 dst_sel:DWORD dst_unused:UNUSED_PAD src0_sel:DWORD src1_sel:WORD_1
    ds_read_b64 v[100:101], v100
    ds_read_b64 v[102:103], v102
    s_add_u32 s20, s20, 0x1d000
    buffer_load_dwordx4 v[116:119], v71, s[12:15], s20 offen offset:0 sc1
    s_waitcnt lgkmcnt(9)
    v_add3_u32 v56, v56, v104, v106
    v_add3_u32 v57, v57, v105, v107
    v_add3_u32 v56, v56, v108, v110
    v_add3_u32 v57, v57, v109, v111
    s_waitcnt vmcnt(6)
    v_lshlrev_b32_sdwa v104, 3, v120 dst_sel:DWORD dst_unused:UNUSED_PAD src0_sel:DWORD src1_sel:WORD_0
    v_lshlrev_b32_sdwa v106, 3, v120 dst_sel:DWORD dst_unused:UNUSED_PAD src0_sel:DWORD src1_sel:WORD_1
    ds_read_b64 v[104:105], v104
    ds_read_b64 v[106:107], v106
    v_lshlrev_b32_sdwa v108, 3, v121 dst_sel:DWORD dst_unused:UNUSED_PAD src0_sel:DWORD src1_sel:WORD_0
    v_lshlrev_b32_sdwa v110, 3, v121 dst_sel:DWORD dst_unused:UNUSED_PAD src0_sel:DWORD src1_sel:WORD_1
    ds_read_b64 v[108:109], v108
    ds_read_b64 v[110:111], v110
    s_waitcnt lgkmcnt(9)
    v_add3_u32 v58, s25, v88, v90
    v_add3_u32 v59, s25, v89, v91
    v_add3_u32 v58, v58, v92, v94
    v_add3_u32 v59, v59, v93, v95
    v_lshlrev_b32_sdwa v88, 3, v122 dst_sel:DWORD dst_unused:UNUSED_PAD src0_sel:DWORD src1_sel:WORD_0
    v_lshlrev_b32_sdwa v90, 3, v122 dst_sel:DWORD dst_unused:UNUSED_PAD src0_sel:DWORD src1_sel:WORD_1
    ds_read_b64 v[88:89], v88
    ds_read_b64 v[90:91], v90
    v_lshlrev_b32_sdwa v92, 3, v123 dst_sel:DWORD dst_unused:UNUSED_PAD src0_sel:DWORD src1_sel:WORD_0
    v_lshlrev_b32_sdwa v94, 3, v123 dst_sel:DWORD dst_unused:UNUSED_PAD src0_sel:DWORD src1_sel:WORD_1
    ds_read_b64 v[92:93], v92
    ds_read_b64 v[94:95], v94
    buffer_load_dwordx4 v[120:123], v71, s[12:15], s20 offen offset:1024 sc1
    s_waitcnt lgkmcnt(8)
    v_add3_u32 v58, v58, v96, v98
    v_add3_u32 v59, v59, v97, v99
    v_add3_u32 v58, v58, v100, v102
    v_add3_u32 v59, v59, v101, v103
    s_waitcnt vmcnt(4)
    v_lshlrev_b32_sdwa v96, 3, v124 dst_sel:DWORD dst_unused:UNUSED_PAD src0_sel:DWORD src1_sel:WORD_0
    v_lshlrev_b32_sdwa v98, 3, v124 dst_sel:DWORD dst_unused:UNUSED_PAD src0_sel:DWORD src1_sel:WORD_1
    ds_read_b64 v[96:97], v96
    ds_read_b64 v[98:99], v98
    v_lshlrev_b32_sdwa v100, 3, v125 dst_sel:DWORD dst_unused:UNUSED_PAD src0_sel:DWORD src1_sel:WORD_0
    v_lshlrev_b32_sdwa v102, 3, v125 dst_sel:DWORD dst_unused:UNUSED_PAD src0_sel:DWORD src1_sel:WORD_1
    ds_read_b64 v[100:101], v100
    ds_read_b64 v[102:103], v102
    s_waitcnt lgkmcnt(8)
    v_add3_u32 v60, s25, v104, v106
    v_add3_u32 v61, s25, v105, v107
    v_add3_u32 v60, v60, v108, v110
    v_add3_u32 v61, v61, v109, v111
    s_setprio 0
    v_lshlrev_b32_sdwa v104, 3, v126 dst_sel:DWORD dst_unused:UNUSED_PAD src0_sel:DWORD src1_sel:WORD_0
    v_lshlrev_b32_sdwa v106, 3, v126 dst_sel:DWORD dst_unused:UNUSED_PAD src0_sel:DWORD src1_sel:WORD_1
    ds_read_b64 v[104:105], v104
    ds_read_b64 v[106:107], v106
    v_lshlrev_b32_sdwa v108, 3, v127 dst_sel:DWORD dst_unused:UNUSED_PAD src0_sel:DWORD src1_sel:WORD_0
    v_lshlrev_b32_sdwa v110, 3, v127 dst_sel:DWORD dst_unused:UNUSED_PAD src0_sel:DWORD src1_sel:WORD_1
    ds_read_b64 v[108:109], v108
    ds_read_b64 v[110:111], v110
    buffer_load_dwordx4 v[124:127], v71, s[12:15], s20 offen offset:2048 sc1
    s_waitcnt lgkmcnt(8)
    v_add3_u32 v60, v60, v88, v90
    v_add3_u32 v61, v61, v89, v91
    v_add3_u32 v60, v60, v92, v94
    v_add3_u32 v61, v61, v93, v95
    s_waitcnt vmcnt(2)
    v_lshlrev_b32_sdwa v88, 3, v118 dst_sel:DWORD dst_unused:UNUSED_PAD src0_sel:DWORD src1_sel:WORD_0
    v_lshlrev_b32_sdwa v90, 3, v118 dst_sel:DWORD dst_unused:UNUSED_PAD src0_sel:DWORD src1_sel:WORD_1
    ds_read_b64 v[88:89], v88
    ds_read_b64 v[90:91], v90
    v_lshlrev_b32_sdwa v92, 3, v119 dst_sel:DWORD dst_unused:UNUSED_PAD src0_sel:DWORD src1_sel:WORD_0
    v_lshlrev_b32_sdwa v94, 3, v119 dst_sel:DWORD dst_unused:UNUSED_PAD src0_sel:DWORD src1_sel:WORD_1
    ds_read_b64 v[92:93], v92
    ds_read_b64 v[94:95], v94
    s_waitcnt lgkmcnt(8)
    v_add3_u32 v62, s25, v96, v98
    v_add3_u32 v63, s25, v97, v99
    v_add3_u32 v62, v62, v100, v102
    v_add3_u32 v63, v63, v101, v103
    s_barrier
    s_setprio 3
    v_lshlrev_b32_sdwa v96, 3, v116 dst_sel:DWORD dst_unused:UNUSED_PAD src0_sel:DWORD src1_sel:WORD_0
    v_lshlrev_b32_sdwa v98, 3, v116 dst_sel:DWORD dst_unused:UNUSED_PAD src0_sel:DWORD src1_sel:WORD_1
    ds_read_b64 v[96:97], v96
    ds_read_b64 v[98:99], v98
    v_lshlrev_b32_sdwa v100, 3, v117 dst_sel:DWORD dst_unused:UNUSED_PAD src0_sel:DWORD src1_sel:WORD_0
    v_lshlrev_b32_sdwa v102, 3, v117 dst_sel:DWORD dst_unused:UNUSED_PAD src0_sel:DWORD src1_sel:WORD_1
    ds_read_b64 v[100:101], v100
    ds_read_b64 v[102:103], v102
    buffer_load_dwordx4 v[116:119], v71, s[12:15], s20 offen offset:3072 sc1
    s_waitcnt lgkmcnt(8)
    v_add3_u32 v62, v62, v104, v106
    v_add3_u32 v63, v63, v105, v107
    v_add3_u32 v62, v62, v108, v110
    v_add3_u32 v63, v63, v109, v111
    v_mfma_f32_16x16x32_bf16 v[112:115], v[72:75], v[128:131], v[66:69]
    s_waitcnt vmcnt(2)
    v_lshlrev_b32_sdwa v104, 3, v122 dst_sel:DWORD dst_unused:UNUSED_PAD src0_sel:DWORD src1_sel:WORD_0
    v_lshlrev_b32_sdwa v106, 3, v122 dst_sel:DWORD dst_unused:UNUSED_PAD src0_sel:DWORD src1_sel:WORD_1
    ds_read_b64 v[104:105], v104
    ds_read_b64 v[106:107], v106
    v_mfma_f32_16x16x32_bf16 v[112:115], v[76:79], v[132:135], v[112:115]
    v_add_u32 v70, 0x10000, v70
    v_lshlrev_b32_sdwa v108, 3, v123 dst_sel:DWORD dst_unused:UNUSED_PAD src0_sel:DWORD src1_sel:WORD_0
    v_lshlrev_b32_sdwa v110, 3, v123 dst_sel:DWORD dst_unused:UNUSED_PAD src0_sel:DWORD src1_sel:WORD_1
    ds_read_b64 v[108:109], v108
    ds_read_b64 v[110:111], v110
    s_waitcnt lgkmcnt(8)
    v_add3_u32 v0, v0, v88, v90
    v_add3_u32 v1, v1, v89, v91
    v_add3_u32 v0, v0, v92, v94
    v_add3_u32 v1, v1, v93, v95
    v_mfma_f32_16x16x32_bf16 v[112:115], v[80:83], v[136:139], v[112:115]
    v_lshlrev_b32_sdwa v88, 3, v120 dst_sel:DWORD dst_unused:UNUSED_PAD src0_sel:DWORD src1_sel:WORD_0
    v_lshlrev_b32_sdwa v90, 3, v120 dst_sel:DWORD dst_unused:UNUSED_PAD src0_sel:DWORD src1_sel:WORD_1
    ds_read_b64 v[88:89], v88
    ds_read_b64 v[90:91], v90
    v_mfma_f32_16x16x32_bf16 v[112:115], v[84:87], v[140:143], v[112:115]
    v_lshlrev_b32_sdwa v92, 3, v121 dst_sel:DWORD dst_unused:UNUSED_PAD src0_sel:DWORD src1_sel:WORD_0
    v_lshlrev_b32_sdwa v94, 3, v121 dst_sel:DWORD dst_unused:UNUSED_PAD src0_sel:DWORD src1_sel:WORD_1
    ds_read_b64 v[92:93], v92
    ds_read_b64 v[94:95], v94
    s_add_u32 s20, s20, 0x1000
    buffer_load_dwordx4 v[120:123], v71, s[12:15], s20 offen offset:0 sc1
    s_waitcnt lgkmcnt(8)
    v_add3_u32 v0, v0, v96, v98
    v_add3_u32 v1, v1, v97, v99
    v_add3_u32 v0, v0, v100, v102
    v_add3_u32 v1, v1, v101, v103
    v_perm_b32 v112, v113, v112, s23
    v_perm_b32 v113, v115, v114, s23
    ds_write_b64 v70, v[112:113] offset:0
    s_waitcnt vmcnt(2)
    v_lshlrev_b32_sdwa v96, 3, v126 dst_sel:DWORD dst_unused:UNUSED_PAD src0_sel:DWORD src1_sel:WORD_0
    v_lshlrev_b32_sdwa v98, 3, v126 dst_sel:DWORD dst_unused:UNUSED_PAD src0_sel:DWORD src1_sel:WORD_1
    ds_read_b64 v[96:97], v96
    ds_read_b64 v[98:99], v98
    v_lshlrev_b32_sdwa v100, 3, v127 dst_sel:DWORD dst_unused:UNUSED_PAD src0_sel:DWORD src1_sel:WORD_0
    v_lshlrev_b32_sdwa v102, 3, v127 dst_sel:DWORD dst_unused:UNUSED_PAD src0_sel:DWORD src1_sel:WORD_1
    ds_read_b64 v[100:101], v100
    ds_read_b64 v[102:103], v102
    s_waitcnt lgkmcnt(9)
    v_add3_u32 v2, v2, v104, v106
    v_add3_u32 v3, v3, v105, v107
    v_add3_u32 v2, v2, v108, v110
    v_add3_u32 v3, v3, v109, v111
    v_mfma_f32_16x16x32_bf16 v[112:115], v[72:75], v[144:147], v[66:69]
    v_lshlrev_b32_sdwa v104, 3, v124 dst_sel:DWORD dst_unused:UNUSED_PAD src0_sel:DWORD src1_sel:WORD_0
    v_lshlrev_b32_sdwa v106, 3, v124 dst_sel:DWORD dst_unused:UNUSED_PAD src0_sel:DWORD src1_sel:WORD_1
    ds_read_b64 v[104:105], v104
    ds_read_b64 v[106:107], v106
    v_mfma_f32_16x16x32_bf16 v[112:115], v[76:79], v[148:151], v[112:115]
    v_lshlrev_b32_sdwa v108, 3, v125 dst_sel:DWORD dst_unused:UNUSED_PAD src0_sel:DWORD src1_sel:WORD_0
    v_lshlrev_b32_sdwa v110, 3, v125 dst_sel:DWORD dst_unused:UNUSED_PAD src0_sel:DWORD src1_sel:WORD_1
    ds_read_b64 v[108:109], v108
    ds_read_b64 v[110:111], v110
    buffer_load_dwordx4 v[124:127], v71, s[12:15], s20 offen offset:1024 sc1
    s_waitcnt lgkmcnt(9)
    v_add3_u32 v2, v2, v88, v90
    v_add3_u32 v3, v3, v89, v91
    v_add3_u32 v2, v2, v92, v94
    v_add3_u32 v3, v3, v93, v95
    v_mfma_f32_16x16x32_bf16 v[112:115], v[80:83], v[152:155], v[112:115]
    s_waitcnt vmcnt(2)
    v_lshlrev_b32_sdwa v88, 3, v118 dst_sel:DWORD dst_unused:UNUSED_PAD src0_sel:DWORD src1_sel:WORD_0
    v_lshlrev_b32_sdwa v90, 3, v118 dst_sel:DWORD dst_unused:UNUSED_PAD src0_sel:DWORD src1_sel:WORD_1
    ds_read_b64 v[88:89], v88
    ds_read_b64 v[90:91], v90
    v_mfma_f32_16x16x32_bf16 v[112:115], v[84:87], v[156:159], v[112:115]
    v_lshlrev_b32_sdwa v92, 3, v119 dst_sel:DWORD dst_unused:UNUSED_PAD src0_sel:DWORD src1_sel:WORD_0
    v_lshlrev_b32_sdwa v94, 3, v119 dst_sel:DWORD dst_unused:UNUSED_PAD src0_sel:DWORD src1_sel:WORD_1
    ds_read_b64 v[92:93], v92
    ds_read_b64 v[94:95], v94
    s_waitcnt lgkmcnt(8)
    v_add3_u32 v4, v4, v96, v98
    v_add3_u32 v5, v5, v97, v99
    v_add3_u32 v4, v4, v100, v102
    v_add3_u32 v5, v5, v101, v103
    v_perm_b32 v112, v113, v112, s23
    v_perm_b32 v113, v115, v114, s23
    ds_write_b64 v70, v[112:113] offset:128
    v_lshlrev_b32_sdwa v96, 3, v116 dst_sel:DWORD dst_unused:UNUSED_PAD src0_sel:DWORD src1_sel:WORD_0
    v_lshlrev_b32_sdwa v98, 3, v116 dst_sel:DWORD dst_unused:UNUSED_PAD src0_sel:DWORD src1_sel:WORD_1
    ds_read_b64 v[96:97], v96
    ds_read_b64 v[98:99], v98
    v_lshlrev_b32_sdwa v100, 3, v117 dst_sel:DWORD dst_unused:UNUSED_PAD src0_sel:DWORD src1_sel:WORD_0
    v_lshlrev_b32_sdwa v102, 3, v117 dst_sel:DWORD dst_unused:UNUSED_PAD src0_sel:DWORD src1_sel:WORD_1
    ds_read_b64 v[100:101], v100
    ds_read_b64 v[102:103], v102
    buffer_load_dwordx4 v[116:119], v71, s[12:15], s20 offen offset:2048 sc1
    s_waitcnt lgkmcnt(9)
    v_add3_u32 v4, v4, v104, v106
    v_add3_u32 v5, v5, v105, v107
    v_add3_u32 v4, v4, v108, v110
    v_add3_u32 v5, v5, v109, v111
    v_mfma_f32_16x16x32_bf16 v[112:115], v[72:75], v[160:163], v[66:69]
    s_waitcnt vmcnt(2)
    v_lshlrev_b32_sdwa v104, 3, v122 dst_sel:DWORD dst_unused:UNUSED_PAD src0_sel:DWORD src1_sel:WORD_0
    v_lshlrev_b32_sdwa v106, 3, v122 dst_sel:DWORD dst_unused:UNUSED_PAD src0_sel:DWORD src1_sel:WORD_1
    ds_read_b64 v[104:105], v104
    ds_read_b64 v[106:107], v106
    v_mfma_f32_16x16x32_bf16 v[112:115], v[76:79], v[164:167], v[112:115]
    v_lshlrev_b32_sdwa v108, 3, v123 dst_sel:DWORD dst_unused:UNUSED_PAD src0_sel:DWORD src1_sel:WORD_0
    v_lshlrev_b32_sdwa v110, 3, v123 dst_sel:DWORD dst_unused:UNUSED_PAD src0_sel:DWORD src1_sel:WORD_1
    ds_read_b64 v[108:109], v108
    ds_read_b64 v[110:111], v110
    s_waitcnt lgkmcnt(9)
    v_add3_u32 v6, v6, v88, v90
    v_add3_u32 v7, v7, v89, v91
    v_add3_u32 v6, v6, v92, v94
    v_add3_u32 v7, v7, v93, v95
    v_mfma_f32_16x16x32_bf16 v[112:115], v[80:83], v[168:171], v[112:115]
    v_lshlrev_b32_sdwa v88, 3, v120 dst_sel:DWORD dst_unused:UNUSED_PAD src0_sel:DWORD src1_sel:WORD_0
    v_lshlrev_b32_sdwa v90, 3, v120 dst_sel:DWORD dst_unused:UNUSED_PAD src0_sel:DWORD src1_sel:WORD_1
    ds_read_b64 v[88:89], v88
    ds_read_b64 v[90:91], v90
    v_mfma_f32_16x16x32_bf16 v[112:115], v[84:87], v[172:175], v[112:115]
    v_lshlrev_b32_sdwa v92, 3, v121 dst_sel:DWORD dst_unused:UNUSED_PAD src0_sel:DWORD src1_sel:WORD_0
    v_lshlrev_b32_sdwa v94, 3, v121 dst_sel:DWORD dst_unused:UNUSED_PAD src0_sel:DWORD src1_sel:WORD_1
    ds_read_b64 v[92:93], v92
    ds_read_b64 v[94:95], v94
    buffer_load_dwordx4 v[120:123], v71, s[12:15], s20 offen offset:3072 sc1
    s_waitcnt lgkmcnt(8)
    v_add3_u32 v6, v6, v96, v98
    v_add3_u32 v7, v7, v97, v99
    v_add3_u32 v6, v6, v100, v102
    v_add3_u32 v7, v7, v101, v103
    v_perm_b32 v112, v113, v112, s23
    v_perm_b32 v113, v115, v114, s23
    ds_write_b64 v70, v[112:113] offset:256
    s_waitcnt vmcnt(2)
    v_lshlrev_b32_sdwa v96, 3, v126 dst_sel:DWORD dst_unused:UNUSED_PAD src0_sel:DWORD src1_sel:WORD_0
    v_lshlrev_b32_sdwa v98, 3, v126 dst_sel:DWORD dst_unused:UNUSED_PAD src0_sel:DWORD src1_sel:WORD_1
    ds_read_b64 v[96:97], v96
    ds_read_b64 v[98:99], v98
    v_lshlrev_b32_sdwa v100, 3, v127 dst_sel:DWORD dst_unused:UNUSED_PAD src0_sel:DWORD src1_sel:WORD_0
    v_lshlrev_b32_sdwa v102, 3, v127 dst_sel:DWORD dst_unused:UNUSED_PAD src0_sel:DWORD src1_sel:WORD_1
    ds_read_b64 v[100:101], v100
    ds_read_b64 v[102:103], v102
    s_waitcnt lgkmcnt(9)
    v_add3_u32 v8, v8, v104, v106
    v_add3_u32 v9, v9, v105, v107
    v_add3_u32 v8, v8, v108, v110
    v_add3_u32 v9, v9, v109, v111
    v_mfma_f32_16x16x32_bf16 v[112:115], v[72:75], v[176:179], v[66:69]
    v_lshlrev_b32_sdwa v104, 3, v124 dst_sel:DWORD dst_unused:UNUSED_PAD src0_sel:DWORD src1_sel:WORD_0
    v_lshlrev_b32_sdwa v106, 3, v124 dst_sel:DWORD dst_unused:UNUSED_PAD src0_sel:DWORD src1_sel:WORD_1
    ds_read_b64 v[104:105], v104
    ds_read_b64 v[106:107], v106
    v_mfma_f32_16x16x32_bf16 v[112:115], v[76:79], v[180:183], v[112:115]
    v_lshlrev_b32_sdwa v108, 3, v125 dst_sel:DWORD dst_unused:UNUSED_PAD src0_sel:DWORD src1_sel:WORD_0
    v_lshlrev_b32_sdwa v110, 3, v125 dst_sel:DWORD dst_unused:UNUSED_PAD src0_sel:DWORD src1_sel:WORD_1
    ds_read_b64 v[108:109], v108
    ds_read_b64 v[110:111], v110
    s_add_u32 s20, s20, 0x1000
    buffer_load_dwordx4 v[124:127], v71, s[12:15], s20 offen offset:0 sc1
    s_waitcnt lgkmcnt(9)
    v_add3_u32 v8, v8, v88, v90
    v_add3_u32 v9, v9, v89, v91
    v_add3_u32 v8, v8, v92, v94
    v_add3_u32 v9, v9, v93, v95
    v_mfma_f32_16x16x32_bf16 v[112:115], v[80:83], v[184:187], v[112:115]
    s_waitcnt vmcnt(2)
    v_lshlrev_b32_sdwa v88, 3, v118 dst_sel:DWORD dst_unused:UNUSED_PAD src0_sel:DWORD src1_sel:WORD_0
    v_lshlrev_b32_sdwa v90, 3, v118 dst_sel:DWORD dst_unused:UNUSED_PAD src0_sel:DWORD src1_sel:WORD_1
    ds_read_b64 v[88:89], v88
    ds_read_b64 v[90:91], v90
    v_mfma_f32_16x16x32_bf16 v[112:115], v[84:87], v[188:191], v[112:115]
    v_lshlrev_b32_sdwa v92, 3, v119 dst_sel:DWORD dst_unused:UNUSED_PAD src0_sel:DWORD src1_sel:WORD_0
    v_lshlrev_b32_sdwa v94, 3, v119 dst_sel:DWORD dst_unused:UNUSED_PAD src0_sel:DWORD src1_sel:WORD_1
    ds_read_b64 v[92:93], v92
    ds_read_b64 v[94:95], v94
    s_waitcnt lgkmcnt(8)
    v_add3_u32 v10, v10, v96, v98
    v_add3_u32 v11, v11, v97, v99
    v_add3_u32 v10, v10, v100, v102
    v_add3_u32 v11, v11, v101, v103
    v_perm_b32 v112, v113, v112, s23
    v_perm_b32 v113, v115, v114, s23
    ds_write_b64 v70, v[112:113] offset:384
    v_lshlrev_b32_sdwa v96, 3, v116 dst_sel:DWORD dst_unused:UNUSED_PAD src0_sel:DWORD src1_sel:WORD_0
    v_lshlrev_b32_sdwa v98, 3, v116 dst_sel:DWORD dst_unused:UNUSED_PAD src0_sel:DWORD src1_sel:WORD_1
    ds_read_b64 v[96:97], v96
    ds_read_b64 v[98:99], v98
    v_lshlrev_b32_sdwa v100, 3, v117 dst_sel:DWORD dst_unused:UNUSED_PAD src0_sel:DWORD src1_sel:WORD_0
    v_lshlrev_b32_sdwa v102, 3, v117 dst_sel:DWORD dst_unused:UNUSED_PAD src0_sel:DWORD src1_sel:WORD_1
    ds_read_b64 v[100:101], v100
    ds_read_b64 v[102:103], v102
    buffer_load_dwordx4 v[116:119], v71, s[12:15], s20 offen offset:1024 sc1
    s_waitcnt lgkmcnt(9)
    v_add3_u32 v10, v10, v104, v106
    v_add3_u32 v11, v11, v105, v107
    v_add3_u32 v10, v10, v108, v110
    v_add3_u32 v11, v11, v109, v111
    v_mfma_f32_16x16x32_bf16 v[112:115], v[72:75], v[192:195], v[66:69]
    s_waitcnt vmcnt(2)
    v_lshlrev_b32_sdwa v104, 3, v122 dst_sel:DWORD dst_unused:UNUSED_PAD src0_sel:DWORD src1_sel:WORD_0
    v_lshlrev_b32_sdwa v106, 3, v122 dst_sel:DWORD dst_unused:UNUSED_PAD src0_sel:DWORD src1_sel:WORD_1
    ds_read_b64 v[104:105], v104
    ds_read_b64 v[106:107], v106
    v_mfma_f32_16x16x32_bf16 v[112:115], v[76:79], v[196:199], v[112:115]
    v_lshlrev_b32_sdwa v108, 3, v123 dst_sel:DWORD dst_unused:UNUSED_PAD src0_sel:DWORD src1_sel:WORD_0
    v_lshlrev_b32_sdwa v110, 3, v123 dst_sel:DWORD dst_unused:UNUSED_PAD src0_sel:DWORD src1_sel:WORD_1
    ds_read_b64 v[108:109], v108
    ds_read_b64 v[110:111], v110
    s_waitcnt lgkmcnt(9)
    v_add3_u32 v12, v12, v88, v90
    v_add3_u32 v13, v13, v89, v91
    v_add3_u32 v12, v12, v92, v94
    v_add3_u32 v13, v13, v93, v95
    v_mfma_f32_16x16x32_bf16 v[112:115], v[80:83], v[200:203], v[112:115]
    v_lshlrev_b32_sdwa v88, 3, v120 dst_sel:DWORD dst_unused:UNUSED_PAD src0_sel:DWORD src1_sel:WORD_0
    v_lshlrev_b32_sdwa v90, 3, v120 dst_sel:DWORD dst_unused:UNUSED_PAD src0_sel:DWORD src1_sel:WORD_1
    ds_read_b64 v[88:89], v88
    ds_read_b64 v[90:91], v90
    v_mfma_f32_16x16x32_bf16 v[112:115], v[84:87], v[204:207], v[112:115]
    v_lshlrev_b32_sdwa v92, 3, v121 dst_sel:DWORD dst_unused:UNUSED_PAD src0_sel:DWORD src1_sel:WORD_0
    v_lshlrev_b32_sdwa v94, 3, v121 dst_sel:DWORD dst_unused:UNUSED_PAD src0_sel:DWORD src1_sel:WORD_1
    ds_read_b64 v[92:93], v92
    ds_read_b64 v[94:95], v94
    buffer_load_dwordx4 v[120:123], v71, s[12:15], s20 offen offset:2048 sc1
    s_waitcnt lgkmcnt(8)
    v_add3_u32 v12, v12, v96, v98
    v_add3_u32 v13, v13, v97, v99
    v_add3_u32 v12, v12, v100, v102
    v_add3_u32 v13, v13, v101, v103
    v_perm_b32 v112, v113, v112, s23
    v_perm_b32 v113, v115, v114, s23
    ds_write_b64 v70, v[112:113] offset:512
    s_waitcnt vmcnt(2)
    v_lshlrev_b32_sdwa v96, 3, v126 dst_sel:DWORD dst_unused:UNUSED_PAD src0_sel:DWORD src1_sel:WORD_0
    v_lshlrev_b32_sdwa v98, 3, v126 dst_sel:DWORD dst_unused:UNUSED_PAD src0_sel:DWORD src1_sel:WORD_1
    ds_read_b64 v[96:97], v96
    ds_read_b64 v[98:99], v98
    v_lshlrev_b32_sdwa v100, 3, v127 dst_sel:DWORD dst_unused:UNUSED_PAD src0_sel:DWORD src1_sel:WORD_0
    v_lshlrev_b32_sdwa v102, 3, v127 dst_sel:DWORD dst_unused:UNUSED_PAD src0_sel:DWORD src1_sel:WORD_1
    ds_read_b64 v[100:101], v100
    ds_read_b64 v[102:103], v102
    s_waitcnt lgkmcnt(9)
    v_add3_u32 v14, v14, v104, v106
    v_add3_u32 v15, v15, v105, v107
    v_add3_u32 v14, v14, v108, v110
    v_add3_u32 v15, v15, v109, v111
    s_setprio 2
    v_mfma_f32_16x16x32_bf16 v[112:115], v[72:75], v[208:211], v[66:69]
    v_lshlrev_b32_sdwa v104, 3, v124 dst_sel:DWORD dst_unused:UNUSED_PAD src0_sel:DWORD src1_sel:WORD_0
    v_lshlrev_b32_sdwa v106, 3, v124 dst_sel:DWORD dst_unused:UNUSED_PAD src0_sel:DWORD src1_sel:WORD_1
    ds_read_b64 v[104:105], v104
    ds_read_b64 v[106:107], v106
    v_mfma_f32_16x16x32_bf16 v[112:115], v[76:79], v[212:215], v[112:115]
    v_lshlrev_b32_sdwa v108, 3, v125 dst_sel:DWORD dst_unused:UNUSED_PAD src0_sel:DWORD src1_sel:WORD_0
    v_lshlrev_b32_sdwa v110, 3, v125 dst_sel:DWORD dst_unused:UNUSED_PAD src0_sel:DWORD src1_sel:WORD_1
    ds_read_b64 v[108:109], v108
    ds_read_b64 v[110:111], v110
    buffer_load_dwordx4 v[124:127], v71, s[12:15], s20 offen offset:3072 sc1
    s_waitcnt lgkmcnt(9)
    v_add3_u32 v14, v14, v88, v90
    v_add3_u32 v15, v15, v89, v91
    v_add3_u32 v14, v14, v92, v94
    v_add3_u32 v15, v15, v93, v95
    v_mfma_f32_16x16x32_bf16 v[112:115], v[80:83], v[216:219], v[112:115]
    s_waitcnt vmcnt(2)
    v_lshlrev_b32_sdwa v88, 3, v118 dst_sel:DWORD dst_unused:UNUSED_PAD src0_sel:DWORD src1_sel:WORD_0
    v_lshlrev_b32_sdwa v90, 3, v118 dst_sel:DWORD dst_unused:UNUSED_PAD src0_sel:DWORD src1_sel:WORD_1
    ds_read_b64 v[88:89], v88
    ds_read_b64 v[90:91], v90
    v_mfma_f32_16x16x32_bf16 v[112:115], v[84:87], v[220:223], v[112:115]
    v_lshlrev_b32_sdwa v92, 3, v119 dst_sel:DWORD dst_unused:UNUSED_PAD src0_sel:DWORD src1_sel:WORD_0
    v_lshlrev_b32_sdwa v94, 3, v119 dst_sel:DWORD dst_unused:UNUSED_PAD src0_sel:DWORD src1_sel:WORD_1
    ds_read_b64 v[92:93], v92
    ds_read_b64 v[94:95], v94
    s_waitcnt lgkmcnt(8)
    v_add3_u32 v16, v16, v96, v98
    v_add3_u32 v17, v17, v97, v99
    v_add3_u32 v16, v16, v100, v102
    v_add3_u32 v17, v17, v101, v103
    v_perm_b32 v112, v113, v112, s23
    v_perm_b32 v113, v115, v114, s23
    ds_write_b64 v70, v[112:113] offset:640
    v_lshlrev_b32_sdwa v96, 3, v116 dst_sel:DWORD dst_unused:UNUSED_PAD src0_sel:DWORD src1_sel:WORD_0
    v_lshlrev_b32_sdwa v98, 3, v116 dst_sel:DWORD dst_unused:UNUSED_PAD src0_sel:DWORD src1_sel:WORD_1
    ds_read_b64 v[96:97], v96
    ds_read_b64 v[98:99], v98
    v_lshlrev_b32_sdwa v100, 3, v117 dst_sel:DWORD dst_unused:UNUSED_PAD src0_sel:DWORD src1_sel:WORD_0
    v_lshlrev_b32_sdwa v102, 3, v117 dst_sel:DWORD dst_unused:UNUSED_PAD src0_sel:DWORD src1_sel:WORD_1
    ds_read_b64 v[100:101], v100
    ds_read_b64 v[102:103], v102
    s_add_u32 s20, s20, 0x1000
    buffer_load_dwordx4 v[116:119], v71, s[12:15], s20 offen offset:0 sc1
    s_waitcnt lgkmcnt(9)
    v_add3_u32 v16, v16, v104, v106
    v_add3_u32 v17, v17, v105, v107
    v_add3_u32 v16, v16, v108, v110
    v_add3_u32 v17, v17, v109, v111
    v_mfma_f32_16x16x32_bf16 v[112:115], v[72:75], v[224:227], v[66:69]
    s_waitcnt vmcnt(2)
    v_lshlrev_b32_sdwa v104, 3, v122 dst_sel:DWORD dst_unused:UNUSED_PAD src0_sel:DWORD src1_sel:WORD_0
    v_lshlrev_b32_sdwa v106, 3, v122 dst_sel:DWORD dst_unused:UNUSED_PAD src0_sel:DWORD src1_sel:WORD_1
    ds_read_b64 v[104:105], v104
    ds_read_b64 v[106:107], v106
    v_mfma_f32_16x16x32_bf16 v[112:115], v[76:79], v[228:231], v[112:115]
    v_lshlrev_b32_sdwa v108, 3, v123 dst_sel:DWORD dst_unused:UNUSED_PAD src0_sel:DWORD src1_sel:WORD_0
    v_lshlrev_b32_sdwa v110, 3, v123 dst_sel:DWORD dst_unused:UNUSED_PAD src0_sel:DWORD src1_sel:WORD_1
    ds_read_b64 v[108:109], v108
    ds_read_b64 v[110:111], v110
    s_waitcnt lgkmcnt(9)
    v_add3_u32 v18, v18, v88, v90
    v_add3_u32 v19, v19, v89, v91
    v_add3_u32 v18, v18, v92, v94
    v_add3_u32 v19, v19, v93, v95
    v_mfma_f32_16x16x32_bf16 v[112:115], v[80:83], v[232:235], v[112:115]
    v_lshlrev_b32_sdwa v88, 3, v120 dst_sel:DWORD dst_unused:UNUSED_PAD src0_sel:DWORD src1_sel:WORD_0
    v_lshlrev_b32_sdwa v90, 3, v120 dst_sel:DWORD dst_unused:UNUSED_PAD src0_sel:DWORD src1_sel:WORD_1
    ds_read_b64 v[88:89], v88
    ds_read_b64 v[90:91], v90
    v_mfma_f32_16x16x32_bf16 v[112:115], v[84:87], v[236:239], v[112:115]
    v_lshlrev_b32_sdwa v92, 3, v121 dst_sel:DWORD dst_unused:UNUSED_PAD src0_sel:DWORD src1_sel:WORD_0
    v_lshlrev_b32_sdwa v94, 3, v121 dst_sel:DWORD dst_unused:UNUSED_PAD src0_sel:DWORD src1_sel:WORD_1
    ds_read_b64 v[92:93], v92
    ds_read_b64 v[94:95], v94
    buffer_load_dwordx4 v[120:123], v71, s[12:15], s20 offen offset:1024 sc1
    s_waitcnt lgkmcnt(8)
    v_add3_u32 v18, v18, v96, v98
    v_add3_u32 v19, v19, v97, v99
    v_add3_u32 v18, v18, v100, v102
    v_add3_u32 v19, v19, v101, v103
    v_perm_b32 v112, v113, v112, s23
    v_perm_b32 v113, v115, v114, s23
    ds_write_b64 v70, v[112:113] offset:768
    s_waitcnt vmcnt(2)
    v_lshlrev_b32_sdwa v96, 3, v126 dst_sel:DWORD dst_unused:UNUSED_PAD src0_sel:DWORD src1_sel:WORD_0
    v_lshlrev_b32_sdwa v98, 3, v126 dst_sel:DWORD dst_unused:UNUSED_PAD src0_sel:DWORD src1_sel:WORD_1
    ds_read_b64 v[96:97], v96
    ds_read_b64 v[98:99], v98
    v_lshlrev_b32_sdwa v100, 3, v127 dst_sel:DWORD dst_unused:UNUSED_PAD src0_sel:DWORD src1_sel:WORD_0
    v_lshlrev_b32_sdwa v102, 3, v127 dst_sel:DWORD dst_unused:UNUSED_PAD src0_sel:DWORD src1_sel:WORD_1
    ds_read_b64 v[100:101], v100
    ds_read_b64 v[102:103], v102
    s_waitcnt lgkmcnt(9)
    v_add3_u32 v20, v20, v104, v106
    v_add3_u32 v21, v21, v105, v107
    v_add3_u32 v20, v20, v108, v110
    v_add3_u32 v21, v21, v109, v111
    v_mfma_f32_16x16x32_bf16 v[112:115], v[72:75], v[240:243], v[66:69]
    buffer_load_dwordx4 v[72:75], v71, s[12:15], s21 offen offset:0
    v_lshlrev_b32_sdwa v104, 3, v124 dst_sel:DWORD dst_unused:UNUSED_PAD src0_sel:DWORD src1_sel:WORD_0
    v_lshlrev_b32_sdwa v106, 3, v124 dst_sel:DWORD dst_unused:UNUSED_PAD src0_sel:DWORD src1_sel:WORD_1
    ds_read_b64 v[104:105], v104
    ds_read_b64 v[106:107], v106
    v_mfma_f32_16x16x32_bf16 v[112:115], v[76:79], v[244:247], v[112:115]
    buffer_load_dwordx4 v[76:79], v71, s[12:15], s21 offen offset:1024
    v_lshlrev_b32_sdwa v108, 3, v125 dst_sel:DWORD dst_unused:UNUSED_PAD src0_sel:DWORD src1_sel:WORD_0
    v_lshlrev_b32_sdwa v110, 3, v125 dst_sel:DWORD dst_unused:UNUSED_PAD src0_sel:DWORD src1_sel:WORD_1
    ds_read_b64 v[108:109], v108
    ds_read_b64 v[110:111], v110
    buffer_load_dwordx4 v[124:127], v71, s[12:15], s20 offen offset:2048 sc1
    s_waitcnt lgkmcnt(9)
    v_add3_u32 v20, v20, v88, v90
    v_add3_u32 v21, v21, v89, v91
    v_add3_u32 v20, v20, v92, v94
    v_add3_u32 v21, v21, v93, v95
    v_mfma_f32_16x16x32_bf16 v[112:115], v[80:83], v[248:251], v[112:115]
    buffer_load_dwordx4 v[80:83], v71, s[12:15], s19 offen offset:0
    s_waitcnt vmcnt(5)
    v_lshlrev_b32_sdwa v88, 3, v118 dst_sel:DWORD dst_unused:UNUSED_PAD src0_sel:DWORD src1_sel:WORD_0
    v_lshlrev_b32_sdwa v90, 3, v118 dst_sel:DWORD dst_unused:UNUSED_PAD src0_sel:DWORD src1_sel:WORD_1
    ds_read_b64 v[88:89], v88
    ds_read_b64 v[90:91], v90
    v_mfma_f32_16x16x32_bf16 v[112:115], v[84:87], v[252:255], v[112:115]
    buffer_load_dwordx4 v[84:87], v71, s[12:15], s19 offen offset:1024
    s_add_u32 s21, s21, 4096
    s_add_u32 s19, s19, 4096
    v_lshlrev_b32_sdwa v92, 3, v119 dst_sel:DWORD dst_unused:UNUSED_PAD src0_sel:DWORD src1_sel:WORD_0
    v_lshlrev_b32_sdwa v94, 3, v119 dst_sel:DWORD dst_unused:UNUSED_PAD src0_sel:DWORD src1_sel:WORD_1
    ds_read_b64 v[92:93], v92
    ds_read_b64 v[94:95], v94
    s_waitcnt lgkmcnt(8)
    v_add3_u32 v22, v22, v96, v98
    v_add3_u32 v23, v23, v97, v99
    v_add3_u32 v22, v22, v100, v102
    v_add3_u32 v23, v23, v101, v103
    v_perm_b32 v112, v113, v112, s23
    v_perm_b32 v113, v115, v114, s23
    ds_write_b64 v70, v[112:113] offset:896
    s_setprio 1
    v_lshlrev_b32_sdwa v96, 3, v116 dst_sel:DWORD dst_unused:UNUSED_PAD src0_sel:DWORD src1_sel:WORD_0
    v_lshlrev_b32_sdwa v98, 3, v116 dst_sel:DWORD dst_unused:UNUSED_PAD src0_sel:DWORD src1_sel:WORD_1
    ds_read_b64 v[96:97], v96
    ds_read_b64 v[98:99], v98
    v_lshlrev_b32_sdwa v100, 3, v117 dst_sel:DWORD dst_unused:UNUSED_PAD src0_sel:DWORD src1_sel:WORD_0
    v_lshlrev_b32_sdwa v102, 3, v117 dst_sel:DWORD dst_unused:UNUSED_PAD src0_sel:DWORD src1_sel:WORD_1
    ds_read_b64 v[100:101], v100
    ds_read_b64 v[102:103], v102
    buffer_load_dwordx4 v[116:119], v71, s[12:15], s20 offen offset:3072 sc1
    s_waitcnt lgkmcnt(9)
    v_add3_u32 v22, v22, v104, v106
    v_add3_u32 v23, v23, v105, v107
    v_add3_u32 v22, v22, v108, v110
    v_add3_u32 v23, v23, v109, v111
    s_waitcnt vmcnt(6)
    v_lshlrev_b32_sdwa v104, 3, v122 dst_sel:DWORD dst_unused:UNUSED_PAD src0_sel:DWORD src1_sel:WORD_0
    v_lshlrev_b32_sdwa v106, 3, v122 dst_sel:DWORD dst_unused:UNUSED_PAD src0_sel:DWORD src1_sel:WORD_1
    ds_read_b64 v[104:105], v104
    ds_read_b64 v[106:107], v106
    v_lshlrev_b32_sdwa v108, 3, v123 dst_sel:DWORD dst_unused:UNUSED_PAD src0_sel:DWORD src1_sel:WORD_0
    v_lshlrev_b32_sdwa v110, 3, v123 dst_sel:DWORD dst_unused:UNUSED_PAD src0_sel:DWORD src1_sel:WORD_1
    ds_read_b64 v[108:109], v108
    ds_read_b64 v[110:111], v110
    s_waitcnt lgkmcnt(9)
    v_add3_u32 v24, v24, v88, v90
    v_add3_u32 v25, v25, v89, v91
    v_add3_u32 v24, v24, v92, v94
    v_add3_u32 v25, v25, v93, v95
    v_lshlrev_b32_sdwa v88, 3, v120 dst_sel:DWORD dst_unused:UNUSED_PAD src0_sel:DWORD src1_sel:WORD_0
    v_lshlrev_b32_sdwa v90, 3, v120 dst_sel:DWORD dst_unused:UNUSED_PAD src0_sel:DWORD src1_sel:WORD_1
    ds_read_b64 v[88:89], v88
    ds_read_b64 v[90:91], v90
    v_lshlrev_b32_sdwa v92, 3, v121 dst_sel:DWORD dst_unused:UNUSED_PAD src0_sel:DWORD src1_sel:WORD_0
    v_lshlrev_b32_sdwa v94, 3, v121 dst_sel:DWORD dst_unused:UNUSED_PAD src0_sel:DWORD src1_sel:WORD_1
    ds_read_b64 v[92:93], v92
    ds_read_b64 v[94:95], v94
    s_add_u32 s20, s20, 0x1d000
    buffer_load_dwordx4 v[120:123], v71, s[12:15], s20 offen offset:0 sc1
    s_waitcnt lgkmcnt(8)
    v_add3_u32 v24, v24, v96, v98
    v_add3_u32 v25, v25, v97, v99
    v_add3_u32 v24, v24, v100, v102
    v_add3_u32 v25, v25, v101, v103
    s_waitcnt vmcnt(4)
    v_lshlrev_b32_sdwa v96, 3, v126 dst_sel:DWORD dst_unused:UNUSED_PAD src0_sel:DWORD src1_sel:WORD_0
    v_lshlrev_b32_sdwa v98, 3, v126 dst_sel:DWORD dst_unused:UNUSED_PAD src0_sel:DWORD src1_sel:WORD_1
    ds_read_b64 v[96:97], v96
    ds_read_b64 v[98:99], v98
    v_lshlrev_b32_sdwa v100, 3, v127 dst_sel:DWORD dst_unused:UNUSED_PAD src0_sel:DWORD src1_sel:WORD_0
    v_lshlrev_b32_sdwa v102, 3, v127 dst_sel:DWORD dst_unused:UNUSED_PAD src0_sel:DWORD src1_sel:WORD_1
    ds_read_b64 v[100:101], v100
    ds_read_b64 v[102:103], v102
    s_waitcnt lgkmcnt(8)
    v_add3_u32 v26, v26, v104, v106
    v_add3_u32 v27, v27, v105, v107
    v_add3_u32 v26, v26, v108, v110
    v_add3_u32 v27, v27, v109, v111
    v_lshlrev_b32_sdwa v104, 3, v124 dst_sel:DWORD dst_unused:UNUSED_PAD src0_sel:DWORD src1_sel:WORD_0
    v_lshlrev_b32_sdwa v106, 3, v124 dst_sel:DWORD dst_unused:UNUSED_PAD src0_sel:DWORD src1_sel:WORD_1
    ds_read_b64 v[104:105], v104
    ds_read_b64 v[106:107], v106
    v_lshlrev_b32_sdwa v108, 3, v125 dst_sel:DWORD dst_unused:UNUSED_PAD src0_sel:DWORD src1_sel:WORD_0
    v_lshlrev_b32_sdwa v110, 3, v125 dst_sel:DWORD dst_unused:UNUSED_PAD src0_sel:DWORD src1_sel:WORD_1
    ds_read_b64 v[108:109], v108
    ds_read_b64 v[110:111], v110
    buffer_load_dwordx4 v[124:127], v71, s[12:15], s20 offen offset:1024 sc1
    s_waitcnt lgkmcnt(8)
    v_add3_u32 v26, v26, v88, v90
    v_add3_u32 v27, v27, v89, v91
    v_add3_u32 v26, v26, v92, v94
    v_add3_u32 v27, v27, v93, v95
    s_waitcnt vmcnt(2)
    v_lshlrev_b32_sdwa v88, 3, v118 dst_sel:DWORD dst_unused:UNUSED_PAD src0_sel:DWORD src1_sel:WORD_0
    v_lshlrev_b32_sdwa v90, 3, v118 dst_sel:DWORD dst_unused:UNUSED_PAD src0_sel:DWORD src1_sel:WORD_1
    ds_read_b64 v[88:89], v88
    ds_read_b64 v[90:91], v90
    v_lshlrev_b32_sdwa v92, 3, v119 dst_sel:DWORD dst_unused:UNUSED_PAD src0_sel:DWORD src1_sel:WORD_0
    v_lshlrev_b32_sdwa v94, 3, v119 dst_sel:DWORD dst_unused:UNUSED_PAD src0_sel:DWORD src1_sel:WORD_1
    ds_read_b64 v[92:93], v92
    ds_read_b64 v[94:95], v94
    s_waitcnt lgkmcnt(8)
    v_add3_u32 v28, v28, v96, v98
    v_add3_u32 v29, v29, v97, v99
    v_add3_u32 v28, v28, v100, v102
    v_add3_u32 v29, v29, v101, v103
    s_setprio 0
    v_lshlrev_b32_sdwa v96, 3, v116 dst_sel:DWORD dst_unused:UNUSED_PAD src0_sel:DWORD src1_sel:WORD_0
    v_lshlrev_b32_sdwa v98, 3, v116 dst_sel:DWORD dst_unused:UNUSED_PAD src0_sel:DWORD src1_sel:WORD_1
    ds_read_b64 v[96:97], v96
    ds_read_b64 v[98:99], v98
    v_lshlrev_b32_sdwa v100, 3, v117 dst_sel:DWORD dst_unused:UNUSED_PAD src0_sel:DWORD src1_sel:WORD_0
    v_lshlrev_b32_sdwa v102, 3, v117 dst_sel:DWORD dst_unused:UNUSED_PAD src0_sel:DWORD src1_sel:WORD_1
    ds_read_b64 v[100:101], v100
    ds_read_b64 v[102:103], v102
    buffer_load_dwordx4 v[116:119], v71, s[12:15], s20 offen offset:2048 sc1
    s_waitcnt lgkmcnt(8)
    v_add3_u32 v28, v28, v104, v106
    v_add3_u32 v29, v29, v105, v107
    v_add3_u32 v28, v28, v108, v110
    v_add3_u32 v29, v29, v109, v111
    s_waitcnt vmcnt(2)
    v_lshlrev_b32_sdwa v104, 3, v120 dst_sel:DWORD dst_unused:UNUSED_PAD src0_sel:DWORD src1_sel:WORD_0
    v_lshlrev_b32_sdwa v106, 3, v120 dst_sel:DWORD dst_unused:UNUSED_PAD src0_sel:DWORD src1_sel:WORD_1
    ds_read_b64 v[104:105], v104
    ds_read_b64 v[106:107], v106
    v_lshlrev_b32_sdwa v108, 3, v121 dst_sel:DWORD dst_unused:UNUSED_PAD src0_sel:DWORD src1_sel:WORD_0
    v_lshlrev_b32_sdwa v110, 3, v121 dst_sel:DWORD dst_unused:UNUSED_PAD src0_sel:DWORD src1_sel:WORD_1
    ds_read_b64 v[108:109], v108
    ds_read_b64 v[110:111], v110
    s_waitcnt lgkmcnt(8)
    v_add3_u32 v30, v30, v88, v90
    v_add3_u32 v31, v31, v89, v91
    v_add3_u32 v30, v30, v92, v94
    v_add3_u32 v31, v31, v93, v95
    s_barrier
    s_setprio 3
    v_lshlrev_b32_sdwa v88, 3, v122 dst_sel:DWORD dst_unused:UNUSED_PAD src0_sel:DWORD src1_sel:WORD_0
    v_lshlrev_b32_sdwa v90, 3, v122 dst_sel:DWORD dst_unused:UNUSED_PAD src0_sel:DWORD src1_sel:WORD_1
    ds_read_b64 v[88:89], v88
    ds_read_b64 v[90:91], v90
    v_lshlrev_b32_sdwa v92, 3, v123 dst_sel:DWORD dst_unused:UNUSED_PAD src0_sel:DWORD src1_sel:WORD_0
    v_lshlrev_b32_sdwa v94, 3, v123 dst_sel:DWORD dst_unused:UNUSED_PAD src0_sel:DWORD src1_sel:WORD_1
    ds_read_b64 v[92:93], v92
    ds_read_b64 v[94:95], v94
    buffer_load_dwordx4 v[120:123], v71, s[12:15], s20 offen offset:3072 sc1
    s_waitcnt lgkmcnt(8)
    v_add3_u32 v30, v30, v96, v98
    v_add3_u32 v31, v31, v97, v99
    v_add3_u32 v30, v30, v100, v102
    v_add3_u32 v31, v31, v101, v103
    v_mfma_f32_16x16x32_bf16 v[112:115], v[72:75], v[128:131], v[66:69]
    s_waitcnt vmcnt(2)
    v_lshlrev_b32_sdwa v96, 3, v124 dst_sel:DWORD dst_unused:UNUSED_PAD src0_sel:DWORD src1_sel:WORD_0
    v_lshlrev_b32_sdwa v98, 3, v124 dst_sel:DWORD dst_unused:UNUSED_PAD src0_sel:DWORD src1_sel:WORD_1
    ds_read_b64 v[96:97], v96
    ds_read_b64 v[98:99], v98
    v_mfma_f32_16x16x32_bf16 v[112:115], v[76:79], v[132:135], v[112:115]
    v_add_u32 v70, 0xfffe0000, v70
    v_lshlrev_b32_sdwa v100, 3, v125 dst_sel:DWORD dst_unused:UNUSED_PAD src0_sel:DWORD src1_sel:WORD_0
    v_lshlrev_b32_sdwa v102, 3, v125 dst_sel:DWORD dst_unused:UNUSED_PAD src0_sel:DWORD src1_sel:WORD_1
    ds_read_b64 v[100:101], v100
    ds_read_b64 v[102:103], v102
    s_waitcnt lgkmcnt(8)
    v_add3_u32 v32, v32, v104, v106
    v_add3_u32 v33, v33, v105, v107
    v_add3_u32 v32, v32, v108, v110
    v_add3_u32 v33, v33, v109, v111
    v_mfma_f32_16x16x32_bf16 v[112:115], v[80:83], v[136:139], v[112:115]
    v_lshlrev_b32_sdwa v104, 3, v126 dst_sel:DWORD dst_unused:UNUSED_PAD src0_sel:DWORD src1_sel:WORD_0
    v_lshlrev_b32_sdwa v106, 3, v126 dst_sel:DWORD dst_unused:UNUSED_PAD src0_sel:DWORD src1_sel:WORD_1
    ds_read_b64 v[104:105], v104
    ds_read_b64 v[106:107], v106
    v_mfma_f32_16x16x32_bf16 v[112:115], v[84:87], v[140:143], v[112:115]
    v_lshlrev_b32_sdwa v108, 3, v127 dst_sel:DWORD dst_unused:UNUSED_PAD src0_sel:DWORD src1_sel:WORD_0
    v_lshlrev_b32_sdwa v110, 3, v127 dst_sel:DWORD dst_unused:UNUSED_PAD src0_sel:DWORD src1_sel:WORD_1
    ds_read_b64 v[108:109], v108
    ds_read_b64 v[110:111], v110
    s_add_u32 s20, s20, 0x1000
    buffer_load_dwordx4 v[124:127], v71, s[12:15], s20 offen offset:0 sc1
    s_waitcnt lgkmcnt(8)
    v_add3_u32 v32, v32, v88, v90
    v_add3_u32 v33, v33, v89, v91
    v_add3_u32 v32, v32, v92, v94
    v_add3_u32 v33, v33, v93, v95
    v_perm_b32 v112, v113, v112, s23
    v_perm_b32 v113, v115, v114, s23
    ds_write_b64 v70, v[112:113] offset:0
    s_waitcnt vmcnt(2)
    v_lshlrev_b32_sdwa v88, 3, v116 dst_sel:DWORD dst_unused:UNUSED_PAD src0_sel:DWORD src1_sel:WORD_0
    v_lshlrev_b32_sdwa v90, 3, v116 dst_sel:DWORD dst_unused:UNUSED_PAD src0_sel:DWORD src1_sel:WORD_1
    ds_read_b64 v[88:89], v88
    ds_read_b64 v[90:91], v90
    v_lshlrev_b32_sdwa v92, 3, v117 dst_sel:DWORD dst_unused:UNUSED_PAD src0_sel:DWORD src1_sel:WORD_0
    v_lshlrev_b32_sdwa v94, 3, v117 dst_sel:DWORD dst_unused:UNUSED_PAD src0_sel:DWORD src1_sel:WORD_1
    ds_read_b64 v[92:93], v92
    ds_read_b64 v[94:95], v94
    s_waitcnt lgkmcnt(9)
    v_add3_u32 v34, v34, v96, v98
    v_add3_u32 v35, v35, v97, v99
    v_add3_u32 v34, v34, v100, v102
    v_add3_u32 v35, v35, v101, v103
    v_mfma_f32_16x16x32_bf16 v[112:115], v[72:75], v[144:147], v[66:69]
    v_lshlrev_b32_sdwa v96, 3, v118 dst_sel:DWORD dst_unused:UNUSED_PAD src0_sel:DWORD src1_sel:WORD_0
    v_lshlrev_b32_sdwa v98, 3, v118 dst_sel:DWORD dst_unused:UNUSED_PAD src0_sel:DWORD src1_sel:WORD_1
    ds_read_b64 v[96:97], v96
    ds_read_b64 v[98:99], v98
    v_mfma_f32_16x16x32_bf16 v[112:115], v[76:79], v[148:151], v[112:115]
    v_lshlrev_b32_sdwa v100, 3, v119 dst_sel:DWORD dst_unused:UNUSED_PAD src0_sel:DWORD src1_sel:WORD_0
    v_lshlrev_b32_sdwa v102, 3, v119 dst_sel:DWORD dst_unused:UNUSED_PAD src0_sel:DWORD src1_sel:WORD_1
    ds_read_b64 v[100:101], v100
    ds_read_b64 v[102:103], v102
    buffer_load_dwordx4 v[116:119], v71, s[12:15], s20 offen offset:1024 sc1
    s_waitcnt lgkmcnt(9)
    v_add3_u32 v34, v34, v104, v106
    v_add3_u32 v35, v35, v105, v107
    v_add3_u32 v34, v34, v108, v110
    v_add3_u32 v35, v35, v109, v111
    v_mfma_f32_16x16x32_bf16 v[112:115], v[80:83], v[152:155], v[112:115]
    s_waitcnt vmcnt(2)
    v_lshlrev_b32_sdwa v104, 3, v120 dst_sel:DWORD dst_unused:UNUSED_PAD src0_sel:DWORD src1_sel:WORD_0
    v_lshlrev_b32_sdwa v106, 3, v120 dst_sel:DWORD dst_unused:UNUSED_PAD src0_sel:DWORD src1_sel:WORD_1
    ds_read_b64 v[104:105], v104
    ds_read_b64 v[106:107], v106
    v_mfma_f32_16x16x32_bf16 v[112:115], v[84:87], v[156:159], v[112:115]
    v_lshlrev_b32_sdwa v108, 3, v121 dst_sel:DWORD dst_unused:UNUSED_PAD src0_sel:DWORD src1_sel:WORD_0
    v_lshlrev_b32_sdwa v110, 3, v121 dst_sel:DWORD dst_unused:UNUSED_PAD src0_sel:DWORD src1_sel:WORD_1
    ds_read_b64 v[108:109], v108
    ds_read_b64 v[110:111], v110
    s_waitcnt lgkmcnt(8)
    v_add3_u32 v36, v36, v88, v90
    v_add3_u32 v37, v37, v89, v91
    v_add3_u32 v36, v36, v92, v94
    v_add3_u32 v37, v37, v93, v95
    v_perm_b32 v112, v113, v112, s23
    v_perm_b32 v113, v115, v114, s23
    ds_write_b64 v70, v[112:113] offset:128
    v_lshlrev_b32_sdwa v88, 3, v122 dst_sel:DWORD dst_unused:UNUSED_PAD src0_sel:DWORD src1_sel:WORD_0
    v_lshlrev_b32_sdwa v90, 3, v122 dst_sel:DWORD dst_unused:UNUSED_PAD src0_sel:DWORD src1_sel:WORD_1
    ds_read_b64 v[88:89], v88
    ds_read_b64 v[90:91], v90
    v_lshlrev_b32_sdwa v92, 3, v123 dst_sel:DWORD dst_unused:UNUSED_PAD src0_sel:DWORD src1_sel:WORD_0
    v_lshlrev_b32_sdwa v94, 3, v123 dst_sel:DWORD dst_unused:UNUSED_PAD src0_sel:DWORD src1_sel:WORD_1
    ds_read_b64 v[92:93], v92
    ds_read_b64 v[94:95], v94
    buffer_load_dwordx4 v[120:123], v71, s[12:15], s20 offen offset:2048 sc1
    s_waitcnt lgkmcnt(9)
    v_add3_u32 v36, v36, v96, v98
    v_add3_u32 v37, v37, v97, v99
    v_add3_u32 v36, v36, v100, v102
    v_add3_u32 v37, v37, v101, v103
    v_mfma_f32_16x16x32_bf16 v[112:115], v[72:75], v[160:163], v[66:69]
    s_waitcnt vmcnt(2)
    v_lshlrev_b32_sdwa v96, 3, v124 dst_sel:DWORD dst_unused:UNUSED_PAD src0_sel:DWORD src1_sel:WORD_0
    v_lshlrev_b32_sdwa v98, 3, v124 dst_sel:DWORD dst_unused:UNUSED_PAD src0_sel:DWORD src1_sel:WORD_1
    ds_read_b64 v[96:97], v96
    ds_read_b64 v[98:99], v98
    v_mfma_f32_16x16x32_bf16 v[112:115], v[76:79], v[164:167], v[112:115]
    v_lshlrev_b32_sdwa v100, 3, v125 dst_sel:DWORD dst_unused:UNUSED_PAD src0_sel:DWORD src1_sel:WORD_0
    v_lshlrev_b32_sdwa v102, 3, v125 dst_sel:DWORD dst_unused:UNUSED_PAD src0_sel:DWORD src1_sel:WORD_1
    ds_read_b64 v[100:101], v100
    ds_read_b64 v[102:103], v102
    s_waitcnt lgkmcnt(9)
    v_add3_u32 v38, v38, v104, v106
    v_add3_u32 v39, v39, v105, v107
    v_add3_u32 v38, v38, v108, v110
    v_add3_u32 v39, v39, v109, v111
    v_mfma_f32_16x16x32_bf16 v[112:115], v[80:83], v[168:171], v[112:115]
    v_lshlrev_b32_sdwa v104, 3, v126 dst_sel:DWORD dst_unused:UNUSED_PAD src0_sel:DWORD src1_sel:WORD_0
    v_lshlrev_b32_sdwa v106, 3, v126 dst_sel:DWORD dst_unused:UNUSED_PAD src0_sel:DWORD src1_sel:WORD_1
    ds_read_b64 v[104:105], v104
    ds_read_b64 v[106:107], v106
    v_mfma_f32_16x16x32_bf16 v[112:115], v[84:87], v[172:175], v[112:115]
    v_lshlrev_b32_sdwa v108, 3, v127 dst_sel:DWORD dst_unused:UNUSED_PAD src0_sel:DWORD src1_sel:WORD_0
    v_lshlrev_b32_sdwa v110, 3, v127 dst_sel:DWORD dst_unused:UNUSED_PAD src0_sel:DWORD src1_sel:WORD_1
    ds_read_b64 v[108:109], v108
    ds_read_b64 v[110:111], v110
    buffer_load_dwordx4 v[124:127], v71, s[12:15], s20 offen offset:3072 sc1
    s_waitcnt lgkmcnt(8)
    v_add3_u32 v38, v38, v88, v90
    v_add3_u32 v39, v39, v89, v91
    v_add3_u32 v38, v38, v92, v94
    v_add3_u32 v39, v39, v93, v95
    v_perm_b32 v112, v113, v112, s23
    v_perm_b32 v113, v115, v114, s23
    ds_write_b64 v70, v[112:113] offset:256
    s_waitcnt vmcnt(2)
    v_lshlrev_b32_sdwa v88, 3, v116 dst_sel:DWORD dst_unused:UNUSED_PAD src0_sel:DWORD src1_sel:WORD_0
    v_lshlrev_b32_sdwa v90, 3, v116 dst_sel:DWORD dst_unused:UNUSED_PAD src0_sel:DWORD src1_sel:WORD_1
    ds_read_b64 v[88:89], v88
    ds_read_b64 v[90:91], v90
    v_lshlrev_b32_sdwa v92, 3, v117 dst_sel:DWORD dst_unused:UNUSED_PAD src0_sel:DWORD src1_sel:WORD_0
    v_lshlrev_b32_sdwa v94, 3, v117 dst_sel:DWORD dst_unused:UNUSED_PAD src0_sel:DWORD src1_sel:WORD_1
    ds_read_b64 v[92:93], v92
    ds_read_b64 v[94:95], v94
    s_waitcnt lgkmcnt(9)
    v_add3_u32 v40, v40, v96, v98
    v_add3_u32 v41, v41, v97, v99
    v_add3_u32 v40, v40, v100, v102
    v_add3_u32 v41, v41, v101, v103
    v_mfma_f32_16x16x32_bf16 v[112:115], v[72:75], v[176:179], v[66:69]
    v_lshlrev_b32_sdwa v96, 3, v118 dst_sel:DWORD dst_unused:UNUSED_PAD src0_sel:DWORD src1_sel:WORD_0
    v_lshlrev_b32_sdwa v98, 3, v118 dst_sel:DWORD dst_unused:UNUSED_PAD src0_sel:DWORD src1_sel:WORD_1
    ds_read_b64 v[96:97], v96
    ds_read_b64 v[98:99], v98
    v_mfma_f32_16x16x32_bf16 v[112:115], v[76:79], v[180:183], v[112:115]
    v_lshlrev_b32_sdwa v100, 3, v119 dst_sel:DWORD dst_unused:UNUSED_PAD src0_sel:DWORD src1_sel:WORD_0
    v_lshlrev_b32_sdwa v102, 3, v119 dst_sel:DWORD dst_unused:UNUSED_PAD src0_sel:DWORD src1_sel:WORD_1
    ds_read_b64 v[100:101], v100
    ds_read_b64 v[102:103], v102
    s_add_u32 s20, s20, 0x1000
    buffer_load_dwordx4 v[116:119], v71, s[12:15], s20 offen offset:0 sc1
    s_waitcnt lgkmcnt(9)
    v_add3_u32 v40, v40, v104, v106
    v_add3_u32 v41, v41, v105, v107
    v_add3_u32 v40, v40, v108, v110
    v_add3_u32 v41, v41, v109, v111
    v_mfma_f32_16x16x32_bf16 v[112:115], v[80:83], v[184:187], v[112:115]
    s_waitcnt vmcnt(2)
    v_lshlrev_b32_sdwa v104, 3, v120 dst_sel:DWORD dst_unused:UNUSED_PAD src0_sel:DWORD src1_sel:WORD_0
    v_lshlrev_b32_sdwa v106, 3, v120 dst_sel:DWORD dst_unused:UNUSED_PAD src0_sel:DWORD src1_sel:WORD_1
    ds_read_b64 v[104:105], v104
    ds_read_b64 v[106:107], v106
    v_mfma_f32_16x16x32_bf16 v[112:115], v[84:87], v[188:191], v[112:115]
    v_lshlrev_b32_sdwa v108, 3, v121 dst_sel:DWORD dst_unused:UNUSED_PAD src0_sel:DWORD src1_sel:WORD_0
    v_lshlrev_b32_sdwa v110, 3, v121 dst_sel:DWORD dst_unused:UNUSED_PAD src0_sel:DWORD src1_sel:WORD_1
    ds_read_b64 v[108:109], v108
    ds_read_b64 v[110:111], v110
    s_waitcnt lgkmcnt(8)
    v_add3_u32 v42, v42, v88, v90
    v_add3_u32 v43, v43, v89, v91
    v_add3_u32 v42, v42, v92, v94
    v_add3_u32 v43, v43, v93, v95
    v_perm_b32 v112, v113, v112, s23
    v_perm_b32 v113, v115, v114, s23
    ds_write_b64 v70, v[112:113] offset:384
    v_lshlrev_b32_sdwa v88, 3, v122 dst_sel:DWORD dst_unused:UNUSED_PAD src0_sel:DWORD src1_sel:WORD_0
    v_lshlrev_b32_sdwa v90, 3, v122 dst_sel:DWORD dst_unused:UNUSED_PAD src0_sel:DWORD src1_sel:WORD_1
    ds_read_b64 v[88:89], v88
    ds_read_b64 v[90:91], v90
    v_lshlrev_b32_sdwa v92, 3, v123 dst_sel:DWORD dst_unused:UNUSED_PAD src0_sel:DWORD src1_sel:WORD_0
    v_lshlrev_b32_sdwa v94, 3, v123 dst_sel:DWORD dst_unused:UNUSED_PAD src0_sel:DWORD src1_sel:WORD_1
    ds_read_b64 v[92:93], v92
    ds_read_b64 v[94:95], v94
    buffer_load_dwordx4 v[120:123], v71, s[12:15], s20 offen offset:1024 sc1
    s_waitcnt lgkmcnt(9)
    v_add3_u32 v42, v42, v96, v98
    v_add3_u32 v43, v43, v97, v99
    v_add3_u32 v42, v42, v100, v102
    v_add3_u32 v43, v43, v101, v103
    v_mfma_f32_16x16x32_bf16 v[112:115], v[72:75], v[192:195], v[66:69]
    s_waitcnt vmcnt(2)
    v_lshlrev_b32_sdwa v96, 3, v124 dst_sel:DWORD dst_unused:UNUSED_PAD src0_sel:DWORD src1_sel:WORD_0
    v_lshlrev_b32_sdwa v98, 3, v124 dst_sel:DWORD dst_unused:UNUSED_PAD src0_sel:DWORD src1_sel:WORD_1
    ds_read_b64 v[96:97], v96
    ds_read_b64 v[98:99], v98
    v_mfma_f32_16x16x32_bf16 v[112:115], v[76:79], v[196:199], v[112:115]
    v_lshlrev_b32_sdwa v100, 3, v125 dst_sel:DWORD dst_unused:UNUSED_PAD src0_sel:DWORD src1_sel:WORD_0
    v_lshlrev_b32_sdwa v102, 3, v125 dst_sel:DWORD dst_unused:UNUSED_PAD src0_sel:DWORD src1_sel:WORD_1
    ds_read_b64 v[100:101], v100
    ds_read_b64 v[102:103], v102
    s_waitcnt lgkmcnt(9)
    v_add3_u32 v44, v44, v104, v106
    v_add3_u32 v45, v45, v105, v107
    v_add3_u32 v44, v44, v108, v110
    v_add3_u32 v45, v45, v109, v111
    v_mfma_f32_16x16x32_bf16 v[112:115], v[80:83], v[200:203], v[112:115]
    v_lshlrev_b32_sdwa v104, 3, v126 dst_sel:DWORD dst_unused:UNUSED_PAD src0_sel:DWORD src1_sel:WORD_0
    v_lshlrev_b32_sdwa v106, 3, v126 dst_sel:DWORD dst_unused:UNUSED_PAD src0_sel:DWORD src1_sel:WORD_1
    ds_read_b64 v[104:105], v104
    ds_read_b64 v[106:107], v106
    v_mfma_f32_16x16x32_bf16 v[112:115], v[84:87], v[204:207], v[112:115]
    v_lshlrev_b32_sdwa v108, 3, v127 dst_sel:DWORD dst_unused:UNUSED_PAD src0_sel:DWORD src1_sel:WORD_0
    v_lshlrev_b32_sdwa v110, 3, v127 dst_sel:DWORD dst_unused:UNUSED_PAD src0_sel:DWORD src1_sel:WORD_1
    ds_read_b64 v[108:109], v108
    ds_read_b64 v[110:111], v110
    buffer_load_dwordx4 v[124:127], v71, s[12:15], s20 offen offset:2048 sc1
    s_waitcnt lgkmcnt(8)
    v_add3_u32 v44, v44, v88, v90
    v_add3_u32 v45, v45, v89, v91
    v_add3_u32 v44, v44, v92, v94
    v_add3_u32 v45, v45, v93, v95
    v_perm_b32 v112, v113, v112, s23
    v_perm_b32 v113, v115, v114, s23
    ds_write_b64 v70, v[112:113] offset:512
    s_waitcnt vmcnt(2)
    v_lshlrev_b32_sdwa v88, 3, v116 dst_sel:DWORD dst_unused:UNUSED_PAD src0_sel:DWORD src1_sel:WORD_0
    v_lshlrev_b32_sdwa v90, 3, v116 dst_sel:DWORD dst_unused:UNUSED_PAD src0_sel:DWORD src1_sel:WORD_1
    ds_read_b64 v[88:89], v88
    ds_read_b64 v[90:91], v90
    v_lshlrev_b32_sdwa v92, 3, v117 dst_sel:DWORD dst_unused:UNUSED_PAD src0_sel:DWORD src1_sel:WORD_0
    v_lshlrev_b32_sdwa v94, 3, v117 dst_sel:DWORD dst_unused:UNUSED_PAD src0_sel:DWORD src1_sel:WORD_1
    ds_read_b64 v[92:93], v92
    ds_read_b64 v[94:95], v94
    s_waitcnt lgkmcnt(9)
    v_add3_u32 v46, v46, v96, v98
    v_add3_u32 v47, v47, v97, v99
    v_add3_u32 v46, v46, v100, v102
    v_add3_u32 v47, v47, v101, v103
    s_setprio 2
    v_mfma_f32_16x16x32_bf16 v[112:115], v[72:75], v[208:211], v[66:69]
    v_lshlrev_b32_sdwa v96, 3, v118 dst_sel:DWORD dst_unused:UNUSED_PAD src0_sel:DWORD src1_sel:WORD_0
    v_lshlrev_b32_sdwa v98, 3, v118 dst_sel:DWORD dst_unused:UNUSED_PAD src0_sel:DWORD src1_sel:WORD_1
    ds_read_b64 v[96:97], v96
    ds_read_b64 v[98:99], v98
    v_mfma_f32_16x16x32_bf16 v[112:115], v[76:79], v[212:215], v[112:115]
    v_lshlrev_b32_sdwa v100, 3, v119 dst_sel:DWORD dst_unused:UNUSED_PAD src0_sel:DWORD src1_sel:WORD_0
    v_lshlrev_b32_sdwa v102, 3, v119 dst_sel:DWORD dst_unused:UNUSED_PAD src0_sel:DWORD src1_sel:WORD_1
    ds_read_b64 v[100:101], v100
    ds_read_b64 v[102:103], v102
    buffer_load_dwordx4 v[116:119], v71, s[12:15], s20 offen offset:3072 sc1
    s_waitcnt lgkmcnt(9)
    v_add3_u32 v46, v46, v104, v106
    v_add3_u32 v47, v47, v105, v107
    v_add3_u32 v46, v46, v108, v110
    v_add3_u32 v47, v47, v109, v111
    v_mfma_f32_16x16x32_bf16 v[112:115], v[80:83], v[216:219], v[112:115]
    s_waitcnt vmcnt(2)
    v_lshlrev_b32_sdwa v104, 3, v120 dst_sel:DWORD dst_unused:UNUSED_PAD src0_sel:DWORD src1_sel:WORD_0
    v_lshlrev_b32_sdwa v106, 3, v120 dst_sel:DWORD dst_unused:UNUSED_PAD src0_sel:DWORD src1_sel:WORD_1
    ds_read_b64 v[104:105], v104
    ds_read_b64 v[106:107], v106
    v_mfma_f32_16x16x32_bf16 v[112:115], v[84:87], v[220:223], v[112:115]
    v_lshlrev_b32_sdwa v108, 3, v121 dst_sel:DWORD dst_unused:UNUSED_PAD src0_sel:DWORD src1_sel:WORD_0
    v_lshlrev_b32_sdwa v110, 3, v121 dst_sel:DWORD dst_unused:UNUSED_PAD src0_sel:DWORD src1_sel:WORD_1
    ds_read_b64 v[108:109], v108
    ds_read_b64 v[110:111], v110
    s_waitcnt lgkmcnt(8)
    v_add3_u32 v48, v48, v88, v90
    v_add3_u32 v49, v49, v89, v91
    v_add3_u32 v48, v48, v92, v94
    v_add3_u32 v49, v49, v93, v95
    v_perm_b32 v112, v113, v112, s23
    v_perm_b32 v113, v115, v114, s23
    ds_write_b64 v70, v[112:113] offset:640
    v_lshlrev_b32_sdwa v88, 3, v122 dst_sel:DWORD dst_unused:UNUSED_PAD src0_sel:DWORD src1_sel:WORD_0
    v_lshlrev_b32_sdwa v90, 3, v122 dst_sel:DWORD dst_unused:UNUSED_PAD src0_sel:DWORD src1_sel:WORD_1
    ds_read_b64 v[88:89], v88
    ds_read_b64 v[90:91], v90
    v_lshlrev_b32_sdwa v92, 3, v123 dst_sel:DWORD dst_unused:UNUSED_PAD src0_sel:DWORD src1_sel:WORD_0
    v_lshlrev_b32_sdwa v94, 3, v123 dst_sel:DWORD dst_unused:UNUSED_PAD src0_sel:DWORD src1_sel:WORD_1
    ds_read_b64 v[92:93], v92
    ds_read_b64 v[94:95], v94
    s_add_u32 s20, s20, 0x1000
    buffer_load_dwordx4 v[120:123], v71, s[12:15], s20 offen offset:0 sc1
    s_waitcnt lgkmcnt(9)
    v_add3_u32 v48, v48, v96, v98
    v_add3_u32 v49, v49, v97, v99
    v_add3_u32 v48, v48, v100, v102
    v_add3_u32 v49, v49, v101, v103
    v_mfma_f32_16x16x32_bf16 v[112:115], v[72:75], v[224:227], v[66:69]
    s_waitcnt vmcnt(2)
    v_lshlrev_b32_sdwa v96, 3, v124 dst_sel:DWORD dst_unused:UNUSED_PAD src0_sel:DWORD src1_sel:WORD_0
    v_lshlrev_b32_sdwa v98, 3, v124 dst_sel:DWORD dst_unused:UNUSED_PAD src0_sel:DWORD src1_sel:WORD_1
    ds_read_b64 v[96:97], v96
    ds_read_b64 v[98:99], v98
    v_mfma_f32_16x16x32_bf16 v[112:115], v[76:79], v[228:231], v[112:115]
    v_lshlrev_b32_sdwa v100, 3, v125 dst_sel:DWORD dst_unused:UNUSED_PAD src0_sel:DWORD src1_sel:WORD_0
    v_lshlrev_b32_sdwa v102, 3, v125 dst_sel:DWORD dst_unused:UNUSED_PAD src0_sel:DWORD src1_sel:WORD_1
    ds_read_b64 v[100:101], v100
    ds_read_b64 v[102:103], v102
    s_waitcnt lgkmcnt(9)
    v_add3_u32 v50, v50, v104, v106
    v_add3_u32 v51, v51, v105, v107
    v_add3_u32 v50, v50, v108, v110
    v_add3_u32 v51, v51, v109, v111
    v_mfma_f32_16x16x32_bf16 v[112:115], v[80:83], v[232:235], v[112:115]
    v_lshlrev_b32_sdwa v104, 3, v126 dst_sel:DWORD dst_unused:UNUSED_PAD src0_sel:DWORD src1_sel:WORD_0
    v_lshlrev_b32_sdwa v106, 3, v126 dst_sel:DWORD dst_unused:UNUSED_PAD src0_sel:DWORD src1_sel:WORD_1
    ds_read_b64 v[104:105], v104
    ds_read_b64 v[106:107], v106
    v_mfma_f32_16x16x32_bf16 v[112:115], v[84:87], v[236:239], v[112:115]
    v_lshlrev_b32_sdwa v108, 3, v127 dst_sel:DWORD dst_unused:UNUSED_PAD src0_sel:DWORD src1_sel:WORD_0
    v_lshlrev_b32_sdwa v110, 3, v127 dst_sel:DWORD dst_unused:UNUSED_PAD src0_sel:DWORD src1_sel:WORD_1
    ds_read_b64 v[108:109], v108
    ds_read_b64 v[110:111], v110
    buffer_load_dwordx4 v[124:127], v71, s[12:15], s20 offen offset:1024 sc1
    s_waitcnt lgkmcnt(8)
    v_add3_u32 v50, v50, v88, v90
    v_add3_u32 v51, v51, v89, v91
    v_add3_u32 v50, v50, v92, v94
    v_add3_u32 v51, v51, v93, v95
    v_perm_b32 v112, v113, v112, s23
    v_perm_b32 v113, v115, v114, s23
    ds_write_b64 v70, v[112:113] offset:768
    s_waitcnt vmcnt(2)
    v_lshlrev_b32_sdwa v88, 3, v116 dst_sel:DWORD dst_unused:UNUSED_PAD src0_sel:DWORD src1_sel:WORD_0
    v_lshlrev_b32_sdwa v90, 3, v116 dst_sel:DWORD dst_unused:UNUSED_PAD src0_sel:DWORD src1_sel:WORD_1
    ds_read_b64 v[88:89], v88
    ds_read_b64 v[90:91], v90
    v_lshlrev_b32_sdwa v92, 3, v117 dst_sel:DWORD dst_unused:UNUSED_PAD src0_sel:DWORD src1_sel:WORD_0
    v_lshlrev_b32_sdwa v94, 3, v117 dst_sel:DWORD dst_unused:UNUSED_PAD src0_sel:DWORD src1_sel:WORD_1
    ds_read_b64 v[92:93], v92
    ds_read_b64 v[94:95], v94
    s_waitcnt lgkmcnt(9)
    v_add3_u32 v52, v52, v96, v98
    v_add3_u32 v53, v53, v97, v99
    v_add3_u32 v52, v52, v100, v102
    v_add3_u32 v53, v53, v101, v103
    v_mfma_f32_16x16x32_bf16 v[112:115], v[72:75], v[240:243], v[66:69]
    buffer_load_dwordx4 v[72:75], v71, s[12:15], s21 offen offset:0
    v_lshlrev_b32_sdwa v96, 3, v118 dst_sel:DWORD dst_unused:UNUSED_PAD src0_sel:DWORD src1_sel:WORD_0
    v_lshlrev_b32_sdwa v98, 3, v118 dst_sel:DWORD dst_unused:UNUSED_PAD src0_sel:DWORD src1_sel:WORD_1
    ds_read_b64 v[96:97], v96
    ds_read_b64 v[98:99], v98
    v_mfma_f32_16x16x32_bf16 v[112:115], v[76:79], v[244:247], v[112:115]
    buffer_load_dwordx4 v[76:79], v71, s[12:15], s21 offen offset:1024
    v_lshlrev_b32_sdwa v100, 3, v119 dst_sel:DWORD dst_unused:UNUSED_PAD src0_sel:DWORD src1_sel:WORD_0
    v_lshlrev_b32_sdwa v102, 3, v119 dst_sel:DWORD dst_unused:UNUSED_PAD src0_sel:DWORD src1_sel:WORD_1
    ds_read_b64 v[100:101], v100
    ds_read_b64 v[102:103], v102
    buffer_load_dwordx4 v[116:119], v71, s[12:15], s20 offen offset:2048 sc1
    s_waitcnt lgkmcnt(9)
    v_add3_u32 v52, v52, v104, v106
    v_add3_u32 v53, v53, v105, v107
    v_add3_u32 v52, v52, v108, v110
    v_add3_u32 v53, v53, v109, v111
    v_mfma_f32_16x16x32_bf16 v[112:115], v[80:83], v[248:251], v[112:115]
    buffer_load_dwordx4 v[80:83], v71, s[12:15], s19 offen offset:0
    s_waitcnt vmcnt(5)
    v_lshlrev_b32_sdwa v104, 3, v120 dst_sel:DWORD dst_unused:UNUSED_PAD src0_sel:DWORD src1_sel:WORD_0
    v_lshlrev_b32_sdwa v106, 3, v120 dst_sel:DWORD dst_unused:UNUSED_PAD src0_sel:DWORD src1_sel:WORD_1
    ds_read_b64 v[104:105], v104
    ds_read_b64 v[106:107], v106
    v_mfma_f32_16x16x32_bf16 v[112:115], v[84:87], v[252:255], v[112:115]
    buffer_load_dwordx4 v[84:87], v71, s[12:15], s19 offen offset:1024
    s_add_u32 s21, s21, 4096
    s_add_u32 s19, s19, 4096
    v_lshlrev_b32_sdwa v108, 3, v121 dst_sel:DWORD dst_unused:UNUSED_PAD src0_sel:DWORD src1_sel:WORD_0
    v_lshlrev_b32_sdwa v110, 3, v121 dst_sel:DWORD dst_unused:UNUSED_PAD src0_sel:DWORD src1_sel:WORD_1
    ds_read_b64 v[108:109], v108
    ds_read_b64 v[110:111], v110
    s_waitcnt lgkmcnt(8)
    v_add3_u32 v54, v54, v88, v90
    v_add3_u32 v55, v55, v89, v91
    v_add3_u32 v54, v54, v92, v94
    v_add3_u32 v55, v55, v93, v95
    v_perm_b32 v112, v113, v112, s23
    v_perm_b32 v113, v115, v114, s23
    ds_write_b64 v70, v[112:113] offset:896
    s_setprio 1
    v_lshlrev_b32_sdwa v88, 3, v122 dst_sel:DWORD dst_unused:UNUSED_PAD src0_sel:DWORD src1_sel:WORD_0
    v_lshlrev_b32_sdwa v90, 3, v122 dst_sel:DWORD dst_unused:UNUSED_PAD src0_sel:DWORD src1_sel:WORD_1
    ds_read_b64 v[88:89], v88
    ds_read_b64 v[90:91], v90
    v_lshlrev_b32_sdwa v92, 3, v123 dst_sel:DWORD dst_unused:UNUSED_PAD src0_sel:DWORD src1_sel:WORD_0
    v_lshlrev_b32_sdwa v94, 3, v123 dst_sel:DWORD dst_unused:UNUSED_PAD src0_sel:DWORD src1_sel:WORD_1
    ds_read_b64 v[92:93], v92
    ds_read_b64 v[94:95], v94
    buffer_load_dwordx4 v[120:123], v71, s[12:15], s20 offen offset:3072 sc1
    s_waitcnt lgkmcnt(9)
    v_add3_u32 v54, v54, v96, v98
    v_add3_u32 v55, v55, v97, v99
    v_add3_u32 v54, v54, v100, v102
    v_add3_u32 v55, v55, v101, v103
    s_waitcnt vmcnt(6)
    v_lshlrev_b32_sdwa v96, 3, v124 dst_sel:DWORD dst_unused:UNUSED_PAD src0_sel:DWORD src1_sel:WORD_0
    v_lshlrev_b32_sdwa v98, 3, v124 dst_sel:DWORD dst_unused:UNUSED_PAD src0_sel:DWORD src1_sel:WORD_1
    ds_read_b64 v[96:97], v96
    ds_read_b64 v[98:99], v98
    v_lshlrev_b32_sdwa v100, 3, v125 dst_sel:DWORD dst_unused:UNUSED_PAD src0_sel:DWORD src1_sel:WORD_0
    v_lshlrev_b32_sdwa v102, 3, v125 dst_sel:DWORD dst_unused:UNUSED_PAD src0_sel:DWORD src1_sel:WORD_1
    ds_read_b64 v[100:101], v100
    ds_read_b64 v[102:103], v102
    s_waitcnt lgkmcnt(9)
    v_add3_u32 v56, v56, v104, v106
    v_add3_u32 v57, v57, v105, v107
    v_add3_u32 v56, v56, v108, v110
    v_add3_u32 v57, v57, v109, v111
    v_lshlrev_b32_sdwa v104, 3, v126 dst_sel:DWORD dst_unused:UNUSED_PAD src0_sel:DWORD src1_sel:WORD_0
    v_lshlrev_b32_sdwa v106, 3, v126 dst_sel:DWORD dst_unused:UNUSED_PAD src0_sel:DWORD src1_sel:WORD_1
    ds_read_b64 v[104:105], v104
    ds_read_b64 v[106:107], v106
    v_lshlrev_b32_sdwa v108, 3, v127 dst_sel:DWORD dst_unused:UNUSED_PAD src0_sel:DWORD src1_sel:WORD_0
    v_lshlrev_b32_sdwa v110, 3, v127 dst_sel:DWORD dst_unused:UNUSED_PAD src0_sel:DWORD src1_sel:WORD_1
    ds_read_b64 v[108:109], v108
    ds_read_b64 v[110:111], v110
    s_add_u32 s20, s20, 0x1d000
    buffer_load_dwordx4 v[124:127], v71, s[12:15], s20 offen offset:0 sc1
    s_waitcnt lgkmcnt(8)
    v_add3_u32 v56, v56, v88, v90
    v_add3_u32 v57, v57, v89, v91
    v_add3_u32 v56, v56, v92, v94
    v_add3_u32 v57, v57, v93, v95
    s_waitcnt vmcnt(4)
    v_lshlrev_b32_sdwa v88, 3, v116 dst_sel:DWORD dst_unused:UNUSED_PAD src0_sel:DWORD src1_sel:WORD_0
    v_lshlrev_b32_sdwa v90, 3, v116 dst_sel:DWORD dst_unused:UNUSED_PAD src0_sel:DWORD src1_sel:WORD_1
    ds_read_b64 v[88:89], v88
    ds_read_b64 v[90:91], v90
    v_lshlrev_b32_sdwa v92, 3, v117 dst_sel:DWORD dst_unused:UNUSED_PAD src0_sel:DWORD src1_sel:WORD_0
    v_lshlrev_b32_sdwa v94, 3, v117 dst_sel:DWORD dst_unused:UNUSED_PAD src0_sel:DWORD src1_sel:WORD_1
    ds_read_b64 v[92:93], v92
    ds_read_b64 v[94:95], v94
    s_waitcnt lgkmcnt(8)
    v_add3_u32 v58, v58, v96, v98
    v_add3_u32 v59, v59, v97, v99
    v_add3_u32 v58, v58, v100, v102
    v_add3_u32 v59, v59, v101, v103
    v_lshlrev_b32_sdwa v96, 3, v118 dst_sel:DWORD dst_unused:UNUSED_PAD src0_sel:DWORD src1_sel:WORD_0
    v_lshlrev_b32_sdwa v98, 3, v118 dst_sel:DWORD dst_unused:UNUSED_PAD src0_sel:DWORD src1_sel:WORD_1
    ds_read_b64 v[96:97], v96
    ds_read_b64 v[98:99], v98
    v_lshlrev_b32_sdwa v100, 3, v119 dst_sel:DWORD dst_unused:UNUSED_PAD src0_sel:DWORD src1_sel:WORD_0
    v_lshlrev_b32_sdwa v102, 3, v119 dst_sel:DWORD dst_unused:UNUSED_PAD src0_sel:DWORD src1_sel:WORD_1
    ds_read_b64 v[100:101], v100
    ds_read_b64 v[102:103], v102
    buffer_load_dwordx4 v[116:119], v71, s[12:15], s20 offen offset:1024 sc1
    s_waitcnt lgkmcnt(8)
    v_add3_u32 v58, v58, v104, v106
    v_add3_u32 v59, v59, v105, v107
    v_add3_u32 v58, v58, v108, v110
    v_add3_u32 v59, v59, v109, v111
    s_waitcnt vmcnt(2)
    v_lshlrev_b32_sdwa v104, 3, v120 dst_sel:DWORD dst_unused:UNUSED_PAD src0_sel:DWORD src1_sel:WORD_0
    v_lshlrev_b32_sdwa v106, 3, v120 dst_sel:DWORD dst_unused:UNUSED_PAD src0_sel:DWORD src1_sel:WORD_1
    ds_read_b64 v[104:105], v104
    ds_read_b64 v[106:107], v106
    v_lshlrev_b32_sdwa v108, 3, v121 dst_sel:DWORD dst_unused:UNUSED_PAD src0_sel:DWORD src1_sel:WORD_0
    v_lshlrev_b32_sdwa v110, 3, v121 dst_sel:DWORD dst_unused:UNUSED_PAD src0_sel:DWORD src1_sel:WORD_1
    ds_read_b64 v[108:109], v108
    ds_read_b64 v[110:111], v110
    s_waitcnt lgkmcnt(8)
    v_add3_u32 v60, v60, v88, v90
    v_add3_u32 v61, v61, v89, v91
    v_add3_u32 v60, v60, v92, v94
    v_add3_u32 v61, v61, v93, v95
    s_setprio 0
    v_lshlrev_b32_sdwa v88, 3, v122 dst_sel:DWORD dst_unused:UNUSED_PAD src0_sel:DWORD src1_sel:WORD_0
    v_lshlrev_b32_sdwa v90, 3, v122 dst_sel:DWORD dst_unused:UNUSED_PAD src0_sel:DWORD src1_sel:WORD_1
    ds_read_b64 v[88:89], v88
    ds_read_b64 v[90:91], v90
    v_lshlrev_b32_sdwa v92, 3, v123 dst_sel:DWORD dst_unused:UNUSED_PAD src0_sel:DWORD src1_sel:WORD_0
    v_lshlrev_b32_sdwa v94, 3, v123 dst_sel:DWORD dst_unused:UNUSED_PAD src0_sel:DWORD src1_sel:WORD_1
    ds_read_b64 v[92:93], v92
    ds_read_b64 v[94:95], v94
    buffer_load_dwordx4 v[120:123], v71, s[12:15], s20 offen offset:2048 sc1
    s_waitcnt lgkmcnt(8)
    v_add3_u32 v60, v60, v96, v98
    v_add3_u32 v61, v61, v97, v99
    v_add3_u32 v60, v60, v100, v102
    v_add3_u32 v61, v61, v101, v103
    s_waitcnt vmcnt(2)
    v_lshlrev_b32_sdwa v96, 3, v126 dst_sel:DWORD dst_unused:UNUSED_PAD src0_sel:DWORD src1_sel:WORD_0
    v_lshlrev_b32_sdwa v98, 3, v126 dst_sel:DWORD dst_unused:UNUSED_PAD src0_sel:DWORD src1_sel:WORD_1
    ds_read_b64 v[96:97], v96
    ds_read_b64 v[98:99], v98
    v_lshlrev_b32_sdwa v100, 3, v127 dst_sel:DWORD dst_unused:UNUSED_PAD src0_sel:DWORD src1_sel:WORD_0
    v_lshlrev_b32_sdwa v102, 3, v127 dst_sel:DWORD dst_unused:UNUSED_PAD src0_sel:DWORD src1_sel:WORD_1
    ds_read_b64 v[100:101], v100
    ds_read_b64 v[102:103], v102
    s_waitcnt lgkmcnt(8)
    v_add3_u32 v62, v62, v104, v106
    v_add3_u32 v63, v63, v105, v107
    v_add3_u32 v62, v62, v108, v110
    v_add3_u32 v63, v63, v109, v111
    s_barrier
    s_setprio 3
    v_lshlrev_b32_sdwa v104, 3, v124 dst_sel:DWORD dst_unused:UNUSED_PAD src0_sel:DWORD src1_sel:WORD_0
    v_lshlrev_b32_sdwa v106, 3, v124 dst_sel:DWORD dst_unused:UNUSED_PAD src0_sel:DWORD src1_sel:WORD_1
    ds_read_b64 v[104:105], v104
    ds_read_b64 v[106:107], v106
    v_lshlrev_b32_sdwa v108, 3, v125 dst_sel:DWORD dst_unused:UNUSED_PAD src0_sel:DWORD src1_sel:WORD_0
    v_lshlrev_b32_sdwa v110, 3, v125 dst_sel:DWORD dst_unused:UNUSED_PAD src0_sel:DWORD src1_sel:WORD_1
    ds_read_b64 v[108:109], v108
    ds_read_b64 v[110:111], v110
    buffer_load_dwordx4 v[124:127], v71, s[12:15], s20 offen offset:3072 sc1
    s_waitcnt lgkmcnt(8)
    v_add3_u32 v62, v62, v88, v90
    v_add3_u32 v63, v63, v89, v91
    v_add3_u32 v62, v62, v92, v94
    v_add3_u32 v63, v63, v93, v95
    v_mfma_f32_16x16x32_bf16 v[112:115], v[72:75], v[128:131], v[66:69]
    s_waitcnt vmcnt(2)
    v_lshlrev_b32_sdwa v88, 3, v118 dst_sel:DWORD dst_unused:UNUSED_PAD src0_sel:DWORD src1_sel:WORD_0
    v_lshlrev_b32_sdwa v90, 3, v118 dst_sel:DWORD dst_unused:UNUSED_PAD src0_sel:DWORD src1_sel:WORD_1
    ds_read_b64 v[88:89], v88
    ds_read_b64 v[90:91], v90
    v_mfma_f32_16x16x32_bf16 v[112:115], v[76:79], v[132:135], v[112:115]
    v_lshlrev_b32_sdwa v92, 3, v119 dst_sel:DWORD dst_unused:UNUSED_PAD src0_sel:DWORD src1_sel:WORD_0
    v_lshlrev_b32_sdwa v94, 3, v119 dst_sel:DWORD dst_unused:UNUSED_PAD src0_sel:DWORD src1_sel:WORD_1
    ds_read_b64 v[92:93], v92
    ds_read_b64 v[94:95], v94
    s_waitcnt lgkmcnt(8)
    v_add3_u32 v0, v0, v96, v98
    v_add3_u32 v1, v1, v97, v99
    v_add3_u32 v0, v0, v100, v102
    v_add3_u32 v1, v1, v101, v103
    v_mfma_f32_16x16x32_bf16 v[112:115], v[80:83], v[136:139], v[112:115]
    v_lshlrev_b32_sdwa v96, 3, v116 dst_sel:DWORD dst_unused:UNUSED_PAD src0_sel:DWORD src1_sel:WORD_0
    v_lshlrev_b32_sdwa v98, 3, v116 dst_sel:DWORD dst_unused:UNUSED_PAD src0_sel:DWORD src1_sel:WORD_1
    ds_read_b64 v[96:97], v96
    ds_read_b64 v[98:99], v98
    v_mfma_f32_16x16x32_bf16 v[112:115], v[84:87], v[140:143], v[112:115]
    v_lshlrev_b32_sdwa v100, 3, v117 dst_sel:DWORD dst_unused:UNUSED_PAD src0_sel:DWORD src1_sel:WORD_0
    v_lshlrev_b32_sdwa v102, 3, v117 dst_sel:DWORD dst_unused:UNUSED_PAD src0_sel:DWORD src1_sel:WORD_1
    ds_read_b64 v[100:101], v100
    ds_read_b64 v[102:103], v102
    s_add_u32 s20, s20, 0x1000
    buffer_load_dwordx4 v[116:119], v71, s[12:15], s20 offen offset:0 sc1
    s_waitcnt lgkmcnt(8)
    v_add3_u32 v0, v0, v104, v106
    v_add3_u32 v1, v1, v105, v107
    v_add3_u32 v0, v0, v108, v110
    v_add3_u32 v1, v1, v109, v111
    v_perm_b32 v112, v113, v112, s23
    v_perm_b32 v113, v115, v114, s23
    ds_write_b64 v70, v[112:113] offset:32768
    s_waitcnt vmcnt(2)
    v_lshlrev_b32_sdwa v104, 3, v122 dst_sel:DWORD dst_unused:UNUSED_PAD src0_sel:DWORD src1_sel:WORD_0
    v_lshlrev_b32_sdwa v106, 3, v122 dst_sel:DWORD dst_unused:UNUSED_PAD src0_sel:DWORD src1_sel:WORD_1
    ds_read_b64 v[104:105], v104
    ds_read_b64 v[106:107], v106
    v_lshlrev_b32_sdwa v108, 3, v123 dst_sel:DWORD dst_unused:UNUSED_PAD src0_sel:DWORD src1_sel:WORD_0
    v_lshlrev_b32_sdwa v110, 3, v123 dst_sel:DWORD dst_unused:UNUSED_PAD src0_sel:DWORD src1_sel:WORD_1
    ds_read_b64 v[108:109], v108
    ds_read_b64 v[110:111], v110
    s_waitcnt lgkmcnt(9)
    v_add3_u32 v2, v2, v88, v90
    v_add3_u32 v3, v3, v89, v91
    v_add3_u32 v2, v2, v92, v94
    v_add3_u32 v3, v3, v93, v95
    v_mfma_f32_16x16x32_bf16 v[112:115], v[72:75], v[144:147], v[66:69]
    v_lshlrev_b32_sdwa v88, 3, v120 dst_sel:DWORD dst_unused:UNUSED_PAD src0_sel:DWORD src1_sel:WORD_0
    v_lshlrev_b32_sdwa v90, 3, v120 dst_sel:DWORD dst_unused:UNUSED_PAD src0_sel:DWORD src1_sel:WORD_1
    ds_read_b64 v[88:89], v88
    ds_read_b64 v[90:91], v90
    v_mfma_f32_16x16x32_bf16 v[112:115], v[76:79], v[148:151], v[112:115]
    v_lshlrev_b32_sdwa v92, 3, v121 dst_sel:DWORD dst_unused:UNUSED_PAD src0_sel:DWORD src1_sel:WORD_0
    v_lshlrev_b32_sdwa v94, 3, v121 dst_sel:DWORD dst_unused:UNUSED_PAD src0_sel:DWORD src1_sel:WORD_1
    ds_read_b64 v[92:93], v92
    ds_read_b64 v[94:95], v94
    buffer_load_dwordx4 v[120:123], v71, s[12:15], s20 offen offset:1024 sc1
    s_waitcnt lgkmcnt(9)
    v_add3_u32 v2, v2, v96, v98
    v_add3_u32 v3, v3, v97, v99
    v_add3_u32 v2, v2, v100, v102
    v_add3_u32 v3, v3, v101, v103
    v_mfma_f32_16x16x32_bf16 v[112:115], v[80:83], v[152:155], v[112:115]
    s_waitcnt vmcnt(2)
    v_lshlrev_b32_sdwa v96, 3, v126 dst_sel:DWORD dst_unused:UNUSED_PAD src0_sel:DWORD src1_sel:WORD_0
    v_lshlrev_b32_sdwa v98, 3, v126 dst_sel:DWORD dst_unused:UNUSED_PAD src0_sel:DWORD src1_sel:WORD_1
    ds_read_b64 v[96:97], v96
    ds_read_b64 v[98:99], v98
    v_mfma_f32_16x16x32_bf16 v[112:115], v[84:87], v[156:159], v[112:115]
    v_lshlrev_b32_sdwa v100, 3, v127 dst_sel:DWORD dst_unused:UNUSED_PAD src0_sel:DWORD src1_sel:WORD_0
    v_lshlrev_b32_sdwa v102, 3, v127 dst_sel:DWORD dst_unused:UNUSED_PAD src0_sel:DWORD src1_sel:WORD_1
    ds_read_b64 v[100:101], v100
    ds_read_b64 v[102:103], v102
    s_waitcnt lgkmcnt(8)
    v_add3_u32 v4, v4, v104, v106
    v_add3_u32 v5, v5, v105, v107
    v_add3_u32 v4, v4, v108, v110
    v_add3_u32 v5, v5, v109, v111
    v_perm_b32 v112, v113, v112, s23
    v_perm_b32 v113, v115, v114, s23
    ds_write_b64 v70, v[112:113] offset:32896
    v_lshlrev_b32_sdwa v104, 3, v124 dst_sel:DWORD dst_unused:UNUSED_PAD src0_sel:DWORD src1_sel:WORD_0
    v_lshlrev_b32_sdwa v106, 3, v124 dst_sel:DWORD dst_unused:UNUSED_PAD src0_sel:DWORD src1_sel:WORD_1
    ds_read_b64 v[104:105], v104
    ds_read_b64 v[106:107], v106
    v_lshlrev_b32_sdwa v108, 3, v125 dst_sel:DWORD dst_unused:UNUSED_PAD src0_sel:DWORD src1_sel:WORD_0
    v_lshlrev_b32_sdwa v110, 3, v125 dst_sel:DWORD dst_unused:UNUSED_PAD src0_sel:DWORD src1_sel:WORD_1
    ds_read_b64 v[108:109], v108
    ds_read_b64 v[110:111], v110
    buffer_load_dwordx4 v[124:127], v71, s[12:15], s20 offen offset:2048 sc1
    s_waitcnt lgkmcnt(9)
    v_add3_u32 v4, v4, v88, v90
    v_add3_u32 v5, v5, v89, v91
    v_add3_u32 v4, v4, v92, v94
    v_add3_u32 v5, v5, v93, v95
    v_mfma_f32_16x16x32_bf16 v[112:115], v[72:75], v[160:163], v[66:69]
    s_waitcnt vmcnt(2)
    v_lshlrev_b32_sdwa v88, 3, v118 dst_sel:DWORD dst_unused:UNUSED_PAD src0_sel:DWORD src1_sel:WORD_0
    v_lshlrev_b32_sdwa v90, 3, v118 dst_sel:DWORD dst_unused:UNUSED_PAD src0_sel:DWORD src1_sel:WORD_1
    ds_read_b64 v[88:89], v88
    ds_read_b64 v[90:91], v90
    v_mfma_f32_16x16x32_bf16 v[112:115], v[76:79], v[164:167], v[112:115]
    v_lshlrev_b32_sdwa v92, 3, v119 dst_sel:DWORD dst_unused:UNUSED_PAD src0_sel:DWORD src1_sel:WORD_0
    v_lshlrev_b32_sdwa v94, 3, v119 dst_sel:DWORD dst_unused:UNUSED_PAD src0_sel:DWORD src1_sel:WORD_1
    ds_read_b64 v[92:93], v92
    ds_read_b64 v[94:95], v94
    s_waitcnt lgkmcnt(9)
    v_add3_u32 v6, v6, v96, v98
    v_add3_u32 v7, v7, v97, v99
    v_add3_u32 v6, v6, v100, v102
    v_add3_u32 v7, v7, v101, v103
    v_mfma_f32_16x16x32_bf16 v[112:115], v[80:83], v[168:171], v[112:115]
    v_lshlrev_b32_sdwa v96, 3, v116 dst_sel:DWORD dst_unused:UNUSED_PAD src0_sel:DWORD src1_sel:WORD_0
    v_lshlrev_b32_sdwa v98, 3, v116 dst_sel:DWORD dst_unused:UNUSED_PAD src0_sel:DWORD src1_sel:WORD_1
    ds_read_b64 v[96:97], v96
    ds_read_b64 v[98:99], v98
    v_mfma_f32_16x16x32_bf16 v[112:115], v[84:87], v[172:175], v[112:115]
    v_lshlrev_b32_sdwa v100, 3, v117 dst_sel:DWORD dst_unused:UNUSED_PAD src0_sel:DWORD src1_sel:WORD_0
    v_lshlrev_b32_sdwa v102, 3, v117 dst_sel:DWORD dst_unused:UNUSED_PAD src0_sel:DWORD src1_sel:WORD_1
    ds_read_b64 v[100:101], v100
    ds_read_b64 v[102:103], v102
    buffer_load_dwordx4 v[116:119], v71, s[12:15], s20 offen offset:3072 sc1
    s_waitcnt lgkmcnt(8)
    v_add3_u32 v6, v6, v104, v106
    v_add3_u32 v7, v7, v105, v107
    v_add3_u32 v6, v6, v108, v110
    v_add3_u32 v7, v7, v109, v111
    v_perm_b32 v112, v113, v112, s23
    v_perm_b32 v113, v115, v114, s23
    ds_write_b64 v70, v[112:113] offset:33024
    s_waitcnt vmcnt(2)
    v_lshlrev_b32_sdwa v104, 3, v122 dst_sel:DWORD dst_unused:UNUSED_PAD src0_sel:DWORD src1_sel:WORD_0
    v_lshlrev_b32_sdwa v106, 3, v122 dst_sel:DWORD dst_unused:UNUSED_PAD src0_sel:DWORD src1_sel:WORD_1
    ds_read_b64 v[104:105], v104
    ds_read_b64 v[106:107], v106
    v_lshlrev_b32_sdwa v108, 3, v123 dst_sel:DWORD dst_unused:UNUSED_PAD src0_sel:DWORD src1_sel:WORD_0
    v_lshlrev_b32_sdwa v110, 3, v123 dst_sel:DWORD dst_unused:UNUSED_PAD src0_sel:DWORD src1_sel:WORD_1
    ds_read_b64 v[108:109], v108
    ds_read_b64 v[110:111], v110
    s_waitcnt lgkmcnt(9)
    v_add3_u32 v8, v8, v88, v90
    v_add3_u32 v9, v9, v89, v91
    v_add3_u32 v8, v8, v92, v94
    v_add3_u32 v9, v9, v93, v95
    v_mfma_f32_16x16x32_bf16 v[112:115], v[72:75], v[176:179], v[66:69]
    v_lshlrev_b32_sdwa v88, 3, v120 dst_sel:DWORD dst_unused:UNUSED_PAD src0_sel:DWORD src1_sel:WORD_0
    v_lshlrev_b32_sdwa v90, 3, v120 dst_sel:DWORD dst_unused:UNUSED_PAD src0_sel:DWORD src1_sel:WORD_1
    ds_read_b64 v[88:89], v88
    ds_read_b64 v[90:91], v90
    v_mfma_f32_16x16x32_bf16 v[112:115], v[76:79], v[180:183], v[112:115]
    v_lshlrev_b32_sdwa v92, 3, v121 dst_sel:DWORD dst_unused:UNUSED_PAD src0_sel:DWORD src1_sel:WORD_0
    v_lshlrev_b32_sdwa v94, 3, v121 dst_sel:DWORD dst_unused:UNUSED_PAD src0_sel:DWORD src1_sel:WORD_1
    ds_read_b64 v[92:93], v92
    ds_read_b64 v[94:95], v94
    s_add_u32 s20, s20, 0x1000
    buffer_load_dwordx4 v[120:123], v71, s[12:15], s20 offen offset:0 sc1
    s_waitcnt lgkmcnt(9)
    v_add3_u32 v8, v8, v96, v98
    v_add3_u32 v9, v9, v97, v99
    v_add3_u32 v8, v8, v100, v102
    v_add3_u32 v9, v9, v101, v103
    v_mfma_f32_16x16x32_bf16 v[112:115], v[80:83], v[184:187], v[112:115]
    s_waitcnt vmcnt(2)
    v_lshlrev_b32_sdwa v96, 3, v126 dst_sel:DWORD dst_unused:UNUSED_PAD src0_sel:DWORD src1_sel:WORD_0
    v_lshlrev_b32_sdwa v98, 3, v126 dst_sel:DWORD dst_unused:UNUSED_PAD src0_sel:DWORD src1_sel:WORD_1
    ds_read_b64 v[96:97], v96
    ds_read_b64 v[98:99], v98
    v_mfma_f32_16x16x32_bf16 v[112:115], v[84:87], v[188:191], v[112:115]
    v_lshlrev_b32_sdwa v100, 3, v127 dst_sel:DWORD dst_unused:UNUSED_PAD src0_sel:DWORD src1_sel:WORD_0
    v_lshlrev_b32_sdwa v102, 3, v127 dst_sel:DWORD dst_unused:UNUSED_PAD src0_sel:DWORD src1_sel:WORD_1
    ds_read_b64 v[100:101], v100
    ds_read_b64 v[102:103], v102
    s_waitcnt lgkmcnt(8)
    v_add3_u32 v10, v10, v104, v106
    v_add3_u32 v11, v11, v105, v107
    v_add3_u32 v10, v10, v108, v110
    v_add3_u32 v11, v11, v109, v111
    v_perm_b32 v112, v113, v112, s23
    v_perm_b32 v113, v115, v114, s23
    ds_write_b64 v70, v[112:113] offset:33152
    v_lshlrev_b32_sdwa v104, 3, v124 dst_sel:DWORD dst_unused:UNUSED_PAD src0_sel:DWORD src1_sel:WORD_0
    v_lshlrev_b32_sdwa v106, 3, v124 dst_sel:DWORD dst_unused:UNUSED_PAD src0_sel:DWORD src1_sel:WORD_1
    ds_read_b64 v[104:105], v104
    ds_read_b64 v[106:107], v106
    v_lshlrev_b32_sdwa v108, 3, v125 dst_sel:DWORD dst_unused:UNUSED_PAD src0_sel:DWORD src1_sel:WORD_0
    v_lshlrev_b32_sdwa v110, 3, v125 dst_sel:DWORD dst_unused:UNUSED_PAD src0_sel:DWORD src1_sel:WORD_1
    ds_read_b64 v[108:109], v108
    ds_read_b64 v[110:111], v110
    buffer_load_dwordx4 v[124:127], v71, s[12:15], s20 offen offset:1024 sc1
    s_waitcnt lgkmcnt(9)
    v_add3_u32 v10, v10, v88, v90
    v_add3_u32 v11, v11, v89, v91
    v_add3_u32 v10, v10, v92, v94
    v_add3_u32 v11, v11, v93, v95
    v_mfma_f32_16x16x32_bf16 v[112:115], v[72:75], v[192:195], v[66:69]
    s_waitcnt vmcnt(2)
    v_lshlrev_b32_sdwa v88, 3, v118 dst_sel:DWORD dst_unused:UNUSED_PAD src0_sel:DWORD src1_sel:WORD_0
    v_lshlrev_b32_sdwa v90, 3, v118 dst_sel:DWORD dst_unused:UNUSED_PAD src0_sel:DWORD src1_sel:WORD_1
    ds_read_b64 v[88:89], v88
    ds_read_b64 v[90:91], v90
    v_mfma_f32_16x16x32_bf16 v[112:115], v[76:79], v[196:199], v[112:115]
    v_lshlrev_b32_sdwa v92, 3, v119 dst_sel:DWORD dst_unused:UNUSED_PAD src0_sel:DWORD src1_sel:WORD_0
    v_lshlrev_b32_sdwa v94, 3, v119 dst_sel:DWORD dst_unused:UNUSED_PAD src0_sel:DWORD src1_sel:WORD_1
    ds_read_b64 v[92:93], v92
    ds_read_b64 v[94:95], v94
    s_waitcnt lgkmcnt(9)
    v_add3_u32 v12, v12, v96, v98
    v_add3_u32 v13, v13, v97, v99
    v_add3_u32 v12, v12, v100, v102
    v_add3_u32 v13, v13, v101, v103
    v_mfma_f32_16x16x32_bf16 v[112:115], v[80:83], v[200:203], v[112:115]
    v_lshlrev_b32_sdwa v96, 3, v116 dst_sel:DWORD dst_unused:UNUSED_PAD src0_sel:DWORD src1_sel:WORD_0
    v_lshlrev_b32_sdwa v98, 3, v116 dst_sel:DWORD dst_unused:UNUSED_PAD src0_sel:DWORD src1_sel:WORD_1
    ds_read_b64 v[96:97], v96
    ds_read_b64 v[98:99], v98
    v_mfma_f32_16x16x32_bf16 v[112:115], v[84:87], v[204:207], v[112:115]
    v_lshlrev_b32_sdwa v100, 3, v117 dst_sel:DWORD dst_unused:UNUSED_PAD src0_sel:DWORD src1_sel:WORD_0
    v_lshlrev_b32_sdwa v102, 3, v117 dst_sel:DWORD dst_unused:UNUSED_PAD src0_sel:DWORD src1_sel:WORD_1
    ds_read_b64 v[100:101], v100
    ds_read_b64 v[102:103], v102
    buffer_load_dwordx4 v[116:119], v71, s[12:15], s20 offen offset:2048 sc1
    s_waitcnt lgkmcnt(8)
    v_add3_u32 v12, v12, v104, v106
    v_add3_u32 v13, v13, v105, v107
    v_add3_u32 v12, v12, v108, v110
    v_add3_u32 v13, v13, v109, v111
    v_perm_b32 v112, v113, v112, s23
    v_perm_b32 v113, v115, v114, s23
    ds_write_b64 v70, v[112:113] offset:33280
    s_waitcnt vmcnt(2)
    v_lshlrev_b32_sdwa v104, 3, v122 dst_sel:DWORD dst_unused:UNUSED_PAD src0_sel:DWORD src1_sel:WORD_0
    v_lshlrev_b32_sdwa v106, 3, v122 dst_sel:DWORD dst_unused:UNUSED_PAD src0_sel:DWORD src1_sel:WORD_1
    ds_read_b64 v[104:105], v104
    ds_read_b64 v[106:107], v106
    v_lshlrev_b32_sdwa v108, 3, v123 dst_sel:DWORD dst_unused:UNUSED_PAD src0_sel:DWORD src1_sel:WORD_0
    v_lshlrev_b32_sdwa v110, 3, v123 dst_sel:DWORD dst_unused:UNUSED_PAD src0_sel:DWORD src1_sel:WORD_1
    ds_read_b64 v[108:109], v108
    ds_read_b64 v[110:111], v110
    s_waitcnt lgkmcnt(9)
    v_add3_u32 v14, v14, v88, v90
    v_add3_u32 v15, v15, v89, v91
    v_add3_u32 v14, v14, v92, v94
    v_add3_u32 v15, v15, v93, v95
    s_setprio 2
    v_mfma_f32_16x16x32_bf16 v[112:115], v[72:75], v[208:211], v[66:69]
    v_lshlrev_b32_sdwa v88, 3, v120 dst_sel:DWORD dst_unused:UNUSED_PAD src0_sel:DWORD src1_sel:WORD_0
    v_lshlrev_b32_sdwa v90, 3, v120 dst_sel:DWORD dst_unused:UNUSED_PAD src0_sel:DWORD src1_sel:WORD_1
    ds_read_b64 v[88:89], v88
    ds_read_b64 v[90:91], v90
    v_mfma_f32_16x16x32_bf16 v[112:115], v[76:79], v[212:215], v[112:115]
    v_lshlrev_b32_sdwa v92, 3, v121 dst_sel:DWORD dst_unused:UNUSED_PAD src0_sel:DWORD src1_sel:WORD_0
    v_lshlrev_b32_sdwa v94, 3, v121 dst_sel:DWORD dst_unused:UNUSED_PAD src0_sel:DWORD src1_sel:WORD_1
    ds_read_b64 v[92:93], v92
    ds_read_b64 v[94:95], v94
    buffer_load_dwordx4 v[120:123], v71, s[12:15], s20 offen offset:3072 sc1
    s_waitcnt lgkmcnt(9)
    v_add3_u32 v14, v14, v96, v98
    v_add3_u32 v15, v15, v97, v99
    v_add3_u32 v14, v14, v100, v102
    v_add3_u32 v15, v15, v101, v103
    v_mfma_f32_16x16x32_bf16 v[112:115], v[80:83], v[216:219], v[112:115]
    s_waitcnt vmcnt(2)
    v_lshlrev_b32_sdwa v96, 3, v126 dst_sel:DWORD dst_unused:UNUSED_PAD src0_sel:DWORD src1_sel:WORD_0
    v_lshlrev_b32_sdwa v98, 3, v126 dst_sel:DWORD dst_unused:UNUSED_PAD src0_sel:DWORD src1_sel:WORD_1
    ds_read_b64 v[96:97], v96
    ds_read_b64 v[98:99], v98
    v_mfma_f32_16x16x32_bf16 v[112:115], v[84:87], v[220:223], v[112:115]
    v_lshlrev_b32_sdwa v100, 3, v127 dst_sel:DWORD dst_unused:UNUSED_PAD src0_sel:DWORD src1_sel:WORD_0
    v_lshlrev_b32_sdwa v102, 3, v127 dst_sel:DWORD dst_unused:UNUSED_PAD src0_sel:DWORD src1_sel:WORD_1
    ds_read_b64 v[100:101], v100
    ds_read_b64 v[102:103], v102
    s_waitcnt lgkmcnt(8)
    v_add3_u32 v16, v16, v104, v106
    v_add3_u32 v17, v17, v105, v107
    v_add3_u32 v16, v16, v108, v110
    v_add3_u32 v17, v17, v109, v111
    v_perm_b32 v112, v113, v112, s23
    v_perm_b32 v113, v115, v114, s23
    ds_write_b64 v70, v[112:113] offset:33408
    v_lshlrev_b32_sdwa v104, 3, v124 dst_sel:DWORD dst_unused:UNUSED_PAD src0_sel:DWORD src1_sel:WORD_0
    v_lshlrev_b32_sdwa v106, 3, v124 dst_sel:DWORD dst_unused:UNUSED_PAD src0_sel:DWORD src1_sel:WORD_1
    ds_read_b64 v[104:105], v104
    ds_read_b64 v[106:107], v106
    v_lshlrev_b32_sdwa v108, 3, v125 dst_sel:DWORD dst_unused:UNUSED_PAD src0_sel:DWORD src1_sel:WORD_0
    v_lshlrev_b32_sdwa v110, 3, v125 dst_sel:DWORD dst_unused:UNUSED_PAD src0_sel:DWORD src1_sel:WORD_1
    ds_read_b64 v[108:109], v108
    ds_read_b64 v[110:111], v110
    s_add_u32 s20, s20, 0x1000
    buffer_load_dwordx4 v[124:127], v71, s[12:15], s20 offen offset:0 sc1
    s_waitcnt lgkmcnt(9)
    v_add3_u32 v16, v16, v88, v90
    v_add3_u32 v17, v17, v89, v91
    v_add3_u32 v16, v16, v92, v94
    v_add3_u32 v17, v17, v93, v95
    v_mfma_f32_16x16x32_bf16 v[112:115], v[72:75], v[224:227], v[66:69]
    s_waitcnt vmcnt(2)
    v_lshlrev_b32_sdwa v88, 3, v118 dst_sel:DWORD dst_unused:UNUSED_PAD src0_sel:DWORD src1_sel:WORD_0
    v_lshlrev_b32_sdwa v90, 3, v118 dst_sel:DWORD dst_unused:UNUSED_PAD src0_sel:DWORD src1_sel:WORD_1
    ds_read_b64 v[88:89], v88
    ds_read_b64 v[90:91], v90
    v_mfma_f32_16x16x32_bf16 v[112:115], v[76:79], v[228:231], v[112:115]
    v_lshlrev_b32_sdwa v92, 3, v119 dst_sel:DWORD dst_unused:UNUSED_PAD src0_sel:DWORD src1_sel:WORD_0
    v_lshlrev_b32_sdwa v94, 3, v119 dst_sel:DWORD dst_unused:UNUSED_PAD src0_sel:DWORD src1_sel:WORD_1
    ds_read_b64 v[92:93], v92
    ds_read_b64 v[94:95], v94
    s_waitcnt lgkmcnt(9)
    v_add3_u32 v18, v18, v96, v98
    v_add3_u32 v19, v19, v97, v99
    v_add3_u32 v18, v18, v100, v102
    v_add3_u32 v19, v19, v101, v103
    v_mfma_f32_16x16x32_bf16 v[112:115], v[80:83], v[232:235], v[112:115]
    v_lshlrev_b32_sdwa v96, 3, v116 dst_sel:DWORD dst_unused:UNUSED_PAD src0_sel:DWORD src1_sel:WORD_0
    v_lshlrev_b32_sdwa v98, 3, v116 dst_sel:DWORD dst_unused:UNUSED_PAD src0_sel:DWORD src1_sel:WORD_1
    ds_read_b64 v[96:97], v96
    ds_read_b64 v[98:99], v98
    v_mfma_f32_16x16x32_bf16 v[112:115], v[84:87], v[236:239], v[112:115]
    v_lshlrev_b32_sdwa v100, 3, v117 dst_sel:DWORD dst_unused:UNUSED_PAD src0_sel:DWORD src1_sel:WORD_0
    v_lshlrev_b32_sdwa v102, 3, v117 dst_sel:DWORD dst_unused:UNUSED_PAD src0_sel:DWORD src1_sel:WORD_1
    ds_read_b64 v[100:101], v100
    ds_read_b64 v[102:103], v102
    buffer_load_dwordx4 v[116:119], v71, s[12:15], s20 offen offset:1024 sc1
    s_waitcnt lgkmcnt(8)
    v_add3_u32 v18, v18, v104, v106
    v_add3_u32 v19, v19, v105, v107
    v_add3_u32 v18, v18, v108, v110
    v_add3_u32 v19, v19, v109, v111
    v_perm_b32 v112, v113, v112, s23
    v_perm_b32 v113, v115, v114, s23
    ds_write_b64 v70, v[112:113] offset:33536
    s_waitcnt vmcnt(2)
    v_lshlrev_b32_sdwa v104, 3, v122 dst_sel:DWORD dst_unused:UNUSED_PAD src0_sel:DWORD src1_sel:WORD_0
    v_lshlrev_b32_sdwa v106, 3, v122 dst_sel:DWORD dst_unused:UNUSED_PAD src0_sel:DWORD src1_sel:WORD_1
    ds_read_b64 v[104:105], v104
    ds_read_b64 v[106:107], v106
    v_lshlrev_b32_sdwa v108, 3, v123 dst_sel:DWORD dst_unused:UNUSED_PAD src0_sel:DWORD src1_sel:WORD_0
    v_lshlrev_b32_sdwa v110, 3, v123 dst_sel:DWORD dst_unused:UNUSED_PAD src0_sel:DWORD src1_sel:WORD_1
    ds_read_b64 v[108:109], v108
    ds_read_b64 v[110:111], v110
    s_waitcnt lgkmcnt(9)
    v_add3_u32 v20, v20, v88, v90
    v_add3_u32 v21, v21, v89, v91
    v_add3_u32 v20, v20, v92, v94
    v_add3_u32 v21, v21, v93, v95
    v_mfma_f32_16x16x32_bf16 v[112:115], v[72:75], v[240:243], v[66:69]
    buffer_load_dwordx4 v[72:75], v71, s[12:15], s21 offen offset:0
    v_lshlrev_b32_sdwa v88, 3, v120 dst_sel:DWORD dst_unused:UNUSED_PAD src0_sel:DWORD src1_sel:WORD_0
    v_lshlrev_b32_sdwa v90, 3, v120 dst_sel:DWORD dst_unused:UNUSED_PAD src0_sel:DWORD src1_sel:WORD_1
    ds_read_b64 v[88:89], v88
    ds_read_b64 v[90:91], v90
    v_mfma_f32_16x16x32_bf16 v[112:115], v[76:79], v[244:247], v[112:115]
    buffer_load_dwordx4 v[76:79], v71, s[12:15], s21 offen offset:1024
    v_lshlrev_b32_sdwa v92, 3, v121 dst_sel:DWORD dst_unused:UNUSED_PAD src0_sel:DWORD src1_sel:WORD_0
    v_lshlrev_b32_sdwa v94, 3, v121 dst_sel:DWORD dst_unused:UNUSED_PAD src0_sel:DWORD src1_sel:WORD_1
    ds_read_b64 v[92:93], v92
    ds_read_b64 v[94:95], v94
    buffer_load_dwordx4 v[120:123], v71, s[12:15], s20 offen offset:2048 sc1
    s_waitcnt lgkmcnt(9)
    v_add3_u32 v20, v20, v96, v98
    v_add3_u32 v21, v21, v97, v99
    v_add3_u32 v20, v20, v100, v102
    v_add3_u32 v21, v21, v101, v103
    v_mfma_f32_16x16x32_bf16 v[112:115], v[80:83], v[248:251], v[112:115]
    buffer_load_dwordx4 v[80:83], v71, s[12:15], s19 offen offset:0
    s_waitcnt vmcnt(5)
    v_lshlrev_b32_sdwa v96, 3, v126 dst_sel:DWORD dst_unused:UNUSED_PAD src0_sel:DWORD src1_sel:WORD_0
    v_lshlrev_b32_sdwa v98, 3, v126 dst_sel:DWORD dst_unused:UNUSED_PAD src0_sel:DWORD src1_sel:WORD_1
    ds_read_b64 v[96:97], v96
    ds_read_b64 v[98:99], v98
    v_mfma_f32_16x16x32_bf16 v[112:115], v[84:87], v[252:255], v[112:115]
    buffer_load_dwordx4 v[84:87], v71, s[12:15], s19 offen offset:1024
    s_add_u32 s21, s21, 4096
    s_add_u32 s19, s19, 4096
    v_lshlrev_b32_sdwa v100, 3, v127 dst_sel:DWORD dst_unused:UNUSED_PAD src0_sel:DWORD src1_sel:WORD_0
    v_lshlrev_b32_sdwa v102, 3, v127 dst_sel:DWORD dst_unused:UNUSED_PAD src0_sel:DWORD src1_sel:WORD_1
    ds_read_b64 v[100:101], v100
    ds_read_b64 v[102:103], v102
    s_waitcnt lgkmcnt(8)
    v_add3_u32 v22, v22, v104, v106
    v_add3_u32 v23, v23, v105, v107
    v_add3_u32 v22, v22, v108, v110
    v_add3_u32 v23, v23, v109, v111
    v_perm_b32 v112, v113, v112, s23
    v_perm_b32 v113, v115, v114, s23
    ds_write_b64 v70, v[112:113] offset:33664
    s_setprio 1
    v_lshlrev_b32_sdwa v104, 3, v124 dst_sel:DWORD dst_unused:UNUSED_PAD src0_sel:DWORD src1_sel:WORD_0
    v_lshlrev_b32_sdwa v106, 3, v124 dst_sel:DWORD dst_unused:UNUSED_PAD src0_sel:DWORD src1_sel:WORD_1
    ds_read_b64 v[104:105], v104
    ds_read_b64 v[106:107], v106
    v_lshlrev_b32_sdwa v108, 3, v125 dst_sel:DWORD dst_unused:UNUSED_PAD src0_sel:DWORD src1_sel:WORD_0
    v_lshlrev_b32_sdwa v110, 3, v125 dst_sel:DWORD dst_unused:UNUSED_PAD src0_sel:DWORD src1_sel:WORD_1
    ds_read_b64 v[108:109], v108
    ds_read_b64 v[110:111], v110
    buffer_load_dwordx4 v[124:127], v71, s[12:15], s20 offen offset:3072 sc1
    s_waitcnt lgkmcnt(9)
    v_add3_u32 v22, v22, v88, v90
    v_add3_u32 v23, v23, v89, v91
    v_add3_u32 v22, v22, v92, v94
    v_add3_u32 v23, v23, v93, v95
    s_waitcnt vmcnt(6)
    v_lshlrev_b32_sdwa v88, 3, v118 dst_sel:DWORD dst_unused:UNUSED_PAD src0_sel:DWORD src1_sel:WORD_0
    v_lshlrev_b32_sdwa v90, 3, v118 dst_sel:DWORD dst_unused:UNUSED_PAD src0_sel:DWORD src1_sel:WORD_1
    ds_read_b64 v[88:89], v88
    ds_read_b64 v[90:91], v90
    v_lshlrev_b32_sdwa v92, 3, v119 dst_sel:DWORD dst_unused:UNUSED_PAD src0_sel:DWORD src1_sel:WORD_0
    v_lshlrev_b32_sdwa v94, 3, v119 dst_sel:DWORD dst_unused:UNUSED_PAD src0_sel:DWORD src1_sel:WORD_1
    ds_read_b64 v[92:93], v92
    ds_read_b64 v[94:95], v94
    s_waitcnt lgkmcnt(9)
    v_add3_u32 v24, v24, v96, v98
    v_add3_u32 v25, v25, v97, v99
    v_add3_u32 v24, v24, v100, v102
    v_add3_u32 v25, v25, v101, v103
    v_lshlrev_b32_sdwa v96, 3, v116 dst_sel:DWORD dst_unused:UNUSED_PAD src0_sel:DWORD src1_sel:WORD_0
    v_lshlrev_b32_sdwa v98, 3, v116 dst_sel:DWORD dst_unused:UNUSED_PAD src0_sel:DWORD src1_sel:WORD_1
    ds_read_b64 v[96:97], v96
    ds_read_b64 v[98:99], v98
    v_lshlrev_b32_sdwa v100, 3, v117 dst_sel:DWORD dst_unused:UNUSED_PAD src0_sel:DWORD src1_sel:WORD_0
    v_lshlrev_b32_sdwa v102, 3, v117 dst_sel:DWORD dst_unused:UNUSED_PAD src0_sel:DWORD src1_sel:WORD_1
    ds_read_b64 v[100:101], v100
    ds_read_b64 v[102:103], v102
    s_add_u32 s20, s20, 0x1d000
    buffer_load_dwordx4 v[116:119], v71, s[12:15], s20 offen offset:0 sc1
    s_waitcnt lgkmcnt(8)
    v_add3_u32 v24, v24, v104, v106
    v_add3_u32 v25, v25, v105, v107
    v_add3_u32 v24, v24, v108, v110
    v_add3_u32 v25, v25, v109, v111
    s_waitcnt vmcnt(4)
    v_lshlrev_b32_sdwa v104, 3, v122 dst_sel:DWORD dst_unused:UNUSED_PAD src0_sel:DWORD src1_sel:WORD_0
    v_lshlrev_b32_sdwa v106, 3, v122 dst_sel:DWORD dst_unused:UNUSED_PAD src0_sel:DWORD src1_sel:WORD_1
    ds_read_b64 v[104:105], v104
    ds_read_b64 v[106:107], v106
    v_lshlrev_b32_sdwa v108, 3, v123 dst_sel:DWORD dst_unused:UNUSED_PAD src0_sel:DWORD src1_sel:WORD_0
    v_lshlrev_b32_sdwa v110, 3, v123 dst_sel:DWORD dst_unused:UNUSED_PAD src0_sel:DWORD src1_sel:WORD_1
    ds_read_b64 v[108:109], v108
    ds_read_b64 v[110:111], v110
    s_waitcnt lgkmcnt(8)
    v_add3_u32 v26, v26, v88, v90
    v_add3_u32 v27, v27, v89, v91
    v_add3_u32 v26, v26, v92, v94
    v_add3_u32 v27, v27, v93, v95
    v_lshlrev_b32_sdwa v88, 3, v120 dst_sel:DWORD dst_unused:UNUSED_PAD src0_sel:DWORD src1_sel:WORD_0
    v_lshlrev_b32_sdwa v90, 3, v120 dst_sel:DWORD dst_unused:UNUSED_PAD src0_sel:DWORD src1_sel:WORD_1
    ds_read_b64 v[88:89], v88
    ds_read_b64 v[90:91], v90
    v_lshlrev_b32_sdwa v92, 3, v121 dst_sel:DWORD dst_unused:UNUSED_PAD src0_sel:DWORD src1_sel:WORD_0
    v_lshlrev_b32_sdwa v94, 3, v121 dst_sel:DWORD dst_unused:UNUSED_PAD src0_sel:DWORD src1_sel:WORD_1
    ds_read_b64 v[92:93], v92
    ds_read_b64 v[94:95], v94
    buffer_load_dwordx4 v[120:123], v71, s[12:15], s20 offen offset:1024 sc1
    s_waitcnt lgkmcnt(8)
    v_add3_u32 v26, v26, v96, v98
    v_add3_u32 v27, v27, v97, v99
    v_add3_u32 v26, v26, v100, v102
    v_add3_u32 v27, v27, v101, v103
    s_waitcnt vmcnt(2)
    v_lshlrev_b32_sdwa v96, 3, v126 dst_sel:DWORD dst_unused:UNUSED_PAD src0_sel:DWORD src1_sel:WORD_0
    v_lshlrev_b32_sdwa v98, 3, v126 dst_sel:DWORD dst_unused:UNUSED_PAD src0_sel:DWORD src1_sel:WORD_1
    ds_read_b64 v[96:97], v96
    ds_read_b64 v[98:99], v98
    v_lshlrev_b32_sdwa v100, 3, v127 dst_sel:DWORD dst_unused:UNUSED_PAD src0_sel:DWORD src1_sel:WORD_0
    v_lshlrev_b32_sdwa v102, 3, v127 dst_sel:DWORD dst_unused:UNUSED_PAD src0_sel:DWORD src1_sel:WORD_1
    ds_read_b64 v[100:101], v100
    ds_read_b64 v[102:103], v102
    s_waitcnt lgkmcnt(8)
    v_add3_u32 v28, v28, v104, v106
    v_add3_u32 v29, v29, v105, v107
    v_add3_u32 v28, v28, v108, v110
    v_add3_u32 v29, v29, v109, v111
    s_setprio 0
    v_lshlrev_b32_sdwa v104, 3, v124 dst_sel:DWORD dst_unused:UNUSED_PAD src0_sel:DWORD src1_sel:WORD_0
    v_lshlrev_b32_sdwa v106, 3, v124 dst_sel:DWORD dst_unused:UNUSED_PAD src0_sel:DWORD src1_sel:WORD_1
    ds_read_b64 v[104:105], v104
    ds_read_b64 v[106:107], v106
    v_lshlrev_b32_sdwa v108, 3, v125 dst_sel:DWORD dst_unused:UNUSED_PAD src0_sel:DWORD src1_sel:WORD_0
    v_lshlrev_b32_sdwa v110, 3, v125 dst_sel:DWORD dst_unused:UNUSED_PAD src0_sel:DWORD src1_sel:WORD_1
    ds_read_b64 v[108:109], v108
    ds_read_b64 v[110:111], v110
    buffer_load_dwordx4 v[124:127], v71, s[12:15], s20 offen offset:2048 sc1
    s_waitcnt lgkmcnt(8)
    v_add3_u32 v28, v28, v88, v90
    v_add3_u32 v29, v29, v89, v91
    v_add3_u32 v28, v28, v92, v94
    v_add3_u32 v29, v29, v93, v95
    s_waitcnt vmcnt(2)
    v_lshlrev_b32_sdwa v88, 3, v116 dst_sel:DWORD dst_unused:UNUSED_PAD src0_sel:DWORD src1_sel:WORD_0
    v_lshlrev_b32_sdwa v90, 3, v116 dst_sel:DWORD dst_unused:UNUSED_PAD src0_sel:DWORD src1_sel:WORD_1
    ds_read_b64 v[88:89], v88
    ds_read_b64 v[90:91], v90
    v_lshlrev_b32_sdwa v92, 3, v117 dst_sel:DWORD dst_unused:UNUSED_PAD src0_sel:DWORD src1_sel:WORD_0
    v_lshlrev_b32_sdwa v94, 3, v117 dst_sel:DWORD dst_unused:UNUSED_PAD src0_sel:DWORD src1_sel:WORD_1
    ds_read_b64 v[92:93], v92
    ds_read_b64 v[94:95], v94
    s_waitcnt lgkmcnt(8)
    v_add3_u32 v30, v30, v96, v98
    v_add3_u32 v31, v31, v97, v99
    v_add3_u32 v30, v30, v100, v102
    v_add3_u32 v31, v31, v101, v103
    s_barrier
    s_setprio 3
    v_lshlrev_b32_sdwa v96, 3, v118 dst_sel:DWORD dst_unused:UNUSED_PAD src0_sel:DWORD src1_sel:WORD_0
    v_lshlrev_b32_sdwa v98, 3, v118 dst_sel:DWORD dst_unused:UNUSED_PAD src0_sel:DWORD src1_sel:WORD_1
    ds_read_b64 v[96:97], v96
    ds_read_b64 v[98:99], v98
    v_lshlrev_b32_sdwa v100, 3, v119 dst_sel:DWORD dst_unused:UNUSED_PAD src0_sel:DWORD src1_sel:WORD_0
    v_lshlrev_b32_sdwa v102, 3, v119 dst_sel:DWORD dst_unused:UNUSED_PAD src0_sel:DWORD src1_sel:WORD_1
    ds_read_b64 v[100:101], v100
    ds_read_b64 v[102:103], v102
    buffer_load_dwordx4 v[116:119], v71, s[12:15], s20 offen offset:3072 sc1
    s_waitcnt lgkmcnt(8)
    v_add3_u32 v30, v30, v104, v106
    v_add3_u32 v31, v31, v105, v107
    v_add3_u32 v30, v30, v108, v110
    v_add3_u32 v31, v31, v109, v111
    v_mfma_f32_16x16x32_bf16 v[112:115], v[72:75], v[128:131], v[66:69]
    s_waitcnt vmcnt(2)
    v_lshlrev_b32_sdwa v104, 3, v120 dst_sel:DWORD dst_unused:UNUSED_PAD src0_sel:DWORD src1_sel:WORD_0
    v_lshlrev_b32_sdwa v106, 3, v120 dst_sel:DWORD dst_unused:UNUSED_PAD src0_sel:DWORD src1_sel:WORD_1
    ds_read_b64 v[104:105], v104
    ds_read_b64 v[106:107], v106
    v_mfma_f32_16x16x32_bf16 v[112:115], v[76:79], v[132:135], v[112:115]
    v_add_u32 v70, 0x10000, v70
    v_lshlrev_b32_sdwa v108, 3, v121 dst_sel:DWORD dst_unused:UNUSED_PAD src0_sel:DWORD src1_sel:WORD_0
    v_lshlrev_b32_sdwa v110, 3, v121 dst_sel:DWORD dst_unused:UNUSED_PAD src0_sel:DWORD src1_sel:WORD_1
    ds_read_b64 v[108:109], v108
    ds_read_b64 v[110:111], v110
    s_waitcnt lgkmcnt(8)
    v_add3_u32 v32, v32, v88, v90
    v_add3_u32 v33, v33, v89, v91
    v_add3_u32 v32, v32, v92, v94
    v_add3_u32 v33, v33, v93, v95
    v_mfma_f32_16x16x32_bf16 v[112:115], v[80:83], v[136:139], v[112:115]
    v_lshlrev_b32_sdwa v88, 3, v122 dst_sel:DWORD dst_unused:UNUSED_PAD src0_sel:DWORD src1_sel:WORD_0
    v_lshlrev_b32_sdwa v90, 3, v122 dst_sel:DWORD dst_unused:UNUSED_PAD src0_sel:DWORD src1_sel:WORD_1
    ds_read_b64 v[88:89], v88
    ds_read_b64 v[90:91], v90
    v_mfma_f32_16x16x32_bf16 v[112:115], v[84:87], v[140:143], v[112:115]
    v_lshlrev_b32_sdwa v92, 3, v123 dst_sel:DWORD dst_unused:UNUSED_PAD src0_sel:DWORD src1_sel:WORD_0
    v_lshlrev_b32_sdwa v94, 3, v123 dst_sel:DWORD dst_unused:UNUSED_PAD src0_sel:DWORD src1_sel:WORD_1
    ds_read_b64 v[92:93], v92
    ds_read_b64 v[94:95], v94
    s_add_u32 s20, s20, 0x1000
    buffer_load_dwordx4 v[120:123], v71, s[12:15], s20 offen offset:0 sc1
    s_waitcnt lgkmcnt(8)
    v_add3_u32 v32, v32, v96, v98
    v_add3_u32 v33, v33, v97, v99
    v_add3_u32 v32, v32, v100, v102
    v_add3_u32 v33, v33, v101, v103
    v_perm_b32 v112, v113, v112, s23
    v_perm_b32 v113, v115, v114, s23
    ds_write_b64 v70, v[112:113] offset:0
    s_waitcnt vmcnt(2)
    v_lshlrev_b32_sdwa v96, 3, v124 dst_sel:DWORD dst_unused:UNUSED_PAD src0_sel:DWORD src1_sel:WORD_0
    v_lshlrev_b32_sdwa v98, 3, v124 dst_sel:DWORD dst_unused:UNUSED_PAD src0_sel:DWORD src1_sel:WORD_1
    ds_read_b64 v[96:97], v96
    ds_read_b64 v[98:99], v98
    v_lshlrev_b32_sdwa v100, 3, v125 dst_sel:DWORD dst_unused:UNUSED_PAD src0_sel:DWORD src1_sel:WORD_0
    v_lshlrev_b32_sdwa v102, 3, v125 dst_sel:DWORD dst_unused:UNUSED_PAD src0_sel:DWORD src1_sel:WORD_1
    ds_read_b64 v[100:101], v100
    ds_read_b64 v[102:103], v102
    s_waitcnt lgkmcnt(9)
    v_add3_u32 v34, v34, v104, v106
    v_add3_u32 v35, v35, v105, v107
    v_add3_u32 v34, v34, v108, v110
    v_add3_u32 v35, v35, v109, v111
    v_mfma_f32_16x16x32_bf16 v[112:115], v[72:75], v[144:147], v[66:69]
    v_lshlrev_b32_sdwa v104, 3, v126 dst_sel:DWORD dst_unused:UNUSED_PAD src0_sel:DWORD src1_sel:WORD_0
    v_lshlrev_b32_sdwa v106, 3, v126 dst_sel:DWORD dst_unused:UNUSED_PAD src0_sel:DWORD src1_sel:WORD_1
    ds_read_b64 v[104:105], v104
    ds_read_b64 v[106:107], v106
    v_mfma_f32_16x16x32_bf16 v[112:115], v[76:79], v[148:151], v[112:115]
    v_lshlrev_b32_sdwa v108, 3, v127 dst_sel:DWORD dst_unused:UNUSED_PAD src0_sel:DWORD src1_sel:WORD_0
    v_lshlrev_b32_sdwa v110, 3, v127 dst_sel:DWORD dst_unused:UNUSED_PAD src0_sel:DWORD src1_sel:WORD_1
    ds_read_b64 v[108:109], v108
    ds_read_b64 v[110:111], v110
    buffer_load_dwordx4 v[124:127], v71, s[12:15], s20 offen offset:1024 sc1
    s_waitcnt lgkmcnt(9)
    v_add3_u32 v34, v34, v88, v90
    v_add3_u32 v35, v35, v89, v91
    v_add3_u32 v34, v34, v92, v94
    v_add3_u32 v35, v35, v93, v95
    v_mfma_f32_16x16x32_bf16 v[112:115], v[80:83], v[152:155], v[112:115]
    s_waitcnt vmcnt(2)
    v_lshlrev_b32_sdwa v88, 3, v116 dst_sel:DWORD dst_unused:UNUSED_PAD src0_sel:DWORD src1_sel:WORD_0
    v_lshlrev_b32_sdwa v90, 3, v116 dst_sel:DWORD dst_unused:UNUSED_PAD src0_sel:DWORD src1_sel:WORD_1
    ds_read_b64 v[88:89], v88
    ds_read_b64 v[90:91], v90
    v_mfma_f32_16x16x32_bf16 v[112:115], v[84:87], v[156:159], v[112:115]
    v_lshlrev_b32_sdwa v92, 3, v117 dst_sel:DWORD dst_unused:UNUSED_PAD src0_sel:DWORD src1_sel:WORD_0
    v_lshlrev_b32_sdwa v94, 3, v117 dst_sel:DWORD dst_unused:UNUSED_PAD src0_sel:DWORD src1_sel:WORD_1
    ds_read_b64 v[92:93], v92
    ds_read_b64 v[94:95], v94
    s_waitcnt lgkmcnt(8)
    v_add3_u32 v36, v36, v96, v98
    v_add3_u32 v37, v37, v97, v99
    v_add3_u32 v36, v36, v100, v102
    v_add3_u32 v37, v37, v101, v103
    v_perm_b32 v112, v113, v112, s23
    v_perm_b32 v113, v115, v114, s23
    ds_write_b64 v70, v[112:113] offset:128
    v_lshlrev_b32_sdwa v96, 3, v118 dst_sel:DWORD dst_unused:UNUSED_PAD src0_sel:DWORD src1_sel:WORD_0
    v_lshlrev_b32_sdwa v98, 3, v118 dst_sel:DWORD dst_unused:UNUSED_PAD src0_sel:DWORD src1_sel:WORD_1
    ds_read_b64 v[96:97], v96
    ds_read_b64 v[98:99], v98
    v_lshlrev_b32_sdwa v100, 3, v119 dst_sel:DWORD dst_unused:UNUSED_PAD src0_sel:DWORD src1_sel:WORD_0
    v_lshlrev_b32_sdwa v102, 3, v119 dst_sel:DWORD dst_unused:UNUSED_PAD src0_sel:DWORD src1_sel:WORD_1
    ds_read_b64 v[100:101], v100
    ds_read_b64 v[102:103], v102
    buffer_load_dwordx4 v[116:119], v71, s[12:15], s20 offen offset:2048 sc1
    s_waitcnt lgkmcnt(9)
    v_add3_u32 v36, v36, v104, v106
    v_add3_u32 v37, v37, v105, v107
    v_add3_u32 v36, v36, v108, v110
    v_add3_u32 v37, v37, v109, v111
    v_mfma_f32_16x16x32_bf16 v[112:115], v[72:75], v[160:163], v[66:69]
    s_waitcnt vmcnt(2)
    v_lshlrev_b32_sdwa v104, 3, v120 dst_sel:DWORD dst_unused:UNUSED_PAD src0_sel:DWORD src1_sel:WORD_0
    v_lshlrev_b32_sdwa v106, 3, v120 dst_sel:DWORD dst_unused:UNUSED_PAD src0_sel:DWORD src1_sel:WORD_1
    ds_read_b64 v[104:105], v104
    ds_read_b64 v[106:107], v106
    v_mfma_f32_16x16x32_bf16 v[112:115], v[76:79], v[164:167], v[112:115]
    v_lshlrev_b32_sdwa v108, 3, v121 dst_sel:DWORD dst_unused:UNUSED_PAD src0_sel:DWORD src1_sel:WORD_0
    v_lshlrev_b32_sdwa v110, 3, v121 dst_sel:DWORD dst_unused:UNUSED_PAD src0_sel:DWORD src1_sel:WORD_1
    ds_read_b64 v[108:109], v108
    ds_read_b64 v[110:111], v110
    s_waitcnt lgkmcnt(9)
    v_add3_u32 v38, v38, v88, v90
    v_add3_u32 v39, v39, v89, v91
    v_add3_u32 v38, v38, v92, v94
    v_add3_u32 v39, v39, v93, v95
    v_mfma_f32_16x16x32_bf16 v[112:115], v[80:83], v[168:171], v[112:115]
    v_lshlrev_b32_sdwa v88, 3, v122 dst_sel:DWORD dst_unused:UNUSED_PAD src0_sel:DWORD src1_sel:WORD_0
    v_lshlrev_b32_sdwa v90, 3, v122 dst_sel:DWORD dst_unused:UNUSED_PAD src0_sel:DWORD src1_sel:WORD_1
    ds_read_b64 v[88:89], v88
    ds_read_b64 v[90:91], v90
    v_mfma_f32_16x16x32_bf16 v[112:115], v[84:87], v[172:175], v[112:115]
    v_lshlrev_b32_sdwa v92, 3, v123 dst_sel:DWORD dst_unused:UNUSED_PAD src0_sel:DWORD src1_sel:WORD_0
    v_lshlrev_b32_sdwa v94, 3, v123 dst_sel:DWORD dst_unused:UNUSED_PAD src0_sel:DWORD src1_sel:WORD_1
    ds_read_b64 v[92:93], v92
    ds_read_b64 v[94:95], v94
    buffer_load_dwordx4 v[120:123], v71, s[12:15], s20 offen offset:3072 sc1
    s_waitcnt lgkmcnt(8)
    v_add3_u32 v38, v38, v96, v98
    v_add3_u32 v39, v39, v97, v99
    v_add3_u32 v38, v38, v100, v102
    v_add3_u32 v39, v39, v101, v103
    v_perm_b32 v112, v113, v112, s23
    v_perm_b32 v113, v115, v114, s23
    ds_write_b64 v70, v[112:113] offset:256
    s_waitcnt vmcnt(2)
    v_lshlrev_b32_sdwa v96, 3, v124 dst_sel:DWORD dst_unused:UNUSED_PAD src0_sel:DWORD src1_sel:WORD_0
    v_lshlrev_b32_sdwa v98, 3, v124 dst_sel:DWORD dst_unused:UNUSED_PAD src0_sel:DWORD src1_sel:WORD_1
    ds_read_b64 v[96:97], v96
    ds_read_b64 v[98:99], v98
    v_lshlrev_b32_sdwa v100, 3, v125 dst_sel:DWORD dst_unused:UNUSED_PAD src0_sel:DWORD src1_sel:WORD_0
    v_lshlrev_b32_sdwa v102, 3, v125 dst_sel:DWORD dst_unused:UNUSED_PAD src0_sel:DWORD src1_sel:WORD_1
    ds_read_b64 v[100:101], v100
    ds_read_b64 v[102:103], v102
    s_waitcnt lgkmcnt(9)
    v_add3_u32 v40, v40, v104, v106
    v_add3_u32 v41, v41, v105, v107
    v_add3_u32 v40, v40, v108, v110
    v_add3_u32 v41, v41, v109, v111
    v_mfma_f32_16x16x32_bf16 v[112:115], v[72:75], v[176:179], v[66:69]
    v_lshlrev_b32_sdwa v104, 3, v126 dst_sel:DWORD dst_unused:UNUSED_PAD src0_sel:DWORD src1_sel:WORD_0
    v_lshlrev_b32_sdwa v106, 3, v126 dst_sel:DWORD dst_unused:UNUSED_PAD src0_sel:DWORD src1_sel:WORD_1
    ds_read_b64 v[104:105], v104
    ds_read_b64 v[106:107], v106
    v_mfma_f32_16x16x32_bf16 v[112:115], v[76:79], v[180:183], v[112:115]
    v_lshlrev_b32_sdwa v108, 3, v127 dst_sel:DWORD dst_unused:UNUSED_PAD src0_sel:DWORD src1_sel:WORD_0
    v_lshlrev_b32_sdwa v110, 3, v127 dst_sel:DWORD dst_unused:UNUSED_PAD src0_sel:DWORD src1_sel:WORD_1
    ds_read_b64 v[108:109], v108
    ds_read_b64 v[110:111], v110
    s_add_u32 s20, s20, 0x1000
    buffer_load_dwordx4 v[124:127], v71, s[12:15], s20 offen offset:0 sc1
    s_waitcnt lgkmcnt(9)
    v_add3_u32 v40, v40, v88, v90
    v_add3_u32 v41, v41, v89, v91
    v_add3_u32 v40, v40, v92, v94
    v_add3_u32 v41, v41, v93, v95
    v_mfma_f32_16x16x32_bf16 v[112:115], v[80:83], v[184:187], v[112:115]
    s_waitcnt vmcnt(2)
    v_lshlrev_b32_sdwa v88, 3, v116 dst_sel:DWORD dst_unused:UNUSED_PAD src0_sel:DWORD src1_sel:WORD_0
    v_lshlrev_b32_sdwa v90, 3, v116 dst_sel:DWORD dst_unused:UNUSED_PAD src0_sel:DWORD src1_sel:WORD_1
    ds_read_b64 v[88:89], v88
    ds_read_b64 v[90:91], v90
    v_mfma_f32_16x16x32_bf16 v[112:115], v[84:87], v[188:191], v[112:115]
    v_lshlrev_b32_sdwa v92, 3, v117 dst_sel:DWORD dst_unused:UNUSED_PAD src0_sel:DWORD src1_sel:WORD_0
    v_lshlrev_b32_sdwa v94, 3, v117 dst_sel:DWORD dst_unused:UNUSED_PAD src0_sel:DWORD src1_sel:WORD_1
    ds_read_b64 v[92:93], v92
    ds_read_b64 v[94:95], v94
    s_waitcnt lgkmcnt(8)
    v_add3_u32 v42, v42, v96, v98
    v_add3_u32 v43, v43, v97, v99
    v_add3_u32 v42, v42, v100, v102
    v_add3_u32 v43, v43, v101, v103
    v_perm_b32 v112, v113, v112, s23
    v_perm_b32 v113, v115, v114, s23
    ds_write_b64 v70, v[112:113] offset:384
    v_lshlrev_b32_sdwa v96, 3, v118 dst_sel:DWORD dst_unused:UNUSED_PAD src0_sel:DWORD src1_sel:WORD_0
    v_lshlrev_b32_sdwa v98, 3, v118 dst_sel:DWORD dst_unused:UNUSED_PAD src0_sel:DWORD src1_sel:WORD_1
    ds_read_b64 v[96:97], v96
    ds_read_b64 v[98:99], v98
    v_lshlrev_b32_sdwa v100, 3, v119 dst_sel:DWORD dst_unused:UNUSED_PAD src0_sel:DWORD src1_sel:WORD_0
    v_lshlrev_b32_sdwa v102, 3, v119 dst_sel:DWORD dst_unused:UNUSED_PAD src0_sel:DWORD src1_sel:WORD_1
    ds_read_b64 v[100:101], v100
    ds_read_b64 v[102:103], v102
    buffer_load_dwordx4 v[116:119], v71, s[12:15], s20 offen offset:1024 sc1
    s_waitcnt lgkmcnt(9)
    v_add3_u32 v42, v42, v104, v106
    v_add3_u32 v43, v43, v105, v107
    v_add3_u32 v42, v42, v108, v110
    v_add3_u32 v43, v43, v109, v111
    v_mfma_f32_16x16x32_bf16 v[112:115], v[72:75], v[192:195], v[66:69]
    s_waitcnt vmcnt(2)
    v_lshlrev_b32_sdwa v104, 3, v120 dst_sel:DWORD dst_unused:UNUSED_PAD src0_sel:DWORD src1_sel:WORD_0
    v_lshlrev_b32_sdwa v106, 3, v120 dst_sel:DWORD dst_unused:UNUSED_PAD src0_sel:DWORD src1_sel:WORD_1
    ds_read_b64 v[104:105], v104
    ds_read_b64 v[106:107], v106
    v_mfma_f32_16x16x32_bf16 v[112:115], v[76:79], v[196:199], v[112:115]
    v_lshlrev_b32_sdwa v108, 3, v121 dst_sel:DWORD dst_unused:UNUSED_PAD src0_sel:DWORD src1_sel:WORD_0
    v_lshlrev_b32_sdwa v110, 3, v121 dst_sel:DWORD dst_unused:UNUSED_PAD src0_sel:DWORD src1_sel:WORD_1
    ds_read_b64 v[108:109], v108
    ds_read_b64 v[110:111], v110
    s_waitcnt lgkmcnt(9)
    v_add3_u32 v44, v44, v88, v90
    v_add3_u32 v45, v45, v89, v91
    v_add3_u32 v44, v44, v92, v94
    v_add3_u32 v45, v45, v93, v95
    v_mfma_f32_16x16x32_bf16 v[112:115], v[80:83], v[200:203], v[112:115]
    v_lshlrev_b32_sdwa v88, 3, v122 dst_sel:DWORD dst_unused:UNUSED_PAD src0_sel:DWORD src1_sel:WORD_0
    v_lshlrev_b32_sdwa v90, 3, v122 dst_sel:DWORD dst_unused:UNUSED_PAD src0_sel:DWORD src1_sel:WORD_1
    ds_read_b64 v[88:89], v88
    ds_read_b64 v[90:91], v90
    v_mfma_f32_16x16x32_bf16 v[112:115], v[84:87], v[204:207], v[112:115]
    v_lshlrev_b32_sdwa v92, 3, v123 dst_sel:DWORD dst_unused:UNUSED_PAD src0_sel:DWORD src1_sel:WORD_0
    v_lshlrev_b32_sdwa v94, 3, v123 dst_sel:DWORD dst_unused:UNUSED_PAD src0_sel:DWORD src1_sel:WORD_1
    ds_read_b64 v[92:93], v92
    ds_read_b64 v[94:95], v94
    buffer_load_dwordx4 v[120:123], v71, s[12:15], s20 offen offset:2048 sc1
    s_waitcnt lgkmcnt(8)
    v_add3_u32 v44, v44, v96, v98
    v_add3_u32 v45, v45, v97, v99
    v_add3_u32 v44, v44, v100, v102
    v_add3_u32 v45, v45, v101, v103
    v_perm_b32 v112, v113, v112, s23
    v_perm_b32 v113, v115, v114, s23
    ds_write_b64 v70, v[112:113] offset:512
    s_waitcnt vmcnt(2)
    v_lshlrev_b32_sdwa v96, 3, v124 dst_sel:DWORD dst_unused:UNUSED_PAD src0_sel:DWORD src1_sel:WORD_0
    v_lshlrev_b32_sdwa v98, 3, v124 dst_sel:DWORD dst_unused:UNUSED_PAD src0_sel:DWORD src1_sel:WORD_1
    ds_read_b64 v[96:97], v96
    ds_read_b64 v[98:99], v98
    v_lshlrev_b32_sdwa v100, 3, v125 dst_sel:DWORD dst_unused:UNUSED_PAD src0_sel:DWORD src1_sel:WORD_0
    v_lshlrev_b32_sdwa v102, 3, v125 dst_sel:DWORD dst_unused:UNUSED_PAD src0_sel:DWORD src1_sel:WORD_1
    ds_read_b64 v[100:101], v100
    ds_read_b64 v[102:103], v102
    s_waitcnt lgkmcnt(9)
    v_add3_u32 v46, v46, v104, v106
    v_add3_u32 v47, v47, v105, v107
    v_add3_u32 v46, v46, v108, v110
    v_add3_u32 v47, v47, v109, v111
    s_setprio 2
    v_mfma_f32_16x16x32_bf16 v[112:115], v[72:75], v[208:211], v[66:69]
    v_lshlrev_b32_sdwa v104, 3, v126 dst_sel:DWORD dst_unused:UNUSED_PAD src0_sel:DWORD src1_sel:WORD_0
    v_lshlrev_b32_sdwa v106, 3, v126 dst_sel:DWORD dst_unused:UNUSED_PAD src0_sel:DWORD src1_sel:WORD_1
    ds_read_b64 v[104:105], v104
    ds_read_b64 v[106:107], v106
    v_mfma_f32_16x16x32_bf16 v[112:115], v[76:79], v[212:215], v[112:115]
    v_lshlrev_b32_sdwa v108, 3, v127 dst_sel:DWORD dst_unused:UNUSED_PAD src0_sel:DWORD src1_sel:WORD_0
    v_lshlrev_b32_sdwa v110, 3, v127 dst_sel:DWORD dst_unused:UNUSED_PAD src0_sel:DWORD src1_sel:WORD_1
    ds_read_b64 v[108:109], v108
    ds_read_b64 v[110:111], v110
    buffer_load_dwordx4 v[124:127], v71, s[12:15], s20 offen offset:3072 sc1
    s_waitcnt lgkmcnt(9)
    v_add3_u32 v46, v46, v88, v90
    v_add3_u32 v47, v47, v89, v91
    v_add3_u32 v46, v46, v92, v94
    v_add3_u32 v47, v47, v93, v95
    v_mfma_f32_16x16x32_bf16 v[112:115], v[80:83], v[216:219], v[112:115]
    s_waitcnt vmcnt(2)
    v_lshlrev_b32_sdwa v88, 3, v116 dst_sel:DWORD dst_unused:UNUSED_PAD src0_sel:DWORD src1_sel:WORD_0
    v_lshlrev_b32_sdwa v90, 3, v116 dst_sel:DWORD dst_unused:UNUSED_PAD src0_sel:DWORD src1_sel:WORD_1
    ds_read_b64 v[88:89], v88
    ds_read_b64 v[90:91], v90
    v_mfma_f32_16x16x32_bf16 v[112:115], v[84:87], v[220:223], v[112:115]
    v_lshlrev_b32_sdwa v92, 3, v117 dst_sel:DWORD dst_unused:UNUSED_PAD src0_sel:DWORD src1_sel:WORD_0
    v_lshlrev_b32_sdwa v94, 3, v117 dst_sel:DWORD dst_unused:UNUSED_PAD src0_sel:DWORD src1_sel:WORD_1
    ds_read_b64 v[92:93], v92
    ds_read_b64 v[94:95], v94
    s_waitcnt lgkmcnt(8)
    v_add3_u32 v48, v48, v96, v98
    v_add3_u32 v49, v49, v97, v99
    v_add3_u32 v48, v48, v100, v102
    v_add3_u32 v49, v49, v101, v103
    v_perm_b32 v112, v113, v112, s23
    v_perm_b32 v113, v115, v114, s23
    ds_write_b64 v70, v[112:113] offset:640
    v_lshlrev_b32_sdwa v96, 3, v118 dst_sel:DWORD dst_unused:UNUSED_PAD src0_sel:DWORD src1_sel:WORD_0
    v_lshlrev_b32_sdwa v98, 3, v118 dst_sel:DWORD dst_unused:UNUSED_PAD src0_sel:DWORD src1_sel:WORD_1
    ds_read_b64 v[96:97], v96
    ds_read_b64 v[98:99], v98
    v_lshlrev_b32_sdwa v100, 3, v119 dst_sel:DWORD dst_unused:UNUSED_PAD src0_sel:DWORD src1_sel:WORD_0
    v_lshlrev_b32_sdwa v102, 3, v119 dst_sel:DWORD dst_unused:UNUSED_PAD src0_sel:DWORD src1_sel:WORD_1
    ds_read_b64 v[100:101], v100
    ds_read_b64 v[102:103], v102
    s_add_u32 s20, s20, 0x1000
    buffer_load_dwordx4 v[116:119], v71, s[12:15], s20 offen offset:0 sc1
    s_waitcnt lgkmcnt(9)
    v_add3_u32 v48, v48, v104, v106
    v_add3_u32 v49, v49, v105, v107
    v_add3_u32 v48, v48, v108, v110
    v_add3_u32 v49, v49, v109, v111
    v_mfma_f32_16x16x32_bf16 v[112:115], v[72:75], v[224:227], v[66:69]
    s_waitcnt vmcnt(2)
    v_lshlrev_b32_sdwa v104, 3, v120 dst_sel:DWORD dst_unused:UNUSED_PAD src0_sel:DWORD src1_sel:WORD_0
    v_lshlrev_b32_sdwa v106, 3, v120 dst_sel:DWORD dst_unused:UNUSED_PAD src0_sel:DWORD src1_sel:WORD_1
    ds_read_b64 v[104:105], v104
    ds_read_b64 v[106:107], v106
    v_mfma_f32_16x16x32_bf16 v[112:115], v[76:79], v[228:231], v[112:115]
    v_lshlrev_b32_sdwa v108, 3, v121 dst_sel:DWORD dst_unused:UNUSED_PAD src0_sel:DWORD src1_sel:WORD_0
    v_lshlrev_b32_sdwa v110, 3, v121 dst_sel:DWORD dst_unused:UNUSED_PAD src0_sel:DWORD src1_sel:WORD_1
    ds_read_b64 v[108:109], v108
    ds_read_b64 v[110:111], v110
    s_waitcnt lgkmcnt(9)
    v_add3_u32 v50, v50, v88, v90
    v_add3_u32 v51, v51, v89, v91
    v_add3_u32 v50, v50, v92, v94
    v_add3_u32 v51, v51, v93, v95
    v_mfma_f32_16x16x32_bf16 v[112:115], v[80:83], v[232:235], v[112:115]
    v_lshlrev_b32_sdwa v88, 3, v122 dst_sel:DWORD dst_unused:UNUSED_PAD src0_sel:DWORD src1_sel:WORD_0
    v_lshlrev_b32_sdwa v90, 3, v122 dst_sel:DWORD dst_unused:UNUSED_PAD src0_sel:DWORD src1_sel:WORD_1
    ds_read_b64 v[88:89], v88
    ds_read_b64 v[90:91], v90
    v_mfma_f32_16x16x32_bf16 v[112:115], v[84:87], v[236:239], v[112:115]
    v_lshlrev_b32_sdwa v92, 3, v123 dst_sel:DWORD dst_unused:UNUSED_PAD src0_sel:DWORD src1_sel:WORD_0
    v_lshlrev_b32_sdwa v94, 3, v123 dst_sel:DWORD dst_unused:UNUSED_PAD src0_sel:DWORD src1_sel:WORD_1
    ds_read_b64 v[92:93], v92
    ds_read_b64 v[94:95], v94
    buffer_load_dwordx4 v[120:123], v71, s[12:15], s20 offen offset:1024 sc1
    s_waitcnt lgkmcnt(8)
    v_add3_u32 v50, v50, v96, v98
    v_add3_u32 v51, v51, v97, v99
    v_add3_u32 v50, v50, v100, v102
    v_add3_u32 v51, v51, v101, v103
    v_perm_b32 v112, v113, v112, s23
    v_perm_b32 v113, v115, v114, s23
    ds_write_b64 v70, v[112:113] offset:768
    s_waitcnt vmcnt(2)
    v_lshlrev_b32_sdwa v96, 3, v124 dst_sel:DWORD dst_unused:UNUSED_PAD src0_sel:DWORD src1_sel:WORD_0
    v_lshlrev_b32_sdwa v98, 3, v124 dst_sel:DWORD dst_unused:UNUSED_PAD src0_sel:DWORD src1_sel:WORD_1
    ds_read_b64 v[96:97], v96
    ds_read_b64 v[98:99], v98
    v_lshlrev_b32_sdwa v100, 3, v125 dst_sel:DWORD dst_unused:UNUSED_PAD src0_sel:DWORD src1_sel:WORD_0
    v_lshlrev_b32_sdwa v102, 3, v125 dst_sel:DWORD dst_unused:UNUSED_PAD src0_sel:DWORD src1_sel:WORD_1
    ds_read_b64 v[100:101], v100
    ds_read_b64 v[102:103], v102
    s_waitcnt lgkmcnt(9)
    v_add3_u32 v52, v52, v104, v106
    v_add3_u32 v53, v53, v105, v107
    v_add3_u32 v52, v52, v108, v110
    v_add3_u32 v53, v53, v109, v111
    v_mfma_f32_16x16x32_bf16 v[112:115], v[72:75], v[240:243], v[66:69]
    buffer_load_dwordx4 v[72:75], v71, s[12:15], s21 offen offset:0
    v_lshlrev_b32_sdwa v104, 3, v126 dst_sel:DWORD dst_unused:UNUSED_PAD src0_sel:DWORD src1_sel:WORD_0
    v_lshlrev_b32_sdwa v106, 3, v126 dst_sel:DWORD dst_unused:UNUSED_PAD src0_sel:DWORD src1_sel:WORD_1
    ds_read_b64 v[104:105], v104
    ds_read_b64 v[106:107], v106
    v_mfma_f32_16x16x32_bf16 v[112:115], v[76:79], v[244:247], v[112:115]
    buffer_load_dwordx4 v[76:79], v71, s[12:15], s21 offen offset:1024
    v_lshlrev_b32_sdwa v108, 3, v127 dst_sel:DWORD dst_unused:UNUSED_PAD src0_sel:DWORD src1_sel:WORD_0
    v_lshlrev_b32_sdwa v110, 3, v127 dst_sel:DWORD dst_unused:UNUSED_PAD src0_sel:DWORD src1_sel:WORD_1
    ds_read_b64 v[108:109], v108
    ds_read_b64 v[110:111], v110
    buffer_load_dwordx4 v[124:127], v71, s[12:15], s20 offen offset:2048 sc1
    s_waitcnt lgkmcnt(9)
    v_add3_u32 v52, v52, v88, v90
    v_add3_u32 v53, v53, v89, v91
    v_add3_u32 v52, v52, v92, v94
    v_add3_u32 v53, v53, v93, v95
    v_mfma_f32_16x16x32_bf16 v[112:115], v[80:83], v[248:251], v[112:115]
    buffer_load_dwordx4 v[80:83], v71, s[12:15], s19 offen offset:0
    s_waitcnt vmcnt(5)
    v_lshlrev_b32_sdwa v88, 3, v116 dst_sel:DWORD dst_unused:UNUSED_PAD src0_sel:DWORD src1_sel:WORD_0
    v_lshlrev_b32_sdwa v90, 3, v116 dst_sel:DWORD dst_unused:UNUSED_PAD src0_sel:DWORD src1_sel:WORD_1
    ds_read_b64 v[88:89], v88
    ds_read_b64 v[90:91], v90
    v_mfma_f32_16x16x32_bf16 v[112:115], v[84:87], v[252:255], v[112:115]
    buffer_load_dwordx4 v[84:87], v71, s[12:15], s19 offen offset:1024
    s_add_u32 s21, s21, 4096
    s_add_u32 s19, s19, 4096
    v_lshlrev_b32_sdwa v92, 3, v117 dst_sel:DWORD dst_unused:UNUSED_PAD src0_sel:DWORD src1_sel:WORD_0
    v_lshlrev_b32_sdwa v94, 3, v117 dst_sel:DWORD dst_unused:UNUSED_PAD src0_sel:DWORD src1_sel:WORD_1
    ds_read_b64 v[92:93], v92
    ds_read_b64 v[94:95], v94
    s_waitcnt lgkmcnt(8)
    v_add3_u32 v54, v54, v96, v98
    v_add3_u32 v55, v55, v97, v99
    v_add3_u32 v54, v54, v100, v102
    v_add3_u32 v55, v55, v101, v103
    v_perm_b32 v112, v113, v112, s23
    v_perm_b32 v113, v115, v114, s23
    ds_write_b64 v70, v[112:113] offset:896
    s_setprio 1
    v_lshlrev_b32_sdwa v96, 3, v118 dst_sel:DWORD dst_unused:UNUSED_PAD src0_sel:DWORD src1_sel:WORD_0
    v_lshlrev_b32_sdwa v98, 3, v118 dst_sel:DWORD dst_unused:UNUSED_PAD src0_sel:DWORD src1_sel:WORD_1
    ds_read_b64 v[96:97], v96
    ds_read_b64 v[98:99], v98
    v_lshlrev_b32_sdwa v100, 3, v119 dst_sel:DWORD dst_unused:UNUSED_PAD src0_sel:DWORD src1_sel:WORD_0
    v_lshlrev_b32_sdwa v102, 3, v119 dst_sel:DWORD dst_unused:UNUSED_PAD src0_sel:DWORD src1_sel:WORD_1
    ds_read_b64 v[100:101], v100
    ds_read_b64 v[102:103], v102
    buffer_load_dwordx4 v[116:119], v71, s[12:15], s20 offen offset:3072 sc1
    s_waitcnt lgkmcnt(9)
    v_add3_u32 v54, v54, v104, v106
    v_add3_u32 v55, v55, v105, v107
    v_add3_u32 v54, v54, v108, v110
    v_add3_u32 v55, v55, v109, v111
    s_waitcnt vmcnt(6)
    v_lshlrev_b32_sdwa v104, 3, v120 dst_sel:DWORD dst_unused:UNUSED_PAD src0_sel:DWORD src1_sel:WORD_0
    v_lshlrev_b32_sdwa v106, 3, v120 dst_sel:DWORD dst_unused:UNUSED_PAD src0_sel:DWORD src1_sel:WORD_1
    ds_read_b64 v[104:105], v104
    ds_read_b64 v[106:107], v106
    v_lshlrev_b32_sdwa v108, 3, v121 dst_sel:DWORD dst_unused:UNUSED_PAD src0_sel:DWORD src1_sel:WORD_0
    v_lshlrev_b32_sdwa v110, 3, v121 dst_sel:DWORD dst_unused:UNUSED_PAD src0_sel:DWORD src1_sel:WORD_1
    ds_read_b64 v[108:109], v108
    ds_read_b64 v[110:111], v110
    s_waitcnt lgkmcnt(9)
    v_add3_u32 v56, v56, v88, v90
    v_add3_u32 v57, v57, v89, v91
    v_add3_u32 v56, v56, v92, v94
    v_add3_u32 v57, v57, v93, v95
    v_lshlrev_b32_sdwa v88, 3, v122 dst_sel:DWORD dst_unused:UNUSED_PAD src0_sel:DWORD src1_sel:WORD_0
    v_lshlrev_b32_sdwa v90, 3, v122 dst_sel:DWORD dst_unused:UNUSED_PAD src0_sel:DWORD src1_sel:WORD_1
    ds_read_b64 v[88:89], v88
    ds_read_b64 v[90:91], v90
    v_lshlrev_b32_sdwa v92, 3, v123 dst_sel:DWORD dst_unused:UNUSED_PAD src0_sel:DWORD src1_sel:WORD_0
    v_lshlrev_b32_sdwa v94, 3, v123 dst_sel:DWORD dst_unused:UNUSED_PAD src0_sel:DWORD src1_sel:WORD_1
    ds_read_b64 v[92:93], v92
    ds_read_b64 v[94:95], v94
    s_add_u32 s20, s20, 0x1d000
    buffer_load_dwordx4 v[120:123], v71, s[12:15], s20 offen offset:0 sc1
    s_waitcnt lgkmcnt(8)
    v_add3_u32 v56, v56, v96, v98
    v_add3_u32 v57, v57, v97, v99
    v_add3_u32 v56, v56, v100, v102
    v_add3_u32 v57, v57, v101, v103
    s_waitcnt vmcnt(4)
    v_lshlrev_b32_sdwa v96, 3, v124 dst_sel:DWORD dst_unused:UNUSED_PAD src0_sel:DWORD src1_sel:WORD_0
    v_lshlrev_b32_sdwa v98, 3, v124 dst_sel:DWORD dst_unused:UNUSED_PAD src0_sel:DWORD src1_sel:WORD_1
    ds_read_b64 v[96:97], v96
    ds_read_b64 v[98:99], v98
    v_lshlrev_b32_sdwa v100, 3, v125 dst_sel:DWORD dst_unused:UNUSED_PAD src0_sel:DWORD src1_sel:WORD_0
    v_lshlrev_b32_sdwa v102, 3, v125 dst_sel:DWORD dst_unused:UNUSED_PAD src0_sel:DWORD src1_sel:WORD_1
    ds_read_b64 v[100:101], v100
    ds_read_b64 v[102:103], v102
    s_waitcnt lgkmcnt(8)
    v_add3_u32 v58, v58, v104, v106
    v_add3_u32 v59, v59, v105, v107
    v_add3_u32 v58, v58, v108, v110
    v_add3_u32 v59, v59, v109, v111
    v_lshlrev_b32_sdwa v104, 3, v126 dst_sel:DWORD dst_unused:UNUSED_PAD src0_sel:DWORD src1_sel:WORD_0
    v_lshlrev_b32_sdwa v106, 3, v126 dst_sel:DWORD dst_unused:UNUSED_PAD src0_sel:DWORD src1_sel:WORD_1
    ds_read_b64 v[104:105], v104
    ds_read_b64 v[106:107], v106
    v_lshlrev_b32_sdwa v108, 3, v127 dst_sel:DWORD dst_unused:UNUSED_PAD src0_sel:DWORD src1_sel:WORD_0
    v_lshlrev_b32_sdwa v110, 3, v127 dst_sel:DWORD dst_unused:UNUSED_PAD src0_sel:DWORD src1_sel:WORD_1
    ds_read_b64 v[108:109], v108
    ds_read_b64 v[110:111], v110
    buffer_load_dwordx4 v[124:127], v71, s[12:15], s20 offen offset:1024 sc1
    s_waitcnt lgkmcnt(8)
    v_add3_u32 v58, v58, v88, v90
    v_add3_u32 v59, v59, v89, v91
    v_add3_u32 v58, v58, v92, v94
    v_add3_u32 v59, v59, v93, v95
    s_waitcnt vmcnt(2)
    v_lshlrev_b32_sdwa v88, 3, v116 dst_sel:DWORD dst_unused:UNUSED_PAD src0_sel:DWORD src1_sel:WORD_0
    v_lshlrev_b32_sdwa v90, 3, v116 dst_sel:DWORD dst_unused:UNUSED_PAD src0_sel:DWORD src1_sel:WORD_1
    ds_read_b64 v[88:89], v88
    ds_read_b64 v[90:91], v90
    v_lshlrev_b32_sdwa v92, 3, v117 dst_sel:DWORD dst_unused:UNUSED_PAD src0_sel:DWORD src1_sel:WORD_0
    v_lshlrev_b32_sdwa v94, 3, v117 dst_sel:DWORD dst_unused:UNUSED_PAD src0_sel:DWORD src1_sel:WORD_1
    ds_read_b64 v[92:93], v92
    ds_read_b64 v[94:95], v94
    s_waitcnt lgkmcnt(8)
    v_add3_u32 v60, v60, v96, v98
    v_add3_u32 v61, v61, v97, v99
    v_add3_u32 v60, v60, v100, v102
    v_add3_u32 v61, v61, v101, v103
    s_setprio 0
    v_lshlrev_b32_sdwa v96, 3, v118 dst_sel:DWORD dst_unused:UNUSED_PAD src0_sel:DWORD src1_sel:WORD_0
    v_lshlrev_b32_sdwa v98, 3, v118 dst_sel:DWORD dst_unused:UNUSED_PAD src0_sel:DWORD src1_sel:WORD_1
    ds_read_b64 v[96:97], v96
    ds_read_b64 v[98:99], v98
    v_lshlrev_b32_sdwa v100, 3, v119 dst_sel:DWORD dst_unused:UNUSED_PAD src0_sel:DWORD src1_sel:WORD_0
    v_lshlrev_b32_sdwa v102, 3, v119 dst_sel:DWORD dst_unused:UNUSED_PAD src0_sel:DWORD src1_sel:WORD_1
    ds_read_b64 v[100:101], v100
    ds_read_b64 v[102:103], v102
    buffer_load_dwordx4 v[116:119], v71, s[12:15], s20 offen offset:2048 sc1
    s_waitcnt lgkmcnt(8)
    v_add3_u32 v60, v60, v104, v106
    v_add3_u32 v61, v61, v105, v107
    v_add3_u32 v60, v60, v108, v110
    v_add3_u32 v61, v61, v109, v111
    s_waitcnt vmcnt(2)
    v_lshlrev_b32_sdwa v104, 3, v122 dst_sel:DWORD dst_unused:UNUSED_PAD src0_sel:DWORD src1_sel:WORD_0
    v_lshlrev_b32_sdwa v106, 3, v122 dst_sel:DWORD dst_unused:UNUSED_PAD src0_sel:DWORD src1_sel:WORD_1
    ds_read_b64 v[104:105], v104
    ds_read_b64 v[106:107], v106
    v_lshlrev_b32_sdwa v108, 3, v123 dst_sel:DWORD dst_unused:UNUSED_PAD src0_sel:DWORD src1_sel:WORD_0
    v_lshlrev_b32_sdwa v110, 3, v123 dst_sel:DWORD dst_unused:UNUSED_PAD src0_sel:DWORD src1_sel:WORD_1
    ds_read_b64 v[108:109], v108
    ds_read_b64 v[110:111], v110
    s_waitcnt lgkmcnt(8)
    v_add3_u32 v62, v62, v88, v90
    v_add3_u32 v63, v63, v89, v91
    v_add3_u32 v62, v62, v92, v94
    v_add3_u32 v63, v63, v93, v95
    s_barrier
    s_setprio 3
    v_lshlrev_b32_sdwa v88, 3, v120 dst_sel:DWORD dst_unused:UNUSED_PAD src0_sel:DWORD src1_sel:WORD_0
    v_lshlrev_b32_sdwa v90, 3, v120 dst_sel:DWORD dst_unused:UNUSED_PAD src0_sel:DWORD src1_sel:WORD_1
    ds_read_b64 v[88:89], v88
    ds_read_b64 v[90:91], v90
    v_lshlrev_b32_sdwa v92, 3, v121 dst_sel:DWORD dst_unused:UNUSED_PAD src0_sel:DWORD src1_sel:WORD_0
    v_lshlrev_b32_sdwa v94, 3, v121 dst_sel:DWORD dst_unused:UNUSED_PAD src0_sel:DWORD src1_sel:WORD_1
    ds_read_b64 v[92:93], v92
    ds_read_b64 v[94:95], v94
    buffer_load_dwordx4 v[120:123], v71, s[12:15], s20 offen offset:3072 sc1
    s_waitcnt lgkmcnt(8)
    v_add3_u32 v62, v62, v96, v98
    v_add3_u32 v63, v63, v97, v99
    v_add3_u32 v62, v62, v100, v102
    v_add3_u32 v63, v63, v101, v103
    v_mfma_f32_16x16x32_bf16 v[112:115], v[72:75], v[128:131], v[66:69]
    s_waitcnt vmcnt(2)
    v_lshlrev_b32_sdwa v96, 3, v126 dst_sel:DWORD dst_unused:UNUSED_PAD src0_sel:DWORD src1_sel:WORD_0
    v_lshlrev_b32_sdwa v98, 3, v126 dst_sel:DWORD dst_unused:UNUSED_PAD src0_sel:DWORD src1_sel:WORD_1
    ds_read_b64 v[96:97], v96
    ds_read_b64 v[98:99], v98
    v_mfma_f32_16x16x32_bf16 v[112:115], v[76:79], v[132:135], v[112:115]
    v_lshlrev_b32_sdwa v100, 3, v127 dst_sel:DWORD dst_unused:UNUSED_PAD src0_sel:DWORD src1_sel:WORD_0
    v_lshlrev_b32_sdwa v102, 3, v127 dst_sel:DWORD dst_unused:UNUSED_PAD src0_sel:DWORD src1_sel:WORD_1
    ds_read_b64 v[100:101], v100
    ds_read_b64 v[102:103], v102
    s_waitcnt lgkmcnt(8)
    v_add3_u32 v0, v0, v104, v106
    v_add3_u32 v1, v1, v105, v107
    v_add3_u32 v0, v0, v108, v110
    v_add3_u32 v1, v1, v109, v111
    v_mfma_f32_16x16x32_bf16 v[112:115], v[80:83], v[136:139], v[112:115]
    v_lshlrev_b32_sdwa v104, 3, v124 dst_sel:DWORD dst_unused:UNUSED_PAD src0_sel:DWORD src1_sel:WORD_0
    v_lshlrev_b32_sdwa v106, 3, v124 dst_sel:DWORD dst_unused:UNUSED_PAD src0_sel:DWORD src1_sel:WORD_1
    ds_read_b64 v[104:105], v104
    ds_read_b64 v[106:107], v106
    v_mfma_f32_16x16x32_bf16 v[112:115], v[84:87], v[140:143], v[112:115]
    v_lshlrev_b32_sdwa v108, 3, v125 dst_sel:DWORD dst_unused:UNUSED_PAD src0_sel:DWORD src1_sel:WORD_0
    v_lshlrev_b32_sdwa v110, 3, v125 dst_sel:DWORD dst_unused:UNUSED_PAD src0_sel:DWORD src1_sel:WORD_1
    ds_read_b64 v[108:109], v108
    ds_read_b64 v[110:111], v110
    s_add_u32 s20, s20, 0x1000
    buffer_load_dwordx4 v[124:127], v71, s[12:15], s20 offen offset:0 sc1
    s_waitcnt lgkmcnt(8)
    v_add3_u32 v0, v0, v88, v90
    v_add3_u32 v1, v1, v89, v91
    v_add3_u32 v0, v0, v92, v94
    v_add3_u32 v1, v1, v93, v95
    v_perm_b32 v112, v113, v112, s23
    v_perm_b32 v113, v115, v114, s23
    ds_write_b64 v70, v[112:113] offset:32768
    s_waitcnt vmcnt(2)
    v_lshlrev_b32_sdwa v88, 3, v118 dst_sel:DWORD dst_unused:UNUSED_PAD src0_sel:DWORD src1_sel:WORD_0
    v_lshlrev_b32_sdwa v90, 3, v118 dst_sel:DWORD dst_unused:UNUSED_PAD src0_sel:DWORD src1_sel:WORD_1
    ds_read_b64 v[88:89], v88
    ds_read_b64 v[90:91], v90
    v_lshlrev_b32_sdwa v92, 3, v119 dst_sel:DWORD dst_unused:UNUSED_PAD src0_sel:DWORD src1_sel:WORD_0
    v_lshlrev_b32_sdwa v94, 3, v119 dst_sel:DWORD dst_unused:UNUSED_PAD src0_sel:DWORD src1_sel:WORD_1
    ds_read_b64 v[92:93], v92
    ds_read_b64 v[94:95], v94
    s_waitcnt lgkmcnt(9)
    v_add3_u32 v2, v2, v96, v98
    v_add3_u32 v3, v3, v97, v99
    v_add3_u32 v2, v2, v100, v102
    v_add3_u32 v3, v3, v101, v103
    v_mfma_f32_16x16x32_bf16 v[112:115], v[72:75], v[144:147], v[66:69]
    v_lshlrev_b32_sdwa v96, 3, v116 dst_sel:DWORD dst_unused:UNUSED_PAD src0_sel:DWORD src1_sel:WORD_0
    v_lshlrev_b32_sdwa v98, 3, v116 dst_sel:DWORD dst_unused:UNUSED_PAD src0_sel:DWORD src1_sel:WORD_1
    ds_read_b64 v[96:97], v96
    ds_read_b64 v[98:99], v98
    v_mfma_f32_16x16x32_bf16 v[112:115], v[76:79], v[148:151], v[112:115]
    v_lshlrev_b32_sdwa v100, 3, v117 dst_sel:DWORD dst_unused:UNUSED_PAD src0_sel:DWORD src1_sel:WORD_0
    v_lshlrev_b32_sdwa v102, 3, v117 dst_sel:DWORD dst_unused:UNUSED_PAD src0_sel:DWORD src1_sel:WORD_1
    ds_read_b64 v[100:101], v100
    ds_read_b64 v[102:103], v102
    buffer_load_dwordx4 v[116:119], v71, s[12:15], s20 offen offset:1024 sc1
    s_waitcnt lgkmcnt(9)
    v_add3_u32 v2, v2, v104, v106
    v_add3_u32 v3, v3, v105, v107
    v_add3_u32 v2, v2, v108, v110
    v_add3_u32 v3, v3, v109, v111
    v_mfma_f32_16x16x32_bf16 v[112:115], v[80:83], v[152:155], v[112:115]
    s_waitcnt vmcnt(2)
    v_lshlrev_b32_sdwa v104, 3, v122 dst_sel:DWORD dst_unused:UNUSED_PAD src0_sel:DWORD src1_sel:WORD_0
    v_lshlrev_b32_sdwa v106, 3, v122 dst_sel:DWORD dst_unused:UNUSED_PAD src0_sel:DWORD src1_sel:WORD_1
    ds_read_b64 v[104:105], v104
    ds_read_b64 v[106:107], v106
    v_mfma_f32_16x16x32_bf16 v[112:115], v[84:87], v[156:159], v[112:115]
    v_lshlrev_b32_sdwa v108, 3, v123 dst_sel:DWORD dst_unused:UNUSED_PAD src0_sel:DWORD src1_sel:WORD_0
    v_lshlrev_b32_sdwa v110, 3, v123 dst_sel:DWORD dst_unused:UNUSED_PAD src0_sel:DWORD src1_sel:WORD_1
    ds_read_b64 v[108:109], v108
    ds_read_b64 v[110:111], v110
    s_waitcnt lgkmcnt(8)
    v_add3_u32 v4, v4, v88, v90
    v_add3_u32 v5, v5, v89, v91
    v_add3_u32 v4, v4, v92, v94
    v_add3_u32 v5, v5, v93, v95
    v_perm_b32 v112, v113, v112, s23
    v_perm_b32 v113, v115, v114, s23
    ds_write_b64 v70, v[112:113] offset:32896
    v_lshlrev_b32_sdwa v88, 3, v120 dst_sel:DWORD dst_unused:UNUSED_PAD src0_sel:DWORD src1_sel:WORD_0
    v_lshlrev_b32_sdwa v90, 3, v120 dst_sel:DWORD dst_unused:UNUSED_PAD src0_sel:DWORD src1_sel:WORD_1
    ds_read_b64 v[88:89], v88
    ds_read_b64 v[90:91], v90
    v_lshlrev_b32_sdwa v92, 3, v121 dst_sel:DWORD dst_unused:UNUSED_PAD src0_sel:DWORD src1_sel:WORD_0
    v_lshlrev_b32_sdwa v94, 3, v121 dst_sel:DWORD dst_unused:UNUSED_PAD src0_sel:DWORD src1_sel:WORD_1
    ds_read_b64 v[92:93], v92
    ds_read_b64 v[94:95], v94
    buffer_load_dwordx4 v[120:123], v71, s[12:15], s20 offen offset:2048 sc1
    s_waitcnt lgkmcnt(9)
    v_add3_u32 v4, v4, v96, v98
    v_add3_u32 v5, v5, v97, v99
    v_add3_u32 v4, v4, v100, v102
    v_add3_u32 v5, v5, v101, v103
    v_mfma_f32_16x16x32_bf16 v[112:115], v[72:75], v[160:163], v[66:69]
    s_waitcnt vmcnt(2)
    v_lshlrev_b32_sdwa v96, 3, v126 dst_sel:DWORD dst_unused:UNUSED_PAD src0_sel:DWORD src1_sel:WORD_0
    v_lshlrev_b32_sdwa v98, 3, v126 dst_sel:DWORD dst_unused:UNUSED_PAD src0_sel:DWORD src1_sel:WORD_1
    ds_read_b64 v[96:97], v96
    ds_read_b64 v[98:99], v98
    v_mfma_f32_16x16x32_bf16 v[112:115], v[76:79], v[164:167], v[112:115]
    v_lshlrev_b32_sdwa v100, 3, v127 dst_sel:DWORD dst_unused:UNUSED_PAD src0_sel:DWORD src1_sel:WORD_0
    v_lshlrev_b32_sdwa v102, 3, v127 dst_sel:DWORD dst_unused:UNUSED_PAD src0_sel:DWORD src1_sel:WORD_1
    ds_read_b64 v[100:101], v100
    ds_read_b64 v[102:103], v102
    s_waitcnt lgkmcnt(9)
    v_add3_u32 v6, v6, v104, v106
    v_add3_u32 v7, v7, v105, v107
    v_add3_u32 v6, v6, v108, v110
    v_add3_u32 v7, v7, v109, v111
    v_mfma_f32_16x16x32_bf16 v[112:115], v[80:83], v[168:171], v[112:115]
    v_lshlrev_b32_sdwa v104, 3, v124 dst_sel:DWORD dst_unused:UNUSED_PAD src0_sel:DWORD src1_sel:WORD_0
    v_lshlrev_b32_sdwa v106, 3, v124 dst_sel:DWORD dst_unused:UNUSED_PAD src0_sel:DWORD src1_sel:WORD_1
    ds_read_b64 v[104:105], v104
    ds_read_b64 v[106:107], v106
    v_mfma_f32_16x16x32_bf16 v[112:115], v[84:87], v[172:175], v[112:115]
    v_lshlrev_b32_sdwa v108, 3, v125 dst_sel:DWORD dst_unused:UNUSED_PAD src0_sel:DWORD src1_sel:WORD_0
    v_lshlrev_b32_sdwa v110, 3, v125 dst_sel:DWORD dst_unused:UNUSED_PAD src0_sel:DWORD src1_sel:WORD_1
    ds_read_b64 v[108:109], v108
    ds_read_b64 v[110:111], v110
    buffer_load_dwordx4 v[124:127], v71, s[12:15], s20 offen offset:3072 sc1
    s_waitcnt lgkmcnt(8)
    v_add3_u32 v6, v6, v88, v90
    v_add3_u32 v7, v7, v89, v91
    v_add3_u32 v6, v6, v92, v94
    v_add3_u32 v7, v7, v93, v95
    v_perm_b32 v112, v113, v112, s23
    v_perm_b32 v113, v115, v114, s23
    ds_write_b64 v70, v[112:113] offset:33024
    s_waitcnt vmcnt(2)
    v_lshlrev_b32_sdwa v88, 3, v118 dst_sel:DWORD dst_unused:UNUSED_PAD src0_sel:DWORD src1_sel:WORD_0
    v_lshlrev_b32_sdwa v90, 3, v118 dst_sel:DWORD dst_unused:UNUSED_PAD src0_sel:DWORD src1_sel:WORD_1
    ds_read_b64 v[88:89], v88
    ds_read_b64 v[90:91], v90
    v_lshlrev_b32_sdwa v92, 3, v119 dst_sel:DWORD dst_unused:UNUSED_PAD src0_sel:DWORD src1_sel:WORD_0
    v_lshlrev_b32_sdwa v94, 3, v119 dst_sel:DWORD dst_unused:UNUSED_PAD src0_sel:DWORD src1_sel:WORD_1
    ds_read_b64 v[92:93], v92
    ds_read_b64 v[94:95], v94
    s_waitcnt lgkmcnt(9)
    v_add3_u32 v8, v8, v96, v98
    v_add3_u32 v9, v9, v97, v99
    v_add3_u32 v8, v8, v100, v102
    v_add3_u32 v9, v9, v101, v103
    v_mfma_f32_16x16x32_bf16 v[112:115], v[72:75], v[176:179], v[66:69]
    v_lshlrev_b32_sdwa v96, 3, v116 dst_sel:DWORD dst_unused:UNUSED_PAD src0_sel:DWORD src1_sel:WORD_0
    v_lshlrev_b32_sdwa v98, 3, v116 dst_sel:DWORD dst_unused:UNUSED_PAD src0_sel:DWORD src1_sel:WORD_1
    ds_read_b64 v[96:97], v96
    ds_read_b64 v[98:99], v98
    v_mfma_f32_16x16x32_bf16 v[112:115], v[76:79], v[180:183], v[112:115]
    v_lshlrev_b32_sdwa v100, 3, v117 dst_sel:DWORD dst_unused:UNUSED_PAD src0_sel:DWORD src1_sel:WORD_0
    v_lshlrev_b32_sdwa v102, 3, v117 dst_sel:DWORD dst_unused:UNUSED_PAD src0_sel:DWORD src1_sel:WORD_1
    ds_read_b64 v[100:101], v100
    ds_read_b64 v[102:103], v102
    s_add_u32 s20, s20, 0x1000
    buffer_load_dwordx4 v[116:119], v71, s[12:15], s20 offen offset:0 sc1
    s_waitcnt lgkmcnt(9)
    v_add3_u32 v8, v8, v104, v106
    v_add3_u32 v9, v9, v105, v107
    v_add3_u32 v8, v8, v108, v110
    v_add3_u32 v9, v9, v109, v111
    v_mfma_f32_16x16x32_bf16 v[112:115], v[80:83], v[184:187], v[112:115]
    s_waitcnt vmcnt(2)
    v_lshlrev_b32_sdwa v104, 3, v122 dst_sel:DWORD dst_unused:UNUSED_PAD src0_sel:DWORD src1_sel:WORD_0
    v_lshlrev_b32_sdwa v106, 3, v122 dst_sel:DWORD dst_unused:UNUSED_PAD src0_sel:DWORD src1_sel:WORD_1
    ds_read_b64 v[104:105], v104
    ds_read_b64 v[106:107], v106
    v_mfma_f32_16x16x32_bf16 v[112:115], v[84:87], v[188:191], v[112:115]
    v_lshlrev_b32_sdwa v108, 3, v123 dst_sel:DWORD dst_unused:UNUSED_PAD src0_sel:DWORD src1_sel:WORD_0
    v_lshlrev_b32_sdwa v110, 3, v123 dst_sel:DWORD dst_unused:UNUSED_PAD src0_sel:DWORD src1_sel:WORD_1
    ds_read_b64 v[108:109], v108
    ds_read_b64 v[110:111], v110
    s_waitcnt lgkmcnt(8)
    v_add3_u32 v10, v10, v88, v90
    v_add3_u32 v11, v11, v89, v91
    v_add3_u32 v10, v10, v92, v94
    v_add3_u32 v11, v11, v93, v95
    v_perm_b32 v112, v113, v112, s23
    v_perm_b32 v113, v115, v114, s23
    ds_write_b64 v70, v[112:113] offset:33152
    v_lshlrev_b32_sdwa v88, 3, v120 dst_sel:DWORD dst_unused:UNUSED_PAD src0_sel:DWORD src1_sel:WORD_0
    v_lshlrev_b32_sdwa v90, 3, v120 dst_sel:DWORD dst_unused:UNUSED_PAD src0_sel:DWORD src1_sel:WORD_1
    ds_read_b64 v[88:89], v88
    ds_read_b64 v[90:91], v90
    v_lshlrev_b32_sdwa v92, 3, v121 dst_sel:DWORD dst_unused:UNUSED_PAD src0_sel:DWORD src1_sel:WORD_0
    v_lshlrev_b32_sdwa v94, 3, v121 dst_sel:DWORD dst_unused:UNUSED_PAD src0_sel:DWORD src1_sel:WORD_1
    ds_read_b64 v[92:93], v92
    ds_read_b64 v[94:95], v94
    buffer_load_dwordx4 v[120:123], v71, s[12:15], s20 offen offset:1024 sc1
    s_waitcnt lgkmcnt(9)
    v_add3_u32 v10, v10, v96, v98
    v_add3_u32 v11, v11, v97, v99
    v_add3_u32 v10, v10, v100, v102
    v_add3_u32 v11, v11, v101, v103
    v_mfma_f32_16x16x32_bf16 v[112:115], v[72:75], v[192:195], v[66:69]
    s_waitcnt vmcnt(2)
    v_lshlrev_b32_sdwa v96, 3, v126 dst_sel:DWORD dst_unused:UNUSED_PAD src0_sel:DWORD src1_sel:WORD_0
    v_lshlrev_b32_sdwa v98, 3, v126 dst_sel:DWORD dst_unused:UNUSED_PAD src0_sel:DWORD src1_sel:WORD_1
    ds_read_b64 v[96:97], v96
    ds_read_b64 v[98:99], v98
    v_mfma_f32_16x16x32_bf16 v[112:115], v[76:79], v[196:199], v[112:115]
    v_lshlrev_b32_sdwa v100, 3, v127 dst_sel:DWORD dst_unused:UNUSED_PAD src0_sel:DWORD src1_sel:WORD_0
    v_lshlrev_b32_sdwa v102, 3, v127 dst_sel:DWORD dst_unused:UNUSED_PAD src0_sel:DWORD src1_sel:WORD_1
    ds_read_b64 v[100:101], v100
    ds_read_b64 v[102:103], v102
    s_waitcnt lgkmcnt(9)
    v_add3_u32 v12, v12, v104, v106
    v_add3_u32 v13, v13, v105, v107
    v_add3_u32 v12, v12, v108, v110
    v_add3_u32 v13, v13, v109, v111
    v_mfma_f32_16x16x32_bf16 v[112:115], v[80:83], v[200:203], v[112:115]
    v_lshlrev_b32_sdwa v104, 3, v124 dst_sel:DWORD dst_unused:UNUSED_PAD src0_sel:DWORD src1_sel:WORD_0
    v_lshlrev_b32_sdwa v106, 3, v124 dst_sel:DWORD dst_unused:UNUSED_PAD src0_sel:DWORD src1_sel:WORD_1
    ds_read_b64 v[104:105], v104
    ds_read_b64 v[106:107], v106
    v_mfma_f32_16x16x32_bf16 v[112:115], v[84:87], v[204:207], v[112:115]
    v_lshlrev_b32_sdwa v108, 3, v125 dst_sel:DWORD dst_unused:UNUSED_PAD src0_sel:DWORD src1_sel:WORD_0
    v_lshlrev_b32_sdwa v110, 3, v125 dst_sel:DWORD dst_unused:UNUSED_PAD src0_sel:DWORD src1_sel:WORD_1
    ds_read_b64 v[108:109], v108
    ds_read_b64 v[110:111], v110
    buffer_load_dwordx4 v[124:127], v71, s[12:15], s20 offen offset:2048 sc1
    s_waitcnt lgkmcnt(8)
    v_add3_u32 v12, v12, v88, v90
    v_add3_u32 v13, v13, v89, v91
    v_add3_u32 v12, v12, v92, v94
    v_add3_u32 v13, v13, v93, v95
    v_perm_b32 v112, v113, v112, s23
    v_perm_b32 v113, v115, v114, s23
    ds_write_b64 v70, v[112:113] offset:33280
    s_waitcnt vmcnt(2)
    v_lshlrev_b32_sdwa v88, 3, v118 dst_sel:DWORD dst_unused:UNUSED_PAD src0_sel:DWORD src1_sel:WORD_0
    v_lshlrev_b32_sdwa v90, 3, v118 dst_sel:DWORD dst_unused:UNUSED_PAD src0_sel:DWORD src1_sel:WORD_1
    ds_read_b64 v[88:89], v88
    ds_read_b64 v[90:91], v90
    v_lshlrev_b32_sdwa v92, 3, v119 dst_sel:DWORD dst_unused:UNUSED_PAD src0_sel:DWORD src1_sel:WORD_0
    v_lshlrev_b32_sdwa v94, 3, v119 dst_sel:DWORD dst_unused:UNUSED_PAD src0_sel:DWORD src1_sel:WORD_1
    ds_read_b64 v[92:93], v92
    ds_read_b64 v[94:95], v94
    s_waitcnt lgkmcnt(9)
    v_add3_u32 v14, v14, v96, v98
    v_add3_u32 v15, v15, v97, v99
    v_add3_u32 v14, v14, v100, v102
    v_add3_u32 v15, v15, v101, v103
    s_setprio 2
    v_mfma_f32_16x16x32_bf16 v[112:115], v[72:75], v[208:211], v[66:69]
    v_lshlrev_b32_sdwa v96, 3, v116 dst_sel:DWORD dst_unused:UNUSED_PAD src0_sel:DWORD src1_sel:WORD_0
    v_lshlrev_b32_sdwa v98, 3, v116 dst_sel:DWORD dst_unused:UNUSED_PAD src0_sel:DWORD src1_sel:WORD_1
    ds_read_b64 v[96:97], v96
    ds_read_b64 v[98:99], v98
    v_mfma_f32_16x16x32_bf16 v[112:115], v[76:79], v[212:215], v[112:115]
    v_lshlrev_b32_sdwa v100, 3, v117 dst_sel:DWORD dst_unused:UNUSED_PAD src0_sel:DWORD src1_sel:WORD_0
    v_lshlrev_b32_sdwa v102, 3, v117 dst_sel:DWORD dst_unused:UNUSED_PAD src0_sel:DWORD src1_sel:WORD_1
    ds_read_b64 v[100:101], v100
    ds_read_b64 v[102:103], v102
    buffer_load_dwordx4 v[116:119], v71, s[12:15], s20 offen offset:3072 sc1
    s_waitcnt lgkmcnt(9)
    v_add3_u32 v14, v14, v104, v106
    v_add3_u32 v15, v15, v105, v107
    v_add3_u32 v14, v14, v108, v110
    v_add3_u32 v15, v15, v109, v111
    v_mfma_f32_16x16x32_bf16 v[112:115], v[80:83], v[216:219], v[112:115]
    s_waitcnt vmcnt(2)
    v_lshlrev_b32_sdwa v104, 3, v122 dst_sel:DWORD dst_unused:UNUSED_PAD src0_sel:DWORD src1_sel:WORD_0
    v_lshlrev_b32_sdwa v106, 3, v122 dst_sel:DWORD dst_unused:UNUSED_PAD src0_sel:DWORD src1_sel:WORD_1
    ds_read_b64 v[104:105], v104
    ds_read_b64 v[106:107], v106
    v_mfma_f32_16x16x32_bf16 v[112:115], v[84:87], v[220:223], v[112:115]
    v_lshlrev_b32_sdwa v108, 3, v123 dst_sel:DWORD dst_unused:UNUSED_PAD src0_sel:DWORD src1_sel:WORD_0
    v_lshlrev_b32_sdwa v110, 3, v123 dst_sel:DWORD dst_unused:UNUSED_PAD src0_sel:DWORD src1_sel:WORD_1
    ds_read_b64 v[108:109], v108
    ds_read_b64 v[110:111], v110
    s_waitcnt lgkmcnt(8)
    v_add3_u32 v16, v16, v88, v90
    v_add3_u32 v17, v17, v89, v91
    v_add3_u32 v16, v16, v92, v94
    v_add3_u32 v17, v17, v93, v95
    v_perm_b32 v112, v113, v112, s23
    v_perm_b32 v113, v115, v114, s23
    ds_write_b64 v70, v[112:113] offset:33408
    v_lshlrev_b32_sdwa v88, 3, v120 dst_sel:DWORD dst_unused:UNUSED_PAD src0_sel:DWORD src1_sel:WORD_0
    v_lshlrev_b32_sdwa v90, 3, v120 dst_sel:DWORD dst_unused:UNUSED_PAD src0_sel:DWORD src1_sel:WORD_1
    ds_read_b64 v[88:89], v88
    ds_read_b64 v[90:91], v90
    v_lshlrev_b32_sdwa v92, 3, v121 dst_sel:DWORD dst_unused:UNUSED_PAD src0_sel:DWORD src1_sel:WORD_0
    v_lshlrev_b32_sdwa v94, 3, v121 dst_sel:DWORD dst_unused:UNUSED_PAD src0_sel:DWORD src1_sel:WORD_1
    ds_read_b64 v[92:93], v92
    ds_read_b64 v[94:95], v94
    s_add_u32 s20, s20, 0x1000
    buffer_load_dwordx4 v[120:123], v71, s[12:15], s20 offen offset:0 sc1
    s_waitcnt lgkmcnt(9)
    v_add3_u32 v16, v16, v96, v98
    v_add3_u32 v17, v17, v97, v99
    v_add3_u32 v16, v16, v100, v102
    v_add3_u32 v17, v17, v101, v103
    v_mfma_f32_16x16x32_bf16 v[112:115], v[72:75], v[224:227], v[66:69]
    s_waitcnt vmcnt(2)
    v_lshlrev_b32_sdwa v96, 3, v126 dst_sel:DWORD dst_unused:UNUSED_PAD src0_sel:DWORD src1_sel:WORD_0
    v_lshlrev_b32_sdwa v98, 3, v126 dst_sel:DWORD dst_unused:UNUSED_PAD src0_sel:DWORD src1_sel:WORD_1
    ds_read_b64 v[96:97], v96
    ds_read_b64 v[98:99], v98
    v_mfma_f32_16x16x32_bf16 v[112:115], v[76:79], v[228:231], v[112:115]
    v_lshlrev_b32_sdwa v100, 3, v127 dst_sel:DWORD dst_unused:UNUSED_PAD src0_sel:DWORD src1_sel:WORD_0
    v_lshlrev_b32_sdwa v102, 3, v127 dst_sel:DWORD dst_unused:UNUSED_PAD src0_sel:DWORD src1_sel:WORD_1
    ds_read_b64 v[100:101], v100
    ds_read_b64 v[102:103], v102
    s_waitcnt lgkmcnt(9)
    v_add3_u32 v18, v18, v104, v106
    v_add3_u32 v19, v19, v105, v107
    v_add3_u32 v18, v18, v108, v110
    v_add3_u32 v19, v19, v109, v111
    v_mfma_f32_16x16x32_bf16 v[112:115], v[80:83], v[232:235], v[112:115]
    v_lshlrev_b32_sdwa v104, 3, v124 dst_sel:DWORD dst_unused:UNUSED_PAD src0_sel:DWORD src1_sel:WORD_0
    v_lshlrev_b32_sdwa v106, 3, v124 dst_sel:DWORD dst_unused:UNUSED_PAD src0_sel:DWORD src1_sel:WORD_1
    ds_read_b64 v[104:105], v104
    ds_read_b64 v[106:107], v106
    v_mfma_f32_16x16x32_bf16 v[112:115], v[84:87], v[236:239], v[112:115]
    v_lshlrev_b32_sdwa v108, 3, v125 dst_sel:DWORD dst_unused:UNUSED_PAD src0_sel:DWORD src1_sel:WORD_0
    v_lshlrev_b32_sdwa v110, 3, v125 dst_sel:DWORD dst_unused:UNUSED_PAD src0_sel:DWORD src1_sel:WORD_1
    ds_read_b64 v[108:109], v108
    ds_read_b64 v[110:111], v110
    buffer_load_dwordx4 v[124:127], v71, s[12:15], s20 offen offset:1024 sc1
    s_waitcnt lgkmcnt(8)
    v_add3_u32 v18, v18, v88, v90
    v_add3_u32 v19, v19, v89, v91
    v_add3_u32 v18, v18, v92, v94
    v_add3_u32 v19, v19, v93, v95
    v_perm_b32 v112, v113, v112, s23
    v_perm_b32 v113, v115, v114, s23
    ds_write_b64 v70, v[112:113] offset:33536
    s_waitcnt vmcnt(2)
    v_lshlrev_b32_sdwa v88, 3, v118 dst_sel:DWORD dst_unused:UNUSED_PAD src0_sel:DWORD src1_sel:WORD_0
    v_lshlrev_b32_sdwa v90, 3, v118 dst_sel:DWORD dst_unused:UNUSED_PAD src0_sel:DWORD src1_sel:WORD_1
    ds_read_b64 v[88:89], v88
    ds_read_b64 v[90:91], v90
    v_lshlrev_b32_sdwa v92, 3, v119 dst_sel:DWORD dst_unused:UNUSED_PAD src0_sel:DWORD src1_sel:WORD_0
    v_lshlrev_b32_sdwa v94, 3, v119 dst_sel:DWORD dst_unused:UNUSED_PAD src0_sel:DWORD src1_sel:WORD_1
    ds_read_b64 v[92:93], v92
    ds_read_b64 v[94:95], v94
    s_waitcnt lgkmcnt(9)
    v_add3_u32 v20, v20, v96, v98
    v_add3_u32 v21, v21, v97, v99
    v_add3_u32 v20, v20, v100, v102
    v_add3_u32 v21, v21, v101, v103
    v_mfma_f32_16x16x32_bf16 v[112:115], v[72:75], v[240:243], v[66:69]
    buffer_load_dwordx4 v[72:75], v71, s[12:15], s21 offen offset:0
    v_lshlrev_b32_sdwa v96, 3, v116 dst_sel:DWORD dst_unused:UNUSED_PAD src0_sel:DWORD src1_sel:WORD_0
    v_lshlrev_b32_sdwa v98, 3, v116 dst_sel:DWORD dst_unused:UNUSED_PAD src0_sel:DWORD src1_sel:WORD_1
    ds_read_b64 v[96:97], v96
    ds_read_b64 v[98:99], v98
    v_mfma_f32_16x16x32_bf16 v[112:115], v[76:79], v[244:247], v[112:115]
    buffer_load_dwordx4 v[76:79], v71, s[12:15], s21 offen offset:1024
    v_lshlrev_b32_sdwa v100, 3, v117 dst_sel:DWORD dst_unused:UNUSED_PAD src0_sel:DWORD src1_sel:WORD_0
    v_lshlrev_b32_sdwa v102, 3, v117 dst_sel:DWORD dst_unused:UNUSED_PAD src0_sel:DWORD src1_sel:WORD_1
    ds_read_b64 v[100:101], v100
    ds_read_b64 v[102:103], v102
    buffer_load_dwordx4 v[116:119], v71, s[12:15], s20 offen offset:2048 sc1
    s_waitcnt lgkmcnt(9)
    v_add3_u32 v20, v20, v104, v106
    v_add3_u32 v21, v21, v105, v107
    v_add3_u32 v20, v20, v108, v110
    v_add3_u32 v21, v21, v109, v111
    v_mfma_f32_16x16x32_bf16 v[112:115], v[80:83], v[248:251], v[112:115]
    buffer_load_dwordx4 v[80:83], v71, s[12:15], s19 offen offset:0
    s_waitcnt vmcnt(5)
    v_lshlrev_b32_sdwa v104, 3, v122 dst_sel:DWORD dst_unused:UNUSED_PAD src0_sel:DWORD src1_sel:WORD_0
    v_lshlrev_b32_sdwa v106, 3, v122 dst_sel:DWORD dst_unused:UNUSED_PAD src0_sel:DWORD src1_sel:WORD_1
    ds_read_b64 v[104:105], v104
    ds_read_b64 v[106:107], v106
    v_mfma_f32_16x16x32_bf16 v[112:115], v[84:87], v[252:255], v[112:115]
    buffer_load_dwordx4 v[84:87], v71, s[12:15], s19 offen offset:1024
    s_add_u32 s21, s21, 4096
    s_add_u32 s19, s19, 4096
    v_lshlrev_b32_sdwa v108, 3, v123 dst_sel:DWORD dst_unused:UNUSED_PAD src0_sel:DWORD src1_sel:WORD_0
    v_lshlrev_b32_sdwa v110, 3, v123 dst_sel:DWORD dst_unused:UNUSED_PAD src0_sel:DWORD src1_sel:WORD_1
    ds_read_b64 v[108:109], v108
    ds_read_b64 v[110:111], v110
    s_waitcnt lgkmcnt(8)
    v_add3_u32 v22, v22, v88, v90
    v_add3_u32 v23, v23, v89, v91
    v_add3_u32 v22, v22, v92, v94
    v_add3_u32 v23, v23, v93, v95
    v_perm_b32 v112, v113, v112, s23
    v_perm_b32 v113, v115, v114, s23
    ds_write_b64 v70, v[112:113] offset:33664
    s_setprio 1
    v_lshlrev_b32_sdwa v88, 3, v120 dst_sel:DWORD dst_unused:UNUSED_PAD src0_sel:DWORD src1_sel:WORD_0
    v_lshlrev_b32_sdwa v90, 3, v120 dst_sel:DWORD dst_unused:UNUSED_PAD src0_sel:DWORD src1_sel:WORD_1
    ds_read_b64 v[88:89], v88
    ds_read_b64 v[90:91], v90
    v_lshlrev_b32_sdwa v92, 3, v121 dst_sel:DWORD dst_unused:UNUSED_PAD src0_sel:DWORD src1_sel:WORD_0
    v_lshlrev_b32_sdwa v94, 3, v121 dst_sel:DWORD dst_unused:UNUSED_PAD src0_sel:DWORD src1_sel:WORD_1
    ds_read_b64 v[92:93], v92
    ds_read_b64 v[94:95], v94
    buffer_load_dwordx4 v[120:123], v71, s[12:15], s20 offen offset:3072 sc1
    s_waitcnt lgkmcnt(9)
    v_add3_u32 v22, v22, v96, v98
    v_add3_u32 v23, v23, v97, v99
    v_add3_u32 v22, v22, v100, v102
    v_add3_u32 v23, v23, v101, v103
    s_waitcnt vmcnt(6)
    v_lshlrev_b32_sdwa v96, 3, v126 dst_sel:DWORD dst_unused:UNUSED_PAD src0_sel:DWORD src1_sel:WORD_0
    v_lshlrev_b32_sdwa v98, 3, v126 dst_sel:DWORD dst_unused:UNUSED_PAD src0_sel:DWORD src1_sel:WORD_1
    ds_read_b64 v[96:97], v96
    ds_read_b64 v[98:99], v98
    v_lshlrev_b32_sdwa v100, 3, v127 dst_sel:DWORD dst_unused:UNUSED_PAD src0_sel:DWORD src1_sel:WORD_0
    v_lshlrev_b32_sdwa v102, 3, v127 dst_sel:DWORD dst_unused:UNUSED_PAD src0_sel:DWORD src1_sel:WORD_1
    ds_read_b64 v[100:101], v100
    ds_read_b64 v[102:103], v102
    s_waitcnt lgkmcnt(9)
    v_add3_u32 v24, v24, v104, v106
    v_add3_u32 v25, v25, v105, v107
    v_add3_u32 v24, v24, v108, v110
    v_add3_u32 v25, v25, v109, v111
    v_lshlrev_b32_sdwa v104, 3, v124 dst_sel:DWORD dst_unused:UNUSED_PAD src0_sel:DWORD src1_sel:WORD_0
    v_lshlrev_b32_sdwa v106, 3, v124 dst_sel:DWORD dst_unused:UNUSED_PAD src0_sel:DWORD src1_sel:WORD_1
    ds_read_b64 v[104:105], v104
    ds_read_b64 v[106:107], v106
    v_lshlrev_b32_sdwa v108, 3, v125 dst_sel:DWORD dst_unused:UNUSED_PAD src0_sel:DWORD src1_sel:WORD_0
    v_lshlrev_b32_sdwa v110, 3, v125 dst_sel:DWORD dst_unused:UNUSED_PAD src0_sel:DWORD src1_sel:WORD_1
    ds_read_b64 v[108:109], v108
    ds_read_b64 v[110:111], v110
    s_add_u32 s20, s20, 0x1d000
    buffer_load_dwordx4 v[124:127], v71, s[12:15], s20 offen offset:0 sc1
    s_waitcnt lgkmcnt(8)
    v_add3_u32 v24, v24, v88, v90
    v_add3_u32 v25, v25, v89, v91
    v_add3_u32 v24, v24, v92, v94
    v_add3_u32 v25, v25, v93, v95
    s_waitcnt vmcnt(4)
    v_lshlrev_b32_sdwa v88, 3, v118 dst_sel:DWORD dst_unused:UNUSED_PAD src0_sel:DWORD src1_sel:WORD_0
    v_lshlrev_b32_sdwa v90, 3, v118 dst_sel:DWORD dst_unused:UNUSED_PAD src0_sel:DWORD src1_sel:WORD_1
    ds_read_b64 v[88:89], v88
    ds_read_b64 v[90:91], v90
    v_lshlrev_b32_sdwa v92, 3, v119 dst_sel:DWORD dst_unused:UNUSED_PAD src0_sel:DWORD src1_sel:WORD_0
    v_lshlrev_b32_sdwa v94, 3, v119 dst_sel:DWORD dst_unused:UNUSED_PAD src0_sel:DWORD src1_sel:WORD_1
    ds_read_b64 v[92:93], v92
    ds_read_b64 v[94:95], v94
    s_waitcnt lgkmcnt(8)
    v_add3_u32 v26, v26, v96, v98
    v_add3_u32 v27, v27, v97, v99
    v_add3_u32 v26, v26, v100, v102
    v_add3_u32 v27, v27, v101, v103
    v_lshlrev_b32_sdwa v96, 3, v116 dst_sel:DWORD dst_unused:UNUSED_PAD src0_sel:DWORD src1_sel:WORD_0
    v_lshlrev_b32_sdwa v98, 3, v116 dst_sel:DWORD dst_unused:UNUSED_PAD src0_sel:DWORD src1_sel:WORD_1
    ds_read_b64 v[96:97], v96
    ds_read_b64 v[98:99], v98
    v_lshlrev_b32_sdwa v100, 3, v117 dst_sel:DWORD dst_unused:UNUSED_PAD src0_sel:DWORD src1_sel:WORD_0
    v_lshlrev_b32_sdwa v102, 3, v117 dst_sel:DWORD dst_unused:UNUSED_PAD src0_sel:DWORD src1_sel:WORD_1
    ds_read_b64 v[100:101], v100
    ds_read_b64 v[102:103], v102
    buffer_load_dwordx4 v[116:119], v71, s[12:15], s20 offen offset:1024 sc1
    s_waitcnt lgkmcnt(8)
    v_add3_u32 v26, v26, v104, v106
    v_add3_u32 v27, v27, v105, v107
    v_add3_u32 v26, v26, v108, v110
    v_add3_u32 v27, v27, v109, v111
    s_waitcnt vmcnt(2)
    v_lshlrev_b32_sdwa v104, 3, v122 dst_sel:DWORD dst_unused:UNUSED_PAD src0_sel:DWORD src1_sel:WORD_0
    v_lshlrev_b32_sdwa v106, 3, v122 dst_sel:DWORD dst_unused:UNUSED_PAD src0_sel:DWORD src1_sel:WORD_1
    ds_read_b64 v[104:105], v104
    ds_read_b64 v[106:107], v106
    v_lshlrev_b32_sdwa v108, 3, v123 dst_sel:DWORD dst_unused:UNUSED_PAD src0_sel:DWORD src1_sel:WORD_0
    v_lshlrev_b32_sdwa v110, 3, v123 dst_sel:DWORD dst_unused:UNUSED_PAD src0_sel:DWORD src1_sel:WORD_1
    ds_read_b64 v[108:109], v108
    ds_read_b64 v[110:111], v110
    s_waitcnt lgkmcnt(8)
    v_add3_u32 v28, v28, v88, v90
    v_add3_u32 v29, v29, v89, v91
    v_add3_u32 v28, v28, v92, v94
    v_add3_u32 v29, v29, v93, v95
    s_setprio 0
    v_lshlrev_b32_sdwa v88, 3, v120 dst_sel:DWORD dst_unused:UNUSED_PAD src0_sel:DWORD src1_sel:WORD_0
    v_lshlrev_b32_sdwa v90, 3, v120 dst_sel:DWORD dst_unused:UNUSED_PAD src0_sel:DWORD src1_sel:WORD_1
    ds_read_b64 v[88:89], v88
    ds_read_b64 v[90:91], v90
    v_lshlrev_b32_sdwa v92, 3, v121 dst_sel:DWORD dst_unused:UNUSED_PAD src0_sel:DWORD src1_sel:WORD_0
    v_lshlrev_b32_sdwa v94, 3, v121 dst_sel:DWORD dst_unused:UNUSED_PAD src0_sel:DWORD src1_sel:WORD_1
    ds_read_b64 v[92:93], v92
    ds_read_b64 v[94:95], v94
    buffer_load_dwordx4 v[120:123], v71, s[12:15], s20 offen offset:2048 sc1
    s_waitcnt lgkmcnt(8)
    v_add3_u32 v28, v28, v96, v98
    v_add3_u32 v29, v29, v97, v99
    v_add3_u32 v28, v28, v100, v102
    v_add3_u32 v29, v29, v101, v103
    s_waitcnt vmcnt(2)
    v_lshlrev_b32_sdwa v96, 3, v124 dst_sel:DWORD dst_unused:UNUSED_PAD src0_sel:DWORD src1_sel:WORD_0
    v_lshlrev_b32_sdwa v98, 3, v124 dst_sel:DWORD dst_unused:UNUSED_PAD src0_sel:DWORD src1_sel:WORD_1
    ds_read_b64 v[96:97], v96
    ds_read_b64 v[98:99], v98
    v_lshlrev_b32_sdwa v100, 3, v125 dst_sel:DWORD dst_unused:UNUSED_PAD src0_sel:DWORD src1_sel:WORD_0
    v_lshlrev_b32_sdwa v102, 3, v125 dst_sel:DWORD dst_unused:UNUSED_PAD src0_sel:DWORD src1_sel:WORD_1
    ds_read_b64 v[100:101], v100
    ds_read_b64 v[102:103], v102
    s_waitcnt lgkmcnt(8)
    v_add3_u32 v30, v30, v104, v106
    v_add3_u32 v31, v31, v105, v107
    v_add3_u32 v30, v30, v108, v110
    v_add3_u32 v31, v31, v109, v111
    s_waitcnt lgkmcnt(4)
    s_barrier
    s_setprio 3
    v_lshlrev_b32_sdwa v104, 3, v126 dst_sel:DWORD dst_unused:UNUSED_PAD src0_sel:DWORD src1_sel:WORD_0
    v_lshlrev_b32_sdwa v106, 3, v126 dst_sel:DWORD dst_unused:UNUSED_PAD src0_sel:DWORD src1_sel:WORD_1
    ds_read_b64 v[104:105], v104
    ds_read_b64 v[106:107], v106
    v_lshlrev_b32_sdwa v108, 3, v127 dst_sel:DWORD dst_unused:UNUSED_PAD src0_sel:DWORD src1_sel:WORD_0
    v_lshlrev_b32_sdwa v110, 3, v127 dst_sel:DWORD dst_unused:UNUSED_PAD src0_sel:DWORD src1_sel:WORD_1
    ds_read_b64 v[108:109], v108
    ds_read_b64 v[110:111], v110
    buffer_load_dwordx4 v[124:127], v71, s[12:15], s20 offen offset:3072 sc1
    v_add3_u32 v30, v30, v88, v90
    v_add3_u32 v31, v31, v89, v91
    v_add3_u32 v30, v30, v92, v94
    v_add3_u32 v31, v31, v93, v95
    v_mfma_f32_16x16x32_bf16 v[112:115], v[72:75], v[128:131], v[66:69]
    v_mfma_f32_16x16x32_bf16 v[112:115], v[76:79], v[132:135], v[112:115]
    v_add_u32 v70, 0x10000, v70
    s_waitcnt vmcnt(2)
    v_lshlrev_b32_sdwa v88, 3, v116 dst_sel:DWORD dst_unused:UNUSED_PAD src0_sel:DWORD src1_sel:WORD_0
    v_lshlrev_b32_sdwa v90, 3, v116 dst_sel:DWORD dst_unused:UNUSED_PAD src0_sel:DWORD src1_sel:WORD_1
    ds_read_b64 v[88:89], v88
    ds_read_b64 v[90:91], v90
    v_mfma_f32_16x16x32_bf16 v[112:115], v[80:83], v[136:139], v[112:115]
    v_mfma_f32_16x16x32_bf16 v[112:115], v[84:87], v[140:143], v[112:115]
    v_lshlrev_b32_sdwa v92, 3, v117 dst_sel:DWORD dst_unused:UNUSED_PAD src0_sel:DWORD src1_sel:WORD_0
    v_lshlrev_b32_sdwa v94, 3, v117 dst_sel:DWORD dst_unused:UNUSED_PAD src0_sel:DWORD src1_sel:WORD_1
    ds_read_b64 v[92:93], v92
    ds_read_b64 v[94:95], v94
    s_waitcnt lgkmcnt(8)
    v_add3_u32 v32, v32, v96, v98
    v_add3_u32 v33, v33, v97, v99
    v_add3_u32 v32, v32, v100, v102
    v_add3_u32 v33, v33, v101, v103
    v_perm_b32 v112, v113, v112, s23
    v_perm_b32 v113, v115, v114, s23
    ds_write_b64 v70, v[112:113] offset:0
    v_mfma_f32_16x16x32_bf16 v[112:115], v[72:75], v[144:147], v[66:69]
    v_mfma_f32_16x16x32_bf16 v[112:115], v[76:79], v[148:151], v[112:115]
    v_lshlrev_b32_sdwa v96, 3, v118 dst_sel:DWORD dst_unused:UNUSED_PAD src0_sel:DWORD src1_sel:WORD_0
    v_lshlrev_b32_sdwa v98, 3, v118 dst_sel:DWORD dst_unused:UNUSED_PAD src0_sel:DWORD src1_sel:WORD_1
    ds_read_b64 v[96:97], v96
    ds_read_b64 v[98:99], v98
    v_mfma_f32_16x16x32_bf16 v[112:115], v[80:83], v[152:155], v[112:115]
    v_mfma_f32_16x16x32_bf16 v[112:115], v[84:87], v[156:159], v[112:115]
    v_lshlrev_b32_sdwa v100, 3, v119 dst_sel:DWORD dst_unused:UNUSED_PAD src0_sel:DWORD src1_sel:WORD_0
    v_lshlrev_b32_sdwa v102, 3, v119 dst_sel:DWORD dst_unused:UNUSED_PAD src0_sel:DWORD src1_sel:WORD_1
    ds_read_b64 v[100:101], v100
    ds_read_b64 v[102:103], v102
    s_add_u32 s20, s20, 0x1000
    buffer_load_dwordx4 v[116:119], v71, s[12:15], s20 offen offset:0 sc1
    s_waitcnt lgkmcnt(9)
    v_add3_u32 v32, v32, v104, v106
    v_add3_u32 v33, v33, v105, v107
    v_add3_u32 v32, v32, v108, v110
    v_add3_u32 v33, v33, v109, v111
    v_perm_b32 v112, v113, v112, s23
    v_perm_b32 v113, v115, v114, s23
    ds_write_b64 v70, v[112:113] offset:128
    v_mfma_f32_16x16x32_bf16 v[112:115], v[72:75], v[160:163], v[66:69]
    v_mfma_f32_16x16x32_bf16 v[112:115], v[76:79], v[164:167], v[112:115]
    s_waitcnt vmcnt(2)
    v_lshlrev_b32_sdwa v104, 3, v120 dst_sel:DWORD dst_unused:UNUSED_PAD src0_sel:DWORD src1_sel:WORD_0
    v_lshlrev_b32_sdwa v106, 3, v120 dst_sel:DWORD dst_unused:UNUSED_PAD src0_sel:DWORD src1_sel:WORD_1
    ds_read_b64 v[104:105], v104
    ds_read_b64 v[106:107], v106
    v_mfma_f32_16x16x32_bf16 v[112:115], v[80:83], v[168:171], v[112:115]
    v_mfma_f32_16x16x32_bf16 v[112:115], v[84:87], v[172:175], v[112:115]
    v_lshlrev_b32_sdwa v108, 3, v121 dst_sel:DWORD dst_unused:UNUSED_PAD src0_sel:DWORD src1_sel:WORD_0
    v_lshlrev_b32_sdwa v110, 3, v121 dst_sel:DWORD dst_unused:UNUSED_PAD src0_sel:DWORD src1_sel:WORD_1
    ds_read_b64 v[108:109], v108
    ds_read_b64 v[110:111], v110
    s_waitcnt lgkmcnt(10)
    v_add3_u32 v34, v34, v88, v90
    v_add3_u32 v35, v35, v89, v91
    v_add3_u32 v34, v34, v92, v94
    v_add3_u32 v35, v35, v93, v95
    v_perm_b32 v112, v113, v112, s23
    v_perm_b32 v113, v115, v114, s23
    ds_write_b64 v70, v[112:113] offset:256
    v_mfma_f32_16x16x32_bf16 v[112:115], v[72:75], v[176:179], v[66:69]
    v_mfma_f32_16x16x32_bf16 v[112:115], v[76:79], v[180:183], v[112:115]
    v_lshlrev_b32_sdwa v88, 3, v122 dst_sel:DWORD dst_unused:UNUSED_PAD src0_sel:DWORD src1_sel:WORD_0
    v_lshlrev_b32_sdwa v90, 3, v122 dst_sel:DWORD dst_unused:UNUSED_PAD src0_sel:DWORD src1_sel:WORD_1
    ds_read_b64 v[88:89], v88
    ds_read_b64 v[90:91], v90
    v_mfma_f32_16x16x32_bf16 v[112:115], v[80:83], v[184:187], v[112:115]
    v_mfma_f32_16x16x32_bf16 v[112:115], v[84:87], v[188:191], v[112:115]
    v_lshlrev_b32_sdwa v92, 3, v123 dst_sel:DWORD dst_unused:UNUSED_PAD src0_sel:DWORD src1_sel:WORD_0
    v_lshlrev_b32_sdwa v94, 3, v123 dst_sel:DWORD dst_unused:UNUSED_PAD src0_sel:DWORD src1_sel:WORD_1
    ds_read_b64 v[92:93], v92
    ds_read_b64 v[94:95], v94
    buffer_load_dwordx4 v[120:123], v71, s[12:15], s20 offen offset:1024 sc1
    s_waitcnt lgkmcnt(10)
    v_add3_u32 v34, v34, v96, v98
    v_add3_u32 v35, v35, v97, v99
    v_add3_u32 v34, v34, v100, v102
    v_add3_u32 v35, v35, v101, v103
    v_perm_b32 v112, v113, v112, s23
    v_perm_b32 v113, v115, v114, s23
    ds_write_b64 v70, v[112:113] offset:384
    v_mfma_f32_16x16x32_bf16 v[112:115], v[72:75], v[192:195], v[66:69]
    v_mfma_f32_16x16x32_bf16 v[112:115], v[76:79], v[196:199], v[112:115]
    s_waitcnt vmcnt(2)
    v_lshlrev_b32_sdwa v96, 3, v124 dst_sel:DWORD dst_unused:UNUSED_PAD src0_sel:DWORD src1_sel:WORD_0
    v_lshlrev_b32_sdwa v98, 3, v124 dst_sel:DWORD dst_unused:UNUSED_PAD src0_sel:DWORD src1_sel:WORD_1
    ds_read_b64 v[96:97], v96
    ds_read_b64 v[98:99], v98
    v_mfma_f32_16x16x32_bf16 v[112:115], v[80:83], v[200:203], v[112:115]
    v_mfma_f32_16x16x32_bf16 v[112:115], v[84:87], v[204:207], v[112:115]
    v_lshlrev_b32_sdwa v100, 3, v125 dst_sel:DWORD dst_unused:UNUSED_PAD src0_sel:DWORD src1_sel:WORD_0
    v_lshlrev_b32_sdwa v102, 3, v125 dst_sel:DWORD dst_unused:UNUSED_PAD src0_sel:DWORD src1_sel:WORD_1
    ds_read_b64 v[100:101], v100
    ds_read_b64 v[102:103], v102
    s_waitcnt lgkmcnt(10)
    v_add3_u32 v36, v36, v104, v106
    v_add3_u32 v37, v37, v105, v107
    v_add3_u32 v36, v36, v108, v110
    v_add3_u32 v37, v37, v109, v111
    v_perm_b32 v112, v113, v112, s23
    v_perm_b32 v113, v115, v114, s23
    ds_write_b64 v70, v[112:113] offset:512
    v_mfma_f32_16x16x32_bf16 v[112:115], v[72:75], v[208:211], v[66:69]
    v_mfma_f32_16x16x32_bf16 v[112:115], v[76:79], v[212:215], v[112:115]
    v_lshlrev_b32_sdwa v104, 3, v126 dst_sel:DWORD dst_unused:UNUSED_PAD src0_sel:DWORD src1_sel:WORD_0
    v_lshlrev_b32_sdwa v106, 3, v126 dst_sel:DWORD dst_unused:UNUSED_PAD src0_sel:DWORD src1_sel:WORD_1
    ds_read_b64 v[104:105], v104
    ds_read_b64 v[106:107], v106
    v_mfma_f32_16x16x32_bf16 v[112:115], v[80:83], v[216:219], v[112:115]
    v_mfma_f32_16x16x32_bf16 v[112:115], v[84:87], v[220:223], v[112:115]
    v_lshlrev_b32_sdwa v108, 3, v127 dst_sel:DWORD dst_unused:UNUSED_PAD src0_sel:DWORD src1_sel:WORD_0
    v_lshlrev_b32_sdwa v110, 3, v127 dst_sel:DWORD dst_unused:UNUSED_PAD src0_sel:DWORD src1_sel:WORD_1
    ds_read_b64 v[108:109], v108
    ds_read_b64 v[110:111], v110
    buffer_load_dwordx4 v[124:127], v71, s[12:15], s20 offen offset:2048 sc1
    s_waitcnt lgkmcnt(10)
    v_add3_u32 v36, v36, v88, v90
    v_add3_u32 v37, v37, v89, v91
    v_add3_u32 v36, v36, v92, v94
    v_add3_u32 v37, v37, v93, v95
    v_perm_b32 v112, v113, v112, s23
    v_perm_b32 v113, v115, v114, s23
    ds_write_b64 v70, v[112:113] offset:640
    v_mfma_f32_16x16x32_bf16 v[112:115], v[72:75], v[224:227], v[66:69]
    v_mfma_f32_16x16x32_bf16 v[112:115], v[76:79], v[228:231], v[112:115]
    s_waitcnt vmcnt(2)
    v_lshlrev_b32_sdwa v88, 3, v116 dst_sel:DWORD dst_unused:UNUSED_PAD src0_sel:DWORD src1_sel:WORD_0
    v_lshlrev_b32_sdwa v90, 3, v116 dst_sel:DWORD dst_unused:UNUSED_PAD src0_sel:DWORD src1_sel:WORD_1
    ds_read_b64 v[88:89], v88
    ds_read_b64 v[90:91], v90
    v_mfma_f32_16x16x32_bf16 v[112:115], v[80:83], v[232:235], v[112:115]
    v_mfma_f32_16x16x32_bf16 v[112:115], v[84:87], v[236:239], v[112:115]
    v_lshlrev_b32_sdwa v92, 3, v117 dst_sel:DWORD dst_unused:UNUSED_PAD src0_sel:DWORD src1_sel:WORD_0
    v_lshlrev_b32_sdwa v94, 3, v117 dst_sel:DWORD dst_unused:UNUSED_PAD src0_sel:DWORD src1_sel:WORD_1
    ds_read_b64 v[92:93], v92
    ds_read_b64 v[94:95], v94
    s_waitcnt lgkmcnt(10)
    v_add3_u32 v38, v38, v96, v98
    v_add3_u32 v39, v39, v97, v99
    v_add3_u32 v38, v38, v100, v102
    v_add3_u32 v39, v39, v101, v103
    v_perm_b32 v112, v113, v112, s23
    v_perm_b32 v113, v115, v114, s23
    ds_write_b64 v70, v[112:113] offset:768
    v_mfma_f32_16x16x32_bf16 v[112:115], v[72:75], v[240:243], v[66:69]
    buffer_load_dwordx4 v[72:75], v71, s[12:15], s21 offen offset:0
    v_mfma_f32_16x16x32_bf16 v[112:115], v[76:79], v[244:247], v[112:115]
    buffer_load_dwordx4 v[76:79], v71, s[12:15], s21 offen offset:1024
    v_lshlrev_b32_sdwa v96, 3, v118 dst_sel:DWORD dst_unused:UNUSED_PAD src0_sel:DWORD src1_sel:WORD_0
    v_lshlrev_b32_sdwa v98, 3, v118 dst_sel:DWORD dst_unused:UNUSED_PAD src0_sel:DWORD src1_sel:WORD_1
    ds_read_b64 v[96:97], v96
    ds_read_b64 v[98:99], v98
    v_mfma_f32_16x16x32_bf16 v[112:115], v[80:83], v[248:251], v[112:115]
    buffer_load_dwordx4 v[80:83], v71, s[12:15], s19 offen offset:0
    v_mfma_f32_16x16x32_bf16 v[112:115], v[84:87], v[252:255], v[112:115]
    buffer_load_dwordx4 v[84:87], v71, s[12:15], s19 offen offset:1024
    s_add_u32 s21, s21, 4096
    s_add_u32 s19, s19, 4096
    v_lshlrev_b32_sdwa v100, 3, v119 dst_sel:DWORD dst_unused:UNUSED_PAD src0_sel:DWORD src1_sel:WORD_0
    v_lshlrev_b32_sdwa v102, 3, v119 dst_sel:DWORD dst_unused:UNUSED_PAD src0_sel:DWORD src1_sel:WORD_1
    ds_read_b64 v[100:101], v100
    ds_read_b64 v[102:103], v102
    buffer_load_dwordx4 v[116:119], v71, s[12:15], s20 offen offset:3072 sc1
    s_waitcnt lgkmcnt(10)
    v_add3_u32 v38, v38, v104, v106
    v_add3_u32 v39, v39, v105, v107
    v_add3_u32 v38, v38, v108, v110
    v_add3_u32 v39, v39, v109, v111
    v_perm_b32 v112, v113, v112, s23
    v_perm_b32 v113, v115, v114, s23
    ds_write_b64 v70, v[112:113] offset:896
    s_waitcnt vmcnt(6)
    v_lshlrev_b32_sdwa v104, 3, v120 dst_sel:DWORD dst_unused:UNUSED_PAD src0_sel:DWORD src1_sel:WORD_0
    v_lshlrev_b32_sdwa v106, 3, v120 dst_sel:DWORD dst_unused:UNUSED_PAD src0_sel:DWORD src1_sel:WORD_1
    ds_read_b64 v[104:105], v104
    ds_read_b64 v[106:107], v106
    v_lshlrev_b32_sdwa v108, 3, v121 dst_sel:DWORD dst_unused:UNUSED_PAD src0_sel:DWORD src1_sel:WORD_0
    v_lshlrev_b32_sdwa v110, 3, v121 dst_sel:DWORD dst_unused:UNUSED_PAD src0_sel:DWORD src1_sel:WORD_1
    ds_read_b64 v[108:109], v108
    ds_read_b64 v[110:111], v110
    s_waitcnt lgkmcnt(10)
    v_add3_u32 v40, v40, v88, v90
    v_add3_u32 v41, v41, v89, v91
    v_add3_u32 v40, v40, v92, v94
    v_add3_u32 v41, v41, v93, v95
    v_lshlrev_b32_sdwa v88, 3, v122 dst_sel:DWORD dst_unused:UNUSED_PAD src0_sel:DWORD src1_sel:WORD_0
    v_lshlrev_b32_sdwa v90, 3, v122 dst_sel:DWORD dst_unused:UNUSED_PAD src0_sel:DWORD src1_sel:WORD_1
    ds_read_b64 v[88:89], v88
    ds_read_b64 v[90:91], v90
    v_lshlrev_b32_sdwa v92, 3, v123 dst_sel:DWORD dst_unused:UNUSED_PAD src0_sel:DWORD src1_sel:WORD_0
    v_lshlrev_b32_sdwa v94, 3, v123 dst_sel:DWORD dst_unused:UNUSED_PAD src0_sel:DWORD src1_sel:WORD_1
    ds_read_b64 v[92:93], v92
    ds_read_b64 v[94:95], v94
    s_add_u32 s20, s20, 0x1000
    buffer_load_dwordx4 v[120:123], v71, s[12:15], s20 offen offset:0 sc1
    s_waitcnt lgkmcnt(9)
    v_add3_u32 v40, v40, v96, v98
    v_add3_u32 v41, v41, v97, v99
    v_add3_u32 v40, v40, v100, v102
    v_add3_u32 v41, v41, v101, v103
    s_waitcnt vmcnt(6)
    v_lshlrev_b32_sdwa v96, 3, v124 dst_sel:DWORD dst_unused:UNUSED_PAD src0_sel:DWORD src1_sel:WORD_0
    v_lshlrev_b32_sdwa v98, 3, v124 dst_sel:DWORD dst_unused:UNUSED_PAD src0_sel:DWORD src1_sel:WORD_1
    ds_read_b64 v[96:97], v96
    ds_read_b64 v[98:99], v98
    v_lshlrev_b32_sdwa v100, 3, v125 dst_sel:DWORD dst_unused:UNUSED_PAD src0_sel:DWORD src1_sel:WORD_0
    v_lshlrev_b32_sdwa v102, 3, v125 dst_sel:DWORD dst_unused:UNUSED_PAD src0_sel:DWORD src1_sel:WORD_1
    ds_read_b64 v[100:101], v100
    ds_read_b64 v[102:103], v102
    s_waitcnt lgkmcnt(8)
    v_add3_u32 v42, v42, v104, v106
    v_add3_u32 v43, v43, v105, v107
    v_add3_u32 v42, v42, v108, v110
    v_add3_u32 v43, v43, v109, v111
    v_lshlrev_b32_sdwa v104, 3, v126 dst_sel:DWORD dst_unused:UNUSED_PAD src0_sel:DWORD src1_sel:WORD_0
    v_lshlrev_b32_sdwa v106, 3, v126 dst_sel:DWORD dst_unused:UNUSED_PAD src0_sel:DWORD src1_sel:WORD_1
    ds_read_b64 v[104:105], v104
    ds_read_b64 v[106:107], v106
    v_lshlrev_b32_sdwa v108, 3, v127 dst_sel:DWORD dst_unused:UNUSED_PAD src0_sel:DWORD src1_sel:WORD_0
    v_lshlrev_b32_sdwa v110, 3, v127 dst_sel:DWORD dst_unused:UNUSED_PAD src0_sel:DWORD src1_sel:WORD_1
    ds_read_b64 v[108:109], v108
    ds_read_b64 v[110:111], v110
    buffer_load_dwordx4 v[124:127], v71, s[12:15], s20 offen offset:1024 sc1
    s_waitcnt lgkmcnt(8)
    v_add3_u32 v42, v42, v88, v90
    v_add3_u32 v43, v43, v89, v91
    v_add3_u32 v42, v42, v92, v94
    v_add3_u32 v43, v43, v93, v95
    s_waitcnt vmcnt(2)
    v_lshlrev_b32_sdwa v88, 3, v116 dst_sel:DWORD dst_unused:UNUSED_PAD src0_sel:DWORD src1_sel:WORD_0
    v_lshlrev_b32_sdwa v90, 3, v116 dst_sel:DWORD dst_unused:UNUSED_PAD src0_sel:DWORD src1_sel:WORD_1
    ds_read_b64 v[88:89], v88
    ds_read_b64 v[90:91], v90
    v_lshlrev_b32_sdwa v92, 3, v117 dst_sel:DWORD dst_unused:UNUSED_PAD src0_sel:DWORD src1_sel:WORD_0
    v_lshlrev_b32_sdwa v94, 3, v117 dst_sel:DWORD dst_unused:UNUSED_PAD src0_sel:DWORD src1_sel:WORD_1
    ds_read_b64 v[92:93], v92
    ds_read_b64 v[94:95], v94
    s_waitcnt lgkmcnt(8)
    v_add3_u32 v44, v44, v96, v98
    v_add3_u32 v45, v45, v97, v99
    v_add3_u32 v44, v44, v100, v102
    v_add3_u32 v45, v45, v101, v103
    v_lshlrev_b32_sdwa v96, 3, v118 dst_sel:DWORD dst_unused:UNUSED_PAD src0_sel:DWORD src1_sel:WORD_0
    v_lshlrev_b32_sdwa v98, 3, v118 dst_sel:DWORD dst_unused:UNUSED_PAD src0_sel:DWORD src1_sel:WORD_1
    ds_read_b64 v[96:97], v96
    ds_read_b64 v[98:99], v98
    v_lshlrev_b32_sdwa v100, 3, v119 dst_sel:DWORD dst_unused:UNUSED_PAD src0_sel:DWORD src1_sel:WORD_0
    v_lshlrev_b32_sdwa v102, 3, v119 dst_sel:DWORD dst_unused:UNUSED_PAD src0_sel:DWORD src1_sel:WORD_1
    ds_read_b64 v[100:101], v100
    ds_read_b64 v[102:103], v102
    buffer_load_dwordx4 v[116:119], v71, s[12:15], s20 offen offset:2048 sc1
    s_waitcnt lgkmcnt(8)
    v_add3_u32 v44, v44, v104, v106
    v_add3_u32 v45, v45, v105, v107
    v_add3_u32 v44, v44, v108, v110
    v_add3_u32 v45, v45, v109, v111
    s_setprio 2
    s_waitcnt vmcnt(2)
    v_lshlrev_b32_sdwa v104, 3, v120 dst_sel:DWORD dst_unused:UNUSED_PAD src0_sel:DWORD src1_sel:WORD_0
    v_lshlrev_b32_sdwa v106, 3, v120 dst_sel:DWORD dst_unused:UNUSED_PAD src0_sel:DWORD src1_sel:WORD_1
    ds_read_b64 v[104:105], v104
    ds_read_b64 v[106:107], v106
    v_lshlrev_b32_sdwa v108, 3, v121 dst_sel:DWORD dst_unused:UNUSED_PAD src0_sel:DWORD src1_sel:WORD_0
    v_lshlrev_b32_sdwa v110, 3, v121 dst_sel:DWORD dst_unused:UNUSED_PAD src0_sel:DWORD src1_sel:WORD_1
    ds_read_b64 v[108:109], v108
    ds_read_b64 v[110:111], v110
    s_waitcnt lgkmcnt(8)
    v_add3_u32 v46, v46, v88, v90
    v_add3_u32 v47, v47, v89, v91
    v_add3_u32 v46, v46, v92, v94
    v_add3_u32 v47, v47, v93, v95
    v_lshlrev_b32_sdwa v88, 3, v122 dst_sel:DWORD dst_unused:UNUSED_PAD src0_sel:DWORD src1_sel:WORD_0
    v_lshlrev_b32_sdwa v90, 3, v122 dst_sel:DWORD dst_unused:UNUSED_PAD src0_sel:DWORD src1_sel:WORD_1
    ds_read_b64 v[88:89], v88
    ds_read_b64 v[90:91], v90
    v_lshlrev_b32_sdwa v92, 3, v123 dst_sel:DWORD dst_unused:UNUSED_PAD src0_sel:DWORD src1_sel:WORD_0
    v_lshlrev_b32_sdwa v94, 3, v123 dst_sel:DWORD dst_unused:UNUSED_PAD src0_sel:DWORD src1_sel:WORD_1
    ds_read_b64 v[92:93], v92
    ds_read_b64 v[94:95], v94
    buffer_load_dwordx4 v[120:123], v71, s[12:15], s20 offen offset:3072 sc1
    s_waitcnt lgkmcnt(8)
    v_add3_u32 v46, v46, v96, v98
    v_add3_u32 v47, v47, v97, v99
    v_add3_u32 v46, v46, v100, v102
    v_add3_u32 v47, v47, v101, v103
    s_waitcnt vmcnt(2)
    v_lshlrev_b32_sdwa v96, 3, v124 dst_sel:DWORD dst_unused:UNUSED_PAD src0_sel:DWORD src1_sel:WORD_0
    v_lshlrev_b32_sdwa v98, 3, v124 dst_sel:DWORD dst_unused:UNUSED_PAD src0_sel:DWORD src1_sel:WORD_1
    ds_read_b64 v[96:97], v96
    ds_read_b64 v[98:99], v98
    v_lshlrev_b32_sdwa v100, 3, v125 dst_sel:DWORD dst_unused:UNUSED_PAD src0_sel:DWORD src1_sel:WORD_0
    v_lshlrev_b32_sdwa v102, 3, v125 dst_sel:DWORD dst_unused:UNUSED_PAD src0_sel:DWORD src1_sel:WORD_1
    ds_read_b64 v[100:101], v100
    ds_read_b64 v[102:103], v102
    s_waitcnt lgkmcnt(8)
    v_add3_u32 v48, v48, v104, v106
    v_add3_u32 v49, v49, v105, v107
    v_add3_u32 v48, v48, v108, v110
    v_add3_u32 v49, v49, v109, v111
    v_lshlrev_b32_sdwa v104, 3, v126 dst_sel:DWORD dst_unused:UNUSED_PAD src0_sel:DWORD src1_sel:WORD_0
    v_lshlrev_b32_sdwa v106, 3, v126 dst_sel:DWORD dst_unused:UNUSED_PAD src0_sel:DWORD src1_sel:WORD_1
    ds_read_b64 v[104:105], v104
    ds_read_b64 v[106:107], v106
    v_lshlrev_b32_sdwa v108, 3, v127 dst_sel:DWORD dst_unused:UNUSED_PAD src0_sel:DWORD src1_sel:WORD_0
    v_lshlrev_b32_sdwa v110, 3, v127 dst_sel:DWORD dst_unused:UNUSED_PAD src0_sel:DWORD src1_sel:WORD_1
    ds_read_b64 v[108:109], v108
    ds_read_b64 v[110:111], v110
    s_add_u32 s20, s20, 0x1000
    buffer_load_dwordx4 v[124:127], v71, s[12:15], s20 offen offset:0 sc1
    s_waitcnt lgkmcnt(8)
    v_add3_u32 v48, v48, v88, v90
    v_add3_u32 v49, v49, v89, v91
    v_add3_u32 v48, v48, v92, v94
    v_add3_u32 v49, v49, v93, v95
    s_waitcnt vmcnt(2)
    v_lshlrev_b32_sdwa v88, 3, v116 dst_sel:DWORD dst_unused:UNUSED_PAD src0_sel:DWORD src1_sel:WORD_0
    v_lshlrev_b32_sdwa v90, 3, v116 dst_sel:DWORD dst_unused:UNUSED_PAD src0_sel:DWORD src1_sel:WORD_1
    ds_read_b64 v[88:89], v88
    ds_read_b64 v[90:91], v90
    v_lshlrev_b32_sdwa v92, 3, v117 dst_sel:DWORD dst_unused:UNUSED_PAD src0_sel:DWORD src1_sel:WORD_0
    v_lshlrev_b32_sdwa v94, 3, v117 dst_sel:DWORD dst_unused:UNUSED_PAD src0_sel:DWORD src1_sel:WORD_1
    ds_read_b64 v[92:93], v92
    ds_read_b64 v[94:95], v94
    s_waitcnt lgkmcnt(8)
    v_add3_u32 v50, v50, v96, v98
    v_add3_u32 v51, v51, v97, v99
    v_add3_u32 v50, v50, v100, v102
    v_add3_u32 v51, v51, v101, v103
    v_lshlrev_b32_sdwa v96, 3, v118 dst_sel:DWORD dst_unused:UNUSED_PAD src0_sel:DWORD src1_sel:WORD_0
    v_lshlrev_b32_sdwa v98, 3, v118 dst_sel:DWORD dst_unused:UNUSED_PAD src0_sel:DWORD src1_sel:WORD_1
    ds_read_b64 v[96:97], v96
    ds_read_b64 v[98:99], v98
    v_lshlrev_b32_sdwa v100, 3, v119 dst_sel:DWORD dst_unused:UNUSED_PAD src0_sel:DWORD src1_sel:WORD_0
    v_lshlrev_b32_sdwa v102, 3, v119 dst_sel:DWORD dst_unused:UNUSED_PAD src0_sel:DWORD src1_sel:WORD_1
    ds_read_b64 v[100:101], v100
    ds_read_b64 v[102:103], v102
    buffer_load_dwordx4 v[116:119], v71, s[12:15], s20 offen offset:1024 sc1
    s_waitcnt lgkmcnt(8)
    v_add3_u32 v50, v50, v104, v106
    v_add3_u32 v51, v51, v105, v107
    v_add3_u32 v50, v50, v108, v110
    v_add3_u32 v51, v51, v109, v111
    v_mfma_f32_16x16x32_bf16 v[112:115], v[72:75], v[128:131], v[66:69]
    v_mfma_f32_16x16x32_bf16 v[112:115], v[76:79], v[132:135], v[112:115]
    v_add_u32 v70, 0xfffe0000, v70
    s_waitcnt vmcnt(2)
    v_lshlrev_b32_sdwa v104, 3, v120 dst_sel:DWORD dst_unused:UNUSED_PAD src0_sel:DWORD src1_sel:WORD_0
    v_lshlrev_b32_sdwa v106, 3, v120 dst_sel:DWORD dst_unused:UNUSED_PAD src0_sel:DWORD src1_sel:WORD_1
    ds_read_b64 v[104:105], v104
    ds_read_b64 v[106:107], v106
    v_mfma_f32_16x16x32_bf16 v[112:115], v[80:83], v[136:139], v[112:115]
    v_mfma_f32_16x16x32_bf16 v[112:115], v[84:87], v[140:143], v[112:115]
    v_lshlrev_b32_sdwa v108, 3, v121 dst_sel:DWORD dst_unused:UNUSED_PAD src0_sel:DWORD src1_sel:WORD_0
    v_lshlrev_b32_sdwa v110, 3, v121 dst_sel:DWORD dst_unused:UNUSED_PAD src0_sel:DWORD src1_sel:WORD_1
    ds_read_b64 v[108:109], v108
    ds_read_b64 v[110:111], v110
    s_waitcnt lgkmcnt(8)
    v_add3_u32 v52, v52, v88, v90
    v_add3_u32 v53, v53, v89, v91
    v_add3_u32 v52, v52, v92, v94
    v_add3_u32 v53, v53, v93, v95
    v_perm_b32 v112, v113, v112, s23
    v_perm_b32 v113, v115, v114, s23
    ds_write_b64 v70, v[112:113] offset:0
    v_mfma_f32_16x16x32_bf16 v[112:115], v[72:75], v[144:147], v[66:69]
    v_mfma_f32_16x16x32_bf16 v[112:115], v[76:79], v[148:151], v[112:115]
    v_lshlrev_b32_sdwa v88, 3, v122 dst_sel:DWORD dst_unused:UNUSED_PAD src0_sel:DWORD src1_sel:WORD_0
    v_lshlrev_b32_sdwa v90, 3, v122 dst_sel:DWORD dst_unused:UNUSED_PAD src0_sel:DWORD src1_sel:WORD_1
    ds_read_b64 v[88:89], v88
    ds_read_b64 v[90:91], v90
    v_mfma_f32_16x16x32_bf16 v[112:115], v[80:83], v[152:155], v[112:115]
    v_mfma_f32_16x16x32_bf16 v[112:115], v[84:87], v[156:159], v[112:115]
    v_lshlrev_b32_sdwa v92, 3, v123 dst_sel:DWORD dst_unused:UNUSED_PAD src0_sel:DWORD src1_sel:WORD_0
    v_lshlrev_b32_sdwa v94, 3, v123 dst_sel:DWORD dst_unused:UNUSED_PAD src0_sel:DWORD src1_sel:WORD_1
    ds_read_b64 v[92:93], v92
    ds_read_b64 v[94:95], v94
    buffer_load_dwordx4 v[120:123], v71, s[12:15], s20 offen offset:2048 sc1
    s_waitcnt lgkmcnt(9)
    v_add3_u32 v52, v52, v96, v98
    v_add3_u32 v53, v53, v97, v99
    v_add3_u32 v52, v52, v100, v102
    v_add3_u32 v53, v53, v101, v103
    v_perm_b32 v112, v113, v112, s23
    v_perm_b32 v113, v115, v114, s23
    ds_write_b64 v70, v[112:113] offset:128
    s_setprio 1
    v_mfma_f32_16x16x32_bf16 v[112:115], v[72:75], v[160:163], v[66:69]
    v_mfma_f32_16x16x32_bf16 v[112:115], v[76:79], v[164:167], v[112:115]
    s_waitcnt vmcnt(2)
    v_lshlrev_b32_sdwa v96, 3, v124 dst_sel:DWORD dst_unused:UNUSED_PAD src0_sel:DWORD src1_sel:WORD_0
    v_lshlrev_b32_sdwa v98, 3, v124 dst_sel:DWORD dst_unused:UNUSED_PAD src0_sel:DWORD src1_sel:WORD_1
    ds_read_b64 v[96:97], v96
    ds_read_b64 v[98:99], v98
    v_mfma_f32_16x16x32_bf16 v[112:115], v[80:83], v[168:171], v[112:115]
    v_mfma_f32_16x16x32_bf16 v[112:115], v[84:87], v[172:175], v[112:115]
    v_lshlrev_b32_sdwa v100, 3, v125 dst_sel:DWORD dst_unused:UNUSED_PAD src0_sel:DWORD src1_sel:WORD_0
    v_lshlrev_b32_sdwa v102, 3, v125 dst_sel:DWORD dst_unused:UNUSED_PAD src0_sel:DWORD src1_sel:WORD_1
    ds_read_b64 v[100:101], v100
    ds_read_b64 v[102:103], v102
    s_waitcnt lgkmcnt(10)
    v_add3_u32 v54, v54, v104, v106
    v_add3_u32 v55, v55, v105, v107
    v_add3_u32 v54, v54, v108, v110
    v_add3_u32 v55, v55, v109, v111
    v_perm_b32 v112, v113, v112, s23
    v_perm_b32 v113, v115, v114, s23
    ds_write_b64 v70, v[112:113] offset:256
    v_mfma_f32_16x16x32_bf16 v[112:115], v[72:75], v[176:179], v[66:69]
    v_mfma_f32_16x16x32_bf16 v[112:115], v[76:79], v[180:183], v[112:115]
    v_lshlrev_b32_sdwa v104, 3, v126 dst_sel:DWORD dst_unused:UNUSED_PAD src0_sel:DWORD src1_sel:WORD_0
    v_lshlrev_b32_sdwa v106, 3, v126 dst_sel:DWORD dst_unused:UNUSED_PAD src0_sel:DWORD src1_sel:WORD_1
    ds_read_b64 v[104:105], v104
    ds_read_b64 v[106:107], v106
    v_mfma_f32_16x16x32_bf16 v[112:115], v[80:83], v[184:187], v[112:115]
    v_mfma_f32_16x16x32_bf16 v[112:115], v[84:87], v[188:191], v[112:115]
    v_lshlrev_b32_sdwa v108, 3, v127 dst_sel:DWORD dst_unused:UNUSED_PAD src0_sel:DWORD src1_sel:WORD_0
    v_lshlrev_b32_sdwa v110, 3, v127 dst_sel:DWORD dst_unused:UNUSED_PAD src0_sel:DWORD src1_sel:WORD_1
    ds_read_b64 v[108:109], v108
    ds_read_b64 v[110:111], v110
    buffer_load_dwordx4 v[124:127], v71, s[12:15], s20 offen offset:3072 sc1
    s_waitcnt lgkmcnt(10)
    v_add3_u32 v54, v54, v88, v90
    v_add3_u32 v55, v55, v89, v91
    v_add3_u32 v54, v54, v92, v94
    v_add3_u32 v55, v55, v93, v95
    v_perm_b32 v112, v113, v112, s23
    v_perm_b32 v113, v115, v114, s23
    ds_write_b64 v70, v[112:113] offset:384
    v_mfma_f32_16x16x32_bf16 v[112:115], v[72:75], v[192:195], v[66:69]
    v_mfma_f32_16x16x32_bf16 v[112:115], v[76:79], v[196:199], v[112:115]
    s_waitcnt vmcnt(2)
    v_lshlrev_b32_sdwa v88, 3, v116 dst_sel:DWORD dst_unused:UNUSED_PAD src0_sel:DWORD src1_sel:WORD_0
    v_lshlrev_b32_sdwa v90, 3, v116 dst_sel:DWORD dst_unused:UNUSED_PAD src0_sel:DWORD src1_sel:WORD_1
    ds_read_b64 v[88:89], v88
    ds_read_b64 v[90:91], v90
    v_mfma_f32_16x16x32_bf16 v[112:115], v[80:83], v[200:203], v[112:115]
    v_mfma_f32_16x16x32_bf16 v[112:115], v[84:87], v[204:207], v[112:115]
    v_lshlrev_b32_sdwa v92, 3, v117 dst_sel:DWORD dst_unused:UNUSED_PAD src0_sel:DWORD src1_sel:WORD_0
    v_lshlrev_b32_sdwa v94, 3, v117 dst_sel:DWORD dst_unused:UNUSED_PAD src0_sel:DWORD src1_sel:WORD_1
    ds_read_b64 v[92:93], v92
    ds_read_b64 v[94:95], v94
    s_waitcnt lgkmcnt(10)
    v_add3_u32 v56, v56, v96, v98
    v_add3_u32 v57, v57, v97, v99
    v_add3_u32 v56, v56, v100, v102
    v_add3_u32 v57, v57, v101, v103
    v_perm_b32 v112, v113, v112, s23
    v_perm_b32 v113, v115, v114, s23
    ds_write_b64 v70, v[112:113] offset:512
    v_mfma_f32_16x16x32_bf16 v[112:115], v[72:75], v[208:211], v[66:69]
    v_mfma_f32_16x16x32_bf16 v[112:115], v[76:79], v[212:215], v[112:115]
    v_lshlrev_b32_sdwa v96, 3, v118 dst_sel:DWORD dst_unused:UNUSED_PAD src0_sel:DWORD src1_sel:WORD_0
    v_lshlrev_b32_sdwa v98, 3, v118 dst_sel:DWORD dst_unused:UNUSED_PAD src0_sel:DWORD src1_sel:WORD_1
    ds_read_b64 v[96:97], v96
    ds_read_b64 v[98:99], v98
    v_mfma_f32_16x16x32_bf16 v[112:115], v[80:83], v[216:219], v[112:115]
    v_mfma_f32_16x16x32_bf16 v[112:115], v[84:87], v[220:223], v[112:115]
    v_lshlrev_b32_sdwa v100, 3, v119 dst_sel:DWORD dst_unused:UNUSED_PAD src0_sel:DWORD src1_sel:WORD_0
    v_lshlrev_b32_sdwa v102, 3, v119 dst_sel:DWORD dst_unused:UNUSED_PAD src0_sel:DWORD src1_sel:WORD_1
    ds_read_b64 v[100:101], v100
    ds_read_b64 v[102:103], v102
    s_add_u32 s20, s20, 0x3d000
    buffer_load_dwordx4 v[116:119], v71, s[12:15], s20 offen offset:0 sc1
    s_waitcnt lgkmcnt(10)
    v_add3_u32 v56, v56, v104, v106
    v_add3_u32 v57, v57, v105, v107
    v_add3_u32 v56, v56, v108, v110
    v_add3_u32 v57, v57, v109, v111
    v_perm_b32 v112, v113, v112, s23
    v_perm_b32 v113, v115, v114, s23
    ds_write_b64 v70, v[112:113] offset:640
    v_mfma_f32_16x16x32_bf16 v[112:115], v[72:75], v[224:227], v[66:69]
    v_mfma_f32_16x16x32_bf16 v[112:115], v[76:79], v[228:231], v[112:115]
    s_waitcnt vmcnt(2)
    v_lshlrev_b32_sdwa v104, 3, v120 dst_sel:DWORD dst_unused:UNUSED_PAD src0_sel:DWORD src1_sel:WORD_0
    v_lshlrev_b32_sdwa v106, 3, v120 dst_sel:DWORD dst_unused:UNUSED_PAD src0_sel:DWORD src1_sel:WORD_1
    ds_read_b64 v[104:105], v104
    ds_read_b64 v[106:107], v106
    v_mfma_f32_16x16x32_bf16 v[112:115], v[80:83], v[232:235], v[112:115]
    v_mfma_f32_16x16x32_bf16 v[112:115], v[84:87], v[236:239], v[112:115]
    v_lshlrev_b32_sdwa v108, 3, v121 dst_sel:DWORD dst_unused:UNUSED_PAD src0_sel:DWORD src1_sel:WORD_0
    v_lshlrev_b32_sdwa v110, 3, v121 dst_sel:DWORD dst_unused:UNUSED_PAD src0_sel:DWORD src1_sel:WORD_1
    ds_read_b64 v[108:109], v108
    ds_read_b64 v[110:111], v110
    s_waitcnt lgkmcnt(10)
    v_add3_u32 v58, v58, v88, v90
    v_add3_u32 v59, v59, v89, v91
    v_add3_u32 v58, v58, v92, v94
    v_add3_u32 v59, v59, v93, v95
    v_perm_b32 v112, v113, v112, s23
    v_perm_b32 v113, v115, v114, s23
    ds_write_b64 v70, v[112:113] offset:768
    v_mfma_f32_16x16x32_bf16 v[112:115], v[72:75], v[240:243], v[66:69]
    buffer_load_dwordx4 v[72:75], v71, s[12:15], s21 offen offset:0
    v_mfma_f32_16x16x32_bf16 v[112:115], v[76:79], v[244:247], v[112:115]
    buffer_load_dwordx4 v[76:79], v71, s[12:15], s21 offen offset:1024
    v_lshlrev_b32_sdwa v88, 3, v122 dst_sel:DWORD dst_unused:UNUSED_PAD src0_sel:DWORD src1_sel:WORD_0
    v_lshlrev_b32_sdwa v90, 3, v122 dst_sel:DWORD dst_unused:UNUSED_PAD src0_sel:DWORD src1_sel:WORD_1
    ds_read_b64 v[88:89], v88
    ds_read_b64 v[90:91], v90
    v_mfma_f32_16x16x32_bf16 v[112:115], v[80:83], v[248:251], v[112:115]
    buffer_load_dwordx4 v[80:83], v71, s[12:15], s19 offen offset:0
    v_mfma_f32_16x16x32_bf16 v[112:115], v[84:87], v[252:255], v[112:115]
    buffer_load_dwordx4 v[84:87], v71, s[12:15], s19 offen offset:1024
    s_add_u32 s21, s21, s22
    s_add_u32 s19, s19, s22
    v_lshlrev_b32_sdwa v92, 3, v123 dst_sel:DWORD dst_unused:UNUSED_PAD src0_sel:DWORD src1_sel:WORD_0
    v_lshlrev_b32_sdwa v94, 3, v123 dst_sel:DWORD dst_unused:UNUSED_PAD src0_sel:DWORD src1_sel:WORD_1
    ds_read_b64 v[92:93], v92
    ds_read_b64 v[94:95], v94
    buffer_load_dwordx4 v[120:123], v71, s[12:15], s20 offen offset:1024 sc1
    s_waitcnt lgkmcnt(10)
    v_add3_u32 v58, v58, v96, v98
    v_add3_u32 v59, v59, v97, v99
    v_add3_u32 v58, v58, v100, v102
    v_add3_u32 v59, v59, v101, v103
    v_perm_b32 v112, v113, v112, s23
    v_perm_b32 v113, v115, v114, s23
    ds_write_b64 v70, v[112:113] offset:896
    s_setprio 0
    s_waitcnt vmcnt(6)
    v_lshlrev_b32_sdwa v96, 3, v124 dst_sel:DWORD dst_unused:UNUSED_PAD src0_sel:DWORD src1_sel:WORD_0
    v_lshlrev_b32_sdwa v98, 3, v124 dst_sel:DWORD dst_unused:UNUSED_PAD src0_sel:DWORD src1_sel:WORD_1
    ds_read_b64 v[96:97], v96
    ds_read_b64 v[98:99], v98
    v_lshlrev_b32_sdwa v100, 3, v125 dst_sel:DWORD dst_unused:UNUSED_PAD src0_sel:DWORD src1_sel:WORD_0
    v_lshlrev_b32_sdwa v102, 3, v125 dst_sel:DWORD dst_unused:UNUSED_PAD src0_sel:DWORD src1_sel:WORD_1
    ds_read_b64 v[100:101], v100
    ds_read_b64 v[102:103], v102
    s_waitcnt lgkmcnt(10)
    v_add3_u32 v60, v60, v104, v106
    v_add3_u32 v61, v61, v105, v107
    v_add3_u32 v60, v60, v108, v110
    v_add3_u32 v61, v61, v109, v111
    v_lshlrev_b32_sdwa v104, 3, v126 dst_sel:DWORD dst_unused:UNUSED_PAD src0_sel:DWORD src1_sel:WORD_0
    v_lshlrev_b32_sdwa v106, 3, v126 dst_sel:DWORD dst_unused:UNUSED_PAD src0_sel:DWORD src1_sel:WORD_1
    ds_read_b64 v[104:105], v104
    ds_read_b64 v[106:107], v106
    v_lshlrev_b32_sdwa v108, 3, v127 dst_sel:DWORD dst_unused:UNUSED_PAD src0_sel:DWORD src1_sel:WORD_0
    v_lshlrev_b32_sdwa v110, 3, v127 dst_sel:DWORD dst_unused:UNUSED_PAD src0_sel:DWORD src1_sel:WORD_1
    ds_read_b64 v[108:109], v108
    ds_read_b64 v[110:111], v110
    buffer_load_dwordx4 v[124:127], v71, s[12:15], s20 offen offset:2048 sc1
    s_waitcnt lgkmcnt(9)
    v_add3_u32 v60, v60, v88, v90
    v_add3_u32 v61, v61, v89, v91
    v_add3_u32 v60, v60, v92, v94
    v_add3_u32 v61, v61, v93, v95
    s_waitcnt lgkmcnt(0)
    s_barrier
    s_setprio 3
    s_waitcnt vmcnt(6)
    v_lshlrev_b32_sdwa v88, 3, v116 dst_sel:DWORD dst_unused:UNUSED_PAD src0_sel:DWORD src1_sel:WORD_0
    v_lshlrev_b32_sdwa v90, 3, v116 dst_sel:DWORD dst_unused:UNUSED_PAD src0_sel:DWORD src1_sel:WORD_1
    ds_read_b64 v[88:89], v88
    ds_read_b64 v[90:91], v90
    v_lshlrev_b32_sdwa v92, 3, v117 dst_sel:DWORD dst_unused:UNUSED_PAD src0_sel:DWORD src1_sel:WORD_0
    v_lshlrev_b32_sdwa v94, 3, v117 dst_sel:DWORD dst_unused:UNUSED_PAD src0_sel:DWORD src1_sel:WORD_1
    ds_read_b64 v[92:93], v92
    ds_read_b64 v[94:95], v94
    v_add3_u32 v62, v62, v96, v98
    v_add3_u32 v63, v63, v97, v99
    v_add3_u32 v62, v62, v100, v102
    v_add3_u32 v63, v63, v101, v103
    v_lshlrev_b32_sdwa v96, 3, v118 dst_sel:DWORD dst_unused:UNUSED_PAD src0_sel:DWORD src1_sel:WORD_0
    v_lshlrev_b32_sdwa v98, 3, v118 dst_sel:DWORD dst_unused:UNUSED_PAD src0_sel:DWORD src1_sel:WORD_1
    ds_read_b64 v[96:97], v96
    ds_read_b64 v[98:99], v98
    v_lshlrev_b32_sdwa v100, 3, v119 dst_sel:DWORD dst_unused:UNUSED_PAD src0_sel:DWORD src1_sel:WORD_0
    v_lshlrev_b32_sdwa v102, 3, v119 dst_sel:DWORD dst_unused:UNUSED_PAD src0_sel:DWORD src1_sel:WORD_1
    ds_read_b64 v[100:101], v100
    ds_read_b64 v[102:103], v102
    buffer_load_dwordx4 v[116:119], v71, s[12:15], s20 offen offset:3072 sc1
    v_add3_u32 v62, v62, v104, v106
    v_add3_u32 v63, v63, v105, v107
    v_add3_u32 v62, v62, v108, v110
    v_add3_u32 v63, v63, v109, v111
    s_waitcnt vmcnt(2)
    v_lshlrev_b32_sdwa v104, 3, v120 dst_sel:DWORD dst_unused:UNUSED_PAD src0_sel:DWORD src1_sel:WORD_0
    v_lshlrev_b32_sdwa v106, 3, v120 dst_sel:DWORD dst_unused:UNUSED_PAD src0_sel:DWORD src1_sel:WORD_1
    ds_read_b64 v[104:105], v104
    ds_read_b64 v[106:107], v106
    v_lshlrev_b32_sdwa v108, 3, v121 dst_sel:DWORD dst_unused:UNUSED_PAD src0_sel:DWORD src1_sel:WORD_0
    v_lshlrev_b32_sdwa v110, 3, v121 dst_sel:DWORD dst_unused:UNUSED_PAD src0_sel:DWORD src1_sel:WORD_1
    ds_read_b64 v[108:109], v108
    ds_read_b64 v[110:111], v110
    s_waitcnt lgkmcnt(8)
    v_add3_u32 v32, v32, v88, v90
    v_add3_u32 v33, v33, v89, v91
    v_add3_u32 v32, v32, v92, v94
    v_add3_u32 v33, v33, v93, v95
    v_lshlrev_b32_sdwa v88, 3, v122 dst_sel:DWORD dst_unused:UNUSED_PAD src0_sel:DWORD src1_sel:WORD_0
    v_lshlrev_b32_sdwa v90, 3, v122 dst_sel:DWORD dst_unused:UNUSED_PAD src0_sel:DWORD src1_sel:WORD_1
    ds_read_b64 v[88:89], v88
    ds_read_b64 v[90:91], v90
    v_lshlrev_b32_sdwa v92, 3, v123 dst_sel:DWORD dst_unused:UNUSED_PAD src0_sel:DWORD src1_sel:WORD_0
    v_lshlrev_b32_sdwa v94, 3, v123 dst_sel:DWORD dst_unused:UNUSED_PAD src0_sel:DWORD src1_sel:WORD_1
    ds_read_b64 v[92:93], v92
    ds_read_b64 v[94:95], v94
    s_add_u32 s20, s20, 0x1000
    buffer_load_dwordx4 v[120:123], v71, s[12:15], s20 offen offset:0 sc1
    s_waitcnt lgkmcnt(8)
    v_add3_u32 v32, v32, v96, v98
    v_add3_u32 v33, v33, v97, v99
    v_add3_u32 v32, v32, v100, v102
    v_add3_u32 v33, v33, v101, v103
    s_waitcnt vmcnt(2)
    v_lshlrev_b32_sdwa v96, 3, v124 dst_sel:DWORD dst_unused:UNUSED_PAD src0_sel:DWORD src1_sel:WORD_0
    v_lshlrev_b32_sdwa v98, 3, v124 dst_sel:DWORD dst_unused:UNUSED_PAD src0_sel:DWORD src1_sel:WORD_1
    ds_read_b64 v[96:97], v96
    ds_read_b64 v[98:99], v98
    v_lshlrev_b32_sdwa v100, 3, v125 dst_sel:DWORD dst_unused:UNUSED_PAD src0_sel:DWORD src1_sel:WORD_0
    v_lshlrev_b32_sdwa v102, 3, v125 dst_sel:DWORD dst_unused:UNUSED_PAD src0_sel:DWORD src1_sel:WORD_1
    ds_read_b64 v[100:101], v100
    ds_read_b64 v[102:103], v102
    s_waitcnt lgkmcnt(8)
    v_add3_u32 v34, v34, v104, v106
    v_add3_u32 v35, v35, v105, v107
    v_add3_u32 v34, v34, v108, v110
    v_add3_u32 v35, v35, v109, v111
    v_lshlrev_b32_sdwa v104, 3, v126 dst_sel:DWORD dst_unused:UNUSED_PAD src0_sel:DWORD src1_sel:WORD_0
    v_lshlrev_b32_sdwa v106, 3, v126 dst_sel:DWORD dst_unused:UNUSED_PAD src0_sel:DWORD src1_sel:WORD_1
    ds_read_b64 v[104:105], v104
    ds_read_b64 v[106:107], v106
    v_lshlrev_b32_sdwa v108, 3, v127 dst_sel:DWORD dst_unused:UNUSED_PAD src0_sel:DWORD src1_sel:WORD_0
    v_lshlrev_b32_sdwa v110, 3, v127 dst_sel:DWORD dst_unused:UNUSED_PAD src0_sel:DWORD src1_sel:WORD_1
    ds_read_b64 v[108:109], v108
    ds_read_b64 v[110:111], v110
    buffer_load_dwordx4 v[124:127], v71, s[12:15], s20 offen offset:1024 sc1
    s_waitcnt lgkmcnt(8)
    v_add3_u32 v34, v34, v88, v90
    v_add3_u32 v35, v35, v89, v91
    v_add3_u32 v34, v34, v92, v94
    v_add3_u32 v35, v35, v93, v95
    s_waitcnt vmcnt(2)
    v_lshlrev_b32_sdwa v88, 3, v116 dst_sel:DWORD dst_unused:UNUSED_PAD src0_sel:DWORD src1_sel:WORD_0
    v_lshlrev_b32_sdwa v90, 3, v116 dst_sel:DWORD dst_unused:UNUSED_PAD src0_sel:DWORD src1_sel:WORD_1
    ds_read_b64 v[88:89], v88
    ds_read_b64 v[90:91], v90
    v_lshlrev_b32_sdwa v92, 3, v117 dst_sel:DWORD dst_unused:UNUSED_PAD src0_sel:DWORD src1_sel:WORD_0
    v_lshlrev_b32_sdwa v94, 3, v117 dst_sel:DWORD dst_unused:UNUSED_PAD src0_sel:DWORD src1_sel:WORD_1
    ds_read_b64 v[92:93], v92
    ds_read_b64 v[94:95], v94
    s_waitcnt lgkmcnt(8)
    v_add3_u32 v36, v36, v96, v98
    v_add3_u32 v37, v37, v97, v99
    v_add3_u32 v36, v36, v100, v102
    v_add3_u32 v37, v37, v101, v103
    v_lshlrev_b32_sdwa v96, 3, v118 dst_sel:DWORD dst_unused:UNUSED_PAD src0_sel:DWORD src1_sel:WORD_0
    v_lshlrev_b32_sdwa v98, 3, v118 dst_sel:DWORD dst_unused:UNUSED_PAD src0_sel:DWORD src1_sel:WORD_1
    ds_read_b64 v[96:97], v96
    ds_read_b64 v[98:99], v98
    v_lshlrev_b32_sdwa v100, 3, v119 dst_sel:DWORD dst_unused:UNUSED_PAD src0_sel:DWORD src1_sel:WORD_0
    v_lshlrev_b32_sdwa v102, 3, v119 dst_sel:DWORD dst_unused:UNUSED_PAD src0_sel:DWORD src1_sel:WORD_1
    ds_read_b64 v[100:101], v100
    ds_read_b64 v[102:103], v102
    buffer_load_dwordx4 v[116:119], v71, s[12:15], s20 offen offset:2048 sc1
    s_waitcnt lgkmcnt(8)
    v_add3_u32 v36, v36, v104, v106
    v_add3_u32 v37, v37, v105, v107
    v_add3_u32 v36, v36, v108, v110
    v_add3_u32 v37, v37, v109, v111
    v_mfma_f32_16x16x32_bf16 v[112:115], v[72:75], v[128:131], v[66:69]
    s_waitcnt vmcnt(2)
    v_lshlrev_b32_sdwa v104, 3, v120 dst_sel:DWORD dst_unused:UNUSED_PAD src0_sel:DWORD src1_sel:WORD_0
    v_lshlrev_b32_sdwa v106, 3, v120 dst_sel:DWORD dst_unused:UNUSED_PAD src0_sel:DWORD src1_sel:WORD_1
    ds_read_b64 v[104:105], v104
    ds_read_b64 v[106:107], v106
    v_mfma_f32_16x16x32_bf16 v[112:115], v[76:79], v[132:135], v[112:115]
    v_lshlrev_b32_sdwa v108, 3, v121 dst_sel:DWORD dst_unused:UNUSED_PAD src0_sel:DWORD src1_sel:WORD_0
    v_lshlrev_b32_sdwa v110, 3, v121 dst_sel:DWORD dst_unused:UNUSED_PAD src0_sel:DWORD src1_sel:WORD_1
    ds_read_b64 v[108:109], v108
    ds_read_b64 v[110:111], v110
    s_waitcnt lgkmcnt(8)
    v_add3_u32 v38, v38, v88, v90
    v_add3_u32 v39, v39, v89, v91
    v_add3_u32 v38, v38, v92, v94
    v_add3_u32 v39, v39, v93, v95
    v_mfma_f32_16x16x32_bf16 v[112:115], v[80:83], v[136:139], v[112:115]
    v_lshlrev_b32_sdwa v88, 3, v122 dst_sel:DWORD dst_unused:UNUSED_PAD src0_sel:DWORD src1_sel:WORD_0
    v_lshlrev_b32_sdwa v90, 3, v122 dst_sel:DWORD dst_unused:UNUSED_PAD src0_sel:DWORD src1_sel:WORD_1
    ds_read_b64 v[88:89], v88
    ds_read_b64 v[90:91], v90
    v_mfma_f32_16x16x32_bf16 v[112:115], v[84:87], v[140:143], v[112:115]
    v_lshlrev_b32_sdwa v92, 3, v123 dst_sel:DWORD dst_unused:UNUSED_PAD src0_sel:DWORD src1_sel:WORD_0
    v_lshlrev_b32_sdwa v94, 3, v123 dst_sel:DWORD dst_unused:UNUSED_PAD src0_sel:DWORD src1_sel:WORD_1
    ds_read_b64 v[92:93], v92
    ds_read_b64 v[94:95], v94
    buffer_load_dwordx4 v[120:123], v71, s[12:15], s20 offen offset:3072 sc1
    s_waitcnt lgkmcnt(8)
    v_add3_u32 v38, v38, v96, v98
    v_add3_u32 v39, v39, v97, v99
    v_add3_u32 v38, v38, v100, v102
    v_add3_u32 v39, v39, v101, v103
    v_perm_b32 v112, v113, v112, s23
    v_perm_b32 v113, v115, v114, s23
    ds_write_b64 v70, v[112:113] offset:32768
    s_waitcnt vmcnt(2)
    v_lshlrev_b32_sdwa v96, 3, v124 dst_sel:DWORD dst_unused:UNUSED_PAD src0_sel:DWORD src1_sel:WORD_0
    v_lshlrev_b32_sdwa v98, 3, v124 dst_sel:DWORD dst_unused:UNUSED_PAD src0_sel:DWORD src1_sel:WORD_1
    ds_read_b64 v[96:97], v96
    ds_read_b64 v[98:99], v98
    v_lshlrev_b32_sdwa v100, 3, v125 dst_sel:DWORD dst_unused:UNUSED_PAD src0_sel:DWORD src1_sel:WORD_0
    v_lshlrev_b32_sdwa v102, 3, v125 dst_sel:DWORD dst_unused:UNUSED_PAD src0_sel:DWORD src1_sel:WORD_1
    ds_read_b64 v[100:101], v100
    ds_read_b64 v[102:103], v102
    s_waitcnt lgkmcnt(9)
    v_add3_u32 v40, v40, v104, v106
    v_add3_u32 v41, v41, v105, v107
    v_add3_u32 v40, v40, v108, v110
    v_add3_u32 v41, v41, v109, v111
    v_mfma_f32_16x16x32_bf16 v[112:115], v[72:75], v[144:147], v[66:69]
    v_lshlrev_b32_sdwa v104, 3, v126 dst_sel:DWORD dst_unused:UNUSED_PAD src0_sel:DWORD src1_sel:WORD_0
    v_lshlrev_b32_sdwa v106, 3, v126 dst_sel:DWORD dst_unused:UNUSED_PAD src0_sel:DWORD src1_sel:WORD_1
    ds_read_b64 v[104:105], v104
    ds_read_b64 v[106:107], v106
    v_mfma_f32_16x16x32_bf16 v[112:115], v[76:79], v[148:151], v[112:115]
    v_lshlrev_b32_sdwa v108, 3, v127 dst_sel:DWORD dst_unused:UNUSED_PAD src0_sel:DWORD src1_sel:WORD_0
    v_lshlrev_b32_sdwa v110, 3, v127 dst_sel:DWORD dst_unused:UNUSED_PAD src0_sel:DWORD src1_sel:WORD_1
    ds_read_b64 v[108:109], v108
    ds_read_b64 v[110:111], v110
    s_add_u32 s20, s20, 0x1000
    buffer_load_dwordx4 v[124:127], v71, s[12:15], s20 offen offset:0 sc1
    s_waitcnt lgkmcnt(9)
    v_add3_u32 v40, v40, v88, v90
    v_add3_u32 v41, v41, v89, v91
    v_add3_u32 v40, v40, v92, v94
    v_add3_u32 v41, v41, v93, v95
    v_mfma_f32_16x16x32_bf16 v[112:115], v[80:83], v[152:155], v[112:115]
    s_waitcnt vmcnt(2)
    v_lshlrev_b32_sdwa v88, 3, v116 dst_sel:DWORD dst_unused:UNUSED_PAD src0_sel:DWORD src1_sel:WORD_0
    v_lshlrev_b32_sdwa v90, 3, v116 dst_sel:DWORD dst_unused:UNUSED_PAD src0_sel:DWORD src1_sel:WORD_1
    ds_read_b64 v[88:89], v88
    ds_read_b64 v[90:91], v90
    v_mfma_f32_16x16x32_bf16 v[112:115], v[84:87], v[156:159], v[112:115]
    v_lshlrev_b32_sdwa v92, 3, v117 dst_sel:DWORD dst_unused:UNUSED_PAD src0_sel:DWORD src1_sel:WORD_0
    v_lshlrev_b32_sdwa v94, 3, v117 dst_sel:DWORD dst_unused:UNUSED_PAD src0_sel:DWORD src1_sel:WORD_1
    ds_read_b64 v[92:93], v92
    ds_read_b64 v[94:95], v94
    s_waitcnt lgkmcnt(8)
    v_add3_u32 v42, v42, v96, v98
    v_add3_u32 v43, v43, v97, v99
    v_add3_u32 v42, v42, v100, v102
    v_add3_u32 v43, v43, v101, v103
    v_perm_b32 v112, v113, v112, s23
    v_perm_b32 v113, v115, v114, s23
    ds_write_b64 v70, v[112:113] offset:32896
    v_lshlrev_b32_sdwa v96, 3, v118 dst_sel:DWORD dst_unused:UNUSED_PAD src0_sel:DWORD src1_sel:WORD_0
    v_lshlrev_b32_sdwa v98, 3, v118 dst_sel:DWORD dst_unused:UNUSED_PAD src0_sel:DWORD src1_sel:WORD_1
    ds_read_b64 v[96:97], v96
    ds_read_b64 v[98:99], v98
    v_lshlrev_b32_sdwa v100, 3, v119 dst_sel:DWORD dst_unused:UNUSED_PAD src0_sel:DWORD src1_sel:WORD_0
    v_lshlrev_b32_sdwa v102, 3, v119 dst_sel:DWORD dst_unused:UNUSED_PAD src0_sel:DWORD src1_sel:WORD_1
    ds_read_b64 v[100:101], v100
    ds_read_b64 v[102:103], v102
    buffer_load_dwordx4 v[116:119], v71, s[12:15], s20 offen offset:1024 sc1
    s_waitcnt lgkmcnt(9)
    v_add3_u32 v42, v42, v104, v106
    v_add3_u32 v43, v43, v105, v107
    v_add3_u32 v42, v42, v108, v110
    v_add3_u32 v43, v43, v109, v111
    v_mfma_f32_16x16x32_bf16 v[112:115], v[72:75], v[160:163], v[66:69]
    s_waitcnt vmcnt(2)
    v_lshlrev_b32_sdwa v104, 3, v120 dst_sel:DWORD dst_unused:UNUSED_PAD src0_sel:DWORD src1_sel:WORD_0
    v_lshlrev_b32_sdwa v106, 3, v120 dst_sel:DWORD dst_unused:UNUSED_PAD src0_sel:DWORD src1_sel:WORD_1
    ds_read_b64 v[104:105], v104
    ds_read_b64 v[106:107], v106
    v_mfma_f32_16x16x32_bf16 v[112:115], v[76:79], v[164:167], v[112:115]
    v_lshlrev_b32_sdwa v108, 3, v121 dst_sel:DWORD dst_unused:UNUSED_PAD src0_sel:DWORD src1_sel:WORD_0
    v_lshlrev_b32_sdwa v110, 3, v121 dst_sel:DWORD dst_unused:UNUSED_PAD src0_sel:DWORD src1_sel:WORD_1
    ds_read_b64 v[108:109], v108
    ds_read_b64 v[110:111], v110
    s_waitcnt lgkmcnt(9)
    v_add3_u32 v44, v44, v88, v90
    v_add3_u32 v45, v45, v89, v91
    v_add3_u32 v44, v44, v92, v94
    v_add3_u32 v45, v45, v93, v95
    s_lshl_b32 s28, s38, 16
    s_and_b32 s29, s38, 0xffff0000
    v_mfma_f32_16x16x32_bf16 v[112:115], v[80:83], v[168:171], v[112:115]
    v_lshlrev_b32_sdwa v88, 3, v122 dst_sel:DWORD dst_unused:UNUSED_PAD src0_sel:DWORD src1_sel:WORD_0
    v_lshlrev_b32_sdwa v90, 3, v122 dst_sel:DWORD dst_unused:UNUSED_PAD src0_sel:DWORD src1_sel:WORD_1
    ds_read_b64 v[88:89], v88
    ds_read_b64 v[90:91], v90
    v_mfma_f32_16x16x32_bf16 v[112:115], v[84:87], v[172:175], v[112:115]
    v_lshlrev_b32_sdwa v92, 3, v123 dst_sel:DWORD dst_unused:UNUSED_PAD src0_sel:DWORD src1_sel:WORD_0
    v_lshlrev_b32_sdwa v94, 3, v123 dst_sel:DWORD dst_unused:UNUSED_PAD src0_sel:DWORD src1_sel:WORD_1
    ds_read_b64 v[92:93], v92
    ds_read_b64 v[94:95], v94
    buffer_load_dwordx4 v[120:123], v71, s[12:15], s20 offen offset:2048 sc1
    s_waitcnt lgkmcnt(8)
    v_add3_u32 v44, v44, v96, v98
    v_add3_u32 v45, v45, v97, v99
    v_add3_u32 v44, v44, v100, v102
    v_add3_u32 v45, v45, v101, v103
    v_perm_b32 v112, v113, v112, s23
    v_perm_b32 v113, v115, v114, s23
    ds_write_b64 v70, v[112:113] offset:33024
    s_setprio 2
    s_lshl_b32 s30, s39, 16
    s_and_b32 s31, s39, 0xffff0000
    s_waitcnt vmcnt(2)
    v_lshlrev_b32_sdwa v96, 3, v124 dst_sel:DWORD dst_unused:UNUSED_PAD src0_sel:DWORD src1_sel:WORD_0
    v_lshlrev_b32_sdwa v98, 3, v124 dst_sel:DWORD dst_unused:UNUSED_PAD src0_sel:DWORD src1_sel:WORD_1
    ds_read_b64 v[96:97], v96
    ds_read_b64 v[98:99], v98
    v_lshlrev_b32_sdwa v100, 3, v125 dst_sel:DWORD dst_unused:UNUSED_PAD src0_sel:DWORD src1_sel:WORD_0
    v_lshlrev_b32_sdwa v102, 3, v125 dst_sel:DWORD dst_unused:UNUSED_PAD src0_sel:DWORD src1_sel:WORD_1
    ds_read_b64 v[100:101], v100
    ds_read_b64 v[102:103], v102
    s_waitcnt lgkmcnt(9)
    v_add3_u32 v46, v46, v104, v106
    v_add3_u32 v47, v47, v105, v107
    v_add3_u32 v46, v46, v108, v110
    v_add3_u32 v47, v47, v109, v111
    s_lshl1_add_u32 s35, s33, s34
    s_lshl3_add_u32 s35, s35, s3
    v_mfma_f32_16x16x32_bf16 v[112:115], v[72:75], v[176:179], v[66:69]
    v_lshlrev_b32_sdwa v104, 3, v126 dst_sel:DWORD dst_unused:UNUSED_PAD src0_sel:DWORD src1_sel:WORD_0
    v_lshlrev_b32_sdwa v106, 3, v126 dst_sel:DWORD dst_unused:UNUSED_PAD src0_sel:DWORD src1_sel:WORD_1
    ds_read_b64 v[104:105], v104
    ds_read_b64 v[106:107], v106
    v_mfma_f32_16x16x32_bf16 v[112:115], v[76:79], v[180:183], v[112:115]
    v_lshlrev_b32_sdwa v108, 3, v127 dst_sel:DWORD dst_unused:UNUSED_PAD src0_sel:DWORD src1_sel:WORD_0
    v_lshlrev_b32_sdwa v110, 3, v127 dst_sel:DWORD dst_unused:UNUSED_PAD src0_sel:DWORD src1_sel:WORD_1
    ds_read_b64 v[108:109], v108
    ds_read_b64 v[110:111], v110
    buffer_load_dwordx4 v[124:127], v71, s[12:15], s20 offen offset:3072 sc1
    s_waitcnt lgkmcnt(9)
    v_add3_u32 v46, v46, v88, v90
    v_add3_u32 v47, v47, v89, v91
    v_add3_u32 v46, v46, v92, v94
    v_add3_u32 v47, v47, v93, v95
    s_lshl_b32 s35, s35, 12
    s_and_b32 s64, s48, 1
    v_mfma_f32_16x16x32_bf16 v[112:115], v[80:83], v[184:187], v[112:115]
    s_waitcnt vmcnt(2)
    v_lshlrev_b32_sdwa v88, 3, v116 dst_sel:DWORD dst_unused:UNUSED_PAD src0_sel:DWORD src1_sel:WORD_0
    v_lshlrev_b32_sdwa v90, 3, v116 dst_sel:DWORD dst_unused:UNUSED_PAD src0_sel:DWORD src1_sel:WORD_1
    ds_read_b64 v[88:89], v88
    ds_read_b64 v[90:91], v90
    v_mfma_f32_16x16x32_bf16 v[112:115], v[84:87], v[188:191], v[112:115]
    v_lshlrev_b32_sdwa v92, 3, v117 dst_sel:DWORD dst_unused:UNUSED_PAD src0_sel:DWORD src1_sel:WORD_0
    v_lshlrev_b32_sdwa v94, 3, v117 dst_sel:DWORD dst_unused:UNUSED_PAD src0_sel:DWORD src1_sel:WORD_1
    ds_read_b64 v[92:93], v92
    ds_read_b64 v[94:95], v94
    s_waitcnt lgkmcnt(8)
    v_add3_u32 v48, v48, v96, v98
    v_add3_u32 v49, v49, v97, v99
    v_add3_u32 v48, v48, v100, v102
    v_add3_u32 v49, v49, v101, v103
    v_perm_b32 v112, v113, v112, s23
    v_perm_b32 v113, v115, v114, s23
    ds_write_b64 v70, v[112:113] offset:33152
    s_lshl_b32 s64, s64, 25
    s_add_u32 s35, s35, s64
    v_lshlrev_b32_sdwa v96, 3, v118 dst_sel:DWORD dst_unused:UNUSED_PAD src0_sel:DWORD src1_sel:WORD_0
    v_lshlrev_b32_sdwa v98, 3, v118 dst_sel:DWORD dst_unused:UNUSED_PAD src0_sel:DWORD src1_sel:WORD_1
    ds_read_b64 v[96:97], v96
    ds_read_b64 v[98:99], v98
    v_lshlrev_b32_sdwa v100, 3, v119 dst_sel:DWORD dst_unused:UNUSED_PAD src0_sel:DWORD src1_sel:WORD_0
    v_lshlrev_b32_sdwa v102, 3, v119 dst_sel:DWORD dst_unused:UNUSED_PAD src0_sel:DWORD src1_sel:WORD_1
    ds_read_b64 v[100:101], v100
    ds_read_b64 v[102:103], v102
    s_add_u32 s20, s20, 0x1000
    buffer_load_dwordx4 v[116:119], v71, s[12:15], s20 offen offset:0 sc1
    s_waitcnt lgkmcnt(9)
    v_add3_u32 v48, v48, v104, v106
    v_add3_u32 v49, v49, v105, v107
    v_add3_u32 v48, v48, v108, v110
    v_add3_u32 v49, v49, v109, v111
    s_add_u32 s35, s35, 20971520
    s_and_b32 s57, s57, 0xffff
    v_mfma_f32_16x16x32_bf16 v[112:115], v[72:75], v[192:195], v[66:69]
    s_waitcnt vmcnt(2)
    v_lshlrev_b32_sdwa v104, 3, v120 dst_sel:DWORD dst_unused:UNUSED_PAD src0_sel:DWORD src1_sel:WORD_0
    v_lshlrev_b32_sdwa v106, 3, v120 dst_sel:DWORD dst_unused:UNUSED_PAD src0_sel:DWORD src1_sel:WORD_1
    ds_read_b64 v[104:105], v104
    ds_read_b64 v[106:107], v106
    v_mfma_f32_16x16x32_bf16 v[112:115], v[76:79], v[196:199], v[112:115]
    v_lshlrev_b32_sdwa v108, 3, v121 dst_sel:DWORD dst_unused:UNUSED_PAD src0_sel:DWORD src1_sel:WORD_0
    v_lshlrev_b32_sdwa v110, 3, v121 dst_sel:DWORD dst_unused:UNUSED_PAD src0_sel:DWORD src1_sel:WORD_1
    ds_read_b64 v[108:109], v108
    ds_read_b64 v[110:111], v110
    s_waitcnt lgkmcnt(9)
    v_add3_u32 v50, v50, v88, v90
    v_add3_u32 v51, v51, v89, v91
    v_add3_u32 v50, v50, v92, v94
    v_add3_u32 v51, v51, v93, v95
    s_mov_b32 s58, 2
    s_mov_b32 s59, 0x00020000
    v_mfma_f32_16x16x32_bf16 v[112:115], v[80:83], v[200:203], v[112:115]
    v_lshlrev_b32_sdwa v88, 3, v122 dst_sel:DWORD dst_unused:UNUSED_PAD src0_sel:DWORD src1_sel:WORD_0
    v_lshlrev_b32_sdwa v90, 3, v122 dst_sel:DWORD dst_unused:UNUSED_PAD src0_sel:DWORD src1_sel:WORD_1
    ds_read_b64 v[88:89], v88
    ds_read_b64 v[90:91], v90
    v_mfma_f32_16x16x32_bf16 v[112:115], v[84:87], v[204:207], v[112:115]
    v_lshlrev_b32_sdwa v92, 3, v123 dst_sel:DWORD dst_unused:UNUSED_PAD src0_sel:DWORD src1_sel:WORD_0
    v_lshlrev_b32_sdwa v94, 3, v123 dst_sel:DWORD dst_unused:UNUSED_PAD src0_sel:DWORD src1_sel:WORD_1
    ds_read_b64 v[92:93], v92
    ds_read_b64 v[94:95], v94
    buffer_load_dwordx4 v[120:123], v71, s[12:15], s20 offen offset:1024 sc1
    s_waitcnt lgkmcnt(8)
    v_add3_u32 v50, v50, v96, v98
    v_add3_u32 v51, v51, v97, v99
    v_add3_u32 v50, v50, v100, v102
    v_add3_u32 v51, v51, v101, v103
    v_perm_b32 v112, v113, v112, s23
    v_perm_b32 v113, v115, v114, s23
    ds_write_b64 v70, v[112:113] offset:33280
    s_and_b32 s61, s61, 0xffff
    s_mov_b32 s62, 32768
    s_waitcnt vmcnt(2)
    v_lshlrev_b32_sdwa v96, 3, v124 dst_sel:DWORD dst_unused:UNUSED_PAD src0_sel:DWORD src1_sel:WORD_0
    v_lshlrev_b32_sdwa v98, 3, v124 dst_sel:DWORD dst_unused:UNUSED_PAD src0_sel:DWORD src1_sel:WORD_1
    ds_read_b64 v[96:97], v96
    ds_read_b64 v[98:99], v98
    v_lshlrev_b32_sdwa v100, 3, v125 dst_sel:DWORD dst_unused:UNUSED_PAD src0_sel:DWORD src1_sel:WORD_0
    v_lshlrev_b32_sdwa v102, 3, v125 dst_sel:DWORD dst_unused:UNUSED_PAD src0_sel:DWORD src1_sel:WORD_1
    ds_read_b64 v[100:101], v100
    ds_read_b64 v[102:103], v102
    s_waitcnt lgkmcnt(9)
    v_add3_u32 v52, v52, v104, v106
    v_add3_u32 v53, v53, v105, v107
    v_add3_u32 v52, v52, v108, v110
    v_add3_u32 v53, v53, v109, v111
    s_mov_b32 s63, 0x00020000
    s_xor_b32 s64, s34, 1
    v_mfma_f32_16x16x32_bf16 v[112:115], v[72:75], v[208:211], v[66:69]
    v_lshlrev_b32_sdwa v104, 3, v126 dst_sel:DWORD dst_unused:UNUSED_PAD src0_sel:DWORD src1_sel:WORD_0
    v_lshlrev_b32_sdwa v106, 3, v126 dst_sel:DWORD dst_unused:UNUSED_PAD src0_sel:DWORD src1_sel:WORD_1
    ds_read_b64 v[104:105], v104
    ds_read_b64 v[106:107], v106
    v_mfma_f32_16x16x32_bf16 v[112:115], v[76:79], v[212:215], v[112:115]
    v_lshlrev_b32_sdwa v108, 3, v127 dst_sel:DWORD dst_unused:UNUSED_PAD src0_sel:DWORD src1_sel:WORD_0
    v_lshlrev_b32_sdwa v110, 3, v127 dst_sel:DWORD dst_unused:UNUSED_PAD src0_sel:DWORD src1_sel:WORD_1
    ds_read_b64 v[108:109], v108
    ds_read_b64 v[110:111], v110
    buffer_load_dwordx4 v[124:127], v71, s[12:15], s20 offen offset:2048 sc1
    s_waitcnt lgkmcnt(9)
    v_add3_u32 v52, v52, v88, v90
    v_add3_u32 v53, v53, v89, v91
    v_add3_u32 v52, v52, v92, v94
    v_add3_u32 v53, v53, v93, v95
    s_setprio 1
    s_lshl_b32 s64, s64, 7
    s_add_u32 s64, s64, s33
    v_mfma_f32_16x16x32_bf16 v[112:115], v[80:83], v[216:219], v[112:115]
    s_waitcnt vmcnt(2)
    v_lshlrev_b32_sdwa v88, 3, v116 dst_sel:DWORD dst_unused:UNUSED_PAD src0_sel:DWORD src1_sel:WORD_0
    v_lshlrev_b32_sdwa v90, 3, v116 dst_sel:DWORD dst_unused:UNUSED_PAD src0_sel:DWORD src1_sel:WORD_1
    ds_read_b64 v[88:89], v88
    ds_read_b64 v[90:91], v90
    v_mfma_f32_16x16x32_bf16 v[112:115], v[84:87], v[220:223], v[112:115]
    v_lshlrev_b32_sdwa v92, 3, v117 dst_sel:DWORD dst_unused:UNUSED_PAD src0_sel:DWORD src1_sel:WORD_0
    v_lshlrev_b32_sdwa v94, 3, v117 dst_sel:DWORD dst_unused:UNUSED_PAD src0_sel:DWORD src1_sel:WORD_1
    ds_read_b64 v[92:93], v92
    ds_read_b64 v[94:95], v94
    s_waitcnt lgkmcnt(8)
    v_add3_u32 v54, v54, v96, v98
    v_add3_u32 v55, v55, v97, v99
    v_add3_u32 v54, v54, v100, v102
    v_add3_u32 v55, v55, v101, v103
    v_perm_b32 v112, v113, v112, s23
    v_perm_b32 v113, v115, v114, s23
    ds_write_b64 v70, v[112:113] offset:33408
    s_lshl_b32 s65, s3, 20
    s_add_u32 s66, s65, 1048576
    v_lshlrev_b32_sdwa v96, 3, v118 dst_sel:DWORD dst_unused:UNUSED_PAD src0_sel:DWORD src1_sel:WORD_0
    v_lshlrev_b32_sdwa v98, 3, v118 dst_sel:DWORD dst_unused:UNUSED_PAD src0_sel:DWORD src1_sel:WORD_1
    ds_read_b64 v[96:97], v96
    ds_read_b64 v[98:99], v98
    v_lshlrev_b32_sdwa v100, 3, v119 dst_sel:DWORD dst_unused:UNUSED_PAD src0_sel:DWORD src1_sel:WORD_0
    v_lshlrev_b32_sdwa v102, 3, v119 dst_sel:DWORD dst_unused:UNUSED_PAD src0_sel:DWORD src1_sel:WORD_1
    ds_read_b64 v[100:101], v100
    ds_read_b64 v[102:103], v102
    buffer_load_dwordx4 v[116:119], v71, s[12:15], s20 offen offset:3072 sc1
    s_waitcnt lgkmcnt(9)
    v_add3_u32 v54, v54, v104, v106
    v_add3_u32 v55, v55, v105, v107
    v_add3_u32 v54, v54, v108, v110
    v_add3_u32 v55, v55, v109, v111
    s_lshl_b32 s67, s3, 14
    s_add_u32 s67, s67, 8000
    v_mfma_f32_16x16x32_bf16 v[112:115], v[72:75], v[224:227], v[66:69]
    s_waitcnt vmcnt(2)
    v_lshlrev_b32_sdwa v104, 3, v120 dst_sel:DWORD dst_unused:UNUSED_PAD src0_sel:DWORD src1_sel:WORD_0
    v_lshlrev_b32_sdwa v106, 3, v120 dst_sel:DWORD dst_unused:UNUSED_PAD src0_sel:DWORD src1_sel:WORD_1
    ds_read_b64 v[104:105], v104
    ds_read_b64 v[106:107], v106
    v_mfma_f32_16x16x32_bf16 v[112:115], v[76:79], v[228:231], v[112:115]
    v_lshlrev_b32_sdwa v108, 3, v121 dst_sel:DWORD dst_unused:UNUSED_PAD src0_sel:DWORD src1_sel:WORD_0
    v_lshlrev_b32_sdwa v110, 3, v121 dst_sel:DWORD dst_unused:UNUSED_PAD src0_sel:DWORD src1_sel:WORD_1
    ds_read_b64 v[108:109], v108
    ds_read_b64 v[110:111], v110
    s_waitcnt lgkmcnt(9)
    v_add3_u32 v56, v56, v88, v90
    v_add3_u32 v57, v57, v89, v91
    v_add3_u32 v56, v56, v92, v94
    v_add3_u32 v57, v57, v93, v95
    s_lshl_b32 s68, s64, 7
    s_lshl_b32 s69, s64, 8
    v_mfma_f32_16x16x32_bf16 v[112:115], v[80:83], v[232:235], v[112:115]
    v_lshlrev_b32_sdwa v88, 3, v122 dst_sel:DWORD dst_unused:UNUSED_PAD src0_sel:DWORD src1_sel:WORD_0
    v_lshlrev_b32_sdwa v90, 3, v122 dst_sel:DWORD dst_unused:UNUSED_PAD src0_sel:DWORD src1_sel:WORD_1
    ds_read_b64 v[88:89], v88
    ds_read_b64 v[90:91], v90
    v_mfma_f32_16x16x32_bf16 v[112:115], v[84:87], v[236:239], v[112:115]
    v_lshlrev_b32_sdwa v92, 3, v123 dst_sel:DWORD dst_unused:UNUSED_PAD src0_sel:DWORD src1_sel:WORD_0
    v_lshlrev_b32_sdwa v94, 3, v123 dst_sel:DWORD dst_unused:UNUSED_PAD src0_sel:DWORD src1_sel:WORD_1
    ds_read_b64 v[92:93], v92
    ds_read_b64 v[94:95], v94
    s_add_u32 s20, s20, 0x3d000
    buffer_load_dwordx4 v[120:123], v71, s[12:15], s20 offen offset:0 sc1
    s_waitcnt lgkmcnt(8)
    v_add3_u32 v56, v56, v96, v98
    v_add3_u32 v57, v57, v97, v99
    v_add3_u32 v56, v56, v100, v102
    v_add3_u32 v57, v57, v101, v103
    v_perm_b32 v112, v113, v112, s23
    v_perm_b32 v113, v115, v114, s23
    ds_write_b64 v70, v[112:113] offset:33536
    s_add_u32 s69, s69, s65
    s_add_u32 s69, s69, 20971520
    s_waitcnt vmcnt(2)
    v_lshlrev_b32_sdwa v96, 3, v124 dst_sel:DWORD dst_unused:UNUSED_PAD src0_sel:DWORD src1_sel:WORD_0
    v_lshlrev_b32_sdwa v98, 3, v124 dst_sel:DWORD dst_unused:UNUSED_PAD src0_sel:DWORD src1_sel:WORD_1
    ds_read_b64 v[96:97], v96
    ds_read_b64 v[98:99], v98
    v_lshlrev_b32_sdwa v100, 3, v125 dst_sel:DWORD dst_unused:UNUSED_PAD src0_sel:DWORD src1_sel:WORD_0
    v_lshlrev_b32_sdwa v102, 3, v125 dst_sel:DWORD dst_unused:UNUSED_PAD src0_sel:DWORD src1_sel:WORD_1
    ds_read_b64 v[100:101], v100
    ds_read_b64 v[102:103], v102
    s_waitcnt lgkmcnt(9)
    v_add3_u32 v58, v58, v104, v106
    v_add3_u32 v59, v59, v105, v107
    v_add3_u32 v58, v58, v108, v110
    v_add3_u32 v59, v59, v109, v111
    s_mov_b32 s42, 0
    s_mov_b32 s43, 0
    v_mfma_f32_16x16x32_bf16 v[112:115], v[72:75], v[240:243], v[66:69]
    v_lshlrev_b32_sdwa v104, 3, v126 dst_sel:DWORD dst_unused:UNUSED_PAD src0_sel:DWORD src1_sel:WORD_0
    v_lshlrev_b32_sdwa v106, 3, v126 dst_sel:DWORD dst_unused:UNUSED_PAD src0_sel:DWORD src1_sel:WORD_1
    ds_read_b64 v[104:105], v104
    ds_read_b64 v[106:107], v106
    v_mfma_f32_16x16x32_bf16 v[112:115], v[76:79], v[244:247], v[112:115]
    v_lshlrev_b32_sdwa v108, 3, v127 dst_sel:DWORD dst_unused:UNUSED_PAD src0_sel:DWORD src1_sel:WORD_0
    v_lshlrev_b32_sdwa v110, 3, v127 dst_sel:DWORD dst_unused:UNUSED_PAD src0_sel:DWORD src1_sel:WORD_1
    ds_read_b64 v[108:109], v108
    ds_read_b64 v[110:111], v110
    buffer_load_dwordx4 v[72:75], v71, s[12:15], s20 offen offset:1024 sc1
    s_waitcnt lgkmcnt(9)
    v_add3_u32 v58, v58, v88, v90
    v_add3_u32 v59, v59, v89, v91
    v_add3_u32 v58, v58, v92, v94
    v_add3_u32 v59, v59, v93, v95
    s_setprio 0
    s_add_u32 s17, s16, 4096
    s_add_u32 s32, s18, 4096
    v_mfma_f32_16x16x32_bf16 v[112:115], v[80:83], v[248:251], v[112:115]
    s_waitcnt vmcnt(2)
    v_lshlrev_b32_sdwa v88, 3, v116 dst_sel:DWORD dst_unused:UNUSED_PAD src0_sel:DWORD src1_sel:WORD_0
    v_lshlrev_b32_sdwa v90, 3, v116 dst_sel:DWORD dst_unused:UNUSED_PAD src0_sel:DWORD src1_sel:WORD_1
    ds_read_b64 v[88:89], v88
    ds_read_b64 v[90:91], v90
    v_mfma_f32_16x16x32_bf16 v[112:115], v[84:87], v[252:255], v[112:115]
    v_lshlrev_b32_sdwa v92, 3, v117 dst_sel:DWORD dst_unused:UNUSED_PAD src0_sel:DWORD src1_sel:WORD_0
    v_lshlrev_b32_sdwa v94, 3, v117 dst_sel:DWORD dst_unused:UNUSED_PAD src0_sel:DWORD src1_sel:WORD_1
    ds_read_b64 v[92:93], v92
    ds_read_b64 v[94:95], v94
    buffer_load_dwordx4 v[76:79], v71, s[12:15], s20 offen offset:2048 sc1
    s_waitcnt lgkmcnt(8)
    v_add3_u32 v60, v60, v96, v98
    v_add3_u32 v61, v61, v97, v99
    v_add3_u32 v60, v60, v100, v102
    v_add3_u32 v61, v61, v101, v103
    v_perm_b32 v112, v113, v112, s23
    v_perm_b32 v113, v115, v114, s23
    ds_write_b64 v70, v[112:113] offset:33664
    v_lshlrev_b32_sdwa v96, 3, v118 dst_sel:DWORD dst_unused:UNUSED_PAD src0_sel:DWORD src1_sel:WORD_0
    v_lshlrev_b32_sdwa v98, 3, v118 dst_sel:DWORD dst_unused:UNUSED_PAD src0_sel:DWORD src1_sel:WORD_1
    ds_read_b64 v[96:97], v96
    ds_read_b64 v[98:99], v98
    v_lshlrev_b32_sdwa v100, 3, v119 dst_sel:DWORD dst_unused:UNUSED_PAD src0_sel:DWORD src1_sel:WORD_0
    v_lshlrev_b32_sdwa v102, 3, v119 dst_sel:DWORD dst_unused:UNUSED_PAD src0_sel:DWORD src1_sel:WORD_1
    ds_read_b64 v[100:101], v100
    ds_read_b64 v[102:103], v102
    buffer_load_dwordx4 v[124:127], v71, s[12:15], s20 offen offset:3072 sc1
    s_waitcnt lgkmcnt(9)
    v_add3_u32 v60, v60, v104, v106
    v_add3_u32 v61, v61, v105, v107
    v_add3_u32 v60, v60, v108, v110
    v_add3_u32 v61, v61, v109, v111
    s_waitcnt lgkmcnt(4)
    s_barrier
    s_setprio 3
    s_waitcnt vmcnt(3)
    v_lshlrev_b32_sdwa v104, 3, v120 dst_sel:DWORD dst_unused:UNUSED_PAD src0_sel:DWORD src1_sel:WORD_0
    v_lshlrev_b32_sdwa v106, 3, v120 dst_sel:DWORD dst_unused:UNUSED_PAD src0_sel:DWORD src1_sel:WORD_1
    ds_read_b64 v[104:105], v104
    ds_read_b64 v[106:107], v106
    v_lshlrev_b32_sdwa v108, 3, v121 dst_sel:DWORD dst_unused:UNUSED_PAD src0_sel:DWORD src1_sel:WORD_0
    v_lshlrev_b32_sdwa v110, 3, v121 dst_sel:DWORD dst_unused:UNUSED_PAD src0_sel:DWORD src1_sel:WORD_1
    ds_read_b64 v[108:109], v108
    ds_read_b64 v[110:111], v110
    s_add_u32 s20, s20, 0x1000
    buffer_load_dwordx4 v[80:83], v71, s[12:15], s20 offen offset:0 sc1
    v_add3_u32 v62, v62, v88, v90
    v_add3_u32 v63, v63, v89, v91
    v_add3_u32 v62, v62, v92, v94
    v_add3_u32 v63, v63, v93, v95
    v_lshlrev_b32_sdwa v88, 3, v122 dst_sel:DWORD dst_unused:UNUSED_PAD src0_sel:DWORD src1_sel:WORD_0
    v_lshlrev_b32_sdwa v90, 3, v122 dst_sel:DWORD dst_unused:UNUSED_PAD src0_sel:DWORD src1_sel:WORD_1
    ds_read_b64 v[88:89], v88
    ds_read_b64 v[90:91], v90
    v_lshlrev_b32_sdwa v92, 3, v123 dst_sel:DWORD dst_unused:UNUSED_PAD src0_sel:DWORD src1_sel:WORD_0
    v_lshlrev_b32_sdwa v94, 3, v123 dst_sel:DWORD dst_unused:UNUSED_PAD src0_sel:DWORD src1_sel:WORD_1
    ds_read_b64 v[92:93], v92
    ds_read_b64 v[94:95], v94
    buffer_load_dwordx4 v[84:87], v71, s[12:15], s20 offen offset:1024 sc1
    s_waitcnt lgkmcnt(8)
    v_add3_u32 v62, v62, v96, v98
    v_add3_u32 v63, v63, v97, v99
    v_add3_u32 v62, v62, v100, v102
    v_add3_u32 v63, v63, v101, v103
    s_waitcnt vmcnt(4)
    v_lshlrev_b32_sdwa v96, 3, v72 dst_sel:DWORD dst_unused:UNUSED_PAD src0_sel:DWORD src1_sel:WORD_0
    v_lshlrev_b32_sdwa v98, 3, v72 dst_sel:DWORD dst_unused:UNUSED_PAD src0_sel:DWORD src1_sel:WORD_1
    ds_read_b64 v[96:97], v96
    ds_read_b64 v[98:99], v98
    v_lshlrev_b32_sdwa v100, 3, v73 dst_sel:DWORD dst_unused:UNUSED_PAD src0_sel:DWORD src1_sel:WORD_0
    v_lshlrev_b32_sdwa v102, 3, v73 dst_sel:DWORD dst_unused:UNUSED_PAD src0_sel:DWORD src1_sel:WORD_1
    ds_read_b64 v[100:101], v100
    ds_read_b64 v[102:103], v102
    buffer_load_dwordx4 v[116:119], v71, s[12:15], s20 offen offset:2048 sc1
    s_waitcnt lgkmcnt(8)
    v_add3_u32 v32, v32, v104, v106
    v_add3_u32 v33, v33, v105, v107
    v_add3_u32 v32, v32, v108, v110
    v_add3_u32 v33, v33, v109, v111
    v_lshlrev_b32_sdwa v104, 3, v74 dst_sel:DWORD dst_unused:UNUSED_PAD src0_sel:DWORD src1_sel:WORD_0
    v_lshlrev_b32_sdwa v106, 3, v74 dst_sel:DWORD dst_unused:UNUSED_PAD src0_sel:DWORD src1_sel:WORD_1
    ds_read_b64 v[104:105], v104
    ds_read_b64 v[106:107], v106
    v_lshlrev_b32_sdwa v108, 3, v75 dst_sel:DWORD dst_unused:UNUSED_PAD src0_sel:DWORD src1_sel:WORD_0
    v_lshlrev_b32_sdwa v110, 3, v75 dst_sel:DWORD dst_unused:UNUSED_PAD src0_sel:DWORD src1_sel:WORD_1
    ds_read_b64 v[108:109], v108
    ds_read_b64 v[110:111], v110
    buffer_load_dwordx4 v[120:123], v71, s[12:15], s20 offen offset:3072 sc1
    s_waitcnt lgkmcnt(8)
    v_add3_u32 v32, v32, v88, v90
    v_add3_u32 v33, v33, v89, v91
    v_add3_u32 v32, v32, v92, v94
    v_add3_u32 v33, v33, v93, v95
    s_waitcnt vmcnt(5)
    v_lshlrev_b32_sdwa v88, 3, v76 dst_sel:DWORD dst_unused:UNUSED_PAD src0_sel:DWORD src1_sel:WORD_0
    v_lshlrev_b32_sdwa v90, 3, v76 dst_sel:DWORD dst_unused:UNUSED_PAD src0_sel:DWORD src1_sel:WORD_1
    ds_read_b64 v[88:89], v88
    ds_read_b64 v[90:91], v90
    v_lshlrev_b32_sdwa v92, 3, v77 dst_sel:DWORD dst_unused:UNUSED_PAD src0_sel:DWORD src1_sel:WORD_0
    v_lshlrev_b32_sdwa v94, 3, v77 dst_sel:DWORD dst_unused:UNUSED_PAD src0_sel:DWORD src1_sel:WORD_1
    ds_read_b64 v[92:93], v92
    ds_read_b64 v[94:95], v94
    s_add_u32 s20, s20, 0x1000
    buffer_load_dwordx4 v[72:75], v71, s[12:15], s20 offen offset:0 sc1
    s_waitcnt lgkmcnt(8)
    v_add3_u32 v34, v34, v96, v98
    v_add3_u32 v35, v35, v97, v99
    v_add3_u32 v34, v34, v100, v102
    v_add3_u32 v35, v35, v101, v103
    v_lshlrev_b32_sdwa v96, 3, v78 dst_sel:DWORD dst_unused:UNUSED_PAD src0_sel:DWORD src1_sel:WORD_0
    v_lshlrev_b32_sdwa v98, 3, v78 dst_sel:DWORD dst_unused:UNUSED_PAD src0_sel:DWORD src1_sel:WORD_1
    ds_read_b64 v[96:97], v96
    ds_read_b64 v[98:99], v98
    v_lshlrev_b32_sdwa v100, 3, v79 dst_sel:DWORD dst_unused:UNUSED_PAD src0_sel:DWORD src1_sel:WORD_0
    v_lshlrev_b32_sdwa v102, 3, v79 dst_sel:DWORD dst_unused:UNUSED_PAD src0_sel:DWORD src1_sel:WORD_1
    ds_read_b64 v[100:101], v100
    ds_read_b64 v[102:103], v102
    buffer_load_dwordx4 v[76:79], v71, s[12:15], s20 offen offset:1024 sc1
    s_waitcnt lgkmcnt(8)
    v_add3_u32 v34, v34, v104, v106
    v_add3_u32 v35, v35, v105, v107
    v_add3_u32 v34, v34, v108, v110
    v_add3_u32 v35, v35, v109, v111
    s_waitcnt vmcnt(6)
    v_lshlrev_b32_sdwa v104, 3, v124 dst_sel:DWORD dst_unused:UNUSED_PAD src0_sel:DWORD src1_sel:WORD_0
    v_lshlrev_b32_sdwa v106, 3, v124 dst_sel:DWORD dst_unused:UNUSED_PAD src0_sel:DWORD src1_sel:WORD_1
    ds_read_b64 v[104:105], v104
    ds_read_b64 v[106:107], v106
    v_lshlrev_b32_sdwa v108, 3, v125 dst_sel:DWORD dst_unused:UNUSED_PAD src0_sel:DWORD src1_sel:WORD_0
    v_lshlrev_b32_sdwa v110, 3, v125 dst_sel:DWORD dst_unused:UNUSED_PAD src0_sel:DWORD src1_sel:WORD_1
    ds_read_b64 v[108:109], v108
    ds_read_b64 v[110:111], v110
    buffer_store_dwordx4 v[32:35], v71, s[12:15], s16 offen offset:0 sc1
    s_waitcnt lgkmcnt(8)
    v_add3_u32 v36, v36, v88, v90
    v_add3_u32 v37, v37, v89, v91
    v_add3_u32 v36, v36, v92, v94
    v_add3_u32 v37, v37, v93, v95
    v_lshlrev_b32_sdwa v88, 3, v126 dst_sel:DWORD dst_unused:UNUSED_PAD src0_sel:DWORD src1_sel:WORD_0
    v_lshlrev_b32_sdwa v90, 3, v126 dst_sel:DWORD dst_unused:UNUSED_PAD src0_sel:DWORD src1_sel:WORD_1
    ds_read_b64 v[88:89], v88
    ds_read_b64 v[90:91], v90
    v_lshlrev_b32_sdwa v92, 3, v127 dst_sel:DWORD dst_unused:UNUSED_PAD src0_sel:DWORD src1_sel:WORD_0
    v_lshlrev_b32_sdwa v94, 3, v127 dst_sel:DWORD dst_unused:UNUSED_PAD src0_sel:DWORD src1_sel:WORD_1
    ds_read_b64 v[92:93], v92
    ds_read_b64 v[94:95], v94
    buffer_load_dwordx4 v[32:35], v71, s[12:15], s20 offen offset:2048 sc1
    s_waitcnt lgkmcnt(8)
    v_add3_u32 v36, v36, v96, v98
    v_add3_u32 v37, v37, v97, v99
    v_add3_u32 v36, v36, v100, v102
    v_add3_u32 v37, v37, v101, v103
    s_waitcnt vmcnt(7)
    v_lshlrev_b32_sdwa v96, 3, v80 dst_sel:DWORD dst_unused:UNUSED_PAD src0_sel:DWORD src1_sel:WORD_0
    v_lshlrev_b32_sdwa v98, 3, v80 dst_sel:DWORD dst_unused:UNUSED_PAD src0_sel:DWORD src1_sel:WORD_1
    ds_read_b64 v[96:97], v96
    ds_read_b64 v[98:99], v98
    v_lshlrev_b32_sdwa v100, 3, v81 dst_sel:DWORD dst_unused:UNUSED_PAD src0_sel:DWORD src1_sel:WORD_0
    v_lshlrev_b32_sdwa v102, 3, v81 dst_sel:DWORD dst_unused:UNUSED_PAD src0_sel:DWORD src1_sel:WORD_1
    ds_read_b64 v[100:101], v100
    ds_read_b64 v[102:103], v102
    buffer_load_dwordx4 v[124:127], v71, s[12:15], s20 offen offset:3072 sc1
    s_waitcnt lgkmcnt(8)
    v_add3_u32 v38, v38, v104, v106
    v_add3_u32 v39, v39, v105, v107
    v_add3_u32 v38, v38, v108, v110
    v_add3_u32 v39, v39, v109, v111
    v_lshlrev_b32_sdwa v104, 3, v82 dst_sel:DWORD dst_unused:UNUSED_PAD src0_sel:DWORD src1_sel:WORD_0
    v_lshlrev_b32_sdwa v106, 3, v82 dst_sel:DWORD dst_unused:UNUSED_PAD src0_sel:DWORD src1_sel:WORD_1
    ds_read_b64 v[104:105], v104
    ds_read_b64 v[106:107], v106
    v_lshlrev_b32_sdwa v108, 3, v83 dst_sel:DWORD dst_unused:UNUSED_PAD src0_sel:DWORD src1_sel:WORD_0
    v_lshlrev_b32_sdwa v110, 3, v83 dst_sel:DWORD dst_unused:UNUSED_PAD src0_sel:DWORD src1_sel:WORD_1
    ds_read_b64 v[108:109], v108
    ds_read_b64 v[110:111], v110
    s_waitcnt lgkmcnt(8)
    v_add3_u32 v38, v38, v88, v90
    v_add3_u32 v39, v39, v89, v91
    v_add3_u32 v38, v38, v92, v94
    v_add3_u32 v39, v39, v93, v95
    s_waitcnt vmcnt(7)
    v_lshlrev_b32_sdwa v88, 3, v84 dst_sel:DWORD dst_unused:UNUSED_PAD src0_sel:DWORD src1_sel:WORD_0
    v_lshlrev_b32_sdwa v90, 3, v84 dst_sel:DWORD dst_unused:UNUSED_PAD src0_sel:DWORD src1_sel:WORD_1
    ds_read_b64 v[88:89], v88
    ds_read_b64 v[90:91], v90
    v_lshlrev_b32_sdwa v92, 3, v85 dst_sel:DWORD dst_unused:UNUSED_PAD src0_sel:DWORD src1_sel:WORD_0
    v_lshlrev_b32_sdwa v94, 3, v85 dst_sel:DWORD dst_unused:UNUSED_PAD src0_sel:DWORD src1_sel:WORD_1
    ds_read_b64 v[92:93], v92
    ds_read_b64 v[94:95], v94
    s_add_u32 s20, s20, 0x1000
    buffer_load_dwordx4 v[80:83], v71, s[12:15], s20 offen offset:0 sc1
    s_waitcnt lgkmcnt(8)
    v_add3_u32 v40, v40, v96, v98
    v_add3_u32 v41, v41, v97, v99
    v_add3_u32 v40, v40, v100, v102
    v_add3_u32 v41, v41, v101, v103
    v_lshlrev_b32_sdwa v96, 3, v86 dst_sel:DWORD dst_unused:UNUSED_PAD src0_sel:DWORD src1_sel:WORD_0
    v_lshlrev_b32_sdwa v98, 3, v86 dst_sel:DWORD dst_unused:UNUSED_PAD src0_sel:DWORD src1_sel:WORD_1
    ds_read_b64 v[96:97], v96
    ds_read_b64 v[98:99], v98
    v_lshlrev_b32_sdwa v100, 3, v87 dst_sel:DWORD dst_unused:UNUSED_PAD src0_sel:DWORD src1_sel:WORD_0
    v_lshlrev_b32_sdwa v102, 3, v87 dst_sel:DWORD dst_unused:UNUSED_PAD src0_sel:DWORD src1_sel:WORD_1
    ds_read_b64 v[100:101], v100
    ds_read_b64 v[102:103], v102
    s_waitcnt lgkmcnt(8)
    v_add3_u32 v40, v40, v104, v106
    v_add3_u32 v41, v41, v105, v107
    v_add3_u32 v40, v40, v108, v110
    v_add3_u32 v41, v41, v109, v111
    s_waitcnt vmcnt(7)
    v_lshlrev_b32_sdwa v104, 3, v116 dst_sel:DWORD dst_unused:UNUSED_PAD src0_sel:DWORD src1_sel:WORD_0
    v_lshlrev_b32_sdwa v106, 3, v116 dst_sel:DWORD dst_unused:UNUSED_PAD src0_sel:DWORD src1_sel:WORD_1
    ds_read_b64 v[104:105], v104
    ds_read_b64 v[106:107], v106
    v_lshlrev_b32_sdwa v108, 3, v117 dst_sel:DWORD dst_unused:UNUSED_PAD src0_sel:DWORD src1_sel:WORD_0
    v_lshlrev_b32_sdwa v110, 3, v117 dst_sel:DWORD dst_unused:UNUSED_PAD src0_sel:DWORD src1_sel:WORD_1
    ds_read_b64 v[108:109], v108
    ds_read_b64 v[110:111], v110
    buffer_load_dwordx4 v[84:87], v71, s[12:15], s20 offen offset:1024 sc1
    s_waitcnt lgkmcnt(8)
    v_add3_u32 v42, v42, v88, v90
    v_add3_u32 v43, v43, v89, v91
    v_add3_u32 v42, v42, v92, v94
    v_add3_u32 v43, v43, v93, v95
    v_lshlrev_b32_sdwa v88, 3, v118 dst_sel:DWORD dst_unused:UNUSED_PAD src0_sel:DWORD src1_sel:WORD_0
    v_lshlrev_b32_sdwa v90, 3, v118 dst_sel:DWORD dst_unused:UNUSED_PAD src0_sel:DWORD src1_sel:WORD_1
    ds_read_b64 v[88:89], v88
    ds_read_b64 v[90:91], v90
    v_lshlrev_b32_sdwa v92, 3, v119 dst_sel:DWORD dst_unused:UNUSED_PAD src0_sel:DWORD src1_sel:WORD_0
    v_lshlrev_b32_sdwa v94, 3, v119 dst_sel:DWORD dst_unused:UNUSED_PAD src0_sel:DWORD src1_sel:WORD_1
    ds_read_b64 v[92:93], v92
    ds_read_b64 v[94:95], v94
    s_waitcnt lgkmcnt(8)
    v_add3_u32 v42, v42, v96, v98
    v_add3_u32 v43, v43, v97, v99
    v_add3_u32 v42, v42, v100, v102
    v_add3_u32 v43, v43, v101, v103
    s_waitcnt vmcnt(7)
    v_lshlrev_b32_sdwa v96, 3, v120 dst_sel:DWORD dst_unused:UNUSED_PAD src0_sel:DWORD src1_sel:WORD_0
    v_lshlrev_b32_sdwa v98, 3, v120 dst_sel:DWORD dst_unused:UNUSED_PAD src0_sel:DWORD src1_sel:WORD_1
    ds_read_b64 v[96:97], v96
    ds_read_b64 v[98:99], v98
    v_lshlrev_b32_sdwa v100, 3, v121 dst_sel:DWORD dst_unused:UNUSED_PAD src0_sel:DWORD src1_sel:WORD_0
    v_lshlrev_b32_sdwa v102, 3, v121 dst_sel:DWORD dst_unused:UNUSED_PAD src0_sel:DWORD src1_sel:WORD_1
    ds_read_b64 v[100:101], v100
    ds_read_b64 v[102:103], v102
    buffer_load_dwordx4 v[116:119], v71, s[12:15], s20 offen offset:2048 sc1
    buffer_store_dwordx4 v[36:39], v71, s[12:15], s16 offen offset:1024 sc1
    s_waitcnt lgkmcnt(8)
    v_add3_u32 v44, v44, v104, v106
    v_add3_u32 v45, v45, v105, v107
    v_add3_u32 v44, v44, v108, v110
    v_add3_u32 v45, v45, v109, v111
    v_lshlrev_b32_sdwa v104, 3, v122 dst_sel:DWORD dst_unused:UNUSED_PAD src0_sel:DWORD src1_sel:WORD_0
    v_lshlrev_b32_sdwa v106, 3, v122 dst_sel:DWORD dst_unused:UNUSED_PAD src0_sel:DWORD src1_sel:WORD_1
    ds_read_b64 v[104:105], v104
    ds_read_b64 v[106:107], v106
    v_lshlrev_b32_sdwa v108, 3, v123 dst_sel:DWORD dst_unused:UNUSED_PAD src0_sel:DWORD src1_sel:WORD_0
    v_lshlrev_b32_sdwa v110, 3, v123 dst_sel:DWORD dst_unused:UNUSED_PAD src0_sel:DWORD src1_sel:WORD_1
    ds_read_b64 v[108:109], v108
    ds_read_b64 v[110:111], v110
    s_waitcnt lgkmcnt(8)
    v_add3_u32 v44, v44, v88, v90
    v_add3_u32 v45, v45, v89, v91
    v_add3_u32 v44, v44, v92, v94
    v_add3_u32 v45, v45, v93, v95
    s_waitcnt vmcnt(8)
    v_lshlrev_b32_sdwa v88, 3, v72 dst_sel:DWORD dst_unused:UNUSED_PAD src0_sel:DWORD src1_sel:WORD_0
    v_lshlrev_b32_sdwa v90, 3, v72 dst_sel:DWORD dst_unused:UNUSED_PAD src0_sel:DWORD src1_sel:WORD_1
    ds_read_b64 v[88:89], v88
    ds_read_b64 v[90:91], v90
    v_lshlrev_b32_sdwa v92, 3, v73 dst_sel:DWORD dst_unused:UNUSED_PAD src0_sel:DWORD src1_sel:WORD_0
    v_lshlrev_b32_sdwa v94, 3, v73 dst_sel:DWORD dst_unused:UNUSED_PAD src0_sel:DWORD src1_sel:WORD_1
    ds_read_b64 v[92:93], v92
    ds_read_b64 v[94:95], v94
    buffer_load_dwordx4 v[36:39], v71, s[12:15], s20 offen offset:3072 sc1
    s_waitcnt lgkmcnt(8)
    v_add3_u32 v46, v46, v96, v98
    v_add3_u32 v47, v47, v97, v99
    v_add3_u32 v46, v46, v100, v102
    v_add3_u32 v47, v47, v101, v103
    v_lshlrev_b32_sdwa v96, 3, v74 dst_sel:DWORD dst_unused:UNUSED_PAD src0_sel:DWORD src1_sel:WORD_0
    v_lshlrev_b32_sdwa v98, 3, v74 dst_sel:DWORD dst_unused:UNUSED_PAD src0_sel:DWORD src1_sel:WORD_1
    ds_read_b64 v[96:97], v96
    ds_read_b64 v[98:99], v98
    v_lshlrev_b32_sdwa v100, 3, v75 dst_sel:DWORD dst_unused:UNUSED_PAD src0_sel:DWORD src1_sel:WORD_0
    v_lshlrev_b32_sdwa v102, 3, v75 dst_sel:DWORD dst_unused:UNUSED_PAD src0_sel:DWORD src1_sel:WORD_1
    ds_read_b64 v[100:101], v100
    ds_read_b64 v[102:103], v102
    s_waitcnt lgkmcnt(8)
    v_add3_u32 v46, v46, v104, v106
    v_add3_u32 v47, v47, v105, v107
    v_add3_u32 v46, v46, v108, v110
    v_add3_u32 v47, v47, v109, v111
    s_waitcnt vmcnt(8)
    v_lshlrev_b32_sdwa v104, 3, v76 dst_sel:DWORD dst_unused:UNUSED_PAD src0_sel:DWORD src1_sel:WORD_0
    v_lshlrev_b32_sdwa v106, 3, v76 dst_sel:DWORD dst_unused:UNUSED_PAD src0_sel:DWORD src1_sel:WORD_1
    ds_read_b64 v[104:105], v104
    ds_read_b64 v[106:107], v106
    v_lshlrev_b32_sdwa v108, 3, v77 dst_sel:DWORD dst_unused:UNUSED_PAD src0_sel:DWORD src1_sel:WORD_0
    v_lshlrev_b32_sdwa v110, 3, v77 dst_sel:DWORD dst_unused:UNUSED_PAD src0_sel:DWORD src1_sel:WORD_1
    ds_read_b64 v[108:109], v108
    ds_read_b64 v[110:111], v110
    s_add_u32 s20, s20, 0xfff9d000
    buffer_load_dwordx4 v[120:123], v71, s[12:15], s20 offen offset:0 sc1
    s_waitcnt lgkmcnt(8)
    v_add3_u32 v48, v48, v88, v90
    v_add3_u32 v49, v49, v89, v91
    v_add3_u32 v48, v48, v92, v94
    v_add3_u32 v49, v49, v93, v95
    v_lshlrev_b32_sdwa v88, 3, v78 dst_sel:DWORD dst_unused:UNUSED_PAD src0_sel:DWORD src1_sel:WORD_0
    v_lshlrev_b32_sdwa v90, 3, v78 dst_sel:DWORD dst_unused:UNUSED_PAD src0_sel:DWORD src1_sel:WORD_1
    ds_read_b64 v[88:89], v88
    ds_read_b64 v[90:91], v90
    v_lshlrev_b32_sdwa v92, 3, v79 dst_sel:DWORD dst_unused:UNUSED_PAD src0_sel:DWORD src1_sel:WORD_0
    v_lshlrev_b32_sdwa v94, 3, v79 dst_sel:DWORD dst_unused:UNUSED_PAD src0_sel:DWORD src1_sel:WORD_1
    ds_read_b64 v[92:93], v92
    ds_read_b64 v[94:95], v94
    s_waitcnt lgkmcnt(8)
    v_add3_u32 v48, v48, v96, v98
    v_add3_u32 v49, v49, v97, v99
    v_add3_u32 v48, v48, v100, v102
    v_add3_u32 v49, v49, v101, v103
    s_waitcnt vmcnt(7)
    v_lshlrev_b32_sdwa v96, 3, v32 dst_sel:DWORD dst_unused:UNUSED_PAD src0_sel:DWORD src1_sel:WORD_0
    v_lshlrev_b32_sdwa v98, 3, v32 dst_sel:DWORD dst_unused:UNUSED_PAD src0_sel:DWORD src1_sel:WORD_1
    ds_read_b64 v[96:97], v96
    ds_read_b64 v[98:99], v98
    v_lshlrev_b32_sdwa v100, 3, v33 dst_sel:DWORD dst_unused:UNUSED_PAD src0_sel:DWORD src1_sel:WORD_0
    v_lshlrev_b32_sdwa v102, 3, v33 dst_sel:DWORD dst_unused:UNUSED_PAD src0_sel:DWORD src1_sel:WORD_1
    ds_read_b64 v[100:101], v100
    ds_read_b64 v[102:103], v102
    buffer_load_dwordx4 v[72:75], v71, s[12:15], s20 offen offset:1024 sc1
    s_waitcnt lgkmcnt(8)
    v_add3_u32 v50, v50, v104, v106
    v_add3_u32 v51, v51, v105, v107
    v_add3_u32 v50, v50, v108, v110
    v_add3_u32 v51, v51, v109, v111
    v_lshlrev_b32_sdwa v104, 3, v34 dst_sel:DWORD dst_unused:UNUSED_PAD src0_sel:DWORD src1_sel:WORD_0
    v_lshlrev_b32_sdwa v106, 3, v34 dst_sel:DWORD dst_unused:UNUSED_PAD src0_sel:DWORD src1_sel:WORD_1
    ds_read_b64 v[104:105], v104
    ds_read_b64 v[106:107], v106
    v_lshlrev_b32_sdwa v108, 3, v35 dst_sel:DWORD dst_unused:UNUSED_PAD src0_sel:DWORD src1_sel:WORD_0
    v_lshlrev_b32_sdwa v110, 3, v35 dst_sel:DWORD dst_unused:UNUSED_PAD src0_sel:DWORD src1_sel:WORD_1
    ds_read_b64 v[108:109], v108
    ds_read_b64 v[110:111], v110
    s_waitcnt lgkmcnt(8)
    v_add3_u32 v50, v50, v88, v90
    v_add3_u32 v51, v51, v89, v91
    v_add3_u32 v50, v50, v92, v94
    v_add3_u32 v51, v51, v93, v95
    s_waitcnt vmcnt(7)
    v_lshlrev_b32_sdwa v88, 3, v124 dst_sel:DWORD dst_unused:UNUSED_PAD src0_sel:DWORD src1_sel:WORD_0
    v_lshlrev_b32_sdwa v90, 3, v124 dst_sel:DWORD dst_unused:UNUSED_PAD src0_sel:DWORD src1_sel:WORD_1
    ds_read_b64 v[88:89], v88
    ds_read_b64 v[90:91], v90
    v_lshlrev_b32_sdwa v92, 3, v125 dst_sel:DWORD dst_unused:UNUSED_PAD src0_sel:DWORD src1_sel:WORD_0
    v_lshlrev_b32_sdwa v94, 3, v125 dst_sel:DWORD dst_unused:UNUSED_PAD src0_sel:DWORD src1_sel:WORD_1
    ds_read_b64 v[92:93], v92
    ds_read_b64 v[94:95], v94
    buffer_load_dwordx4 v[76:79], v71, s[12:15], s20 offen offset:2048 sc1
    buffer_store_dwordx4 v[40:43], v71, s[12:15], s16 offen offset:2048 sc1
    s_waitcnt lgkmcnt(8)
    v_add3_u32 v52, v52, v96, v98
    v_add3_u32 v53, v53, v97, v99
    v_add3_u32 v52, v52, v100, v102
    v_add3_u32 v53, v53, v101, v103
    v_lshlrev_b32_sdwa v96, 3, v126 dst_sel:DWORD dst_unused:UNUSED_PAD src0_sel:DWORD src1_sel:WORD_0
    v_lshlrev_b32_sdwa v98, 3, v126 dst_sel:DWORD dst_unused:UNUSED_PAD src0_sel:DWORD src1_sel:WORD_1
    ds_read_b64 v[96:97], v96
    ds_read_b64 v[98:99], v98
    v_lshlrev_b32_sdwa v100, 3, v127 dst_sel:DWORD dst_unused:UNUSED_PAD src0_sel:DWORD src1_sel:WORD_0
    v_lshlrev_b32_sdwa v102, 3, v127 dst_sel:DWORD dst_unused:UNUSED_PAD src0_sel:DWORD src1_sel:WORD_1
    ds_read_b64 v[100:101], v100
    ds_read_b64 v[102:103], v102
    s_waitcnt lgkmcnt(8)
    v_add3_u32 v52, v52, v104, v106
    v_add3_u32 v53, v53, v105, v107
    v_add3_u32 v52, v52, v108, v110
    v_add3_u32 v53, v53, v109, v111
    s_waitcnt vmcnt(8)
    v_lshlrev_b32_sdwa v104, 3, v80 dst_sel:DWORD dst_unused:UNUSED_PAD src0_sel:DWORD src1_sel:WORD_0
    v_lshlrev_b32_sdwa v106, 3, v80 dst_sel:DWORD dst_unused:UNUSED_PAD src0_sel:DWORD src1_sel:WORD_1
    ds_read_b64 v[104:105], v104
    ds_read_b64 v[106:107], v106
    v_lshlrev_b32_sdwa v108, 3, v81 dst_sel:DWORD dst_unused:UNUSED_PAD src0_sel:DWORD src1_sel:WORD_0
    v_lshlrev_b32_sdwa v110, 3, v81 dst_sel:DWORD dst_unused:UNUSED_PAD src0_sel:DWORD src1_sel:WORD_1
    ds_read_b64 v[108:109], v108
    ds_read_b64 v[110:111], v110
    buffer_load_dwordx4 v[32:35], v71, s[12:15], s20 offen offset:3072 sc1
    s_waitcnt lgkmcnt(8)
    v_add3_u32 v54, v54, v88, v90
    v_add3_u32 v55, v55, v89, v91
    v_add3_u32 v54, v54, v92, v94
    v_add3_u32 v55, v55, v93, v95
    v_lshlrev_b32_sdwa v88, 3, v82 dst_sel:DWORD dst_unused:UNUSED_PAD src0_sel:DWORD src1_sel:WORD_0
    v_lshlrev_b32_sdwa v90, 3, v82 dst_sel:DWORD dst_unused:UNUSED_PAD src0_sel:DWORD src1_sel:WORD_1
    ds_read_b64 v[88:89], v88
    ds_read_b64 v[90:91], v90
    v_lshlrev_b32_sdwa v92, 3, v83 dst_sel:DWORD dst_unused:UNUSED_PAD src0_sel:DWORD src1_sel:WORD_0
    v_lshlrev_b32_sdwa v94, 3, v83 dst_sel:DWORD dst_unused:UNUSED_PAD src0_sel:DWORD src1_sel:WORD_1
    ds_read_b64 v[92:93], v92
    ds_read_b64 v[94:95], v94
    buffer_load_dwordx4 v[80:83], v71, s[12:15], s19 offen offset:0
    s_waitcnt lgkmcnt(8)
    v_add3_u32 v54, v54, v96, v98
    v_add3_u32 v55, v55, v97, v99
    v_add3_u32 v54, v54, v100, v102
    v_add3_u32 v55, v55, v101, v103
    s_waitcnt vmcnt(9)
    v_lshlrev_b32_sdwa v96, 3, v84 dst_sel:DWORD dst_unused:UNUSED_PAD src0_sel:DWORD src1_sel:WORD_0
    v_lshlrev_b32_sdwa v98, 3, v84 dst_sel:DWORD dst_unused:UNUSED_PAD src0_sel:DWORD src1_sel:WORD_1
    ds_read_b64 v[96:97], v96
    ds_read_b64 v[98:99], v98
    v_lshlrev_b32_sdwa v100, 3, v85 dst_sel:DWORD dst_unused:UNUSED_PAD src0_sel:DWORD src1_sel:WORD_0
    v_lshlrev_b32_sdwa v102, 3, v85 dst_sel:DWORD dst_unused:UNUSED_PAD src0_sel:DWORD src1_sel:WORD_1
    ds_read_b64 v[100:101], v100
    ds_read_b64 v[102:103], v102
    s_add_u32 s20, s20, 0x1000
    buffer_load_dwordx4 v[40:43], v71, s[12:15], s20 offen offset:0 sc1
    s_waitcnt lgkmcnt(8)
    v_add3_u32 v56, v56, v104, v106
    v_add3_u32 v57, v57, v105, v107
    v_add3_u32 v56, v56, v108, v110
    v_add3_u32 v57, v57, v109, v111
    v_lshlrev_b32_sdwa v104, 3, v86 dst_sel:DWORD dst_unused:UNUSED_PAD src0_sel:DWORD src1_sel:WORD_0
    v_lshlrev_b32_sdwa v106, 3, v86 dst_sel:DWORD dst_unused:UNUSED_PAD src0_sel:DWORD src1_sel:WORD_1
    ds_read_b64 v[104:105], v104
    ds_read_b64 v[106:107], v106
    v_lshlrev_b32_sdwa v108, 3, v87 dst_sel:DWORD dst_unused:UNUSED_PAD src0_sel:DWORD src1_sel:WORD_0
    v_lshlrev_b32_sdwa v110, 3, v87 dst_sel:DWORD dst_unused:UNUSED_PAD src0_sel:DWORD src1_sel:WORD_1
    ds_read_b64 v[108:109], v108
    ds_read_b64 v[110:111], v110
    buffer_load_dwordx4 v[84:87], v71, s[12:15], s19 offen offset:1024
    s_waitcnt lgkmcnt(8)
    v_add3_u32 v56, v56, v88, v90
    v_add3_u32 v57, v57, v89, v91
    v_add3_u32 v56, v56, v92, v94
    v_add3_u32 v57, v57, v93, v95
    s_waitcnt vmcnt(10)
    v_lshlrev_b32_sdwa v88, 3, v116 dst_sel:DWORD dst_unused:UNUSED_PAD src0_sel:DWORD src1_sel:WORD_0
    v_lshlrev_b32_sdwa v90, 3, v116 dst_sel:DWORD dst_unused:UNUSED_PAD src0_sel:DWORD src1_sel:WORD_1
    ds_read_b64 v[88:89], v88
    ds_read_b64 v[90:91], v90
    v_lshlrev_b32_sdwa v92, 3, v117 dst_sel:DWORD dst_unused:UNUSED_PAD src0_sel:DWORD src1_sel:WORD_0
    v_lshlrev_b32_sdwa v94, 3, v117 dst_sel:DWORD dst_unused:UNUSED_PAD src0_sel:DWORD src1_sel:WORD_1
    ds_read_b64 v[92:93], v92
    ds_read_b64 v[94:95], v94
    buffer_load_dwordx4 v[124:127], v71, s[12:15], s20 offen offset:1024 sc1
    s_waitcnt lgkmcnt(8)
    v_add3_u32 v58, v58, v96, v98
    v_add3_u32 v59, v59, v97, v99
    v_add3_u32 v58, v58, v100, v102
    v_add3_u32 v59, v59, v101, v103
    v_lshlrev_b32_sdwa v96, 3, v118 dst_sel:DWORD dst_unused:UNUSED_PAD src0_sel:DWORD src1_sel:WORD_0
    v_lshlrev_b32_sdwa v98, 3, v118 dst_sel:DWORD dst_unused:UNUSED_PAD src0_sel:DWORD src1_sel:WORD_1
    ds_read_b64 v[96:97], v96
    ds_read_b64 v[98:99], v98
    v_lshlrev_b32_sdwa v100, 3, v119 dst_sel:DWORD dst_unused:UNUSED_PAD src0_sel:DWORD src1_sel:WORD_0
    v_lshlrev_b32_sdwa v102, 3, v119 dst_sel:DWORD dst_unused:UNUSED_PAD src0_sel:DWORD src1_sel:WORD_1
    ds_read_b64 v[100:101], v100
    ds_read_b64 v[102:103], v102
    s_waitcnt lgkmcnt(8)
    v_add3_u32 v58, v58, v104, v106
    v_add3_u32 v59, v59, v105, v107
    v_add3_u32 v58, v58, v108, v110
    v_add3_u32 v59, v59, v109, v111
    s_waitcnt vmcnt(9)
    v_lshlrev_b32_sdwa v104, 3, v36 dst_sel:DWORD dst_unused:UNUSED_PAD src0_sel:DWORD src1_sel:WORD_0
    v_lshlrev_b32_sdwa v106, 3, v36 dst_sel:DWORD dst_unused:UNUSED_PAD src0_sel:DWORD src1_sel:WORD_1
    ds_read_b64 v[104:105], v104
    ds_read_b64 v[106:107], v106
    v_lshlrev_b32_sdwa v108, 3, v37 dst_sel:DWORD dst_unused:UNUSED_PAD src0_sel:DWORD src1_sel:WORD_0
    v_lshlrev_b32_sdwa v110, 3, v37 dst_sel:DWORD dst_unused:UNUSED_PAD src0_sel:DWORD src1_sel:WORD_1
    ds_read_b64 v[108:109], v108
    ds_read_b64 v[110:111], v110
    buffer_load_dwordx4 v[116:119], v71, s[12:15], s20 offen offset:2048 sc1
    buffer_store_dwordx4 v[44:47], v71, s[12:15], s16 offen offset:3072 sc1
    s_waitcnt lgkmcnt(8)
    v_add3_u32 v60, v60, v88, v90
    v_add3_u32 v61, v61, v89, v91
    v_add3_u32 v60, v60, v92, v94
    v_add3_u32 v61, v61, v93, v95
    v_lshlrev_b32_sdwa v88, 3, v38 dst_sel:DWORD dst_unused:UNUSED_PAD src0_sel:DWORD src1_sel:WORD_0
    v_lshlrev_b32_sdwa v90, 3, v38 dst_sel:DWORD dst_unused:UNUSED_PAD src0_sel:DWORD src1_sel:WORD_1
    ds_read_b64 v[88:89], v88
    ds_read_b64 v[90:91], v90
    v_lshlrev_b32_sdwa v92, 3, v39 dst_sel:DWORD dst_unused:UNUSED_PAD src0_sel:DWORD src1_sel:WORD_0
    v_lshlrev_b32_sdwa v94, 3, v39 dst_sel:DWORD dst_unused:UNUSED_PAD src0_sel:DWORD src1_sel:WORD_1
    ds_read_b64 v[92:93], v92
    ds_read_b64 v[94:95], v94
    s_waitcnt lgkmcnt(8)
    v_add3_u32 v60, v60, v96, v98
    v_add3_u32 v61, v61, v97, v99
    v_add3_u32 v60, v60, v100, v102
    v_add3_u32 v61, v61, v101, v103
    s_waitcnt vmcnt(10)
    v_lshlrev_b32_sdwa v96, 3, v120 dst_sel:DWORD dst_unused:UNUSED_PAD src0_sel:DWORD src1_sel:WORD_0
    v_lshlrev_b32_sdwa v98, 3, v120 dst_sel:DWORD dst_unused:UNUSED_PAD src0_sel:DWORD src1_sel:WORD_1
    ds_read_b64 v[96:97], v96
    ds_read_b64 v[98:99], v98
    v_lshlrev_b32_sdwa v100, 3, v121 dst_sel:DWORD dst_unused:UNUSED_PAD src0_sel:DWORD src1_sel:WORD_0
    v_lshlrev_b32_sdwa v102, 3, v121 dst_sel:DWORD dst_unused:UNUSED_PAD src0_sel:DWORD src1_sel:WORD_1
    ds_read_b64 v[100:101], v100
    ds_read_b64 v[102:103], v102
    buffer_load_dwordx4 v[44:47], v71, s[12:15], s20 offen offset:3072 sc1
    s_waitcnt lgkmcnt(8)
    v_add3_u32 v62, v62, v104, v106
    v_add3_u32 v63, v63, v105, v107
    v_add3_u32 v62, v62, v108, v110
    v_add3_u32 v63, v63, v109, v111
    v_lshlrev_b32_sdwa v104, 3, v122 dst_sel:DWORD dst_unused:UNUSED_PAD src0_sel:DWORD src1_sel:WORD_0
    v_lshlrev_b32_sdwa v106, 3, v122 dst_sel:DWORD dst_unused:UNUSED_PAD src0_sel:DWORD src1_sel:WORD_1
    ds_read_b64 v[104:105], v104
    ds_read_b64 v[106:107], v106
    v_lshlrev_b32_sdwa v108, 3, v123 dst_sel:DWORD dst_unused:UNUSED_PAD src0_sel:DWORD src1_sel:WORD_0
    v_lshlrev_b32_sdwa v110, 3, v123 dst_sel:DWORD dst_unused:UNUSED_PAD src0_sel:DWORD src1_sel:WORD_1
    ds_read_b64 v[108:109], v108
    ds_read_b64 v[110:111], v110
    s_waitcnt lgkmcnt(8)
    v_add3_u32 v62, v62, v88, v90
    v_add3_u32 v63, v63, v89, v91
    v_add3_u32 v62, v62, v92, v94
    v_add3_u32 v63, v63, v93, v95
    s_waitcnt vmcnt(10)
    v_lshlrev_b32_sdwa v88, 3, v72 dst_sel:DWORD dst_unused:UNUSED_PAD src0_sel:DWORD src1_sel:WORD_0
    v_lshlrev_b32_sdwa v90, 3, v72 dst_sel:DWORD dst_unused:UNUSED_PAD src0_sel:DWORD src1_sel:WORD_1
    ds_read_b64 v[88:89], v88
    ds_read_b64 v[90:91], v90
    v_lshlrev_b32_sdwa v92, 3, v73 dst_sel:DWORD dst_unused:UNUSED_PAD src0_sel:DWORD src1_sel:WORD_0
    v_lshlrev_b32_sdwa v94, 3, v73 dst_sel:DWORD dst_unused:UNUSED_PAD src0_sel:DWORD src1_sel:WORD_1
    ds_read_b64 v[92:93], v92
    ds_read_b64 v[94:95], v94
    s_add_u32 s20, s20, 0x1000
    buffer_load_dwordx4 v[36:39], v71, s[12:15], s20 offen offset:0 sc1
    s_waitcnt lgkmcnt(8)
    v_add3_u32 v0, v0, v96, v98
    v_add3_u32 v1, v1, v97, v99
    v_add3_u32 v0, v0, v100, v102
    v_add3_u32 v1, v1, v101, v103
    v_lshlrev_b32_sdwa v96, 3, v74 dst_sel:DWORD dst_unused:UNUSED_PAD src0_sel:DWORD src1_sel:WORD_0
    v_lshlrev_b32_sdwa v98, 3, v74 dst_sel:DWORD dst_unused:UNUSED_PAD src0_sel:DWORD src1_sel:WORD_1
    ds_read_b64 v[96:97], v96
    ds_read_b64 v[98:99], v98
    v_lshlrev_b32_sdwa v100, 3, v75 dst_sel:DWORD dst_unused:UNUSED_PAD src0_sel:DWORD src1_sel:WORD_0
    v_lshlrev_b32_sdwa v102, 3, v75 dst_sel:DWORD dst_unused:UNUSED_PAD src0_sel:DWORD src1_sel:WORD_1
    ds_read_b64 v[100:101], v100
    ds_read_b64 v[102:103], v102
    buffer_load_dwordx4 v[72:75], v71, s[12:15], s21 offen offset:0
    s_waitcnt lgkmcnt(8)
    v_add3_u32 v0, v0, v104, v106
    v_add3_u32 v1, v1, v105, v107
    v_add3_u32 v0, v0, v108, v110
    v_add3_u32 v1, v1, v109, v111
    s_waitcnt vmcnt(11)
    v_lshlrev_b32_sdwa v104, 3, v76 dst_sel:DWORD dst_unused:UNUSED_PAD src0_sel:DWORD src1_sel:WORD_0
    v_lshlrev_b32_sdwa v106, 3, v76 dst_sel:DWORD dst_unused:UNUSED_PAD src0_sel:DWORD src1_sel:WORD_1
    ds_read_b64 v[104:105], v104
    ds_read_b64 v[106:107], v106
    v_lshlrev_b32_sdwa v108, 3, v77 dst_sel:DWORD dst_unused:UNUSED_PAD src0_sel:DWORD src1_sel:WORD_0
    v_lshlrev_b32_sdwa v110, 3, v77 dst_sel:DWORD dst_unused:UNUSED_PAD src0_sel:DWORD src1_sel:WORD_1
    ds_read_b64 v[108:109], v108
    ds_read_b64 v[110:111], v110
    buffer_load_dwordx4 v[120:123], v71, s[12:15], s20 offen offset:1024 sc1
    s_waitcnt lgkmcnt(8)
    v_add3_u32 v2, v2, v88, v90
    v_add3_u32 v3, v3, v89, v91
    v_add3_u32 v2, v2, v92, v94
    v_add3_u32 v3, v3, v93, v95
    v_lshlrev_b32_sdwa v88, 3, v78 dst_sel:DWORD dst_unused:UNUSED_PAD src0_sel:DWORD src1_sel:WORD_0
    v_lshlrev_b32_sdwa v90, 3, v78 dst_sel:DWORD dst_unused:UNUSED_PAD src0_sel:DWORD src1_sel:WORD_1
    ds_read_b64 v[88:89], v88
    ds_read_b64 v[90:91], v90
    v_lshlrev_b32_sdwa v92, 3, v79 dst_sel:DWORD dst_unused:UNUSED_PAD src0_sel:DWORD src1_sel:WORD_0
    v_lshlrev_b32_sdwa v94, 3, v79 dst_sel:DWORD dst_unused:UNUSED_PAD src0_sel:DWORD src1_sel:WORD_1
    ds_read_b64 v[92:93], v92
    ds_read_b64 v[94:95], v94
    buffer_load_dwordx4 v[76:79], v71, s[12:15], s21 offen offset:1024
    s_waitcnt lgkmcnt(8)
    v_add3_u32 v2, v2, v96, v98
    v_add3_u32 v3, v3, v97, v99
    v_add3_u32 v2, v2, v100, v102
    v_add3_u32 v3, v3, v101, v103
    s_waitcnt vmcnt(11)
    v_lshlrev_b32_sdwa v96, 3, v32 dst_sel:DWORD dst_unused:UNUSED_PAD src0_sel:DWORD src1_sel:WORD_0
    v_lshlrev_b32_sdwa v98, 3, v32 dst_sel:DWORD dst_unused:UNUSED_PAD src0_sel:DWORD src1_sel:WORD_1
    ds_read_b64 v[96:97], v96
    ds_read_b64 v[98:99], v98
    v_lshlrev_b32_sdwa v100, 3, v33 dst_sel:DWORD dst_unused:UNUSED_PAD src0_sel:DWORD src1_sel:WORD_0
    v_lshlrev_b32_sdwa v102, 3, v33 dst_sel:DWORD dst_unused:UNUSED_PAD src0_sel:DWORD src1_sel:WORD_1
    ds_read_b64 v[100:101], v100
    ds_read_b64 v[102:103], v102
    buffer_store_dwordx4 v[48:51], v71, s[12:15], s17 offen offset:0 sc1
    s_waitcnt lgkmcnt(8)
    v_add3_u32 v4, v4, v104, v106
    v_add3_u32 v5, v5, v105, v107
    v_add3_u32 v4, v4, v108, v110
    v_add3_u32 v5, v5, v109, v111
    v_lshlrev_b32_sdwa v104, 3, v34 dst_sel:DWORD dst_unused:UNUSED_PAD src0_sel:DWORD src1_sel:WORD_0
    v_lshlrev_b32_sdwa v106, 3, v34 dst_sel:DWORD dst_unused:UNUSED_PAD src0_sel:DWORD src1_sel:WORD_1
    ds_read_b64 v[104:105], v104
    ds_read_b64 v[106:107], v106
    v_lshlrev_b32_sdwa v108, 3, v35 dst_sel:DWORD dst_unused:UNUSED_PAD src0_sel:DWORD src1_sel:WORD_0
    v_lshlrev_b32_sdwa v110, 3, v35 dst_sel:DWORD dst_unused:UNUSED_PAD src0_sel:DWORD src1_sel:WORD_1
    ds_read_b64 v[108:109], v108
    ds_read_b64 v[110:111], v110
    buffer_load_dwordx4 v[32:35], v71, s[12:15], s20 offen offset:2048 sc1
    s_waitcnt lgkmcnt(8)
    v_add3_u32 v4, v4, v88, v90
    v_add3_u32 v5, v5, v89, v91
    v_add3_u32 v4, v4, v92, v94
    v_add3_u32 v5, v5, v93, v95
    s_waitcnt vmcnt(11)
    v_lshlrev_b32_sdwa v88, 3, v40 dst_sel:DWORD dst_unused:UNUSED_PAD src0_sel:DWORD src1_sel:WORD_0
    v_lshlrev_b32_sdwa v90, 3, v40 dst_sel:DWORD dst_unused:UNUSED_PAD src0_sel:DWORD src1_sel:WORD_1
    ds_read_b64 v[88:89], v88
    ds_read_b64 v[90:91], v90
    v_lshlrev_b32_sdwa v92, 3, v41 dst_sel:DWORD dst_unused:UNUSED_PAD src0_sel:DWORD src1_sel:WORD_0
    v_lshlrev_b32_sdwa v94, 3, v41 dst_sel:DWORD dst_unused:UNUSED_PAD src0_sel:DWORD src1_sel:WORD_1
    ds_read_b64 v[92:93], v92
    ds_read_b64 v[94:95], v94
    s_waitcnt lgkmcnt(8)
    v_add3_u32 v6, v6, v96, v98
    v_add3_u32 v7, v7, v97, v99
    v_add3_u32 v6, v6, v100, v102
    v_add3_u32 v7, v7, v101, v103
    v_lshlrev_b32_sdwa v96, 3, v42 dst_sel:DWORD dst_unused:UNUSED_PAD src0_sel:DWORD src1_sel:WORD_0
    v_lshlrev_b32_sdwa v98, 3, v42 dst_sel:DWORD dst_unused:UNUSED_PAD src0_sel:DWORD src1_sel:WORD_1
    ds_read_b64 v[96:97], v96
    ds_read_b64 v[98:99], v98
    v_lshlrev_b32_sdwa v100, 3, v43 dst_sel:DWORD dst_unused:UNUSED_PAD src0_sel:DWORD src1_sel:WORD_0
    v_lshlrev_b32_sdwa v102, 3, v43 dst_sel:DWORD dst_unused:UNUSED_PAD src0_sel:DWORD src1_sel:WORD_1
    ds_read_b64 v[100:101], v100
    ds_read_b64 v[102:103], v102
    buffer_load_dwordx4 v[40:43], v71, s[12:15], s20 offen offset:3072 sc1
    s_waitcnt lgkmcnt(8)
    v_add3_u32 v6, v6, v104, v106
    v_add3_u32 v7, v7, v105, v107
    v_add3_u32 v6, v6, v108, v110
    v_add3_u32 v7, v7, v109, v111
    s_waitcnt vmcnt(10)
    v_lshlrev_b32_sdwa v104, 3, v124 dst_sel:DWORD dst_unused:UNUSED_PAD src0_sel:DWORD src1_sel:WORD_0
    v_lshlrev_b32_sdwa v106, 3, v124 dst_sel:DWORD dst_unused:UNUSED_PAD src0_sel:DWORD src1_sel:WORD_1
    ds_read_b64 v[104:105], v104
    ds_read_b64 v[106:107], v106
    v_lshlrev_b32_sdwa v108, 3, v125 dst_sel:DWORD dst_unused:UNUSED_PAD src0_sel:DWORD src1_sel:WORD_0
    v_lshlrev_b32_sdwa v110, 3, v125 dst_sel:DWORD dst_unused:UNUSED_PAD src0_sel:DWORD src1_sel:WORD_1
    ds_read_b64 v[108:109], v108
    ds_read_b64 v[110:111], v110
    s_waitcnt lgkmcnt(8)
    v_add3_u32 v8, v8, v88, v90
    v_add3_u32 v9, v9, v89, v91
    v_add3_u32 v8, v8, v92, v94
    v_add3_u32 v9, v9, v93, v95
    v_lshlrev_b32_sdwa v88, 3, v126 dst_sel:DWORD dst_unused:UNUSED_PAD src0_sel:DWORD src1_sel:WORD_0
    v_lshlrev_b32_sdwa v90, 3, v126 dst_sel:DWORD dst_unused:UNUSED_PAD src0_sel:DWORD src1_sel:WORD_1
    ds_read_b64 v[88:89], v88
    ds_read_b64 v[90:91], v90
    v_lshlrev_b32_sdwa v92, 3, v127 dst_sel:DWORD dst_unused:UNUSED_PAD src0_sel:DWORD src1_sel:WORD_0
    v_lshlrev_b32_sdwa v94, 3, v127 dst_sel:DWORD dst_unused:UNUSED_PAD src0_sel:DWORD src1_sel:WORD_1
    ds_read_b64 v[92:93], v92
    ds_read_b64 v[94:95], v94
    s_add_u32 s20, s20, 0x1000
    buffer_load_dwordx4 v[124:127], v71, s[12:15], s20 offen offset:0 sc1
    s_waitcnt lgkmcnt(8)
    v_add3_u32 v8, v8, v96, v98
    v_add3_u32 v9, v9, v97, v99
    v_add3_u32 v8, v8, v100, v102
    v_add3_u32 v9, v9, v101, v103
    s_waitcnt vmcnt(10)
    v_lshlrev_b32_sdwa v96, 3, v116 dst_sel:DWORD dst_unused:UNUSED_PAD src0_sel:DWORD src1_sel:WORD_0
    v_lshlrev_b32_sdwa v98, 3, v116 dst_sel:DWORD dst_unused:UNUSED_PAD src0_sel:DWORD src1_sel:WORD_1
    ds_read_b64 v[96:97], v96
    ds_read_b64 v[98:99], v98
    v_lshlrev_b32_sdwa v100, 3, v117 dst_sel:DWORD dst_unused:UNUSED_PAD src0_sel:DWORD src1_sel:WORD_0
    v_lshlrev_b32_sdwa v102, 3, v117 dst_sel:DWORD dst_unused:UNUSED_PAD src0_sel:DWORD src1_sel:WORD_1
    ds_read_b64 v[100:101], v100
    ds_read_b64 v[102:103], v102
    s_waitcnt lgkmcnt(8)
    v_add3_u32 v10, v10, v104, v106
    v_add3_u32 v11, v11, v105, v107
    v_add3_u32 v10, v10, v108, v110
    v_add3_u32 v11, v11, v109, v111
    v_lshlrev_b32_sdwa v104, 3, v118 dst_sel:DWORD dst_unused:UNUSED_PAD src0_sel:DWORD src1_sel:WORD_0
    v_lshlrev_b32_sdwa v106, 3, v118 dst_sel:DWORD dst_unused:UNUSED_PAD src0_sel:DWORD src1_sel:WORD_1
    ds_read_b64 v[104:105], v104
    ds_read_b64 v[106:107], v106
    v_lshlrev_b32_sdwa v108, 3, v119 dst_sel:DWORD dst_unused:UNUSED_PAD src0_sel:DWORD src1_sel:WORD_0
    v_lshlrev_b32_sdwa v110, 3, v119 dst_sel:DWORD dst_unused:UNUSED_PAD src0_sel:DWORD src1_sel:WORD_1
    ds_read_b64 v[108:109], v108
    ds_read_b64 v[110:111], v110
    buffer_load_dwordx4 v[116:119], v71, s[12:15], s20 offen offset:1024 sc1
    s_waitcnt lgkmcnt(8)
    v_add3_u32 v10, v10, v88, v90
    v_add3_u32 v11, v11, v89, v91
    v_add3_u32 v10, v10, v92, v94
    v_add3_u32 v11, v11, v93, v95
    s_waitcnt vmcnt(9)
    v_lshlrev_b32_sdwa v88, 3, v44 dst_sel:DWORD dst_unused:UNUSED_PAD src0_sel:DWORD src1_sel:WORD_0
    v_lshlrev_b32_sdwa v90, 3, v44 dst_sel:DWORD dst_unused:UNUSED_PAD src0_sel:DWORD src1_sel:WORD_1
    ds_read_b64 v[88:89], v88
    ds_read_b64 v[90:91], v90
    v_lshlrev_b32_sdwa v92, 3, v45 dst_sel:DWORD dst_unused:UNUSED_PAD src0_sel:DWORD src1_sel:WORD_0
    v_lshlrev_b32_sdwa v94, 3, v45 dst_sel:DWORD dst_unused:UNUSED_PAD src0_sel:DWORD src1_sel:WORD_1
    ds_read_b64 v[92:93], v92
    ds_read_b64 v[94:95], v94
    v_mov_b32 v64, 1
    s_mov_b64 exec, 1
    buffer_store_dword v64, off, s[12:15], s46 sc1
    s_mov_b64 exec, -1
    buffer_store_dwordx4 v[52:55], v71, s[12:15], s17 offen offset:1024 sc1
    s_waitcnt lgkmcnt(8)
    v_add3_u32 v12, v12, v96, v98
    v_add3_u32 v13, v13, v97, v99
    v_add3_u32 v12, v12, v100, v102
    v_add3_u32 v13, v13, v101, v103
    v_lshlrev_b32_sdwa v96, 3, v46 dst_sel:DWORD dst_unused:UNUSED_PAD src0_sel:DWORD src1_sel:WORD_0
    v_lshlrev_b32_sdwa v98, 3, v46 dst_sel:DWORD dst_unused:UNUSED_PAD src0_sel:DWORD src1_sel:WORD_1
    ds_read_b64 v[96:97], v96
    ds_read_b64 v[98:99], v98
    v_lshlrev_b32_sdwa v100, 3, v47 dst_sel:DWORD dst_unused:UNUSED_PAD src0_sel:DWORD src1_sel:WORD_0
    v_lshlrev_b32_sdwa v102, 3, v47 dst_sel:DWORD dst_unused:UNUSED_PAD src0_sel:DWORD src1_sel:WORD_1
    ds_read_b64 v[100:101], v100
    ds_read_b64 v[102:103], v102
    buffer_load_dwordx4 v[44:47], v71, s[12:15], s20 offen offset:2048 sc1
    s_waitcnt lgkmcnt(8)
    v_add3_u32 v12, v12, v104, v106
    v_add3_u32 v13, v13, v105, v107
    v_add3_u32 v12, v12, v108, v110
    v_add3_u32 v13, v13, v109, v111
    s_waitcnt vmcnt(11)
    v_lshlrev_b32_sdwa v104, 3, v36 dst_sel:DWORD dst_unused:UNUSED_PAD src0_sel:DWORD src1_sel:WORD_0
    v_lshlrev_b32_sdwa v106, 3, v36 dst_sel:DWORD dst_unused:UNUSED_PAD src0_sel:DWORD src1_sel:WORD_1
    ds_read_b64 v[104:105], v104
    ds_read_b64 v[106:107], v106
    v_lshlrev_b32_sdwa v108, 3, v37 dst_sel:DWORD dst_unused:UNUSED_PAD src0_sel:DWORD src1_sel:WORD_0
    v_lshlrev_b32_sdwa v110, 3, v37 dst_sel:DWORD dst_unused:UNUSED_PAD src0_sel:DWORD src1_sel:WORD_1
    ds_read_b64 v[108:109], v108
    ds_read_b64 v[110:111], v110
    s_waitcnt lgkmcnt(8)
    v_add3_u32 v14, v14, v88, v90
    v_add3_u32 v15, v15, v89, v91
    v_add3_u32 v14, v14, v92, v94
    v_add3_u32 v15, v15, v93, v95
    s_setprio 2
    v_lshlrev_b32_sdwa v88, 3, v38 dst_sel:DWORD dst_unused:UNUSED_PAD src0_sel:DWORD src1_sel:WORD_0
    v_lshlrev_b32_sdwa v90, 3, v38 dst_sel:DWORD dst_unused:UNUSED_PAD src0_sel:DWORD src1_sel:WORD_1
    ds_read_b64 v[88:89], v88
    ds_read_b64 v[90:91], v90
    v_lshlrev_b32_sdwa v92, 3, v39 dst_sel:DWORD dst_unused:UNUSED_PAD src0_sel:DWORD src1_sel:WORD_0
    v_lshlrev_b32_sdwa v94, 3, v39 dst_sel:DWORD dst_unused:UNUSED_PAD src0_sel:DWORD src1_sel:WORD_1
    ds_read_b64 v[92:93], v92
    ds_read_b64 v[94:95], v94
    buffer_load_dwordx4 v[36:39], v71, s[12:15], s20 offen offset:3072 sc1
    s_waitcnt lgkmcnt(8)
    v_add3_u32 v14, v14, v96, v98
    v_add3_u32 v15, v15, v97, v99
    v_add3_u32 v14, v14, v100, v102
    v_add3_u32 v15, v15, v101, v103
    s_waitcnt vmcnt(10)
    v_lshlrev_b32_sdwa v96, 3, v120 dst_sel:DWORD dst_unused:UNUSED_PAD src0_sel:DWORD src1_sel:WORD_0
    v_lshlrev_b32_sdwa v98, 3, v120 dst_sel:DWORD dst_unused:UNUSED_PAD src0_sel:DWORD src1_sel:WORD_1
    ds_read_b64 v[96:97], v96
    ds_read_b64 v[98:99], v98
    v_lshlrev_b32_sdwa v100, 3, v121 dst_sel:DWORD dst_unused:UNUSED_PAD src0_sel:DWORD src1_sel:WORD_0
    v_lshlrev_b32_sdwa v102, 3, v121 dst_sel:DWORD dst_unused:UNUSED_PAD src0_sel:DWORD src1_sel:WORD_1
    ds_read_b64 v[100:101], v100
    ds_read_b64 v[102:103], v102
    s_waitcnt lgkmcnt(8)
    v_add3_u32 v16, v16, v104, v106
    v_add3_u32 v17, v17, v105, v107
    v_add3_u32 v16, v16, v108, v110
    v_add3_u32 v17, v17, v109, v111
    v_lshlrev_b32_sdwa v104, 3, v122 dst_sel:DWORD dst_unused:UNUSED_PAD src0_sel:DWORD src1_sel:WORD_0
    v_lshlrev_b32_sdwa v106, 3, v122 dst_sel:DWORD dst_unused:UNUSED_PAD src0_sel:DWORD src1_sel:WORD_1
    ds_read_b64 v[104:105], v104
    ds_read_b64 v[106:107], v106
    v_lshlrev_b32_sdwa v108, 3, v123 dst_sel:DWORD dst_unused:UNUSED_PAD src0_sel:DWORD src1_sel:WORD_0
    v_lshlrev_b32_sdwa v110, 3, v123 dst_sel:DWORD dst_unused:UNUSED_PAD src0_sel:DWORD src1_sel:WORD_1
    ds_read_b64 v[108:109], v108
    ds_read_b64 v[110:111], v110
    s_add_u32 s20, s20, 0x3d000
    buffer_load_dwordx4 v[120:123], v71, s[12:15], s20 offen offset:0 sc1
    s_waitcnt lgkmcnt(8)
    v_add3_u32 v16, v16, v88, v90
    v_add3_u32 v17, v17, v89, v91
    v_add3_u32 v16, v16, v92, v94
    v_add3_u32 v17, v17, v93, v95
    s_waitcnt vmcnt(8)
    v_lshlrev_b32_sdwa v88, 3, v32 dst_sel:DWORD dst_unused:UNUSED_PAD src0_sel:DWORD src1_sel:WORD_0
    v_lshlrev_b32_sdwa v90, 3, v32 dst_sel:DWORD dst_unused:UNUSED_PAD src0_sel:DWORD src1_sel:WORD_1
    ds_read_b64 v[88:89], v88
    ds_read_b64 v[90:91], v90
    v_lshlrev_b32_sdwa v92, 3, v33 dst_sel:DWORD dst_unused:UNUSED_PAD src0_sel:DWORD src1_sel:WORD_0
    v_lshlrev_b32_sdwa v94, 3, v33 dst_sel:DWORD dst_unused:UNUSED_PAD src0_sel:DWORD src1_sel:WORD_1
    ds_read_b64 v[92:93], v92
    ds_read_b64 v[94:95], v94
    s_waitcnt lgkmcnt(8)
    v_add3_u32 v18, v18, v96, v98
    v_add3_u32 v19, v19, v97, v99
    v_add3_u32 v18, v18, v100, v102
    v_add3_u32 v19, v19, v101, v103
    v_lshlrev_b32_sdwa v96, 3, v34 dst_sel:DWORD dst_unused:UNUSED_PAD src0_sel:DWORD src1_sel:WORD_0
    v_lshlrev_b32_sdwa v98, 3, v34 dst_sel:DWORD dst_unused:UNUSED_PAD src0_sel:DWORD src1_sel:WORD_1
    ds_read_b64 v[96:97], v96
    ds_read_b64 v[98:99], v98
    v_lshlrev_b32_sdwa v100, 3, v35 dst_sel:DWORD dst_unused:UNUSED_PAD src0_sel:DWORD src1_sel:WORD_0
    v_lshlrev_b32_sdwa v102, 3, v35 dst_sel:DWORD dst_unused:UNUSED_PAD src0_sel:DWORD src1_sel:WORD_1
    ds_read_b64 v[100:101], v100
    ds_read_b64 v[102:103], v102
    buffer_load_dwordx4 v[32:35], v71, s[12:15], s20 offen offset:2048 sc1
    s_waitcnt lgkmcnt(8)
    v_add3_u32 v18, v18, v104, v106
    v_add3_u32 v19, v19, v105, v107
    v_add3_u32 v18, v18, v108, v110
    v_add3_u32 v19, v19, v109, v111
    s_waitcnt vmcnt(8)
    v_lshlrev_b32_sdwa v104, 3, v40 dst_sel:DWORD dst_unused:UNUSED_PAD src0_sel:DWORD src1_sel:WORD_0
    v_lshlrev_b32_sdwa v106, 3, v40 dst_sel:DWORD dst_unused:UNUSED_PAD src0_sel:DWORD src1_sel:WORD_1
    ds_read_b64 v[104:105], v104
    ds_read_b64 v[106:107], v106
    v_lshlrev_b32_sdwa v108, 3, v41 dst_sel:DWORD dst_unused:UNUSED_PAD src0_sel:DWORD src1_sel:WORD_0
    v_lshlrev_b32_sdwa v110, 3, v41 dst_sel:DWORD dst_unused:UNUSED_PAD src0_sel:DWORD src1_sel:WORD_1
    ds_read_b64 v[108:109], v108
    ds_read_b64 v[110:111], v110
    buffer_store_dwordx4 v[56:59], v71, s[12:15], s17 offen offset:2048 sc1
    s_waitcnt lgkmcnt(8)
    v_add3_u32 v20, v20, v88, v90
    v_add3_u32 v21, v21, v89, v91
    v_add3_u32 v20, v20, v92, v94
    v_add3_u32 v21, v21, v93, v95
    v_lshlrev_b32_sdwa v88, 3, v42 dst_sel:DWORD dst_unused:UNUSED_PAD src0_sel:DWORD src1_sel:WORD_0
    v_lshlrev_b32_sdwa v90, 3, v42 dst_sel:DWORD dst_unused:UNUSED_PAD src0_sel:DWORD src1_sel:WORD_1
    ds_read_b64 v[88:89], v88
    ds_read_b64 v[90:91], v90
    v_lshlrev_b32_sdwa v92, 3, v43 dst_sel:DWORD dst_unused:UNUSED_PAD src0_sel:DWORD src1_sel:WORD_0
    v_lshlrev_b32_sdwa v94, 3, v43 dst_sel:DWORD dst_unused:UNUSED_PAD src0_sel:DWORD src1_sel:WORD_1
    ds_read_b64 v[92:93], v92
    ds_read_b64 v[94:95], v94
    s_add_u32 s20, s20, 0x1000
    buffer_load_dwordx4 v[40:43], v71, s[12:15], s20 offen offset:0 sc1
    s_waitcnt lgkmcnt(8)
    v_add3_u32 v20, v20, v96, v98
    v_add3_u32 v21, v21, v97, v99
    v_add3_u32 v20, v20, v100, v102
    v_add3_u32 v21, v21, v101, v103
    s_waitcnt vmcnt(9)
    v_lshlrev_b32_sdwa v96, 3, v124 dst_sel:DWORD dst_unused:UNUSED_PAD src0_sel:DWORD src1_sel:WORD_0
    v_lshlrev_b32_sdwa v98, 3, v124 dst_sel:DWORD dst_unused:UNUSED_PAD src0_sel:DWORD src1_sel:WORD_1
    ds_read_b64 v[96:97], v96
    ds_read_b64 v[98:99], v98
    v_lshlrev_b32_sdwa v100, 3, v125 dst_sel:DWORD dst_unused:UNUSED_PAD src0_sel:DWORD src1_sel:WORD_0
    v_lshlrev_b32_sdwa v102, 3, v125 dst_sel:DWORD dst_unused:UNUSED_PAD src0_sel:DWORD src1_sel:WORD_1
    ds_read_b64 v[100:101], v100
    ds_read_b64 v[102:103], v102
    s_waitcnt lgkmcnt(8)
    v_add3_u32 v22, v22, v104, v106
    v_add3_u32 v23, v23, v105, v107
    v_add3_u32 v22, v22, v108, v110
    v_add3_u32 v23, v23, v109, v111
    s_setprio 1
    v_lshlrev_b32_sdwa v104, 3, v126 dst_sel:DWORD dst_unused:UNUSED_PAD src0_sel:DWORD src1_sel:WORD_0
    v_lshlrev_b32_sdwa v106, 3, v126 dst_sel:DWORD dst_unused:UNUSED_PAD src0_sel:DWORD src1_sel:WORD_1
    ds_read_b64 v[104:105], v104
    ds_read_b64 v[106:107], v106
    v_lshlrev_b32_sdwa v108, 3, v127 dst_sel:DWORD dst_unused:UNUSED_PAD src0_sel:DWORD src1_sel:WORD_0
    v_lshlrev_b32_sdwa v110, 3, v127 dst_sel:DWORD dst_unused:UNUSED_PAD src0_sel:DWORD src1_sel:WORD_1
    ds_read_b64 v[108:109], v108
    ds_read_b64 v[110:111], v110
    buffer_load_dwordx4 v[124:127], v71, s[12:15], s20 offen offset:2048 sc1
    s_waitcnt lgkmcnt(8)
    v_add3_u32 v22, v22, v88, v90
    v_add3_u32 v23, v23, v89, v91
    v_add3_u32 v22, v22, v92, v94
    v_add3_u32 v23, v23, v93, v95
    s_waitcnt vmcnt(9)
    v_lshlrev_b32_sdwa v88, 3, v116 dst_sel:DWORD dst_unused:UNUSED_PAD src0_sel:DWORD src1_sel:WORD_0
    v_lshlrev_b32_sdwa v90, 3, v116 dst_sel:DWORD dst_unused:UNUSED_PAD src0_sel:DWORD src1_sel:WORD_1
    ds_read_b64 v[88:89], v88
    ds_read_b64 v[90:91], v90
    v_lshlrev_b32_sdwa v92, 3, v117 dst_sel:DWORD dst_unused:UNUSED_PAD src0_sel:DWORD src1_sel:WORD_0
    v_lshlrev_b32_sdwa v94, 3, v117 dst_sel:DWORD dst_unused:UNUSED_PAD src0_sel:DWORD src1_sel:WORD_1
    ds_read_b64 v[92:93], v92
    ds_read_b64 v[94:95], v94
    s_waitcnt lgkmcnt(8)
    v_add3_u32 v24, v24, v96, v98
    v_add3_u32 v25, v25, v97, v99
    v_add3_u32 v24, v24, v100, v102
    v_add3_u32 v25, v25, v101, v103
    v_lshlrev_b32_sdwa v96, 3, v118 dst_sel:DWORD dst_unused:UNUSED_PAD src0_sel:DWORD src1_sel:WORD_0
    v_lshlrev_b32_sdwa v98, 3, v118 dst_sel:DWORD dst_unused:UNUSED_PAD src0_sel:DWORD src1_sel:WORD_1
    ds_read_b64 v[96:97], v96
    ds_read_b64 v[98:99], v98
    v_lshlrev_b32_sdwa v100, 3, v119 dst_sel:DWORD dst_unused:UNUSED_PAD src0_sel:DWORD src1_sel:WORD_0
    v_lshlrev_b32_sdwa v102, 3, v119 dst_sel:DWORD dst_unused:UNUSED_PAD src0_sel:DWORD src1_sel:WORD_1
    ds_read_b64 v[100:101], v100
    ds_read_b64 v[102:103], v102
    s_add_u32 s20, s20, 0x1000
    buffer_load_dwordx4 v[116:119], v71, s[12:15], s20 offen offset:0 sc1
    s_waitcnt lgkmcnt(8)
    v_add3_u32 v24, v24, v104, v106
    v_add3_u32 v25, v25, v105, v107
    v_add3_u32 v24, v24, v108, v110
    v_add3_u32 v25, v25, v109, v111
    s_waitcnt vmcnt(7)
    v_lshlrev_b32_sdwa v104, 3, v44 dst_sel:DWORD dst_unused:UNUSED_PAD src0_sel:DWORD src1_sel:WORD_0
    v_lshlrev_b32_sdwa v106, 3, v44 dst_sel:DWORD dst_unused:UNUSED_PAD src0_sel:DWORD src1_sel:WORD_1
    ds_read_b64 v[104:105], v104
    ds_read_b64 v[106:107], v106
    v_lshlrev_b32_sdwa v108, 3, v45 dst_sel:DWORD dst_unused:UNUSED_PAD src0_sel:DWORD src1_sel:WORD_0
    v_lshlrev_b32_sdwa v110, 3, v45 dst_sel:DWORD dst_unused:UNUSED_PAD src0_sel:DWORD src1_sel:WORD_1
    ds_read_b64 v[108:109], v108
    ds_read_b64 v[110:111], v110
    s_mov_b64 exec, 1
    buffer_load_dword v65, off, s[12:15], s47 sc1
    s_mov_b64 exec, -1
    s_waitcnt lgkmcnt(8)
    v_add3_u32 v26, v26, v88, v90
    v_add3_u32 v27, v27, v89, v91
    v_add3_u32 v26, v26, v92, v94
    v_add3_u32 v27, v27, v93, v95
    v_lshlrev_b32_sdwa v88, 3, v46 dst_sel:DWORD dst_unused:UNUSED_PAD src0_sel:DWORD src1_sel:WORD_0
    v_lshlrev_b32_sdwa v90, 3, v46 dst_sel:DWORD dst_unused:UNUSED_PAD src0_sel:DWORD src1_sel:WORD_1
    ds_read_b64 v[88:89], v88
    ds_read_b64 v[90:91], v90
    v_lshlrev_b32_sdwa v92, 3, v47 dst_sel:DWORD dst_unused:UNUSED_PAD src0_sel:DWORD src1_sel:WORD_0
    v_lshlrev_b32_sdwa v94, 3, v47 dst_sel:DWORD dst_unused:UNUSED_PAD src0_sel:DWORD src1_sel:WORD_1
    ds_read_b64 v[92:93], v92
    ds_read_b64 v[94:95], v94
    buffer_load_dwordx4 v[44:47], v71, s[12:15], s20 offen offset:2048 sc1
    s_waitcnt lgkmcnt(8)
    v_add3_u32 v26, v26, v96, v98
    v_add3_u32 v27, v27, v97, v99
    v_add3_u32 v26, v26, v100, v102
    v_add3_u32 v27, v27, v101, v103
    s_waitcnt vmcnt(8)
    v_lshlrev_b32_sdwa v96, 3, v36 dst_sel:DWORD dst_unused:UNUSED_PAD src0_sel:DWORD src1_sel:WORD_0
    v_lshlrev_b32_sdwa v98, 3, v36 dst_sel:DWORD dst_unused:UNUSED_PAD src0_sel:DWORD src1_sel:WORD_1
    ds_read_b64 v[96:97], v96
    ds_read_b64 v[98:99], v98
    v_lshlrev_b32_sdwa v100, 3, v37 dst_sel:DWORD dst_unused:UNUSED_PAD src0_sel:DWORD src1_sel:WORD_0
    v_lshlrev_b32_sdwa v102, 3, v37 dst_sel:DWORD dst_unused:UNUSED_PAD src0_sel:DWORD src1_sel:WORD_1
    ds_read_b64 v[100:101], v100
    ds_read_b64 v[102:103], v102
    buffer_store_dwordx4 v[60:63], v71, s[12:15], s17 offen offset:3072 sc1
    s_cmp_eq_u32 s48, 1
    s_cbranch_scc1 k1_kernel_solo2
    s_waitcnt lgkmcnt(8)
    v_add3_u32 v28, v28, v104, v106
    v_add3_u32 v29, v29, v105, v107
    v_add3_u32 v28, v28, v108, v110
    v_add3_u32 v29, v29, v109, v111
    s_setprio 0
    v_lshlrev_b32_sdwa v104, 3, v38 dst_sel:DWORD dst_unused:UNUSED_PAD src0_sel:DWORD src1_sel:WORD_0
    v_lshlrev_b32_sdwa v106, 3, v38 dst_sel:DWORD dst_unused:UNUSED_PAD src0_sel:DWORD src1_sel:WORD_1
    ds_read_b64 v[104:105], v104
    ds_read_b64 v[106:107], v106
    v_lshlrev_b32_sdwa v108, 3, v39 dst_sel:DWORD dst_unused:UNUSED_PAD src0_sel:DWORD src1_sel:WORD_0
    v_lshlrev_b32_sdwa v110, 3, v39 dst_sel:DWORD dst_unused:UNUSED_PAD src0_sel:DWORD src1_sel:WORD_1
    ds_read_b64 v[108:109], v108
    ds_read_b64 v[110:111], v110
    s_add_u32 s20, s20, 0x1000
    buffer_load_dwordx4 v[36:39], v71, s[12:15], s20 offen offset:0 sc1
    s_waitcnt lgkmcnt(8)
    v_add3_u32 v28, v28, v88, v90
    v_add3_u32 v29, v29, v89, v91
    v_add3_u32 v28, v28, v92, v94
    v_add3_u32 v29, v29, v93, v95
    v_mfma_f32_16x16x32_bf16 v[112:115], v[72:75], v[128:131], v[66:69]
    s_waitcnt vmcnt(9)
    v_lshlrev_b32_sdwa v88, 3, v120 dst_sel:DWORD dst_unused:UNUSED_PAD src0_sel:DWORD src1_sel:WORD_0
    v_lshlrev_b32_sdwa v90, 3, v120 dst_sel:DWORD dst_unused:UNUSED_PAD src0_sel:DWORD src1_sel:WORD_1
    ds_read_b64 v[88:89], v88
    ds_read_b64 v[90:91], v90
    v_mfma_f32_16x16x32_bf16 v[112:115], v[76:79], v[132:135], v[112:115]
    v_add_u32 v70, 0x10000, v70
    v_lshlrev_b32_sdwa v92, 3, v121 dst_sel:DWORD dst_unused:UNUSED_PAD src0_sel:DWORD src1_sel:WORD_0
    v_lshlrev_b32_sdwa v94, 3, v121 dst_sel:DWORD dst_unused:UNUSED_PAD src0_sel:DWORD src1_sel:WORD_1
    ds_read_b64 v[92:93], v92
    ds_read_b64 v[94:95], v94
    s_waitcnt lgkmcnt(8)
    v_add3_u32 v30, v30, v96, v98
    v_add3_u32 v31, v31, v97, v99
    v_add3_u32 v30, v30, v100, v102
    v_add3_u32 v31, v31, v101, v103
    s_waitcnt lgkmcnt(4)
    s_barrier
    s_setprio 3
    v_mfma_f32_16x16x32_bf16 v[112:115], v[80:83], v[136:139], v[112:115]
    v_lshlrev_b32_sdwa v96, 3, v122 dst_sel:DWORD dst_unused:UNUSED_PAD src0_sel:DWORD src1_sel:WORD_0
    v_lshlrev_b32_sdwa v98, 3, v122 dst_sel:DWORD dst_unused:UNUSED_PAD src0_sel:DWORD src1_sel:WORD_1
    ds_read_b64 v[96:97], v96
    ds_read_b64 v[98:99], v98
    v_mfma_f32_16x16x32_bf16 v[112:115], v[84:87], v[140:143], v[112:115]
    v_lshlrev_b32_sdwa v100, 3, v123 dst_sel:DWORD dst_unused:UNUSED_PAD src0_sel:DWORD src1_sel:WORD_0
    v_lshlrev_b32_sdwa v102, 3, v123 dst_sel:DWORD dst_unused:UNUSED_PAD src0_sel:DWORD src1_sel:WORD_1
    ds_read_b64 v[100:101], v100
    ds_read_b64 v[102:103], v102
    buffer_load_dwordx4 v[120:123], v71, s[12:15], s20 offen offset:2048 sc1
    v_add3_u32 v30, v30, v104, v106
    v_add3_u32 v31, v31, v105, v107
    v_add3_u32 v30, v30, v108, v110
    v_add3_u32 v31, v31, v109, v111
    v_perm_b32 v112, v113, v112, s23
    v_perm_b32 v113, v115, v114, s23
    ds_write_b64 v70, v[112:113] offset:0
    v_mfma_f32_16x16x32_bf16 v[112:115], v[72:75], v[144:147], v[66:69]
    s_waitcnt vmcnt(9)
    v_lshlrev_b32_sdwa v104, 3, v32 dst_sel:DWORD dst_unused:UNUSED_PAD src0_sel:DWORD src1_sel:WORD_0
    v_lshlrev_b32_sdwa v106, 3, v32 dst_sel:DWORD dst_unused:UNUSED_PAD src0_sel:DWORD src1_sel:WORD_1
    ds_read_b64 v[104:105], v104
    ds_read_b64 v[106:107], v106
    v_mfma_f32_16x16x32_bf16 v[112:115], v[76:79], v[148:151], v[112:115]
    v_lshlrev_b32_sdwa v108, 3, v33 dst_sel:DWORD dst_unused:UNUSED_PAD src0_sel:DWORD src1_sel:WORD_0
    v_lshlrev_b32_sdwa v110, 3, v33 dst_sel:DWORD dst_unused:UNUSED_PAD src0_sel:DWORD src1_sel:WORD_1
    ds_read_b64 v[108:109], v108
    ds_read_b64 v[110:111], v110
    s_waitcnt lgkmcnt(9)
    v_add3_u32 v0, v0, v88, v90
    v_add3_u32 v1, v1, v89, v91
    v_add3_u32 v0, v0, v92, v94
    v_add3_u32 v1, v1, v93, v95
    v_mfma_f32_16x16x32_bf16 v[112:115], v[80:83], v[152:155], v[112:115]
    v_lshlrev_b32_sdwa v88, 3, v34 dst_sel:DWORD dst_unused:UNUSED_PAD src0_sel:DWORD src1_sel:WORD_0
    v_lshlrev_b32_sdwa v90, 3, v34 dst_sel:DWORD dst_unused:UNUSED_PAD src0_sel:DWORD src1_sel:WORD_1
    ds_read_b64 v[88:89], v88
    ds_read_b64 v[90:91], v90
    v_mfma_f32_16x16x32_bf16 v[112:115], v[84:87], v[156:159], v[112:115]
    v_lshlrev_b32_sdwa v92, 3, v35 dst_sel:DWORD dst_unused:UNUSED_PAD src0_sel:DWORD src1_sel:WORD_0
    v_lshlrev_b32_sdwa v94, 3, v35 dst_sel:DWORD dst_unused:UNUSED_PAD src0_sel:DWORD src1_sel:WORD_1
    ds_read_b64 v[92:93], v92
    ds_read_b64 v[94:95], v94
    s_add_u32 s20, s20, 0x3d000
    buffer_load_dwordx4 v[32:35], v71, s[12:15], s20 offen offset:0 sc1
    s_waitcnt lgkmcnt(9)
    v_add3_u32 v0, v0, v96, v98
    v_add3_u32 v1, v1, v97, v99
    v_add3_u32 v0, v0, v100, v102
    v_add3_u32 v1, v1, v101, v103
    v_perm_b32 v112, v113, v112, s23
    v_perm_b32 v113, v115, v114, s23
    ds_write_b64 v70, v[112:113] offset:128
    v_mfma_f32_16x16x32_bf16 v[112:115], v[72:75], v[160:163], v[66:69]
    s_waitcnt vmcnt(8)
    v_lshlrev_b32_sdwa v96, 3, v40 dst_sel:DWORD dst_unused:UNUSED_PAD src0_sel:DWORD src1_sel:WORD_0
    v_lshlrev_b32_sdwa v98, 3, v40 dst_sel:DWORD dst_unused:UNUSED_PAD src0_sel:DWORD src1_sel:WORD_1
    ds_read_b64 v[96:97], v96
    ds_read_b64 v[98:99], v98
    v_mfma_f32_16x16x32_bf16 v[112:115], v[76:79], v[164:167], v[112:115]
    v_lshlrev_b32_sdwa v100, 3, v41 dst_sel:DWORD dst_unused:UNUSED_PAD src0_sel:DWORD src1_sel:WORD_0
    v_lshlrev_b32_sdwa v102, 3, v41 dst_sel:DWORD dst_unused:UNUSED_PAD src0_sel:DWORD src1_sel:WORD_1
    ds_read_b64 v[100:101], v100
    ds_read_b64 v[102:103], v102
    s_waitcnt vmcnt(5)
    v_readfirstlane_b32 s44, v65
    s_cmp_le_u32 s44, 0
    s_cbranch_scc1 k1_kernel_xw0
k1_kernel_xb0:
    buffer_load_dwordx4 v[128:131], v71, s[12:15], s18 offen offset:0 sc1
    s_waitcnt lgkmcnt(9)
    v_add3_u32 v4, v4, v104, v106
    v_add3_u32 v5, v5, v105, v107
    v_add3_u32 v4, v4, v108, v110
    v_add3_u32 v5, v5, v109, v111
    v_mfma_f32_16x16x32_bf16 v[112:115], v[80:83], v[168:171], v[112:115]
    v_lshlrev_b32_sdwa v104, 3, v42 dst_sel:DWORD dst_unused:UNUSED_PAD src0_sel:DWORD src1_sel:WORD_0
    v_lshlrev_b32_sdwa v106, 3, v42 dst_sel:DWORD dst_unused:UNUSED_PAD src0_sel:DWORD src1_sel:WORD_1
    ds_read_b64 v[104:105], v104
    ds_read_b64 v[106:107], v106
    v_mfma_f32_16x16x32_bf16 v[112:115], v[84:87], v[172:175], v[112:115]
    v_lshlrev_b32_sdwa v108, 3, v43 dst_sel:DWORD dst_unused:UNUSED_PAD src0_sel:DWORD src1_sel:WORD_0
    v_lshlrev_b32_sdwa v110, 3, v43 dst_sel:DWORD dst_unused:UNUSED_PAD src0_sel:DWORD src1_sel:WORD_1
    ds_read_b64 v[108:109], v108
    ds_read_b64 v[110:111], v110
    s_add_u32 s20, s20, 0xfffc0400
    buffer_load_dwordx4 v[40:43], v71, s[12:15], s20 offen offset:0 sc1
    s_waitcnt lgkmcnt(9)
    v_add3_u32 v4, v4, v88, v90
    v_add3_u32 v5, v5, v89, v91
    v_add3_u32 v4, v4, v92, v94
    v_add3_u32 v5, v5, v93, v95
    v_perm_b32 v112, v113, v112, s23
    v_perm_b32 v113, v115, v114, s23
    ds_write_b64 v70, v[112:113] offset:256
    v_mfma_f32_16x16x32_bf16 v[112:115], v[72:75], v[176:179], v[66:69]
    v_lshlrev_b32_sdwa v88, 3, v124 dst_sel:DWORD dst_unused:UNUSED_PAD src0_sel:DWORD src1_sel:WORD_0
    v_lshlrev_b32_sdwa v90, 3, v124 dst_sel:DWORD dst_unused:UNUSED_PAD src0_sel:DWORD src1_sel:WORD_1
    ds_read_b64 v[88:89], v88
    ds_read_b64 v[90:91], v90
    v_mfma_f32_16x16x32_bf16 v[112:115], v[76:79], v[180:183], v[112:115]
    v_lshlrev_b32_sdwa v92, 3, v125 dst_sel:DWORD dst_unused:UNUSED_PAD src0_sel:DWORD src1_sel:WORD_0
    v_lshlrev_b32_sdwa v94, 3, v125 dst_sel:DWORD dst_unused:UNUSED_PAD src0_sel:DWORD src1_sel:WORD_1
    ds_read_b64 v[92:93], v92
    ds_read_b64 v[94:95], v94
    s_waitcnt lgkmcnt(9)
    v_add3_u32 v8, v8, v96, v98
    v_add3_u32 v9, v9, v97, v99
    v_add3_u32 v8, v8, v100, v102
    v_add3_u32 v9, v9, v101, v103
    v_mfma_f32_16x16x32_bf16 v[112:115], v[80:83], v[184:187], v[112:115]
    v_lshlrev_b32_sdwa v96, 3, v126 dst_sel:DWORD dst_unused:UNUSED_PAD src0_sel:DWORD src1_sel:WORD_0
    v_lshlrev_b32_sdwa v98, 3, v126 dst_sel:DWORD dst_unused:UNUSED_PAD src0_sel:DWORD src1_sel:WORD_1
    ds_read_b64 v[96:97], v96
    ds_read_b64 v[98:99], v98
    v_mfma_f32_16x16x32_bf16 v[112:115], v[84:87], v[188:191], v[112:115]
    v_lshlrev_b32_sdwa v100, 3, v127 dst_sel:DWORD dst_unused:UNUSED_PAD src0_sel:DWORD src1_sel:WORD_0
    v_lshlrev_b32_sdwa v102, 3, v127 dst_sel:DWORD dst_unused:UNUSED_PAD src0_sel:DWORD src1_sel:WORD_1
    ds_read_b64 v[100:101], v100
    ds_read_b64 v[102:103], v102
    s_add_u32 s20, s20, 0x40000
    buffer_load_dwordx4 v[124:127], v71, s[12:15], s20 offen offset:0 sc1
    s_waitcnt lgkmcnt(9)
    v_add3_u32 v8, v8, v104, v106
    v_add3_u32 v9, v9, v105, v107
    v_add3_u32 v8, v8, v108, v110
    v_add3_u32 v9, v9, v109, v111
    v_perm_b32 v112, v113, v112, s23
    v_perm_b32 v113, v115, v114, s23
    ds_write_b64 v70, v[112:113] offset:384
    s_setprio 1
    v_mfma_f32_16x16x32_bf16 v[112:115], v[72:75], v[192:195], v[66:69]
    v_lshlrev_b32_sdwa v104, 3, v116 dst_sel:DWORD dst_unused:UNUSED_PAD src0_sel:DWORD src1_sel:WORD_0
    v_lshlrev_b32_sdwa v106, 3, v116 dst_sel:DWORD dst_unused:UNUSED_PAD src0_sel:DWORD src1_sel:WORD_1
    ds_read_b64 v[104:105], v104
    ds_read_b64 v[106:107], v106
    v_mfma_f32_16x16x32_bf16 v[112:115], v[76:79], v[196:199], v[112:115]
    v_lshlrev_b32_sdwa v108, 3, v117 dst_sel:DWORD dst_unused:UNUSED_PAD src0_sel:DWORD src1_sel:WORD_0
    v_lshlrev_b32_sdwa v110, 3, v117 dst_sel:DWORD dst_unused:UNUSED_PAD src0_sel:DWORD src1_sel:WORD_1
    ds_read_b64 v[108:109], v108
    ds_read_b64 v[110:111], v110
    s_waitcnt lgkmcnt(9)
    v_add3_u32 v12, v12, v88, v90
    v_add3_u32 v13, v13, v89, v91
    v_add3_u32 v12, v12, v92, v94
    v_add3_u32 v13, v13, v93, v95
    v_mfma_f32_16x16x32_bf16 v[112:115], v[80:83], v[200:203], v[112:115]
    v_lshlrev_b32_sdwa v88, 3, v118 dst_sel:DWORD dst_unused:UNUSED_PAD src0_sel:DWORD src1_sel:WORD_0
    v_lshlrev_b32_sdwa v90, 3, v118 dst_sel:DWORD dst_unused:UNUSED_PAD src0_sel:DWORD src1_sel:WORD_1
    ds_read_b64 v[88:89], v88
    ds_read_b64 v[90:91], v90
    v_mfma_f32_16x16x32_bf16 v[112:115], v[84:87], v[204:207], v[112:115]
    v_lshlrev_b32_sdwa v92, 3, v119 dst_sel:DWORD dst_unused:UNUSED_PAD src0_sel:DWORD src1_sel:WORD_0
    v_lshlrev_b32_sdwa v94, 3, v119 dst_sel:DWORD dst_unused:UNUSED_PAD src0_sel:DWORD src1_sel:WORD_1
    ds_read_b64 v[92:93], v92
    ds_read_b64 v[94:95], v94
    buffer_load_dwordx4 v[116:119], v71, s[12:15], s20 offen offset:1024 sc1
    s_waitcnt lgkmcnt(9)
    v_add3_u32 v12, v12, v96, v98
    v_add3_u32 v13, v13, v97, v99
    v_add3_u32 v12, v12, v100, v102
    v_add3_u32 v13, v13, v101, v103
    v_perm_b32 v112, v113, v112, s23
    v_perm_b32 v113, v115, v114, s23
    ds_write_b64 v70, v[112:113] offset:512
    v_mfma_f32_16x16x32_bf16 v[112:115], v[72:75], v[208:211], v[66:69]
    s_waitcnt vmcnt(8)
    v_lshlrev_b32_sdwa v96, 3, v44 dst_sel:DWORD dst_unused:UNUSED_PAD src0_sel:DWORD src1_sel:WORD_0
    v_lshlrev_b32_sdwa v98, 3, v44 dst_sel:DWORD dst_unused:UNUSED_PAD src0_sel:DWORD src1_sel:WORD_1
    ds_read_b64 v[96:97], v96
    ds_read_b64 v[98:99], v98
    v_mfma_f32_16x16x32_bf16 v[112:115], v[76:79], v[212:215], v[112:115]
    v_lshlrev_b32_sdwa v100, 3, v45 dst_sel:DWORD dst_unused:UNUSED_PAD src0_sel:DWORD src1_sel:WORD_0
    v_lshlrev_b32_sdwa v102, 3, v45 dst_sel:DWORD dst_unused:UNUSED_PAD src0_sel:DWORD src1_sel:WORD_1
    ds_read_b64 v[100:101], v100
    ds_read_b64 v[102:103], v102
    buffer_load_dwordx4 v[132:135], v71, s[12:15], s18 offen offset:1024 sc1
    s_waitcnt lgkmcnt(9)
    v_add3_u32 v16, v16, v104, v106
    v_add3_u32 v17, v17, v105, v107
    v_add3_u32 v16, v16, v108, v110
    v_add3_u32 v17, v17, v109, v111
    v_mfma_f32_16x16x32_bf16 v[112:115], v[80:83], v[216:219], v[112:115]
    v_lshlrev_b32_sdwa v104, 3, v46 dst_sel:DWORD dst_unused:UNUSED_PAD src0_sel:DWORD src1_sel:WORD_0
    v_lshlrev_b32_sdwa v106, 3, v46 dst_sel:DWORD dst_unused:UNUSED_PAD src0_sel:DWORD src1_sel:WORD_1
    ds_read_b64 v[104:105], v104
    ds_read_b64 v[106:107], v106
    v_mfma_f32_16x16x32_bf16 v[112:115], v[84:87], v[220:223], v[112:115]
    v_lshlrev_b32_sdwa v108, 3, v47 dst_sel:DWORD dst_unused:UNUSED_PAD src0_sel:DWORD src1_sel:WORD_0
    v_lshlrev_b32_sdwa v110, 3, v47 dst_sel:DWORD dst_unused:UNUSED_PAD src0_sel:DWORD src1_sel:WORD_1
    ds_read_b64 v[108:109], v108
    ds_read_b64 v[110:111], v110
    s_add_u32 s20, s20, 0xfffc0800
    buffer_load_dwordx4 v[44:47], v71, s[12:15], s20 offen offset:0 sc1
    s_waitcnt lgkmcnt(9)
    v_add3_u32 v16, v16, v88, v90
    v_add3_u32 v17, v17, v89, v91
    v_add3_u32 v16, v16, v92, v94
    v_add3_u32 v17, v17, v93, v95
    v_perm_b32 v112, v113, v112, s23
    v_perm_b32 v113, v115, v114, s23
    ds_write_b64 v70, v[112:113] offset:640
    v_mfma_f32_16x16x32_bf16 v[112:115], v[72:75], v[224:227], v[66:69]
    s_waitcnt vmcnt(8)
    v_lshlrev_b32_sdwa v88, 3, v36 dst_sel:DWORD dst_unused:UNUSED_PAD src0_sel:DWORD src1_sel:WORD_0
    v_lshlrev_b32_sdwa v90, 3, v36 dst_sel:DWORD dst_unused:UNUSED_PAD src0_sel:DWORD src1_sel:WORD_1
    ds_read_b64 v[88:89], v88
    ds_read_b64 v[90:91], v90
    v_mfma_f32_16x16x32_bf16 v[112:115], v[76:79], v[228:231], v[112:115]
    v_lshlrev_b32_sdwa v92, 3, v37 dst_sel:DWORD dst_unused:UNUSED_PAD src0_sel:DWORD src1_sel:WORD_0
    v_lshlrev_b32_sdwa v94, 3, v37 dst_sel:DWORD dst_unused:UNUSED_PAD src0_sel:DWORD src1_sel:WORD_1
    ds_read_b64 v[92:93], v92
    ds_read_b64 v[94:95], v94
    v_mov_b32 v64, 2
    s_mov_b64 exec, 1
    buffer_store_dword v64, off, s[12:15], s46 sc1
    s_mov_b64 exec, -1
    s_waitcnt lgkmcnt(9)
    v_add3_u32 v20, v20, v96, v98
    v_add3_u32 v21, v21, v97, v99
    v_add3_u32 v20, v20, v100, v102
    v_add3_u32 v21, v21, v101, v103
    v_mfma_f32_16x16x32_bf16 v[112:115], v[80:83], v[232:235], v[112:115]
    v_lshlrev_b32_sdwa v96, 3, v38 dst_sel:DWORD dst_unused:UNUSED_PAD src0_sel:DWORD src1_sel:WORD_0
    v_lshlrev_b32_sdwa v98, 3, v38 dst_sel:DWORD dst_unused:UNUSED_PAD src0_sel:DWORD src1_sel:WORD_1
    ds_read_b64 v[96:97], v96
    ds_read_b64 v[98:99], v98
    v_mfma_f32_16x16x32_bf16 v[112:115], v[84:87], v[236:239], v[112:115]
    v_lshlrev_b32_sdwa v100, 3, v39 dst_sel:DWORD dst_unused:UNUSED_PAD src0_sel:DWORD src1_sel:WORD_0
    v_lshlrev_b32_sdwa v102, 3, v39 dst_sel:DWORD dst_unused:UNUSED_PAD src0_sel:DWORD src1_sel:WORD_1
    ds_read_b64 v[100:101], v100
    ds_read_b64 v[102:103], v102
    s_add_u32 s20, s20, 0x40000
    buffer_load_dwordx4 v[36:39], v71, s[12:15], s20 offen offset:0 sc1
    s_waitcnt lgkmcnt(9)
    v_add3_u32 v20, v20, v104, v106
    v_add3_u32 v21, v21, v105, v107
    v_add3_u32 v20, v20, v108, v110
    v_add3_u32 v21, v21, v109, v111
    v_perm_b32 v112, v113, v112, s23
    v_perm_b32 v113, v115, v114, s23
    ds_write_b64 v70, v[112:113] offset:768
    s_setprio 0
    v_mfma_f32_16x16x32_bf16 v[112:115], v[72:75], v[240:243], v[66:69]
    s_waitcnt vmcnt(9)
    v_lshlrev_b32_sdwa v104, 3, v120 dst_sel:DWORD dst_unused:UNUSED_PAD src0_sel:DWORD src1_sel:WORD_0
    v_lshlrev_b32_sdwa v106, 3, v120 dst_sel:DWORD dst_unused:UNUSED_PAD src0_sel:DWORD src1_sel:WORD_1
    ds_read_b64 v[104:105], v104
    ds_read_b64 v[106:107], v106
    v_mfma_f32_16x16x32_bf16 v[112:115], v[76:79], v[244:247], v[112:115]
    v_lshlrev_b32_sdwa v108, 3, v121 dst_sel:DWORD dst_unused:UNUSED_PAD src0_sel:DWORD src1_sel:WORD_0
    v_lshlrev_b32_sdwa v110, 3, v121 dst_sel:DWORD dst_unused:UNUSED_PAD src0_sel:DWORD src1_sel:WORD_1
    ds_read_b64 v[108:109], v108
    ds_read_b64 v[110:111], v110
    s_waitcnt lgkmcnt(9)
    v_add3_u32 v24, v24, v88, v90
    v_add3_u32 v25, v25, v89, v91
    v_add3_u32 v24, v24, v92, v94
    v_add3_u32 v25, v25, v93, v95
    v_mfma_f32_16x16x32_bf16 v[112:115], v[80:83], v[248:251], v[112:115]
    v_lshlrev_b32_sdwa v88, 3, v122 dst_sel:DWORD dst_unused:UNUSED_PAD src0_sel:DWORD src1_sel:WORD_0
    v_lshlrev_b32_sdwa v90, 3, v122 dst_sel:DWORD dst_unused:UNUSED_PAD src0_sel:DWORD src1_sel:WORD_1
    ds_read_b64 v[88:89], v88
    ds_read_b64 v[90:91], v90
    v_mfma_f32_16x16x32_bf16 v[112:115], v[84:87], v[252:255], v[112:115]
    v_lshlrev_b32_sdwa v92, 3, v123 dst_sel:DWORD dst_unused:UNUSED_PAD src0_sel:DWORD src1_sel:WORD_0
    v_lshlrev_b32_sdwa v94, 3, v123 dst_sel:DWORD dst_unused:UNUSED_PAD src0_sel:DWORD src1_sel:WORD_1
    ds_read_b64 v[92:93], v92
    ds_read_b64 v[94:95], v94
    buffer_load_dwordx4 v[120:123], v71, s[12:15], s20 offen offset:1024 sc1
    s_waitcnt lgkmcnt(9)
    v_add3_u32 v24, v24, v96, v98
    v_add3_u32 v25, v25, v97, v99
    v_add3_u32 v24, v24, v100, v102
    v_add3_u32 v25, v25, v101, v103
    v_perm_b32 v112, v113, v112, s23
    v_perm_b32 v113, v115, v114, s23
    ds_write_b64 v70, v[112:113] offset:896
    s_waitcnt lgkmcnt(0)
    s_barrier
    s_setprio 3
    v_mov_b32 v212, 0xbdd2d3e8
    v_mov_b32 v213, 0xbdd2d3e8
    v_mov_b32 v214, 0xc0135761
    v_mov_b32 v215, 0xc0135761
    v_mov_b32 v222, s26
    v_mov_b32 v223, s26
    s_waitcnt vmcnt(9)
    v_lshlrev_b32_sdwa v96, 3, v32 dst_sel:DWORD dst_unused:UNUSED_PAD src0_sel:DWORD src1_sel:WORD_0
    v_lshlrev_b32_sdwa v98, 3, v32 dst_sel:DWORD dst_unused:UNUSED_PAD src0_sel:DWORD src1_sel:WORD_1
    ds_read_b64 v[96:97], v96
    ds_read_b64 v[98:99], v98
    v_mov_b32 v216, 0xcb010000
    v_lshlrev_b32 v66, 16, s36
    v_mov_b32_sdwa v67, s36 dst_sel:WORD_1 dst_unused:UNUSED_PAD src0_sel:WORD_1
    v_lshlrev_b32 v68, 16, s37
    v_mov_b32_sdwa v69, s37 dst_sel:WORD_1 dst_unused:UNUSED_PAD src0_sel:WORD_1
    v_lshlrev_b32_sdwa v100, 3, v33 dst_sel:DWORD dst_unused:UNUSED_PAD src0_sel:DWORD src1_sel:WORD_0
    v_lshlrev_b32_sdwa v102, 3, v33 dst_sel:DWORD dst_unused:UNUSED_PAD src0_sel:DWORD src1_sel:WORD_1
    ds_read_b64 v[100:101], v100
    ds_read_b64 v[102:103], v102
    buffer_load_dwordx4 v[136:139], v71, s[12:15], s18 offen offset:2048 sc1
    s_add_u32 s20, s20, 0xfffc0800
    buffer_load_dwordx4 v[160:163], v71, s[12:15], s20 offen offset:0 sc1
    v_add3_u32 v28, v28, v104, v106
    v_add3_u32 v29, v29, v105, v107
    v_add3_u32 v28, v28, v108, v110
    v_add3_u32 v29, v29, v109, v111
    v_fmac_f32 v66, v216, v222
    v_fmac_f32 v67, v216, v222
    v_fmac_f32 v68, v216, v222
    v_fmac_f32 v69, v216, v222
    v_mov_b32 v218, s28
    v_mov_b32 v219, s29
    v_lshlrev_b32_sdwa v104, 3, v34 dst_sel:DWORD dst_unused:UNUSED_PAD src0_sel:DWORD src1_sel:WORD_0
    v_lshlrev_b32_sdwa v106, 3, v34 dst_sel:DWORD dst_unused:UNUSED_PAD src0_sel:DWORD src1_sel:WORD_1
    ds_read_b64 v[104:105], v104
    ds_read_b64 v[106:107], v106
    v_mov_b32 v220, s30
    v_mov_b32 v221, s31
    v_rcp_f32 v218, v218
    v_rcp_f32 v219, v219
    v_rcp_f32 v220, v220
    v_lshlrev_b32_sdwa v108, 3, v35 dst_sel:DWORD dst_unused:UNUSED_PAD src0_sel:DWORD src1_sel:WORD_0
    v_lshlrev_b32_sdwa v110, 3, v35 dst_sel:DWORD dst_unused:UNUSED_PAD src0_sel:DWORD src1_sel:WORD_1
    ds_read_b64 v[108:109], v108
    ds_read_b64 v[110:111], v110
    v_add3_u32 v28, v28, v88, v90
    v_add3_u32 v29, v29, v89, v91
    v_add3_u32 v28, v28, v92, v94
    v_add3_u32 v29, v29, v93, v95
    v_rcp_f32 v221, v221
    v_mov_b32 v216, 0x7f7fffff
    v_mov_b32 v217, 0xff7fffff
    v_med3_f32 v218, v218, v216, v217
    v_med3_f32 v219, v219, v216, v217
    v_med3_f32 v220, v220, v216, v217
    s_waitcnt vmcnt(9)
    v_lshlrev_b32_sdwa v88, 3, v40 dst_sel:DWORD dst_unused:UNUSED_PAD src0_sel:DWORD src1_sel:WORD_0
    v_lshlrev_b32_sdwa v90, 3, v40 dst_sel:DWORD dst_unused:UNUSED_PAD src0_sel:DWORD src1_sel:WORD_1
    ds_read_b64 v[88:89], v88
    ds_read_b64 v[90:91], v90
    v_med3_f32 v221, v221, v216, v217
    v_mov_b32 v73, 0
    v_lshrrev_b32 v76, 2, v71
    v_mov_b32 v79, 0
    v_and_b32 v75, 0xf0, v71
    v_lshlrev_b32_sdwa v92, 3, v41 dst_sel:DWORD dst_unused:UNUSED_PAD src0_sel:DWORD src1_sel:WORD_0
    v_lshlrev_b32_sdwa v94, 3, v41 dst_sel:DWORD dst_unused:UNUSED_PAD src0_sel:DWORD src1_sel:WORD_1
    ds_read_b64 v[92:93], v92
    ds_read_b64 v[94:95], v94
    s_add_u32 s20, s20, 0x40000
    buffer_load_dwordx4 v[164:167], v71, s[12:15], s20 offen offset:0 sc1
    s_waitcnt lgkmcnt(8)
    v_add3_u32 v0, v0, v96, v98
    v_add3_u32 v1, v1, v97, v99
    v_add3_u32 v0, v0, v100, v102
    v_add3_u32 v1, v1, v101, v103
    v_lshrrev_b32 v80, 8, v71
    v_lshl_add_u32 v74, v80, 16, v75
    v_lshl_add_u32 v75, v80, 2, v75
    v_lshrrev_b32 v77, 9, v71
    v_mul_u32_u24 v77, 8064, v77
    v_add3_u32 v77, v77, v76, s67
    v_lshlrev_b32_sdwa v96, 3, v42 dst_sel:DWORD dst_unused:UNUSED_PAD src0_sel:DWORD src1_sel:WORD_0
    v_lshlrev_b32_sdwa v98, 3, v42 dst_sel:DWORD dst_unused:UNUSED_PAD src0_sel:DWORD src1_sel:WORD_1
    ds_read_b64 v[96:97], v96
    ds_read_b64 v[98:99], v98
    v_lshrrev_b32 v78, 1, v75
    v_lshlrev_b32_sdwa v100, 3, v43 dst_sel:DWORD dst_unused:UNUSED_PAD src0_sel:DWORD src1_sel:WORD_0
    v_lshlrev_b32_sdwa v102, 3, v43 dst_sel:DWORD dst_unused:UNUSED_PAD src0_sel:DWORD src1_sel:WORD_1
    ds_read_b64 v[100:101], v100
    ds_read_b64 v[102:103], v102
    s_waitcnt lgkmcnt(8)
    v_add3_u32 v0, v0, v104, v106
    v_add3_u32 v1, v1, v105, v107
    v_add3_u32 v0, v0, v108, v110
    v_add3_u32 v1, v1, v109, v111
    s_waitcnt vmcnt(9)
    v_lshlrev_b32_sdwa v104, 3, v124 dst_sel:DWORD dst_unused:UNUSED_PAD src0_sel:DWORD src1_sel:WORD_0
    v_lshlrev_b32_sdwa v106, 3, v124 dst_sel:DWORD dst_unused:UNUSED_PAD src0_sel:DWORD src1_sel:WORD_1
    ds_read_b64 v[104:105], v104
    ds_read_b64 v[106:107], v106
    v_mad_u32_u16 v188, v0, 1, s27 op_sel:[0,0,0,0]
    v_mad_u32_u16 v189, v0, 1, s27 op_sel:[1,0,0,0]
    v_mad_u32_u16 v190, v1, 1, s27 op_sel:[0,0,0,0]
    v_mad_u32_u16 v191, v1, 1, s27 op_sel:[1,0,0,0]
    v_mad_u32_u16 v188, v128, 1, v188 op_sel:[0,0,0,0]
    v_lshlrev_b32_sdwa v108, 3, v125 dst_sel:DWORD dst_unused:UNUSED_PAD src0_sel:DWORD src1_sel:WORD_0
    v_lshlrev_b32_sdwa v110, 3, v125 dst_sel:DWORD dst_unused:UNUSED_PAD src0_sel:DWORD src1_sel:WORD_1
    ds_read_b64 v[108:109], v108
    ds_read_b64 v[110:111], v110
    s_mov_b64 exec, 1
    buffer_load_dword v65, off, s[12:15], s47 sc1
    s_mov_b64 exec, -1
    buffer_load_dwordx4 v[168:171], v71, s[12:15], s20 offen offset:1024 sc1
    s_waitcnt lgkmcnt(8)
    v_add3_u32 v2, v2, v88, v90
    v_add3_u32 v3, v3, v89, v91
    v_add3_u32 v2, v2, v92, v94
    v_add3_u32 v3, v3, v93, v95
    v_mad_u32_u16 v189, v128, 1, v189 op_sel:[1,0,0,0]
    v_mad_u32_u16 v190, v129, 1, v190 op_sel:[0,0,0,0]
    v_mad_u32_u16 v191, v129, 1, v191 op_sel:[1,0,0,0]
    v_pk_fma_f32 v[188:189], v[188:189], v[222:223], v[66:67]
    v_pk_fma_f32 v[190:191], v[190:191], v[222:223], v[68:69]
    v_pk_mul_f32 v[224:225], v[188:189], v[188:189]
    v_lshlrev_b32_sdwa v88, 3, v126 dst_sel:DWORD dst_unused:UNUSED_PAD src0_sel:DWORD src1_sel:WORD_0
    v_lshlrev_b32_sdwa v90, 3, v126 dst_sel:DWORD dst_unused:UNUSED_PAD src0_sel:DWORD src1_sel:WORD_1
    ds_read_b64 v[88:89], v88
    ds_read_b64 v[90:91], v90
    v_pk_fma_f32 v[224:225], v[224:225], v[212:213], v[214:215]
    v_pk_mul_f32 v[226:227], v[190:191], v[190:191]
    v_pk_mul_f32 v[224:225], v[224:225], v[188:189]
    v_pk_fma_f32 v[226:227], v[226:227], v[212:213], v[214:215]
    v_exp_f32 v224, v224
    v_lshlrev_b32_sdwa v92, 3, v127 dst_sel:DWORD dst_unused:UNUSED_PAD src0_sel:DWORD src1_sel:WORD_0
    v_lshlrev_b32_sdwa v94, 3, v127 dst_sel:DWORD dst_unused:UNUSED_PAD src0_sel:DWORD src1_sel:WORD_1
    ds_read_b64 v[92:93], v92
    ds_read_b64 v[94:95], v94
    s_waitcnt lgkmcnt(8)
    v_add3_u32 v2, v2, v96, v98
    v_add3_u32 v3, v3, v97, v99
    v_add3_u32 v2, v2, v100, v102
    v_add3_u32 v3, v3, v101, v103
    v_exp_f32 v225, v225
    v_pk_mul_f32 v[226:227], v[226:227], v[190:191]
    s_waitcnt vmcnt(10)
    v_lshlrev_b32_sdwa v96, 3, v116 dst_sel:DWORD dst_unused:UNUSED_PAD src0_sel:DWORD src1_sel:WORD_0
    v_lshlrev_b32_sdwa v98, 3, v116 dst_sel:DWORD dst_unused:UNUSED_PAD src0_sel:DWORD src1_sel:WORD_1
    ds_read_b64 v[96:97], v96
    ds_read_b64 v[98:99], v98
    v_exp_f32 v226, v226
    v_pk_fma_f32 v[224:225], v[224:225], v[218:219], v[218:219]
    v_exp_f32 v227, v227
    v_rcp_f32 v224, v224
    v_rcp_f32 v225, v225
    v_lshlrev_b32_sdwa v100, 3, v117 dst_sel:DWORD dst_unused:UNUSED_PAD src0_sel:DWORD src1_sel:WORD_0
    v_lshlrev_b32_sdwa v102, 3, v117 dst_sel:DWORD dst_unused:UNUSED_PAD src0_sel:DWORD src1_sel:WORD_1
    ds_read_b64 v[100:101], v100
    ds_read_b64 v[102:103], v102
    buffer_load_dwordx4 v[140:143], v71, s[12:15], s18 offen offset:3072 sc1
    s_add_u32 s20, s20, 0xfffc0800
    buffer_load_dwordx4 v[172:175], v71, s[12:15], s20 offen offset:0 sc1
    s_waitcnt lgkmcnt(8)
    v_add3_u32 v2, v2, v104, v106
    v_add3_u32 v3, v3, v105, v107
    v_add3_u32 v2, v2, v108, v110
    v_add3_u32 v3, v3, v109, v111
    v_pk_fma_f32 v[226:227], v[226:227], v[220:221], v[220:221]
    v_pk_mul_f32 v[228:229], v[188:189], v[224:225]
    v_rcp_f32 v226, v226
    v_rcp_f32 v227, v227
    v_lshlrev_b32_sdwa v104, 3, v118 dst_sel:DWORD dst_unused:UNUSED_PAD src0_sel:DWORD src1_sel:WORD_0
    v_lshlrev_b32_sdwa v106, 3, v118 dst_sel:DWORD dst_unused:UNUSED_PAD src0_sel:DWORD src1_sel:WORD_1
    ds_read_b64 v[104:105], v104
    ds_read_b64 v[106:107], v106
    v_pk_fma_f32 v[228:229], v[190:191], v[226:227], v[228:229]
    v_lshlrev_b32_sdwa v108, 3, v119 dst_sel:DWORD dst_unused:UNUSED_PAD src0_sel:DWORD src1_sel:WORD_0
    v_lshlrev_b32_sdwa v110, 3, v119 dst_sel:DWORD dst_unused:UNUSED_PAD src0_sel:DWORD src1_sel:WORD_1
    ds_read_b64 v[108:109], v108
    ds_read_b64 v[110:111], v110
    s_waitcnt lgkmcnt(8)
    v_add3_u32 v2, v2, v88, v90
    v_add3_u32 v3, v3, v89, v91
    v_add3_u32 v2, v2, v92, v94
    v_add3_u32 v3, v3, v93, v95
    v_add_f32 v228, v228, v229
    v_mad_u32_u16 v192, v2, 1, s27 op_sel:[0,0,0,0]
    v_min_u32 v228, -2, v228
    v_mad_u32_u16 v193, v2, 1, s27 op_sel:[1,0,0,0]
    buffer_store_dword v228, v76, s[12:15], s35 offen offset:0 sc1
    v_mad_u32_u16 v194, v3, 1, s27 op_sel:[0,0,0,0]
    s_waitcnt vmcnt(11)
    v_lshlrev_b32_sdwa v88, 3, v44 dst_sel:DWORD dst_unused:UNUSED_PAD src0_sel:DWORD src1_sel:WORD_0
    v_lshlrev_b32_sdwa v90, 3, v44 dst_sel:DWORD dst_unused:UNUSED_PAD src0_sel:DWORD src1_sel:WORD_1
    ds_read_b64 v[88:89], v88
    ds_read_b64 v[90:91], v90
    v_mad_u32_u16 v195, v3, 1, s27 op_sel:[1,0,0,0]
    v_mad_u32_u16 v192, v130, 1, v192 op_sel:[0,0,0,0]
    v_mad_u32_u16 v193, v130, 1, v193 op_sel:[1,0,0,0]
    v_mad_u32_u16 v194, v131, 1, v194 op_sel:[0,0,0,0]
    v_mad_u32_u16 v195, v131, 1, v195 op_sel:[1,0,0,0]
    v_lshlrev_b32_sdwa v92, 3, v45 dst_sel:DWORD dst_unused:UNUSED_PAD src0_sel:DWORD src1_sel:WORD_0
    v_lshlrev_b32_sdwa v94, 3, v45 dst_sel:DWORD dst_unused:UNUSED_PAD src0_sel:DWORD src1_sel:WORD_1
    ds_read_b64 v[92:93], v92
    ds_read_b64 v[94:95], v94
    s_add_u32 s20, s20, 0x40000
    buffer_load_dwordx4 v[32:35], v71, s[12:15], s20 offen offset:0 sc1
    s_waitcnt lgkmcnt(8)
    v_add3_u32 v4, v4, v96, v98
    v_add3_u32 v5, v5, v97, v99
    v_add3_u32 v4, v4, v100, v102
    v_add3_u32 v5, v5, v101, v103
    v_pk_fma_f32 v[192:193], v[192:193], v[222:223], v[66:67]
    v_pk_fma_f32 v[194:195], v[194:195], v[222:223], v[68:69]
    v_pk_mul_f32 v[230:231], v[192:193], v[192:193]
    v_pk_mul_f32 v[232:233], v[194:195], v[194:195]
    v_pk_fma_f32 v[230:231], v[230:231], v[212:213], v[214:215]
    v_pk_fma_f32 v[232:233], v[232:233], v[212:213], v[214:215]
    v_lshlrev_b32_sdwa v96, 3, v46 dst_sel:DWORD dst_unused:UNUSED_PAD src0_sel:DWORD src1_sel:WORD_0
    v_lshlrev_b32_sdwa v98, 3, v46 dst_sel:DWORD dst_unused:UNUSED_PAD src0_sel:DWORD src1_sel:WORD_1
    ds_read_b64 v[96:97], v96
    ds_read_b64 v[98:99], v98
    v_pk_mul_f32 v[230:231], v[230:231], v[192:193]
    v_pk_mul_f32 v[232:233], v[232:233], v[194:195]
    v_exp_f32 v230, v230
    v_exp_f32 v231, v231
    v_exp_f32 v232, v232
    v_lshlrev_b32_sdwa v100, 3, v47 dst_sel:DWORD dst_unused:UNUSED_PAD src0_sel:DWORD src1_sel:WORD_0
    v_lshlrev_b32_sdwa v102, 3, v47 dst_sel:DWORD dst_unused:UNUSED_PAD src0_sel:DWORD src1_sel:WORD_1
    ds_read_b64 v[100:101], v100
    ds_read_b64 v[102:103], v102
    s_waitcnt lgkmcnt(8)
    v_add3_u32 v4, v4, v104, v106
    v_add3_u32 v5, v5, v105, v107
    v_add3_u32 v4, v4, v108, v110
    v_add3_u32 v5, v5, v109, v111
    v_exp_f32 v233, v233
    v_pk_fma_f32 v[230:231], v[230:231], v[218:219], v[218:219]
    v_mad_u32_u16 v196, v4, 1, s27 op_sel:[0,0,0,0]
    v_rcp_f32 v230, v230
    v_pk_fma_f32 v[232:233], v[232:233], v[220:221], v[220:221]
    v_mad_u32_u16 v197, v4, 1, s27 op_sel:[1,0,0,0]
    s_waitcnt vmcnt(10)
    v_lshlrev_b32_sdwa v104, 3, v36 dst_sel:DWORD dst_unused:UNUSED_PAD src0_sel:DWORD src1_sel:WORD_0
    v_lshlrev_b32_sdwa v106, 3, v36 dst_sel:DWORD dst_unused:UNUSED_PAD src0_sel:DWORD src1_sel:WORD_1
    ds_read_b64 v[104:105], v104
    ds_read_b64 v[106:107], v106
    v_rcp_f32 v231, v231
    v_mad_u32_u16 v198, v5, 1, s27 op_sel:[0,0,0,0]
    v_mad_u32_u16 v199, v5, 1, s27 op_sel:[1,0,0,0]
    v_rcp_f32 v232, v232
    v_pk_mul_f32 v[234:235], v[192:193], v[230:231]
    v_lshlrev_b32_sdwa v108, 3, v37 dst_sel:DWORD dst_unused:UNUSED_PAD src0_sel:DWORD src1_sel:WORD_0
    v_lshlrev_b32_sdwa v110, 3, v37 dst_sel:DWORD dst_unused:UNUSED_PAD src0_sel:DWORD src1_sel:WORD_1
    ds_read_b64 v[108:109], v108
    ds_read_b64 v[110:111], v110
    buffer_load_dwordx4 v[40:43], v71, s[12:15], s20 offen offset:1024 sc1
    s_waitcnt lgkmcnt(8)
    v_add3_u32 v6, v6, v88, v90
    v_add3_u32 v7, v7, v89, v91
    v_add3_u32 v6, v6, v92, v94
    v_add3_u32 v7, v7, v93, v95
    v_rcp_f32 v233, v233
    v_mad_u32_u16 v196, v132, 1, v196 op_sel:[0,0,0,0]
    v_mad_u32_u16 v197, v132, 1, v197 op_sel:[1,0,0,0]
    v_pk_fma_f32 v[234:235], v[194:195], v[232:233], v[234:235]
    v_mad_u32_u16 v198, v133, 1, v198 op_sel:[0,0,0,0]
    v_add_f32 v234, v234, v235
    v_lshlrev_b32_sdwa v88, 3, v38 dst_sel:DWORD dst_unused:UNUSED_PAD src0_sel:DWORD src1_sel:WORD_0
    v_lshlrev_b32_sdwa v90, 3, v38 dst_sel:DWORD dst_unused:UNUSED_PAD src0_sel:DWORD src1_sel:WORD_1
    ds_read_b64 v[88:89], v88
    ds_read_b64 v[90:91], v90
    v_min_u32 v234, -2, v234
    v_mad_u32_u16 v199, v133, 1, v199 op_sel:[1,0,0,0]
    buffer_store_dword v234, v76, s[12:15], s35 offen offset:256 sc1
    v_pk_fma_f32 v[196:197], v[196:197], v[222:223], v[66:67]
    v_pk_fma_f32 v[198:199], v[198:199], v[222:223], v[68:69]
    v_lshlrev_b32_sdwa v92, 3, v39 dst_sel:DWORD dst_unused:UNUSED_PAD src0_sel:DWORD src1_sel:WORD_0
    v_lshlrev_b32_sdwa v94, 3, v39 dst_sel:DWORD dst_unused:UNUSED_PAD src0_sel:DWORD src1_sel:WORD_1
    ds_read_b64 v[92:93], v92
    ds_read_b64 v[94:95], v94
    s_waitcnt lgkmcnt(8)
    v_add3_u32 v6, v6, v96, v98
    v_add3_u32 v7, v7, v97, v99
    v_add3_u32 v6, v6, v100, v102
    v_add3_u32 v7, v7, v101, v103
    v_pk_mul_f32 v[236:237], v[196:197], v[196:197]
    v_pk_mul_f32 v[238:239], v[198:199], v[198:199]
    v_pk_fma_f32 v[236:237], v[236:237], v[212:213], v[214:215]
    v_pk_fma_f32 v[238:239], v[238:239], v[212:213], v[214:215]
    v_pk_mul_f32 v[236:237], v[236:237], v[196:197]
    v_pk_mul_f32 v[238:239], v[238:239], v[198:199]
    s_waitcnt vmcnt(11)
    v_lshlrev_b32_sdwa v96, 3, v120 dst_sel:DWORD dst_unused:UNUSED_PAD src0_sel:DWORD src1_sel:WORD_0
    v_lshlrev_b32_sdwa v98, 3, v120 dst_sel:DWORD dst_unused:UNUSED_PAD src0_sel:DWORD src1_sel:WORD_1
    ds_read_b64 v[96:97], v96
    ds_read_b64 v[98:99], v98
    v_exp_f32 v236, v236
    v_exp_f32 v237, v237
    v_exp_f32 v238, v238
    v_exp_f32 v239, v239
    v_pk_fma_f32 v[236:237], v[236:237], v[218:219], v[218:219]
    v_lshlrev_b32_sdwa v100, 3, v121 dst_sel:DWORD dst_unused:UNUSED_PAD src0_sel:DWORD src1_sel:WORD_0
    v_lshlrev_b32_sdwa v102, 3, v121 dst_sel:DWORD dst_unused:UNUSED_PAD src0_sel:DWORD src1_sel:WORD_1
    ds_read_b64 v[100:101], v100
    ds_read_b64 v[102:103], v102
    s_waitcnt vmcnt(7)
    v_readfirstlane_b32 s44, v65
    s_cmp_le_u32 s44, 1
    s_cbranch_scc1 k1_kernel_xw1
k1_kernel_xb1:
    buffer_load_dwordx4 v[144:147], v71, s[12:15], s32 offen offset:0 sc1
    s_add_u32 s20, s20, 0xfffc0800
    buffer_load_dwordx4 v[124:127], v71, s[12:15], s20 offen offset:0 sc1
    s_waitcnt lgkmcnt(8)
    v_add3_u32 v6, v6, v104, v106
    v_add3_u32 v7, v7, v105, v107
    v_add3_u32 v6, v6, v108, v110
    v_add3_u32 v7, v7, v109, v111
    v_rcp_f32 v236, v236
    v_pk_fma_f32 v[238:239], v[238:239], v[220:221], v[220:221]
    v_rcp_f32 v237, v237
    v_rcp_f32 v238, v238
    v_rcp_f32 v239, v239
    v_pk_mul_f32 v[240:241], v[196:197], v[236:237]
    v_lshlrev_b32_sdwa v104, 3, v122 dst_sel:DWORD dst_unused:UNUSED_PAD src0_sel:DWORD src1_sel:WORD_0
    v_lshlrev_b32_sdwa v106, 3, v122 dst_sel:DWORD dst_unused:UNUSED_PAD src0_sel:DWORD src1_sel:WORD_1
    ds_read_b64 v[104:105], v104
    ds_read_b64 v[106:107], v106
    v_pk_fma_f32 v[240:241], v[198:199], v[238:239], v[240:241]
    v_lshlrev_b32_sdwa v108, 3, v123 dst_sel:DWORD dst_unused:UNUSED_PAD src0_sel:DWORD src1_sel:WORD_0
    v_lshlrev_b32_sdwa v110, 3, v123 dst_sel:DWORD dst_unused:UNUSED_PAD src0_sel:DWORD src1_sel:WORD_1
    ds_read_b64 v[108:109], v108
    ds_read_b64 v[110:111], v110
    s_waitcnt lgkmcnt(8)
    v_add3_u32 v6, v6, v88, v90
    v_add3_u32 v7, v7, v89, v91
    v_add3_u32 v6, v6, v92, v94
    v_add3_u32 v7, v7, v93, v95
    v_add_f32 v240, v240, v241
    v_mad_u32_u16 v200, v6, 1, s27 op_sel:[0,0,0,0]
    v_min_u32 v240, -2, v240
    v_mad_u32_u16 v201, v6, 1, s27 op_sel:[1,0,0,0]
    buffer_store_dword v240, v76, s[12:15], s35 offen offset:512 sc1
    v_mad_u32_u16 v202, v7, 1, s27 op_sel:[0,0,0,0]
    v_lshlrev_b32_sdwa v88, 3, v160 dst_sel:DWORD dst_unused:UNUSED_PAD src0_sel:DWORD src1_sel:WORD_0
    v_lshlrev_b32_sdwa v90, 3, v160 dst_sel:DWORD dst_unused:UNUSED_PAD src0_sel:DWORD src1_sel:WORD_1
    ds_read_b64 v[88:89], v88
    ds_read_b64 v[90:91], v90
    v_mad_u32_u16 v203, v7, 1, s27 op_sel:[1,0,0,0]
    v_mad_u32_u16 v200, v134, 1, v200 op_sel:[0,0,0,0]
    v_mad_u32_u16 v201, v134, 1, v201 op_sel:[1,0,0,0]
    v_mad_u32_u16 v202, v135, 1, v202 op_sel:[0,0,0,0]
    v_mad_u32_u16 v203, v135, 1, v203 op_sel:[1,0,0,0]
    v_lshlrev_b32_sdwa v92, 3, v161 dst_sel:DWORD dst_unused:UNUSED_PAD src0_sel:DWORD src1_sel:WORD_0
    v_lshlrev_b32_sdwa v94, 3, v161 dst_sel:DWORD dst_unused:UNUSED_PAD src0_sel:DWORD src1_sel:WORD_1
    ds_read_b64 v[92:93], v92
    ds_read_b64 v[94:95], v94
    s_add_u32 s20, s20, 0x40000
    buffer_load_dwordx4 v[116:119], v71, s[12:15], s20 offen offset:0 sc1
    s_waitcnt lgkmcnt(8)
    v_add3_u32 v8, v8, v96, v98
    v_add3_u32 v9, v9, v97, v99
    v_add3_u32 v8, v8, v100, v102
    v_add3_u32 v9, v9, v101, v103
    v_pk_fma_f32 v[200:201], v[200:201], v[222:223], v[66:67]
    v_pk_fma_f32 v[202:203], v[202:203], v[222:223], v[68:69]
    v_pk_mul_f32 v[242:243], v[200:201], v[200:201]
    v_pk_mul_f32 v[244:245], v[202:203], v[202:203]
    v_pk_fma_f32 v[242:243], v[242:243], v[212:213], v[214:215]
    v_pk_fma_f32 v[244:245], v[244:245], v[212:213], v[214:215]
    v_lshlrev_b32_sdwa v96, 3, v162 dst_sel:DWORD dst_unused:UNUSED_PAD src0_sel:DWORD src1_sel:WORD_0
    v_lshlrev_b32_sdwa v98, 3, v162 dst_sel:DWORD dst_unused:UNUSED_PAD src0_sel:DWORD src1_sel:WORD_1
    ds_read_b64 v[96:97], v96
    ds_read_b64 v[98:99], v98
    v_pk_mul_f32 v[242:243], v[242:243], v[200:201]
    v_pk_mul_f32 v[244:245], v[244:245], v[202:203]
    v_exp_f32 v242, v242
    v_exp_f32 v243, v243
    v_exp_f32 v244, v244
    v_lshlrev_b32_sdwa v100, 3, v163 dst_sel:DWORD dst_unused:UNUSED_PAD src0_sel:DWORD src1_sel:WORD_0
    v_lshlrev_b32_sdwa v102, 3, v163 dst_sel:DWORD dst_unused:UNUSED_PAD src0_sel:DWORD src1_sel:WORD_1
    ds_read_b64 v[100:101], v100
    ds_read_b64 v[102:103], v102
    s_waitcnt lgkmcnt(8)
    v_add3_u32 v8, v8, v104, v106
    v_add3_u32 v9, v9, v105, v107
    v_add3_u32 v8, v8, v108, v110
    v_add3_u32 v9, v9, v109, v111
    v_exp_f32 v245, v245
    v_pk_fma_f32 v[242:243], v[242:243], v[218:219], v[218:219]
    v_mad_u32_u16 v204, v8, 1, s27 op_sel:[0,0,0,0]
    v_rcp_f32 v242, v242
    v_pk_fma_f32 v[244:245], v[244:245], v[220:221], v[220:221]
    v_mad_u32_u16 v205, v8, 1, s27 op_sel:[1,0,0,0]
    v_lshlrev_b32_sdwa v104, 3, v164 dst_sel:DWORD dst_unused:UNUSED_PAD src0_sel:DWORD src1_sel:WORD_0
    v_lshlrev_b32_sdwa v106, 3, v164 dst_sel:DWORD dst_unused:UNUSED_PAD src0_sel:DWORD src1_sel:WORD_1
    ds_read_b64 v[104:105], v104
    ds_read_b64 v[106:107], v106
    v_rcp_f32 v243, v243
    v_mad_u32_u16 v206, v9, 1, s27 op_sel:[0,0,0,0]
    v_mad_u32_u16 v207, v9, 1, s27 op_sel:[1,0,0,0]
    v_rcp_f32 v244, v244
    v_pk_mul_f32 v[246:247], v[200:201], v[242:243]
    v_lshlrev_b32_sdwa v108, 3, v165 dst_sel:DWORD dst_unused:UNUSED_PAD src0_sel:DWORD src1_sel:WORD_0
    v_lshlrev_b32_sdwa v110, 3, v165 dst_sel:DWORD dst_unused:UNUSED_PAD src0_sel:DWORD src1_sel:WORD_1
    ds_read_b64 v[108:109], v108
    ds_read_b64 v[110:111], v110
    buffer_load_dwordx4 v[44:47], v71, s[12:15], s20 offen offset:1024 sc1
    s_waitcnt lgkmcnt(8)
    v_add3_u32 v10, v10, v88, v90
    v_add3_u32 v11, v11, v89, v91
    v_add3_u32 v10, v10, v92, v94
    v_add3_u32 v11, v11, v93, v95
    v_rcp_f32 v245, v245
    v_mad_u32_u16 v204, v136, 1, v204 op_sel:[0,0,0,0]
    v_mad_u32_u16 v205, v136, 1, v205 op_sel:[1,0,0,0]
    v_pk_fma_f32 v[246:247], v[202:203], v[244:245], v[246:247]
    v_mad_u32_u16 v206, v137, 1, v206 op_sel:[0,0,0,0]
    v_add_f32 v246, v246, v247
    v_lshlrev_b32_sdwa v88, 3, v166 dst_sel:DWORD dst_unused:UNUSED_PAD src0_sel:DWORD src1_sel:WORD_0
    v_lshlrev_b32_sdwa v90, 3, v166 dst_sel:DWORD dst_unused:UNUSED_PAD src0_sel:DWORD src1_sel:WORD_1
    ds_read_b64 v[88:89], v88
    ds_read_b64 v[90:91], v90
    v_min_u32 v246, -2, v246
    v_mad_u32_u16 v207, v137, 1, v207 op_sel:[1,0,0,0]
    buffer_store_dword v246, v76, s[12:15], s35 offen offset:768 sc1
    v_pk_fma_f32 v[204:205], v[204:205], v[222:223], v[66:67]
    v_pk_fma_f32 v[206:207], v[206:207], v[222:223], v[68:69]
    v_lshlrev_b32_sdwa v92, 3, v167 dst_sel:DWORD dst_unused:UNUSED_PAD src0_sel:DWORD src1_sel:WORD_0
    v_lshlrev_b32_sdwa v94, 3, v167 dst_sel:DWORD dst_unused:UNUSED_PAD src0_sel:DWORD src1_sel:WORD_1
    ds_read_b64 v[92:93], v92
    ds_read_b64 v[94:95], v94
    s_waitcnt lgkmcnt(8)
    v_add3_u32 v10, v10, v96, v98
    v_add3_u32 v11, v11, v97, v99
    v_add3_u32 v10, v10, v100, v102
    v_add3_u32 v11, v11, v101, v103
    v_pk_mul_f32 v[248:249], v[204:205], v[204:205]
    v_pk_mul_f32 v[250:251], v[206:207], v[206:207]
    v_pk_fma_f32 v[248:249], v[248:249], v[212:213], v[214:215]
    v_pk_fma_f32 v[250:251], v[250:251], v[212:213], v[214:215]
    v_pk_mul_f32 v[248:249], v[248:249], v[204:205]
    v_pk_mul_f32 v[250:251], v[250:251], v[206:207]
    s_waitcnt vmcnt(12)
    v_lshlrev_b32_sdwa v96, 3, v168 dst_sel:DWORD dst_unused:UNUSED_PAD src0_sel:DWORD src1_sel:WORD_0
    v_lshlrev_b32_sdwa v98, 3, v168 dst_sel:DWORD dst_unused:UNUSED_PAD src0_sel:DWORD src1_sel:WORD_1
    ds_read_b64 v[96:97], v96
    ds_read_b64 v[98:99], v98
    v_exp_f32 v248, v248
    v_exp_f32 v249, v249
    v_exp_f32 v250, v250
    v_exp_f32 v251, v251
    v_pk_fma_f32 v[248:249], v[248:249], v[218:219], v[218:219]
    v_lshlrev_b32_sdwa v100, 3, v169 dst_sel:DWORD dst_unused:UNUSED_PAD src0_sel:DWORD src1_sel:WORD_0
    v_lshlrev_b32_sdwa v102, 3, v169 dst_sel:DWORD dst_unused:UNUSED_PAD src0_sel:DWORD src1_sel:WORD_1
    ds_read_b64 v[100:101], v100
    ds_read_b64 v[102:103], v102
    buffer_load_dwordx4 v[148:151], v71, s[12:15], s32 offen offset:1024 sc1
    s_add_u32 s20, s20, 0xfffc0800
    buffer_load_dwordx4 v[36:39], v71, s[12:15], s20 offen offset:0 sc1
    s_waitcnt lgkmcnt(8)
    v_add3_u32 v10, v10, v104, v106
    v_add3_u32 v11, v11, v105, v107
    v_add3_u32 v10, v10, v108, v110
    v_add3_u32 v11, v11, v109, v111
    v_rcp_f32 v248, v248
    v_pk_fma_f32 v[250:251], v[250:251], v[220:221], v[220:221]
    v_rcp_f32 v249, v249
    v_rcp_f32 v250, v250
    v_rcp_f32 v251, v251
    v_pk_mul_f32 v[252:253], v[204:205], v[248:249]
    v_lshlrev_b32_sdwa v104, 3, v170 dst_sel:DWORD dst_unused:UNUSED_PAD src0_sel:DWORD src1_sel:WORD_0
    v_lshlrev_b32_sdwa v106, 3, v170 dst_sel:DWORD dst_unused:UNUSED_PAD src0_sel:DWORD src1_sel:WORD_1
    ds_read_b64 v[104:105], v104
    ds_read_b64 v[106:107], v106
    v_pk_fma_f32 v[252:253], v[206:207], v[250:251], v[252:253]
    v_lshlrev_b32_sdwa v108, 3, v171 dst_sel:DWORD dst_unused:UNUSED_PAD src0_sel:DWORD src1_sel:WORD_0
    v_lshlrev_b32_sdwa v110, 3, v171 dst_sel:DWORD dst_unused:UNUSED_PAD src0_sel:DWORD src1_sel:WORD_1
    ds_read_b64 v[108:109], v108
    ds_read_b64 v[110:111], v110
    s_waitcnt lgkmcnt(8)
    v_add3_u32 v10, v10, v88, v90
    v_add3_u32 v11, v11, v89, v91
    v_add3_u32 v10, v10, v92, v94
    v_add3_u32 v11, v11, v93, v95
    v_add_f32 v252, v252, v253
    v_mad_u32_u16 v188, v10, 1, s27 op_sel:[0,0,0,0]
    v_min_u32 v252, -2, v252
    v_mad_u32_u16 v189, v10, 1, s27 op_sel:[1,0,0,0]
    buffer_store_dword v252, v76, s[12:15], s35 offen offset:1024 sc1
    v_mad_u32_u16 v190, v11, 1, s27 op_sel:[0,0,0,0]
    s_waitcnt vmcnt(13)
    v_lshlrev_b32_sdwa v88, 3, v172 dst_sel:DWORD dst_unused:UNUSED_PAD src0_sel:DWORD src1_sel:WORD_0
    v_lshlrev_b32_sdwa v90, 3, v172 dst_sel:DWORD dst_unused:UNUSED_PAD src0_sel:DWORD src1_sel:WORD_1
    ds_read_b64 v[88:89], v88
    ds_read_b64 v[90:91], v90
    v_mad_u32_u16 v191, v11, 1, s27 op_sel:[1,0,0,0]
    v_mad_u32_u16 v188, v138, 1, v188 op_sel:[0,0,0,0]
    v_mad_u32_u16 v189, v138, 1, v189 op_sel:[1,0,0,0]
    v_mad_u32_u16 v190, v139, 1, v190 op_sel:[0,0,0,0]
    v_mad_u32_u16 v191, v139, 1, v191 op_sel:[1,0,0,0]
    v_lshlrev_b32_sdwa v92, 3, v173 dst_sel:DWORD dst_unused:UNUSED_PAD src0_sel:DWORD src1_sel:WORD_0
    v_lshlrev_b32_sdwa v94, 3, v173 dst_sel:DWORD dst_unused:UNUSED_PAD src0_sel:DWORD src1_sel:WORD_1
    ds_read_b64 v[92:93], v92
    ds_read_b64 v[94:95], v94
    s_add_u32 s20, s20, 0x40000
    buffer_load_dwordx4 v[120:123], v71, s[12:15], s20 offen offset:0 sc1
    s_waitcnt lgkmcnt(8)
    v_add3_u32 v12, v12, v96, v98
    v_add3_u32 v13, v13, v97, v99
    v_add3_u32 v12, v12, v100, v102
    v_add3_u32 v13, v13, v101, v103
    v_pk_fma_f32 v[188:189], v[188:189], v[222:223], v[66:67]
    v_pk_fma_f32 v[190:191], v[190:191], v[222:223], v[68:69]
    v_pk_mul_f32 v[224:225], v[188:189], v[188:189]
    v_pk_mul_f32 v[226:227], v[190:191], v[190:191]
    v_pk_fma_f32 v[224:225], v[224:225], v[212:213], v[214:215]
    v_pk_fma_f32 v[226:227], v[226:227], v[212:213], v[214:215]
    v_lshlrev_b32_sdwa v96, 3, v174 dst_sel:DWORD dst_unused:UNUSED_PAD src0_sel:DWORD src1_sel:WORD_0
    v_lshlrev_b32_sdwa v98, 3, v174 dst_sel:DWORD dst_unused:UNUSED_PAD src0_sel:DWORD src1_sel:WORD_1
    ds_read_b64 v[96:97], v96
    ds_read_b64 v[98:99], v98
    v_pk_mul_f32 v[224:225], v[224:225], v[188:189]
    v_pk_mul_f32 v[226:227], v[226:227], v[190:191]
    v_exp_f32 v224, v224
    v_exp_f32 v225, v225
    v_exp_f32 v226, v226
    v_lshlrev_b32_sdwa v100, 3, v175 dst_sel:DWORD dst_unused:UNUSED_PAD src0_sel:DWORD src1_sel:WORD_0
    v_lshlrev_b32_sdwa v102, 3, v175 dst_sel:DWORD dst_unused:UNUSED_PAD src0_sel:DWORD src1_sel:WORD_1
    ds_read_b64 v[100:101], v100
    ds_read_b64 v[102:103], v102
    s_waitcnt lgkmcnt(8)
    v_add3_u32 v12, v12, v104, v106
    v_add3_u32 v13, v13, v105, v107
    v_add3_u32 v12, v12, v108, v110
    v_add3_u32 v13, v13, v109, v111
    v_exp_f32 v227, v227
    v_pk_fma_f32 v[224:225], v[224:225], v[218:219], v[218:219]
    v_mad_u32_u16 v192, v12, 1, s27 op_sel:[0,0,0,0]
    v_rcp_f32 v224, v224
    v_pk_fma_f32 v[226:227], v[226:227], v[220:221], v[220:221]
    v_mad_u32_u16 v193, v12, 1, s27 op_sel:[1,0,0,0]
    s_waitcnt vmcnt(12)
    v_lshlrev_b32_sdwa v104, 3, v32 dst_sel:DWORD dst_unused:UNUSED_PAD src0_sel:DWORD src1_sel:WORD_0
    v_lshlrev_b32_sdwa v106, 3, v32 dst_sel:DWORD dst_unused:UNUSED_PAD src0_sel:DWORD src1_sel:WORD_1
    ds_read_b64 v[104:105], v104
    ds_read_b64 v[106:107], v106
    v_rcp_f32 v225, v225
    v_mad_u32_u16 v194, v13, 1, s27 op_sel:[0,0,0,0]
    v_mad_u32_u16 v195, v13, 1, s27 op_sel:[1,0,0,0]
    v_rcp_f32 v226, v226
    v_pk_mul_f32 v[228:229], v[188:189], v[224:225]
    v_lshlrev_b32_sdwa v108, 3, v33 dst_sel:DWORD dst_unused:UNUSED_PAD src0_sel:DWORD src1_sel:WORD_0
    v_lshlrev_b32_sdwa v110, 3, v33 dst_sel:DWORD dst_unused:UNUSED_PAD src0_sel:DWORD src1_sel:WORD_1
    ds_read_b64 v[108:109], v108
    ds_read_b64 v[110:111], v110
    buffer_load_dwordx4 v[160:163], v71, s[12:15], s20 offen offset:1024 sc1
    s_waitcnt lgkmcnt(8)
    v_add3_u32 v14, v14, v88, v90
    v_add3_u32 v15, v15, v89, v91
    v_add3_u32 v14, v14, v92, v94
    v_add3_u32 v15, v15, v93, v95
    s_setprio 2
    v_rcp_f32 v227, v227
    v_mad_u32_u16 v192, v140, 1, v192 op_sel:[0,0,0,0]
    v_mad_u32_u16 v193, v140, 1, v193 op_sel:[1,0,0,0]
    v_pk_fma_f32 v[228:229], v[190:191], v[226:227], v[228:229]
    v_mad_u32_u16 v194, v141, 1, v194 op_sel:[0,0,0,0]
    v_add_f32 v228, v228, v229
    v_lshlrev_b32_sdwa v88, 3, v34 dst_sel:DWORD dst_unused:UNUSED_PAD src0_sel:DWORD src1_sel:WORD_0
    v_lshlrev_b32_sdwa v90, 3, v34 dst_sel:DWORD dst_unused:UNUSED_PAD src0_sel:DWORD src1_sel:WORD_1
    ds_read_b64 v[88:89], v88
    ds_read_b64 v[90:91], v90
    v_min_u32 v228, -2, v228
    v_mad_u32_u16 v195, v141, 1, v195 op_sel:[1,0,0,0]
    buffer_store_dword v228, v76, s[12:15], s35 offen offset:1280 sc1
    v_pk_fma_f32 v[192:193], v[192:193], v[222:223], v[66:67]
    v_pk_fma_f32 v[194:195], v[194:195], v[222:223], v[68:69]
    v_lshlrev_b32_sdwa v92, 3, v35 dst_sel:DWORD dst_unused:UNUSED_PAD src0_sel:DWORD src1_sel:WORD_0
    v_lshlrev_b32_sdwa v94, 3, v35 dst_sel:DWORD dst_unused:UNUSED_PAD src0_sel:DWORD src1_sel:WORD_1
    ds_read_b64 v[92:93], v92
    ds_read_b64 v[94:95], v94
    s_waitcnt lgkmcnt(8)
    v_add3_u32 v14, v14, v96, v98
    v_add3_u32 v15, v15, v97, v99
    v_add3_u32 v14, v14, v100, v102
    v_add3_u32 v15, v15, v101, v103
    v_pk_mul_f32 v[230:231], v[192:193], v[192:193]
    v_pk_mul_f32 v[232:233], v[194:195], v[194:195]
    v_pk_fma_f32 v[230:231], v[230:231], v[212:213], v[214:215]
    v_pk_fma_f32 v[232:233], v[232:233], v[212:213], v[214:215]
    v_pk_mul_f32 v[230:231], v[230:231], v[192:193]
    v_pk_mul_f32 v[232:233], v[232:233], v[194:195]
    s_waitcnt vmcnt(13)
    v_lshlrev_b32_sdwa v96, 3, v40 dst_sel:DWORD dst_unused:UNUSED_PAD src0_sel:DWORD src1_sel:WORD_0
    v_lshlrev_b32_sdwa v98, 3, v40 dst_sel:DWORD dst_unused:UNUSED_PAD src0_sel:DWORD src1_sel:WORD_1
    ds_read_b64 v[96:97], v96
    ds_read_b64 v[98:99], v98
    v_exp_f32 v230, v230
    v_exp_f32 v231, v231
    v_exp_f32 v232, v232
    v_exp_f32 v233, v233
    v_pk_fma_f32 v[230:231], v[230:231], v[218:219], v[218:219]
    v_lshlrev_b32_sdwa v100, 3, v41 dst_sel:DWORD dst_unused:UNUSED_PAD src0_sel:DWORD src1_sel:WORD_0
    v_lshlrev_b32_sdwa v102, 3, v41 dst_sel:DWORD dst_unused:UNUSED_PAD src0_sel:DWORD src1_sel:WORD_1
    ds_read_b64 v[100:101], v100
    ds_read_b64 v[102:103], v102
    buffer_load_dwordx4 v[152:155], v71, s[12:15], s32 offen offset:2048 sc1
    s_add_u32 s20, s20, 0xfffc0800
    buffer_load_dwordx4 v[164:167], v71, s[12:15], s20 offen offset:0 sc1
    s_waitcnt lgkmcnt(8)
    v_add3_u32 v14, v14, v104, v106
    v_add3_u32 v15, v15, v105, v107
    v_add3_u32 v14, v14, v108, v110
    v_add3_u32 v15, v15, v109, v111
    v_rcp_f32 v230, v230
    v_pk_fma_f32 v[232:233], v[232:233], v[220:221], v[220:221]
    v_rcp_f32 v231, v231
    v_rcp_f32 v232, v232
    v_rcp_f32 v233, v233
    v_pk_mul_f32 v[234:235], v[192:193], v[230:231]
    v_lshlrev_b32_sdwa v104, 3, v42 dst_sel:DWORD dst_unused:UNUSED_PAD src0_sel:DWORD src1_sel:WORD_0
    v_lshlrev_b32_sdwa v106, 3, v42 dst_sel:DWORD dst_unused:UNUSED_PAD src0_sel:DWORD src1_sel:WORD_1
    ds_read_b64 v[104:105], v104
    ds_read_b64 v[106:107], v106
    v_pk_fma_f32 v[234:235], v[194:195], v[232:233], v[234:235]
    v_lshlrev_b32_sdwa v108, 3, v43 dst_sel:DWORD dst_unused:UNUSED_PAD src0_sel:DWORD src1_sel:WORD_0
    v_lshlrev_b32_sdwa v110, 3, v43 dst_sel:DWORD dst_unused:UNUSED_PAD src0_sel:DWORD src1_sel:WORD_1
    ds_read_b64 v[108:109], v108
    ds_read_b64 v[110:111], v110
    s_waitcnt lgkmcnt(8)
    v_add3_u32 v14, v14, v88, v90
    v_add3_u32 v15, v15, v89, v91
    v_add3_u32 v14, v14, v92, v94
    v_add3_u32 v15, v15, v93, v95
    v_add_f32 v234, v234, v235
    v_mad_u32_u16 v196, v14, 1, s27 op_sel:[0,0,0,0]
    v_min_u32 v234, -2, v234
    v_mad_u32_u16 v197, v14, 1, s27 op_sel:[1,0,0,0]
    buffer_store_dword v234, v76, s[12:15], s35 offen offset:1536 sc1
    v_mad_u32_u16 v198, v15, 1, s27 op_sel:[0,0,0,0]
    s_waitcnt vmcnt(13)
    v_lshlrev_b32_sdwa v88, 3, v124 dst_sel:DWORD dst_unused:UNUSED_PAD src0_sel:DWORD src1_sel:WORD_0
    v_lshlrev_b32_sdwa v90, 3, v124 dst_sel:DWORD dst_unused:UNUSED_PAD src0_sel:DWORD src1_sel:WORD_1
    ds_read_b64 v[88:89], v88
    ds_read_b64 v[90:91], v90
    v_mad_u32_u16 v199, v15, 1, s27 op_sel:[1,0,0,0]
    v_mad_u32_u16 v196, v142, 1, v196 op_sel:[0,0,0,0]
    v_mad_u32_u16 v197, v142, 1, v197 op_sel:[1,0,0,0]
    v_mad_u32_u16 v198, v143, 1, v198 op_sel:[0,0,0,0]
    v_mad_u32_u16 v199, v143, 1, v199 op_sel:[1,0,0,0]
    v_lshlrev_b32_sdwa v92, 3, v125 dst_sel:DWORD dst_unused:UNUSED_PAD src0_sel:DWORD src1_sel:WORD_0
    v_lshlrev_b32_sdwa v94, 3, v125 dst_sel:DWORD dst_unused:UNUSED_PAD src0_sel:DWORD src1_sel:WORD_1
    ds_read_b64 v[92:93], v92
    ds_read_b64 v[94:95], v94
    s_add_u32 s20, s20, 0x40000
    buffer_load_dwordx4 v[168:171], v71, s[12:15], s20 offen offset:0 sc1
    s_waitcnt lgkmcnt(8)
    v_add3_u32 v16, v16, v96, v98
    v_add3_u32 v17, v17, v97, v99
    v_add3_u32 v16, v16, v100, v102
    v_add3_u32 v17, v17, v101, v103
    v_pk_fma_f32 v[196:197], v[196:197], v[222:223], v[66:67]
    v_pk_fma_f32 v[198:199], v[198:199], v[222:223], v[68:69]
    v_pk_mul_f32 v[236:237], v[196:197], v[196:197]
    v_pk_mul_f32 v[238:239], v[198:199], v[198:199]
    v_pk_fma_f32 v[236:237], v[236:237], v[212:213], v[214:215]
    v_pk_fma_f32 v[238:239], v[238:239], v[212:213], v[214:215]
    v_lshlrev_b32_sdwa v96, 3, v126 dst_sel:DWORD dst_unused:UNUSED_PAD src0_sel:DWORD src1_sel:WORD_0
    v_lshlrev_b32_sdwa v98, 3, v126 dst_sel:DWORD dst_unused:UNUSED_PAD src0_sel:DWORD src1_sel:WORD_1
    ds_read_b64 v[96:97], v96
    ds_read_b64 v[98:99], v98
    v_pk_mul_f32 v[236:237], v[236:237], v[196:197]
    v_pk_mul_f32 v[238:239], v[238:239], v[198:199]
    v_exp_f32 v236, v236
    v_exp_f32 v237, v237
    v_exp_f32 v238, v238
    v_lshlrev_b32_sdwa v100, 3, v127 dst_sel:DWORD dst_unused:UNUSED_PAD src0_sel:DWORD src1_sel:WORD_0
    v_lshlrev_b32_sdwa v102, 3, v127 dst_sel:DWORD dst_unused:UNUSED_PAD src0_sel:DWORD src1_sel:WORD_1
    ds_read_b64 v[100:101], v100
    ds_read_b64 v[102:103], v102
    s_waitcnt lgkmcnt(8)
    v_add3_u32 v16, v16, v104, v106
    v_add3_u32 v17, v17, v105, v107
    v_add3_u32 v16, v16, v108, v110
    v_add3_u32 v17, v17, v109, v111
    v_exp_f32 v239, v239
    v_pk_fma_f32 v[236:237], v[236:237], v[218:219], v[218:219]
    v_mad_u32_u16 v200, v16, 1, s27 op_sel:[0,0,0,0]
    v_rcp_f32 v236, v236
    v_pk_fma_f32 v[238:239], v[238:239], v[220:221], v[220:221]
    v_mad_u32_u16 v201, v16, 1, s27 op_sel:[1,0,0,0]
    s_waitcnt vmcnt(12)
    v_lshlrev_b32_sdwa v104, 3, v116 dst_sel:DWORD dst_unused:UNUSED_PAD src0_sel:DWORD src1_sel:WORD_0
    v_lshlrev_b32_sdwa v106, 3, v116 dst_sel:DWORD dst_unused:UNUSED_PAD src0_sel:DWORD src1_sel:WORD_1
    ds_read_b64 v[104:105], v104
    ds_read_b64 v[106:107], v106
    v_rcp_f32 v237, v237
    v_mad_u32_u16 v202, v17, 1, s27 op_sel:[0,0,0,0]
    v_mad_u32_u16 v203, v17, 1, s27 op_sel:[1,0,0,0]
    v_rcp_f32 v238, v238
    v_pk_mul_f32 v[240:241], v[196:197], v[236:237]
    v_lshlrev_b32_sdwa v108, 3, v117 dst_sel:DWORD dst_unused:UNUSED_PAD src0_sel:DWORD src1_sel:WORD_0
    v_lshlrev_b32_sdwa v110, 3, v117 dst_sel:DWORD dst_unused:UNUSED_PAD src0_sel:DWORD src1_sel:WORD_1
    ds_read_b64 v[108:109], v108
    ds_read_b64 v[110:111], v110
    buffer_load_dwordx4 v[172:175], v71, s[12:15], s20 offen offset:1024 sc1
    s_waitcnt lgkmcnt(8)
    v_add3_u32 v18, v18, v88, v90
    v_add3_u32 v19, v19, v89, v91
    v_add3_u32 v18, v18, v92, v94
    v_add3_u32 v19, v19, v93, v95
    v_rcp_f32 v239, v239
    v_mad_u32_u16 v200, v144, 1, v200 op_sel:[0,0,0,0]
    v_mad_u32_u16 v201, v144, 1, v201 op_sel:[1,0,0,0]
    v_pk_fma_f32 v[240:241], v[198:199], v[238:239], v[240:241]
    v_mad_u32_u16 v202, v145, 1, v202 op_sel:[0,0,0,0]
    v_add_f32 v240, v240, v241
    v_lshlrev_b32_sdwa v88, 3, v118 dst_sel:DWORD dst_unused:UNUSED_PAD src0_sel:DWORD src1_sel:WORD_0
    v_lshlrev_b32_sdwa v90, 3, v118 dst_sel:DWORD dst_unused:UNUSED_PAD src0_sel:DWORD src1_sel:WORD_1
    ds_read_b64 v[88:89], v88
    ds_read_b64 v[90:91], v90
    v_min_u32 v240, -2, v240
    v_mad_u32_u16 v203, v145, 1, v203 op_sel:[1,0,0,0]
    buffer_store_dword v240, v76, s[12:15], s35 offen offset:1792 sc1
    v_pk_fma_f32 v[200:201], v[200:201], v[222:223], v[66:67]
    v_pk_fma_f32 v[202:203], v[202:203], v[222:223], v[68:69]
    v_lshlrev_b32_sdwa v92, 3, v119 dst_sel:DWORD dst_unused:UNUSED_PAD src0_sel:DWORD src1_sel:WORD_0
    v_lshlrev_b32_sdwa v94, 3, v119 dst_sel:DWORD dst_unused:UNUSED_PAD src0_sel:DWORD src1_sel:WORD_1
    ds_read_b64 v[92:93], v92
    ds_read_b64 v[94:95], v94
    s_waitcnt lgkmcnt(8)
    v_add3_u32 v18, v18, v96, v98
    v_add3_u32 v19, v19, v97, v99
    v_add3_u32 v18, v18, v100, v102
    v_add3_u32 v19, v19, v101, v103
    v_pk_mul_f32 v[242:243], v[200:201], v[200:201]
    v_pk_mul_f32 v[244:245], v[202:203], v[202:203]
    v_pk_fma_f32 v[242:243], v[242:243], v[212:213], v[214:215]
    v_pk_fma_f32 v[244:245], v[244:245], v[212:213], v[214:215]
    v_pk_mul_f32 v[242:243], v[242:243], v[200:201]
    v_pk_mul_f32 v[244:245], v[244:245], v[202:203]
    s_waitcnt vmcnt(13)
    v_lshlrev_b32_sdwa v96, 3, v44 dst_sel:DWORD dst_unused:UNUSED_PAD src0_sel:DWORD src1_sel:WORD_0
    v_lshlrev_b32_sdwa v98, 3, v44 dst_sel:DWORD dst_unused:UNUSED_PAD src0_sel:DWORD src1_sel:WORD_1
    ds_read_b64 v[96:97], v96
    ds_read_b64 v[98:99], v98
    v_exp_f32 v242, v242
    v_exp_f32 v243, v243
    v_exp_f32 v244, v244
    v_exp_f32 v245, v245
    v_pk_fma_f32 v[242:243], v[242:243], v[218:219], v[218:219]
    v_lshlrev_b32_sdwa v100, 3, v45 dst_sel:DWORD dst_unused:UNUSED_PAD src0_sel:DWORD src1_sel:WORD_0
    v_lshlrev_b32_sdwa v102, 3, v45 dst_sel:DWORD dst_unused:UNUSED_PAD src0_sel:DWORD src1_sel:WORD_1
    ds_read_b64 v[100:101], v100
    ds_read_b64 v[102:103], v102
    buffer_load_dwordx4 v[156:159], v71, s[12:15], s32 offen offset:3072 sc1
    s_add_u32 s20, s20, 0xfffc0800
    buffer_load_dwordx4 v[32:35], v71, s[12:15], s20 offen offset:0 sc1
    s_waitcnt lgkmcnt(8)
    v_add3_u32 v18, v18, v104, v106
    v_add3_u32 v19, v19, v105, v107
    v_add3_u32 v18, v18, v108, v110
    v_add3_u32 v19, v19, v109, v111
    v_rcp_f32 v242, v242
    v_pk_fma_f32 v[244:245], v[244:245], v[220:221], v[220:221]
    v_rcp_f32 v243, v243
    v_rcp_f32 v244, v244
    v_rcp_f32 v245, v245
    v_pk_mul_f32 v[246:247], v[200:201], v[242:243]
    v_lshlrev_b32_sdwa v104, 3, v46 dst_sel:DWORD dst_unused:UNUSED_PAD src0_sel:DWORD src1_sel:WORD_0
    v_lshlrev_b32_sdwa v106, 3, v46 dst_sel:DWORD dst_unused:UNUSED_PAD src0_sel:DWORD src1_sel:WORD_1
    ds_read_b64 v[104:105], v104
    ds_read_b64 v[106:107], v106
    v_pk_fma_f32 v[246:247], v[202:203], v[244:245], v[246:247]
    v_lshlrev_b32_sdwa v108, 3, v47 dst_sel:DWORD dst_unused:UNUSED_PAD src0_sel:DWORD src1_sel:WORD_0
    v_lshlrev_b32_sdwa v110, 3, v47 dst_sel:DWORD dst_unused:UNUSED_PAD src0_sel:DWORD src1_sel:WORD_1
    ds_read_b64 v[108:109], v108
    ds_read_b64 v[110:111], v110
    s_waitcnt lgkmcnt(8)
    v_add3_u32 v18, v18, v88, v90
    v_add3_u32 v19, v19, v89, v91
    v_add3_u32 v18, v18, v92, v94
    v_add3_u32 v19, v19, v93, v95
    v_add_f32 v246, v246, v247
    v_mad_u32_u16 v204, v18, 1, s27 op_sel:[0,0,0,0]
    v_min_u32 v246, -2, v246
    v_mad_u32_u16 v205, v18, 1, s27 op_sel:[1,0,0,0]
    buffer_store_dword v246, v76, s[12:15], s35 offen offset:2048 sc1
    v_mad_u32_u16 v206, v19, 1, s27 op_sel:[0,0,0,0]
    s_waitcnt vmcnt(13)
    v_lshlrev_b32_sdwa v88, 3, v36 dst_sel:DWORD dst_unused:UNUSED_PAD src0_sel:DWORD src1_sel:WORD_0
    v_lshlrev_b32_sdwa v90, 3, v36 dst_sel:DWORD dst_unused:UNUSED_PAD src0_sel:DWORD src1_sel:WORD_1
    ds_read_b64 v[88:89], v88
    ds_read_b64 v[90:91], v90
    v_mad_u32_u16 v207, v19, 1, s27 op_sel:[1,0,0,0]
    v_mad_u32_u16 v204, v146, 1, v204 op_sel:[0,0,0,0]
    v_mad_u32_u16 v205, v146, 1, v205 op_sel:[1,0,0,0]
    v_mad_u32_u16 v206, v147, 1, v206 op_sel:[0,0,0,0]
    v_mad_u32_u16 v207, v147, 1, v207 op_sel:[1,0,0,0]
    v_lshlrev_b32_sdwa v92, 3, v37 dst_sel:DWORD dst_unused:UNUSED_PAD src0_sel:DWORD src1_sel:WORD_0
    v_lshlrev_b32_sdwa v94, 3, v37 dst_sel:DWORD dst_unused:UNUSED_PAD src0_sel:DWORD src1_sel:WORD_1
    ds_read_b64 v[92:93], v92
    ds_read_b64 v[94:95], v94
    s_add_u32 s20, s20, 0x40000
    buffer_load_dwordx4 v[40:43], v71, s[12:15], s20 offen offset:0 sc1
    s_waitcnt lgkmcnt(8)
    v_add3_u32 v20, v20, v96, v98
    v_add3_u32 v21, v21, v97, v99
    v_add3_u32 v20, v20, v100, v102
    v_add3_u32 v21, v21, v101, v103
    v_pk_fma_f32 v[204:205], v[204:205], v[222:223], v[66:67]
    v_pk_fma_f32 v[206:207], v[206:207], v[222:223], v[68:69]
    v_pk_mul_f32 v[248:249], v[204:205], v[204:205]
    v_pk_mul_f32 v[250:251], v[206:207], v[206:207]
    v_pk_fma_f32 v[248:249], v[248:249], v[212:213], v[214:215]
    v_pk_fma_f32 v[250:251], v[250:251], v[212:213], v[214:215]
    v_lshlrev_b32_sdwa v96, 3, v38 dst_sel:DWORD dst_unused:UNUSED_PAD src0_sel:DWORD src1_sel:WORD_0
    v_lshlrev_b32_sdwa v98, 3, v38 dst_sel:DWORD dst_unused:UNUSED_PAD src0_sel:DWORD src1_sel:WORD_1
    ds_read_b64 v[96:97], v96
    ds_read_b64 v[98:99], v98
    v_pk_mul_f32 v[248:249], v[248:249], v[204:205]
    v_pk_mul_f32 v[250:251], v[250:251], v[206:207]
    v_exp_f32 v248, v248
    v_exp_f32 v249, v249
    v_exp_f32 v250, v250
    v_lshlrev_b32_sdwa v100, 3, v39 dst_sel:DWORD dst_unused:UNUSED_PAD src0_sel:DWORD src1_sel:WORD_0
    v_lshlrev_b32_sdwa v102, 3, v39 dst_sel:DWORD dst_unused:UNUSED_PAD src0_sel:DWORD src1_sel:WORD_1
    ds_read_b64 v[100:101], v100
    ds_read_b64 v[102:103], v102
    s_waitcnt lgkmcnt(8)
    v_add3_u32 v20, v20, v104, v106
    v_add3_u32 v21, v21, v105, v107
    v_add3_u32 v20, v20, v108, v110
    v_add3_u32 v21, v21, v109, v111
    v_exp_f32 v251, v251
    v_pk_fma_f32 v[248:249], v[248:249], v[218:219], v[218:219]
    v_mad_u32_u16 v188, v20, 1, s27 op_sel:[0,0,0,0]
    v_rcp_f32 v248, v248
    v_pk_fma_f32 v[250:251], v[250:251], v[220:221], v[220:221]
    v_mad_u32_u16 v189, v20, 1, s27 op_sel:[1,0,0,0]
    s_waitcnt vmcnt(12)
    v_lshlrev_b32_sdwa v104, 3, v120 dst_sel:DWORD dst_unused:UNUSED_PAD src0_sel:DWORD src1_sel:WORD_0
    v_lshlrev_b32_sdwa v106, 3, v120 dst_sel:DWORD dst_unused:UNUSED_PAD src0_sel:DWORD src1_sel:WORD_1
    ds_read_b64 v[104:105], v104
    ds_read_b64 v[106:107], v106
    v_rcp_f32 v249, v249
    v_mad_u32_u16 v190, v21, 1, s27 op_sel:[0,0,0,0]
    v_mad_u32_u16 v191, v21, 1, s27 op_sel:[1,0,0,0]
    v_rcp_f32 v250, v250
    v_pk_mul_f32 v[252:253], v[204:205], v[248:249]
    v_lshlrev_b32_sdwa v108, 3, v121 dst_sel:DWORD dst_unused:UNUSED_PAD src0_sel:DWORD src1_sel:WORD_0
    v_lshlrev_b32_sdwa v110, 3, v121 dst_sel:DWORD dst_unused:UNUSED_PAD src0_sel:DWORD src1_sel:WORD_1
    ds_read_b64 v[108:109], v108
    ds_read_b64 v[110:111], v110
    s_waitcnt lgkmcnt(8)
    v_add3_u32 v22, v22, v88, v90
    v_add3_u32 v23, v23, v89, v91
    v_add3_u32 v22, v22, v92, v94
    v_add3_u32 v23, v23, v93, v95
    v_rcp_f32 v251, v251
    v_mad_u32_u16 v188, v148, 1, v188 op_sel:[0,0,0,0]
    v_mad_u32_u16 v189, v148, 1, v189 op_sel:[1,0,0,0]
    v_pk_fma_f32 v[252:253], v[206:207], v[250:251], v[252:253]
    v_mad_u32_u16 v190, v149, 1, v190 op_sel:[0,0,0,0]
    v_add_f32 v252, v252, v253
    v_lshlrev_b32_sdwa v88, 3, v122 dst_sel:DWORD dst_unused:UNUSED_PAD src0_sel:DWORD src1_sel:WORD_0
    v_lshlrev_b32_sdwa v90, 3, v122 dst_sel:DWORD dst_unused:UNUSED_PAD src0_sel:DWORD src1_sel:WORD_1
    ds_read_b64 v[88:89], v88
    ds_read_b64 v[90:91], v90
    v_min_u32 v252, -2, v252
    v_mad_u32_u16 v191, v149, 1, v191 op_sel:[1,0,0,0]
    buffer_store_dword v252, v76, s[12:15], s35 offen offset:2304 sc1
    v_pk_fma_f32 v[188:189], v[188:189], v[222:223], v[66:67]
    v_pk_fma_f32 v[190:191], v[190:191], v[222:223], v[68:69]
    v_lshlrev_b32_sdwa v92, 3, v123 dst_sel:DWORD dst_unused:UNUSED_PAD src0_sel:DWORD src1_sel:WORD_0
    v_lshlrev_b32_sdwa v94, 3, v123 dst_sel:DWORD dst_unused:UNUSED_PAD src0_sel:DWORD src1_sel:WORD_1
    ds_read_b64 v[92:93], v92
    ds_read_b64 v[94:95], v94
    s_waitcnt lgkmcnt(8)
    v_add3_u32 v22, v22, v96, v98
    v_add3_u32 v23, v23, v97, v99
    v_add3_u32 v22, v22, v100, v102
    v_add3_u32 v23, v23, v101, v103
    v_pk_mul_f32 v[224:225], v[188:189], v[188:189]
    v_pk_mul_f32 v[226:227], v[190:191], v[190:191]
    v_pk_fma_f32 v[224:225], v[224:225], v[212:213], v[214:215]
    v_pk_fma_f32 v[226:227], v[226:227], v[212:213], v[214:215]
    v_pk_mul_f32 v[224:225], v[224:225], v[188:189]
    v_pk_mul_f32 v[226:227], v[226:227], v[190:191]
    s_waitcnt vmcnt(12)
    v_lshlrev_b32_sdwa v96, 3, v160 dst_sel:DWORD dst_unused:UNUSED_PAD src0_sel:DWORD src1_sel:WORD_0
    v_lshlrev_b32_sdwa v98, 3, v160 dst_sel:DWORD dst_unused:UNUSED_PAD src0_sel:DWORD src1_sel:WORD_1
    ds_read_b64 v[96:97], v96
    ds_read_b64 v[98:99], v98
    v_exp_f32 v224, v224
    v_exp_f32 v225, v225
    v_exp_f32 v226, v226
    v_exp_f32 v227, v227
    v_pk_fma_f32 v[224:225], v[224:225], v[218:219], v[218:219]
    v_lshlrev_b32_sdwa v100, 3, v161 dst_sel:DWORD dst_unused:UNUSED_PAD src0_sel:DWORD src1_sel:WORD_0
    v_lshlrev_b32_sdwa v102, 3, v161 dst_sel:DWORD dst_unused:UNUSED_PAD src0_sel:DWORD src1_sel:WORD_1
    ds_read_b64 v[100:101], v100
    ds_read_b64 v[102:103], v102
    s_waitcnt lgkmcnt(8)
    v_add3_u32 v22, v22, v104, v106
    v_add3_u32 v23, v23, v105, v107
    v_add3_u32 v22, v22, v108, v110
    v_add3_u32 v23, v23, v109, v111
    v_rcp_f32 v224, v224
    v_pk_fma_f32 v[226:227], v[226:227], v[220:221], v[220:221]
    v_rcp_f32 v225, v225
    v_rcp_f32 v226, v226
    v_rcp_f32 v227, v227
    v_pk_mul_f32 v[228:229], v[188:189], v[224:225]
    v_lshlrev_b32_sdwa v104, 3, v162 dst_sel:DWORD dst_unused:UNUSED_PAD src0_sel:DWORD src1_sel:WORD_0
    v_lshlrev_b32_sdwa v106, 3, v162 dst_sel:DWORD dst_unused:UNUSED_PAD src0_sel:DWORD src1_sel:WORD_1
    ds_read_b64 v[104:105], v104
    ds_read_b64 v[106:107], v106
    v_pk_fma_f32 v[228:229], v[190:191], v[226:227], v[228:229]
    v_lshlrev_b32_sdwa v108, 3, v163 dst_sel:DWORD dst_unused:UNUSED_PAD src0_sel:DWORD src1_sel:WORD_0
    v_lshlrev_b32_sdwa v110, 3, v163 dst_sel:DWORD dst_unused:UNUSED_PAD src0_sel:DWORD src1_sel:WORD_1
    ds_read_b64 v[108:109], v108
    ds_read_b64 v[110:111], v110
    s_waitcnt lgkmcnt(8)
    v_add3_u32 v22, v22, v88, v90
    v_add3_u32 v23, v23, v89, v91
    v_add3_u32 v22, v22, v92, v94
    v_add3_u32 v23, v23, v93, v95
    v_add_f32 v228, v228, v229
    v_mad_u32_u16 v192, v22, 1, s27 op_sel:[0,0,0,0]
    v_min_u32 v228, -2, v228
    v_mad_u32_u16 v193, v22, 1, s27 op_sel:[1,0,0,0]
    buffer_store_dword v228, v76, s[12:15], s35 offen offset:2560 sc1
    v_mad_u32_u16 v194, v23, 1, s27 op_sel:[0,0,0,0]
    s_waitcnt vmcnt(10)
    v_lshlrev_b32_sdwa v88, 3, v164 dst_sel:DWORD dst_unused:UNUSED_PAD src0_sel:DWORD src1_sel:WORD_0
    v_lshlrev_b32_sdwa v90, 3, v164 dst_sel:DWORD dst_unused:UNUSED_PAD src0_sel:DWORD src1_sel:WORD_1
    ds_read_b64 v[88:89], v88
    ds_read_b64 v[90:91], v90
    v_mad_u32_u16 v195, v23, 1, s27 op_sel:[1,0,0,0]
    v_mad_u32_u16 v192, v150, 1, v192 op_sel:[0,0,0,0]
    v_mad_u32_u16 v193, v150, 1, v193 op_sel:[1,0,0,0]
    v_mad_u32_u16 v194, v151, 1, v194 op_sel:[0,0,0,0]
    v_mad_u32_u16 v195, v151, 1, v195 op_sel:[1,0,0,0]
    v_lshlrev_b32_sdwa v92, 3, v165 dst_sel:DWORD dst_unused:UNUSED_PAD src0_sel:DWORD src1_sel:WORD_0
    v_lshlrev_b32_sdwa v94, 3, v165 dst_sel:DWORD dst_unused:UNUSED_PAD src0_sel:DWORD src1_sel:WORD_1
    ds_read_b64 v[92:93], v92
    ds_read_b64 v[94:95], v94
    s_waitcnt lgkmcnt(8)
    v_add3_u32 v24, v24, v96, v98
    v_add3_u32 v25, v25, v97, v99
    v_add3_u32 v24, v24, v100, v102
    v_add3_u32 v25, v25, v101, v103
    s_setprio 1
    v_pk_fma_f32 v[192:193], v[192:193], v[222:223], v[66:67]
    v_pk_fma_f32 v[194:195], v[194:195], v[222:223], v[68:69]
    v_pk_mul_f32 v[230:231], v[192:193], v[192:193]
    v_pk_mul_f32 v[232:233], v[194:195], v[194:195]
    v_pk_fma_f32 v[230:231], v[230:231], v[212:213], v[214:215]
    v_pk_fma_f32 v[232:233], v[232:233], v[212:213], v[214:215]
    v_lshlrev_b32_sdwa v96, 3, v166 dst_sel:DWORD dst_unused:UNUSED_PAD src0_sel:DWORD src1_sel:WORD_0
    v_lshlrev_b32_sdwa v98, 3, v166 dst_sel:DWORD dst_unused:UNUSED_PAD src0_sel:DWORD src1_sel:WORD_1
    ds_read_b64 v[96:97], v96
    ds_read_b64 v[98:99], v98
    v_pk_mul_f32 v[230:231], v[230:231], v[192:193]
    v_pk_mul_f32 v[232:233], v[232:233], v[194:195]
    v_exp_f32 v230, v230
    v_exp_f32 v231, v231
    v_exp_f32 v232, v232
    v_lshlrev_b32_sdwa v100, 3, v167 dst_sel:DWORD dst_unused:UNUSED_PAD src0_sel:DWORD src1_sel:WORD_0
    v_lshlrev_b32_sdwa v102, 3, v167 dst_sel:DWORD dst_unused:UNUSED_PAD src0_sel:DWORD src1_sel:WORD_1
    ds_read_b64 v[100:101], v100
    ds_read_b64 v[102:103], v102
    s_waitcnt lgkmcnt(8)
    v_add3_u32 v24, v24, v104, v106
    v_add3_u32 v25, v25, v105, v107
    v_add3_u32 v24, v24, v108, v110
    v_add3_u32 v25, v25, v109, v111
    v_exp_f32 v233, v233
    v_pk_fma_f32 v[230:231], v[230:231], v[218:219], v[218:219]
    v_mad_u32_u16 v196, v24, 1, s27 op_sel:[0,0,0,0]
    v_rcp_f32 v230, v230
    v_pk_fma_f32 v[232:233], v[232:233], v[220:221], v[220:221]
    v_mad_u32_u16 v197, v24, 1, s27 op_sel:[1,0,0,0]
    s_waitcnt vmcnt(8)
    v_lshlrev_b32_sdwa v104, 3, v168 dst_sel:DWORD dst_unused:UNUSED_PAD src0_sel:DWORD src1_sel:WORD_0
    v_lshlrev_b32_sdwa v106, 3, v168 dst_sel:DWORD dst_unused:UNUSED_PAD src0_sel:DWORD src1_sel:WORD_1
    ds_read_b64 v[104:105], v104
    ds_read_b64 v[106:107], v106
    v_rcp_f32 v231, v231
    v_mad_u32_u16 v198, v25, 1, s27 op_sel:[0,0,0,0]
    v_mad_u32_u16 v199, v25, 1, s27 op_sel:[1,0,0,0]
    v_rcp_f32 v232, v232
    v_pk_mul_f32 v[234:235], v[192:193], v[230:231]
    v_lshlrev_b32_sdwa v108, 3, v169 dst_sel:DWORD dst_unused:UNUSED_PAD src0_sel:DWORD src1_sel:WORD_0
    v_lshlrev_b32_sdwa v110, 3, v169 dst_sel:DWORD dst_unused:UNUSED_PAD src0_sel:DWORD src1_sel:WORD_1
    ds_read_b64 v[108:109], v108
    ds_read_b64 v[110:111], v110
    s_waitcnt lgkmcnt(8)
    v_add3_u32 v26, v26, v88, v90
    v_add3_u32 v27, v27, v89, v91
    v_add3_u32 v26, v26, v92, v94
    v_add3_u32 v27, v27, v93, v95
    v_rcp_f32 v233, v233
    v_mad_u32_u16 v196, v152, 1, v196 op_sel:[0,0,0,0]
    v_mad_u32_u16 v197, v152, 1, v197 op_sel:[1,0,0,0]
    v_pk_fma_f32 v[234:235], v[194:195], v[232:233], v[234:235]
    v_mad_u32_u16 v198, v153, 1, v198 op_sel:[0,0,0,0]
    v_add_f32 v234, v234, v235
    v_lshlrev_b32_sdwa v88, 3, v170 dst_sel:DWORD dst_unused:UNUSED_PAD src0_sel:DWORD src1_sel:WORD_0
    v_lshlrev_b32_sdwa v90, 3, v170 dst_sel:DWORD dst_unused:UNUSED_PAD src0_sel:DWORD src1_sel:WORD_1
    ds_read_b64 v[88:89], v88
    ds_read_b64 v[90:91], v90
    v_min_u32 v234, -2, v234
    v_mad_u32_u16 v199, v153, 1, v199 op_sel:[1,0,0,0]
    buffer_store_dword v234, v76, s[12:15], s35 offen offset:2816 sc1
    v_pk_fma_f32 v[196:197], v[196:197], v[222:223], v[66:67]
    v_pk_fma_f32 v[198:199], v[198:199], v[222:223], v[68:69]
    v_lshlrev_b32_sdwa v92, 3, v171 dst_sel:DWORD dst_unused:UNUSED_PAD src0_sel:DWORD src1_sel:WORD_0
    v_lshlrev_b32_sdwa v94, 3, v171 dst_sel:DWORD dst_unused:UNUSED_PAD src0_sel:DWORD src1_sel:WORD_1
    ds_read_b64 v[92:93], v92
    ds_read_b64 v[94:95], v94
    s_waitcnt lgkmcnt(8)
    v_add3_u32 v26, v26, v96, v98
    v_add3_u32 v27, v27, v97, v99
    v_add3_u32 v26, v26, v100, v102
    v_add3_u32 v27, v27, v101, v103
    v_pk_mul_f32 v[236:237], v[196:197], v[196:197]
    v_pk_mul_f32 v[238:239], v[198:199], v[198:199]
    v_pk_fma_f32 v[236:237], v[236:237], v[212:213], v[214:215]
    v_pk_fma_f32 v[238:239], v[238:239], v[212:213], v[214:215]
    v_pk_mul_f32 v[236:237], v[236:237], v[196:197]
    v_pk_mul_f32 v[238:239], v[238:239], v[198:199]
    s_waitcnt vmcnt(8)
    v_lshlrev_b32_sdwa v96, 3, v172 dst_sel:DWORD dst_unused:UNUSED_PAD src0_sel:DWORD src1_sel:WORD_0
    v_lshlrev_b32_sdwa v98, 3, v172 dst_sel:DWORD dst_unused:UNUSED_PAD src0_sel:DWORD src1_sel:WORD_1
    ds_read_b64 v[96:97], v96
    ds_read_b64 v[98:99], v98
    v_exp_f32 v236, v236
    v_exp_f32 v237, v237
    v_exp_f32 v238, v238
    v_exp_f32 v239, v239
    v_pk_fma_f32 v[236:237], v[236:237], v[218:219], v[218:219]
    v_lshlrev_b32_sdwa v100, 3, v173 dst_sel:DWORD dst_unused:UNUSED_PAD src0_sel:DWORD src1_sel:WORD_0
    v_lshlrev_b32_sdwa v102, 3, v173 dst_sel:DWORD dst_unused:UNUSED_PAD src0_sel:DWORD src1_sel:WORD_1
    ds_read_b64 v[100:101], v100
    ds_read_b64 v[102:103], v102
    s_waitcnt lgkmcnt(8)
    v_add3_u32 v26, v26, v104, v106
    v_add3_u32 v27, v27, v105, v107
    v_add3_u32 v26, v26, v108, v110
    v_add3_u32 v27, v27, v109, v111
    buffer_load_dword v72, v76, s[52:55], 0 offen offset:32 sc1
    buffer_load_short_d16_hi v73, v79, s[56:59], 0 offen
    buffer_load_ushort v81, v78, s[60:63], s68 offen
    buffer_load_dword v82, v79, s[12:15], s69 offen sc1
    v_rcp_f32 v236, v236
    v_pk_fma_f32 v[238:239], v[238:239], v[220:221], v[220:221]
    v_lshlrev_b32_sdwa v104, 3, v174 dst_sel:DWORD dst_unused:UNUSED_PAD src0_sel:DWORD src1_sel:WORD_0
    v_lshlrev_b32_sdwa v106, 3, v174 dst_sel:DWORD dst_unused:UNUSED_PAD src0_sel:DWORD src1_sel:WORD_1
    ds_read_b64 v[104:105], v104
    ds_read_b64 v[106:107], v106
    v_rcp_f32 v237, v237
    v_rcp_f32 v238, v238
    v_rcp_f32 v239, v239
    v_pk_mul_f32 v[240:241], v[196:197], v[236:237]
    v_lshlrev_b32_sdwa v108, 3, v175 dst_sel:DWORD dst_unused:UNUSED_PAD src0_sel:DWORD src1_sel:WORD_0
    v_lshlrev_b32_sdwa v110, 3, v175 dst_sel:DWORD dst_unused:UNUSED_PAD src0_sel:DWORD src1_sel:WORD_1
    ds_read_b64 v[108:109], v108
    ds_read_b64 v[110:111], v110
    s_waitcnt lgkmcnt(8)
    v_add3_u32 v26, v26, v88, v90
    v_add3_u32 v27, v27, v89, v91
    v_add3_u32 v26, v26, v92, v94
    v_add3_u32 v27, v27, v93, v95
    v_pk_fma_f32 v[240:241], v[198:199], v[238:239], v[240:241]
    v_mad_u32_u16 v200, v26, 1, s27 op_sel:[0,0,0,0]
    v_add_f32 v240, v240, v241
    v_mad_u32_u16 v201, v26, 1, s27 op_sel:[1,0,0,0]
    v_min_u32 v240, -2, v240
    v_mad_u32_u16 v202, v27, 1, s27 op_sel:[0,0,0,0]
    s_waitcnt vmcnt(9)
    v_lshlrev_b32_sdwa v88, 3, v32 dst_sel:DWORD dst_unused:UNUSED_PAD src0_sel:DWORD src1_sel:WORD_0
    v_lshlrev_b32_sdwa v90, 3, v32 dst_sel:DWORD dst_unused:UNUSED_PAD src0_sel:DWORD src1_sel:WORD_1
    ds_read_b64 v[88:89], v88
    ds_read_b64 v[90:91], v90
    buffer_store_dword v240, v76, s[12:15], s35 offen offset:3072 sc1
    v_mad_u32_u16 v203, v27, 1, s27 op_sel:[1,0,0,0]
    v_mad_u32_u16 v200, v154, 1, v200 op_sel:[0,0,0,0]
    v_mad_u32_u16 v201, v154, 1, v201 op_sel:[1,0,0,0]
    v_mad_u32_u16 v202, v155, 1, v202 op_sel:[0,0,0,0]
    v_lshlrev_b32_sdwa v92, 3, v33 dst_sel:DWORD dst_unused:UNUSED_PAD src0_sel:DWORD src1_sel:WORD_0
    v_lshlrev_b32_sdwa v94, 3, v33 dst_sel:DWORD dst_unused:UNUSED_PAD src0_sel:DWORD src1_sel:WORD_1
    ds_read_b64 v[92:93], v92
    ds_read_b64 v[94:95], v94
    s_waitcnt lgkmcnt(8)
    v_add3_u32 v28, v28, v96, v98
    v_add3_u32 v29, v29, v97, v99
    v_add3_u32 v28, v28, v100, v102
    v_add3_u32 v29, v29, v101, v103
    v_mad_u32_u16 v203, v155, 1, v203 op_sel:[1,0,0,0]
    v_pk_fma_f32 v[200:201], v[200:201], v[222:223], v[66:67]
    v_pk_fma_f32 v[202:203], v[202:203], v[222:223], v[68:69]
    v_pk_mul_f32 v[242:243], v[200:201], v[200:201]
    v_pk_mul_f32 v[244:245], v[202:203], v[202:203]
    v_pk_fma_f32 v[242:243], v[242:243], v[212:213], v[214:215]
    v_lshlrev_b32_sdwa v96, 3, v34 dst_sel:DWORD dst_unused:UNUSED_PAD src0_sel:DWORD src1_sel:WORD_0
    v_lshlrev_b32_sdwa v98, 3, v34 dst_sel:DWORD dst_unused:UNUSED_PAD src0_sel:DWORD src1_sel:WORD_1
    ds_read_b64 v[96:97], v96
    ds_read_b64 v[98:99], v98
    v_pk_mul_f32 v[242:243], v[242:243], v[200:201]
    v_pk_fma_f32 v[244:245], v[244:245], v[212:213], v[214:215]
    v_exp_f32 v242, v242
    v_pk_mul_f32 v[244:245], v[244:245], v[202:203]
    v_exp_f32 v243, v243
    v_lshlrev_b32_sdwa v100, 3, v35 dst_sel:DWORD dst_unused:UNUSED_PAD src0_sel:DWORD src1_sel:WORD_0
    v_lshlrev_b32_sdwa v102, 3, v35 dst_sel:DWORD dst_unused:UNUSED_PAD src0_sel:DWORD src1_sel:WORD_1
    ds_read_b64 v[100:101], v100
    ds_read_b64 v[102:103], v102
    s_waitcnt lgkmcnt(8)
    v_add3_u32 v28, v28, v104, v106
    v_add3_u32 v29, v29, v105, v107
    v_add3_u32 v28, v28, v108, v110
    v_add3_u32 v29, v29, v109, v111
    v_exp_f32 v244, v244
    v_pk_fma_f32 v[242:243], v[242:243], v[218:219], v[218:219]
    v_mad_u32_u16 v204, v28, 1, s27 op_sel:[0,0,0,0]
    v_rcp_f32 v242, v242
    v_mad_u32_u16 v205, v28, 1, s27 op_sel:[1,0,0,0]
    v_mad_u32_u16 v206, v29, 1, s27 op_sel:[0,0,0,0]
    s_waitcnt vmcnt(8)
    v_lshlrev_b32_sdwa v104, 3, v40 dst_sel:DWORD dst_unused:UNUSED_PAD src0_sel:DWORD src1_sel:WORD_0
    v_lshlrev_b32_sdwa v106, 3, v40 dst_sel:DWORD dst_unused:UNUSED_PAD src0_sel:DWORD src1_sel:WORD_1
    ds_read_b64 v[104:105], v104
    ds_read_b64 v[106:107], v106
    v_rcp_f32 v243, v243
    v_mad_u32_u16 v207, v29, 1, s27 op_sel:[1,0,0,0]
    v_mad_u32_u16 v204, v156, 1, v204 op_sel:[0,0,0,0]
    v_exp_f32 v245, v245
    v_pk_mul_f32 v[246:247], v[200:201], v[242:243]
    v_lshlrev_b32_sdwa v108, 3, v41 dst_sel:DWORD dst_unused:UNUSED_PAD src0_sel:DWORD src1_sel:WORD_0
    v_lshlrev_b32_sdwa v110, 3, v41 dst_sel:DWORD dst_unused:UNUSED_PAD src0_sel:DWORD src1_sel:WORD_1
    ds_read_b64 v[108:109], v108
    ds_read_b64 v[110:111], v110
    s_waitcnt lgkmcnt(8)
    v_add3_u32 v30, v30, v88, v90
    v_add3_u32 v31, v31, v89, v91
    v_add3_u32 v30, v30, v92, v94
    v_add3_u32 v31, v31, v93, v95
    s_setprio 0
    v_pk_fma_f32 v[244:245], v[244:245], v[220:221], v[220:221]
    v_mad_u32_u16 v205, v156, 1, v205 op_sel:[1,0,0,0]
    v_rcp_f32 v244, v244
    v_mad_u32_u16 v206, v157, 1, v206 op_sel:[0,0,0,0]
    v_mad_u32_u16 v207, v157, 1, v207 op_sel:[1,0,0,0]
    v_rcp_f32 v245, v245
    v_lshlrev_b32_sdwa v88, 3, v42 dst_sel:DWORD dst_unused:UNUSED_PAD src0_sel:DWORD src1_sel:WORD_0
    v_lshlrev_b32_sdwa v90, 3, v42 dst_sel:DWORD dst_unused:UNUSED_PAD src0_sel:DWORD src1_sel:WORD_1
    ds_read_b64 v[88:89], v88
    ds_read_b64 v[90:91], v90
    v_pk_fma_f32 v[246:247], v[202:203], v[244:245], v[246:247]
    v_pk_fma_f32 v[204:205], v[204:205], v[222:223], v[66:67]
    v_add_f32 v246, v246, v247
    v_pk_fma_f32 v[206:207], v[206:207], v[222:223], v[68:69]
    v_min_u32 v246, -2, v246
    v_lshlrev_b32_sdwa v92, 3, v43 dst_sel:DWORD dst_unused:UNUSED_PAD src0_sel:DWORD src1_sel:WORD_0
    v_lshlrev_b32_sdwa v94, 3, v43 dst_sel:DWORD dst_unused:UNUSED_PAD src0_sel:DWORD src1_sel:WORD_1
    ds_read_b64 v[92:93], v92
    ds_read_b64 v[94:95], v94
    s_waitcnt lgkmcnt(8)
    v_add3_u32 v30, v30, v96, v98
    v_add3_u32 v31, v31, v97, v99
    v_add3_u32 v30, v30, v100, v102
    v_add3_u32 v31, v31, v101, v103
    buffer_store_dword v246, v76, s[12:15], s35 offen offset:3328 sc1
    v_pk_mul_f32 v[248:249], v[204:205], v[204:205]
    v_pk_mul_f32 v[250:251], v[206:207], v[206:207]
    v_pk_fma_f32 v[248:249], v[248:249], v[212:213], v[214:215]
    v_pk_fma_f32 v[250:251], v[250:251], v[212:213], v[214:215]
    v_pk_mul_f32 v[248:249], v[248:249], v[204:205]
    v_pk_mul_f32 v[250:251], v[250:251], v[206:207]
    v_exp_f32 v248, v248
    v_exp_f32 v249, v249
    v_exp_f32 v250, v250
    v_exp_f32 v251, v251
    s_waitcnt lgkmcnt(4)
    v_add3_u32 v30, v30, v104, v106
    v_add3_u32 v31, v31, v105, v107
    v_add3_u32 v30, v30, v108, v110
    v_add3_u32 v31, v31, v109, v111
    v_pk_fma_f32 v[248:249], v[248:249], v[218:219], v[218:219]
    v_pk_fma_f32 v[250:251], v[250:251], v[220:221], v[220:221]
    v_rcp_f32 v248, v248
    v_rcp_f32 v249, v249
    v_rcp_f32 v250, v250
    v_rcp_f32 v251, v251
    v_pk_mul_f32 v[252:253], v[204:205], v[248:249]
    s_waitcnt lgkmcnt(0)
    v_add3_u32 v30, v30, v88, v90
    v_add3_u32 v31, v31, v89, v91
    v_add3_u32 v30, v30, v92, v94
    v_add3_u32 v31, v31, v93, v95
    v_pk_fma_f32 v[252:253], v[206:207], v[250:251], v[252:253]
    v_mad_u32_u16 v188, v30, 1, s27 op_sel:[0,0,0,0]
    v_add_f32 v252, v252, v253
    v_mad_u32_u16 v189, v30, 1, s27 op_sel:[1,0,0,0]
    v_min_u32 v252, -2, v252
    v_mad_u32_u16 v190, v31, 1, s27 op_sel:[0,0,0,0]
    buffer_store_dword v252, v76, s[12:15], s35 offen offset:3584 sc1
    v_mad_u32_u16 v191, v31, 1, s27 op_sel:[1,0,0,0]
    v_mad_u32_u16 v188, v158, 1, v188 op_sel:[0,0,0,0]
    v_mad_u32_u16 v189, v158, 1, v189 op_sel:[1,0,0,0]
    v_mad_u32_u16 v190, v159, 1, v190 op_sel:[0,0,0,0]
    v_mad_u32_u16 v191, v159, 1, v191 op_sel:[1,0,0,0]
    v_pk_fma_f32 v[188:189], v[188:189], v[222:223], v[66:67]
    v_pk_fma_f32 v[190:191], v[190:191], v[222:223], v[68:69]
    v_pk_mul_f32 v[224:225], v[188:189], v[188:189]
    v_pk_mul_f32 v[226:227], v[190:191], v[190:191]
    v_pk_fma_f32 v[224:225], v[224:225], v[212:213], v[214:215]
    v_pk_fma_f32 v[226:227], v[226:227], v[212:213], v[214:215]
    v_pk_mul_f32 v[224:225], v[224:225], v[188:189]
    v_pk_mul_f32 v[226:227], v[226:227], v[190:191]
    v_exp_f32 v224, v224
    v_exp_f32 v225, v225
    v_exp_f32 v226, v226
    v_exp_f32 v227, v227
    v_pk_fma_f32 v[224:225], v[224:225], v[218:219], v[218:219]
    s_nop 0
    v_rcp_f32 v224, v224
    v_pk_fma_f32 v[226:227], v[226:227], v[220:221], v[220:221]
    v_rcp_f32 v225, v225
    v_rcp_f32 v226, v226
    v_rcp_f32 v227, v227
    v_pk_mul_f32 v[228:229], v[188:189], v[224:225]
    s_nop 0
    v_pk_fma_f32 v[228:229], v[190:191], v[226:227], v[228:229]
    s_nop 0
    v_add_f32 v228, v228, v229
    s_nop 0
    v_min_u32 v228, -2, v228
    s_nop 0
    buffer_store_dword v228, v76, s[12:15], s35 offen offset:3840 sc1
    s_waitcnt vmcnt(4)

    v_cmp_ne_u32 vcc, 128, v72
    s_and_b32 s44, vcc_hi, 0x1
    s_and_b32 s45, vcc_lo, 0x1
    s_or_b32 s45, s45, s44
    s_cbranch_scc1 k1_kernel_rslow

k1_kernel_rjob:

    s_lshl_b32 s67, s64, 8
    s_add_u32 s68, s67, 29360128
    s_add_u32 s69, s68, 65536
    s_add_u32 s67, s67, 20971520

k1_kernel_rgrp:

    s_add_u32 s70, s67, s65
    s_add_u32 s71, s70, 262144
    s_add_u32 s72, s70, 524288
    s_add_u32 s73, s70, 786432
    s_add_u32 s65, s65, 1048576

    buffer_load_dwordx4 v[0:3], v74, s[12:15], s70 offen sc1
    buffer_load_dwordx4 v[4:7], v74, s[12:15], s71 offen sc1
    buffer_load_dwordx4 v[8:11], v74, s[12:15], s72 offen sc1
    buffer_load_dwordx4 v[12:15], v74, s[12:15], s73 offen sc1
    buffer_load_dword v16, v75, s[12:15], s68 offen sc1
    buffer_load_dword v17, v75, s[12:15], s69 offen sc1
    s_branch k1_kernel_rchk
k1_kernel_rpoll:
    s_mov_b64 exec, s[74:75]
    s_cbranch_execz k1_kernel_rsk0
    buffer_load_dwordx4 v[0:3], v74, s[12:15], s70 offen sc1
k1_kernel_rsk0:
    s_mov_b64 exec, s[76:77]
    s_cbranch_execz k1_kernel_rsk1
    buffer_load_dwordx4 v[4:7], v74, s[12:15], s71 offen sc1
k1_kernel_rsk1:
    s_mov_b64 exec, s[78:79]
    s_cbranch_execz k1_kernel_rsk2
    buffer_load_dwordx4 v[8:11], v74, s[12:15], s72 offen sc1
k1_kernel_rsk2:
    s_mov_b64 exec, s[80:81]
    s_cbranch_execz k1_kernel_rsk3
    buffer_load_dwordx4 v[12:15], v74, s[12:15], s73 offen sc1
k1_kernel_rsk3:
    s_mov_b64 exec, -1
k1_kernel_rchk:
    s_waitcnt vmcnt(0)
k1_kernel_rchk0:
    v_max3_u32 v20, v0, v1, v2
    v_max3_u32 v21, v4, v5, v6
    v_max3_u32 v22, v8, v9, v10
    v_max3_u32 v23, v12, v13, v14
    v_max_u32 v20, v20, v3
    v_max_u32 v21, v21, v7
    v_max_u32 v22, v22, v11
    v_max_u32 v23, v23, v15
    v_cmp_eq_u32 s[74:75], -1, v20
    v_cmp_eq_u32 s[76:77], -1, v21
    v_cmp_eq_u32 s[78:79], -1, v22
    v_cmp_eq_u32 s[80:81], -1, v23

    v_pk_add_f32 v[26:27], v[0:1], v[4:5]
    v_pk_add_f32 v[28:29], v[2:3], v[6:7]
    v_pk_add_f32 v[30:31], v[8:9], v[12:13]
    v_pk_add_f32 v[32:33], v[10:11], v[14:15]
    s_or_b64 s[82:83], s[74:75], s[76:77]
    s_or_b64 s[84:85], s[78:79], s[80:81]
    v_pk_add_f32 v[26:27], v[26:27], v[30:31]
    v_pk_add_f32 v[28:29], v[28:29], v[32:33]
    s_or_b64 s[82:83], s[82:83], s[84:85]
    s_cbranch_scc1 k1_kernel_rpoll
    v_permlane32_swap_b32 v26, v28
    v_permlane32_swap_b32 v27, v29
    s_cmp_lt_u32 s65, s66
    s_nop 0
    v_pk_add_f32 v[26:27], v[26:27], v[28:29]
    s_nop 1
    v_permlane16_swap_b32 v26, v27
    s_nop 1
    v_add_f32 v26, v26, v27
    v_add_f32 v79, v79, v26
    s_cbranch_scc1 k1_kernel_rgrp
    s_cmp_lg_u32 s43, 0
    s_cbranch_scc1 k1_kernel_rpn
    ds_write_b32 v77, v79
    v_add_u32 v21, 0x10000, v77
    s_cmp_lg_u32 s3, 0
    s_waitcnt lgkmcnt(0)
    s_barrier
    s_cbranch_scc1 k1_kernel_rend

    ds_read2st64_b32 v[40:41], v77 offset0:0 offset1:64
    ds_read2st64_b32 v[42:43], v77 offset0:128 offset1:192
    ds_read2st64_b32 v[44:45], v21 offset0:0 offset1:64
    ds_read2st64_b32 v[46:47], v21 offset0:128 offset1:192

    s_waitcnt lgkmcnt(2)
    v_pk_add_f32 v[26:27], v[40:41], v[42:43]
    v_max3_u32 v20, v41, v42, v43
    s_waitcnt lgkmcnt(0)
    v_pk_add_f32 v[28:29], v[44:45], v[46:47]
    v_max3_u32 v20, v20, v44, v45
    v_pk_add_f32 v[26:27], v[26:27], v[28:29]
    v_max3_u32 v20, v20, v46, v47
    v_add_f32 v79, v26, v27
    v_cmp_eq_u32 vcc, -1, v20
    s_cbranch_vccnz k1_kernel_rnext

k1_kernel_rpn:

    v_max_u32 v20, v16, v17
    v_add_f32 v21, v16, v17
    v_cmp_eq_u32 vcc, -1, v20
    v_cvt_pk_bf16_f32 v21, v79, v21
    s_cbranch_vccnz k1_kernel_rpn2
    v_lshlrev_b32 v22, 16, v21
    v_and_b32 v21, 0xffff0000, v21
    v_add_f32 v22, v22, v73
    v_cvt_pk_bf16_f32 v22, v22, v22
    v_lshlrev_b32 v22, 16, v22
    v_add_f32 v22, v22, v21
    s_lshl_b32 s45, s64, 7
    v_cvt_pk_bf16_f32 v22, v22, v22
    buffer_store_short v22, v78, s[60:63], s45 offen

k1_kernel_rnext:

    v_cmp_ne_u32 vcc, 0, v72
    s_and_b32 s45, vcc_lo, 0xff00
    s_cbranch_scc1 k1_kernel_rmore

k1_kernel_rend:
    s_endpgm
k1_kernel_rpn2:
    buffer_load_dword v16, v75, s[12:15], s68 offen sc1
    buffer_load_dword v17, v75, s[12:15], s69 offen sc1
    s_waitcnt vmcnt(0)
    s_branch k1_kernel_rpn
k1_kernel_rmore:

    s_ff1_i32_b32 s45, s45
    s_mov_b32 s43, 1
    s_mov_b32 s65, 0
    s_mov_b32 s66, 8388608
    v_readlane_b32 s44, v72, s45
    v_mov_b32 v79, 0
    s_mov_b32 m0, s45
    s_ff1_i32_b32 s64, s44
    s_bitset0_b32 s44, s64
    s_sub_u32 s45, s45, 8
    s_lshl_b32 s45, s45, 5
    s_add_u32 s64, s64, s45
    v_writelane_b32 v72, s44, m0
    s_branch k1_kernel_rjob

k1_kernel_rslow:
    s_lshl_b32 s65, s3, 20
    buffer_load_dword v72, v76, s[52:55], 0 offen offset:32 sc1
    s_waitcnt vmcnt(0)

    v_cmp_ne_u32 vcc, 128, v72
    s_and_b32 s44, vcc_hi, 0x1
    s_and_b32 s45, vcc_lo, 0x1
    s_or_b32 s45, s45, s44
    s_cbranch_scc0 k1_kernel_rjob

    s_add_u32 s42, s42, 1
    s_cmp_lt_u32 s42, 200
    s_cbranch_scc1 k1_kernel_rslow
    s_lshl_b32 s44, 1, s64
    s_lshr_b32 s45, s64, 5
    s_lshl_b32 s45, s45, 2
    v_mov_b32 v20, s44
    s_mov_b64 exec, 1
    buffer_atomic_or v20, v76, s[52:55], s45 offen offset:64 sc0
    s_mov_b64 exec, -1
    s_waitcnt vmcnt(0)
    buffer_load_dword v72, v76, s[52:55], 0 offen offset:32 sc1
    s_waitcnt vmcnt(0)

    v_cmp_ne_u32 vcc, 128, v72
    s_and_b32 s44, vcc_hi, 0x1
    s_and_b32 s45, vcc_lo, 0x1
    s_or_b32 s45, s45, s44
    s_cbranch_scc0 k1_kernel_rjob

    v_mov_b32 v20, -1
    ds_write_b32 v77, v20
    s_waitcnt lgkmcnt(0)
    s_endpgm

k1_kernel_xw0:

    buffer_load_dword v65, off, s[12:15], s47 sc1
    s_waitcnt vmcnt(0)
    v_readfirstlane_b32 s44, v65
    s_cmp_le_u32 s44, 0
    s_cbranch_scc1 k1_kernel_xw0
    s_branch k1_kernel_xb0

k1_kernel_xw1:

    buffer_load_dword v65, off, s[12:15], s47 sc1
    s_waitcnt vmcnt(0)
    v_readfirstlane_b32 s44, v65
    s_cmp_le_u32 s44, 1
    s_cbranch_scc1 k1_kernel_xw1
    s_branch k1_kernel_xb1

k1_kernel_scr0:
    s_sleep 8
    v_bfe_u32 v84, v71, 2, 7
    s_mov_b32 s35, 15466496
    buffer_load_dwordx4 v[72:75], v71, s[12:15], s35 offen offset:0 sc1
    buffer_load_dwordx4 v[76:79], v71, s[12:15], s35 offen offset:1024 sc1
    buffer_load_dwordx4 v[80:83], v71, s[12:15], s35 offen offset:2048 sc1
    buffer_load_dword v84, v84, s[12:15], s35 offen offset:3584 sc1
    s_waitcnt vmcnt(0)
    s_branch k1_kernel_scb0

k1_kernel_solo1:
    s_mov_b32 s48, 1
    s_add_u32 s16, s16, 33554432
    s_add_u32 s46, s46, 33554432
    s_mov_b32 s18, s16
    s_mov_b32 s47, s46
    s_xor_b32 s49, s34, 1
    s_branch k1_kernel_solo3
k1_kernel_solo2:
    s_mov_b32 s48, 2
    s_waitcnt vmcnt(0)
    v_mov_b32 v0, 2
    buffer_store_dword v0, off, s[12:15], s46 sc1

    s_lshl_b32 s16, s2, 3
    s_add_u32 s16, s16, s3
    s_lshl_b32 s46, s16, 7
    s_mul_i32 s16, s16, 8448
    s_add_u32 s46, s46, 30408704
    s_add_u32 s16, s16, 67108864

    s_mov_b32 s49, s34
k1_kernel_solo3:
    s_load_dwordx2 s[4:5], s[0:1], 8
    s_mov_b32 s6, 256000
    s_mov_b32 s7, 0x00020000

    s_mul_i32 s21, s33, 102656
    s_mul_i32 s35, s49, 49152
    s_sub_u32 s22, 53248, s35
    s_add_u32 s21, s21, s35
    s_lshl_b32 s35, s50, 11
    s_xor_b32 s19, s35, 2048
    s_add_u32 s19, s19, s21
    s_add_u32 s21, s21, s35
    s_mul_i32 s20, s49, 1703936
    s_add_u32 s20, s20, 16777216
    s_lshl_b32 s35, s3, 14
    s_add_u32 s20, s20, s35

    s_waitcnt vmcnt(0) lgkmcnt(0)
    s_and_b32 s5, s5, 0xffff
    s_barrier
    v_bfe_u32 v1, v71, 4, 4
    v_lshrrev_b32 v2, 8, v71
    v_lshlrev_b32 v65, 8, v1
    v_lshl_add_u32 v65, v2, 4, v65
    v_and_b32 v70, 0x7fff, v70
    v_mov_b32 v64, v70
    s_add_u32 s44, s26, 0x7c00080
    v_mov_b32 v66, s44
    v_mov_b32 v67, s44
    v_mov_b32 v68, s44
    v_mov_b32 v69, s44
    s_lshl_b32 s44, s3, 15
    s_lshl_b32 s45, s50, 7
    s_add_u32 s44, s44, s45
    s_xor_b32 s45, s44, 128

    buffer_load_dwordx4 v[128:131], v65, s[4:7], s44 offen offset:0
    buffer_load_dwordx4 v[132:135], v65, s[4:7], s44 offen offset:64
    buffer_load_dwordx4 v[136:139], v65, s[4:7], s45 offen offset:0
    buffer_load_dwordx4 v[140:143], v65, s[4:7], s45 offen offset:64
    s_add_u32 s44, s44, 4096
    s_add_u32 s45, s45, 4096
    buffer_load_dwordx4 v[144:147], v65, s[4:7], s44 offen offset:0
    buffer_load_dwordx4 v[148:151], v65, s[4:7], s44 offen offset:64
    buffer_load_dwordx4 v[152:155], v65, s[4:7], s45 offen offset:0
    buffer_load_dwordx4 v[156:159], v65, s[4:7], s45 offen offset:64
    s_add_u32 s44, s44, 4096
    s_add_u32 s45, s45, 4096
    buffer_load_dwordx4 v[160:163], v65, s[4:7], s44 offen offset:0
    buffer_load_dwordx4 v[164:167], v65, s[4:7], s44 offen offset:64
    buffer_load_dwordx4 v[168:171], v65, s[4:7], s45 offen offset:0
    buffer_load_dwordx4 v[172:175], v65, s[4:7], s45 offen offset:64
    s_add_u32 s44, s44, 4096
    s_add_u32 s45, s45, 4096
    buffer_load_dwordx4 v[176:179], v65, s[4:7], s44 offen offset:0
    buffer_load_dwordx4 v[180:183], v65, s[4:7], s44 offen offset:64
    buffer_load_dwordx4 v[184:187], v65, s[4:7], s45 offen offset:0
    buffer_load_dwordx4 v[188:191], v65, s[4:7], s45 offen offset:64
    s_add_u32 s44, s44, 4096
    s_add_u32 s45, s45, 4096
    buffer_load_dwordx4 v[192:195], v65, s[4:7], s44 offen offset:0
    buffer_load_dwordx4 v[196:199], v65, s[4:7], s44 offen offset:64
    buffer_load_dwordx4 v[200:203], v65, s[4:7], s45 offen offset:0
    buffer_load_dwordx4 v[204:207], v65, s[4:7], s45 offen offset:64
    s_add_u32 s44, s44, 4096
    s_add_u32 s45, s45, 4096
    buffer_load_dwordx4 v[208:211], v65, s[4:7], s44 offen offset:0
    buffer_load_dwordx4 v[212:215], v65, s[4:7], s44 offen offset:64
    buffer_load_dwordx4 v[216:219], v65, s[4:7], s45 offen offset:0
    buffer_load_dwordx4 v[220:223], v65, s[4:7], s45 offen offset:64
    s_add_u32 s44, s44, 4096
    s_add_u32 s45, s45, 4096
    buffer_load_dwordx4 v[224:227], v65, s[4:7], s44 offen offset:0
    buffer_load_dwordx4 v[228:231], v65, s[4:7], s44 offen offset:64
    buffer_load_dwordx4 v[232:235], v65, s[4:7], s45 offen offset:0
    buffer_load_dwordx4 v[236:239], v65, s[4:7], s45 offen offset:64
    s_add_u32 s44, s44, 4096
    s_add_u32 s45, s45, 4096
    buffer_load_dwordx4 v[240:243], v65, s[4:7], s44 offen offset:0
    buffer_load_dwordx4 v[244:247], v65, s[4:7], s44 offen offset:64
    buffer_load_dwordx4 v[248:251], v65, s[4:7], s45 offen offset:0
    buffer_load_dwordx4 v[252:255], v65, s[4:7], s45 offen offset:64
    s_add_u32 s44, s44, 4096
    s_add_u32 s45, s45, 4096
    buffer_load_dwordx4 v[0:3], v71, s[12:15], s21 offen offset:0
    buffer_load_dwordx4 v[4:7], v71, s[12:15], s21 offen offset:1024
    buffer_load_dwordx4 v[8:11], v71, s[12:15], s19 offen offset:0
    buffer_load_dwordx4 v[12:15], v71, s[12:15], s19 offen offset:1024
    s_add_u32 s21, s21, 4096
    s_add_u32 s19, s19, 4096
    buffer_load_dwordx4 v[16:19], v71, s[12:15], s21 offen offset:0
    buffer_load_dwordx4 v[20:23], v71, s[12:15], s21 offen offset:1024
    buffer_load_dwordx4 v[24:27], v71, s[12:15], s19 offen offset:0
    buffer_load_dwordx4 v[28:31], v71, s[12:15], s19 offen offset:1024
    s_add_u32 s21, s21, 4096
    s_add_u32 s19, s19, 4096
    buffer_load_dwordx4 v[32:35], v71, s[12:15], s21 offen offset:0
    buffer_load_dwordx4 v[36:39], v71, s[12:15], s21 offen offset:1024
    buffer_load_dwordx4 v[40:43], v71, s[12:15], s19 offen offset:0
    buffer_load_dwordx4 v[44:47], v71, s[12:15], s19 offen offset:1024
    s_add_u32 s21, s21, 4096
    s_add_u32 s19, s19, 4096
    buffer_load_dwordx4 v[72:75], v71, s[12:15], s21 offen offset:0
    buffer_load_dwordx4 v[76:79], v71, s[12:15], s21 offen offset:1024
    buffer_load_dwordx4 v[80:83], v71, s[12:15], s19 offen offset:0
    buffer_load_dwordx4 v[84:87], v71, s[12:15], s19 offen offset:1024
    s_add_u32 s21, s21, 4096
    s_add_u32 s19, s19, 4096
    buffer_load_dwordx2 v[116:117], v71, s[12:15], s20 offen offset:0 sc1
    buffer_load_dwordx2 v[118:119], v71, s[12:15], s20 offen offset:1024 sc1
    buffer_load_dwordx2 v[120:121], v71, s[12:15], s20 offen offset:2048 sc1
    buffer_load_dwordx2 v[122:123], v71, s[12:15], s20 offen offset:3072 sc1
    s_add_u32 s20, s20, 4096
    buffer_load_dwordx2 v[124:125], v71, s[12:15], s20 offen offset:0 sc1
    buffer_load_dwordx2 v[126:127], v71, s[12:15], s20 offen offset:1024 sc1
    s_waitcnt vmcnt(0)
    v_mfma_f32_16x16x32_bf16 v[96:99], v[0:3], v[128:131], v[66:69]
    v_mfma_f32_16x16x32_bf16 v[100:103], v[0:3], v[144:147], v[66:69]
    v_mfma_f32_16x16x32_bf16 v[96:99], v[4:7], v[132:135], v[96:99]
    v_mfma_f32_16x16x32_bf16 v[100:103], v[4:7], v[148:151], v[100:103]
    v_mfma_f32_16x16x32_bf16 v[96:99], v[8:11], v[136:139], v[96:99]
    v_mfma_f32_16x16x32_bf16 v[100:103], v[8:11], v[152:155], v[100:103]
    v_mfma_f32_16x16x32_bf16 v[96:99], v[12:15], v[140:143], v[96:99]
    v_mfma_f32_16x16x32_bf16 v[100:103], v[12:15], v[156:159], v[100:103]
    v_mfma_f32_16x16x32_bf16 v[104:107], v[0:3], v[160:163], v[66:69]
    v_mfma_f32_16x16x32_bf16 v[108:111], v[0:3], v[176:179], v[66:69]
    v_mfma_f32_16x16x32_bf16 v[104:107], v[4:7], v[164:167], v[104:107]
    v_perm_b32 v96, v97, v96, s23
    v_mfma_f32_16x16x32_bf16 v[108:111], v[4:7], v[180:183], v[108:111]
    v_perm_b32 v97, v99, v98, s23
    v_mfma_f32_16x16x32_bf16 v[104:107], v[8:11], v[168:171], v[104:107]
    ds_write_b64 v64, v[96:97] offset:0
    v_mfma_f32_16x16x32_bf16 v[108:111], v[8:11], v[184:187], v[108:111]
    v_perm_b32 v100, v101, v100, s23
    v_mfma_f32_16x16x32_bf16 v[104:107], v[12:15], v[172:175], v[104:107]
    v_perm_b32 v101, v103, v102, s23
    v_mfma_f32_16x16x32_bf16 v[108:111], v[12:15], v[188:191], v[108:111]
    ds_write_b64 v64, v[100:101] offset:128
    v_mfma_f32_16x16x32_bf16 v[88:91], v[0:3], v[192:195], v[66:69]
    v_mfma_f32_16x16x32_bf16 v[92:95], v[0:3], v[208:211], v[66:69]
    v_mfma_f32_16x16x32_bf16 v[88:91], v[4:7], v[196:199], v[88:91]
    v_perm_b32 v104, v105, v104, s23
    v_mfma_f32_16x16x32_bf16 v[92:95], v[4:7], v[212:215], v[92:95]
    v_perm_b32 v105, v107, v106, s23
    v_mfma_f32_16x16x32_bf16 v[88:91], v[8:11], v[200:203], v[88:91]
    ds_write_b64 v64, v[104:105] offset:256
    v_mfma_f32_16x16x32_bf16 v[92:95], v[8:11], v[216:219], v[92:95]
    v_perm_b32 v108, v109, v108, s23
    v_mfma_f32_16x16x32_bf16 v[88:91], v[12:15], v[204:207], v[88:91]
    v_perm_b32 v109, v111, v110, s23
    v_mfma_f32_16x16x32_bf16 v[92:95], v[12:15], v[220:223], v[92:95]
    ds_write_b64 v64, v[108:109] offset:384
    v_mfma_f32_16x16x32_bf16 v[96:99], v[0:3], v[224:227], v[66:69]
    v_mfma_f32_16x16x32_bf16 v[100:103], v[0:3], v[240:243], v[66:69]
    v_mfma_f32_16x16x32_bf16 v[96:99], v[4:7], v[228:231], v[96:99]
    v_perm_b32 v88, v89, v88, s23
    v_mfma_f32_16x16x32_bf16 v[100:103], v[4:7], v[244:247], v[100:103]
    v_perm_b32 v89, v91, v90, s23
    v_mfma_f32_16x16x32_bf16 v[96:99], v[8:11], v[232:235], v[96:99]
    ds_write_b64 v64, v[88:89] offset:512
    v_mfma_f32_16x16x32_bf16 v[100:103], v[8:11], v[248:251], v[100:103]
    v_perm_b32 v92, v93, v92, s23
    v_mfma_f32_16x16x32_bf16 v[96:99], v[12:15], v[236:239], v[96:99]
    v_perm_b32 v93, v95, v94, s23
    v_mfma_f32_16x16x32_bf16 v[100:103], v[12:15], v[252:255], v[100:103]
    ds_write_b64 v64, v[92:93] offset:640
    s_nop 7
    v_perm_b32 v96, v97, v96, s23
    v_perm_b32 v97, v99, v98, s23
    ds_write_b64 v64, v[96:97] offset:768
    v_perm_b32 v100, v101, v100, s23
    v_perm_b32 v101, v103, v102, s23
    ds_write_b64 v64, v[100:101] offset:896
    v_add_u32 v64, 0x8000, v64
    v_mfma_f32_16x16x32_bf16 v[104:107], v[16:19], v[128:131], v[66:69]
    v_mfma_f32_16x16x32_bf16 v[108:111], v[16:19], v[144:147], v[66:69]
    v_mfma_f32_16x16x32_bf16 v[104:107], v[20:23], v[132:135], v[104:107]
    v_mfma_f32_16x16x32_bf16 v[108:111], v[20:23], v[148:151], v[108:111]
    v_mfma_f32_16x16x32_bf16 v[104:107], v[24:27], v[136:139], v[104:107]
    v_mfma_f32_16x16x32_bf16 v[108:111], v[24:27], v[152:155], v[108:111]
    v_mfma_f32_16x16x32_bf16 v[104:107], v[28:31], v[140:143], v[104:107]
    v_mfma_f32_16x16x32_bf16 v[108:111], v[28:31], v[156:159], v[108:111]
    v_mfma_f32_16x16x32_bf16 v[88:91], v[16:19], v[160:163], v[66:69]
    v_mfma_f32_16x16x32_bf16 v[92:95], v[16:19], v[176:179], v[66:69]
    v_mfma_f32_16x16x32_bf16 v[88:91], v[20:23], v[164:167], v[88:91]
    v_perm_b32 v104, v105, v104, s23
    v_mfma_f32_16x16x32_bf16 v[92:95], v[20:23], v[180:183], v[92:95]
    v_perm_b32 v105, v107, v106, s23
    v_mfma_f32_16x16x32_bf16 v[88:91], v[24:27], v[168:171], v[88:91]
    ds_write_b64 v64, v[104:105] offset:0
    v_mfma_f32_16x16x32_bf16 v[92:95], v[24:27], v[184:187], v[92:95]
    v_perm_b32 v108, v109, v108, s23
    v_mfma_f32_16x16x32_bf16 v[88:91], v[28:31], v[172:175], v[88:91]
    v_perm_b32 v109, v111, v110, s23
    v_mfma_f32_16x16x32_bf16 v[92:95], v[28:31], v[188:191], v[92:95]
    ds_write_b64 v64, v[108:109] offset:128
    v_mfma_f32_16x16x32_bf16 v[96:99], v[16:19], v[192:195], v[66:69]
    v_mfma_f32_16x16x32_bf16 v[100:103], v[16:19], v[208:211], v[66:69]
    v_mfma_f32_16x16x32_bf16 v[96:99], v[20:23], v[196:199], v[96:99]
    v_perm_b32 v88, v89, v88, s23
    v_mfma_f32_16x16x32_bf16 v[100:103], v[20:23], v[212:215], v[100:103]
    v_perm_b32 v89, v91, v90, s23
    v_mfma_f32_16x16x32_bf16 v[96:99], v[24:27], v[200:203], v[96:99]
    ds_write_b64 v64, v[88:89] offset:256
    v_mfma_f32_16x16x32_bf16 v[100:103], v[24:27], v[216:219], v[100:103]
    v_perm_b32 v92, v93, v92, s23
    v_mfma_f32_16x16x32_bf16 v[96:99], v[28:31], v[204:207], v[96:99]
    v_perm_b32 v93, v95, v94, s23
    v_mfma_f32_16x16x32_bf16 v[100:103], v[28:31], v[220:223], v[100:103]
    ds_write_b64 v64, v[92:93] offset:384
    v_mfma_f32_16x16x32_bf16 v[104:107], v[16:19], v[224:227], v[66:69]
    v_mfma_f32_16x16x32_bf16 v[108:111], v[16:19], v[240:243], v[66:69]
    v_mfma_f32_16x16x32_bf16 v[104:107], v[20:23], v[228:231], v[104:107]
    v_perm_b32 v96, v97, v96, s23
    v_mfma_f32_16x16x32_bf16 v[108:111], v[20:23], v[244:247], v[108:111]
    v_perm_b32 v97, v99, v98, s23
    v_mfma_f32_16x16x32_bf16 v[104:107], v[24:27], v[232:235], v[104:107]
    ds_write_b64 v64, v[96:97] offset:512
    v_mfma_f32_16x16x32_bf16 v[108:111], v[24:27], v[248:251], v[108:111]
    v_perm_b32 v100, v101, v100, s23
    v_mfma_f32_16x16x32_bf16 v[104:107], v[28:31], v[236:239], v[104:107]
    v_perm_b32 v101, v103, v102, s23
    v_mfma_f32_16x16x32_bf16 v[108:111], v[28:31], v[252:255], v[108:111]
    ds_write_b64 v64, v[100:101] offset:640
    s_nop 7
    v_perm_b32 v104, v105, v104, s23
    v_perm_b32 v105, v107, v106, s23
    ds_write_b64 v64, v[104:105] offset:768
    v_perm_b32 v108, v109, v108, s23
    v_perm_b32 v109, v111, v110, s23
    ds_write_b64 v64, v[108:109] offset:896
    v_add_u32 v64, 0x8000, v64
    v_mfma_f32_16x16x32_bf16 v[88:91], v[32:35], v[128:131], v[66:69]
    v_mfma_f32_16x16x32_bf16 v[92:95], v[32:35], v[144:147], v[66:69]
    v_mfma_f32_16x16x32_bf16 v[88:91], v[36:39], v[132:135], v[88:91]
    v_mfma_f32_16x16x32_bf16 v[92:95], v[36:39], v[148:151], v[92:95]
    v_mfma_f32_16x16x32_bf16 v[88:91], v[40:43], v[136:139], v[88:91]
    v_mfma_f32_16x16x32_bf16 v[92:95], v[40:43], v[152:155], v[92:95]
    v_mfma_f32_16x16x32_bf16 v[88:91], v[44:47], v[140:143], v[88:91]
    v_mfma_f32_16x16x32_bf16 v[92:95], v[44:47], v[156:159], v[92:95]
    v_mfma_f32_16x16x32_bf16 v[96:99], v[32:35], v[160:163], v[66:69]
    v_mfma_f32_16x16x32_bf16 v[100:103], v[32:35], v[176:179], v[66:69]
    v_mfma_f32_16x16x32_bf16 v[96:99], v[36:39], v[164:167], v[96:99]
    v_perm_b32 v88, v89, v88, s23
    v_mfma_f32_16x16x32_bf16 v[100:103], v[36:39], v[180:183], v[100:103]
    v_perm_b32 v89, v91, v90, s23
    v_mfma_f32_16x16x32_bf16 v[96:99], v[40:43], v[168:171], v[96:99]
    ds_write_b64 v64, v[88:89] offset:0
    v_mfma_f32_16x16x32_bf16 v[100:103], v[40:43], v[184:187], v[100:103]
    v_perm_b32 v92, v93, v92, s23
    v_mfma_f32_16x16x32_bf16 v[96:99], v[44:47], v[172:175], v[96:99]
    v_perm_b32 v93, v95, v94, s23
    v_mfma_f32_16x16x32_bf16 v[100:103], v[44:47], v[188:191], v[100:103]
    ds_write_b64 v64, v[92:93] offset:128
    v_mfma_f32_16x16x32_bf16 v[104:107], v[32:35], v[192:195], v[66:69]
    v_mfma_f32_16x16x32_bf16 v[108:111], v[32:35], v[208:211], v[66:69]
    v_mfma_f32_16x16x32_bf16 v[104:107], v[36:39], v[196:199], v[104:107]
    v_perm_b32 v96, v97, v96, s23
    v_mfma_f32_16x16x32_bf16 v[108:111], v[36:39], v[212:215], v[108:111]
    v_perm_b32 v97, v99, v98, s23
    v_mfma_f32_16x16x32_bf16 v[104:107], v[40:43], v[200:203], v[104:107]
    ds_write_b64 v64, v[96:97] offset:256
    v_mfma_f32_16x16x32_bf16 v[108:111], v[40:43], v[216:219], v[108:111]
    v_perm_b32 v100, v101, v100, s23
    v_mfma_f32_16x16x32_bf16 v[104:107], v[44:47], v[204:207], v[104:107]
    v_perm_b32 v101, v103, v102, s23
    v_mfma_f32_16x16x32_bf16 v[108:111], v[44:47], v[220:223], v[108:111]
    ds_write_b64 v64, v[100:101] offset:384
    v_mfma_f32_16x16x32_bf16 v[88:91], v[32:35], v[224:227], v[66:69]
    v_mfma_f32_16x16x32_bf16 v[92:95], v[32:35], v[240:243], v[66:69]
    v_mfma_f32_16x16x32_bf16 v[88:91], v[36:39], v[228:231], v[88:91]
    v_perm_b32 v104, v105, v104, s23
    v_mfma_f32_16x16x32_bf16 v[92:95], v[36:39], v[244:247], v[92:95]
    v_perm_b32 v105, v107, v106, s23
    v_mfma_f32_16x16x32_bf16 v[88:91], v[40:43], v[232:235], v[88:91]
    ds_write_b64 v64, v[104:105] offset:512
    v_mfma_f32_16x16x32_bf16 v[92:95], v[40:43], v[248:251], v[92:95]
    v_perm_b32 v108, v109, v108, s23
    v_mfma_f32_16x16x32_bf16 v[88:91], v[44:47], v[236:239], v[88:91]
    v_perm_b32 v109, v111, v110, s23
    v_mfma_f32_16x16x32_bf16 v[92:95], v[44:47], v[252:255], v[92:95]
    ds_write_b64 v64, v[108:109] offset:640
    s_nop 7
    v_perm_b32 v88, v89, v88, s23
    v_perm_b32 v89, v91, v90, s23
    ds_write_b64 v64, v[88:89] offset:768
    v_perm_b32 v92, v93, v92, s23
    v_perm_b32 v93, v95, v94, s23
    ds_write_b64 v64, v[92:93] offset:896
    v_add_u32 v64, 0x8000, v64

    s_mov_b32 s64, 0
    s_cmp_eq_u32 s3, 7
    s_cbranch_scc1 k1_kernel_k2w
    s_branch k1_kernel_k2j

k1_kernel_end:
    s_endpgm
k1_kernel_main:
    s_setprio 3
    s_mov_b32 s16, s4
    s_and_b32 s17, s5, 0xffff
    s_mov_b32 s20, s6
    s_and_b32 s21, s7, 0xffff
    s_mov_b32 s28, s10
    s_and_b32 s29, s11, 0xffff
    s_mov_b32 s32, s12
    s_and_b32 s33, s13, 0xffff
    s_and_b32 s13, s13, 0xffff
    s_and_b32 s53, s53, 0xffff

    v_and_b32 v5, 15, v255
    v_lshrrev_b32 v6, 4, v255
    v_and_b32 v7, 3, v255
    v_bfe_u32 v8, v255, 2, 2
    v_lshl_add_u32 v9, v7, 2, v8
    v_cmp_eq_u32 s[46:47], 0, v7
    s_movk_i32 s45, 200
    v_mov_b32 v10, 144384
    v_mad_u32_u24 v11, v9, s45, v10
    v_and_b32 v213, 48, v255
    v_add_u32 v128, v11, v213
    v_mul_u32_u24 v12, 6400, v6
    v_add_u32 v132, v11, v12
    v_and_b32 v12, 16, v255
    v_add_u32 v10, v10, v12
    v_add_u32 v11, v11, v12
    v_and_b32 v12, 32, v255
    v_mul_u32_u24 v12, 100, v12
    v_add_u32 v131, v11, v12
    v_and_b32 v12, 8, v255
    v_lshl_add_u32 v13, v7, 1, v12
    v_and_b32 v14, 1, v8
    v_add_u32 v13, v13, v14
    v_lshrrev_b32 v14, 5, v255
    v_lshl_add_u32 v14, v13, 1, v14
    v_mad_u32_u24 v129, v14, s45, v10
    v_lshl_add_u32 v130, v12, 2, v129
    v_lshlrev_b32 v15, 2, v6
    v_sub_u32 v13, v13, v15
    v_lshrrev_b32 v14, 1, v9
    v_sub_u32 v14, v14, v15
    v_sub_u32 v15, v5, v15
    v_and_b32 v12, 1, v9
    v_lshlrev_b32 v12, 4, v12
    v_mov_b32 v16, 0x3f80
    v_lshlrev_b32 v12, v12, v16
    v_mov_b32 v17, 0x3f800000

    v_cmp_eq_u32 vcc, 0, v13
    v_cndmask_b32 v120, 0, v16, vcc
    v_cmp_eq_u32 vcc, 0, v14
    v_cndmask_b32 v112, 0, v12, vcc
    v_cmp_eq_u32 vcc, -8, v14
    v_cndmask_b32 v116, 0, v12, vcc
    v_cmp_eq_u32 vcc, 0, v15
    v_cndmask_b32 v200, 0, v17, vcc
    v_lshlrev_b32 v124, 16, v120

    v_cmp_eq_u32 vcc, 1, v13
    v_cndmask_b32 v121, 0, v16, vcc
    v_cmp_eq_u32 vcc, 1, v14
    v_cndmask_b32 v113, 0, v12, vcc
    v_cmp_eq_u32 vcc, -7, v14
    v_cndmask_b32 v117, 0, v12, vcc
    v_cmp_eq_u32 vcc, 1, v15
    v_cndmask_b32 v201, 0, v17, vcc
    v_lshlrev_b32 v125, 16, v121

    v_cmp_eq_u32 vcc, 2, v13
    v_cndmask_b32 v122, 0, v16, vcc
    v_cmp_eq_u32 vcc, 2, v14
    v_cndmask_b32 v114, 0, v12, vcc
    v_cmp_eq_u32 vcc, -6, v14
    v_cndmask_b32 v118, 0, v12, vcc
    v_cmp_eq_u32 vcc, 2, v15
    v_cndmask_b32 v202, 0, v17, vcc
    v_lshlrev_b32 v126, 16, v122

    v_cmp_eq_u32 vcc, 3, v13
    v_cndmask_b32 v123, 0, v16, vcc
    v_cmp_eq_u32 vcc, 3, v14
    v_cndmask_b32 v115, 0, v12, vcc
    v_cmp_eq_u32 vcc, -5, v14
    v_cndmask_b32 v119, 0, v12, vcc
    v_cmp_eq_u32 vcc, 3, v15
    v_cndmask_b32 v203, 0, v17, vcc
    v_lshlrev_b32 v127, 16, v123

    s_mul_i32 s45, s3, 36864
    s_add_u32 s45, s45, 128
    s_movk_i32 s57, 144
    v_mov_b32 v10, s45
    v_mad_u32_u24 v214, v5, s57, v10
    v_mad_u32_u24 v218, v255, s57, v10
    v_add_u32 v218, 12, v218
    v_cmp_lt_u32 vcc, 25, v255
    v_subrev_u32 v11, 26, v255
    v_cndmask_b32 v11, v255, v11, vcc
    v_add_u32 v12, 2304, v10
    v_cndmask_b32 v10, v10, v12, vcc
    v_and_b32 v12, 3, v11
    v_mad_u32_u24 v10, v12, s57, v10
    v_lshrrev_b32 v11, 2, v11
    v_lshl_add_u32 v215, v11, 1, v10
    v_cmp_gt_u32 vcc, 52, v255
    v_add_u32 v11, 2304, v218
    v_cndmask_b32 v215, v11, v215, vcc
    v_mov_b32 v216, 0xdddddddd
    v_mov_b32 v219, 1000
    s_mov_b32 s60, 0xff00ff00
    s_mov_b32 s61, 0xff00ff00
    s_mov_b32 s62, -1
    s_mov_b32 s63, 0xffff

    s_waitcnt vmcnt(3)

    s_mov_b64 exec, 1
    ds_add_u32 v252, v253 offset:0
    s_mov_b64 exec, -1

k1_kernel_wf1:

    ds_read_b32 v251, v252 offset:0
    s_waitcnt lgkmcnt(0)
    v_readfirstlane_b32 s45, v251
    s_cmp_lt_u32 s45, 4
    s_cbranch_scc1 k1_kernel_wf1

    v_mov_b32 v72, 0
    v_mov_b32 v73, 0
    v_mov_b32 v74, 0
    v_mov_b32 v75, 0
    s_mov_b64 exec, s[62:63]
    ds_read_b64 v[72:73], v132 offset:192
    ds_read_b64 v[74:75], v132 offset:3392
    s_mov_b64 exec, -1
    ds_read_b64 v[76:77], v128 offset:16160
    ds_read_b64 v[78:79], v128 offset:16168
    ds_read_b64 v[80:81], v128 offset:0
    ds_read_b64 v[82:83], v128 offset:8
    ds_read_b64 v[84:85], v131 offset:0
    ds_read_b64 v[86:87], v131 offset:8
    s_waitcnt vmcnt(2)
    s_waitcnt lgkmcnt(4)
    v_mfma_f32_16x16x32_bf16 v[64:67], v[112:115], v[72:75], 0
    ds_read_b64 v[88:89], v128 offset:3232
    ds_read_b64 v[90:91], v128 offset:3240
    v_mfma_f32_16x16x32_bf16 v[68:71], v[116:119], v[72:75], 0
    v_mfma_f32_16x16x32_bf16 v[60:63], v[112:115], v[76:79], 0
    v_mfma_f32_16x16x32_bf16 v[64:67], v[232:235], v[112:115], v[64:67]
    v_mov_b32 v92, 0
    v_mov_b32 v93, 0
    v_mov_b32 v94, 0
    v_mov_b32 v95, 0
    s_mov_b64 exec, s[60:61]
    ds_read_b64 v[92:93], v129 offset:3232
    ds_read_b64 v[94:95], v129 offset:3240
    s_mov_b64 exec, -1
    v_mfma_f32_16x16x32_bf16 v[68:71], v[232:235], v[116:119], v[68:71]
    s_waitcnt lgkmcnt(4)
    v_mfma_f32_16x16x32_bf16 v[0:3], v[112:115], v[80:83], 0
    ds_read_b64 v[72:73], v128 offset:64
    ds_read_b64 v[74:75], v128 offset:72
    v_mfma_f32_16x16x32_bf16 v[4:7], v[116:119], v[80:83], 0
    v_mfma_f32_16x16x32_bf16 v[4:7], v[84:87], v[116:119], v[4:7]
    v_cndmask_b32 v70, 0, v70, s[46:47]
    ds_read_b64 v[76:77], v131 offset:6400
    ds_read_b64 v[78:79], v131 offset:6408
    s_waitcnt lgkmcnt(4)
    v_mfma_f32_16x16x32_bf16 v[96:99], v[120:123], v[88:91], 0
    ds_read_b64 v[80:81], v128 offset:9632
    ds_read_b64 v[82:83], v128 offset:9640
    v_mfma_f32_16x16x32_bf16 v[100:103], v[124:127], v[88:91], 0
    v_mfma_f32_16x16x32_bf16 v[96:99], v[92:95], v[112:115], v[96:99]
    v_mfma_f32_16x16x32_bf16 v[100:103], v[92:95], v[116:119], v[100:103]
    ds_read_b64 v[84:85], v129 offset:3296
    ds_read_b64 v[86:87], v129 offset:3304
    s_waitcnt lgkmcnt(4)
    v_mfma_f32_16x16x32_bf16 v[12:15], v[112:115], v[72:75], 0
    ds_read_b64 v[88:89], v128 offset:6464
    ds_read_b64 v[90:91], v128 offset:6472
    v_mfma_f32_16x16x32_bf16 v[16:19], v[116:119], v[72:75], 0
    v_cvt_pk_bf16_f32 v8, v96, v97
    v_cvt_pk_bf16_f32 v9, v98, v99
    v_mfma_f32_16x16x32_bf16 v[12:15], v[76:79], v[112:115], v[12:15]
    v_cvt_pk_bf16_f32 v10, v100, v101
    v_cvt_pk_bf16_f32 v11, v102, v103
    v_mfma_f32_16x16x32_bf16 v[16:19], v[76:79], v[116:119], v[16:19]
    ds_read_b64 v[92:93], v128 offset:9696
    ds_read_b64 v[94:95], v128 offset:9704
    s_waitcnt lgkmcnt(4)
    v_mfma_f32_16x16x32_bf16 v[96:99], v[120:123], v[80:83], 0
    ds_read_b64 v[72:73], v128 offset:128
    ds_read_b64 v[74:75], v128 offset:136
    v_mfma_f32_16x16x32_bf16 v[100:103], v[124:127], v[80:83], 0
    v_mfma_f32_16x16x32_bf16 v[96:99], v[84:87], v[112:115], v[96:99]
    v_mfma_f32_16x16x32_bf16 v[100:103], v[84:87], v[116:119], v[100:103]
    ds_read_b64 v[76:77], v129 offset:12800
    ds_read_b64 v[78:79], v129 offset:12808
    s_waitcnt lgkmcnt(4)
    v_mfma_f32_16x16x32_bf16 v[24:27], v[112:115], v[88:91], 0
    ds_read_b64 v[80:81], v128 offset:3328
    ds_read_b64 v[82:83], v128 offset:3336
    v_mfma_f32_16x16x32_bf16 v[28:31], v[112:115], v[92:95], 0
    v_cvt_pk_bf16_f32 v20, v96, v97
    v_cvt_pk_bf16_f32 v21, v98, v99
    s_nop 3
    v_cvt_pk_bf16_f32 v22, v100, v101
    v_cvt_pk_bf16_f32 v23, v102, v103
    ds_read_b64 v[84:85], v131 offset:12832
    ds_read_b64 v[86:87], v131 offset:12840
    s_waitcnt lgkmcnt(4)
    v_mfma_f32_16x16x32_bf16 v[96:99], v[120:123], v[72:75], 0
    ds_read_b64 v[88:89], v128 offset:6528
    ds_read_b64 v[90:91], v128 offset:6536
    v_mfma_f32_16x16x32_bf16 v[100:103], v[124:127], v[72:75], 0
    v_mfma_f32_16x16x32_bf16 v[96:99], v[76:79], v[112:115], v[96:99]
    v_mfma_f32_16x16x32_bf16 v[100:103], v[76:79], v[116:119], v[100:103]
    ds_read_b64 v[92:93], v129 offset:12864
    ds_read_b64 v[94:95], v129 offset:12872
    s_waitcnt lgkmcnt(4)
    v_mfma_f32_16x16x32_bf16 v[36:39], v[112:115], v[80:83], 0
    ds_read_b64 v[72:73], v128 offset:9728
    ds_read_b64 v[74:75], v128 offset:9736
    v_mfma_f32_16x16x32_bf16 v[40:43], v[116:119], v[80:83], 0
    v_cvt_pk_bf16_f32 v32, v96, v97
    v_cvt_pk_bf16_f32 v33, v98, v99
    v_mfma_f32_16x16x32_bf16 v[36:39], v[84:87], v[112:115], v[36:39]
    v_cvt_pk_bf16_f32 v34, v100, v101
    v_cvt_pk_bf16_f32 v35, v102, v103
    v_mfma_f32_16x16x32_bf16 v[40:43], v[84:87], v[116:119], v[40:43]
    ds_read_b64 v[76:77], v131 offset:12896
    ds_read_b64 v[78:79], v131 offset:12904
    s_waitcnt lgkmcnt(4)
    v_mfma_f32_16x16x32_bf16 v[96:99], v[120:123], v[88:91], 0
    ds_read_b64 v[80:81], v128 offset:12928
    ds_read_b64 v[82:83], v128 offset:12936
    v_mfma_f32_16x16x32_bf16 v[100:103], v[124:127], v[88:91], 0
    v_mfma_f32_16x16x32_bf16 v[96:99], v[92:95], v[112:115], v[96:99]
    v_mfma_f32_16x16x32_bf16 v[100:103], v[92:95], v[116:119], v[100:103]
    v_mov_b32 v84, 0
    v_mov_b32 v85, 0
    v_mov_b32 v86, 0
    v_mov_b32 v87, 0
    s_mov_b64 exec, s[60:61]
    ds_read_b64 v[84:85], v129 offset:12928
    ds_read_b64 v[86:87], v129 offset:12936
    s_mov_b64 exec, -1
    s_waitcnt lgkmcnt(4)
    v_mfma_f32_16x16x32_bf16 v[48:51], v[112:115], v[72:75], 0
    v_mfma_f32_16x16x32_bf16 v[52:55], v[116:119], v[72:75], 0
    v_cvt_pk_bf16_f32 v44, v96, v97
    v_cvt_pk_bf16_f32 v45, v98, v99
    v_mfma_f32_16x16x32_bf16 v[48:51], v[76:79], v[112:115], v[48:51]
    v_cvt_pk_bf16_f32 v46, v100, v101
    v_cvt_pk_bf16_f32 v47, v102, v103
    v_mfma_f32_16x16x32_bf16 v[52:55], v[76:79], v[116:119], v[52:55]
    s_waitcnt lgkmcnt(0)

    s_mov_b64 exec, 1
    ds_add_u32 v252, v253 offset:12
    s_mov_b64 exec, -1

    v_mfma_f32_16x16x32_bf16 v[96:99], v[120:123], v[80:83], 0
    v_mfma_f32_16x16x32_bf16 v[100:103], v[124:127], v[80:83], 0
    v_mfma_f32_16x16x32_bf16 v[96:99], v[84:87], v[112:115], v[96:99]
    v_mfma_f32_16x16x32_bf16 v[100:103], v[84:87], v[116:119], v[100:103]
    s_nop 7
    v_cvt_pk_bf16_f32 v56, v96, v97
    v_cvt_pk_bf16_f32 v57, v98, v99
    v_cvt_pk_bf16_f32 v58, v100, v101
    v_cvt_pk_bf16_f32 v59, v102, v103

    v_mov_b32_dpp v71, v70 row_shr:1 row_mask:0xf bank_mask:0xf bound_ctrl:0
    ds_write_b32 v218, v219
    v_and_b32 v217, 1, v255
    v_lshlrev_b32 v248, 1, v213
    v_lshl_add_u32 v248, v217, 2, v248
    v_mul_u32_u24 v208, 0xaaaa, v217
    v_mov_b32 v217, 0
    s_mov_b32 vcc_lo, 0x01010101
    s_mov_b32 vcc_hi, 0x01010101
    s_movk_i32 s58, 7

    v_mov_b64 v[172:173], 0
    v_mov_b64 v[176:177], 0
    v_mov_b64 v[180:181], 0
    v_mov_b64 v[184:185], 0
    v_mov_b64 v[188:189], 0
    v_mov_b64 v[192:193], 0
    v_mov_b64 v[196:197], 0
    v_mov_b64 v[198:199], 0
    s_waitcnt vmcnt(1)
    ds_write_b16 v215, v240 offset:0
    ds_write_b16 v215, v241 offset:576
    ds_write_b16 v215, v242 offset:1152
    ds_write_b16 v215, v243 offset:1728
    v_add_u32 v250, 0x4444, v208
    ds_read_b128 v[204:207], v214 offset:0
k1_kernel_wf2:

    ds_read_b32 v251, v252 offset:16
    s_waitcnt lgkmcnt(0)
    v_readfirstlane_b32 s45, v251
    s_cmp_lt_u32 s45, 4
    s_cbranch_scc1 k1_kernel_wf2

    s_setprio 2
    v_mad_u32_u16 v76, v204, s57, v213 op_sel:[0,0,0,0]
    ds_read_b128 v[72:75], v76 offset:0
    ds_read_b128 v[76:79], v76 offset:64
    v_mad_u32_u16 v84, v204, s57, v213 op_sel:[1,0,0,0]
    ds_read_b128 v[80:83], v84 offset:0
    ds_read_b128 v[84:87], v84 offset:64
    v_mad_u32_u16 v92, v205, s57, v213 op_sel:[0,0,0,0]
    ds_read_b128 v[88:91], v92 offset:0
    ds_read_b128 v[92:95], v92 offset:64
    v_mad_u32_u16 v100, v205, s57, v213 op_sel:[1,0,0,0]
    ds_read_b128 v[96:99], v100 offset:0
    ds_read_b128 v[100:103], v100 offset:64
    v_mad_u32_u16 v108, v206, s57, v213 op_sel:[0,0,0,0]
    ds_read_b128 v[104:107], v108 offset:0
    ds_read_b128 v[108:111], v108 offset:64
    buffer_load_dwordx4 v[240:243], v249, s[16:19], s74 offen offset:0
    s_waitcnt lgkmcnt(4)
    v_mad_u32_u16 v116, v206, s57, v213 op_sel:[1,0,0,0]
    ds_read_b128 v[112:115], v116 offset:0
k1_kernel_loop:
    v_mfma_f32_16x16x32_bf16 v[124:127], v[72:75], v[72:75], 0
    ds_read_b128 v[116:119], v116 offset:64
    v_mad_u32_u16 v122, v207, s57, v248 op_sel:[0,0,0,0]
    ds_read2_b32 v[120:121], v122 offset0:0 offset1:2
    v_mfma_f32_16x16x32_bf16 v[124:127], v[76:79], v[76:79], v[124:127]
    ds_read2_b32 v[122:123], v122 offset0:4 offset1:6
    ds_read_b128 v[204:207], v214 offset:2304
    v_mfma_f32_16x16x32_bf16 v[128:131], v[80:83], v[72:75], 0
    v_fmac_f32 v217, v189, v68
    v_fmac_f32 v217, v196, v200
    v_mfma_f32_16x16x32_bf16 v[128:131], v[84:87], v[76:79], v[128:131]
    v_fmac_f32 v217, v192, v69
    v_fmac_f32 v217, v197, v201
    v_mfma_f32_16x16x32_bf16 v[132:135], v[80:83], v[80:83], 0
    v_fmac_f32 v217, v193, v69
    v_fmac_f32 v217, v198, v202
    v_mfma_f32_16x16x32_bf16 v[132:135], v[84:87], v[84:87], v[132:135]
    v_fmac_f32 v217, v199, v203
    v_fmac_f32 v209, v153, v53
    v_mfma_f32_16x16x32_bf16 v[136:139], v[88:91], v[80:83], 0
    v_fmac_f32 v208, v154, v54
    v_fmac_f32 v209, v155, v55
    v_mfma_f32_16x16x32_bf16 v[136:139], v[92:95], v[84:87], v[136:139]
    v_fmac_f32 v208, v164, v60
    v_fmac_f32 v209, v165, v61
    v_mfma_f32_16x16x32_bf16 v[140:143], v[88:91], v[72:75], 0
    v_fmac_f32 v208, v166, v62
    v_fmac_f32 v209, v167, v63
    v_mfma_f32_16x16x32_bf16 v[140:143], v[92:95], v[76:79], v[140:143]
    s_waitcnt lgkmcnt(7)
    v_add_f32 v209, v209, v217
    v_smfmac_f32_16x16x64_bf16 v[196:199], v[8:11], v[132:139], v216
    v_fmac_f32 v208, v168, v70
    v_mfma_f32_16x16x32_bf16 v[144:147], v[96:99], v[72:75], 0
    v_fmac_f32 v208, v169, v71
    v_add_f32 v211, v208, v209
    v_mfma_f32_16x16x32_bf16 v[144:147], v[100:103], v[76:79], v[144:147]
    v_fma_f32 v208, v124, v0, -v217
    v_mul_f32 v209, v125, v1
    v_mfma_f32_16x16x32_bf16 v[148:151], v[80:83], v[96:99], 0
    v_fmac_f32 v208, v126, v2
    v_fmac_f32 v209, v127, v3
    v_mfma_f32_16x16x32_bf16 v[148:151], v[84:87], v[100:103], v[148:151]
    v_fmac_f32 v208, v128, v4
    v_fmac_f32 v209, v129, v5
    v_mfma_f32_16x16x32_bf16 v[152:155], v[88:91], v[96:99], 0
    v_fmac_f32 v208, v130, v6
    v_fmac_f32 v209, v131, v7
    v_mfma_f32_16x16x32_bf16 v[152:155], v[92:95], v[100:103], v[152:155]
    v_fmac_f32 v208, v140, v12
    v_fmac_f32 v209, v141, v13
    v_mfma_f32_16x16x32_bf16 v[156:159], v[88:91], v[88:91], 0
    v_fmac_f32 v208, v142, v14
    v_fmac_f32 v209, v143, v15
    v_mfma_f32_16x16x32_bf16 v[156:159], v[92:95], v[92:95], v[156:159]
    v_fmac_f32 v208, v144, v16
    v_fmac_f32 v209, v145, v17
    v_smfmac_f32_16x16x64_bf16 v[196:199], v[20:23], v[148:155], v216
    v_fmac_f32 v208, v146, v18
    v_mfma_f32_16x16x32_bf16 v[160:163], v[96:99], v[96:99], 0
    s_waitcnt lgkmcnt(0)
    v_fmac_f32 v209, v147, v19
    v_mfma_f32_16x16x32_bf16 v[160:163], v[100:103], v[100:103], v[160:163]
    v_fmac_f32 v208, v156, v24
    v_fmac_f32 v209, v157, v25
    v_mfma_f32_16x16x32_bf16 v[124:127], v[104:107], v[72:75], 0
    v_fmac_f32 v208, v158, v26
    v_fmac_f32 v209, v159, v27
    v_mfma_f32_16x16x32_bf16 v[124:127], v[108:111], v[76:79], v[124:127]
    v_permlane32_swap_b32 v210, v211
    s_waitcnt vmcnt(1)
    v_mfma_f32_16x16x32_bf16 v[128:131], v[112:115], v[72:75], 0
    v_fmac_f32 v208, v160, v28
    v_fmac_f32 v209, v161, v29
    v_mfma_f32_16x16x32_bf16 v[128:131], v[116:119], v[76:79], v[128:131]
    v_fmac_f32 v208, v162, v30
    v_fmac_f32 v209, v163, v31
    v_smfmac_f32_16x16x64_bf16 v[172:175], v[120:123], v[72:79], v250
    v_mad_u32_u16 v76, v204, s57, v213 op_sel:[0,0,0,0]
    v_mfma_f32_16x16x32_bf16 v[132:135], v[104:107], v[80:83], 0
    ds_read_b128 v[72:75], v76 offset:0
    ds_read_b128 v[76:79], v76 offset:64
    v_smfmac_f32_16x16x64_bf16 v[196:199], v[32:35], v[124:131], v216
    v_add_f32 v219, v210, v211
    v_mfma_f32_16x16x32_bf16 v[132:135], v[108:111], v[84:87], v[132:135]
    v_mul_f32 v217, v172, v64
    ds_write_b16 v215, v244 offset:4608
    v_mfma_f32_16x16x32_bf16 v[136:139], v[112:115], v[80:83], 0
    v_fmac_f32 v217, v173, v64
    ds_write_b16 v215, v245 offset:5184
    v_mfma_f32_16x16x32_bf16 v[136:139], v[116:119], v[84:87], v[136:139]
    ds_write_b16 v215, v246 offset:5760
    ds_write_b16 v215, v247 offset:6336
    v_smfmac_f32_16x16x64_bf16 v[176:179], v[120:123], v[80:87], v250
    v_mad_u32_u16 v84, v204, s57, v213 op_sel:[1,0,0,0]
    v_mfma_f32_16x16x32_bf16 v[140:143], v[104:107], v[88:91], 0
    ds_read_b128 v[80:83], v84 offset:0
    ds_read_b128 v[84:87], v84 offset:64
    v_mfma_f32_16x16x32_bf16 v[140:143], v[108:111], v[92:95], v[140:143]
    v_fmac_f32 v208, v132, v36
    v_fmac_f32 v209, v133, v37
    v_mfma_f32_16x16x32_bf16 v[144:147], v[112:115], v[88:91], 0
    v_fmac_f32 v217, v176, v65
    v_fmac_f32 v208, v134, v38
    v_mfma_f32_16x16x32_bf16 v[144:147], v[116:119], v[92:95], v[144:147]
    v_fmac_f32 v217, v177, v65
    v_fmac_f32 v209, v135, v39
    v_smfmac_f32_16x16x64_bf16 v[180:183], v[120:123], v[88:95], v250
    v_mad_u32_u16 v92, v205, s57, v213 op_sel:[0,0,0,0]
    v_mfma_f32_16x16x32_bf16 v[148:151], v[104:107], v[96:99], 0
    ds_read_b128 v[88:91], v92 offset:0
    ds_read_b128 v[92:95], v92 offset:64
    v_smfmac_f32_16x16x64_bf16 v[196:199], v[44:47], v[140:147], v216
    v_fmac_f32 v208, v136, v40
    v_mfma_f32_16x16x32_bf16 v[148:151], v[108:111], v[100:103], v[148:151]
    v_fmac_f32 v217, v180, v66
    v_fmac_f32 v209, v137, v41
    v_mfma_f32_16x16x32_bf16 v[152:155], v[112:115], v[96:99], 0
    v_fmac_f32 v217, v181, v66
    v_fmac_f32 v208, v138, v42
    v_mfma_f32_16x16x32_bf16 v[152:155], v[116:119], v[100:103], v[152:155]
    v_fmac_f32 v209, v139, v43
    buffer_load_dwordx4 v[244:247], v249, s[16:19], s74 offen offset:800
    v_smfmac_f32_16x16x64_bf16 v[184:187], v[120:123], v[96:103], v250
    v_mad_u32_u16 v100, v205, s57, v213 op_sel:[1,0,0,0]
    v_mfma_f32_16x16x32_bf16 v[156:159], v[104:107], v[104:107], 0
    ds_read_b128 v[96:99], v100 offset:0
    ds_read_b128 v[100:103], v100 offset:64
    v_mfma_f32_16x16x32_bf16 v[156:159], v[108:111], v[108:111], v[156:159]
    v_fmac_f32 v208, v148, v48
    v_fmac_f32 v209, v149, v49
    v_mfma_f32_16x16x32_bf16 v[160:163], v[112:115], v[104:107], 0
    v_fmac_f32 v217, v184, v67
    v_fmac_f32 v208, v150, v50
    v_mfma_f32_16x16x32_bf16 v[160:163], v[116:119], v[108:111], v[160:163]
    v_fmac_f32 v217, v185, v67
    v_fmac_f32 v209, v151, v51
    v_smfmac_f32_16x16x64_bf16 v[188:191], v[120:123], v[104:111], v250
    v_mad_u32_u16 v108, v206, s57, v213 op_sel:[0,0,0,0]
    v_mfma_f32_16x16x32_bf16 v[164:167], v[112:115], v[112:115], 0
    ds_read_b128 v[104:107], v108 offset:0
    ds_read_b128 v[108:111], v108 offset:64
    v_smfmac_f32_16x16x64_bf16 v[196:199], v[56:59], v[156:163], v216
    s_waitcnt lgkmcnt(4)
    v_mfma_f32_16x16x32_bf16 v[164:167], v[116:119], v[116:119], v[164:167]
    v_fmac_f32 v217, v188, v68
    v_fmac_f32 v208, v152, v52
    v_smfmac_f32_16x16x64_bf16 v[192:195], v[120:123], v[112:119], v250
    v_mad_u32_u16 v116, v206, s57, v213 op_sel:[1,0,0,0]
    v_mfma_f32_16x16x32_bf16 v[168:171], v[120:123], v[120:123], 0
    ds_read_b128 v[112:115], v116 offset:0
    v_mfma_f32_16x16x32_bf16 v[124:127], v[72:75], v[72:75], 0
    ds_read_b128 v[116:119], v116 offset:64
    v_mad_u32_u16 v122, v207, s57, v248 op_sel:[0,0,0,0]
    ds_read2_b32 v[120:121], v122 offset0:0 offset1:2
    v_mfma_f32_16x16x32_bf16 v[124:127], v[76:79], v[76:79], v[124:127]
    ds_read2_b32 v[122:123], v122 offset0:4 offset1:6
    ds_read_b128 v[204:207], v214 offset:4608
    v_mfma_f32_16x16x32_bf16 v[128:131], v[80:83], v[72:75], 0
    v_fmac_f32 v217, v189, v68
    v_fmac_f32 v217, v196, v200
    v_mfma_f32_16x16x32_bf16 v[128:131], v[84:87], v[76:79], v[128:131]
    v_fmac_f32 v217, v192, v69
    v_fmac_f32 v217, v197, v201
    v_mfma_f32_16x16x32_bf16 v[132:135], v[80:83], v[80:83], 0
    v_fmac_f32 v217, v193, v69
    v_fmac_f32 v217, v198, v202
    v_mfma_f32_16x16x32_bf16 v[132:135], v[84:87], v[84:87], v[132:135]
    v_fmac_f32 v217, v199, v203
    v_fmac_f32 v209, v153, v53
    v_mfma_f32_16x16x32_bf16 v[136:139], v[88:91], v[80:83], 0
    v_fmac_f32 v208, v154, v54
    v_fmac_f32 v209, v155, v55
    v_mfma_f32_16x16x32_bf16 v[136:139], v[92:95], v[84:87], v[136:139]
    v_fmac_f32 v208, v164, v60
    v_fmac_f32 v209, v165, v61
    v_mfma_f32_16x16x32_bf16 v[140:143], v[88:91], v[72:75], 0
    v_fmac_f32 v208, v166, v62
    v_fmac_f32 v209, v167, v63
    v_mfma_f32_16x16x32_bf16 v[140:143], v[92:95], v[76:79], v[140:143]
    s_waitcnt lgkmcnt(7)
    v_add_f32 v209, v209, v217
    v_smfmac_f32_16x16x64_bf16 v[196:199], v[8:11], v[132:139], v216
    v_fmac_f32 v208, v168, v70
    v_mfma_f32_16x16x32_bf16 v[144:147], v[96:99], v[72:75], 0
    v_fmac_f32 v208, v169, v71
    v_add_f32 v210, v208, v209
    v_mfma_f32_16x16x32_bf16 v[144:147], v[100:103], v[76:79], v[144:147]
    v_fma_f32 v208, v124, v0, -v217
    v_mul_f32 v209, v125, v1
    v_mfma_f32_16x16x32_bf16 v[148:151], v[80:83], v[96:99], 0
    v_fmac_f32 v208, v126, v2
    v_fmac_f32 v209, v127, v3
    v_mfma_f32_16x16x32_bf16 v[148:151], v[84:87], v[100:103], v[148:151]
    v_fmac_f32 v208, v128, v4
    v_fmac_f32 v209, v129, v5
    v_mfma_f32_16x16x32_bf16 v[152:155], v[88:91], v[96:99], 0
    v_fmac_f32 v208, v130, v6
    v_fmac_f32 v209, v131, v7
    v_mfma_f32_16x16x32_bf16 v[152:155], v[92:95], v[100:103], v[152:155]
    v_fmac_f32 v208, v140, v12
    v_fmac_f32 v209, v141, v13
    v_mfma_f32_16x16x32_bf16 v[156:159], v[88:91], v[88:91], 0
    v_fmac_f32 v208, v142, v14
    v_fmac_f32 v209, v143, v15
    v_mfma_f32_16x16x32_bf16 v[156:159], v[92:95], v[92:95], v[156:159]
    v_fmac_f32 v208, v144, v16
    v_fmac_f32 v209, v145, v17
    v_smfmac_f32_16x16x64_bf16 v[196:199], v[20:23], v[148:155], v216
    v_fmac_f32 v208, v146, v18
    v_mfma_f32_16x16x32_bf16 v[160:163], v[96:99], v[96:99], 0
    s_waitcnt lgkmcnt(0)
    v_fmac_f32 v209, v147, v19
    v_mfma_f32_16x16x32_bf16 v[160:163], v[100:103], v[100:103], v[160:163]
    v_fmac_f32 v208, v156, v24
    v_fmac_f32 v209, v157, v25
    v_mfma_f32_16x16x32_bf16 v[124:127], v[104:107], v[72:75], 0
    v_fmac_f32 v208, v158, v26
    v_fmac_f32 v209, v159, v27
    v_mfma_f32_16x16x32_bf16 v[124:127], v[108:111], v[76:79], v[124:127]
    v_permlane16_swap_b32 v218, v219
    s_add_u32 s74, s74, s77
    v_mfma_f32_16x16x32_bf16 v[128:131], v[112:115], v[72:75], 0
    v_fmac_f32 v208, v160, v28
    v_fmac_f32 v209, v161, v29
    v_mfma_f32_16x16x32_bf16 v[128:131], v[116:119], v[76:79], v[128:131]
    v_fmac_f32 v208, v162, v30
    v_fmac_f32 v209, v163, v31
    v_smfmac_f32_16x16x64_bf16 v[172:175], v[120:123], v[72:79], v250
    v_mad_u32_u16 v76, v204, s57, v213 op_sel:[0,0,0,0]
    v_mfma_f32_16x16x32_bf16 v[132:135], v[104:107], v[80:83], 0
    ds_read_b128 v[72:75], v76 offset:0
    ds_read_b128 v[76:79], v76 offset:64
    v_smfmac_f32_16x16x64_bf16 v[196:199], v[32:35], v[124:131], v216
    v_add_f32 v220, v218, v219
    v_mfma_f32_16x16x32_bf16 v[132:135], v[108:111], v[84:87], v[132:135]
    v_mul_f32 v217, v172, v64
    s_min_i32 s74, s74, s79
    v_mfma_f32_16x16x32_bf16 v[136:139], v[112:115], v[80:83], 0
    v_fmac_f32 v217, v173, v64
    s_max_i32 s74, s74, s78
    v_mfma_f32_16x16x32_bf16 v[136:139], v[116:119], v[84:87], v[136:139]
    v_smfmac_f32_16x16x64_bf16 v[176:179], v[120:123], v[80:87], v250
    v_mad_u32_u16 v84, v204, s57, v213 op_sel:[1,0,0,0]
    v_mfma_f32_16x16x32_bf16 v[140:143], v[104:107], v[88:91], 0
    ds_read_b128 v[80:83], v84 offset:0
    ds_read_b128 v[84:87], v84 offset:64
    v_mfma_f32_16x16x32_bf16 v[140:143], v[108:111], v[92:95], v[140:143]
    v_fmac_f32 v208, v132, v36
    v_fmac_f32 v209, v133, v37
    v_mfma_f32_16x16x32_bf16 v[144:147], v[112:115], v[88:91], 0
    v_fmac_f32 v217, v176, v65
    v_fmac_f32 v208, v134, v38
    v_mfma_f32_16x16x32_bf16 v[144:147], v[116:119], v[92:95], v[144:147]
    v_fmac_f32 v217, v177, v65
    v_fmac_f32 v209, v135, v39
    v_smfmac_f32_16x16x64_bf16 v[180:183], v[120:123], v[88:95], v250
    v_mad_u32_u16 v92, v205, s57, v213 op_sel:[0,0,0,0]
    v_mfma_f32_16x16x32_bf16 v[148:151], v[104:107], v[96:99], 0
    ds_read_b128 v[88:91], v92 offset:0
    ds_read_b128 v[92:95], v92 offset:64
    v_smfmac_f32_16x16x64_bf16 v[196:199], v[44:47], v[140:147], v216
    v_fmac_f32 v208, v136, v40
    v_mfma_f32_16x16x32_bf16 v[148:151], v[108:111], v[100:103], v[148:151]
    v_fmac_f32 v217, v180, v66
    v_fmac_f32 v209, v137, v41
    v_mfma_f32_16x16x32_bf16 v[152:155], v[112:115], v[96:99], 0
    v_fmac_f32 v217, v181, v66
    v_fmac_f32 v208, v138, v42
    v_mfma_f32_16x16x32_bf16 v[152:155], v[116:119], v[100:103], v[152:155]
    v_fmac_f32 v209, v139, v43
    v_smfmac_f32_16x16x64_bf16 v[184:187], v[120:123], v[96:103], v250
    v_mad_u32_u16 v100, v205, s57, v213 op_sel:[1,0,0,0]
    v_mfma_f32_16x16x32_bf16 v[156:159], v[104:107], v[104:107], 0
    ds_read_b128 v[96:99], v100 offset:0
    ds_read_b128 v[100:103], v100 offset:64
    v_mfma_f32_16x16x32_bf16 v[156:159], v[108:111], v[108:111], v[156:159]
    v_fmac_f32 v208, v148, v48
    v_fmac_f32 v209, v149, v49
    v_mfma_f32_16x16x32_bf16 v[160:163], v[112:115], v[104:107], 0
    v_fmac_f32 v217, v184, v67
    v_fmac_f32 v208, v150, v50
    v_mfma_f32_16x16x32_bf16 v[160:163], v[116:119], v[108:111], v[160:163]
    v_fmac_f32 v217, v185, v67
    v_fmac_f32 v209, v151, v51
    v_smfmac_f32_16x16x64_bf16 v[188:191], v[120:123], v[104:111], v250
    v_mad_u32_u16 v108, v206, s57, v213 op_sel:[0,0,0,0]
    v_mfma_f32_16x16x32_bf16 v[164:167], v[112:115], v[112:115], 0
    ds_read_b128 v[104:107], v108 offset:0
    ds_read_b128 v[108:111], v108 offset:64
    v_smfmac_f32_16x16x64_bf16 v[196:199], v[56:59], v[156:163], v216
    s_waitcnt lgkmcnt(4)
    v_mfma_f32_16x16x32_bf16 v[164:167], v[116:119], v[116:119], v[164:167]
    v_fmac_f32 v217, v188, v68
    v_fmac_f32 v208, v152, v52
    v_smfmac_f32_16x16x64_bf16 v[192:195], v[120:123], v[112:119], v250
    v_mad_u32_u16 v116, v206, s57, v213 op_sel:[1,0,0,0]
    v_mfma_f32_16x16x32_bf16 v[168:171], v[120:123], v[120:123], 0
    ds_read_b128 v[112:115], v116 offset:0
    v_mfma_f32_16x16x32_bf16 v[124:127], v[72:75], v[72:75], 0
    ds_read_b128 v[116:119], v116 offset:64
    v_mad_u32_u16 v122, v207, s57, v248 op_sel:[0,0,0,0]
    ds_read2_b32 v[120:121], v122 offset0:0 offset1:2
    v_mfma_f32_16x16x32_bf16 v[124:127], v[76:79], v[76:79], v[124:127]
    ds_read2_b32 v[122:123], v122 offset0:4 offset1:6
    ds_read_b128 v[204:207], v214 offset:6912
    v_mfma_f32_16x16x32_bf16 v[128:131], v[80:83], v[72:75], 0
    v_fmac_f32 v217, v189, v68
    v_fmac_f32 v217, v196, v200
    v_mfma_f32_16x16x32_bf16 v[128:131], v[84:87], v[76:79], v[128:131]
    v_fmac_f32 v217, v192, v69
    v_fmac_f32 v217, v197, v201
    v_mfma_f32_16x16x32_bf16 v[132:135], v[80:83], v[80:83], 0
    v_fmac_f32 v217, v193, v69
    v_fmac_f32 v217, v198, v202
    v_mfma_f32_16x16x32_bf16 v[132:135], v[84:87], v[84:87], v[132:135]
    v_fmac_f32 v217, v199, v203
    v_fmac_f32 v209, v153, v53
    v_mfma_f32_16x16x32_bf16 v[136:139], v[88:91], v[80:83], 0
    v_fmac_f32 v208, v154, v54
    v_fmac_f32 v209, v155, v55
    v_mfma_f32_16x16x32_bf16 v[136:139], v[92:95], v[84:87], v[136:139]
    v_fmac_f32 v208, v164, v60
    v_fmac_f32 v209, v165, v61
    v_mfma_f32_16x16x32_bf16 v[140:143], v[88:91], v[72:75], 0
    v_fmac_f32 v208, v166, v62
    v_fmac_f32 v209, v167, v63
    v_mfma_f32_16x16x32_bf16 v[140:143], v[92:95], v[76:79], v[140:143]
    s_waitcnt lgkmcnt(7)
    v_add_f32 v209, v209, v217
    v_smfmac_f32_16x16x64_bf16 v[196:199], v[8:11], v[132:139], v216
    v_fmac_f32 v208, v168, v70
    v_mfma_f32_16x16x32_bf16 v[144:147], v[96:99], v[72:75], 0
    v_fmac_f32 v208, v169, v71
    v_add_f32 v211, v208, v209
    v_mfma_f32_16x16x32_bf16 v[144:147], v[100:103], v[76:79], v[144:147]
    v_fma_f32 v208, v124, v0, -v217
    v_mul_f32 v209, v125, v1
    v_mfma_f32_16x16x32_bf16 v[148:151], v[80:83], v[96:99], 0
    v_fmac_f32 v208, v126, v2
    v_fmac_f32 v209, v127, v3
    v_mfma_f32_16x16x32_bf16 v[148:151], v[84:87], v[100:103], v[148:151]
    v_fmac_f32 v208, v128, v4
    v_fmac_f32 v209, v129, v5
    v_mfma_f32_16x16x32_bf16 v[152:155], v[88:91], v[96:99], 0
    v_fmac_f32 v208, v130, v6
    v_fmac_f32 v209, v131, v7
    v_mfma_f32_16x16x32_bf16 v[152:155], v[92:95], v[100:103], v[152:155]
    v_fmac_f32 v208, v140, v12
    v_fmac_f32 v209, v141, v13
    v_mfma_f32_16x16x32_bf16 v[156:159], v[88:91], v[88:91], 0
    v_fmac_f32 v208, v142, v14
    v_fmac_f32 v209, v143, v15
    v_mfma_f32_16x16x32_bf16 v[156:159], v[92:95], v[92:95], v[156:159]
    v_fmac_f32 v208, v144, v16
    v_fmac_f32 v209, v145, v17
    v_smfmac_f32_16x16x64_bf16 v[196:199], v[20:23], v[148:155], v216
    v_fmac_f32 v208, v146, v18
    v_mfma_f32_16x16x32_bf16 v[160:163], v[96:99], v[96:99], 0
    s_waitcnt lgkmcnt(0)
    v_fmac_f32 v209, v147, v19
    v_mfma_f32_16x16x32_bf16 v[160:163], v[100:103], v[100:103], v[160:163]
    v_fmac_f32 v208, v156, v24
    v_fmac_f32 v209, v157, v25
    v_mfma_f32_16x16x32_bf16 v[124:127], v[104:107], v[72:75], 0
    v_fmac_f32 v208, v158, v26
    v_fmac_f32 v209, v159, v27
    v_mfma_f32_16x16x32_bf16 v[124:127], v[108:111], v[76:79], v[124:127]
    v_permlane32_swap_b32 v210, v211
    s_waitcnt vmcnt(1)
    v_mfma_f32_16x16x32_bf16 v[128:131], v[112:115], v[72:75], 0
    v_fmac_f32 v208, v160, v28
    v_fmac_f32 v209, v161, v29
    v_mfma_f32_16x16x32_bf16 v[128:131], v[116:119], v[76:79], v[128:131]
    v_fmac_f32 v208, v162, v30
    v_fmac_f32 v209, v163, v31
    v_smfmac_f32_16x16x64_bf16 v[172:175], v[120:123], v[72:79], v250
    v_mad_u32_u16 v76, v204, s57, v213 op_sel:[0,0,0,0]
    v_mfma_f32_16x16x32_bf16 v[132:135], v[104:107], v[80:83], 0
    ds_read_b128 v[72:75], v76 offset:0
    ds_read_b128 v[76:79], v76 offset:64
    v_smfmac_f32_16x16x64_bf16 v[196:199], v[32:35], v[124:131], v216
    v_add_f32 v218, v210, v211
    v_mfma_f32_16x16x32_bf16 v[132:135], v[108:111], v[84:87], v[132:135]
    v_mul_f32 v217, v172, v64
    ds_write_b16 v215, v240 offset:0
    v_mfma_f32_16x16x32_bf16 v[136:139], v[112:115], v[80:83], 0
    v_fmac_f32 v217, v173, v64
    ds_write_b16 v215, v241 offset:576
    v_mfma_f32_16x16x32_bf16 v[136:139], v[116:119], v[84:87], v[136:139]
    ds_write_b16 v215, v242 offset:1152
    ds_write_b16 v215, v243 offset:1728
    v_smfmac_f32_16x16x64_bf16 v[176:179], v[120:123], v[80:87], v250
    v_mad_u32_u16 v84, v204, s57, v213 op_sel:[1,0,0,0]
    v_mfma_f32_16x16x32_bf16 v[140:143], v[104:107], v[88:91], 0
    ds_read_b128 v[80:83], v84 offset:0
    ds_read_b128 v[84:87], v84 offset:64
    v_mfma_f32_16x16x32_bf16 v[140:143], v[108:111], v[92:95], v[140:143]
    v_fmac_f32 v208, v132, v36
    v_fmac_f32 v209, v133, v37
    v_mfma_f32_16x16x32_bf16 v[144:147], v[112:115], v[88:91], 0
    v_fmac_f32 v217, v176, v65
    v_fmac_f32 v208, v134, v38
    v_mfma_f32_16x16x32_bf16 v[144:147], v[116:119], v[92:95], v[144:147]
    v_fmac_f32 v217, v177, v65
    v_fmac_f32 v209, v135, v39
    v_smfmac_f32_16x16x64_bf16 v[180:183], v[120:123], v[88:95], v250
    v_mad_u32_u16 v92, v205, s57, v213 op_sel:[0,0,0,0]
    v_mfma_f32_16x16x32_bf16 v[148:151], v[104:107], v[96:99], 0
    ds_read_b128 v[88:91], v92 offset:0
    ds_read_b128 v[92:95], v92 offset:64
    v_smfmac_f32_16x16x64_bf16 v[196:199], v[44:47], v[140:147], v216
    v_fmac_f32 v208, v136, v40
    v_mfma_f32_16x16x32_bf16 v[148:151], v[108:111], v[100:103], v[148:151]
    v_fmac_f32 v217, v180, v66
    v_fmac_f32 v209, v137, v41
    v_mfma_f32_16x16x32_bf16 v[152:155], v[112:115], v[96:99], 0
    v_fmac_f32 v217, v181, v66
    v_fmac_f32 v208, v138, v42
    v_mfma_f32_16x16x32_bf16 v[152:155], v[116:119], v[100:103], v[152:155]
    v_fmac_f32 v209, v139, v43
    buffer_load_dwordx4 v[240:243], v249, s[16:19], s74 offen offset:0
    v_smfmac_f32_16x16x64_bf16 v[184:187], v[120:123], v[96:103], v250
    v_mad_u32_u16 v100, v205, s57, v213 op_sel:[1,0,0,0]
    v_mfma_f32_16x16x32_bf16 v[156:159], v[104:107], v[104:107], 0
    ds_read_b128 v[96:99], v100 offset:0
    ds_read_b128 v[100:103], v100 offset:64
    v_mfma_f32_16x16x32_bf16 v[156:159], v[108:111], v[108:111], v[156:159]
    v_fmac_f32 v208, v148, v48
    v_fmac_f32 v209, v149, v49
    v_mfma_f32_16x16x32_bf16 v[160:163], v[112:115], v[104:107], 0
    v_fmac_f32 v217, v184, v67
    v_fmac_f32 v208, v150, v50
    v_mfma_f32_16x16x32_bf16 v[160:163], v[116:119], v[108:111], v[160:163]
    v_fmac_f32 v217, v185, v67
    v_fmac_f32 v209, v151, v51
    v_smfmac_f32_16x16x64_bf16 v[188:191], v[120:123], v[104:111], v250
    v_mad_u32_u16 v108, v206, s57, v213 op_sel:[0,0,0,0]
    v_mfma_f32_16x16x32_bf16 v[164:167], v[112:115], v[112:115], 0
    ds_read_b128 v[104:107], v108 offset:0
    ds_read_b128 v[108:111], v108 offset:64
    v_smfmac_f32_16x16x64_bf16 v[196:199], v[56:59], v[156:163], v216
    s_waitcnt lgkmcnt(4)
    v_mfma_f32_16x16x32_bf16 v[164:167], v[116:119], v[116:119], v[164:167]
    v_fmac_f32 v217, v188, v68
    v_fmac_f32 v208, v152, v52
    v_smfmac_f32_16x16x64_bf16 v[192:195], v[120:123], v[112:119], v250
    v_mad_u32_u16 v116, v206, s57, v213 op_sel:[1,0,0,0]
    v_mfma_f32_16x16x32_bf16 v[168:171], v[120:123], v[120:123], 0
    ds_read_b128 v[112:115], v116 offset:0
    v_mfma_f32_16x16x32_bf16 v[124:127], v[72:75], v[72:75], 0
    ds_read_b128 v[116:119], v116 offset:64
    v_mad_u32_u16 v122, v207, s57, v248 op_sel:[0,0,0,0]
    ds_read2_b32 v[120:121], v122 offset0:0 offset1:2
    v_mfma_f32_16x16x32_bf16 v[124:127], v[76:79], v[76:79], v[124:127]
    ds_read2_b32 v[122:123], v122 offset0:4 offset1:6
    ds_read_b128 v[204:207], v214 offset:0
    v_mfma_f32_16x16x32_bf16 v[128:131], v[80:83], v[72:75], 0
    v_fmac_f32 v217, v189, v68
    v_fmac_f32 v217, v196, v200
    v_mfma_f32_16x16x32_bf16 v[128:131], v[84:87], v[76:79], v[128:131]
    v_fmac_f32 v217, v192, v69
    v_fmac_f32 v217, v197, v201
    v_mfma_f32_16x16x32_bf16 v[132:135], v[80:83], v[80:83], 0
    v_fmac_f32 v217, v193, v69
    v_fmac_f32 v217, v198, v202
    v_mfma_f32_16x16x32_bf16 v[132:135], v[84:87], v[84:87], v[132:135]
    v_fmac_f32 v217, v199, v203
    v_fmac_f32 v209, v153, v53
    v_mfma_f32_16x16x32_bf16 v[136:139], v[88:91], v[80:83], 0
    v_fmac_f32 v208, v154, v54
    v_fmac_f32 v209, v155, v55
    v_mfma_f32_16x16x32_bf16 v[136:139], v[92:95], v[84:87], v[136:139]
    v_fmac_f32 v208, v164, v60
    v_fmac_f32 v209, v165, v61
    v_mfma_f32_16x16x32_bf16 v[140:143], v[88:91], v[72:75], 0
    v_fmac_f32 v208, v166, v62
    v_fmac_f32 v209, v167, v63
    v_mfma_f32_16x16x32_bf16 v[140:143], v[92:95], v[76:79], v[140:143]
    s_waitcnt lgkmcnt(7)
    v_add_f32 v209, v209, v217
    v_smfmac_f32_16x16x64_bf16 v[196:199], v[8:11], v[132:139], v216
    v_fmac_f32 v208, v168, v70
    v_mfma_f32_16x16x32_bf16 v[144:147], v[96:99], v[72:75], 0
    v_fmac_f32 v208, v169, v71
    v_add_f32 v210, v208, v209
    v_mfma_f32_16x16x32_bf16 v[144:147], v[100:103], v[76:79], v[144:147]
    v_fma_f32 v208, v124, v0, -v217
    v_mul_f32 v209, v125, v1
    v_mfma_f32_16x16x32_bf16 v[148:151], v[80:83], v[96:99], 0
    v_fmac_f32 v208, v126, v2
    v_fmac_f32 v209, v127, v3
    v_mfma_f32_16x16x32_bf16 v[148:151], v[84:87], v[100:103], v[148:151]
    v_fmac_f32 v208, v128, v4
    v_fmac_f32 v209, v129, v5
    v_mfma_f32_16x16x32_bf16 v[152:155], v[88:91], v[96:99], 0
    v_fmac_f32 v208, v130, v6
    v_fmac_f32 v209, v131, v7
    v_mfma_f32_16x16x32_bf16 v[152:155], v[92:95], v[100:103], v[152:155]
    v_fmac_f32 v208, v140, v12
    v_fmac_f32 v209, v141, v13
    v_mfma_f32_16x16x32_bf16 v[156:159], v[88:91], v[88:91], 0
    v_fmac_f32 v208, v142, v14
    v_fmac_f32 v209, v143, v15
    v_mfma_f32_16x16x32_bf16 v[156:159], v[92:95], v[92:95], v[156:159]
    v_fmac_f32 v208, v144, v16
    v_fmac_f32 v209, v145, v17
    v_smfmac_f32_16x16x64_bf16 v[196:199], v[20:23], v[148:155], v216
    v_fmac_f32 v208, v146, v18
    v_mfma_f32_16x16x32_bf16 v[160:163], v[96:99], v[96:99], 0
    s_waitcnt lgkmcnt(0)
    v_fmac_f32 v209, v147, v19
    v_mfma_f32_16x16x32_bf16 v[160:163], v[100:103], v[100:103], v[160:163]
    v_fmac_f32 v208, v156, v24
    v_fmac_f32 v209, v157, v25
    v_mfma_f32_16x16x32_bf16 v[124:127], v[104:107], v[72:75], 0
    v_fmac_f32 v208, v158, v26
    v_fmac_f32 v209, v159, v27
    v_mfma_f32_16x16x32_bf16 v[124:127], v[108:111], v[76:79], v[124:127]
    v_add_f32_dpp v220, v220, v220 quad_perm:[1,0,3,2] row_mask:0xf bank_mask:0xf
    s_sub_u32 s58, s58, 1
    v_mfma_f32_16x16x32_bf16 v[128:131], v[112:115], v[72:75], 0
    v_fmac_f32 v208, v160, v28
    v_fmac_f32 v209, v161, v29
    v_mfma_f32_16x16x32_bf16 v[128:131], v[116:119], v[76:79], v[128:131]
    v_fmac_f32 v208, v162, v30
    v_fmac_f32 v209, v163, v31
    v_smfmac_f32_16x16x64_bf16 v[172:175], v[120:123], v[72:79], v250
    v_mad_u32_u16 v76, v204, s57, v213 op_sel:[0,0,0,0]
    v_mfma_f32_16x16x32_bf16 v[132:135], v[104:107], v[80:83], 0
    ds_read_b128 v[72:75], v76 offset:0
    ds_read_b128 v[76:79], v76 offset:64
    v_smfmac_f32_16x16x64_bf16 v[196:199], v[32:35], v[124:131], v216
    v_add_f32_dpp v220, v220, v220 quad_perm:[2,3,0,1] row_mask:0xf bank_mask:0xf
    v_mfma_f32_16x16x32_bf16 v[132:135], v[108:111], v[84:87], v[132:135]
    v_mul_f32 v217, v172, v64
    v_mfma_f32_16x16x32_bf16 v[136:139], v[112:115], v[80:83], 0
    v_fmac_f32 v217, v173, v64
    v_add_f32_dpp v220, v220, v220 row_half_mirror row_mask:0xf bank_mask:0xf
    v_mfma_f32_16x16x32_bf16 v[136:139], v[116:119], v[84:87], v[136:139]
    v_smfmac_f32_16x16x64_bf16 v[176:179], v[120:123], v[80:87], v250
    v_mad_u32_u16 v84, v204, s57, v213 op_sel:[1,0,0,0]
    v_mfma_f32_16x16x32_bf16 v[140:143], v[104:107], v[88:91], 0
    ds_read_b128 v[80:83], v84 offset:0
    ds_read_b128 v[84:87], v84 offset:64
    v_mfma_f32_16x16x32_bf16 v[140:143], v[108:111], v[92:95], v[140:143]
    v_fmac_f32 v208, v132, v36
    v_fmac_f32 v209, v133, v37
    v_mfma_f32_16x16x32_bf16 v[144:147], v[112:115], v[88:91], 0
    v_fmac_f32 v217, v176, v65
    v_fmac_f32 v208, v134, v38
    v_mfma_f32_16x16x32_bf16 v[144:147], v[116:119], v[92:95], v[144:147]
    v_fmac_f32 v217, v177, v65
    v_fmac_f32 v209, v135, v39
    v_smfmac_f32_16x16x64_bf16 v[180:183], v[120:123], v[88:95], v250
    v_mad_u32_u16 v92, v205, s57, v213 op_sel:[0,0,0,0]
    v_mfma_f32_16x16x32_bf16 v[148:151], v[104:107], v[96:99], 0
    ds_read_b128 v[88:91], v92 offset:0
    ds_read_b128 v[92:95], v92 offset:64
    v_smfmac_f32_16x16x64_bf16 v[196:199], v[44:47], v[140:147], v216
    v_fmac_f32 v208, v136, v40
    v_mfma_f32_16x16x32_bf16 v[148:151], v[108:111], v[100:103], v[148:151]
    v_fmac_f32 v217, v180, v66
    v_fmac_f32 v209, v137, v41
    v_mfma_f32_16x16x32_bf16 v[152:155], v[112:115], v[96:99], 0
    v_fmac_f32 v217, v181, v66
    v_fmac_f32 v208, v138, v42
    v_mfma_f32_16x16x32_bf16 v[152:155], v[116:119], v[100:103], v[152:155]
    v_fmac_f32 v209, v139, v43
    v_cndmask_b32_dpp v212, v212, v220, vcc row_shr:1 row_mask:0xf bank_mask:0xf bound_ctrl:0
    v_smfmac_f32_16x16x64_bf16 v[184:187], v[120:123], v[96:103], v250
    v_mad_u32_u16 v100, v205, s57, v213 op_sel:[1,0,0,0]
    v_mfma_f32_16x16x32_bf16 v[156:159], v[104:107], v[104:107], 0
    ds_read_b128 v[96:99], v100 offset:0
    ds_read_b128 v[100:103], v100 offset:64
    v_mfma_f32_16x16x32_bf16 v[156:159], v[108:111], v[108:111], v[156:159]
    v_fmac_f32 v208, v148, v48
    v_fmac_f32 v209, v149, v49
    v_mfma_f32_16x16x32_bf16 v[160:163], v[112:115], v[104:107], 0
    v_fmac_f32 v217, v184, v67
    v_fmac_f32 v208, v150, v50
    v_mfma_f32_16x16x32_bf16 v[160:163], v[116:119], v[108:111], v[160:163]
    v_fmac_f32 v217, v185, v67
    v_fmac_f32 v209, v151, v51
    v_smfmac_f32_16x16x64_bf16 v[188:191], v[120:123], v[104:111], v250
    v_mad_u32_u16 v108, v206, s57, v213 op_sel:[0,0,0,0]
    v_mfma_f32_16x16x32_bf16 v[164:167], v[112:115], v[112:115], 0
    ds_read_b128 v[104:107], v108 offset:0
    ds_read_b128 v[108:111], v108 offset:64
    v_smfmac_f32_16x16x64_bf16 v[196:199], v[56:59], v[156:163], v216
    s_waitcnt lgkmcnt(4)
    v_mfma_f32_16x16x32_bf16 v[164:167], v[116:119], v[116:119], v[164:167]
    v_fmac_f32 v217, v188, v68
    v_fmac_f32 v208, v152, v52
    v_smfmac_f32_16x16x64_bf16 v[192:195], v[120:123], v[112:119], v250
    v_mad_u32_u16 v116, v206, s57, v213 op_sel:[1,0,0,0]
    v_mfma_f32_16x16x32_bf16 v[168:171], v[120:123], v[120:123], 0
    ds_read_b128 v[112:115], v116 offset:0
    s_cbranch_scc0 k1_kernel_loop
    ds_read_b32 v43, v252 offset:24
    s_nop 7
    v_fmac_f32 v217, v189, v68
    v_fmac_f32 v217, v196, v200
    v_fmac_f32 v217, v192, v69
    v_fmac_f32 v217, v197, v201
    v_fmac_f32 v217, v193, v69
    v_fmac_f32 v217, v198, v202
    v_fmac_f32 v217, v199, v203
    v_fmac_f32 v209, v153, v53
    v_fmac_f32 v208, v154, v54
    v_fmac_f32 v209, v155, v55
    v_fmac_f32 v208, v164, v60
    v_fmac_f32 v209, v165, v61
    v_fmac_f32 v208, v166, v62
    v_fmac_f32 v209, v167, v63
    v_add_f32 v209, v209, v217
    v_fmac_f32 v208, v168, v70
    v_fmac_f32 v208, v169, v71
    v_add_f32 v211, v208, v209
    v_and_b32 v40, 7, v255
    s_mul_i32 s76, s36, 7
    v_permlane32_swap_b32 v210, v211
    v_add_f32 v219, v210, v211
    s_waitcnt lgkmcnt(0)
    v_lshrrev_b32 v41, 5, v255
    v_permlane16_swap_b32 v218, v219
    v_add_f32 v220, v218, v219
    s_xor_b32 s76, s76, 7
    v_bfe_u32 v42, v255, 4, 1
    v_add_f32_dpp v220, v220, v220 quad_perm:[1,0,3,2] row_mask:0xf bank_mask:0xf
    v_xor_b32 v40, s76, v40
    v_lshl_add_u32 v41, v42, 1, v41
    v_add_f32_dpp v220, v220, v220 quad_perm:[2,3,0,1] row_mask:0xf bank_mask:0xf
    s_lshl_b32 s74, s72, 2
    v_lshl_add_u32 v40, v40, 2, v41
    v_add_f32_dpp v220, v220, v220 row_half_mirror row_mask:0xf bank_mask:0xf
    v_cndmask_b32_dpp v212, v212, v220, vcc row_shr:1 row_mask:0xf bank_mask:0xf bound_ctrl:0
    s_lshl_b32 s76, s36, 16
    v_lshlrev_b32 v113, 2, v40
    v_add_f32_dpp v112, v212, v212 row_ror:8 row_mask:0xf bank_mask:0xf
    s_add_u32 s74, s74, s76
    s_add_u32 s74, s74, 29360128
    v_readfirstlane_b32 s64, v43
    s_waitcnt vmcnt(0)
    v_min_u32 v112, -2, v112
    s_branch k1_kernel_k2
k1_kernel_last:
    s_endpgm
.section .rodata,"a"
.p2align 6
.amdhsa_kernel standalone__deep_cross_pnn__recsys_kernel
  .amdhsa_next_free_vgpr 256
  .amdhsa_next_free_sgpr 102
  .amdhsa_accum_offset 256
  .amdhsa_group_segment_fixed_size 0
  .amdhsa_kernarg_size 80
  .amdhsa_user_sgpr_count 2
  .amdhsa_user_sgpr_kernarg_segment_ptr 1
  .amdhsa_system_sgpr_workgroup_id_x 1
.end_amdhsa_kernel
```

```asm
; @launch grid=(256,1,1) block=(512,1,1) lds=163840
.amdgcn_target "amdgcn-amd-amdhsa--gfx950"
.text
.globl standalone__deep_cross_pnn__recsys_kernel
.p2align 8
.type standalone__deep_cross_pnn__recsys_kernel,@function
standalone__deep_cross_pnn__recsys_kernel:

    s_cmp_ge_u32 s2, 256
    s_cbranch_scc1 k1_kernel_end

    s_load_dwordx8 s[4:11], s[0:1], 0
    s_load_dwordx2 s[12:13], s[0:1], 72
    s_load_dwordx2 s[52:53], s[0:1], 64

    v_cmp_gt_u32 vcc, 40, v0
    s_and_saveexec_b64 s[48:49], vcc
    s_cbranch_execz k1_kernel_ncp
    s_getpc_b64 s[46:47]
k1_kernel_pc:
    s_bfe_u32 s38, s2, 0x40003
    s_lshl_b32 s38, s38, 7
    v_lshl_add_u32 v2, v0, 11, s38
    v_min_u32 v2, k1_kernel_last-k1_kernel_pc, v2
    global_load_dword v250, v2, s[46:47]
k1_kernel_ncp:
    s_mov_b64 exec, s[48:49]

    v_lshrrev_b32 v1, 6, v0
    v_and_b32 v255, 63, v0
    s_bfe_u32 s36, s2, 0x10003
    v_readfirstlane_b32 s3, v1
    s_lshr_b32 s37, s2, 4
    s_lshl_b32 s37, s37, 3
    s_and_b32 s38, s2, 7
    s_or_b32 s37, s37, s38
    v_lshlrev_b32 v254, 4, v255
    v_mov_b32 v252, 144144
    v_mov_b32 v253, 1
    v_mov_b32 v40, 0
    v_lshl_add_u32 v41, v0, 2, v252
    v_cmp_gt_u32 vcc, 8, v0
    s_and_saveexec_b64 s[46:47], vcc
    ds_write_b32 v41, v40
    s_mov_b64 exec, s[46:47]
    v_mul_u32_u24 v6, 57, v255
    v_lshrrev_b32 v6, 9, v6
    v_mul_u32_u24 v5, 9, v6
    v_sub_u32 v5, v255, v5
    v_cmp_gt_u32 s[40:41], 8, v5
    s_lshl_b32 s38, s36, 7
    v_lshl_add_u32 v5, v5, 4, s38
    v_lshl_add_u32 v83, v6, 8, v5
    s_and_b32 s56, s3, 3
    s_bitset0_b32 s41, 31
    s_lshr_b32 s42, s2, 3
    s_mul_i32 s42, s42, 36
    s_lshr_b32 s42, s42, 5
    s_lshl_b32 s42, s42, 2
    s_add_u32 s42, s42, s56
    s_mov_b32 s43, s42
    s_mov_b32 s50, s36
    s_lshl_b32 s72, s37, 7
    s_lshl_b32 s73, s3, 5
    s_add_u32 s72, s72, s73
    s_mul_i32 s74, s72, 400
    s_mul_i32 s45, s36, 11200
    s_add_u32 s74, s74, s45
    s_lshl_b32 s38, s3, 10
    s_add_u32 m0, s38, 144384

    s_mov_b32 s18, 6553600
    s_mov_b32 s19, 0x00020000
    s_mov_b32 s22, 256000
    s_mov_b32 s23, 0x00020000
    s_mov_b32 s26, 20000
    s_mov_b32 s27, 0x00020000
    s_mov_b32 s30, 13107200
    s_mov_b32 s31, 0x00020000
    s_mov_b32 s34, 268435456
    s_mov_b32 s35, 0x00020000
    s_mov_b32 s14, 268435456
    s_mov_b32 s15, 0x00020000
    s_mov_b32 s54, 256
    s_mov_b32 s55, 0x00020000

    v_bfe_u32 v5, v255, 2, 2
    v_mul_u32_u24 v5, 200, v5
    v_and_b32 v6, 3, v255
    v_lshl_add_u32 v5, v6, 5, v5
    v_and_b32 v6, 32, v255
    v_lshl_add_u32 v5, v6, 2, v5
    v_and_b32 v6, 16, v255
    v_add_u32 v5, v5, v6
    s_movk_i32 s39, 19200
    s_cmp_ge_u32 s3, 4
    s_waitcnt lgkmcnt(0)
    s_barrier
    s_cbranch_scc1 k1_kernel_dma

    s_mov_b32 s24, s8
    s_and_b32 s25, s9, 0xffff
    buffer_load_dwordx4 v254, s[24:27], s38 offen lds
    s_add_u32 s38, s38, 4096
    s_add_u32 m0, s38, 144384
    s_mov_b32 s16, s4
    s_and_b32 s17, s5, 0xffff
    buffer_load_dwordx4 v254, s[24:27], s38 offen lds
    s_add_u32 s38, s38, 4096
    s_add_u32 m0, s38, 144384
    v_cmp_lt_u32 vcc, 24, v255
    buffer_load_dwordx4 v254, s[24:27], s38 offen lds
    s_add_u32 s38, s38, 4096
    s_add_u32 m0, s38, 144384
    v_subbrev_co_u32 v249, vcc, 0, v255, vcc
    buffer_load_dwordx4 v254, s[24:27], s38 offen lds
    s_add_u32 s38, s38, 4096
    s_min_u32 s38, s38, 18432
    s_add_u32 m0, s38, 144384
    v_min_u32 v249, 49, v249
    v_lshlrev_b32 v249, 4, v249
    buffer_load_dwordx4 v254, s[24:27], s38 offen lds
    buffer_load_dwordx4 v[232:235], v5, s[24:27], s39 offen
    buffer_load_dwordx4 v[240:243], v249, s[16:19], s74 offen offset:0
    buffer_load_dwordx4 v[244:247], v249, s[16:19], s74 offen offset:800

    s_mul_i32 s77, s36, -3200
    s_mul_i32 s78, s72, 400
    s_addk_i32 s77, 1600
    s_add_u32 s79, s78, 11200
    s_add_u32 s74, s74, s77

    s_branch k1_kernel_main
k1_kernel_dma:
    s_mov_b32 s20, s6
    s_and_b32 s21, s7, 0xffff
    s_mov_b64 exec, s[40:41]
k1_kernel_dml:

    s_min_u32 s38, s42, 142
    s_mul_i32 m0, s38, 1008
    s_mul_i32 s39, s38, 1792
    s_add_u32 s42, s42, 4
    buffer_load_dwordx4 v83, s[20:23], s39 offen lds
    s_cmp_ge_u32 s42, 144
    s_cselect_b32 s38, 144, 0
    s_sub_u32 s42, s42, s38
    s_cmp_lg_u32 s42, s43
    s_cbranch_scc1 k1_kernel_dml
    s_mov_b64 exec, -1

    s_mov_b32 s16, s4
    s_and_b32 s17, s5, 0xffff
    s_mov_b32 s20, s6
    s_and_b32 s21, s7, 0xffff
    s_mov_b32 s28, s10
    s_and_b32 s29, s11, 0xffff
    s_mov_b32 s32, s12
    s_and_b32 s33, s13, 0xffff
    s_and_b32 s13, s13, 0xffff
    s_and_b32 s53, s53, 0xffff
k1_kernel_aux:

    s_setprio 0
    v_mov_b32 v8, v255
    v_mov_b32 v9, v254
    v_mov_b32 v10, v253
    v_mov_b32 v11, v252
    s_mov_b32 s51, s2
    s_mov_b32 s64, 0
    s_mov_b32 s65, 0

k1_kernel_unit:

    s_bfe_u32 s60, s51, 0x10003
    s_lshr_b32 s38, s51, 7
    s_xnor_b32 s36, s60, s38
    s_and_b32 s36, s36, 1

    s_lshr_b32 s38, s51, 4
    s_and_b32 s39, s51, 7
    s_sub_u32 s57, 2, s36
    s_lshl_b32 s57, s39, s57
    s_lshl_b32 s37, s36, 5
    s_add_u32 s57, s57, s37
    s_add_u32 s57, s57, s56
    s_mul_i32 s37, s38, 48
    s_add_u32 s37, s37, s57
    s_lshl_b32 s38, s38, 1
    s_lshr_b32 s39, s39, 2
    s_add_u32 s38, s38, s39
    s_add_u32 s38, s38, 768
    s_and_b32 s57, s57, 7
    s_cmp_eq_u32 s57, 2
    s_cselect_b32 s38, s38, 1000
    s_lshl_b32 s39, s36, 1
    s_and_b32 s39, s39, s56
    s_cselect_b32 s57, s38, s37

    s_mov_b32 s63, s36
    s_mov_b32 s36, s60
    s_lshr_b32 s37, s51, 4
    s_lshl_b32 s37, s37, 3
    s_and_b32 s38, s51, 7
    s_or_b32 s37, s37, s38
    s_and_b32 s58, s56, 1
    s_lshl_b32 s59, s37, 1
    s_add_u32 s58, s58, s59
    s_lshr_b32 s59, s56, 1
    s_xor_b32 s62, s59, 1
    s_and_b32 s59, s59, s63
    s_add_u32 s61, s63, 6
    s_mul_i32 s61, s61, s62
    s_mul_i32 s60, s36, 12
    s_add_u32 s61, s61, s60
    s_mul_i32 s60, s58, 25600
    s_lshl4_add_u32 s60, s61, s60
    s_cmp_eq_u32 s61, 7
    s_cselect_b32 s38, 5, 99
    s_movk_i32 s61, 400
    v_lshrrev_b32 v1, 3, v8
    v_and_b32 v2, 7, v8
    v_cmp_ne_u32 vcc, s38, v2
    v_mul_u32_u24 v0, s61, v1
    v_cmp_gt_u32 s[48:49], 7, v2
    v_cndmask_b32 v5, 17, v2, vcc
    v_lshl_add_u32 v0, v5, 4, v0
    v_and_b32 v5, 15, v8
    v_and_b32 v6, 48, v8
    v_lshl_add_u32 v7, v5, 8, v6
    s_lshl_b32 s44, s56, 15
    s_xor_b32 s38, s50, 1
    s_lshl_b32 s38, s38, 7
    s_add_u32 s44, s44, s38

    s_mov_b64 exec, s[48:49]
    buffer_load_dwordx4 v[224:227], v0, s[16:19], s60 offen
    s_add_u32 s60, s60, 3200
    buffer_load_dwordx4 v[228:231], v0, s[16:19], s60 offen
    s_add_u32 s60, s60, 3200
    buffer_load_dwordx4 v[232:235], v0, s[16:19], s60 offen
    s_add_u32 s60, s60, 3200
    buffer_load_dwordx4 v[236:239], v0, s[16:19], s60 offen
    s_add_u32 s60, s60, 3200
    buffer_load_dwordx4 v[240:243], v0, s[16:19], s60 offen
    s_add_u32 s60, s60, 3200
    buffer_load_dwordx4 v[244:247], v0, s[16:19], s60 offen
    s_add_u32 s60, s60, 3200
    buffer_load_dwordx4 v[248:251], v0, s[16:19], s60 offen
    s_add_u32 s60, s60, 3200
    buffer_load_dwordx4 v[252:255], v0, s[16:19], s60 offen
    s_add_u32 s60, s60, 3200
    s_mov_b64 exec, -1

    s_lshr_b32 s78, s57, 5
    s_bfe_u32 s79, s57, 0x20003
    s_bfe_u32 s80, s57, 0x20001
    s_and_b32 s81, s57, 1
    s_lshl_b32 s77, s78, 2
    s_lshl_b32 s83, s81, 1
    s_add_u32 s77, s77, s83
    s_lshl_b32 s77, s77, 7
    s_lshl_b32 s83, s79, 5
    s_add_u32 s77, s77, s83
    s_lshl_b32 s83, s80, 3
    s_add_u32 s77, s77, s83
    s_lshl_b32 s77, s77, 10
    s_lshl_b32 s82, s78, 12
    s_lshl_b32 s83, s79, 10
    s_add_u32 s82, s82, s83
    s_lshl_b32 s83, s80, 8
    s_add_u32 s82, s82, s83
    s_lshl_b32 s83, s81, 7
    s_add_u32 s82, s82, s83
    s_mov_b32 s84, 205312
    v_lshrrev_b32 v3, 2, v8
    v_and_b32 v4, 3, v8
    v_mul_lo_u32 v14, v3, s84
    v_lshl_add_u32 v14, v4, 4, v14
    s_lshl_b32 s61, s56, 12
    s_add_u32 s61, s61, 147456
    v_and_b32 v3, 3, v3
    v_lshlrev_b32 v36, 6, v8
    v_lshl_add_u32 v36, v3, 4, v36
    v_add_u32 v36, s61, v36
    v_xor_b32 v37, 16, v36
    v_xor_b32 v38, 32, v36
    v_xor_b32 v39, 48, v36
    v_and_b32 v3, 48, v8
    v_xor_b32 v15, v3, v9
    v_add_u32 v15, s61, v15
    s_mov_b32 s84, 0x05040100
    s_mov_b32 s85, 0x07060302
    s_cmp_eq_u32 s64, 0
    s_cbranch_scc1 k1_kernel_nsig0
    s_waitcnt vmcnt(0)

k1_kernel_nsig0:

    s_waitcnt vmcnt(8)
    s_cmp_lg_u32 s64, 0
    s_cbranch_scc1 k1_kernel_nsig

    s_mov_b64 exec, 1
    ds_add_u32 v11, v10 offset:16
    s_mov_b64 exec, -1

k1_kernel_nsig:
    s_setprio 3

    s_lshl_b32 s61, s56, 12
    s_add_u32 s61, s61, 147456
    v_lshlrev_b32 v86, 2, v8
    v_add_u32 v86, s61, v86
    v_and_b32 v85, 0xffffff80, v86
    v_and_b32 v123, 32, v8
    s_add_u32 s61, s61, 256
    v_mul_u32_u24 v31, 56, v8
    v_add_u32 v31, s61, v31
    v_mul_u32_u24 v34, 56, v1
    v_lshl_add_u32 v34, v2, 3, v34
    v_add_u32 v34, s61, v34
    s_lshl_b32 s61, s62, s63
    v_add_u32 v2, s61, v2
    v_subrev_u32 v3, 5, v2
    v_min_u32 v2, v2, v3
    v_mov_b32 v13, 0
    v_mul_u32_u24 v2, 0x10001, v2
    v_lshlrev_b32 v2, 12, v2
    v_add_u32 v32, 67108864, v2
    v_add_u32 v33, 201328640, v2
    v_mov_b32 v71, 0xf00
    s_add_u32 s61, s63, 7
    s_xor_b32 s63, s63, 1
    s_cmp_eq_u32 s62, 1
    s_cselect_b32 s62, s61, s63
    s_cmp_eq_u32 s62, 8
    s_cselect_b32 s80, 1, 0
    s_mul_i32 s63, s36, 13
    s_add_u32 s62, s62, s63
    s_lshl_b32 s62, s62, 7
    s_and_b32 s63, s58, 127
    s_add_u32 s62, s62, s63
    s_lshl_b32 s62, s62, 10
    s_add_u32 s62, s62, 16777216
    s_cmp_eq_u32 s59, 1
    s_cselect_b32 s63, -16, 0x0ffffff0
    s_movk_i32 s66, 0x7c
    s_mov_b32 s67, 0x001f001f
    s_mov_b32 s75, 0x06040200
    v_mov_b32 v54, 0x08040201
    v_mov_b32 v55, 0x80402010

    s_lshl_b32 s72, s2, 15
    s_lshl_b32 s73, s56, 13
    s_add_u32 s72, s72, s73
    s_add_u32 s72, s72, 20971520
    s_lshl_b32 s73, s36, 9
    s_lshl2_add_u32 s73, s37, s73
    s_add_u32 s73, s73, s56
    s_lshl_b32 s73, s73, 7
    s_add_u32 s73, s73, 29360128

k1_kernel_wf3:

    ds_read_b32 v12, v11 offset:12
    s_waitcnt lgkmcnt(0)
    v_readfirstlane_b32 s45, v12
    s_cmp_lt_u32 s45, 4
    s_cbranch_scc1 k1_kernel_wf3

    s_mov_b64 exec, s[48:49]

    s_waitcnt vmcnt(7)
    v_lshl_or_b32 v224, v225, 16, v224
    v_lshl_or_b32 v225, v227, 16, v226
    v_add_u32 v224, v32, v224
    v_add_u32 v225, v33, v225
    ds_write_b64 v34, v[224:225] offset:0

    s_waitcnt vmcnt(6)
    v_lshl_or_b32 v228, v229, 16, v228
    v_lshl_or_b32 v229, v231, 16, v230
    v_add_u32 v228, v32, v228
    v_add_u32 v229, v33, v229
    ds_write_b64 v34, v[228:229] offset:448

    s_waitcnt vmcnt(5)
    v_lshl_or_b32 v232, v233, 16, v232
    v_lshl_or_b32 v233, v235, 16, v234
    v_add_u32 v232, v32, v232
    v_add_u32 v233, v33, v233
    ds_write_b64 v34, v[232:233] offset:896

    s_waitcnt vmcnt(4)
    v_lshl_or_b32 v236, v237, 16, v236
    v_lshl_or_b32 v237, v239, 16, v238
    v_add_u32 v236, v32, v236
    v_add_u32 v237, v33, v237
    ds_write_b64 v34, v[236:237] offset:1344

    s_waitcnt vmcnt(3)
    v_lshl_or_b32 v240, v241, 16, v240
    v_lshl_or_b32 v241, v243, 16, v242
    v_add_u32 v240, v32, v240
    v_add_u32 v241, v33, v241
    ds_write_b64 v34, v[240:241] offset:1792

    s_waitcnt vmcnt(2)
    v_lshl_or_b32 v244, v245, 16, v244
    v_lshl_or_b32 v245, v247, 16, v246
    v_add_u32 v244, v32, v244
    v_add_u32 v245, v33, v245
    ds_write_b64 v34, v[244:245] offset:2240

    s_waitcnt vmcnt(1)
    v_lshl_or_b32 v248, v249, 16, v248
    v_lshl_or_b32 v249, v251, 16, v250
    v_add_u32 v248, v32, v248
    v_add_u32 v249, v33, v249
    ds_write_b64 v34, v[248:249] offset:2688

    s_waitcnt vmcnt(0)
    v_lshl_or_b32 v252, v253, 16, v252
    v_lshl_or_b32 v253, v255, 16, v254
    v_add_u32 v252, v32, v252
    v_add_u32 v253, v33, v253
    ds_write_b64 v34, v[252:253] offset:3136

    s_mov_b64 exec, -1
    ds_read_b64 v[40:41], v31 offset:0
    ds_read_b64 v[42:43], v31 offset:8
    ds_read_b64 v[44:45], v31 offset:16
    ds_read_b64 v[46:47], v31 offset:24
    ds_read_b64 v[48:49], v31 offset:32
    ds_read_b64 v[50:51], v31 offset:40
    ds_read_b64 v[52:53], v31 offset:48

    s_waitcnt lgkmcnt(6)
    v_perm_b32 v72, v41, v40, s75
    v_lshrrev_b32 v73, 3, v72
    v_lshlrev_b32 v64, 2, v72
    v_and_b32 v72, 0x07070707, v72
    v_and_b32 v0, 0x03030303, v73
    v_perm_b32 v16, v55, v54, v72
    v_xor_b32 v23, v55, v16

    s_waitcnt lgkmcnt(5)
    v_perm_b32 v72, v43, v42, s75
    v_lshrrev_b32 v73, 3, v72
    v_lshlrev_b32 v65, 2, v72
    v_and_b32 v72, 0x07070707, v72
    v_and_b32 v1, 0x03030303, v73
    v_perm_b32 v17, v55, v54, v72
    v_xor_b32 v24, v55, v17

    s_waitcnt lgkmcnt(4)
    v_perm_b32 v72, v45, v44, s75
    v_lshrrev_b32 v73, 3, v72
    v_lshlrev_b32 v66, 2, v72
    v_and_b32 v72, 0x07070707, v72
    v_and_b32 v2, 0x03030303, v73
    v_perm_b32 v18, v55, v54, v72
    v_xor_b32 v25, v55, v18

    s_waitcnt lgkmcnt(3)
    v_perm_b32 v72, v47, v46, s75
    v_lshrrev_b32 v73, 3, v72
    v_lshlrev_b32 v67, 2, v72
    v_and_b32 v72, 0x07070707, v72
    v_and_b32 v3, 0x03030303, v73
    v_perm_b32 v19, v55, v54, v72
    v_xor_b32 v26, v55, v19

    s_waitcnt lgkmcnt(2)
    v_perm_b32 v72, v49, v48, s75
    v_lshrrev_b32 v73, 3, v72
    v_lshlrev_b32 v68, 2, v72
    v_and_b32 v72, 0x07070707, v72
    v_and_b32 v4, 0x03030303, v73
    v_perm_b32 v20, v55, v54, v72
    v_xor_b32 v27, v55, v20

    s_waitcnt lgkmcnt(1)
    v_perm_b32 v72, v51, v50, s75
    v_lshrrev_b32 v73, 3, v72
    v_lshlrev_b32 v69, 2, v72
    v_and_b32 v72, 0x07070707, v72
    v_and_b32 v5, 0x03030303, v73
    v_perm_b32 v21, v55, v54, v72
    v_xor_b32 v28, v55, v21

    s_waitcnt lgkmcnt(0)
    v_perm_b32 v72, v53, v52, s75
    v_lshrrev_b32 v73, 3, v72
    v_lshlrev_b32 v70, 2, v72
    v_and_b32 v72, 0x07070707, v72
    v_and_b32 v6, 0x03030303, v73
    v_perm_b32 v22, v55, v54, v72
    v_xor_b32 v29, v55, v22

    ds_write_b32 v86, v13
    v_mov_b32 v71, s63
    v_subrev_u32 v30, 8, v31
    s_setprio 0
    v_ffbl_b32 v84, v71

    v_perm_b32 v72, v64, v64, v84
    v_and_or_b32 v72, v72, s66, v85
    ds_add_rtn_u32 v87, v72, v10
    ds_wrxchg_rtn_b32 v116, v86, v13

    s_waitcnt lgkmcnt(0)
    v_cmp_gt_u32 s[68:69], 2, v116

    v_cmpx_lt_u32 vcc, 1, v87
    s_nop 0
    v_lshrrev_b64 v[74:75], v123, s[68:69]
    v_perm_b32 v121, v74, v74, v1
    v_perm_b32 v122, v74, v74, v0
    v_and_b32 v121, v121, v17
    v_and_b32 v122, v122, v16
    v_msad_u8 v120, v24, v121, 0
    v_lshlrev_b32 v120, 4, v120
    v_msad_u8 v120, v23, v122, v120
    v_and_b32 v120, v120, v71

    v_ffbl_b32 v120, v120
    v_max_i32 v84, v120, v84
    s_mov_b64 exec, -1

    v_lshl_add_u32 v73, v84, 1, v30
    v_lshl_add_u32 v71, -1, v84, v71
    ds_read_u16 v80, v73 offset:0
    v_ffbl_b32 v84, v71

    v_perm_b32 v72, v64, v64, v84
    v_and_or_b32 v72, v72, s66, v85
    ds_add_rtn_u32 v87, v72, v10
    ds_wrxchg_rtn_b32 v116, v86, v13

    s_lshl_b32 s45, s2, 8
    s_add_u32 s45, s45, 14680064
    s_mov_b64 exec, 3
    buffer_store_dword v13, v9, s[12:15], s45 offen sc1
    s_mov_b64 exec, -1
    buffer_load_dwordx4 v[128:131], v9, s[28:31], s77 offen offset:0

    s_waitcnt lgkmcnt(0)
    v_cmp_gt_u32 s[68:69], 2, v116

    v_cmpx_lt_u32 vcc, 1, v87
    s_nop 0
    v_lshrrev_b64 v[74:75], v123, s[68:69]
    v_perm_b32 v121, v74, v74, v1
    v_perm_b32 v122, v74, v74, v0
    v_and_b32 v121, v121, v17
    v_and_b32 v122, v122, v16
    v_msad_u8 v120, v24, v121, 0
    v_lshlrev_b32 v120, 4, v120
    v_msad_u8 v120, v23, v122, v120
    v_and_b32 v120, v120, v71

    v_ffbl_b32 v120, v120
    v_max_i32 v84, v120, v84
    s_mov_b64 exec, -1

    v_lshl_add_u32 v73, v84, 1, v30
    v_lshl_add_u32 v71, -1, v84, v71
    ds_read_u16 v81, v73 offset:0
    v_ffbl_b32 v84, v71

    v_perm_b32 v72, v64, v64, v84
    v_and_or_b32 v72, v72, s66, v85
    ds_add_rtn_u32 v87, v72, v10
    ds_wrxchg_rtn_b32 v116, v86, v13

    s_lshl_b32 s45, s2, 10
    s_add_u32 s45, s45, 30408704
    s_mov_b32 exec_lo, 0x01010101
    s_mov_b32 exec_hi, 0x01010101
    buffer_store_dword v13, v9, s[12:15], s45 offen sc1
    s_mul_i32 s45, s2, 67584
    s_add_u32 s45, s45, 67108864
    s_mov_b64 exec, 1
    buffer_load_dword v117, v13, s[12:15], s45 offen
    s_mov_b64 exec, -1
    buffer_load_dwordx4 v[132:135], v9, s[28:31], s77 offen offset:1024

    s_waitcnt lgkmcnt(0)
    v_cmp_gt_u32 s[68:69], 2, v116

    v_cmpx_lt_u32 vcc, 1, v87
    s_nop 0
    v_lshrrev_b64 v[74:75], v123, s[68:69]
    v_perm_b32 v121, v74, v74, v1
    v_perm_b32 v122, v74, v74, v0
    v_and_b32 v121, v121, v17
    v_and_b32 v122, v122, v16
    v_msad_u8 v120, v24, v121, 0
    v_lshlrev_b32 v120, 4, v120
    v_msad_u8 v120, v23, v122, v120
    v_and_b32 v120, v120, v71

    v_ffbl_b32 v120, v120
    v_max_i32 v84, v120, v84
    s_mov_b64 exec, -1

    v_lshl_add_u32 v73, v84, 1, v30
    v_lshl_add_u32 v71, -1, v84, v71
    ds_read_u16 v82, v73 offset:0
    v_ffbl_b32 v84, v71

    v_perm_b32 v72, v64, v64, v84
    v_and_or_b32 v72, v72, s66, v85
    ds_add_rtn_u32 v87, v72, v10
    ds_wrxchg_rtn_b32 v116, v86, v13

    buffer_load_dwordx4 v[144:147], v9, s[28:31], s77 offen offset:2048

    s_waitcnt lgkmcnt(0)
    v_cmp_gt_u32 s[68:69], 2, v116

    v_cmpx_lt_u32 vcc, 1, v87
    s_nop 0
    v_lshrrev_b64 v[74:75], v123, s[68:69]
    v_perm_b32 v121, v74, v74, v1
    v_and_b32 v121, v121, v17
    v_msad_u8 v120, v24, v121, 0
    v_lshlrev_b32 v120, 4, v120
    v_and_b32 v120, v120, v71

    v_ffbl_b32 v120, v120
    v_max_i32 v84, v120, v84
    s_mov_b64 exec, -1

    v_lshl_add_u32 v73, v84, 1, v30
    v_lshl_add_u32 v71, -1, v84, v71
    ds_read_u16 v83, v73 offset:0
    v_lshrrev_b32 v71, 4, v71
    v_ffbl_b32 v84, v71

    v_perm_b32 v72, v65, v64, v84
    v_and_or_b32 v72, v72, s66, v85
    ds_add_rtn_u32 v87, v72, v10
    ds_wrxchg_rtn_b32 v116, v86, v13

    buffer_load_dwordx4 v[148:151], v9, s[28:31], s77 offen offset:3072
    s_add_u32 s77, s77, 4096
    s_mov_b32 s70, 0x7fff7fff

    s_waitcnt lgkmcnt(0)
    v_cmp_gt_u32 s[68:69], 2, v116

    s_cmp_eq_u32 s59, 0
    v_lshl_or_b32 v76, v81, 16, v80
    v_lshl_or_b32 v77, v83, 16, v82
    s_cbranch_scc1 k1_kernel_nf0
    buffer_store_dwordx4 v[76:79], v9, s[32:35], s62 offen sc1
    s_add_u32 s62, s62, 262144
k1_kernel_nf0:
    v_cmpx_lt_u32 vcc, 1, v87
    v_bfe_i32 v119, s70, v71, 1
    v_lshrrev_b64 v[74:75], v123, s[68:69]
    v_perm_b32 v121, v74, v74, v2
    v_perm_b32 v122, v74, v74, v1
    v_and_b32 v121, v121, v18
    v_and_b32 v122, v122, v17
    v_msad_u8 v120, v25, v121, 0
    v_lshlrev_b32 v120, 4, v120
    v_msad_u8 v120, v24, v122, v120
    v_bitop3_b32 v120, v120, v71, v119 bitop3:0x80

    v_ffbl_b32 v120, v120
    v_max_i32 v84, v120, v84
    s_mov_b64 exec, -1

    v_lshl_add_u32 v73, v84, 1, v30
    v_lshl_add_u32 v71, -1, v84, v71
    ds_read_u16 v80, v73 offset:8
    v_ffbl_b32 v84, v71

    v_perm_b32 v72, v65, v64, v84
    v_and_or_b32 v72, v72, s66, v85
    ds_add_rtn_u32 v87, v72, v10
    ds_wrxchg_rtn_b32 v116, v86, v13

    buffer_load_dwordx4 v[160:163], v9, s[28:31], s77 offen offset:0
    s_mov_b32 s70, 0x977f977f

    s_waitcnt lgkmcnt(0)
    v_cmp_gt_u32 s[68:69], 2, v116

    v_cmpx_lt_u32 vcc, 1, v87
    v_bfe_i32 v119, s70, v71, 1
    v_lshrrev_b64 v[74:75], v123, s[68:69]
    v_perm_b32 v121, v74, v74, v2
    v_perm_b32 v122, v74, v74, v1
    v_and_b32 v121, v121, v18
    v_and_b32 v122, v122, v17
    v_msad_u8 v120, v25, v121, 0
    v_lshlrev_b32 v120, 4, v120
    v_msad_u8 v120, v24, v122, v120
    v_bitop3_b32 v120, v120, v71, v119 bitop3:0x80

    v_ffbl_b32 v120, v120
    v_max_i32 v84, v120, v84
    s_mov_b64 exec, -1

    v_lshl_add_u32 v73, v84, 1, v30
    v_lshl_add_u32 v71, -1, v84, v71
    ds_read_u16 v81, v73 offset:8
    v_ffbl_b32 v84, v71

    v_perm_b32 v72, v65, v64, v84
    v_and_or_b32 v72, v72, s66, v85
    ds_add_rtn_u32 v87, v72, v10
    ds_wrxchg_rtn_b32 v116, v86, v13

    buffer_load_dwordx4 v[164:167], v9, s[28:31], s77 offen offset:1024
    s_mov_b32 s70, 0xe997e997

    s_waitcnt lgkmcnt(0)
    v_cmp_gt_u32 s[68:69], 2, v116

    v_cmpx_lt_u32 vcc, 1, v87
    v_bfe_i32 v119, s70, v71, 1
    v_lshrrev_b64 v[74:75], v123, s[68:69]
    v_perm_b32 v121, v74, v74, v2
    v_perm_b32 v122, v74, v74, v1
    v_and_b32 v121, v121, v18
    v_and_b32 v122, v122, v17
    v_msad_u8 v120, v25, v121, 0
    v_lshlrev_b32 v120, 4, v120
    v_msad_u8 v120, v24, v122, v120
    v_bitop3_b32 v120, v120, v71, v119 bitop3:0x80

    v_ffbl_b32 v120, v120
    v_max_i32 v84, v120, v84
    s_mov_b64 exec, -1

    v_lshl_add_u32 v73, v84, 1, v30
    v_lshl_add_u32 v71, -1, v84, v71
    ds_read_u16 v82, v73 offset:8
    v_ffbl_b32 v84, v71

    v_perm_b32 v72, v65, v64, v84
    v_and_or_b32 v72, v72, s66, v85
    ds_add_rtn_u32 v87, v72, v10
    ds_wrxchg_rtn_b32 v116, v86, v13

    buffer_load_dwordx4 v[176:179], v9, s[28:31], s77 offen offset:2048
    s_add_u32 s47, s44, 12288
    buffer_load_dwordx4 v[56:59], v7, s[20:23], s47 offen offset:0
    buffer_load_dwordx4 v[60:63], v7, s[20:23], s47 offen offset:64
    s_mov_b32 s70, 0xfee9fee9

    s_waitcnt lgkmcnt(0)
    v_cmp_gt_u32 s[68:69], 2, v116

    v_cmpx_lt_u32 vcc, 1, v87
    v_bfe_i32 v119, s70, v71, 1
    v_lshrrev_b64 v[74:75], v123, s[68:69]
    v_perm_b32 v121, v74, v74, v2
    v_and_b32 v121, v121, v18
    v_msad_u8 v120, v25, v121, 0
    v_lshlrev_b32 v120, 4, v120
    v_bitop3_b32 v120, v120, v71, v119 bitop3:0x80

    v_ffbl_b32 v120, v120
    v_max_i32 v84, v120, v84
    s_mov_b64 exec, -1

    v_lshl_add_u32 v73, v84, 1, v30
    v_lshl_add_u32 v71, -1, v84, v71
    ds_read_u16 v83, v73 offset:8
    v_lshrrev_b32 v71, 4, v71
    v_ffbl_b32 v84, v71

    v_perm_b32 v72, v66, v65, v84
    v_and_or_b32 v72, v72, s66, v85
    ds_add_rtn_u32 v87, v72, v10
    ds_wrxchg_rtn_b32 v116, v86, v13

    buffer_load_dwordx4 v[180:183], v9, s[28:31], s77 offen offset:3072
    s_add_u32 s77, s77, 126976
    s_cmp_lg_u32 s64, 0
    s_cbranch_scc1 k1_kernel_nc8
    v_mov_b32 v121, -1
    v_lshlrev_b32 v122, 1, v8
    buffer_store_short v121, v122, s[12:15], s73 offen sc1
k1_kernel_nc8:
    s_add_u32 s47, s44, 16384
    buffer_load_dwordx4 v[88:91], v7, s[20:23], s47 offen offset:0
    buffer_load_dwordx4 v[92:95], v7, s[20:23], s47 offen offset:64
    s_mov_b32 s70, 0x7fff7fff

    s_waitcnt lgkmcnt(0)
    v_cmp_gt_u32 s[68:69], 2, v116

    s_cmp_eq_u32 s59, 1
    v_lshl_or_b32 v78, v81, 16, v80
    v_lshl_or_b32 v79, v83, 16, v82
    s_cbranch_scc1 k1_kernel_nf1
    buffer_store_dwordx4 v[76:79], v9, s[32:35], s62 offen sc1
    s_add_u32 s62, s62, 262144
k1_kernel_nf1:
    v_cmpx_lt_u32 vcc, 1, v87
    v_bfe_i32 v119, s70, v71, 1
    v_lshrrev_b64 v[74:75], v123, s[68:69]
    v_perm_b32 v121, v74, v74, v3
    v_perm_b32 v122, v74, v74, v2
    v_and_b32 v121, v121, v19
    v_and_b32 v122, v122, v18
    v_msad_u8 v120, v26, v121, 0
    v_lshlrev_b32 v120, 4, v120
    v_msad_u8 v120, v25, v122, v120
    v_bitop3_b32 v120, v120, v71, v119 bitop3:0x80

    v_ffbl_b32 v120, v120
    v_max_i32 v84, v120, v84
    s_mov_b64 exec, -1

    v_lshl_add_u32 v73, v84, 1, v30
    v_lshl_add_u32 v71, -1, v84, v71
    ds_read_u16 v80, v73 offset:16
    v_ffbl_b32 v84, v71

    v_perm_b32 v72, v66, v65, v84
    v_and_or_b32 v72, v72, s66, v85
    ds_add_rtn_u32 v87, v72, v10
    ds_wrxchg_rtn_b32 v116, v86, v13

    buffer_load_dwordx4 v[192:195], v9, s[28:31], s77 offen offset:0
    s_add_u32 s47, s44, 20480
    buffer_load_dwordx4 v[96:99], v7, s[20:23], s47 offen offset:0
    buffer_load_dwordx4 v[100:103], v7, s[20:23], s47 offen offset:64
    s_mov_b32 s70, 0x977f977f

    s_waitcnt lgkmcnt(0)
    v_cmp_gt_u32 s[68:69], 2, v116

    v_cmpx_lt_u32 vcc, 1, v87
    v_bfe_i32 v119, s70, v71, 1
    v_lshrrev_b64 v[74:75], v123, s[68:69]
    v_perm_b32 v121, v74, v74, v3
    v_perm_b32 v122, v74, v74, v2
    v_and_b32 v121, v121, v19
    v_and_b32 v122, v122, v18
    v_msad_u8 v120, v26, v121, 0
    v_lshlrev_b32 v120, 4, v120
    v_msad_u8 v120, v25, v122, v120
    v_bitop3_b32 v120, v120, v71, v119 bitop3:0x80

    v_ffbl_b32 v120, v120
    v_max_i32 v84, v120, v84
    s_mov_b64 exec, -1

    v_lshl_add_u32 v73, v84, 1, v30
    v_lshl_add_u32 v71, -1, v84, v71
    ds_read_u16 v81, v73 offset:16
    v_ffbl_b32 v84, v71

    v_perm_b32 v72, v66, v65, v84
    v_and_or_b32 v72, v72, s66, v85
    ds_add_rtn_u32 v87, v72, v10
    ds_wrxchg_rtn_b32 v116, v86, v13

    buffer_load_dwordx4 v[196:199], v9, s[28:31], s77 offen offset:1024
    s_add_u32 s47, s44, 24576
    buffer_load_dwordx4 v[104:107], v7, s[20:23], s47 offen offset:0
    buffer_load_dwordx4 v[108:111], v7, s[20:23], s47 offen offset:64
    s_mov_b32 s70, 0xe997e997

    s_waitcnt lgkmcnt(0)
    v_cmp_gt_u32 s[68:69], 2, v116

    v_cmpx_lt_u32 vcc, 1, v87
    v_bfe_i32 v119, s70, v71, 1
    v_lshrrev_b64 v[74:75], v123, s[68:69]
    v_perm_b32 v121, v74, v74, v3
    v_perm_b32 v122, v74, v74, v2
    v_and_b32 v121, v121, v19
    v_and_b32 v122, v122, v18
    v_msad_u8 v120, v26, v121, 0
    v_lshlrev_b32 v120, 4, v120
    v_msad_u8 v120, v25, v122, v120
    v_bitop3_b32 v120, v120, v71, v119 bitop3:0x80

    v_ffbl_b32 v120, v120
    v_max_i32 v84, v120, v84
    s_mov_b64 exec, -1

    v_lshl_add_u32 v73, v84, 1, v30
    v_lshl_add_u32 v71, -1, v84, v71
    ds_read_u16 v82, v73 offset:16
    v_ffbl_b32 v84, v71

    v_perm_b32 v72, v66, v65, v84
    v_and_or_b32 v72, v72, s66, v85
    ds_add_rtn_u32 v87, v72, v10
    ds_wrxchg_rtn_b32 v116, v86, v13

    buffer_load_dwordx4 v[208:211], v9, s[28:31], s77 offen offset:2048
    s_add_u32 s47, s44, 28672
    buffer_load_dwordx4 v[112:115], v7, s[20:23], s47 offen offset:0
    buffer_load_dwordx4 v[124:127], v7, s[20:23], s47 offen offset:64
    s_mov_b32 s70, 0xfee9fee9

    s_waitcnt lgkmcnt(0)
    v_cmp_gt_u32 s[68:69], 2, v116

    v_cmpx_lt_u32 vcc, 1, v87
    v_bfe_i32 v119, s70, v71, 1
    v_lshrrev_b64 v[74:75], v123, s[68:69]
    v_perm_b32 v121, v74, v74, v3
    v_and_b32 v121, v121, v19
    v_msad_u8 v120, v26, v121, 0
    v_lshlrev_b32 v120, 4, v120
    v_bitop3_b32 v120, v120, v71, v119 bitop3:0x80

    v_ffbl_b32 v120, v120
    v_max_i32 v84, v120, v84
    s_mov_b64 exec, -1

    v_lshl_add_u32 v73, v84, 1, v30
    v_lshl_add_u32 v71, -1, v84, v71
    ds_read_u16 v83, v73 offset:16
    v_lshrrev_b32 v71, 4, v71
    v_ffbl_b32 v84, v71

    v_perm_b32 v72, v67, v66, v84
    v_and_or_b32 v72, v72, s66, v85
    ds_add_rtn_u32 v87, v72, v10
    ds_wrxchg_rtn_b32 v116, v86, v13

    buffer_load_dwordx4 v[212:215], v9, s[28:31], s77 offen offset:3072
    s_add_u32 s77, s77, 4096
    s_add_u32 s47, s44, 131072
    buffer_load_dwordx4 v[136:139], v7, s[20:23], s47 offen offset:0
    buffer_load_dwordx4 v[140:143], v7, s[20:23], s47 offen offset:64
    s_mov_b32 s70, 0x7fff7fff

    s_waitcnt lgkmcnt(0)
    v_cmp_gt_u32 s[68:69], 2, v116

    s_cmp_eq_u32 s59, 0
    v_lshl_or_b32 v76, v81, 16, v80
    v_lshl_or_b32 v77, v83, 16, v82
    s_cbranch_scc1 k1_kernel_nf2
    buffer_store_dwordx4 v[76:79], v9, s[32:35], s62 offen sc1
    s_add_u32 s62, s62, 262144
k1_kernel_nf2:
    v_cmpx_lt_u32 vcc, 1, v87
    v_bfe_i32 v119, s70, v71, 1
    v_lshrrev_b64 v[74:75], v123, s[68:69]
    v_perm_b32 v121, v74, v74, v4
    v_perm_b32 v122, v74, v74, v3
    v_and_b32 v121, v121, v20
    v_and_b32 v122, v122, v19
    v_msad_u8 v120, v27, v121, 0
    v_lshlrev_b32 v120, 4, v120
    v_msad_u8 v120, v26, v122, v120
    v_bitop3_b32 v120, v120, v71, v119 bitop3:0x80

    v_ffbl_b32 v120, v120
    v_max_i32 v84, v120, v84
    s_mov_b64 exec, -1

    v_lshl_add_u32 v73, v84, 1, v30
    v_lshl_add_u32 v71, -1, v84, v71
    ds_read_u16 v80, v73 offset:24
    v_ffbl_b32 v84, v71

    v_perm_b32 v72, v67, v66, v84
    v_and_or_b32 v72, v72, s66, v85
    ds_add_rtn_u32 v87, v72, v10
    ds_wrxchg_rtn_b32 v116, v86, v13

    buffer_load_dwordx4 v[224:227], v9, s[28:31], s77 offen offset:0
    s_add_u32 s47, s44, 135168
    buffer_load_dwordx4 v[152:155], v7, s[20:23], s47 offen offset:0
    buffer_load_dwordx4 v[156:159], v7, s[20:23], s47 offen offset:64
    s_mov_b32 s70, 0x977f977f

    s_waitcnt lgkmcnt(0)
    v_cmp_gt_u32 s[68:69], 2, v116

    v_cmpx_lt_u32 vcc, 1, v87
    v_bfe_i32 v119, s70, v71, 1
    v_lshrrev_b64 v[74:75], v123, s[68:69]
    v_perm_b32 v121, v74, v74, v4
    v_perm_b32 v122, v74, v74, v3
    v_and_b32 v121, v121, v20
    v_and_b32 v122, v122, v19
    v_msad_u8 v120, v27, v121, 0
    v_lshlrev_b32 v120, 4, v120
    v_msad_u8 v120, v26, v122, v120
    v_bitop3_b32 v120, v120, v71, v119 bitop3:0x80

    v_ffbl_b32 v120, v120
    v_max_i32 v84, v120, v84
    s_mov_b64 exec, -1

    v_lshl_add_u32 v73, v84, 1, v30
    v_lshl_add_u32 v71, -1, v84, v71
    ds_read_u16 v81, v73 offset:24
    v_ffbl_b32 v84, v71

    v_perm_b32 v72, v67, v66, v84
    v_and_or_b32 v72, v72, s66, v85
    ds_add_rtn_u32 v87, v72, v10
    ds_wrxchg_rtn_b32 v116, v86, v13

    buffer_load_dwordx4 v[228:231], v9, s[28:31], s77 offen offset:1024
    s_add_u32 s47, s44, 139264
    buffer_load_dwordx4 v[168:171], v7, s[20:23], s47 offen offset:0
    buffer_load_dwordx4 v[172:175], v7, s[20:23], s47 offen offset:64
    s_mov_b32 s70, 0xe997e997

    s_waitcnt lgkmcnt(0)
    v_cmp_gt_u32 s[68:69], 2, v116

    v_cmpx_lt_u32 vcc, 1, v87
    v_bfe_i32 v119, s70, v71, 1
    v_lshrrev_b64 v[74:75], v123, s[68:69]
    v_perm_b32 v121, v74, v74, v4
    v_perm_b32 v122, v74, v74, v3
    v_and_b32 v121, v121, v20
    v_and_b32 v122, v122, v19
    v_msad_u8 v120, v27, v121, 0
    v_lshlrev_b32 v120, 4, v120
    v_msad_u8 v120, v26, v122, v120
    v_bitop3_b32 v120, v120, v71, v119 bitop3:0x80

    v_ffbl_b32 v120, v120
    v_max_i32 v84, v120, v84
    s_mov_b64 exec, -1

    v_lshl_add_u32 v73, v84, 1, v30
    v_lshl_add_u32 v71, -1, v84, v71
    ds_read_u16 v82, v73 offset:24
    v_ffbl_b32 v84, v71

    v_perm_b32 v72, v67, v66, v84
    v_and_or_b32 v72, v72, s66, v85
    ds_add_rtn_u32 v87, v72, v10
    ds_wrxchg_rtn_b32 v116, v86, v13

    buffer_load_dwordx4 v[240:243], v9, s[28:31], s77 offen offset:2048
    s_add_u32 s47, s44, 143360
    buffer_load_dwordx4 v[184:187], v7, s[20:23], s47 offen offset:0
    buffer_load_dwordx4 v[188:191], v7, s[20:23], s47 offen offset:64
    s_mov_b32 s70, 0xfee9fee9

    s_waitcnt lgkmcnt(0)
    v_cmp_gt_u32 s[68:69], 2, v116

    v_cmpx_lt_u32 vcc, 1, v87
    v_bfe_i32 v119, s70, v71, 1
    v_lshrrev_b64 v[74:75], v123, s[68:69]
    v_perm_b32 v121, v74, v74, v4
    v_and_b32 v121, v121, v20
    v_msad_u8 v120, v27, v121, 0
    v_lshlrev_b32 v120, 4, v120
    v_bitop3_b32 v120, v120, v71, v119 bitop3:0x80

    v_ffbl_b32 v120, v120
    v_max_i32 v84, v120, v84
    s_mov_b64 exec, -1

    v_lshl_add_u32 v73, v84, 1, v30
    v_lshl_add_u32 v71, -1, v84, v71
    ds_read_u16 v83, v73 offset:24
    v_lshrrev_b32 v71, 4, v71
    v_ffbl_b32 v84, v71

    v_perm_b32 v72, v68, v67, v84
    v_and_or_b32 v72, v72, s66, v85
    ds_add_rtn_u32 v87, v72, v10
    ds_wrxchg_rtn_b32 v116, v86, v13

    buffer_load_dwordx4 v[244:247], v9, s[28:31], s77 offen offset:3072
    s_add_u32 s47, s44, 147456
    buffer_load_dwordx4 v[200:203], v7, s[20:23], s47 offen offset:0
    buffer_load_dwordx4 v[204:207], v7, s[20:23], s47 offen offset:64
    s_mov_b32 s70, 0x7fff7fff

    s_waitcnt lgkmcnt(0)
    v_cmp_gt_u32 s[68:69], 2, v116

    s_cmp_eq_u32 s59, 1
    v_lshl_or_b32 v78, v81, 16, v80
    v_lshl_or_b32 v79, v83, 16, v82
    s_cbranch_scc1 k1_kernel_nf3
    buffer_store_dwordx4 v[76:79], v9, s[32:35], s62 offen sc1
    s_add_u32 s62, s62, 262144
k1_kernel_nf3:
    v_cmpx_lt_u32 vcc, 1, v87
    v_bfe_i32 v119, s70, v71, 1
    v_lshrrev_b64 v[74:75], v123, s[68:69]
    v_perm_b32 v121, v74, v74, v5
    v_perm_b32 v122, v74, v74, v4
    v_and_b32 v121, v121, v21
    v_and_b32 v122, v122, v20
    v_msad_u8 v120, v28, v121, 0
    v_lshlrev_b32 v120, 4, v120
    v_msad_u8 v120, v27, v122, v120
    v_bitop3_b32 v120, v120, v71, v119 bitop3:0x80

    v_ffbl_b32 v120, v120
    v_max_i32 v84, v120, v84
    s_mov_b64 exec, -1

    v_lshl_add_u32 v73, v84, 1, v30
    v_lshl_add_u32 v71, -1, v84, v71
    ds_read_u16 v80, v73 offset:32
    v_ffbl_b32 v84, v71

    v_perm_b32 v72, v68, v67, v84
    v_and_or_b32 v72, v72, s66, v85
    ds_add_rtn_u32 v87, v72, v10
    ds_wrxchg_rtn_b32 v116, v86, v13

    s_add_u32 s47, s44, 151552
    buffer_load_dwordx4 v[216:219], v7, s[20:23], s47 offen offset:0
    buffer_load_dwordx4 v[220:223], v7, s[20:23], s47 offen offset:64
    s_mov_b32 s70, 0x977f977f

    s_waitcnt lgkmcnt(0)
    v_cmp_gt_u32 s[68:69], 2, v116

    v_cmpx_lt_u32 vcc, 1, v87
    v_bfe_i32 v119, s70, v71, 1
    v_lshrrev_b64 v[74:75], v123, s[68:69]
    v_perm_b32 v121, v74, v74, v5
    v_perm_b32 v122, v74, v74, v4
    v_and_b32 v121, v121, v21
    v_and_b32 v122, v122, v20
    v_msad_u8 v120, v28, v121, 0
    v_lshlrev_b32 v120, 4, v120
    v_msad_u8 v120, v27, v122, v120
    v_bitop3_b32 v120, v120, v71, v119 bitop3:0x80

    v_ffbl_b32 v120, v120
    v_max_i32 v84, v120, v84
    s_mov_b64 exec, -1

    v_lshl_add_u32 v73, v84, 1, v30
    v_lshl_add_u32 v71, -1, v84, v71
    ds_read_u16 v81, v73 offset:32
    v_ffbl_b32 v84, v71

    v_perm_b32 v72, v68, v67, v84
    v_and_or_b32 v72, v72, s66, v85
    ds_add_rtn_u32 v87, v72, v10
    ds_wrxchg_rtn_b32 v116, v86, v13

    s_add_u32 s47, s44, 155648
    buffer_load_dwordx4 v[232:235], v7, s[20:23], s47 offen offset:0
    buffer_load_dwordx4 v[236:239], v7, s[20:23], s47 offen offset:64
    s_mov_b32 s70, 0xe997e997

    s_waitcnt lgkmcnt(0)
    v_cmp_gt_u32 s[68:69], 2, v116

    v_cmpx_lt_u32 vcc, 1, v87
    v_bfe_i32 v119, s70, v71, 1
    v_lshrrev_b64 v[74:75], v123, s[68:69]
    v_perm_b32 v121, v74, v74, v5
    v_perm_b32 v122, v74, v74, v4
    v_and_b32 v121, v121, v21
    v_and_b32 v122, v122, v20
    v_msad_u8 v120, v28, v121, 0
    v_lshlrev_b32 v120, 4, v120
    v_msad_u8 v120, v27, v122, v120
    v_bitop3_b32 v120, v120, v71, v119 bitop3:0x80

    v_ffbl_b32 v120, v120
    v_max_i32 v84, v120, v84
    s_mov_b64 exec, -1

    v_lshl_add_u32 v73, v84, 1, v30
    v_lshl_add_u32 v71, -1, v84, v71
    ds_read_u16 v82, v73 offset:32
    v_ffbl_b32 v84, v71

    v_perm_b32 v72, v68, v67, v84
    v_and_or_b32 v72, v72, s66, v85
    ds_add_rtn_u32 v87, v72, v10
    ds_wrxchg_rtn_b32 v116, v86, v13

    s_add_u32 s47, s44, 159744
    buffer_load_dwordx4 v[248:251], v7, s[20:23], s47 offen offset:0
    buffer_load_dwordx4 v[252:255], v7, s[20:23], s47 offen offset:64
    s_mov_b32 s70, 0xfee9fee9

    s_waitcnt lgkmcnt(0)
    v_cmp_gt_u32 s[68:69], 2, v116

    v_cmpx_lt_u32 vcc, 1, v87
    v_bfe_i32 v119, s70, v71, 1
    v_lshrrev_b64 v[74:75], v123, s[68:69]
    v_perm_b32 v121, v74, v74, v5
    v_and_b32 v121, v121, v21
    v_msad_u8 v120, v28, v121, 0
    v_lshlrev_b32 v120, 4, v120
    v_bitop3_b32 v120, v120, v71, v119 bitop3:0x80

    v_ffbl_b32 v120, v120
    v_max_i32 v84, v120, v84
    s_mov_b64 exec, -1

    v_lshl_add_u32 v73, v84, 1, v30
    v_lshl_add_u32 v71, -1, v84, v71
    ds_read_u16 v83, v73 offset:32
    v_lshrrev_b32 v71, 4, v71

    s_cmp_ge_u32 s57, 800
    s_cbranch_scc1 k1_kernel_norl
    s_waitcnt vmcnt(0)

    s_lshr_b32 s78, s57, 7
    s_lshl_b32 s78, s78, 8
    s_and_b32 s79, s57, 127
    s_add_u32 s78, s78, s79
    s_cmp_ge_u32 s57, 384
    s_cselect_b32 s79, 640, 0
    s_sub_u32 s78, s78, s79
    s_lshl_b32 s79, s78, 10
    buffer_load_dwordx4 v[24:27], v9, s[20:23], s79 offen
    s_lshl2_add_u32 s78, s78, 15466496
    v_mov_b32 v4, -1
    s_mov_b64 exec, 1
    buffer_store_dword v4, off, s[32:35], s78 sc1
    s_mov_b64 exec, -1

    v_perm_b32 v0, v132, v128, s84
    v_perm_b32 v1, v148, v144, s84
    v_perm_b32 v2, v164, v160, s84
    v_perm_b32 v3, v180, v176, s84
    v_perm_b32 v16, v132, v128, s85
    v_perm_b32 v17, v148, v144, s85
    v_perm_b32 v18, v164, v160, s85
    v_perm_b32 v19, v180, v176, s85
    v_perm_b32 v32, v133, v129, s84
    v_perm_b32 v33, v149, v145, s84
    v_perm_b32 v34, v165, v161, s84
    v_perm_b32 v35, v181, v177, s84
    v_perm_b32 v64, v133, v129, s85
    v_perm_b32 v65, v149, v145, s85
    v_perm_b32 v66, v165, v161, s85
    v_perm_b32 v67, v181, v177, s85
    ds_write_b128 v36, v[0:3]
    ds_write_b128 v37, v[16:19]
    ds_write_b128 v38, v[32:35]
    ds_write_b128 v39, v[64:67]
    ds_read_b128 v[40:43], v15 offset:0
    ds_read_b128 v[44:47], v15 offset:1024
    ds_read_b128 v[72:75], v15 offset:2048
    ds_read_b128 v[116:119], v15 offset:3072
    v_perm_b32 v0, v196, v192, s84
    v_perm_b32 v1, v212, v208, s84
    v_perm_b32 v2, v228, v224, s84
    v_perm_b32 v3, v244, v240, s84
    v_perm_b32 v16, v196, v192, s85
    v_perm_b32 v17, v212, v208, s85
    v_perm_b32 v18, v228, v224, s85
    v_perm_b32 v19, v244, v240, s85
    v_perm_b32 v32, v197, v193, s84
    v_perm_b32 v33, v213, v209, s84
    v_perm_b32 v34, v229, v225, s84
    v_perm_b32 v35, v245, v241, s84
    v_perm_b32 v64, v197, v193, s85
    v_perm_b32 v65, v213, v209, s85
    v_perm_b32 v66, v229, v225, s85
    v_perm_b32 v67, v245, v241, s85
    s_waitcnt lgkmcnt(0)
    s_add_u32 s83, s82, 0
    buffer_store_dwordx4 v[40:43], v14, s[32:35], s83 offen sc1
    s_add_u32 s83, s82, 3284992
    buffer_store_dwordx4 v[44:47], v14, s[32:35], s83 offen sc1
    s_add_u32 s83, s82, 6569984
    buffer_store_dwordx4 v[72:75], v14, s[32:35], s83 offen sc1
    s_add_u32 s83, s82, 9854976
    buffer_store_dwordx4 v[116:119], v14, s[32:35], s83 offen sc1
    ds_write_b128 v36, v[0:3]
    ds_write_b128 v37, v[16:19]
    ds_write_b128 v38, v[32:35]
    ds_write_b128 v39, v[64:67]
    ds_read_b128 v[40:43], v15 offset:0
    ds_read_b128 v[44:47], v15 offset:1024
    ds_read_b128 v[72:75], v15 offset:2048
    ds_read_b128 v[116:119], v15 offset:3072
    v_perm_b32 v0, v134, v130, s84
    v_perm_b32 v1, v150, v146, s84
    v_perm_b32 v2, v166, v162, s84
    v_perm_b32 v3, v182, v178, s84
    v_perm_b32 v16, v134, v130, s85
    v_perm_b32 v17, v150, v146, s85
    v_perm_b32 v18, v166, v162, s85
    v_perm_b32 v19, v182, v178, s85
    v_perm_b32 v32, v135, v131, s84
    v_perm_b32 v33, v151, v147, s84
    v_perm_b32 v34, v167, v163, s84
    v_perm_b32 v35, v183, v179, s84
    v_perm_b32 v64, v135, v131, s85
    v_perm_b32 v65, v151, v147, s85
    v_perm_b32 v66, v167, v163, s85
    v_perm_b32 v67, v183, v179, s85
    s_waitcnt lgkmcnt(0)
    s_add_u32 s83, s82, 64
    buffer_store_dwordx4 v[40:43], v14, s[32:35], s83 offen sc1
    s_add_u32 s83, s82, 3285056
    buffer_store_dwordx4 v[44:47], v14, s[32:35], s83 offen sc1
    s_add_u32 s83, s82, 6570048
    buffer_store_dwordx4 v[72:75], v14, s[32:35], s83 offen sc1
    s_add_u32 s83, s82, 9855040
    buffer_store_dwordx4 v[116:119], v14, s[32:35], s83 offen sc1
    ds_write_b128 v36, v[0:3]
    ds_write_b128 v37, v[16:19]
    ds_write_b128 v38, v[32:35]
    ds_write_b128 v39, v[64:67]
    ds_read_b128 v[40:43], v15 offset:0
    ds_read_b128 v[44:47], v15 offset:1024
    ds_read_b128 v[72:75], v15 offset:2048
    ds_read_b128 v[116:119], v15 offset:3072
    v_perm_b32 v0, v198, v194, s84
    v_perm_b32 v1, v214, v210, s84
    v_perm_b32 v2, v230, v226, s84
    v_perm_b32 v3, v246, v242, s84
    v_perm_b32 v16, v198, v194, s85
    v_perm_b32 v17, v214, v210, s85
    v_perm_b32 v18, v230, v226, s85
    v_perm_b32 v19, v246, v242, s85
    v_perm_b32 v32, v199, v195, s84
    v_perm_b32 v33, v215, v211, s84
    v_perm_b32 v34, v231, v227, s84
    v_perm_b32 v35, v247, v243, s84
    v_perm_b32 v64, v199, v195, s85
    v_perm_b32 v65, v215, v211, s85
    v_perm_b32 v66, v231, v227, s85
    v_perm_b32 v67, v247, v243, s85
    s_waitcnt lgkmcnt(0)
    s_add_u32 s83, s82, 102656
    buffer_store_dwordx4 v[40:43], v14, s[32:35], s83 offen sc1
    s_add_u32 s83, s82, 3387648
    buffer_store_dwordx4 v[44:47], v14, s[32:35], s83 offen sc1
    s_add_u32 s83, s82, 6672640
    buffer_store_dwordx4 v[72:75], v14, s[32:35], s83 offen sc1
    s_add_u32 s83, s82, 9957632
    buffer_store_dwordx4 v[116:119], v14, s[32:35], s83 offen sc1
    ds_write_b128 v36, v[0:3]
    ds_write_b128 v37, v[16:19]
    ds_write_b128 v38, v[32:35]
    ds_write_b128 v39, v[64:67]
    ds_read_b128 v[40:43], v15 offset:0
    ds_read_b128 v[44:47], v15 offset:1024
    ds_read_b128 v[72:75], v15 offset:2048
    ds_read_b128 v[116:119], v15 offset:3072
    ds_write_b64 v31, v[48:49] offset:32
    ds_write_b64 v31, v[50:51] offset:40
    ds_write_b64 v31, v[52:53] offset:48
    s_waitcnt lgkmcnt(3)
    s_add_u32 s83, s82, 102720
    buffer_store_dwordx4 v[40:43], v14, s[32:35], s83 offen sc1
    s_add_u32 s83, s82, 3387712
    buffer_store_dwordx4 v[44:47], v14, s[32:35], s83 offen sc1
    s_add_u32 s83, s82, 6672704
    buffer_store_dwordx4 v[72:75], v14, s[32:35], s83 offen sc1
    s_add_u32 s83, s82, 9957696
    buffer_store_dwordx4 v[116:119], v14, s[32:35], s83 offen sc1
k1_kernel_norl:
k1_kernel_rld:
    ds_write_b32 v86, v13
    v_ffbl_b32 v84, v71

    v_perm_b32 v72, v69, v68, v84
    v_and_or_b32 v72, v72, s66, v85
    ds_add_rtn_u32 v87, v72, v10
    ds_wrxchg_rtn_b32 v116, v86, v13

    s_mov_b32 s70, 0x7fff7fff

    s_waitcnt lgkmcnt(0)
    v_cmp_gt_u32 s[68:69], 2, v116

    s_cmp_eq_u32 s59, 0
    v_lshl_or_b32 v76, v81, 16, v80
    v_lshl_or_b32 v77, v83, 16, v82
    s_cbranch_scc1 k1_kernel_nf4
    buffer_store_dwordx4 v[76:79], v9, s[32:35], s62 offen sc1
    s_add_u32 s62, s62, 262144
k1_kernel_nf4:
    v_cmpx_lt_u32 vcc, 1, v87
    v_bfe_i32 v119, s70, v71, 1
    v_lshrrev_b64 v[74:75], v123, s[68:69]
    v_perm_b32 v121, v74, v74, v6
    v_perm_b32 v122, v74, v74, v5
    v_and_b32 v121, v121, v22
    v_and_b32 v122, v122, v21
    v_msad_u8 v120, v29, v121, 0
    v_lshlrev_b32 v120, 4, v120
    v_msad_u8 v120, v28, v122, v120
    v_bitop3_b32 v120, v120, v71, v119 bitop3:0x80

    v_ffbl_b32 v120, v120
    v_max_i32 v84, v120, v84
    s_mov_b64 exec, -1

    v_lshl_add_u32 v73, v84, 1, v30
    v_lshl_add_u32 v71, -1, v84, v71
    ds_read_u16 v80, v73 offset:40
    v_ffbl_b32 v84, v71

    v_perm_b32 v72, v69, v68, v84
    v_and_or_b32 v72, v72, s66, v85
    ds_add_rtn_u32 v87, v72, v10
    ds_wrxchg_rtn_b32 v116, v86, v13

    s_mov_b32 s70, 0x977f977f

    s_waitcnt lgkmcnt(0)
    v_cmp_gt_u32 s[68:69], 2, v116

    v_cmpx_lt_u32 vcc, 1, v87
    v_bfe_i32 v119, s70, v71, 1
    v_lshrrev_b64 v[74:75], v123, s[68:69]
    v_perm_b32 v121, v74, v74, v6
    v_perm_b32 v122, v74, v74, v5
    v_and_b32 v121, v121, v22
    v_and_b32 v122, v122, v21
    v_msad_u8 v120, v29, v121, 0
    v_lshlrev_b32 v120, 4, v120
    v_msad_u8 v120, v28, v122, v120
    v_bitop3_b32 v120, v120, v71, v119 bitop3:0x80

    v_ffbl_b32 v120, v120
    v_max_i32 v84, v120, v84
    s_mov_b64 exec, -1

    v_lshl_add_u32 v73, v84, 1, v30
    v_lshl_add_u32 v71, -1, v84, v71
    ds_read_u16 v81, v73 offset:40
    v_ffbl_b32 v84, v71

    v_perm_b32 v72, v69, v68, v84
    v_and_or_b32 v72, v72, s66, v85
    ds_add_rtn_u32 v87, v72, v10
    ds_wrxchg_rtn_b32 v116, v86, v13

    s_mov_b32 s70, 0xe997e997

    s_waitcnt lgkmcnt(0)
    v_cmp_gt_u32 s[68:69], 2, v116

    v_cmpx_lt_u32 vcc, 1, v87
    v_bfe_i32 v119, s70, v71, 1
    v_lshrrev_b64 v[74:75], v123, s[68:69]
    v_perm_b32 v121, v74, v74, v6
    v_perm_b32 v122, v74, v74, v5
    v_and_b32 v121, v121, v22
    v_and_b32 v122, v122, v21
    v_msad_u8 v120, v29, v121, 0
    v_lshlrev_b32 v120, 4, v120
    v_msad_u8 v120, v28, v122, v120
    v_bitop3_b32 v120, v120, v71, v119 bitop3:0x80

    v_ffbl_b32 v120, v120
    v_max_i32 v84, v120, v84
    s_mov_b64 exec, -1

    v_lshl_add_u32 v73, v84, 1, v30
    v_lshl_add_u32 v71, -1, v84, v71
    ds_read_u16 v82, v73 offset:40
    v_ffbl_b32 v84, v71

    v_perm_b32 v72, v69, v68, v84
    v_and_or_b32 v72, v72, s66, v85
    ds_add_rtn_u32 v87, v72, v10
    ds_wrxchg_rtn_b32 v116, v86, v13

    s_mov_b32 s70, 0xfee9fee9

    s_waitcnt lgkmcnt(0)
    v_cmp_gt_u32 s[68:69], 2, v116

    v_cmpx_lt_u32 vcc, 1, v87
    v_bfe_i32 v119, s70, v71, 1
    v_lshrrev_b64 v[74:75], v123, s[68:69]
    v_perm_b32 v121, v74, v74, v6
    v_and_b32 v121, v121, v22
    v_msad_u8 v120, v29, v121, 0
    v_lshlrev_b32 v120, 4, v120
    v_bitop3_b32 v120, v120, v71, v119 bitop3:0x80

    v_ffbl_b32 v120, v120
    v_max_i32 v84, v120, v84
    s_mov_b64 exec, -1

    v_lshl_add_u32 v73, v84, 1, v30
    v_lshl_add_u32 v71, -1, v84, v71
    ds_read_u16 v83, v73 offset:40
    s_cmp_lg_u32 s59, 1
    s_cbranch_scc1 k1_kernel_sdone
    v_lshrrev_b32 v71, 4, v71
    v_ffbl_b32 v84, v71

    v_perm_b32 v72, v70, v69, v84
    v_and_or_b32 v72, v72, s66, v85
    ds_add_rtn_u32 v87, v72, v10
    ds_wrxchg_rtn_b32 v116, v86, v13

    s_waitcnt lgkmcnt(0)
    v_cmp_gt_u32 s[68:69], 2, v116

    v_lshl_or_b32 v78, v81, 16, v80
    v_lshl_or_b32 v79, v83, 16, v82
    v_cmpx_lt_u32 vcc, 1, v87
    v_lshrrev_b64 v[74:75], v123, s[68:69]
    v_perm_b32 v121, v74, v74, v6
    v_and_b32 v121, v121, v22
    v_msad_u8 v120, v29, v121, 0
    v_and_b32 v120, v120, v71

    v_ffbl_b32 v120, v120
    v_max_i32 v84, v120, v84
    s_mov_b64 exec, -1

    v_lshl_add_u32 v73, v84, 1, v30
    v_lshl_add_u32 v71, -1, v84, v71
    ds_read_u16 v80, v73 offset:48
    v_ffbl_b32 v84, v71

    v_perm_b32 v72, v70, v69, v84
    v_and_or_b32 v72, v72, s66, v85
    ds_add_rtn_u32 v87, v72, v10
    ds_wrxchg_rtn_b32 v116, v86, v13

    s_waitcnt lgkmcnt(0)
    v_cmp_gt_u32 s[68:69], 2, v116

    v_cmpx_lt_u32 vcc, 1, v87
    s_nop 0
    v_lshrrev_b64 v[74:75], v123, s[68:69]
    v_perm_b32 v121, v74, v74, v6
    v_and_b32 v121, v121, v22
    v_msad_u8 v120, v29, v121, 0
    v_and_b32 v120, v120, v71

    v_ffbl_b32 v120, v120
    v_max_i32 v84, v120, v84
    s_mov_b64 exec, -1

    v_lshl_add_u32 v73, v84, 1, v30
    v_lshl_add_u32 v71, -1, v84, v71
    ds_read_u16 v81, v73 offset:48
    v_ffbl_b32 v84, v71

    v_perm_b32 v72, v70, v69, v84
    v_and_or_b32 v72, v72, s66, v85
    ds_add_rtn_u32 v87, v72, v10
    ds_wrxchg_rtn_b32 v116, v86, v13

    s_waitcnt lgkmcnt(0)
    v_cmp_gt_u32 s[68:69], 2, v116

    v_cmpx_lt_u32 vcc, 1, v87
    s_nop 0
    v_lshrrev_b64 v[74:75], v123, s[68:69]
    v_perm_b32 v121, v74, v74, v6
    v_and_b32 v121, v121, v22
    v_msad_u8 v120, v29, v121, 0
    v_and_b32 v120, v120, v71

    v_ffbl_b32 v120, v120
    v_max_i32 v84, v120, v84
    s_mov_b64 exec, -1

    v_lshl_add_u32 v73, v84, 1, v30
    v_lshl_add_u32 v71, -1, v84, v71
    ds_read_u16 v82, v73 offset:48
    v_ffbl_b32 v84, v71
    v_lshl_add_u32 v73, v84, 1, v30
    ds_read_u16 v83, v73 offset:48
    s_waitcnt lgkmcnt(0)
    v_lshl_or_b32 v76, v81, 16, v80
    v_lshl_or_b32 v77, v83, 16, v82
    s_branch k1_kernel_sst
k1_kernel_sdone:
    s_waitcnt lgkmcnt(0)
    v_lshl_or_b32 v78, v81, 16, v80
    v_lshl_or_b32 v79, v83, 16, v82
k1_kernel_sst:
    buffer_store_dwordx4 v[76:79], v9, s[32:35], s62 offen sc1
    s_add_u32 s62, s62, 262144
k1_kernel_udone:
    s_setprio 3

    s_mov_b64 exec, 1
    ds_add_rtn_u32 v12, v11, v10 offset:28
    s_waitcnt lgkmcnt(0)
    v_readfirstlane_b32 s45, v12
    s_cmp_ge_u32 s45, 2
    s_cbranch_scc1 k1_kernel_ncl
    s_mov_b64 exec, -1
    s_mul_i32 s45, s45, 16384
    s_min_u32 s45, s45, 16384
    s_lshl_b32 s72, s2, 15
    s_add_u32 s72, s72, s45
    s_add_u32 s72, s72, 20971520
    v_mov_b32 v40, -1
    v_mov_b32 v41, -1
    v_mov_b32 v42, -1
    v_mov_b32 v43, -1
    buffer_store_dwordx4 v[40:43], v9, s[12:15], s72 offen offset:0 sc1
    buffer_store_dwordx4 v[40:43], v9, s[12:15], s72 offen offset:1024 sc1
    buffer_store_dwordx4 v[40:43], v9, s[12:15], s72 offen offset:2048 sc1
    buffer_store_dwordx4 v[40:43], v9, s[12:15], s72 offen offset:3072 sc1
    s_add_u32 s72, s72, 4096
    buffer_store_dwordx4 v[40:43], v9, s[12:15], s72 offen offset:0 sc1
    buffer_store_dwordx4 v[40:43], v9, s[12:15], s72 offen offset:1024 sc1
    buffer_store_dwordx4 v[40:43], v9, s[12:15], s72 offen offset:2048 sc1
    buffer_store_dwordx4 v[40:43], v9, s[12:15], s72 offen offset:3072 sc1
    s_add_u32 s72, s72, 4096
    buffer_store_dwordx4 v[40:43], v9, s[12:15], s72 offen offset:0 sc1
    buffer_store_dwordx4 v[40:43], v9, s[12:15], s72 offen offset:1024 sc1
    buffer_store_dwordx4 v[40:43], v9, s[12:15], s72 offen offset:2048 sc1
    buffer_store_dwordx4 v[40:43], v9, s[12:15], s72 offen offset:3072 sc1
    s_add_u32 s72, s72, 4096
    buffer_store_dwordx4 v[40:43], v9, s[12:15], s72 offen offset:0 sc1
    buffer_store_dwordx4 v[40:43], v9, s[12:15], s72 offen offset:1024 sc1
    buffer_store_dwordx4 v[40:43], v9, s[12:15], s72 offen offset:2048 sc1
    buffer_store_dwordx4 v[40:43], v9, s[12:15], s72 offen offset:3072 sc1
    s_add_u32 s72, s72, 4096
k1_kernel_ncl:

    s_waitcnt vmcnt(0)

    s_mov_b64 exec, 1
    ds_add_rtn_u32 v12, v11, v10 offset:20
    v_mov_b32 v3, 1
    s_bfe_u32 s39, s2, 0x10004
    s_mul_i32 s38, s39, 128
    s_waitcnt lgkmcnt(0)
    v_readfirstlane_b32 s45, v12
    s_cmp_eq_u32 s45, 3
    s_cbranch_scc0 k1_kernel_tld0
    buffer_atomic_add v3, v13, s[52:55], s38 offen offset:32 sc0
k1_kernel_tld0:
    s_and_b32 s45, s45, 3
k1_kernel_tld:
    s_mov_b64 exec, -1
    s_add_u32 s47, s44, 0
    buffer_load_dwordx4 v[32:35], v7, s[20:23], s47 offen offset:0
    buffer_load_dwordx4 v[36:39], v7, s[20:23], s47 offen offset:64
    s_add_u32 s47, s44, 4096
    buffer_load_dwordx4 v[40:43], v7, s[20:23], s47 offen offset:0
    buffer_load_dwordx4 v[44:47], v7, s[20:23], s47 offen offset:64
    s_add_u32 s47, s44, 8192
    buffer_load_dwordx4 v[48:51], v7, s[20:23], s47 offen offset:0
    buffer_load_dwordx4 v[52:55], v7, s[20:23], s47 offen offset:64
    s_cmp_ge_u32 s57, 800
    s_cbranch_scc1 k1_kernel_nsq
    v_mov_b32 v72, 0x0d800000
    v_mov_b32 v73, 0x0d800000
    v_fma_f32 v64, v128, v128, v72
    v_fma_f32 v65, v129, v129, v73
    v_fma_f32 v66, v130, v130, v72
    v_fma_f32 v67, v131, v131, v73
    v_lshlrev_b64 v[128:129], 16, v[128:129]
    v_lshlrev_b64 v[130:131], 16, v[130:131]
    v_fmac_f32 v64, v132, v132
    v_fmac_f32 v65, v133, v133
    v_fmac_f32 v66, v134, v134
    v_fmac_f32 v67, v135, v135
    v_lshlrev_b64 v[132:133], 16, v[132:133]
    v_lshlrev_b64 v[134:135], 16, v[134:135]
    v_fma_f32 v68, v128, v128, v72
    v_fma_f32 v69, v129, v129, v73
    v_fma_f32 v70, v130, v130, v72
    v_fma_f32 v71, v131, v131, v73
    v_fmac_f32 v64, v144, v144
    v_fmac_f32 v65, v145, v145
    v_fmac_f32 v66, v146, v146
    v_fmac_f32 v67, v147, v147
    v_lshlrev_b64 v[144:145], 16, v[144:145]
    v_lshlrev_b64 v[146:147], 16, v[146:147]
    v_fmac_f32 v68, v132, v132
    v_fmac_f32 v69, v133, v133
    v_fmac_f32 v70, v134, v134
    v_fmac_f32 v71, v135, v135
    v_fmac_f32 v64, v148, v148
    v_fmac_f32 v65, v149, v149
    v_fmac_f32 v66, v150, v150
    v_fmac_f32 v67, v151, v151
    v_lshlrev_b64 v[148:149], 16, v[148:149]
    v_lshlrev_b64 v[150:151], 16, v[150:151]
    v_fmac_f32 v68, v144, v144
    v_fmac_f32 v69, v145, v145
    v_fmac_f32 v70, v146, v146
    v_fmac_f32 v71, v147, v147
    v_fmac_f32 v64, v160, v160
    v_fmac_f32 v65, v161, v161
    v_fmac_f32 v66, v162, v162
    v_fmac_f32 v67, v163, v163
    v_lshlrev_b64 v[160:161], 16, v[160:161]
    v_lshlrev_b64 v[162:163], 16, v[162:163]
    v_fmac_f32 v68, v148, v148
    v_fmac_f32 v69, v149, v149
    v_fmac_f32 v70, v150, v150
    v_fmac_f32 v71, v151, v151
    v_fmac_f32 v64, v164, v164
    v_fmac_f32 v65, v165, v165
    v_fmac_f32 v66, v166, v166
    v_fmac_f32 v67, v167, v167
    v_lshlrev_b64 v[164:165], 16, v[164:165]
    v_lshlrev_b64 v[166:167], 16, v[166:167]
    v_fmac_f32 v68, v160, v160
    v_fmac_f32 v69, v161, v161
    v_fmac_f32 v70, v162, v162
    v_fmac_f32 v71, v163, v163
    v_fmac_f32 v64, v176, v176
    v_fmac_f32 v65, v177, v177
    v_fmac_f32 v66, v178, v178
    v_fmac_f32 v67, v179, v179
    v_lshlrev_b64 v[176:177], 16, v[176:177]
    v_lshlrev_b64 v[178:179], 16, v[178:179]
    v_fmac_f32 v68, v164, v164
    v_fmac_f32 v69, v165, v165
    v_fmac_f32 v70, v166, v166
    v_fmac_f32 v71, v167, v167
    v_fmac_f32 v64, v180, v180
    v_fmac_f32 v65, v181, v181
    v_fmac_f32 v66, v182, v182
    v_fmac_f32 v67, v183, v183
    v_lshlrev_b64 v[180:181], 16, v[180:181]
    v_lshlrev_b64 v[182:183], 16, v[182:183]
    v_fmac_f32 v68, v176, v176
    v_fmac_f32 v69, v177, v177
    v_fmac_f32 v70, v178, v178
    v_fmac_f32 v71, v179, v179
    v_fmac_f32 v64, v192, v192
    v_fmac_f32 v65, v193, v193
    v_fmac_f32 v66, v194, v194
    v_fmac_f32 v67, v195, v195
    v_lshlrev_b64 v[192:193], 16, v[192:193]
    v_lshlrev_b64 v[194:195], 16, v[194:195]
    v_fmac_f32 v68, v180, v180
    v_fmac_f32 v69, v181, v181
    v_fmac_f32 v70, v182, v182
    v_fmac_f32 v71, v183, v183
    v_fmac_f32 v64, v196, v196
    v_fmac_f32 v65, v197, v197
    v_fmac_f32 v66, v198, v198
    v_fmac_f32 v67, v199, v199
    v_lshlrev_b64 v[196:197], 16, v[196:197]
    v_lshlrev_b64 v[198:199], 16, v[198:199]
    v_fmac_f32 v68, v192, v192
    v_fmac_f32 v69, v193, v193
    v_fmac_f32 v70, v194, v194
    v_fmac_f32 v71, v195, v195
    v_fmac_f32 v64, v208, v208
    v_fmac_f32 v65, v209, v209
    v_fmac_f32 v66, v210, v210
    v_fmac_f32 v67, v211, v211
    v_lshlrev_b64 v[208:209], 16, v[208:209]
    v_lshlrev_b64 v[210:211], 16, v[210:211]
    v_fmac_f32 v68, v196, v196
    v_fmac_f32 v69, v197, v197
    v_fmac_f32 v70, v198, v198
    v_fmac_f32 v71, v199, v199
    v_fmac_f32 v64, v212, v212
    v_fmac_f32 v65, v213, v213
    v_fmac_f32 v66, v214, v214
    v_fmac_f32 v67, v215, v215
    v_lshlrev_b64 v[212:213], 16, v[212:213]
    v_lshlrev_b64 v[214:215], 16, v[214:215]
    v_fmac_f32 v68, v208, v208
    v_fmac_f32 v69, v209, v209
    v_fmac_f32 v70, v210, v210
    v_fmac_f32 v71, v211, v211
    v_fmac_f32 v64, v224, v224
    v_fmac_f32 v65, v225, v225
    v_fmac_f32 v66, v226, v226
    v_fmac_f32 v67, v227, v227
    v_lshlrev_b64 v[224:225], 16, v[224:225]
    v_lshlrev_b64 v[226:227], 16, v[226:227]
    v_fmac_f32 v68, v212, v212
    v_fmac_f32 v69, v213, v213
    v_fmac_f32 v70, v214, v214
    v_fmac_f32 v71, v215, v215
    v_fmac_f32 v64, v228, v228
    v_fmac_f32 v65, v229, v229
    v_fmac_f32 v66, v230, v230
    v_fmac_f32 v67, v231, v231
    v_lshlrev_b64 v[228:229], 16, v[228:229]
    v_lshlrev_b64 v[230:231], 16, v[230:231]
    v_fmac_f32 v68, v224, v224
    v_fmac_f32 v69, v225, v225
    v_fmac_f32 v70, v226, v226
    v_fmac_f32 v71, v227, v227
    v_fmac_f32 v64, v240, v240
    v_fmac_f32 v65, v241, v241
    v_fmac_f32 v66, v242, v242
    v_fmac_f32 v67, v243, v243
    v_lshlrev_b64 v[240:241], 16, v[240:241]
    v_lshlrev_b64 v[242:243], 16, v[242:243]
    v_fmac_f32 v68, v228, v228
    v_fmac_f32 v69, v229, v229
    v_fmac_f32 v70, v230, v230
    v_fmac_f32 v71, v231, v231
    v_fmac_f32 v64, v244, v244
    v_fmac_f32 v65, v245, v245
    v_fmac_f32 v66, v246, v246
    v_fmac_f32 v67, v247, v247
    v_lshlrev_b64 v[244:245], 16, v[244:245]
    v_lshlrev_b64 v[246:247], 16, v[246:247]
    v_fmac_f32 v68, v240, v240
    v_fmac_f32 v69, v241, v241
    v_fmac_f32 v70, v242, v242
    v_fmac_f32 v71, v243, v243
    v_fmac_f32 v72, v24, v24
    v_fmac_f32 v73, v25, v25
    v_lshlrev_b64 v[24:25], 16, v[24:25]
    v_fmac_f32 v72, v26, v26
    v_fmac_f32 v73, v27, v27
    v_lshlrev_b64 v[26:27], 16, v[26:27]
    v_fmac_f32 v68, v244, v244
    v_fmac_f32 v69, v245, v245
    v_fmac_f32 v70, v246, v246
    v_fmac_f32 v71, v247, v247

    v_fmac_f32 v72, v24, v24
    v_fmac_f32 v73, v25, v25
    v_max3_u32 v64, v64, v65, v66
    v_max3_u32 v67, v67, v68, v69
    v_fmac_f32 v72, v26, v26
    v_fmac_f32 v73, v27, v27
    v_max3_u32 v64, v64, v70, v71
    v_max_u32 v64, v64, v67
    v_add_f32 v72, v72, v73

    s_nop 0
    v_max_u32_dpp v64, v64, v64 row_ror:8 row_mask:0xf bank_mask:0xf
    v_add_f32_dpp v72, v72, v72 row_ror:8 row_mask:0xf bank_mask:0xf
    s_nop 0
    v_max_u32_dpp v64, v64, v64 row_ror:4 row_mask:0xf bank_mask:0xf
    v_add_f32_dpp v72, v72, v72 row_ror:4 row_mask:0xf bank_mask:0xf
    s_nop 0
    v_max_u32_dpp v64, v64, v64 row_ror:2 row_mask:0xf bank_mask:0xf
    v_add_f32_dpp v72, v72, v72 row_ror:2 row_mask:0xf bank_mask:0xf
    s_nop 0
    v_max_u32_dpp v64, v64, v64 row_ror:1 row_mask:0xf bank_mask:0xf
    v_add_f32_dpp v72, v72, v72 row_ror:1 row_mask:0xf bank_mask:0xf
    s_nop 0
    v_max_u32_dpp v64, v64, v64 row_bcast:15 row_mask:0xa bank_mask:0xf
    v_max_u32_dpp v72, v72, v72 row_bcast:15 row_mask:0xa bank_mask:0xf
    s_nop 0
    v_max_u32_dpp v64, v64, v64 row_bcast:31 row_mask:0xc bank_mask:0xf
    v_max_u32_dpp v72, v72, v72 row_bcast:31 row_mask:0xc bank_mask:0xf

    s_mov_b32 exec_lo, 0
    s_brev_b32 exec_hi, 1
    v_min_u32 v64, 0x7f000000, v64
    v_min_u32 v72, 0x7f000000, v72
    v_perm_b32 v64, v64, v72, s85
    v_add_u32 v64, 0x10001, v64
    buffer_store_dword v64, off, s[32:35], s78 sc1
    s_mov_b64 exec, -1
k1_kernel_nsq:

    s_cmp_eq_u32 s45, 3
    s_cbranch_scc0 k1_kernel_wdec
    s_lshl_b32 s45, s2, 8
    s_add_u32 s45, s45, 14680064
    v_lshlrev_b32 v0, 8, v8
    v_mov_b32 v116, 0
    s_lshl4_add_u32 s38, s39, 14680064
    s_cmp_lg_u32 s64, 0
    s_cbranch_scc1 k1_kernel_bits
    s_waitcnt vmcnt(6)
    v_readfirstlane_b32 s39, v3

    s_cmp_eq_u32 s39, 127
    s_cbranch_scc0 k1_kernel_poll0

    buffer_store_dword v10, v0, s[12:15], s38 offen sc1
    s_add_u32 s38, s38, 16384
    buffer_store_dword v10, v0, s[12:15], s38 offen sc1
    s_add_u32 s38, s38, 16384
    buffer_store_dword v10, v0, s[12:15], s38 offen sc1
    s_add_u32 s38, s38, 16384
    buffer_store_dword v10, v0, s[12:15], s38 offen sc1

k1_kernel_poll0:
    s_mov_b64 exec, 3
k1_kernel_poll:
    buffer_load_dword v116, v9, s[12:15], s45 offen sc1
    s_add_u32 s65, s65, 1
    s_waitcnt vmcnt(0)
    v_cmp_ne_u32 vcc, 1, v116
    s_cbranch_vccz k1_kernel_go

    s_cmp_lt_u32 s65, 200
    s_cbranch_scc1 k1_kernel_poll
k1_kernel_bits:
    s_mov_b64 exec, -1
    s_lshr_b32 s38, s51, 5
    s_lshl_b32 s39, 1, s51
    v_cmp_eq_u32 vcc, s38, v8
    v_mov_b32 v2, s39
    v_lshlrev_b32 v0, 2, v8
    v_cndmask_b32 v2, 0, v2, vcc
    v_mov_b32 v1, v2
    buffer_atomic_or v1, v0, s[52:55], 0 offen sc0
    s_waitcnt vmcnt(0)
    v_cmp_ne_u32 vcc, 128, v1
    v_or_b32 v1, v1, v2
    s_and_b32 s38, vcc_lo, 0x100
    s_and_b32 s39, vcc_hi, 0x100
    v_cmp_ne_u32 vcc, -1, v1
    s_or_b32 s38, s38, s39
    s_cbranch_scc0 k1_kernel_go
    s_and_b32 s39, vcc_lo, 0xff
    s_mov_b32 s38, 0xc0000000
    s_cbranch_scc0 k1_kernel_dec
    s_ff1_i32_b32 s38, s39
    s_nop 3
    v_readlane_b32 s39, v1, s38
    s_ff0_i32_b32 s39, s39
    s_lshl_b32 s38, s38, 5
    s_add_u32 s38, s38, s39
    s_andn2_b32 s39, s64, 255
    s_add_u32 s39, s39, 256
    s_or_b32 s38, s38, s39
    s_branch k1_kernel_dec

k1_kernel_go:

    s_mov_b32 s38, 0x80000000

k1_kernel_dec:

    v_mov_b32 v1, s38
    s_mov_b64 exec, 1
    ds_write_b32 v11, v1 offset:24

k1_kernel_wdec:

    s_mov_b64 exec, -1
    ds_read_b32 v12, v11 offset:24
    s_waitcnt lgkmcnt(0)
    v_readfirstlane_b32 s45, v12
    s_cmp_lg_u32 s45, s64
    s_cbranch_scc1 k1_kernel_gotd
    s_sleep 2
    s_branch k1_kernel_wdec
k1_kernel_redo:
    s_waitcnt vmcnt(0) lgkmcnt(0)
    s_branch k1_kernel_unit

k1_kernel_gotd:

    s_mov_b32 s64, s45
    s_and_b32 s51, s45, 255
    s_mov_b32 s65, 0x10000
    s_bitcmp0_b32 s45, 31
    s_cbranch_scc1 k1_kernel_redo

k1_kernel_k2:

    s_setprio 0
    s_load_dwordx4 s[8:11], s[0:1], 32
    s_load_dwordx2 s[56:57], s[0:1], 48
    s_load_dwordx2 s[60:61], s[0:1], 56
    v_mbcnt_lo_u32_b32 v0, -1, 0
    v_mbcnt_hi_u32_b32 v0, -1, v0
    s_mul_i32 s35, s3, 18432
    v_and_b32 v1, 15, v0
    v_lshrrev_b32 v2, 4, v0
    v_mul_u32_u24 v65, 144, v1
    v_lshl_add_u32 v65, v2, 4, v65
    v_add_u32 v65, s35, v65

    ds_read_b128 v[128:131], v65 offset:0
    ds_read_b128 v[132:135], v65 offset:64
    ds_read_b128 v[144:147], v65 offset:2304
    ds_read_b128 v[148:151], v65 offset:2368
    ds_read_b128 v[160:163], v65 offset:4608
    ds_read_b128 v[164:167], v65 offset:4672
    ds_read_b128 v[176:179], v65 offset:6912
    ds_read_b128 v[180:183], v65 offset:6976
    ds_read_b128 v[192:195], v65 offset:9216
    ds_read_b128 v[196:199], v65 offset:9280
    ds_read_b128 v[208:211], v65 offset:11520
    ds_read_b128 v[212:215], v65 offset:11584
    ds_read_b128 v[224:227], v65 offset:13824
    ds_read_b128 v[228:231], v65 offset:13888
    ds_read_b128 v[240:243], v65 offset:16128
    ds_read_b128 v[244:247], v65 offset:16192

    s_lshr_b32 s33, s2, 1
    s_and_b32 s34, s2, 1
    v_lshlrev_b32 v71, 4, v0

    s_mul_i32 s21, s33, 102656
    s_mul_i32 s35, s34, 49152
    s_sub_u32 s22, 53248, s35
    s_add_u32 s21, s21, s35
    s_lshl_b32 s35, s50, 11
    s_xor_b32 s19, s35, 2048
    s_add_u32 s19, s19, s21
    s_add_u32 s21, s21, s35
    s_mul_i32 s20, s34, 1703936
    s_add_u32 s20, s20, 16777216
    s_lshl_b32 s35, s3, 14
    s_add_u32 s20, s20, s35

    v_lshlrev_b32 v64, 13, v2
    v_lshl_add_u32 v64, v1, 3, v64
    s_lshl_b32 s35, s3, 10
    v_add_u32 v64, s35, v64
    v_mov_b32 v70, v64
    s_mov_b32 s23, 0x06050201

    s_bitcmp0_b32 s64, 31
    s_cbranch_scc1 k1_kernel_k2n
    s_cmp_lt_u32 s3, 4
    s_cbranch_scc1 k1_kernel_k2s
    v_bfe_u32 v84, v71, 2, 7
    s_mov_b32 s35, 15466496
    buffer_load_dwordx4 v[72:75], v71, s[12:15], s35 offen offset:0 sc1
    buffer_load_dwordx4 v[76:79], v71, s[12:15], s35 offen offset:1024 sc1
    buffer_load_dwordx4 v[80:83], v71, s[12:15], s35 offen offset:2048 sc1
    buffer_load_dword v84, v84, s[12:15], s35 offen offset:3584 sc1
k1_kernel_k2s:
    buffer_load_dwordx4 v[0:3], v71, s[12:15], s21 offen offset:0
    buffer_load_dwordx4 v[4:7], v71, s[12:15], s21 offen offset:1024
    buffer_load_dwordx4 v[8:11], v71, s[12:15], s19 offen offset:0
    buffer_load_dwordx4 v[12:15], v71, s[12:15], s19 offen offset:1024
    s_add_u32 s21, s21, 4096
    s_add_u32 s19, s19, 4096
    buffer_load_dwordx4 v[16:19], v71, s[12:15], s21 offen offset:0
    buffer_load_dwordx4 v[20:23], v71, s[12:15], s21 offen offset:1024
    buffer_load_dwordx4 v[24:27], v71, s[12:15], s19 offen offset:0
    buffer_load_dwordx4 v[28:31], v71, s[12:15], s19 offen offset:1024
    s_add_u32 s21, s21, 4096
    s_add_u32 s19, s19, 4096
    s_cmp_lt_u32 s3, 4
    s_cbranch_scc1 k1_kernel_k2n
    s_mov_b32 s44, s21
    s_mov_b32 s45, s19
    s_add_u32 s21, s21, 4096
    s_add_u32 s19, s19, 4096
    buffer_load_dwordx2 v[116:117], v71, s[12:15], s20 offen offset:0 sc1
    buffer_load_dwordx2 v[118:119], v71, s[12:15], s20 offen offset:1024 sc1
    buffer_load_dwordx2 v[120:121], v71, s[12:15], s20 offen offset:2048 sc1
    buffer_load_dwordx2 v[122:123], v71, s[12:15], s20 offen offset:3072 sc1
    s_waitcnt vmcnt(12)

k1_kernel_scb0:
    v_max3_u16 v85, v72, v73, v74
    v_add_f32 v76, v76, v80
    v_add_f32 v77, v77, v81
    v_max_u16_sdwa v85, v85, v75 dst_sel:WORD_1 dst_unused:UNUSED_PAD src0_sel:WORD_0 src1_sel:WORD_0
    v_add_f32 v78, v78, v82
    v_add_f32 v79, v79, v83
    v_add_f32 v72, v72, v74
    v_add_f32 v73, v73, v75
    v_add_f32 v76, v76, v78
    v_add_f32 v77, v77, v79
    v_max_u32_dpp v85, v85, v85 row_ror:8 row_mask:0xf bank_mask:0xf
    v_add_f32 v76, v76, v72
    v_add_f32 v77, v77, v73
    v_max_u32_dpp v85, v85, v85 row_ror:4 row_mask:0xf bank_mask:0xf
    v_add_f32 v76, v76, v77
    v_add_f32 v76, v76, v84
    v_max_u32_dpp v85, v85, v85 row_ror:2 row_mask:0xf bank_mask:0xf
    s_nop 0
    v_add_f32_dpp v76, v76, v76 row_ror:8 row_mask:0xf bank_mask:0xf
    v_max_u32_dpp v85, v85, v85 row_ror:1 row_mask:0xf bank_mask:0xf
    s_nop 0
    v_add_f32_dpp v76, v76, v76 row_ror:4 row_mask:0xf bank_mask:0xf
    v_max_u32_dpp v85, v85, v85 row_bcast:15 row_mask:0xa bank_mask:0xf
    s_nop 0
    v_add_f32_dpp v76, v76, v76 row_ror:2 row_mask:0xf bank_mask:0xf
    v_max_u32_dpp v85, v85, v85 row_bcast:31 row_mask:0xc bank_mask:0xf
    s_nop 0
    v_add_f32_dpp v76, v76, v76 row_ror:1 row_mask:0xf bank_mask:0xf
    v_mul_f32 v85, 0x425428f6, v85
    s_nop 0
    v_add_f32_dpp v76, v76, v76 row_bcast:15 row_mask:0xa bank_mask:0xf
    s_nop 1
    v_max_u32_dpp v76, v76, v76 row_bcast:31 row_mask:0xc bank_mask:0xf
    v_mul_f32 v76, v76, v85
    s_nop 0
    v_readlane_b32 s26, v76, 63
    s_cmp_gt_u32 s26, 0x7f800000
    s_cbranch_scc1 k1_kernel_scr0
    s_add_u32 s26, s26, 0x40800000
    s_lshr_b32 s26, s26, 24
    s_lshl_b32 s26, s26, 23
    s_add_u32 s26, s26, 0x400080
    v_mov_b32 v66, s26
    v_mov_b32 v67, s26
    v_mov_b32 v68, s26
    v_mov_b32 v69, s26
    buffer_load_dwordx4 v[72:75], v71, s[12:15], s21 offen offset:0
    buffer_load_dwordx4 v[76:79], v71, s[12:15], s21 offen offset:1024
    buffer_load_dwordx4 v[80:83], v71, s[12:15], s19 offen offset:0
    buffer_load_dwordx4 v[84:87], v71, s[12:15], s19 offen offset:1024
    s_add_u32 s21, s21, 4096
    s_add_u32 s19, s19, 4096
    v_mov_b32 v65, 0
    ds_write_b128 v65, v[66:69] offset:28928
k1_kernel_k2n:

    s_and_b32 s35, s3, 3
    s_lshl_b32 s35, s35, 14
    s_add_u32 s35, s35, 98304
    v_add_u32 v65, s35, v71

    s_lshl_b32 s16, s2, 3
    s_add_u32 s16, s16, s3
    s_lshl_b32 s46, s16, 7
    s_mul_i32 s16, s16, 8448
    s_add_u32 s46, s46, 30408704
    s_add_u32 s16, s16, 67108864

    s_xor_b32 s47, s46, 1024
    s_mul_i32 s35, s34, 135168
    s_add_u32 s18, s16, 67584
    s_sub_u32 s18, s18, s35
    s_mov_b32 s48, 0
    s_lshl_b32 s35, s33, 3
    s_waitcnt lgkmcnt(0)
    s_add_u32 s8, s8, s35
    s_addc_u32 s9, s9, 0
    s_add_u32 s10, s10, s35
    s_addc_u32 s11, s11, 0
    s_load_dwordx2 s[36:37], s[8:9], 0
    s_load_dwordx2 s[38:39], s[10:11], 0
    s_barrier

    s_cmp_lt_u32 s3, 4
    s_cbranch_scc1 k1_kernel_k2m

    s_waitcnt vmcnt(12)
    s_setprio 1
    ds_write_b128 v65, v[32:35] offset:0
    ds_write_b128 v65, v[36:39] offset:1024
    ds_write_b128 v65, v[40:43] offset:2048
    ds_write_b128 v65, v[44:47] offset:3072
    v_mfma_f32_16x16x32_bf16 v[32:35], v[0:3], v[128:131], v[66:69]
    v_mfma_f32_16x16x32_bf16 v[36:39], v[0:3], v[144:147], v[66:69]
    ds_write_b128 v65, v[48:51] offset:4096
    v_mfma_f32_16x16x32_bf16 v[40:43], v[0:3], v[160:163], v[66:69]
    v_mfma_f32_16x16x32_bf16 v[44:47], v[0:3], v[176:179], v[66:69]
    ds_write_b128 v65, v[52:55] offset:5120
    v_mfma_f32_16x16x32_bf16 v[32:35], v[4:7], v[132:135], v[32:35]
    v_mfma_f32_16x16x32_bf16 v[36:39], v[4:7], v[148:151], v[36:39]
    ds_write_b128 v65, v[56:59] offset:6144
    v_mfma_f32_16x16x32_bf16 v[40:43], v[4:7], v[164:167], v[40:43]
    v_mfma_f32_16x16x32_bf16 v[44:47], v[4:7], v[180:183], v[44:47]
    ds_write_b128 v65, v[60:63] offset:7168
    v_mfma_f32_16x16x32_bf16 v[32:35], v[8:11], v[136:139], v[32:35]
    v_mfma_f32_16x16x32_bf16 v[36:39], v[8:11], v[152:155], v[36:39]
    ds_write_b128 v65, v[88:91] offset:8192
    v_mfma_f32_16x16x32_bf16 v[40:43], v[8:11], v[168:171], v[40:43]
    v_mfma_f32_16x16x32_bf16 v[44:47], v[8:11], v[184:187], v[44:47]
    ds_write_b128 v65, v[92:95] offset:9216
    v_mfma_f32_16x16x32_bf16 v[32:35], v[12:15], v[140:143], v[32:35]
    v_mfma_f32_16x16x32_bf16 v[36:39], v[12:15], v[156:159], v[36:39]
    ds_write_b128 v65, v[96:99] offset:10240
    v_mfma_f32_16x16x32_bf16 v[40:43], v[12:15], v[172:175], v[40:43]
    v_mfma_f32_16x16x32_bf16 v[44:47], v[12:15], v[188:191], v[44:47]
    ds_write_b128 v65, v[100:103] offset:11264
    v_mfma_f32_16x16x32_bf16 v[48:51], v[0:3], v[192:195], v[66:69]
    v_mfma_f32_16x16x32_bf16 v[52:55], v[0:3], v[208:211], v[66:69]
    ds_write_b128 v65, v[104:107] offset:12288
    v_mfma_f32_16x16x32_bf16 v[56:59], v[0:3], v[224:227], v[66:69]
    v_mfma_f32_16x16x32_bf16 v[60:63], v[0:3], v[240:243], v[66:69]
    ds_write_b128 v65, v[108:111] offset:13312
    v_mfma_f32_16x16x32_bf16 v[48:51], v[4:7], v[196:199], v[48:51]
    v_mfma_f32_16x16x32_bf16 v[52:55], v[4:7], v[212:215], v[52:55]
    ds_write_b128 v65, v[112:115] offset:14336
    v_mfma_f32_16x16x32_bf16 v[56:59], v[4:7], v[228:231], v[56:59]
    v_mfma_f32_16x16x32_bf16 v[60:63], v[4:7], v[244:247], v[60:63]
    ds_write_b128 v65, v[124:127] offset:15360
    v_mfma_f32_16x16x32_bf16 v[48:51], v[8:11], v[200:203], v[48:51]
    v_mfma_f32_16x16x32_bf16 v[52:55], v[8:11], v[216:219], v[52:55]
    v_mfma_f32_16x16x32_bf16 v[56:59], v[8:11], v[232:235], v[56:59]
    v_mfma_f32_16x16x32_bf16 v[60:63], v[8:11], v[248:251], v[60:63]
    s_waitcnt lgkmcnt(0)
    s_barrier
    s_setprio 0
    v_mfma_f32_16x16x32_bf16 v[48:51], v[12:15], v[204:207], v[48:51]
    v_mfma_f32_16x16x32_bf16 v[52:55], v[12:15], v[220:223], v[52:55]
    v_mfma_f32_16x16x32_bf16 v[56:59], v[12:15], v[236:239], v[56:59]
    v_mfma_f32_16x16x32_bf16 v[60:63], v[12:15], v[252:255], v[60:63]
    s_add_u32 s20, s20, 4096
    buffer_load_dwordx2 v[124:125], v71, s[12:15], s20 offen offset:0 sc1
    buffer_load_dwordx2 v[126:127], v71, s[12:15], s20 offen offset:1024 sc1
    buffer_load_dwordx4 v[0:3], v71, s[12:15], s44 offen offset:0
    buffer_load_dwordx4 v[4:7], v71, s[12:15], s44 offen offset:1024
    buffer_load_dwordx4 v[8:11], v71, s[12:15], s45 offen offset:0
    buffer_load_dwordx4 v[12:15], v71, s[12:15], s45 offen offset:1024
    s_waitcnt vmcnt(14)
    v_readfirstlane_b32 s26, v66
    s_bfe_u32 s25, s26, 0x10017
    s_lshl1_add_u32 s25, s25, 1
    s_mul_i32 s24, s25, 0xfff30000
    s_mul_i32 s25, s25, 0xfff40000
    s_and_b32 s26, s26, 0x7f800000
    s_add_u32 s24, s24, 0x80008000
    s_add_u32 s25, s25, 0x80008000
    s_sub_u32 s26, s26, 0x7800000
    s_mov_b32 s27, 0x4b000000

    v_mfma_f32_16x16x32_bf16 v[88:91], v[16:19], v[128:131], v[66:69]
    v_mfma_f32_16x16x32_bf16 v[92:95], v[16:19], v[144:147], v[66:69]
    v_mfma_f32_16x16x32_bf16 v[88:91], v[20:23], v[132:135], v[88:91]
    v_mfma_f32_16x16x32_bf16 v[92:95], v[20:23], v[148:151], v[92:95]
    v_mfma_f32_16x16x32_bf16 v[88:91], v[24:27], v[136:139], v[88:91]
    v_perm_b32 v32, v33, v32, s23
    v_mfma_f32_16x16x32_bf16 v[92:95], v[24:27], v[152:155], v[92:95]
    v_perm_b32 v33, v35, v34, s23
    v_mfma_f32_16x16x32_bf16 v[88:91], v[28:31], v[140:143], v[88:91]
    ds_write_b64 v64, v[32:33] offset:0
    v_mfma_f32_16x16x32_bf16 v[92:95], v[28:31], v[156:159], v[92:95]
    v_perm_b32 v36, v37, v36, s23
    v_mfma_f32_16x16x32_bf16 v[96:99], v[16:19], v[160:163], v[66:69]
    v_perm_b32 v37, v39, v38, s23
    v_mfma_f32_16x16x32_bf16 v[100:103], v[16:19], v[176:179], v[66:69]
    ds_write_b64 v64, v[36:37] offset:128
    v_mfma_f32_16x16x32_bf16 v[96:99], v[20:23], v[164:167], v[96:99]
    v_perm_b32 v88, v89, v88, s23
    v_perm_b32 v40, v41, v40, s23
    v_mfma_f32_16x16x32_bf16 v[100:103], v[20:23], v[180:183], v[100:103]
    v_perm_b32 v89, v91, v90, s23
    v_perm_b32 v41, v43, v42, s23
    v_mfma_f32_16x16x32_bf16 v[96:99], v[24:27], v[168:171], v[96:99]
    ds_write_b64 v64, v[88:89] offset:32768
    ds_write_b64 v64, v[40:41] offset:256
    v_mfma_f32_16x16x32_bf16 v[100:103], v[24:27], v[184:187], v[100:103]
    v_perm_b32 v92, v93, v92, s23
    v_perm_b32 v44, v45, v44, s23
    v_mfma_f32_16x16x32_bf16 v[96:99], v[28:31], v[172:175], v[96:99]
    v_perm_b32 v93, v95, v94, s23
    v_perm_b32 v45, v47, v46, s23
    v_mfma_f32_16x16x32_bf16 v[100:103], v[28:31], v[188:191], v[100:103]
    ds_write_b64 v64, v[92:93] offset:32896
    ds_write_b64 v64, v[44:45] offset:384
    v_mfma_f32_16x16x32_bf16 v[104:107], v[16:19], v[192:195], v[66:69]
    v_perm_b32 v48, v49, v48, s23
    v_mfma_f32_16x16x32_bf16 v[108:111], v[16:19], v[208:211], v[66:69]
    v_perm_b32 v49, v51, v50, s23
    v_mfma_f32_16x16x32_bf16 v[104:107], v[20:23], v[196:199], v[104:107]
    v_perm_b32 v96, v97, v96, s23
    ds_write_b64 v64, v[48:49] offset:512
    v_mfma_f32_16x16x32_bf16 v[108:111], v[20:23], v[212:215], v[108:111]
    v_perm_b32 v97, v99, v98, s23
    v_perm_b32 v52, v53, v52, s23
    v_mfma_f32_16x16x32_bf16 v[104:107], v[24:27], v[200:203], v[104:107]
    ds_write_b64 v64, v[96:97] offset:33024
    v_perm_b32 v53, v55, v54, s23
    v_mfma_f32_16x16x32_bf16 v[108:111], v[24:27], v[216:219], v[108:111]
    v_perm_b32 v100, v101, v100, s23
    ds_write_b64 v64, v[52:53] offset:640
    v_mfma_f32_16x16x32_bf16 v[104:107], v[28:31], v[204:207], v[104:107]
    v_perm_b32 v101, v103, v102, s23
    v_perm_b32 v56, v57, v56, s23
    v_mfma_f32_16x16x32_bf16 v[108:111], v[28:31], v[220:223], v[108:111]
    ds_write_b64 v64, v[100:101] offset:33152
    v_perm_b32 v57, v59, v58, s23
    v_mfma_f32_16x16x32_bf16 v[88:91], v[16:19], v[224:227], v[66:69]
    ds_write_b64 v64, v[56:57] offset:768
    v_mfma_f32_16x16x32_bf16 v[92:95], v[16:19], v[240:243], v[66:69]
    v_perm_b32 v60, v61, v60, s23
    v_mfma_f32_16x16x32_bf16 v[88:91], v[20:23], v[228:231], v[88:91]
    v_perm_b32 v104, v105, v104, s23
    v_perm_b32 v61, v63, v62, s23
    v_mfma_f32_16x16x32_bf16 v[92:95], v[20:23], v[244:247], v[92:95]
    v_perm_b32 v105, v107, v106, s23
    ds_write_b64 v64, v[60:61] offset:896
    v_mfma_f32_16x16x32_bf16 v[88:91], v[24:27], v[232:235], v[88:91]
    ds_write_b64 v64, v[104:105] offset:33280
    v_mfma_f32_16x16x32_bf16 v[92:95], v[24:27], v[248:251], v[92:95]
    v_perm_b32 v108, v109, v108, s23
    v_mfma_f32_16x16x32_bf16 v[88:91], v[28:31], v[236:239], v[88:91]
    v_perm_b32 v109, v111, v110, s23
    v_mfma_f32_16x16x32_bf16 v[92:95], v[28:31], v[252:255], v[92:95]
    ds_write_b64 v64, v[108:109] offset:33408
    v_add_u32 v64, 0x8000, v64
    s_waitcnt vmcnt(0)
    v_mfma_f32_16x16x32_bf16 v[96:99], v[0:3], v[128:131], v[66:69]
    v_mfma_f32_16x16x32_bf16 v[100:103], v[0:3], v[144:147], v[66:69]
    v_mfma_f32_16x16x32_bf16 v[96:99], v[4:7], v[132:135], v[96:99]
    v_perm_b32 v88, v89, v88, s23
    v_mfma_f32_16x16x32_bf16 v[100:103], v[4:7], v[148:151], v[100:103]
    v_perm_b32 v89, v91, v90, s23
    v_mfma_f32_16x16x32_bf16 v[96:99], v[8:11], v[136:139], v[96:99]
    ds_write_b64 v64, v[88:89] offset:768
    v_mfma_f32_16x16x32_bf16 v[100:103], v[8:11], v[152:155], v[100:103]
    v_perm_b32 v92, v93, v92, s23
    v_mfma_f32_16x16x32_bf16 v[96:99], v[12:15], v[140:143], v[96:99]
    v_perm_b32 v93, v95, v94, s23
    v_mfma_f32_16x16x32_bf16 v[100:103], v[12:15], v[156:159], v[100:103]
    ds_write_b64 v64, v[92:93] offset:896
    v_mfma_f32_16x16x32_bf16 v[104:107], v[0:3], v[160:163], v[66:69]
    v_mfma_f32_16x16x32_bf16 v[108:111], v[0:3], v[176:179], v[66:69]
    v_mfma_f32_16x16x32_bf16 v[104:107], v[4:7], v[164:167], v[104:107]
    v_perm_b32 v96, v97, v96, s23
    v_mfma_f32_16x16x32_bf16 v[108:111], v[4:7], v[180:183], v[108:111]
    v_perm_b32 v97, v99, v98, s23
    v_mfma_f32_16x16x32_bf16 v[104:107], v[8:11], v[168:171], v[104:107]
    ds_write_b64 v64, v[96:97] offset:32768
    v_mfma_f32_16x16x32_bf16 v[108:111], v[8:11], v[184:187], v[108:111]
    v_perm_b32 v100, v101, v100, s23
    v_mfma_f32_16x16x32_bf16 v[104:107], v[12:15], v[172:175], v[104:107]
    v_perm_b32 v101, v103, v102, s23
    v_mfma_f32_16x16x32_bf16 v[108:111], v[12:15], v[188:191], v[108:111]
    ds_write_b64 v64, v[100:101] offset:32896
    v_mfma_f32_16x16x32_bf16 v[88:91], v[0:3], v[192:195], v[66:69]
    v_mfma_f32_16x16x32_bf16 v[92:95], v[0:3], v[208:211], v[66:69]
    v_mfma_f32_16x16x32_bf16 v[88:91], v[4:7], v[196:199], v[88:91]
    v_perm_b32 v104, v105, v104, s23
    v_mfma_f32_16x16x32_bf16 v[92:95], v[4:7], v[212:215], v[92:95]
    v_perm_b32 v105, v107, v106, s23
    v_mfma_f32_16x16x32_bf16 v[88:91], v[8:11], v[200:203], v[88:91]
    ds_write_b64 v64, v[104:105] offset:33024
    v_mfma_f32_16x16x32_bf16 v[92:95], v[8:11], v[216:219], v[92:95]
    v_perm_b32 v108, v109, v108, s23
    v_mfma_f32_16x16x32_bf16 v[88:91], v[12:15], v[204:207], v[88:91]
    v_perm_b32 v109, v111, v110, s23
    v_mfma_f32_16x16x32_bf16 v[92:95], v[12:15], v[220:223], v[92:95]
    ds_write_b64 v64, v[108:109] offset:33152
    v_mfma_f32_16x16x32_bf16 v[96:99], v[0:3], v[224:227], v[66:69]
    v_mfma_f32_16x16x32_bf16 v[100:103], v[0:3], v[240:243], v[66:69]
    v_mfma_f32_16x16x32_bf16 v[96:99], v[4:7], v[228:231], v[96:99]
    v_perm_b32 v88, v89, v88, s23
    v_mfma_f32_16x16x32_bf16 v[100:103], v[4:7], v[244:247], v[100:103]
    v_perm_b32 v89, v91, v90, s23
    v_mfma_f32_16x16x32_bf16 v[96:99], v[8:11], v[232:235], v[96:99]
    ds_write_b64 v64, v[88:89] offset:33280
    v_mfma_f32_16x16x32_bf16 v[100:103], v[8:11], v[248:251], v[100:103]
    v_perm_b32 v92, v93, v92, s23
    v_mfma_f32_16x16x32_bf16 v[96:99], v[12:15], v[236:239], v[96:99]
    v_perm_b32 v93, v95, v94, s23
    v_mfma_f32_16x16x32_bf16 v[100:103], v[12:15], v[252:255], v[100:103]
    ds_write_b64 v64, v[92:93] offset:33408
    s_nop 7
    v_perm_b32 v96, v97, v96, s23
    v_perm_b32 v97, v99, v98, s23
    ds_write_b64 v64, v[96:97] offset:33536
    v_perm_b32 v100, v101, v100, s23
    v_perm_b32 v101, v103, v102, s23
    ds_write_b64 v64, v[100:101] offset:33664

    s_cmp_lg_u32 s3, 7
    s_cbranch_scc1 k1_kernel_k2j
k1_kernel_k2w:
    s_bfe_u32 s35, s64, 0x1001e
    v_mov_b32 v65, 0
    v_mov_b32 v64, s35
    ds_write_b32 v65, v64 offset:8184
    s_branch k1_kernel_k2j

k1_kernel_k2m:
    s_bitcmp1_b32 s64, 31
    s_cbranch_scc1 k1_kernel_k2e
    buffer_load_dwordx4 v[0:3], v71, s[12:15], s21 offen offset:0
    buffer_load_dwordx4 v[4:7], v71, s[12:15], s21 offen offset:1024
    buffer_load_dwordx4 v[8:11], v71, s[12:15], s19 offen offset:0
    buffer_load_dwordx4 v[12:15], v71, s[12:15], s19 offen offset:1024
    s_add_u32 s21, s21, 4096
    s_add_u32 s19, s19, 4096
    buffer_load_dwordx4 v[16:19], v71, s[12:15], s21 offen offset:0
    buffer_load_dwordx4 v[20:23], v71, s[12:15], s21 offen offset:1024
    buffer_load_dwordx4 v[24:27], v71, s[12:15], s19 offen offset:0
    buffer_load_dwordx4 v[28:31], v71, s[12:15], s19 offen offset:1024
    s_add_u32 s21, s21, 4096
    s_add_u32 s19, s19, 4096
k1_kernel_k2e:
    v_mov_b32 v66, 0
    ds_read_b128 v[66:69], v66 offset:28928
    s_mov_b32 s44, s21
    s_mov_b32 s45, s19
    s_add_u32 s21, s21, 4096
    s_add_u32 s19, s19, 4096
    s_waitcnt vmcnt(4) lgkmcnt(0)
    v_mfma_f32_16x16x32_bf16 v[48:51], v[0:3], v[128:131], v[66:69]
    v_mfma_f32_16x16x32_bf16 v[52:55], v[0:3], v[144:147], v[66:69]
    v_mfma_f32_16x16x32_bf16 v[56:59], v[0:3], v[160:163], v[66:69]
    v_mfma_f32_16x16x32_bf16 v[60:63], v[0:3], v[176:179], v[66:69]
    v_mfma_f32_16x16x32_bf16 v[88:91], v[0:3], v[192:195], v[66:69]
    v_mfma_f32_16x16x32_bf16 v[92:95], v[0:3], v[208:211], v[66:69]
    v_mfma_f32_16x16x32_bf16 v[96:99], v[0:3], v[224:227], v[66:69]
    v_mfma_f32_16x16x32_bf16 v[100:103], v[0:3], v[240:243], v[66:69]
    v_mfma_f32_16x16x32_bf16 v[48:51], v[4:7], v[132:135], v[48:51]
    v_mfma_f32_16x16x32_bf16 v[52:55], v[4:7], v[148:151], v[52:55]
    v_mfma_f32_16x16x32_bf16 v[56:59], v[4:7], v[164:167], v[56:59]
    v_mfma_f32_16x16x32_bf16 v[60:63], v[4:7], v[180:183], v[60:63]
    v_mfma_f32_16x16x32_bf16 v[88:91], v[4:7], v[196:199], v[88:91]
    v_mfma_f32_16x16x32_bf16 v[92:95], v[4:7], v[212:215], v[92:95]
    v_mfma_f32_16x16x32_bf16 v[96:99], v[4:7], v[228:231], v[96:99]
    v_mfma_f32_16x16x32_bf16 v[100:103], v[4:7], v[244:247], v[100:103]
    s_waitcnt vmcnt(0)
    v_mfma_f32_16x16x32_bf16 v[116:119], v[16:19], v[128:131], v[66:69]
    v_mfma_f32_16x16x32_bf16 v[120:123], v[16:19], v[144:147], v[66:69]
    buffer_load_dwordx4 v[32:35], v71, s[12:15], s44 offen offset:0

    v_mfma_f32_16x16x32_bf16 v[72:75], v[16:19], v[160:163], v[66:69]
    v_mfma_f32_16x16x32_bf16 v[76:79], v[16:19], v[176:179], v[66:69]
    v_mfma_f32_16x16x32_bf16 v[80:83], v[16:19], v[192:195], v[66:69]
    v_mfma_f32_16x16x32_bf16 v[84:87], v[16:19], v[208:211], v[66:69]
    buffer_load_dwordx4 v[36:39], v71, s[12:15], s44 offen offset:1024

    v_mfma_f32_16x16x32_bf16 v[104:107], v[16:19], v[224:227], v[66:69]
    v_mfma_f32_16x16x32_bf16 v[108:111], v[16:19], v[240:243], v[66:69]
    v_mfma_f32_16x16x32_bf16 v[116:119], v[20:23], v[132:135], v[116:119]
    v_mfma_f32_16x16x32_bf16 v[120:123], v[20:23], v[148:151], v[120:123]
    buffer_load_dwordx4 v[40:43], v71, s[12:15], s45 offen offset:0

    v_mfma_f32_16x16x32_bf16 v[72:75], v[20:23], v[164:167], v[72:75]
    v_mfma_f32_16x16x32_bf16 v[76:79], v[20:23], v[180:183], v[76:79]
    v_mfma_f32_16x16x32_bf16 v[80:83], v[20:23], v[196:199], v[80:83]
    v_mfma_f32_16x16x32_bf16 v[84:87], v[20:23], v[212:215], v[84:87]
    buffer_load_dwordx4 v[44:47], v71, s[12:15], s45 offen offset:1024

    v_mfma_f32_16x16x32_bf16 v[104:107], v[20:23], v[228:231], v[104:107]
    v_mfma_f32_16x16x32_bf16 v[108:111], v[20:23], v[244:247], v[108:111]
    s_waitcnt lgkmcnt(0)
    s_barrier
    ds_read_b128 v[136:139], v65 offset:0
    ds_read_b128 v[140:143], v65 offset:1024
    ds_read_b128 v[152:155], v65 offset:2048
    ds_read_b128 v[156:159], v65 offset:3072
    ds_read_b128 v[168:171], v65 offset:4096
    ds_read_b128 v[172:175], v65 offset:5120
    ds_read_b128 v[184:187], v65 offset:6144
    ds_read_b128 v[188:191], v65 offset:7168
    ds_read_b128 v[200:203], v65 offset:8192
    ds_read_b128 v[204:207], v65 offset:9216
    ds_read_b128 v[216:219], v65 offset:10240
    ds_read_b128 v[220:223], v65 offset:11264
    ds_read_b128 v[232:235], v65 offset:12288
    ds_read_b128 v[236:239], v65 offset:13312
    ds_read_b128 v[248:251], v65 offset:14336
    ds_read_b128 v[252:255], v65 offset:15360

    v_readfirstlane_b32 s26, v66
    s_bfe_u32 s25, s26, 0x10017
    s_lshl1_add_u32 s25, s25, 1
    s_mul_i32 s24, s25, 0xfff30000
    s_mul_i32 s25, s25, 0xfff40000
    s_and_b32 s26, s26, 0x7f800000
    s_add_u32 s24, s24, 0x80008000
    s_add_u32 s25, s25, 0x80008000
    s_sub_u32 s26, s26, 0x7800000
    s_mov_b32 s27, 0x4b000000

    s_waitcnt lgkmcnt(12)
    v_mfma_f32_16x16x32_bf16 v[116:119], v[24:27], v[136:139], v[116:119]
    v_mfma_f32_16x16x32_bf16 v[120:123], v[24:27], v[152:155], v[120:123]
    v_mfma_f32_16x16x32_bf16 v[48:51], v[8:11], v[136:139], v[48:51]
    v_mfma_f32_16x16x32_bf16 v[52:55], v[8:11], v[152:155], v[52:55]
    v_mfma_f32_16x16x32_bf16 v[116:119], v[28:31], v[140:143], v[116:119]
    v_mfma_f32_16x16x32_bf16 v[120:123], v[28:31], v[156:159], v[120:123]
    v_mfma_f32_16x16x32_bf16 v[48:51], v[12:15], v[140:143], v[48:51]
    v_mfma_f32_16x16x32_bf16 v[52:55], v[12:15], v[156:159], v[52:55]
    s_waitcnt lgkmcnt(8)
    v_mfma_f32_16x16x32_bf16 v[72:75], v[24:27], v[168:171], v[72:75]
    v_mfma_f32_16x16x32_bf16 v[76:79], v[24:27], v[184:187], v[76:79]
    v_mfma_f32_16x16x32_bf16 v[56:59], v[8:11], v[168:171], v[56:59]
    v_perm_b32 v116, v117, v116, s23
    v_perm_b32 v117, v119, v118, s23
    v_mfma_f32_16x16x32_bf16 v[60:63], v[8:11], v[184:187], v[60:63]
    ds_write_b64 v64, v[116:117] offset:32768
    v_perm_b32 v120, v121, v120, s23
    v_mfma_f32_16x16x32_bf16 v[72:75], v[28:31], v[172:175], v[72:75]
    v_perm_b32 v121, v123, v122, s23
    ds_write_b64 v64, v[120:121] offset:32896
    v_mfma_f32_16x16x32_bf16 v[76:79], v[28:31], v[188:191], v[76:79]
    v_perm_b32 v48, v49, v48, s23
    v_perm_b32 v49, v51, v50, s23
    v_mfma_f32_16x16x32_bf16 v[56:59], v[12:15], v[172:175], v[56:59]
    ds_write_b64 v64, v[48:49] offset:0
    v_perm_b32 v52, v53, v52, s23
    v_mfma_f32_16x16x32_bf16 v[60:63], v[12:15], v[188:191], v[60:63]
    v_perm_b32 v53, v55, v54, s23
    ds_write_b64 v64, v[52:53] offset:128
    s_waitcnt lgkmcnt(8)
    v_mfma_f32_16x16x32_bf16 v[80:83], v[24:27], v[200:203], v[80:83]
    buffer_load_dwordx2 v[116:117], v71, s[12:15], s20 offen offset:0 sc1

    v_mfma_f32_16x16x32_bf16 v[84:87], v[24:27], v[216:219], v[84:87]
    v_mfma_f32_16x16x32_bf16 v[88:91], v[8:11], v[200:203], v[88:91]
    v_perm_b32 v72, v73, v72, s23
    v_perm_b32 v73, v75, v74, s23
    buffer_load_dwordx2 v[118:119], v71, s[12:15], s20 offen offset:1024 sc1

    v_mfma_f32_16x16x32_bf16 v[92:95], v[8:11], v[216:219], v[92:95]
    ds_write_b64 v64, v[72:73] offset:33024
    v_perm_b32 v76, v77, v76, s23
    v_mfma_f32_16x16x32_bf16 v[80:83], v[28:31], v[204:207], v[80:83]
    v_perm_b32 v77, v79, v78, s23
    ds_write_b64 v64, v[76:77] offset:33152
    buffer_load_dwordx2 v[120:121], v71, s[12:15], s20 offen offset:2048 sc1

    v_mfma_f32_16x16x32_bf16 v[84:87], v[28:31], v[220:223], v[84:87]
    v_perm_b32 v56, v57, v56, s23
    v_perm_b32 v57, v59, v58, s23
    v_mfma_f32_16x16x32_bf16 v[88:91], v[12:15], v[204:207], v[88:91]
    ds_write_b64 v64, v[56:57] offset:256
    v_perm_b32 v60, v61, v60, s23
    buffer_load_dwordx2 v[122:123], v71, s[12:15], s20 offen offset:3072 sc1

    v_mfma_f32_16x16x32_bf16 v[92:95], v[12:15], v[220:223], v[92:95]
    v_perm_b32 v61, v63, v62, s23
    ds_write_b64 v64, v[60:61] offset:384
    s_waitcnt lgkmcnt(8)
    v_mfma_f32_16x16x32_bf16 v[104:107], v[24:27], v[232:235], v[104:107]
    s_add_u32 s20, s20, 4096
    buffer_load_dwordx2 v[124:125], v71, s[12:15], s20 offen offset:0 sc1

    v_mfma_f32_16x16x32_bf16 v[108:111], v[24:27], v[248:251], v[108:111]
    v_mfma_f32_16x16x32_bf16 v[96:99], v[8:11], v[232:235], v[96:99]
    v_perm_b32 v80, v81, v80, s23
    v_perm_b32 v81, v83, v82, s23
    buffer_load_dwordx2 v[126:127], v71, s[12:15], s20 offen offset:1024 sc1

    v_mfma_f32_16x16x32_bf16 v[100:103], v[8:11], v[248:251], v[100:103]
    ds_write_b64 v64, v[80:81] offset:33280
    v_perm_b32 v84, v85, v84, s23
    v_mfma_f32_16x16x32_bf16 v[104:107], v[28:31], v[236:239], v[104:107]
    v_perm_b32 v85, v87, v86, s23
    ds_write_b64 v64, v[84:85] offset:33408
    v_mfma_f32_16x16x32_bf16 v[108:111], v[28:31], v[252:255], v[108:111]
    v_perm_b32 v88, v89, v88, s23
    v_perm_b32 v89, v91, v90, s23
    v_mfma_f32_16x16x32_bf16 v[96:99], v[12:15], v[236:239], v[96:99]
    ds_write_b64 v64, v[88:89] offset:512
    v_perm_b32 v92, v93, v92, s23
    v_mfma_f32_16x16x32_bf16 v[100:103], v[12:15], v[252:255], v[100:103]
    v_perm_b32 v93, v95, v94, s23
    ds_write_b64 v64, v[92:93] offset:640
    s_waitcnt vmcnt(6)
    v_mfma_f32_16x16x32_bf16 v[48:51], v[32:35], v[128:131], v[66:69]
    v_mfma_f32_16x16x32_bf16 v[52:55], v[32:35], v[144:147], v[66:69]
    v_mfma_f32_16x16x32_bf16 v[48:51], v[36:39], v[132:135], v[48:51]
    v_perm_b32 v104, v105, v104, s23
    v_mfma_f32_16x16x32_bf16 v[52:55], v[36:39], v[148:151], v[52:55]
    v_perm_b32 v105, v107, v106, s23
    v_mfma_f32_16x16x32_bf16 v[48:51], v[40:43], v[136:139], v[48:51]
    ds_write_b64 v64, v[104:105] offset:33536
    v_perm_b32 v96, v97, v96, s23
    v_perm_b32 v97, v99, v98, s23
    v_mfma_f32_16x16x32_bf16 v[52:55], v[40:43], v[152:155], v[52:55]
    v_perm_b32 v108, v109, v108, s23
    ds_write_b64 v64, v[96:97] offset:768
    v_perm_b32 v100, v101, v100, s23
    v_mfma_f32_16x16x32_bf16 v[48:51], v[44:47], v[140:143], v[48:51]
    v_perm_b32 v109, v111, v110, s23
    v_perm_b32 v101, v103, v102, s23
    ds_write_b64 v64, v[100:101] offset:896
    v_mfma_f32_16x16x32_bf16 v[52:55], v[44:47], v[156:159], v[52:55]
    ds_write_b64 v64, v[108:109] offset:33664
    v_add_u32 v64, 0x8000, v64
    v_mfma_f32_16x16x32_bf16 v[56:59], v[32:35], v[160:163], v[66:69]

    v_mfma_f32_16x16x32_bf16 v[60:63], v[32:35], v[176:179], v[66:69]
    buffer_load_dwordx4 v[72:75], v71, s[12:15], s21 offen offset:0

    v_mfma_f32_16x16x32_bf16 v[56:59], v[36:39], v[164:167], v[56:59]
    v_perm_b32 v48, v49, v48, s23

    v_mfma_f32_16x16x32_bf16 v[60:63], v[36:39], v[180:183], v[60:63]
    v_perm_b32 v49, v51, v50, s23

    v_mfma_f32_16x16x32_bf16 v[56:59], v[40:43], v[168:171], v[56:59]
    ds_write_b64 v64, v[48:49] offset:32768
    buffer_load_dwordx4 v[76:79], v71, s[12:15], s21 offen offset:1024

    v_mfma_f32_16x16x32_bf16 v[60:63], v[40:43], v[184:187], v[60:63]
    v_perm_b32 v52, v53, v52, s23

    v_mfma_f32_16x16x32_bf16 v[56:59], v[44:47], v[172:175], v[56:59]
    v_perm_b32 v53, v55, v54, s23

    v_mfma_f32_16x16x32_bf16 v[60:63], v[44:47], v[188:191], v[60:63]
    ds_write_b64 v64, v[52:53] offset:32896
    buffer_load_dwordx4 v[80:83], v71, s[12:15], s19 offen offset:0

    v_mfma_f32_16x16x32_bf16 v[88:91], v[32:35], v[192:195], v[66:69]

    v_mfma_f32_16x16x32_bf16 v[92:95], v[32:35], v[208:211], v[66:69]

    v_mfma_f32_16x16x32_bf16 v[88:91], v[36:39], v[196:199], v[88:91]
    v_perm_b32 v56, v57, v56, s23
    buffer_load_dwordx4 v[84:87], v71, s[12:15], s19 offen offset:1024
    s_add_u32 s21, s21, 4096
    s_add_u32 s19, s19, 4096

    v_mfma_f32_16x16x32_bf16 v[92:95], v[36:39], v[212:215], v[92:95]
    v_perm_b32 v57, v59, v58, s23

    v_mfma_f32_16x16x32_bf16 v[88:91], v[40:43], v[200:203], v[88:91]
    ds_write_b64 v64, v[56:57] offset:33024

    v_mfma_f32_16x16x32_bf16 v[92:95], v[40:43], v[216:219], v[92:95]
    v_perm_b32 v60, v61, v60, s23
    s_mov_b32 exec_lo, 0x00ff00ff
    s_mov_b32 exec_hi, 0x00ff00ff
    buffer_store_dword v112, v113, s[12:15], s74 offen sc1
    s_mov_b64 exec, -1
    v_mfma_f32_16x16x32_bf16 v[88:91], v[44:47], v[204:207], v[88:91]
    v_perm_b32 v61, v63, v62, s23

    v_mfma_f32_16x16x32_bf16 v[92:95], v[44:47], v[220:223], v[92:95]
    ds_write_b64 v64, v[60:61] offset:33152

    v_mfma_f32_16x16x32_bf16 v[48:51], v[32:35], v[224:227], v[66:69]

    v_mfma_f32_16x16x32_bf16 v[52:55], v[32:35], v[240:243], v[66:69]

    v_mfma_f32_16x16x32_bf16 v[48:51], v[36:39], v[228:231], v[48:51]
    v_perm_b32 v88, v89, v88, s23

    v_mfma_f32_16x16x32_bf16 v[52:55], v[36:39], v[244:247], v[52:55]
    v_perm_b32 v89, v91, v90, s23

    v_mfma_f32_16x16x32_bf16 v[48:51], v[40:43], v[232:235], v[48:51]
    ds_write_b64 v64, v[88:89] offset:33280

    v_mfma_f32_16x16x32_bf16 v[52:55], v[40:43], v[248:251], v[52:55]
    v_perm_b32 v92, v93, v92, s23

    v_mfma_f32_16x16x32_bf16 v[48:51], v[44:47], v[236:239], v[48:51]
    v_perm_b32 v93, v95, v94, s23

    v_mfma_f32_16x16x32_bf16 v[52:55], v[44:47], v[252:255], v[52:55]
    ds_write_b64 v64, v[92:93] offset:33408

    s_nop 7
    v_perm_b32 v48, v49, v48, s23
    v_perm_b32 v49, v51, v50, s23
    ds_write_b64 v64, v[48:49] offset:33536
    v_perm_b32 v52, v53, v52, s23
    v_perm_b32 v53, v55, v54, s23
    ds_write_b64 v64, v[52:53] offset:33664
    s_waitcnt vmcnt(5)
k1_kernel_k2j:

    v_mov_b32 v65, 0
    s_waitcnt lgkmcnt(0)
    s_barrier
    ds_read_b32 v65, v65 offset:8184

    s_setprio 3
    v_lshlrev_b32_sdwa v88, 3, v116 dst_sel:DWORD dst_unused:UNUSED_PAD src0_sel:DWORD src1_sel:WORD_0
    v_lshlrev_b32_sdwa v90, 3, v116 dst_sel:DWORD dst_unused:UNUSED_PAD src0_sel:DWORD src1_sel:WORD_1
    ds_read_b64 v[88:89], v88
    ds_read_b64 v[90:91], v90
    v_lshlrev_b32_sdwa v92, 3, v117 dst_sel:DWORD dst_unused:UNUSED_PAD src0_sel:DWORD src1_sel:WORD_0
    v_lshlrev_b32_sdwa v94, 3, v117 dst_sel:DWORD dst_unused:UNUSED_PAD src0_sel:DWORD src1_sel:WORD_1
    ds_read_b64 v[92:93], v92
    ds_read_b64 v[94:95], v94
    v_lshlrev_b32_sdwa v96, 3, v118 dst_sel:DWORD dst_unused:UNUSED_PAD src0_sel:DWORD src1_sel:WORD_0
    v_lshlrev_b32_sdwa v98, 3, v118 dst_sel:DWORD dst_unused:UNUSED_PAD src0_sel:DWORD src1_sel:WORD_1
    ds_read_b64 v[96:97], v96
    ds_read_b64 v[98:99], v98
    v_lshlrev_b32_sdwa v100, 3, v119 dst_sel:DWORD dst_unused:UNUSED_PAD src0_sel:DWORD src1_sel:WORD_0
    v_lshlrev_b32_sdwa v102, 3, v119 dst_sel:DWORD dst_unused:UNUSED_PAD src0_sel:DWORD src1_sel:WORD_1
    ds_read_b64 v[100:101], v100
    ds_read_b64 v[102:103], v102
    buffer_load_dwordx2 v[116:117], v71, s[12:15], s20 offen offset:2048 sc1
    buffer_load_dwordx2 v[118:119], v71, s[12:15], s20 offen offset:3072 sc1
    s_waitcnt lgkmcnt(8)
    v_readfirstlane_b32 s44, v65
    s_cmp_lg_u32 s44, 0
    s_cbranch_scc1 k1_kernel_solo1
    v_lshlrev_b32_sdwa v104, 3, v120 dst_sel:DWORD dst_unused:UNUSED_PAD src0_sel:DWORD src1_sel:WORD_0
    v_lshlrev_b32_sdwa v106, 3, v120 dst_sel:DWORD dst_unused:UNUSED_PAD src0_sel:DWORD src1_sel:WORD_1
    ds_read_b64 v[104:105], v104
    ds_read_b64 v[106:107], v106
    v_lshlrev_b32_sdwa v108, 3, v121 dst_sel:DWORD dst_unused:UNUSED_PAD src0_sel:DWORD src1_sel:WORD_0
    v_lshlrev_b32_sdwa v110, 3, v121 dst_sel:DWORD dst_unused:UNUSED_PAD src0_sel:DWORD src1_sel:WORD_1
    ds_read_b64 v[108:109], v108
    ds_read_b64 v[110:111], v110
    s_waitcnt lgkmcnt(8)
    v_add3_u32 v0, s24, v88, v90
    v_add3_u32 v1, s24, v89, v91
    v_add3_u32 v0, v0, v92, v94
    v_add3_u32 v1, v1, v93, v95
    v_lshlrev_b32_sdwa v88, 3, v122 dst_sel:DWORD dst_unused:UNUSED_PAD src0_sel:DWORD src1_sel:WORD_0
    v_lshlrev_b32_sdwa v90, 3, v122 dst_sel:DWORD dst_unused:UNUSED_PAD src0_sel:DWORD src1_sel:WORD_1
    ds_read_b64 v[88:89], v88
    ds_read_b64 v[90:91], v90
    v_lshlrev_b32_sdwa v92, 3, v123 dst_sel:DWORD dst_unused:UNUSED_PAD src0_sel:DWORD src1_sel:WORD_0
    v_lshlrev_b32_sdwa v94, 3, v123 dst_sel:DWORD dst_unused:UNUSED_PAD src0_sel:DWORD src1_sel:WORD_1
    ds_read_b64 v[92:93], v92
    ds_read_b64 v[94:95], v94
    s_add_u32 s20, s20, 0x1000
    buffer_load_dwordx2 v[120:121], v71, s[12:15], s20 offen offset:0 sc1
    buffer_load_dwordx2 v[122:123], v71, s[12:15], s20 offen offset:1024 sc1
    s_waitcnt lgkmcnt(8)
    v_add3_u32 v2, s24, v96, v98
    v_add3_u32 v3, s24, v97, v99
    v_add3_u32 v2, v2, v100, v102
    v_add3_u32 v3, v3, v101, v103
    v_lshlrev_b32_sdwa v96, 3, v124 dst_sel:DWORD dst_unused:UNUSED_PAD src0_sel:DWORD src1_sel:WORD_0
    v_lshlrev_b32_sdwa v98, 3, v124 dst_sel:DWORD dst_unused:UNUSED_PAD src0_sel:DWORD src1_sel:WORD_1
    ds_read_b64 v[96:97], v96
    ds_read_b64 v[98:99], v98
    v_lshlrev_b32_sdwa v100, 3, v125 dst_sel:DWORD dst_unused:UNUSED_PAD src0_sel:DWORD src1_sel:WORD_0
    v_lshlrev_b32_sdwa v102, 3, v125 dst_sel:DWORD dst_unused:UNUSED_PAD src0_sel:DWORD src1_sel:WORD_1
    ds_read_b64 v[100:101], v100
    ds_read_b64 v[102:103], v102
    s_waitcnt lgkmcnt(8)
    v_add3_u32 v4, s24, v104, v106
    v_add3_u32 v5, s24, v105, v107
    v_add3_u32 v4, v4, v108, v110
    v_add3_u32 v5, v5, v109, v111
    v_lshlrev_b32_sdwa v104, 3, v126 dst_sel:DWORD dst_unused:UNUSED_PAD src0_sel:DWORD src1_sel:WORD_0
    v_lshlrev_b32_sdwa v106, 3, v126 dst_sel:DWORD dst_unused:UNUSED_PAD src0_sel:DWORD src1_sel:WORD_1
    ds_read_b64 v[104:105], v104
    ds_read_b64 v[106:107], v106
    v_lshlrev_b32_sdwa v108, 3, v127 dst_sel:DWORD dst_unused:UNUSED_PAD src0_sel:DWORD src1_sel:WORD_0
    v_lshlrev_b32_sdwa v110, 3, v127 dst_sel:DWORD dst_unused:UNUSED_PAD src0_sel:DWORD src1_sel:WORD_1
    ds_read_b64 v[108:109], v108
    ds_read_b64 v[110:111], v110
    buffer_load_dwordx2 v[124:125], v71, s[12:15], s20 offen offset:2048 sc1
    buffer_load_dwordx2 v[126:127], v71, s[12:15], s20 offen offset:3072 sc1
    s_waitcnt lgkmcnt(8)
    v_add3_u32 v6, s24, v88, v90
    v_add3_u32 v7, s24, v89, v91
    v_add3_u32 v6, v6, v92, v94
    v_add3_u32 v7, v7, v93, v95
    s_waitcnt vmcnt(10)
    v_mfma_f32_16x16x32_bf16 v[112:115], v[72:75], v[128:131], v[66:69]
    s_waitcnt vmcnt(4)
    v_lshlrev_b32_sdwa v88, 3, v116 dst_sel:DWORD dst_unused:UNUSED_PAD src0_sel:DWORD src1_sel:WORD_0
    v_lshlrev_b32_sdwa v90, 3, v116 dst_sel:DWORD dst_unused:UNUSED_PAD src0_sel:DWORD src1_sel:WORD_1
    ds_read_b64 v[88:89], v88
    ds_read_b64 v[90:91], v90
    v_mfma_f32_16x16x32_bf16 v[112:115], v[76:79], v[132:135], v[112:115]
    v_add_u32 v70, 0x10000, v70
    v_lshlrev_b32_sdwa v92, 3, v117 dst_sel:DWORD dst_unused:UNUSED_PAD src0_sel:DWORD src1_sel:WORD_0
    v_lshlrev_b32_sdwa v94, 3, v117 dst_sel:DWORD dst_unused:UNUSED_PAD src0_sel:DWORD src1_sel:WORD_1
    ds_read_b64 v[92:93], v92
    ds_read_b64 v[94:95], v94
    s_waitcnt lgkmcnt(8)
    v_add3_u32 v8, s24, v96, v98
    v_add3_u32 v9, s24, v97, v99
    v_add3_u32 v8, v8, v100, v102
    v_add3_u32 v9, v9, v101, v103
    v_mfma_f32_16x16x32_bf16 v[112:115], v[80:83], v[136:139], v[112:115]
    v_lshlrev_b32_sdwa v96, 3, v118 dst_sel:DWORD dst_unused:UNUSED_PAD src0_sel:DWORD src1_sel:WORD_0
    v_lshlrev_b32_sdwa v98, 3, v118 dst_sel:DWORD dst_unused:UNUSED_PAD src0_sel:DWORD src1_sel:WORD_1
    ds_read_b64 v[96:97], v96
    ds_read_b64 v[98:99], v98
    v_mfma_f32_16x16x32_bf16 v[112:115], v[84:87], v[140:143], v[112:115]
    v_lshlrev_b32_sdwa v100, 3, v119 dst_sel:DWORD dst_unused:UNUSED_PAD src0_sel:DWORD src1_sel:WORD_0
    v_lshlrev_b32_sdwa v102, 3, v119 dst_sel:DWORD dst_unused:UNUSED_PAD src0_sel:DWORD src1_sel:WORD_1
    ds_read_b64 v[100:101], v100
    ds_read_b64 v[102:103], v102
    s_add_u32 s20, s20, 0x1000
    buffer_load_dwordx2 v[116:117], v71, s[12:15], s20 offen offset:0 sc1
    buffer_load_dwordx2 v[118:119], v71, s[12:15], s20 offen offset:1024 sc1
    s_waitcnt lgkmcnt(8)
    v_add3_u32 v10, s24, v104, v106
    v_add3_u32 v11, s24, v105, v107
    v_add3_u32 v10, v10, v108, v110
    v_add3_u32 v11, v11, v109, v111
    v_perm_b32 v112, v113, v112, s23
    v_perm_b32 v113, v115, v114, s23
    ds_write_b64 v70, v[112:113] offset:32768
    s_waitcnt vmcnt(4)
    v_lshlrev_b32_sdwa v104, 3, v120 dst_sel:DWORD dst_unused:UNUSED_PAD src0_sel:DWORD src1_sel:WORD_0
    v_lshlrev_b32_sdwa v106, 3, v120 dst_sel:DWORD dst_unused:UNUSED_PAD src0_sel:DWORD src1_sel:WORD_1
    ds_read_b64 v[104:105], v104
    ds_read_b64 v[106:107], v106
    v_lshlrev_b32_sdwa v108, 3, v121 dst_sel:DWORD dst_unused:UNUSED_PAD src0_sel:DWORD src1_sel:WORD_0
    v_lshlrev_b32_sdwa v110, 3, v121 dst_sel:DWORD dst_unused:UNUSED_PAD src0_sel:DWORD src1_sel:WORD_1
    ds_read_b64 v[108:109], v108
    ds_read_b64 v[110:111], v110
    s_waitcnt lgkmcnt(9)
    v_add3_u32 v12, s24, v88, v90
    v_add3_u32 v13, s24, v89, v91
    v_add3_u32 v12, v12, v92, v94
    v_add3_u32 v13, v13, v93, v95
    v_lshlrev_b32_sdwa v88, 3, v122 dst_sel:DWORD dst_unused:UNUSED_PAD src0_sel:DWORD src1_sel:WORD_0
    v_lshlrev_b32_sdwa v90, 3, v122 dst_sel:DWORD dst_unused:UNUSED_PAD src0_sel:DWORD src1_sel:WORD_1
    ds_read_b64 v[88:89], v88
    ds_read_b64 v[90:91], v90
    v_lshlrev_b32_sdwa v92, 3, v123 dst_sel:DWORD dst_unused:UNUSED_PAD src0_sel:DWORD src1_sel:WORD_0
    v_lshlrev_b32_sdwa v94, 3, v123 dst_sel:DWORD dst_unused:UNUSED_PAD src0_sel:DWORD src1_sel:WORD_1
    ds_read_b64 v[92:93], v92
    ds_read_b64 v[94:95], v94
    buffer_load_dwordx2 v[120:121], v71, s[12:15], s20 offen offset:2048 sc1
    buffer_load_dwordx2 v[122:123], v71, s[12:15], s20 offen offset:3072 sc1
    s_waitcnt lgkmcnt(9)
    v_add3_u32 v14, s24, v96, v98
    v_add3_u32 v15, s24, v97, v99
    v_add3_u32 v14, v14, v100, v102
    v_add3_u32 v15, v15, v101, v103
    s_waitcnt vmcnt(4)
    v_lshlrev_b32_sdwa v96, 3, v124 dst_sel:DWORD dst_unused:UNUSED_PAD src0_sel:DWORD src1_sel:WORD_0
    v_lshlrev_b32_sdwa v98, 3, v124 dst_sel:DWORD dst_unused:UNUSED_PAD src0_sel:DWORD src1_sel:WORD_1
    ds_read_b64 v[96:97], v96
    ds_read_b64 v[98:99], v98
    v_lshlrev_b32_sdwa v100, 3, v125 dst_sel:DWORD dst_unused:UNUSED_PAD src0_sel:DWORD src1_sel:WORD_0
    v_lshlrev_b32_sdwa v102, 3, v125 dst_sel:DWORD dst_unused:UNUSED_PAD src0_sel:DWORD src1_sel:WORD_1
    ds_read_b64 v[100:101], v100
    ds_read_b64 v[102:103], v102
    s_waitcnt lgkmcnt(8)
    v_add3_u32 v16, s24, v104, v106
    v_add3_u32 v17, s24, v105, v107
    v_add3_u32 v16, v16, v108, v110
    v_add3_u32 v17, v17, v109, v111
    v_mfma_f32_16x16x32_bf16 v[112:115], v[72:75], v[144:147], v[66:69]
    v_lshlrev_b32_sdwa v104, 3, v126 dst_sel:DWORD dst_unused:UNUSED_PAD src0_sel:DWORD src1_sel:WORD_0
    v_lshlrev_b32_sdwa v106, 3, v126 dst_sel:DWORD dst_unused:UNUSED_PAD src0_sel:DWORD src1_sel:WORD_1
    ds_read_b64 v[104:105], v104
    ds_read_b64 v[106:107], v106
    v_mfma_f32_16x16x32_bf16 v[112:115], v[76:79], v[148:151], v[112:115]
    v_lshlrev_b32_sdwa v108, 3, v127 dst_sel:DWORD dst_unused:UNUSED_PAD src0_sel:DWORD src1_sel:WORD_0
    v_lshlrev_b32_sdwa v110, 3, v127 dst_sel:DWORD dst_unused:UNUSED_PAD src0_sel:DWORD src1_sel:WORD_1
    ds_read_b64 v[108:109], v108
    ds_read_b64 v[110:111], v110
    s_add_u32 s20, s20, 0x1d000
    buffer_load_dwordx4 v[124:127], v71, s[12:15], s20 offen offset:0 sc1
    s_waitcnt lgkmcnt(8)
    v_add3_u32 v18, s24, v88, v90
    v_add3_u32 v19, s24, v89, v91
    v_add3_u32 v18, v18, v92, v94
    v_add3_u32 v19, v19, v93, v95
    v_mfma_f32_16x16x32_bf16 v[112:115], v[80:83], v[152:155], v[112:115]
    s_waitcnt vmcnt(3)
    v_lshlrev_b32_sdwa v88, 3, v116 dst_sel:DWORD dst_unused:UNUSED_PAD src0_sel:DWORD src1_sel:WORD_0
    v_lshlrev_b32_sdwa v90, 3, v116 dst_sel:DWORD dst_unused:UNUSED_PAD src0_sel:DWORD src1_sel:WORD_1
    ds_read_b64 v[88:89], v88
    ds_read_b64 v[90:91], v90
    v_mfma_f32_16x16x32_bf16 v[112:115], v[84:87], v[156:159], v[112:115]
    v_lshlrev_b32_sdwa v92, 3, v117 dst_sel:DWORD dst_unused:UNUSED_PAD src0_sel:DWORD src1_sel:WORD_0
    v_lshlrev_b32_sdwa v94, 3, v117 dst_sel:DWORD dst_unused:UNUSED_PAD src0_sel:DWORD src1_sel:WORD_1
    ds_read_b64 v[92:93], v92
    ds_read_b64 v[94:95], v94
    s_waitcnt lgkmcnt(8)
    v_add3_u32 v20, s24, v96, v98
    v_add3_u32 v21, s24, v97, v99
    v_add3_u32 v20, v20, v100, v102
    v_add3_u32 v21, v21, v101, v103
    v_perm_b32 v112, v113, v112, s23
    v_perm_b32 v113, v115, v114, s23
    ds_write_b64 v70, v[112:113] offset:32896
    v_lshlrev_b32_sdwa v96, 3, v118 dst_sel:DWORD dst_unused:UNUSED_PAD src0_sel:DWORD src1_sel:WORD_0
    v_lshlrev_b32_sdwa v98, 3, v118 dst_sel:DWORD dst_unused:UNUSED_PAD src0_sel:DWORD src1_sel:WORD_1
    ds_read_b64 v[96:97], v96
    ds_read_b64 v[98:99], v98
    v_lshlrev_b32_sdwa v100, 3, v119 dst_sel:DWORD dst_unused:UNUSED_PAD src0_sel:DWORD src1_sel:WORD_0
    v_lshlrev_b32_sdwa v102, 3, v119 dst_sel:DWORD dst_unused:UNUSED_PAD src0_sel:DWORD src1_sel:WORD_1
    ds_read_b64 v[100:101], v100
    ds_read_b64 v[102:103], v102
    buffer_load_dwordx4 v[116:119], v71, s[12:15], s20 offen offset:1024 sc1
    s_waitcnt lgkmcnt(9)
    v_add3_u32 v22, s24, v104, v106
    v_add3_u32 v23, s24, v105, v107
    v_add3_u32 v22, v22, v108, v110
    v_add3_u32 v23, v23, v109, v111
    s_waitcnt vmcnt(2)
    v_lshlrev_b32_sdwa v104, 3, v120 dst_sel:DWORD dst_unused:UNUSED_PAD src0_sel:DWORD src1_sel:WORD_0
    v_lshlrev_b32_sdwa v106, 3, v120 dst_sel:DWORD dst_unused:UNUSED_PAD src0_sel:DWORD src1_sel:WORD_1
    ds_read_b64 v[104:105], v104
    ds_read_b64 v[106:107], v106
    v_lshlrev_b32_sdwa v108, 3, v121 dst_sel:DWORD dst_unused:UNUSED_PAD src0_sel:DWORD src1_sel:WORD_0
    v_lshlrev_b32_sdwa v110, 3, v121 dst_sel:DWORD dst_unused:UNUSED_PAD src0_sel:DWORD src1_sel:WORD_1
    ds_read_b64 v[108:109], v108
    ds_read_b64 v[110:111], v110
    s_waitcnt lgkmcnt(9)
    v_add3_u32 v24, s24, v88, v90
    v_add3_u32 v25, s24, v89, v91
    v_add3_u32 v24, v24, v92, v94
    v_add3_u32 v25, v25, v93, v95
    v_lshlrev_b32_sdwa v88, 3, v122 dst_sel:DWORD dst_unused:UNUSED_PAD src0_sel:DWORD src1_sel:WORD_0
    v_lshlrev_b32_sdwa v90, 3, v122 dst_sel:DWORD dst_unused:UNUSED_PAD src0_sel:DWORD src1_sel:WORD_1
    ds_read_b64 v[88:89], v88
    ds_read_b64 v[90:91], v90
    v_lshlrev_b32_sdwa v92, 3, v123 dst_sel:DWORD dst_unused:UNUSED_PAD src0_sel:DWORD src1_sel:WORD_0
    v_lshlrev_b32_sdwa v94, 3, v123 dst_sel:DWORD dst_unused:UNUSED_PAD src0_sel:DWORD src1_sel:WORD_1
    ds_read_b64 v[92:93], v92
    ds_read_b64 v[94:95], v94
    buffer_load_dwordx4 v[120:123], v71, s[12:15], s20 offen offset:2048 sc1
    s_waitcnt lgkmcnt(8)
    v_add3_u32 v26, s24, v96, v98
    v_add3_u32 v27, s24, v97, v99
    v_add3_u32 v26, v26, v100, v102
    v_add3_u32 v27, v27, v101, v103
    v_mfma_f32_16x16x32_bf16 v[112:115], v[72:75], v[160:163], v[66:69]
    s_waitcnt vmcnt(2)
    v_lshlrev_b32_sdwa v96, 3, v124 dst_sel:DWORD dst_unused:UNUSED_PAD src0_sel:DWORD src1_sel:WORD_0
    v_lshlrev_b32_sdwa v98, 3, v124 dst_sel:DWORD dst_unused:UNUSED_PAD src0_sel:DWORD src1_sel:WORD_1
    ds_read_b64 v[96:97], v96
    ds_read_b64 v[98:99], v98
    v_mfma_f32_16x16x32_bf16 v[112:115], v[76:79], v[164:167], v[112:115]
    v_lshlrev_b32_sdwa v100, 3, v125 dst_sel:DWORD dst_unused:UNUSED_PAD src0_sel:DWORD src1_sel:WORD_0
    v_lshlrev_b32_sdwa v102, 3, v125 dst_sel:DWORD dst_unused:UNUSED_PAD src0_sel:DWORD src1_sel:WORD_1
    ds_read_b64 v[100:101], v100
    ds_read_b64 v[102:103], v102
    s_waitcnt lgkmcnt(8)
    v_add3_u32 v28, s24, v104, v106
    v_add3_u32 v29, s24, v105, v107
    v_add3_u32 v28, v28, v108, v110
    v_add3_u32 v29, v29, v109, v111
    v_mfma_f32_16x16x32_bf16 v[112:115], v[80:83], v[168:171], v[112:115]
    v_lshlrev_b32_sdwa v104, 3, v126 dst_sel:DWORD dst_unused:UNUSED_PAD src0_sel:DWORD src1_sel:WORD_0
    v_lshlrev_b32_sdwa v106, 3, v126 dst_sel:DWORD dst_unused:UNUSED_PAD src0_sel:DWORD src1_sel:WORD_1
    ds_read_b64 v[104:105], v104
    ds_read_b64 v[106:107], v106
    v_mfma_f32_16x16x32_bf16 v[112:115], v[84:87], v[172:175], v[112:115]
    v_lshlrev_b32_sdwa v108, 3, v127 dst_sel:DWORD dst_unused:UNUSED_PAD src0_sel:DWORD src1_sel:WORD_0
    v_lshlrev_b32_sdwa v110, 3, v127 dst_sel:DWORD dst_unused:UNUSED_PAD src0_sel:DWORD src1_sel:WORD_1
    ds_read_b64 v[108:109], v108
    ds_read_b64 v[110:111], v110
    buffer_load_dwordx4 v[124:127], v71, s[12:15], s20 offen offset:3072 sc1
    s_waitcnt lgkmcnt(8)
    v_add3_u32 v30, s24, v88, v90
    v_add3_u32 v31, s24, v89, v91
    v_add3_u32 v30, v30, v92, v94
    v_add3_u32 v31, v31, v93, v95
    v_perm_b32 v112, v113, v112, s23
    v_perm_b32 v113, v115, v114, s23
    ds_write_b64 v70, v[112:113] offset:33024
    s_waitcnt vmcnt(2)
    v_lshlrev_b32_sdwa v88, 3, v116 dst_sel:DWORD dst_unused:UNUSED_PAD src0_sel:DWORD src1_sel:WORD_0
    v_lshlrev_b32_sdwa v90, 3, v116 dst_sel:DWORD dst_unused:UNUSED_PAD src0_sel:DWORD src1_sel:WORD_1
    ds_read_b64 v[88:89], v88
    ds_read_b64 v[90:91], v90
    v_lshlrev_b32_sdwa v92, 3, v117 dst_sel:DWORD dst_unused:UNUSED_PAD src0_sel:DWORD src1_sel:WORD_0
    v_lshlrev_b32_sdwa v94, 3, v117 dst_sel:DWORD dst_unused:UNUSED_PAD src0_sel:DWORD src1_sel:WORD_1
    ds_read_b64 v[92:93], v92
    ds_read_b64 v[94:95], v94
    s_waitcnt lgkmcnt(9)
    v_add3_u32 v32, s25, v96, v98
    v_add3_u32 v33, s25, v97, v99
    v_add3_u32 v32, v32, v100, v102
    v_add3_u32 v33, v33, v101, v103
    v_lshlrev_b32_sdwa v96, 3, v118 dst_sel:DWORD dst_unused:UNUSED_PAD src0_sel:DWORD src1_sel:WORD_0
    v_lshlrev_b32_sdwa v98, 3, v118 dst_sel:DWORD dst_unused:UNUSED_PAD src0_sel:DWORD src1_sel:WORD_1
    ds_read_b64 v[96:97], v96
    ds_read_b64 v[98:99], v98
    v_lshlrev_b32_sdwa v100, 3, v119 dst_sel:DWORD dst_unused:UNUSED_PAD src0_sel:DWORD src1_sel:WORD_0
    v_lshlrev_b32_sdwa v102, 3, v119 dst_sel:DWORD dst_unused:UNUSED_PAD src0_sel:DWORD src1_sel:WORD_1
    ds_read_b64 v[100:101], v100
    ds_read_b64 v[102:103], v102
    s_add_u32 s20, s20, 0x1000
    buffer_load_dwordx4 v[116:119], v71, s[12:15], s20 offen offset:0 sc1
    s_waitcnt lgkmcnt(9)
    v_add3_u32 v32, v32, v104, v106
    v_add3_u32 v33, v33, v105, v107
    v_add3_u32 v32, v32, v108, v110
    v_add3_u32 v33, v33, v109, v111
    s_waitcnt vmcnt(2)
    v_lshlrev_b32_sdwa v104, 3, v120 dst_sel:DWORD dst_unused:UNUSED_PAD src0_sel:DWORD src1_sel:WORD_0
    v_lshlrev_b32_sdwa v106, 3, v120 dst_sel:DWORD dst_unused:UNUSED_PAD src0_sel:DWORD src1_sel:WORD_1
    ds_read_b64 v[104:105], v104
    ds_read_b64 v[106:107], v106
    v_lshlrev_b32_sdwa v108, 3, v121 dst_sel:DWORD dst_unused:UNUSED_PAD src0_sel:DWORD src1_sel:WORD_0
    v_lshlrev_b32_sdwa v110, 3, v121 dst_sel:DWORD dst_unused:UNUSED_PAD src0_sel:DWORD src1_sel:WORD_1
    ds_read_b64 v[108:109], v108
    ds_read_b64 v[110:111], v110
    s_waitcnt lgkmcnt(8)
    v_add3_u32 v34, s25, v88, v90
    v_add3_u32 v35, s25, v89, v91
    v_add3_u32 v34, v34, v92, v94
    v_add3_u32 v35, v35, v93, v95
    v_mfma_f32_16x16x32_bf16 v[112:115], v[72:75], v[176:179], v[66:69]
    v_lshlrev_b32_sdwa v88, 3, v122 dst_sel:DWORD dst_unused:UNUSED_PAD src0_sel:DWORD src1_sel:WORD_0
    v_lshlrev_b32_sdwa v90, 3, v122 dst_sel:DWORD dst_unused:UNUSED_PAD src0_sel:DWORD src1_sel:WORD_1
    ds_read_b64 v[88:89], v88
    ds_read_b64 v[90:91], v90
    v_mfma_f32_16x16x32_bf16 v[112:115], v[76:79], v[180:183], v[112:115]
    v_lshlrev_b32_sdwa v92, 3, v123 dst_sel:DWORD dst_unused:UNUSED_PAD src0_sel:DWORD src1_sel:WORD_0
    v_lshlrev_b32_sdwa v94, 3, v123 dst_sel:DWORD dst_unused:UNUSED_PAD src0_sel:DWORD src1_sel:WORD_1
    ds_read_b64 v[92:93], v92
    ds_read_b64 v[94:95], v94
    buffer_load_dwordx4 v[120:123], v71, s[12:15], s20 offen offset:1024 sc1
    s_waitcnt lgkmcnt(8)
    v_add3_u32 v34, v34, v96, v98
    v_add3_u32 v35, v35, v97, v99
    v_add3_u32 v34, v34, v100, v102
    v_add3_u32 v35, v35, v101, v103
    v_mfma_f32_16x16x32_bf16 v[112:115], v[80:83], v[184:187], v[112:115]
    s_waitcnt vmcnt(2)
    v_lshlrev_b32_sdwa v96, 3, v124 dst_sel:DWORD dst_unused:UNUSED_PAD src0_sel:DWORD src1_sel:WORD_0
    v_lshlrev_b32_sdwa v98, 3, v124 dst_sel:DWORD dst_unused:UNUSED_PAD src0_sel:DWORD src1_sel:WORD_1
    ds_read_b64 v[96:97], v96
    ds_read_b64 v[98:99], v98
    v_mfma_f32_16x16x32_bf16 v[112:115], v[84:87], v[188:191], v[112:115]
    v_lshlrev_b32_sdwa v100, 3, v125 dst_sel:DWORD dst_unused:UNUSED_PAD src0_sel:DWORD src1_sel:WORD_0
    v_lshlrev_b32_sdwa v102, 3, v125 dst_sel:DWORD dst_unused:UNUSED_PAD src0_sel:DWORD src1_sel:WORD_1
    ds_read_b64 v[100:101], v100
    ds_read_b64 v[102:103], v102
    s_waitcnt lgkmcnt(8)
    v_add3_u32 v36, s25, v104, v106
    v_add3_u32 v37, s25, v105, v107
    v_add3_u32 v36, v36, v108, v110
    v_add3_u32 v37, v37, v109, v111
    v_perm_b32 v112, v113, v112, s23
    v_perm_b32 v113, v115, v114, s23
    ds_write_b64 v70, v[112:113] offset:33152
    v_lshlrev_b32_sdwa v104, 3, v126 dst_sel:DWORD dst_unused:UNUSED_PAD src0_sel:DWORD src1_sel:WORD_0
    v_lshlrev_b32_sdwa v106, 3, v126 dst_sel:DWORD dst_unused:UNUSED_PAD src0_sel:DWORD src1_sel:WORD_1
    ds_read_b64 v[104:105], v104
    ds_read_b64 v[106:107], v106
    v_lshlrev_b32_sdwa v108, 3, v127 dst_sel:DWORD dst_unused:UNUSED_PAD src0_sel:DWORD src1_sel:WORD_0
    v_lshlrev_b32_sdwa v110, 3, v127 dst_sel:DWORD dst_unused:UNUSED_PAD src0_sel:DWORD src1_sel:WORD_1
    ds_read_b64 v[108:109], v108
    ds_read_b64 v[110:111], v110
    buffer_load_dwordx4 v[124:127], v71, s[12:15], s20 offen offset:2048 sc1
    s_waitcnt lgkmcnt(9)
    v_add3_u32 v36, v36, v88, v90
    v_add3_u32 v37, v37, v89, v91
    v_add3_u32 v36, v36, v92, v94
    v_add3_u32 v37, v37, v93, v95
    s_waitcnt vmcnt(2)
    v_lshlrev_b32_sdwa v88, 3, v116 dst_sel:DWORD dst_unused:UNUSED_PAD src0_sel:DWORD src1_sel:WORD_0
    v_lshlrev_b32_sdwa v90, 3, v116 dst_sel:DWORD dst_unused:UNUSED_PAD src0_sel:DWORD src1_sel:WORD_1
    ds_read_b64 v[88:89], v88
    ds_read_b64 v[90:91], v90
    v_lshlrev_b32_sdwa v92, 3, v117 dst_sel:DWORD dst_unused:UNUSED_PAD src0_sel:DWORD src1_sel:WORD_0
    v_lshlrev_b32_sdwa v94, 3, v117 dst_sel:DWORD dst_unused:UNUSED_PAD src0_sel:DWORD src1_sel:WORD_1
    ds_read_b64 v[92:93], v92
    ds_read_b64 v[94:95], v94
    s_waitcnt lgkmcnt(9)
    v_add3_u32 v38, s25, v96, v98
    v_add3_u32 v39, s25, v97, v99
    v_add3_u32 v38, v38, v100, v102
    v_add3_u32 v39, v39, v101, v103
    v_lshlrev_b32_sdwa v96, 3, v118 dst_sel:DWORD dst_unused:UNUSED_PAD src0_sel:DWORD src1_sel:WORD_0
    v_lshlrev_b32_sdwa v98, 3, v118 dst_sel:DWORD dst_unused:UNUSED_PAD src0_sel:DWORD src1_sel:WORD_1
    ds_read_b64 v[96:97], v96
    ds_read_b64 v[98:99], v98
    v_lshlrev_b32_sdwa v100, 3, v119 dst_sel:DWORD dst_unused:UNUSED_PAD src0_sel:DWORD src1_sel:WORD_0
    v_lshlrev_b32_sdwa v102, 3, v119 dst_sel:DWORD dst_unused:UNUSED_PAD src0_sel:DWORD src1_sel:WORD_1
    ds_read_b64 v[100:101], v100
    ds_read_b64 v[102:103], v102
    buffer_load_dwordx4 v[116:119], v71, s[12:15], s20 offen offset:3072 sc1
    s_waitcnt lgkmcnt(8)
    v_add3_u32 v38, v38, v104, v106
    v_add3_u32 v39, v39, v105, v107
    v_add3_u32 v38, v38, v108, v110
    v_add3_u32 v39, v39, v109, v111
    v_mfma_f32_16x16x32_bf16 v[112:115], v[72:75], v[192:195], v[66:69]
    s_waitcnt vmcnt(2)
    v_lshlrev_b32_sdwa v104, 3, v120 dst_sel:DWORD dst_unused:UNUSED_PAD src0_sel:DWORD src1_sel:WORD_0
    v_lshlrev_b32_sdwa v106, 3, v120 dst_sel:DWORD dst_unused:UNUSED_PAD src0_sel:DWORD src1_sel:WORD_1
    ds_read_b64 v[104:105], v104
    ds_read_b64 v[106:107], v106
    v_mfma_f32_16x16x32_bf16 v[112:115], v[76:79], v[196:199], v[112:115]
    v_lshlrev_b32_sdwa v108, 3, v121 dst_sel:DWORD dst_unused:UNUSED_PAD src0_sel:DWORD src1_sel:WORD_0
    v_lshlrev_b32_sdwa v110, 3, v121 dst_sel:DWORD dst_unused:UNUSED_PAD src0_sel:DWORD src1_sel:WORD_1
    ds_read_b64 v[108:109], v108
    ds_read_b64 v[110:111], v110
    s_waitcnt lgkmcnt(8)
    v_add3_u32 v40, s25, v88, v90
    v_add3_u32 v41, s25, v89, v91
    v_add3_u32 v40, v40, v92, v94
    v_add3_u32 v41, v41, v93, v95
    v_mfma_f32_16x16x32_bf16 v[112:115], v[80:83], v[200:203], v[112:115]
    v_lshlrev_b32_sdwa v88, 3, v122 dst_sel:DWORD dst_unused:UNUSED_PAD src0_sel:DWORD src1_sel:WORD_0
    v_lshlrev_b32_sdwa v90, 3, v122 dst_sel:DWORD dst_unused:UNUSED_PAD src0_sel:DWORD src1_sel:WORD_1
    ds_read_b64 v[88:89], v88
    ds_read_b64 v[90:91], v90
    v_mfma_f32_16x16x32_bf16 v[112:115], v[84:87], v[204:207], v[112:115]
    v_lshlrev_b32_sdwa v92, 3, v123 dst_sel:DWORD dst_unused:UNUSED_PAD src0_sel:DWORD src1_sel:WORD_0
    v_lshlrev_b32_sdwa v94, 3, v123 dst_sel:DWORD dst_unused:UNUSED_PAD src0_sel:DWORD src1_sel:WORD_1
    ds_read_b64 v[92:93], v92
    ds_read_b64 v[94:95], v94
    s_add_u32 s20, s20, 0x1000
    buffer_load_dwordx4 v[120:123], v71, s[12:15], s20 offen offset:0 sc1
    s_waitcnt lgkmcnt(8)
    v_add3_u32 v40, v40, v96, v98
    v_add3_u32 v41, v41, v97, v99
    v_add3_u32 v40, v40, v100, v102
    v_add3_u32 v41, v41, v101, v103
    v_perm_b32 v112, v113, v112, s23
    v_perm_b32 v113, v115, v114, s23
    ds_write_b64 v70, v[112:113] offset:33280
    s_waitcnt vmcnt(2)
    v_lshlrev_b32_sdwa v96, 3, v124 dst_sel:DWORD dst_unused:UNUSED_PAD src0_sel:DWORD src1_sel:WORD_0
    v_lshlrev_b32_sdwa v98, 3, v124 dst_sel:DWORD dst_unused:UNUSED_PAD src0_sel:DWORD src1_sel:WORD_1
    ds_read_b64 v[96:97], v96
    ds_read_b64 v[98:99], v98
    v_lshlrev_b32_sdwa v100, 3, v125 dst_sel:DWORD dst_unused:UNUSED_PAD src0_sel:DWORD src1_sel:WORD_0
    v_lshlrev_b32_sdwa v102, 3, v125 dst_sel:DWORD dst_unused:UNUSED_PAD src0_sel:DWORD src1_sel:WORD_1
    ds_read_b64 v[100:101], v100
    ds_read_b64 v[102:103], v102
    s_waitcnt lgkmcnt(9)
    v_add3_u32 v42, s25, v104, v106
    v_add3_u32 v43, s25, v105, v107
    v_add3_u32 v42, v42, v108, v110
    v_add3_u32 v43, v43, v109, v111
    v_lshlrev_b32_sdwa v104, 3, v126 dst_sel:DWORD dst_unused:UNUSED_PAD src0_sel:DWORD src1_sel:WORD_0
    v_lshlrev_b32_sdwa v106, 3, v126 dst_sel:DWORD dst_unused:UNUSED_PAD src0_sel:DWORD src1_sel:WORD_1
    ds_read_b64 v[104:105], v104
    ds_read_b64 v[106:107], v106
    v_lshlrev_b32_sdwa v108, 3, v127 dst_sel:DWORD dst_unused:UNUSED_PAD src0_sel:DWORD src1_sel:WORD_0
    v_lshlrev_b32_sdwa v110, 3, v127 dst_sel:DWORD dst_unused:UNUSED_PAD src0_sel:DWORD src1_sel:WORD_1
    ds_read_b64 v[108:109], v108
    ds_read_b64 v[110:111], v110
    buffer_load_dwordx4 v[124:127], v71, s[12:15], s20 offen offset:1024 sc1
    s_waitcnt lgkmcnt(9)
    v_add3_u32 v42, v42, v88, v90
    v_add3_u32 v43, v43, v89, v91
    v_add3_u32 v42, v42, v92, v94
    v_add3_u32 v43, v43, v93, v95
    s_waitcnt vmcnt(2)
    v_lshlrev_b32_sdwa v88, 3, v116 dst_sel:DWORD dst_unused:UNUSED_PAD src0_sel:DWORD src1_sel:WORD_0
    v_lshlrev_b32_sdwa v90, 3, v116 dst_sel:DWORD dst_unused:UNUSED_PAD src0_sel:DWORD src1_sel:WORD_1
    ds_read_b64 v[88:89], v88
    ds_read_b64 v[90:91], v90
    v_lshlrev_b32_sdwa v92, 3, v117 dst_sel:DWORD dst_unused:UNUSED_PAD src0_sel:DWORD src1_sel:WORD_0
    v_lshlrev_b32_sdwa v94, 3, v117 dst_sel:DWORD dst_unused:UNUSED_PAD src0_sel:DWORD src1_sel:WORD_1
    ds_read_b64 v[92:93], v92
    ds_read_b64 v[94:95], v94
    s_waitcnt lgkmcnt(8)
    v_add3_u32 v44, s25, v96, v98
    v_add3_u32 v45, s25, v97, v99
    v_add3_u32 v44, v44, v100, v102
    v_add3_u32 v45, v45, v101, v103
    v_mfma_f32_16x16x32_bf16 v[112:115], v[72:75], v[208:211], v[66:69]
    v_lshlrev_b32_sdwa v96, 3, v118 dst_sel:DWORD dst_unused:UNUSED_PAD src0_sel:DWORD src1_sel:WORD_0
    v_lshlrev_b32_sdwa v98, 3, v118 dst_sel:DWORD dst_unused:UNUSED_PAD src0_sel:DWORD src1_sel:WORD_1
    ds_read_b64 v[96:97], v96
    ds_read_b64 v[98:99], v98
    v_mfma_f32_16x16x32_bf16 v[112:115], v[76:79], v[212:215], v[112:115]
    v_lshlrev_b32_sdwa v100, 3, v119 dst_sel:DWORD dst_unused:UNUSED_PAD src0_sel:DWORD src1_sel:WORD_0
    v_lshlrev_b32_sdwa v102, 3, v119 dst_sel:DWORD dst_unused:UNUSED_PAD src0_sel:DWORD src1_sel:WORD_1
    ds_read_b64 v[100:101], v100
    ds_read_b64 v[102:103], v102
    buffer_load_dwordx4 v[116:119], v71, s[12:15], s20 offen offset:2048 sc1
    s_waitcnt lgkmcnt(8)
    v_add3_u32 v44, v44, v104, v106
    v_add3_u32 v45, v45, v105, v107
    v_add3_u32 v44, v44, v108, v110
    v_add3_u32 v45, v45, v109, v111
    v_mfma_f32_16x16x32_bf16 v[112:115], v[80:83], v[216:219], v[112:115]
    s_waitcnt vmcnt(2)
    v_lshlrev_b32_sdwa v104, 3, v120 dst_sel:DWORD dst_unused:UNUSED_PAD src0_sel:DWORD src1_sel:WORD_0
    v_lshlrev_b32_sdwa v106, 3, v120 dst_sel:DWORD dst_unused:UNUSED_PAD src0_sel:DWORD src1_sel:WORD_1
    ds_read_b64 v[104:105], v104
    ds_read_b64 v[106:107], v106
    v_mfma_f32_16x16x32_bf16 v[112:115], v[84:87], v[220:223], v[112:115]
    v_lshlrev_b32_sdwa v108, 3, v121 dst_sel:DWORD dst_unused:UNUSED_PAD src0_sel:DWORD src1_sel:WORD_0
    v_lshlrev_b32_sdwa v110, 3, v121 dst_sel:DWORD dst_unused:UNUSED_PAD src0_sel:DWORD src1_sel:WORD_1
    ds_read_b64 v[108:109], v108
    ds_read_b64 v[110:111], v110
    s_waitcnt lgkmcnt(8)
    v_add3_u32 v46, s25, v88, v90
    v_add3_u32 v47, s25, v89, v91
    v_add3_u32 v46, v46, v92, v94
    v_add3_u32 v47, v47, v93, v95
    v_perm_b32 v112, v113, v112, s23
    v_perm_b32 v113, v115, v114, s23
    ds_write_b64 v70, v[112:113] offset:33408
    s_setprio 2
    v_lshlrev_b32_sdwa v88, 3, v122 dst_sel:DWORD dst_unused:UNUSED_PAD src0_sel:DWORD src1_sel:WORD_0
    v_lshlrev_b32_sdwa v90, 3, v122 dst_sel:DWORD dst_unused:UNUSED_PAD src0_sel:DWORD src1_sel:WORD_1
    ds_read_b64 v[88:89], v88
    ds_read_b64 v[90:91], v90
    v_lshlrev_b32_sdwa v92, 3, v123 dst_sel:DWORD dst_unused:UNUSED_PAD src0_sel:DWORD src1_sel:WORD_0
    v_lshlrev_b32_sdwa v94, 3, v123 dst_sel:DWORD dst_unused:UNUSED_PAD src0_sel:DWORD src1_sel:WORD_1
    ds_read_b64 v[92:93], v92
    ds_read_b64 v[94:95], v94
    buffer_load_dwordx4 v[120:123], v71, s[12:15], s20 offen offset:3072 sc1
    s_waitcnt lgkmcnt(9)
    v_add3_u32 v46, v46, v96, v98
    v_add3_u32 v47, v47, v97, v99
    v_add3_u32 v46, v46, v100, v102
    v_add3_u32 v47, v47, v101, v103
    s_waitcnt vmcnt(2)
    v_lshlrev_b32_sdwa v96, 3, v124 dst_sel:DWORD dst_unused:UNUSED_PAD src0_sel:DWORD src1_sel:WORD_0
    v_lshlrev_b32_sdwa v98, 3, v124 dst_sel:DWORD dst_unused:UNUSED_PAD src0_sel:DWORD src1_sel:WORD_1
    ds_read_b64 v[96:97], v96
    ds_read_b64 v[98:99], v98
    v_lshlrev_b32_sdwa v100, 3, v125 dst_sel:DWORD dst_unused:UNUSED_PAD src0_sel:DWORD src1_sel:WORD_0
    v_lshlrev_b32_sdwa v102, 3, v125 dst_sel:DWORD dst_unused:UNUSED_PAD src0_sel:DWORD src1_sel:WORD_1
    ds_read_b64 v[100:101], v100
    ds_read_b64 v[102:103], v102
    s_waitcnt lgkmcnt(9)
    v_add3_u32 v48, s25, v104, v106
    v_add3_u32 v49, s25, v105, v107
    v_add3_u32 v48, v48, v108, v110
    v_add3_u32 v49, v49, v109, v111
    v_lshlrev_b32_sdwa v104, 3, v126 dst_sel:DWORD dst_unused:UNUSED_PAD src0_sel:DWORD src1_sel:WORD_0
    v_lshlrev_b32_sdwa v106, 3, v126 dst_sel:DWORD dst_unused:UNUSED_PAD src0_sel:DWORD src1_sel:WORD_1
    ds_read_b64 v[104:105], v104
    ds_read_b64 v[106:107], v106
    v_lshlrev_b32_sdwa v108, 3, v127 dst_sel:DWORD dst_unused:UNUSED_PAD src0_sel:DWORD src1_sel:WORD_0
    v_lshlrev_b32_sdwa v110, 3, v127 dst_sel:DWORD dst_unused:UNUSED_PAD src0_sel:DWORD src1_sel:WORD_1
    ds_read_b64 v[108:109], v108
    ds_read_b64 v[110:111], v110
    s_add_u32 s20, s20, 0x1000
    buffer_load_dwordx4 v[124:127], v71, s[12:15], s20 offen offset:0 sc1
    s_waitcnt lgkmcnt(8)
    v_add3_u32 v48, v48, v88, v90
    v_add3_u32 v49, v49, v89, v91
    v_add3_u32 v48, v48, v92, v94
    v_add3_u32 v49, v49, v93, v95
    v_mfma_f32_16x16x32_bf16 v[112:115], v[72:75], v[224:227], v[66:69]
    s_waitcnt vmcnt(2)
    v_lshlrev_b32_sdwa v88, 3, v116 dst_sel:DWORD dst_unused:UNUSED_PAD src0_sel:DWORD src1_sel:WORD_0
    v_lshlrev_b32_sdwa v90, 3, v116 dst_sel:DWORD dst_unused:UNUSED_PAD src0_sel:DWORD src1_sel:WORD_1
    ds_read_b64 v[88:89], v88
    ds_read_b64 v[90:91], v90
    v_mfma_f32_16x16x32_bf16 v[112:115], v[76:79], v[228:231], v[112:115]
    v_lshlrev_b32_sdwa v92, 3, v117 dst_sel:DWORD dst_unused:UNUSED_PAD src0_sel:DWORD src1_sel:WORD_0
    v_lshlrev_b32_sdwa v94, 3, v117 dst_sel:DWORD dst_unused:UNUSED_PAD src0_sel:DWORD src1_sel:WORD_1
    ds_read_b64 v[92:93], v92
    ds_read_b64 v[94:95], v94
    s_waitcnt lgkmcnt(8)
    v_add3_u32 v50, s25, v96, v98
    v_add3_u32 v51, s25, v97, v99
    v_add3_u32 v50, v50, v100, v102
    v_add3_u32 v51, v51, v101, v103
    v_mfma_f32_16x16x32_bf16 v[112:115], v[80:83], v[232:235], v[112:115]
    v_lshlrev_b32_sdwa v96, 3, v118 dst_sel:DWORD dst_unused:UNUSED_PAD src0_sel:DWORD src1_sel:WORD_0
    v_lshlrev_b32_sdwa v98, 3, v118 dst_sel:DWORD dst_unused:UNUSED_PAD src0_sel:DWORD src1_sel:WORD_1
    ds_read_b64 v[96:97], v96
    ds_read_b64 v[98:99], v98
    v_mfma_f32_16x16x32_bf16 v[112:115], v[84:87], v[236:239], v[112:115]
    v_lshlrev_b32_sdwa v100, 3, v119 dst_sel:DWORD dst_unused:UNUSED_PAD src0_sel:DWORD src1_sel:WORD_0
    v_lshlrev_b32_sdwa v102, 3, v119 dst_sel:DWORD dst_unused:UNUSED_PAD src0_sel:DWORD src1_sel:WORD_1
    ds_read_b64 v[100:101], v100
    ds_read_b64 v[102:103], v102
    buffer_load_dwordx4 v[116:119], v71, s[12:15], s20 offen offset:1024 sc1
    s_waitcnt lgkmcnt(8)
    v_add3_u32 v50, v50, v104, v106
    v_add3_u32 v51, v51, v105, v107
    v_add3_u32 v50, v50, v108, v110
    v_add3_u32 v51, v51, v109, v111
    v_perm_b32 v112, v113, v112, s23
    v_perm_b32 v113, v115, v114, s23
    ds_write_b64 v70, v[112:113] offset:33536
    s_waitcnt vmcnt(2)
    v_lshlrev_b32_sdwa v104, 3, v120 dst_sel:DWORD dst_unused:UNUSED_PAD src0_sel:DWORD src1_sel:WORD_0
    v_lshlrev_b32_sdwa v106, 3, v120 dst_sel:DWORD dst_unused:UNUSED_PAD src0_sel:DWORD src1_sel:WORD_1
    ds_read_b64 v[104:105], v104
    ds_read_b64 v[106:107], v106
    v_lshlrev_b32_sdwa v108, 3, v121 dst_sel:DWORD dst_unused:UNUSED_PAD src0_sel:DWORD src1_sel:WORD_0
    v_lshlrev_b32_sdwa v110, 3, v121 dst_sel:DWORD dst_unused:UNUSED_PAD src0_sel:DWORD src1_sel:WORD_1
    ds_read_b64 v[108:109], v108
    ds_read_b64 v[110:111], v110
    s_waitcnt lgkmcnt(9)
    v_add3_u32 v52, s25, v88, v90
    v_add3_u32 v53, s25, v89, v91
    v_add3_u32 v52, v52, v92, v94
    v_add3_u32 v53, v53, v93, v95
    v_lshlrev_b32_sdwa v88, 3, v122 dst_sel:DWORD dst_unused:UNUSED_PAD src0_sel:DWORD src1_sel:WORD_0
    v_lshlrev_b32_sdwa v90, 3, v122 dst_sel:DWORD dst_unused:UNUSED_PAD src0_sel:DWORD src1_sel:WORD_1
    ds_read_b64 v[88:89], v88
    ds_read_b64 v[90:91], v90
    v_lshlrev_b32_sdwa v92, 3, v123 dst_sel:DWORD dst_unused:UNUSED_PAD src0_sel:DWORD src1_sel:WORD_0
    v_lshlrev_b32_sdwa v94, 3, v123 dst_sel:DWORD dst_unused:UNUSED_PAD src0_sel:DWORD src1_sel:WORD_1
    ds_read_b64 v[92:93], v92
    ds_read_b64 v[94:95], v94
    buffer_load_dwordx4 v[120:123], v71, s[12:15], s20 offen offset:2048 sc1
    s_waitcnt lgkmcnt(9)
    v_add3_u32 v52, v52, v96, v98
    v_add3_u32 v53, v53, v97, v99
    v_add3_u32 v52, v52, v100, v102
    v_add3_u32 v53, v53, v101, v103
    s_waitcnt vmcnt(2)
    v_lshlrev_b32_sdwa v96, 3, v124 dst_sel:DWORD dst_unused:UNUSED_PAD src0_sel:DWORD src1_sel:WORD_0
    v_lshlrev_b32_sdwa v98, 3, v124 dst_sel:DWORD dst_unused:UNUSED_PAD src0_sel:DWORD src1_sel:WORD_1
    ds_read_b64 v[96:97], v96
    ds_read_b64 v[98:99], v98
    v_lshlrev_b32_sdwa v100, 3, v125 dst_sel:DWORD dst_unused:UNUSED_PAD src0_sel:DWORD src1_sel:WORD_0
    v_lshlrev_b32_sdwa v102, 3, v125 dst_sel:DWORD dst_unused:UNUSED_PAD src0_sel:DWORD src1_sel:WORD_1
    ds_read_b64 v[100:101], v100
    ds_read_b64 v[102:103], v102
    s_waitcnt lgkmcnt(8)
    v_add3_u32 v54, s25, v104, v106
    v_add3_u32 v55, s25, v105, v107
    v_add3_u32 v54, v54, v108, v110
    v_add3_u32 v55, v55, v109, v111
    s_setprio 1
    v_mfma_f32_16x16x32_bf16 v[112:115], v[72:75], v[240:243], v[66:69]
    buffer_load_dwordx4 v[72:75], v71, s[12:15], s21 offen offset:0
    v_lshlrev_b32_sdwa v104, 3, v126 dst_sel:DWORD dst_unused:UNUSED_PAD src0_sel:DWORD src1_sel:WORD_0
    v_lshlrev_b32_sdwa v106, 3, v126 dst_sel:DWORD dst_unused:UNUSED_PAD src0_sel:DWORD src1_sel:WORD_1
    ds_read_b64 v[104:105], v104
    ds_read_b64 v[106:107], v106
    v_mfma_f32_16x16x32_bf16 v[112:115], v[76:79], v[244:247], v[112:115]
    buffer_load_dwordx4 v[76:79], v71, s[12:15], s21 offen offset:1024
    v_lshlrev_b32_sdwa v108, 3, v127 dst_sel:DWORD dst_unused:UNUSED_PAD src0_sel:DWORD src1_sel:WORD_0
    v_lshlrev_b32_sdwa v110, 3, v127 dst_sel:DWORD dst_unused:UNUSED_PAD src0_sel:DWORD src1_sel:WORD_1
    ds_read_b64 v[108:109], v108
    ds_read_b64 v[110:111], v110
    buffer_load_dwordx4 v[124:127], v71, s[12:15], s20 offen offset:3072 sc1
    s_waitcnt lgkmcnt(8)
    v_add3_u32 v54, v54, v88, v90
    v_add3_u32 v55, v55, v89, v91
    v_add3_u32 v54, v54, v92, v94
    v_add3_u32 v55, v55, v93, v95
    v_mfma_f32_16x16x32_bf16 v[112:115], v[80:83], v[248:251], v[112:115]
    buffer_load_dwordx4 v[80:83], v71, s[12:15], s19 offen offset:0
    s_waitcnt vmcnt(5)
    v_lshlrev_b32_sdwa v88, 3, v116 dst_sel:DWORD dst_unused:UNUSED_PAD src0_sel:DWORD src1_sel:WORD_0
    v_lshlrev_b32_sdwa v90, 3, v116 dst_sel:DWORD dst_unused:UNUSED_PAD src0_sel:DWORD src1_sel:WORD_1
    ds_read_b64 v[88:89], v88
    ds_read_b64 v[90:91], v90
    v_mfma_f32_16x16x32_bf16 v[112:115], v[84:87], v[252:255], v[112:115]
    buffer_load_dwordx4 v[84:87], v71, s[12:15], s19 offen offset:1024
    s_add_u32 s21, s21, 4096
    s_add_u32 s19, s19, 4096
    v_lshlrev_b32_sdwa v92, 3, v117 dst_sel:DWORD dst_unused:UNUSED_PAD src0_sel:DWORD src1_sel:WORD_0
    v_lshlrev_b32_sdwa v94, 3, v117 dst_sel:DWORD dst_unused:UNUSED_PAD src0_sel:DWORD src1_sel:WORD_1
    ds_read_b64 v[92:93], v92
    ds_read_b64 v[94:95], v94
    s_waitcnt lgkmcnt(8)
    v_add3_u32 v56, s25, v96, v98
    v_add3_u32 v57, s25, v97, v99
    v_add3_u32 v56, v56, v100, v102
    v_add3_u32 v57, v57, v101, v103
    v_perm_b32 v112, v113, v112, s23
    v_perm_b32 v113, v115, v114, s23
    ds_write_b64 v70, v[112:113] offset:33664
    v_lshlrev_b32_sdwa v96, 3, v118 dst_sel:DWORD dst_unused:UNUSED_PAD src0_sel:DWORD src1_sel:WORD_0
    v_lshlrev_b32_sdwa v98, 3, v118 dst_sel:DWORD dst_unused:UNUSED_PAD src0_sel:DWORD src1_sel:WORD_1
    ds_read_b64 v[96:97], v96
    ds_read_b64 v[98:99], v98
    v_lshlrev_b32_sdwa v100, 3, v119 dst_sel:DWORD dst_unused:UNUSED_PAD src0_sel:DWORD src1_sel:WORD_0
    v_lshlrev_b32_sdwa v102, 3, v119 dst_sel:DWORD dst_unused:UNUSED_PAD src0_sel:DWORD src1_sel:WORD_1
    ds_read_b64 v[100:101], v100
    ds_read_b64 v[102:103], v102
    s_add_u32 s20, s20, 0x1d000
    buffer_load_dwordx4 v[116:119], v71, s[12:15], s20 offen offset:0 sc1
    s_waitcnt lgkmcnt(9)
    v_add3_u32 v56, v56, v104, v106
    v_add3_u32 v57, v57, v105, v107
    v_add3_u32 v56, v56, v108, v110
    v_add3_u32 v57, v57, v109, v111
    s_waitcnt vmcnt(6)
    v_lshlrev_b32_sdwa v104, 3, v120 dst_sel:DWORD dst_unused:UNUSED_PAD src0_sel:DWORD src1_sel:WORD_0
    v_lshlrev_b32_sdwa v106, 3, v120 dst_sel:DWORD dst_unused:UNUSED_PAD src0_sel:DWORD src1_sel:WORD_1
    ds_read_b64 v[104:105], v104
    ds_read_b64 v[106:107], v106
    v_lshlrev_b32_sdwa v108, 3, v121 dst_sel:DWORD dst_unused:UNUSED_PAD src0_sel:DWORD src1_sel:WORD_0
    v_lshlrev_b32_sdwa v110, 3, v121 dst_sel:DWORD dst_unused:UNUSED_PAD src0_sel:DWORD src1_sel:WORD_1
    ds_read_b64 v[108:109], v108
    ds_read_b64 v[110:111], v110
    s_waitcnt lgkmcnt(9)
    v_add3_u32 v58, s25, v88, v90
    v_add3_u32 v59, s25, v89, v91
    v_add3_u32 v58, v58, v92, v94
    v_add3_u32 v59, v59, v93, v95
    v_lshlrev_b32_sdwa v88, 3, v122 dst_sel:DWORD dst_unused:UNUSED_PAD src0_sel:DWORD src1_sel:WORD_0
    v_lshlrev_b32_sdwa v90, 3, v122 dst_sel:DWORD dst_unused:UNUSED_PAD src0_sel:DWORD src1_sel:WORD_1
    ds_read_b64 v[88:89], v88
    ds_read_b64 v[90:91], v90
    v_lshlrev_b32_sdwa v92, 3, v123 dst_sel:DWORD dst_unused:UNUSED_PAD src0_sel:DWORD src1_sel:WORD_0
    v_lshlrev_b32_sdwa v94, 3, v123 dst_sel:DWORD dst_unused:UNUSED_PAD src0_sel:DWORD src1_sel:WORD_1
    ds_read_b64 v[92:93], v92
    ds_read_b64 v[94:95], v94
    buffer_load_dwordx4 v[120:123], v71, s[12:15], s20 offen offset:1024 sc1
    s_waitcnt lgkmcnt(8)
    v_add3_u32 v58, v58, v96, v98
    v_add3_u32 v59, v59, v97, v99
    v_add3_u32 v58, v58, v100, v102
    v_add3_u32 v59, v59, v101, v103
    s_waitcnt vmcnt(4)
    v_lshlrev_b32_sdwa v96, 3, v124 dst_sel:DWORD dst_unused:UNUSED_PAD src0_sel:DWORD src1_sel:WORD_0
    v_lshlrev_b32_sdwa v98, 3, v124 dst_sel:DWORD dst_unused:UNUSED_PAD src0_sel:DWORD src1_sel:WORD_1
    ds_read_b64 v[96:97], v96
    ds_read_b64 v[98:99], v98
    v_lshlrev_b32_sdwa v100, 3, v125 dst_sel:DWORD dst_unused:UNUSED_PAD src0_sel:DWORD src1_sel:WORD_0
    v_lshlrev_b32_sdwa v102, 3, v125 dst_sel:DWORD dst_unused:UNUSED_PAD src0_sel:DWORD src1_sel:WORD_1
    ds_read_b64 v[100:101], v100
    ds_read_b64 v[102:103], v102
    s_waitcnt lgkmcnt(8)
    v_add3_u32 v60, s25, v104, v106
    v_add3_u32 v61, s25, v105, v107
    v_add3_u32 v60, v60, v108, v110
    v_add3_u32 v61, v61, v109, v111
    s_setprio 0
    v_lshlrev_b32_sdwa v104, 3, v126 dst_sel:DWORD dst_unused:UNUSED_PAD src0_sel:DWORD src1_sel:WORD_0
    v_lshlrev_b32_sdwa v106, 3, v126 dst_sel:DWORD dst_unused:UNUSED_PAD src0_sel:DWORD src1_sel:WORD_1
    ds_read_b64 v[104:105], v104
    ds_read_b64 v[106:107], v106
    v_lshlrev_b32_sdwa v108, 3, v127 dst_sel:DWORD dst_unused:UNUSED_PAD src0_sel:DWORD src1_sel:WORD_0
    v_lshlrev_b32_sdwa v110, 3, v127 dst_sel:DWORD dst_unused:UNUSED_PAD src0_sel:DWORD src1_sel:WORD_1
    ds_read_b64 v[108:109], v108
    ds_read_b64 v[110:111], v110
    buffer_load_dwordx4 v[124:127], v71, s[12:15], s20 offen offset:2048 sc1
    s_waitcnt lgkmcnt(8)
    v_add3_u32 v60, v60, v88, v90
    v_add3_u32 v61, v61, v89, v91
    v_add3_u32 v60, v60, v92, v94
    v_add3_u32 v61, v61, v93, v95
    s_waitcnt vmcnt(2)
    v_lshlrev_b32_sdwa v88, 3, v118 dst_sel:DWORD dst_unused:UNUSED_PAD src0_sel:DWORD src1_sel:WORD_0
    v_lshlrev_b32_sdwa v90, 3, v118 dst_sel:DWORD dst_unused:UNUSED_PAD src0_sel:DWORD src1_sel:WORD_1
    ds_read_b64 v[88:89], v88
    ds_read_b64 v[90:91], v90
    v_lshlrev_b32_sdwa v92, 3, v119 dst_sel:DWORD dst_unused:UNUSED_PAD src0_sel:DWORD src1_sel:WORD_0
    v_lshlrev_b32_sdwa v94, 3, v119 dst_sel:DWORD dst_unused:UNUSED_PAD src0_sel:DWORD src1_sel:WORD_1
    ds_read_b64 v[92:93], v92
    ds_read_b64 v[94:95], v94
    s_waitcnt lgkmcnt(8)
    v_add3_u32 v62, s25, v96, v98
    v_add3_u32 v63, s25, v97, v99
    v_add3_u32 v62, v62, v100, v102
    v_add3_u32 v63, v63, v101, v103
    s_barrier
    s_setprio 3
    v_lshlrev_b32_sdwa v96, 3, v116 dst_sel:DWORD dst_unused:UNUSED_PAD src0_sel:DWORD src1_sel:WORD_0
    v_lshlrev_b32_sdwa v98, 3, v116 dst_sel:DWORD dst_unused:UNUSED_PAD src0_sel:DWORD src1_sel:WORD_1
    ds_read_b64 v[96:97], v96
    ds_read_b64 v[98:99], v98
    v_lshlrev_b32_sdwa v100, 3, v117 dst_sel:DWORD dst_unused:UNUSED_PAD src0_sel:DWORD src1_sel:WORD_0
    v_lshlrev_b32_sdwa v102, 3, v117 dst_sel:DWORD dst_unused:UNUSED_PAD src0_sel:DWORD src1_sel:WORD_1
    ds_read_b64 v[100:101], v100
    ds_read_b64 v[102:103], v102
    buffer_load_dwordx4 v[116:119], v71, s[12:15], s20 offen offset:3072 sc1
    s_waitcnt lgkmcnt(8)
    v_add3_u32 v62, v62, v104, v106
    v_add3_u32 v63, v63, v105, v107
    v_add3_u32 v62, v62, v108, v110
    v_add3_u32 v63, v63, v109, v111
    v_mfma_f32_16x16x32_bf16 v[112:115], v[72:75], v[128:131], v[66:69]
    s_waitcnt vmcnt(2)
    v_lshlrev_b32_sdwa v104, 3, v122 dst_sel:DWORD dst_unused:UNUSED_PAD src0_sel:DWORD src1_sel:WORD_0
    v_lshlrev_b32_sdwa v106, 3, v122 dst_sel:DWORD dst_unused:UNUSED_PAD src0_sel:DWORD src1_sel:WORD_1
    ds_read_b64 v[104:105], v104
    ds_read_b64 v[106:107], v106
    v_mfma_f32_16x16x32_bf16 v[112:115], v[76:79], v[132:135], v[112:115]
    v_add_u32 v70, 0x10000, v70
    v_lshlrev_b32_sdwa v108, 3, v123 dst_sel:DWORD dst_unused:UNUSED_PAD src0_sel:DWORD src1_sel:WORD_0
    v_lshlrev_b32_sdwa v110, 3, v123 dst_sel:DWORD dst_unused:UNUSED_PAD src0_sel:DWORD src1_sel:WORD_1
    ds_read_b64 v[108:109], v108
    ds_read_b64 v[110:111], v110
    s_waitcnt lgkmcnt(8)
    v_add3_u32 v0, v0, v88, v90
    v_add3_u32 v1, v1, v89, v91
    v_add3_u32 v0, v0, v92, v94
    v_add3_u32 v1, v1, v93, v95
    v_mfma_f32_16x16x32_bf16 v[112:115], v[80:83], v[136:139], v[112:115]
    v_lshlrev_b32_sdwa v88, 3, v120 dst_sel:DWORD dst_unused:UNUSED_PAD src0_sel:DWORD src1_sel:WORD_0
    v_lshlrev_b32_sdwa v90, 3, v120 dst_sel:DWORD dst_unused:UNUSED_PAD src0_sel:DWORD src1_sel:WORD_1
    ds_read_b64 v[88:89], v88
    ds_read_b64 v[90:91], v90
    v_mfma_f32_16x16x32_bf16 v[112:115], v[84:87], v[140:143], v[112:115]
    v_lshlrev_b32_sdwa v92, 3, v121 dst_sel:DWORD dst_unused:UNUSED_PAD src0_sel:DWORD src1_sel:WORD_0
    v_lshlrev_b32_sdwa v94, 3, v121 dst_sel:DWORD dst_unused:UNUSED_PAD src0_sel:DWORD src1_sel:WORD_1
    ds_read_b64 v[92:93], v92
    ds_read_b64 v[94:95], v94
    s_add_u32 s20, s20, 0x1000
    buffer_load_dwordx4 v[120:123], v71, s[12:15], s20 offen offset:0 sc1
    s_waitcnt lgkmcnt(8)
    v_add3_u32 v0, v0, v96, v98
    v_add3_u32 v1, v1, v97, v99
    v_add3_u32 v0, v0, v100, v102
    v_add3_u32 v1, v1, v101, v103
    v_perm_b32 v112, v113, v112, s23
    v_perm_b32 v113, v115, v114, s23
    ds_write_b64 v70, v[112:113] offset:0
    s_waitcnt vmcnt(2)
    v_lshlrev_b32_sdwa v96, 3, v126 dst_sel:DWORD dst_unused:UNUSED_PAD src0_sel:DWORD src1_sel:WORD_0
    v_lshlrev_b32_sdwa v98, 3, v126 dst_sel:DWORD dst_unused:UNUSED_PAD src0_sel:DWORD src1_sel:WORD_1
    ds_read_b64 v[96:97], v96
    ds_read_b64 v[98:99], v98
    v_lshlrev_b32_sdwa v100, 3, v127 dst_sel:DWORD dst_unused:UNUSED_PAD src0_sel:DWORD src1_sel:WORD_0
    v_lshlrev_b32_sdwa v102, 3, v127 dst_sel:DWORD dst_unused:UNUSED_PAD src0_sel:DWORD src1_sel:WORD_1
    ds_read_b64 v[100:101], v100
    ds_read_b64 v[102:103], v102
    s_waitcnt lgkmcnt(9)
    v_add3_u32 v2, v2, v104, v106
    v_add3_u32 v3, v3, v105, v107
    v_add3_u32 v2, v2, v108, v110
    v_add3_u32 v3, v3, v109, v111
    v_mfma_f32_16x16x32_bf16 v[112:115], v[72:75], v[144:147], v[66:69]
    v_lshlrev_b32_sdwa v104, 3, v124 dst_sel:DWORD dst_unused:UNUSED_PAD src0_sel:DWORD src1_sel:WORD_0
    v_lshlrev_b32_sdwa v106, 3, v124 dst_sel:DWORD dst_unused:UNUSED_PAD src0_sel:DWORD src1_sel:WORD_1
    ds_read_b64 v[104:105], v104
    ds_read_b64 v[106:107], v106
    v_mfma_f32_16x16x32_bf16 v[112:115], v[76:79], v[148:151], v[112:115]
    v_lshlrev_b32_sdwa v108, 3, v125 dst_sel:DWORD dst_unused:UNUSED_PAD src0_sel:DWORD src1_sel:WORD_0
    v_lshlrev_b32_sdwa v110, 3, v125 dst_sel:DWORD dst_unused:UNUSED_PAD src0_sel:DWORD src1_sel:WORD_1
    ds_read_b64 v[108:109], v108
    ds_read_b64 v[110:111], v110
    buffer_load_dwordx4 v[124:127], v71, s[12:15], s20 offen offset:1024 sc1
    s_waitcnt lgkmcnt(9)
    v_add3_u32 v2, v2, v88, v90
    v_add3_u32 v3, v3, v89, v91
    v_add3_u32 v2, v2, v92, v94
    v_add3_u32 v3, v3, v93, v95
    v_mfma_f32_16x16x32_bf16 v[112:115], v[80:83], v[152:155], v[112:115]
    s_waitcnt vmcnt(2)
    v_lshlrev_b32_sdwa v88, 3, v118 dst_sel:DWORD dst_unused:UNUSED_PAD src0_sel:DWORD src1_sel:WORD_0
    v_lshlrev_b32_sdwa v90, 3, v118 dst_sel:DWORD dst_unused:UNUSED_PAD src0_sel:DWORD src1_sel:WORD_1
    ds_read_b64 v[88:89], v88
    ds_read_b64 v[90:91], v90
    v_mfma_f32_16x16x32_bf16 v[112:115], v[84:87], v[156:159], v[112:115]
    v_lshlrev_b32_sdwa v92, 3, v119 dst_sel:DWORD dst_unused:UNUSED_PAD src0_sel:DWORD src1_sel:WORD_0
    v_lshlrev_b32_sdwa v94, 3, v119 dst_sel:DWORD dst_unused:UNUSED_PAD src0_sel:DWORD src1_sel:WORD_1
    ds_read_b64 v[92:93], v92
    ds_read_b64 v[94:95], v94
    s_waitcnt lgkmcnt(8)
    v_add3_u32 v4, v4, v96, v98
    v_add3_u32 v5, v5, v97, v99
    v_add3_u32 v4, v4, v100, v102
    v_add3_u32 v5, v5, v101, v103
    v_perm_b32 v112, v113, v112, s23
    v_perm_b32 v113, v115, v114, s23
    ds_write_b64 v70, v[112:113] offset:128
    v_lshlrev_b32_sdwa v96, 3, v116 dst_sel:DWORD dst_unused:UNUSED_PAD src0_sel:DWORD src1_sel:WORD_0
    v_lshlrev_b32_sdwa v98, 3, v116 dst_sel:DWORD dst_unused:UNUSED_PAD src0_sel:DWORD src1_sel:WORD_1
    ds_read_b64 v[96:97], v96
    ds_read_b64 v[98:99], v98
    v_lshlrev_b32_sdwa v100, 3, v117 dst_sel:DWORD dst_unused:UNUSED_PAD src0_sel:DWORD src1_sel:WORD_0
    v_lshlrev_b32_sdwa v102, 3, v117 dst_sel:DWORD dst_unused:UNUSED_PAD src0_sel:DWORD src1_sel:WORD_1
    ds_read_b64 v[100:101], v100
    ds_read_b64 v[102:103], v102
    buffer_load_dwordx4 v[116:119], v71, s[12:15], s20 offen offset:2048 sc1
    s_waitcnt lgkmcnt(9)
    v_add3_u32 v4, v4, v104, v106
    v_add3_u32 v5, v5, v105, v107
    v_add3_u32 v4, v4, v108, v110
    v_add3_u32 v5, v5, v109, v111
    v_mfma_f32_16x16x32_bf16 v[112:115], v[72:75], v[160:163], v[66:69]
    s_waitcnt vmcnt(2)
    v_lshlrev_b32_sdwa v104, 3, v122 dst_sel:DWORD dst_unused:UNUSED_PAD src0_sel:DWORD src1_sel:WORD_0
    v_lshlrev_b32_sdwa v106, 3, v122 dst_sel:DWORD dst_unused:UNUSED_PAD src0_sel:DWORD src1_sel:WORD_1
    ds_read_b64 v[104:105], v104
    ds_read_b64 v[106:107], v106
    v_mfma_f32_16x16x32_bf16 v[112:115], v[76:79], v[164:167], v[112:115]
    v_lshlrev_b32_sdwa v108, 3, v123 dst_sel:DWORD dst_unused:UNUSED_PAD src0_sel:DWORD src1_sel:WORD_0
    v_lshlrev_b32_sdwa v110, 3, v123 dst_sel:DWORD dst_unused:UNUSED_PAD src0_sel:DWORD src1_sel:WORD_1
    ds_read_b64 v[108:109], v108
    ds_read_b64 v[110:111], v110
    s_waitcnt lgkmcnt(9)
    v_add3_u32 v6, v6, v88, v90
    v_add3_u32 v7, v7, v89, v91
    v_add3_u32 v6, v6, v92, v94
    v_add3_u32 v7, v7, v93, v95
    v_mfma_f32_16x16x32_bf16 v[112:115], v[80:83], v[168:171], v[112:115]
    v_lshlrev_b32_sdwa v88, 3, v120 dst_sel:DWORD dst_unused:UNUSED_PAD src0_sel:DWORD src1_sel:WORD_0
    v_lshlrev_b32_sdwa v90, 3, v120 dst_sel:DWORD dst_unused:UNUSED_PAD src0_sel:DWORD src1_sel:WORD_1
    ds_read_b64 v[88:89], v88
    ds_read_b64 v[90:91], v90
    v_mfma_f32_16x16x32_bf16 v[112:115], v[84:87], v[172:175], v[112:115]
    v_lshlrev_b32_sdwa v92, 3, v121 dst_sel:DWORD dst_unused:UNUSED_PAD src0_sel:DWORD src1_sel:WORD_0
    v_lshlrev_b32_sdwa v94, 3, v121 dst_sel:DWORD dst_unused:UNUSED_PAD src0_sel:DWORD src1_sel:WORD_1
    ds_read_b64 v[92:93], v92
    ds_read_b64 v[94:95], v94
    buffer_load_dwordx4 v[120:123], v71, s[12:15], s20 offen offset:3072 sc1
    s_waitcnt lgkmcnt(8)
    v_add3_u32 v6, v6, v96, v98
    v_add3_u32 v7, v7, v97, v99
    v_add3_u32 v6, v6, v100, v102
    v_add3_u32 v7, v7, v101, v103
    v_perm_b32 v112, v113, v112, s23
    v_perm_b32 v113, v115, v114, s23
    ds_write_b64 v70, v[112:113] offset:256
    s_waitcnt vmcnt(2)
    v_lshlrev_b32_sdwa v96, 3, v126 dst_sel:DWORD dst_unused:UNUSED_PAD src0_sel:DWORD src1_sel:WORD_0
    v_lshlrev_b32_sdwa v98, 3, v126 dst_sel:DWORD dst_unused:UNUSED_PAD src0_sel:DWORD src1_sel:WORD_1
    ds_read_b64 v[96:97], v96
    ds_read_b64 v[98:99], v98
    v_lshlrev_b32_sdwa v100, 3, v127 dst_sel:DWORD dst_unused:UNUSED_PAD src0_sel:DWORD src1_sel:WORD_0
    v_lshlrev_b32_sdwa v102, 3, v127 dst_sel:DWORD dst_unused:UNUSED_PAD src0_sel:DWORD src1_sel:WORD_1
    ds_read_b64 v[100:101], v100
    ds_read_b64 v[102:103], v102
    s_waitcnt lgkmcnt(9)
    v_add3_u32 v8, v8, v104, v106
    v_add3_u32 v9, v9, v105, v107
    v_add3_u32 v8, v8, v108, v110
    v_add3_u32 v9, v9, v109, v111
    v_mfma_f32_16x16x32_bf16 v[112:115], v[72:75], v[176:179], v[66:69]
    v_lshlrev_b32_sdwa v104, 3, v124 dst_sel:DWORD dst_unused:UNUSED_PAD src0_sel:DWORD src1_sel:WORD_0
    v_lshlrev_b32_sdwa v106, 3, v124 dst_sel:DWORD dst_unused:UNUSED_PAD src0_sel:DWORD src1_sel:WORD_1
    ds_read_b64 v[104:105], v104
    ds_read_b64 v[106:107], v106
    v_mfma_f32_16x16x32_bf16 v[112:115], v[76:79], v[180:183], v[112:115]
    v_lshlrev_b32_sdwa v108, 3, v125 dst_sel:DWORD dst_unused:UNUSED_PAD src0_sel:DWORD src1_sel:WORD_0
    v_lshlrev_b32_sdwa v110, 3, v125 dst_sel:DWORD dst_unused:UNUSED_PAD src0_sel:DWORD src1_sel:WORD_1
    ds_read_b64 v[108:109], v108
    ds_read_b64 v[110:111], v110
    s_add_u32 s20, s20, 0x1000
    buffer_load_dwordx4 v[124:127], v71, s[12:15], s20 offen offset:0 sc1
    s_waitcnt lgkmcnt(9)
    v_add3_u32 v8, v8, v88, v90
    v_add3_u32 v9, v9, v89, v91
    v_add3_u32 v8, v8, v92, v94
    v_add3_u32 v9, v9, v93, v95
    v_mfma_f32_16x16x32_bf16 v[112:115], v[80:83], v[184:187], v[112:115]
    s_waitcnt vmcnt(2)
    v_lshlrev_b32_sdwa v88, 3, v118 dst_sel:DWORD dst_unused:UNUSED_PAD src0_sel:DWORD src1_sel:WORD_0
    v_lshlrev_b32_sdwa v90, 3, v118 dst_sel:DWORD dst_unused:UNUSED_PAD src0_sel:DWORD src1_sel:WORD_1
    ds_read_b64 v[88:89], v88
    ds_read_b64 v[90:91], v90
    v_mfma_f32_16x16x32_bf16 v[112:115], v[84:87], v[188:191], v[112:115]
    v_lshlrev_b32_sdwa v92, 3, v119 dst_sel:DWORD dst_unused:UNUSED_PAD src0_sel:DWORD src1_sel:WORD_0
    v_lshlrev_b32_sdwa v94, 3, v119 dst_sel:DWORD dst_unused:UNUSED_PAD src0_sel:DWORD src1_sel:WORD_1
    ds_read_b64 v[92:93], v92
    ds_read_b64 v[94:95], v94
    s_waitcnt lgkmcnt(8)
    v_add3_u32 v10, v10, v96, v98
    v_add3_u32 v11, v11, v97, v99
    v_add3_u32 v10, v10, v100, v102
    v_add3_u32 v11, v11, v101, v103
    v_perm_b32 v112, v113, v112, s23
    v_perm_b32 v113, v115, v114, s23
    ds_write_b64 v70, v[112:113] offset:384
    v_lshlrev_b32_sdwa v96, 3, v116 dst_sel:DWORD dst_unused:UNUSED_PAD src0_sel:DWORD src1_sel:WORD_0
    v_lshlrev_b32_sdwa v98, 3, v116 dst_sel:DWORD dst_unused:UNUSED_PAD src0_sel:DWORD src1_sel:WORD_1
    ds_read_b64 v[96:97], v96
    ds_read_b64 v[98:99], v98
    v_lshlrev_b32_sdwa v100, 3, v117 dst_sel:DWORD dst_unused:UNUSED_PAD src0_sel:DWORD src1_sel:WORD_0
    v_lshlrev_b32_sdwa v102, 3, v117 dst_sel:DWORD dst_unused:UNUSED_PAD src0_sel:DWORD src1_sel:WORD_1
    ds_read_b64 v[100:101], v100
    ds_read_b64 v[102:103], v102
    buffer_load_dwordx4 v[116:119], v71, s[12:15], s20 offen offset:1024 sc1
    s_waitcnt lgkmcnt(9)
    v_add3_u32 v10, v10, v104, v106
    v_add3_u32 v11, v11, v105, v107
    v_add3_u32 v10, v10, v108, v110
    v_add3_u32 v11, v11, v109, v111
    v_mfma_f32_16x16x32_bf16 v[112:115], v[72:75], v[192:195], v[66:69]
    s_waitcnt vmcnt(2)
    v_lshlrev_b32_sdwa v104, 3, v122 dst_sel:DWORD dst_unused:UNUSED_PAD src0_sel:DWORD src1_sel:WORD_0
    v_lshlrev_b32_sdwa v106, 3, v122 dst_sel:DWORD dst_unused:UNUSED_PAD src0_sel:DWORD src1_sel:WORD_1
    ds_read_b64 v[104:105], v104
    ds_read_b64 v[106:107], v106
    v_mfma_f32_16x16x32_bf16 v[112:115], v[76:79], v[196:199], v[112:115]
    v_lshlrev_b32_sdwa v108, 3, v123 dst_sel:DWORD dst_unused:UNUSED_PAD src0_sel:DWORD src1_sel:WORD_0
    v_lshlrev_b32_sdwa v110, 3, v123 dst_sel:DWORD dst_unused:UNUSED_PAD src0_sel:DWORD src1_sel:WORD_1
    ds_read_b64 v[108:109], v108
    ds_read_b64 v[110:111], v110
    s_waitcnt lgkmcnt(9)
    v_add3_u32 v12, v12, v88, v90
    v_add3_u32 v13, v13, v89, v91
    v_add3_u32 v12, v12, v92, v94
    v_add3_u32 v13, v13, v93, v95
    v_mfma_f32_16x16x32_bf16 v[112:115], v[80:83], v[200:203], v[112:115]
    v_lshlrev_b32_sdwa v88, 3, v120 dst_sel:DWORD dst_unused:UNUSED_PAD src0_sel:DWORD src1_sel:WORD_0
    v_lshlrev_b32_sdwa v90, 3, v120 dst_sel:DWORD dst_unused:UNUSED_PAD src0_sel:DWORD src1_sel:WORD_1
    ds_read_b64 v[88:89], v88
    ds_read_b64 v[90:91], v90
    v_mfma_f32_16x16x32_bf16 v[112:115], v[84:87], v[204:207], v[112:115]
    v_lshlrev_b32_sdwa v92, 3, v121 dst_sel:DWORD dst_unused:UNUSED_PAD src0_sel:DWORD src1_sel:WORD_0
    v_lshlrev_b32_sdwa v94, 3, v121 dst_sel:DWORD dst_unused:UNUSED_PAD src0_sel:DWORD src1_sel:WORD_1
    ds_read_b64 v[92:93], v92
    ds_read_b64 v[94:95], v94
    buffer_load_dwordx4 v[120:123], v71, s[12:15], s20 offen offset:2048 sc1
    s_waitcnt lgkmcnt(8)
    v_add3_u32 v12, v12, v96, v98
    v_add3_u32 v13, v13, v97, v99
    v_add3_u32 v12, v12, v100, v102
    v_add3_u32 v13, v13, v101, v103
    v_perm_b32 v112, v113, v112, s23
    v_perm_b32 v113, v115, v114, s23
    ds_write_b64 v70, v[112:113] offset:512
    s_waitcnt vmcnt(2)
    v_lshlrev_b32_sdwa v96, 3, v126 dst_sel:DWORD dst_unused:UNUSED_PAD src0_sel:DWORD src1_sel:WORD_0
    v_lshlrev_b32_sdwa v98, 3, v126 dst_sel:DWORD dst_unused:UNUSED_PAD src0_sel:DWORD src1_sel:WORD_1
    ds_read_b64 v[96:97], v96
    ds_read_b64 v[98:99], v98
    v_lshlrev_b32_sdwa v100, 3, v127 dst_sel:DWORD dst_unused:UNUSED_PAD src0_sel:DWORD src1_sel:WORD_0
    v_lshlrev_b32_sdwa v102, 3, v127 dst_sel:DWORD dst_unused:UNUSED_PAD src0_sel:DWORD src1_sel:WORD_1
    ds_read_b64 v[100:101], v100
    ds_read_b64 v[102:103], v102
    s_waitcnt lgkmcnt(9)
    v_add3_u32 v14, v14, v104, v106
    v_add3_u32 v15, v15, v105, v107
    v_add3_u32 v14, v14, v108, v110
    v_add3_u32 v15, v15, v109, v111
    s_setprio 2
    v_mfma_f32_16x16x32_bf16 v[112:115], v[72:75], v[208:211], v[66:69]
    v_lshlrev_b32_sdwa v104, 3, v124 dst_sel:DWORD dst_unused:UNUSED_PAD src0_sel:DWORD src1_sel:WORD_0
    v_lshlrev_b32_sdwa v106, 3, v124 dst_sel:DWORD dst_unused:UNUSED_PAD src0_sel:DWORD src1_sel:WORD_1
    ds_read_b64 v[104:105], v104
    ds_read_b64 v[106:107], v106
    v_mfma_f32_16x16x32_bf16 v[112:115], v[76:79], v[212:215], v[112:115]
    v_lshlrev_b32_sdwa v108, 3, v125 dst_sel:DWORD dst_unused:UNUSED_PAD src0_sel:DWORD src1_sel:WORD_0
    v_lshlrev_b32_sdwa v110, 3, v125 dst_sel:DWORD dst_unused:UNUSED_PAD src0_sel:DWORD src1_sel:WORD_1
    ds_read_b64 v[108:109], v108
    ds_read_b64 v[110:111], v110
    buffer_load_dwordx4 v[124:127], v71, s[12:15], s20 offen offset:3072 sc1
    s_waitcnt lgkmcnt(9)
    v_add3_u32 v14, v14, v88, v90
    v_add3_u32 v15, v15, v89, v91
    v_add3_u32 v14, v14, v92, v94
    v_add3_u32 v15, v15, v93, v95
    v_mfma_f32_16x16x32_bf16 v[112:115], v[80:83], v[216:219], v[112:115]
    s_waitcnt vmcnt(2)
    v_lshlrev_b32_sdwa v88, 3, v118 dst_sel:DWORD dst_unused:UNUSED_PAD src0_sel:DWORD src1_sel:WORD_0
    v_lshlrev_b32_sdwa v90, 3, v118 dst_sel:DWORD dst_unused:UNUSED_PAD src0_sel:DWORD src1_sel:WORD_1
    ds_read_b64 v[88:89], v88
    ds_read_b64 v[90:91], v90
    v_mfma_f32_16x16x32_bf16 v[112:115], v[84:87], v[220:223], v[112:115]
    v_lshlrev_b32_sdwa v92, 3, v119 dst_sel:DWORD dst_unused:UNUSED_PAD src0_sel:DWORD src1_sel:WORD_0
    v_lshlrev_b32_sdwa v94, 3, v119 dst_sel:DWORD dst_unused:UNUSED_PAD src0_sel:DWORD src1_sel:WORD_1
    ds_read_b64 v[92:93], v92
    ds_read_b64 v[94:95], v94
    s_waitcnt lgkmcnt(8)
    v_add3_u32 v16, v16, v96, v98
    v_add3_u32 v17, v17, v97, v99
    v_add3_u32 v16, v16, v100, v102
    v_add3_u32 v17, v17, v101, v103
    v_perm_b32 v112, v113, v112, s23
    v_perm_b32 v113, v115, v114, s23
    ds_write_b64 v70, v[112:113] offset:640
    v_lshlrev_b32_sdwa v96, 3, v116 dst_sel:DWORD dst_unused:UNUSED_PAD src0_sel:DWORD src1_sel:WORD_0
    v_lshlrev_b32_sdwa v98, 3, v116 dst_sel:DWORD dst_unused:UNUSED_PAD src0_sel:DWORD src1_sel:WORD_1
    ds_read_b64 v[96:97], v96
    ds_read_b64 v[98:99], v98
    v_lshlrev_b32_sdwa v100, 3, v117 dst_sel:DWORD dst_unused:UNUSED_PAD src0_sel:DWORD src1_sel:WORD_0
    v_lshlrev_b32_sdwa v102, 3, v117 dst_sel:DWORD dst_unused:UNUSED_PAD src0_sel:DWORD src1_sel:WORD_1
    ds_read_b64 v[100:101], v100
    ds_read_b64 v[102:103], v102
    s_add_u32 s20, s20, 0x1000
    buffer_load_dwordx4 v[116:119], v71, s[12:15], s20 offen offset:0 sc1
    s_waitcnt lgkmcnt(9)
    v_add3_u32 v16, v16, v104, v106
    v_add3_u32 v17, v17, v105, v107
    v_add3_u32 v16, v16, v108, v110
    v_add3_u32 v17, v17, v109, v111
    v_mfma_f32_16x16x32_bf16 v[112:115], v[72:75], v[224:227], v[66:69]
    s_waitcnt vmcnt(2)
    v_lshlrev_b32_sdwa v104, 3, v122 dst_sel:DWORD dst_unused:UNUSED_PAD src0_sel:DWORD src1_sel:WORD_0
    v_lshlrev_b32_sdwa v106, 3, v122 dst_sel:DWORD dst_unused:UNUSED_PAD src0_sel:DWORD src1_sel:WORD_1
    ds_read_b64 v[104:105], v104
    ds_read_b64 v[106:107], v106
    v_mfma_f32_16x16x32_bf16 v[112:115], v[76:79], v[228:231], v[112:115]
    v_lshlrev_b32_sdwa v108, 3, v123 dst_sel:DWORD dst_unused:UNUSED_PAD src0_sel:DWORD src1_sel:WORD_0
    v_lshlrev_b32_sdwa v110, 3, v123 dst_sel:DWORD dst_unused:UNUSED_PAD src0_sel:DWORD src1_sel:WORD_1
    ds_read_b64 v[108:109], v108
    ds_read_b64 v[110:111], v110
    s_waitcnt lgkmcnt(9)
    v_add3_u32 v18, v18, v88, v90
    v_add3_u32 v19, v19, v89, v91
    v_add3_u32 v18, v18, v92, v94
    v_add3_u32 v19, v19, v93, v95
    v_mfma_f32_16x16x32_bf16 v[112:115], v[80:83], v[232:235], v[112:115]
    v_lshlrev_b32_sdwa v88, 3, v120 dst_sel:DWORD dst_unused:UNUSED_PAD src0_sel:DWORD src1_sel:WORD_0
    v_lshlrev_b32_sdwa v90, 3, v120 dst_sel:DWORD dst_unused:UNUSED_PAD src0_sel:DWORD src1_sel:WORD_1
    ds_read_b64 v[88:89], v88
    ds_read_b64 v[90:91], v90
    v_mfma_f32_16x16x32_bf16 v[112:115], v[84:87], v[236:239], v[112:115]
    v_lshlrev_b32_sdwa v92, 3, v121 dst_sel:DWORD dst_unused:UNUSED_PAD src0_sel:DWORD src1_sel:WORD_0
    v_lshlrev_b32_sdwa v94, 3, v121 dst_sel:DWORD dst_unused:UNUSED_PAD src0_sel:DWORD src1_sel:WORD_1
    ds_read_b64 v[92:93], v92
    ds_read_b64 v[94:95], v94
    buffer_load_dwordx4 v[120:123], v71, s[12:15], s20 offen offset:1024 sc1
    s_waitcnt lgkmcnt(8)
    v_add3_u32 v18, v18, v96, v98
    v_add3_u32 v19, v19, v97, v99
    v_add3_u32 v18, v18, v100, v102
    v_add3_u32 v19, v19, v101, v103
    v_perm_b32 v112, v113, v112, s23
    v_perm_b32 v113, v115, v114, s23
    ds_write_b64 v70, v[112:113] offset:768
    s_waitcnt vmcnt(2)
    v_lshlrev_b32_sdwa v96, 3, v126 dst_sel:DWORD dst_unused:UNUSED_PAD src0_sel:DWORD src1_sel:WORD_0
    v_lshlrev_b32_sdwa v98, 3, v126 dst_sel:DWORD dst_unused:UNUSED_PAD src0_sel:DWORD src1_sel:WORD_1
    ds_read_b64 v[96:97], v96
    ds_read_b64 v[98:99], v98
    v_lshlrev_b32_sdwa v100, 3, v127 dst_sel:DWORD dst_unused:UNUSED_PAD src0_sel:DWORD src1_sel:WORD_0
    v_lshlrev_b32_sdwa v102, 3, v127 dst_sel:DWORD dst_unused:UNUSED_PAD src0_sel:DWORD src1_sel:WORD_1
    ds_read_b64 v[100:101], v100
    ds_read_b64 v[102:103], v102
    s_waitcnt lgkmcnt(9)
    v_add3_u32 v20, v20, v104, v106
    v_add3_u32 v21, v21, v105, v107
    v_add3_u32 v20, v20, v108, v110
    v_add3_u32 v21, v21, v109, v111
    v_mfma_f32_16x16x32_bf16 v[112:115], v[72:75], v[240:243], v[66:69]
    buffer_load_dwordx4 v[72:75], v71, s[12:15], s21 offen offset:0
    v_lshlrev_b32_sdwa v104, 3, v124 dst_sel:DWORD dst_unused:UNUSED_PAD src0_sel:DWORD src1_sel:WORD_0
    v_lshlrev_b32_sdwa v106, 3, v124 dst_sel:DWORD dst_unused:UNUSED_PAD src0_sel:DWORD src1_sel:WORD_1
    ds_read_b64 v[104:105], v104
    ds_read_b64 v[106:107], v106
    v_mfma_f32_16x16x32_bf16 v[112:115], v[76:79], v[244:247], v[112:115]
    buffer_load_dwordx4 v[76:79], v71, s[12:15], s21 offen offset:1024
    v_lshlrev_b32_sdwa v108, 3, v125 dst_sel:DWORD dst_unused:UNUSED_PAD src0_sel:DWORD src1_sel:WORD_0
    v_lshlrev_b32_sdwa v110, 3, v125 dst_sel:DWORD dst_unused:UNUSED_PAD src0_sel:DWORD src1_sel:WORD_1
    ds_read_b64 v[108:109], v108
    ds_read_b64 v[110:111], v110
    buffer_load_dwordx4 v[124:127], v71, s[12:15], s20 offen offset:2048 sc1
    s_waitcnt lgkmcnt(9)
    v_add3_u32 v20, v20, v88, v90
    v_add3_u32 v21, v21, v89, v91
    v_add3_u32 v20, v20, v92, v94
    v_add3_u32 v21, v21, v93, v95
    v_mfma_f32_16x16x32_bf16 v[112:115], v[80:83], v[248:251], v[112:115]
    buffer_load_dwordx4 v[80:83], v71, s[12:15], s19 offen offset:0
    s_waitcnt vmcnt(5)
    v_lshlrev_b32_sdwa v88, 3, v118 dst_sel:DWORD dst_unused:UNUSED_PAD src0_sel:DWORD src1_sel:WORD_0
    v_lshlrev_b32_sdwa v90, 3, v118 dst_sel:DWORD dst_unused:UNUSED_PAD src0_sel:DWORD src1_sel:WORD_1
    ds_read_b64 v[88:89], v88
    ds_read_b64 v[90:91], v90
    v_mfma_f32_16x16x32_bf16 v[112:115], v[84:87], v[252:255], v[112:115]
    buffer_load_dwordx4 v[84:87], v71, s[12:15], s19 offen offset:1024
    s_add_u32 s21, s21, 4096
    s_add_u32 s19, s19, 4096
    v_lshlrev_b32_sdwa v92, 3, v119 dst_sel:DWORD dst_unused:UNUSED_PAD src0_sel:DWORD src1_sel:WORD_0
    v_lshlrev_b32_sdwa v94, 3, v119 dst_sel:DWORD dst_unused:UNUSED_PAD src0_sel:DWORD src1_sel:WORD_1
    ds_read_b64 v[92:93], v92
    ds_read_b64 v[94:95], v94
    s_waitcnt lgkmcnt(8)
    v_add3_u32 v22, v22, v96, v98
    v_add3_u32 v23, v23, v97, v99
    v_add3_u32 v22, v22, v100, v102
    v_add3_u32 v23, v23, v101, v103
    v_perm_b32 v112, v113, v112, s23
    v_perm_b32 v113, v115, v114, s23
    ds_write_b64 v70, v[112:113] offset:896
    s_setprio 1
    v_lshlrev_b32_sdwa v96, 3, v116 dst_sel:DWORD dst_unused:UNUSED_PAD src0_sel:DWORD src1_sel:WORD_0
    v_lshlrev_b32_sdwa v98, 3, v116 dst_sel:DWORD dst_unused:UNUSED_PAD src0_sel:DWORD src1_sel:WORD_1
    ds_read_b64 v[96:97], v96
    ds_read_b64 v[98:99], v98
    v_lshlrev_b32_sdwa v100, 3, v117 dst_sel:DWORD dst_unused:UNUSED_PAD src0_sel:DWORD src1_sel:WORD_0
    v_lshlrev_b32_sdwa v102, 3, v117 dst_sel:DWORD dst_unused:UNUSED_PAD src0_sel:DWORD src1_sel:WORD_1
    ds_read_b64 v[100:101], v100
    ds_read_b64 v[102:103], v102
    buffer_load_dwordx4 v[116:119], v71, s[12:15], s20 offen offset:3072 sc1
    s_waitcnt lgkmcnt(9)
    v_add3_u32 v22, v22, v104, v106
    v_add3_u32 v23, v23, v105, v107
    v_add3_u32 v22, v22, v108, v110
    v_add3_u32 v23, v23, v109, v111
    s_waitcnt vmcnt(6)
    v_lshlrev_b32_sdwa v104, 3, v122 dst_sel:DWORD dst_unused:UNUSED_PAD src0_sel:DWORD src1_sel:WORD_0
    v_lshlrev_b32_sdwa v106, 3, v122 dst_sel:DWORD dst_unused:UNUSED_PAD src0_sel:DWORD src1_sel:WORD_1
    ds_read_b64 v[104:105], v104
    ds_read_b64 v[106:107], v106
    v_lshlrev_b32_sdwa v108, 3, v123 dst_sel:DWORD dst_unused:UNUSED_PAD src0_sel:DWORD src1_sel:WORD_0
    v_lshlrev_b32_sdwa v110, 3, v123 dst_sel:DWORD dst_unused:UNUSED_PAD src0_sel:DWORD src1_sel:WORD_1
    ds_read_b64 v[108:109], v108
    ds_read_b64 v[110:111], v110
    s_waitcnt lgkmcnt(9)
    v_add3_u32 v24, v24, v88, v90
    v_add3_u32 v25, v25, v89, v91
    v_add3_u32 v24, v24, v92, v94
    v_add3_u32 v25, v25, v93, v95
    v_lshlrev_b32_sdwa v88, 3, v120 dst_sel:DWORD dst_unused:UNUSED_PAD src0_sel:DWORD src1_sel:WORD_0
    v_lshlrev_b32_sdwa v90, 3, v120 dst_sel:DWORD dst_unused:UNUSED_PAD src0_sel:DWORD src1_sel:WORD_1
    ds_read_b64 v[88:89], v88
    ds_read_b64 v[90:91], v90
    v_lshlrev_b32_sdwa v92, 3, v121 dst_sel:DWORD dst_unused:UNUSED_PAD src0_sel:DWORD src1_sel:WORD_0
    v_lshlrev_b32_sdwa v94, 3, v121 dst_sel:DWORD dst_unused:UNUSED_PAD src0_sel:DWORD src1_sel:WORD_1
    ds_read_b64 v[92:93], v92
    ds_read_b64 v[94:95], v94
    s_add_u32 s20, s20, 0x1d000
    buffer_load_dwordx4 v[120:123], v71, s[12:15], s20 offen offset:0 sc1
    s_waitcnt lgkmcnt(8)
    v_add3_u32 v24, v24, v96, v98
    v_add3_u32 v25, v25, v97, v99
    v_add3_u32 v24, v24, v100, v102
    v_add3_u32 v25, v25, v101, v103
    s_waitcnt vmcnt(4)
    v_lshlrev_b32_sdwa v96, 3, v126 dst_sel:DWORD dst_unused:UNUSED_PAD src0_sel:DWORD src1_sel:WORD_0
    v_lshlrev_b32_sdwa v98, 3, v126 dst_sel:DWORD dst_unused:UNUSED_PAD src0_sel:DWORD src1_sel:WORD_1
    ds_read_b64 v[96:97], v96
    ds_read_b64 v[98:99], v98
    v_lshlrev_b32_sdwa v100, 3, v127 dst_sel:DWORD dst_unused:UNUSED_PAD src0_sel:DWORD src1_sel:WORD_0
    v_lshlrev_b32_sdwa v102, 3, v127 dst_sel:DWORD dst_unused:UNUSED_PAD src0_sel:DWORD src1_sel:WORD_1
    ds_read_b64 v[100:101], v100
    ds_read_b64 v[102:103], v102
    s_waitcnt lgkmcnt(8)
    v_add3_u32 v26, v26, v104, v106
    v_add3_u32 v27, v27, v105, v107
    v_add3_u32 v26, v26, v108, v110
    v_add3_u32 v27, v27, v109, v111
    v_lshlrev_b32_sdwa v104, 3, v124 dst_sel:DWORD dst_unused:UNUSED_PAD src0_sel:DWORD src1_sel:WORD_0
    v_lshlrev_b32_sdwa v106, 3, v124 dst_sel:DWORD dst_unused:UNUSED_PAD src0_sel:DWORD src1_sel:WORD_1
    ds_read_b64 v[104:105], v104
    ds_read_b64 v[106:107], v106
    v_lshlrev_b32_sdwa v108, 3, v125 dst_sel:DWORD dst_unused:UNUSED_PAD src0_sel:DWORD src1_sel:WORD_0
    v_lshlrev_b32_sdwa v110, 3, v125 dst_sel:DWORD dst_unused:UNUSED_PAD src0_sel:DWORD src1_sel:WORD_1
    ds_read_b64 v[108:109], v108
    ds_read_b64 v[110:111], v110
    buffer_load_dwordx4 v[124:127], v71, s[12:15], s20 offen offset:1024 sc1
    s_waitcnt lgkmcnt(8)
    v_add3_u32 v26, v26, v88, v90
    v_add3_u32 v27, v27, v89, v91
    v_add3_u32 v26, v26, v92, v94
    v_add3_u32 v27, v27, v93, v95
    s_waitcnt vmcnt(2)
    v_lshlrev_b32_sdwa v88, 3, v118 dst_sel:DWORD dst_unused:UNUSED_PAD src0_sel:DWORD src1_sel:WORD_0
    v_lshlrev_b32_sdwa v90, 3, v118 dst_sel:DWORD dst_unused:UNUSED_PAD src0_sel:DWORD src1_sel:WORD_1
    ds_read_b64 v[88:89], v88
    ds_read_b64 v[90:91], v90
    v_lshlrev_b32_sdwa v92, 3, v119 dst_sel:DWORD dst_unused:UNUSED_PAD src0_sel:DWORD src1_sel:WORD_0
    v_lshlrev_b32_sdwa v94, 3, v119 dst_sel:DWORD dst_unused:UNUSED_PAD src0_sel:DWORD src1_sel:WORD_1
    ds_read_b64 v[92:93], v92
    ds_read_b64 v[94:95], v94
    s_waitcnt lgkmcnt(8)
    v_add3_u32 v28, v28, v96, v98
    v_add3_u32 v29, v29, v97, v99
    v_add3_u32 v28, v28, v100, v102
    v_add3_u32 v29, v29, v101, v103
    s_setprio 0
    v_lshlrev_b32_sdwa v96, 3, v116 dst_sel:DWORD dst_unused:UNUSED_PAD src0_sel:DWORD src1_sel:WORD_0
    v_lshlrev_b32_sdwa v98, 3, v116 dst_sel:DWORD dst_unused:UNUSED_PAD src0_sel:DWORD src1_sel:WORD_1
    ds_read_b64 v[96:97], v96
    ds_read_b64 v[98:99], v98
    v_lshlrev_b32_sdwa v100, 3, v117 dst_sel:DWORD dst_unused:UNUSED_PAD src0_sel:DWORD src1_sel:WORD_0
    v_lshlrev_b32_sdwa v102, 3, v117 dst_sel:DWORD dst_unused:UNUSED_PAD src0_sel:DWORD src1_sel:WORD_1
    ds_read_b64 v[100:101], v100
    ds_read_b64 v[102:103], v102
    buffer_load_dwordx4 v[116:119], v71, s[12:15], s20 offen offset:2048 sc1
    s_waitcnt lgkmcnt(8)
    v_add3_u32 v28, v28, v104, v106
    v_add3_u32 v29, v29, v105, v107
    v_add3_u32 v28, v28, v108, v110
    v_add3_u32 v29, v29, v109, v111
    s_waitcnt vmcnt(2)
    v_lshlrev_b32_sdwa v104, 3, v120 dst_sel:DWORD dst_unused:UNUSED_PAD src0_sel:DWORD src1_sel:WORD_0
    v_lshlrev_b32_sdwa v106, 3, v120 dst_sel:DWORD dst_unused:UNUSED_PAD src0_sel:DWORD src1_sel:WORD_1
    ds_read_b64 v[104:105], v104
    ds_read_b64 v[106:107], v106
    v_lshlrev_b32_sdwa v108, 3, v121 dst_sel:DWORD dst_unused:UNUSED_PAD src0_sel:DWORD src1_sel:WORD_0
    v_lshlrev_b32_sdwa v110, 3, v121 dst_sel:DWORD dst_unused:UNUSED_PAD src0_sel:DWORD src1_sel:WORD_1
    ds_read_b64 v[108:109], v108
    ds_read_b64 v[110:111], v110
    s_waitcnt lgkmcnt(8)
    v_add3_u32 v30, v30, v88, v90
    v_add3_u32 v31, v31, v89, v91
    v_add3_u32 v30, v30, v92, v94
    v_add3_u32 v31, v31, v93, v95
    s_barrier
    s_setprio 3
    v_lshlrev_b32_sdwa v88, 3, v122 dst_sel:DWORD dst_unused:UNUSED_PAD src0_sel:DWORD src1_sel:WORD_0
    v_lshlrev_b32_sdwa v90, 3, v122 dst_sel:DWORD dst_unused:UNUSED_PAD src0_sel:DWORD src1_sel:WORD_1
    ds_read_b64 v[88:89], v88
    ds_read_b64 v[90:91], v90
    v_lshlrev_b32_sdwa v92, 3, v123 dst_sel:DWORD dst_unused:UNUSED_PAD src0_sel:DWORD src1_sel:WORD_0
    v_lshlrev_b32_sdwa v94, 3, v123 dst_sel:DWORD dst_unused:UNUSED_PAD src0_sel:DWORD src1_sel:WORD_1
    ds_read_b64 v[92:93], v92
    ds_read_b64 v[94:95], v94
    buffer_load_dwordx4 v[120:123], v71, s[12:15], s20 offen offset:3072 sc1
    s_waitcnt lgkmcnt(8)
    v_add3_u32 v30, v30, v96, v98
    v_add3_u32 v31, v31, v97, v99
    v_add3_u32 v30, v30, v100, v102
    v_add3_u32 v31, v31, v101, v103
    v_mfma_f32_16x16x32_bf16 v[112:115], v[72:75], v[128:131], v[66:69]
    s_waitcnt vmcnt(2)
    v_lshlrev_b32_sdwa v96, 3, v124 dst_sel:DWORD dst_unused:UNUSED_PAD src0_sel:DWORD src1_sel:WORD_0
    v_lshlrev_b32_sdwa v98, 3, v124 dst_sel:DWORD dst_unused:UNUSED_PAD src0_sel:DWORD src1_sel:WORD_1
    ds_read_b64 v[96:97], v96
    ds_read_b64 v[98:99], v98
    v_mfma_f32_16x16x32_bf16 v[112:115], v[76:79], v[132:135], v[112:115]
    v_add_u32 v70, 0xfffe0000, v70
    v_lshlrev_b32_sdwa v100, 3, v125 dst_sel:DWORD dst_unused:UNUSED_PAD src0_sel:DWORD src1_sel:WORD_0
    v_lshlrev_b32_sdwa v102, 3, v125 dst_sel:DWORD dst_unused:UNUSED_PAD src0_sel:DWORD src1_sel:WORD_1
    ds_read_b64 v[100:101], v100
    ds_read_b64 v[102:103], v102
    s_waitcnt lgkmcnt(8)
    v_add3_u32 v32, v32, v104, v106
    v_add3_u32 v33, v33, v105, v107
    v_add3_u32 v32, v32, v108, v110
    v_add3_u32 v33, v33, v109, v111
    v_mfma_f32_16x16x32_bf16 v[112:115], v[80:83], v[136:139], v[112:115]
    v_lshlrev_b32_sdwa v104, 3, v126 dst_sel:DWORD dst_unused:UNUSED_PAD src0_sel:DWORD src1_sel:WORD_0
    v_lshlrev_b32_sdwa v106, 3, v126 dst_sel:DWORD dst_unused:UNUSED_PAD src0_sel:DWORD src1_sel:WORD_1
    ds_read_b64 v[104:105], v104
    ds_read_b64 v[106:107], v106
    v_mfma_f32_16x16x32_bf16 v[112:115], v[84:87], v[140:143], v[112:115]
    v_lshlrev_b32_sdwa v108, 3, v127 dst_sel:DWORD dst_unused:UNUSED_PAD src0_sel:DWORD src1_sel:WORD_0
    v_lshlrev_b32_sdwa v110, 3, v127 dst_sel:DWORD dst_unused:UNUSED_PAD src0_sel:DWORD src1_sel:WORD_1
    ds_read_b64 v[108:109], v108
    ds_read_b64 v[110:111], v110
    s_add_u32 s20, s20, 0x1000
    buffer_load_dwordx4 v[124:127], v71, s[12:15], s20 offen offset:0 sc1
    s_waitcnt lgkmcnt(8)
    v_add3_u32 v32, v32, v88, v90
    v_add3_u32 v33, v33, v89, v91
    v_add3_u32 v32, v32, v92, v94
    v_add3_u32 v33, v33, v93, v95
    v_perm_b32 v112, v113, v112, s23
    v_perm_b32 v113, v115, v114, s23
    ds_write_b64 v70, v[112:113] offset:0
    s_waitcnt vmcnt(2)
    v_lshlrev_b32_sdwa v88, 3, v116 dst_sel:DWORD dst_unused:UNUSED_PAD src0_sel:DWORD src1_sel:WORD_0
    v_lshlrev_b32_sdwa v90, 3, v116 dst_sel:DWORD dst_unused:UNUSED_PAD src0_sel:DWORD src1_sel:WORD_1
    ds_read_b64 v[88:89], v88
    ds_read_b64 v[90:91], v90
    v_lshlrev_b32_sdwa v92, 3, v117 dst_sel:DWORD dst_unused:UNUSED_PAD src0_sel:DWORD src1_sel:WORD_0
    v_lshlrev_b32_sdwa v94, 3, v117 dst_sel:DWORD dst_unused:UNUSED_PAD src0_sel:DWORD src1_sel:WORD_1
    ds_read_b64 v[92:93], v92
    ds_read_b64 v[94:95], v94
    s_waitcnt lgkmcnt(9)
    v_add3_u32 v34, v34, v96, v98
    v_add3_u32 v35, v35, v97, v99
    v_add3_u32 v34, v34, v100, v102
    v_add3_u32 v35, v35, v101, v103
    v_mfma_f32_16x16x32_bf16 v[112:115], v[72:75], v[144:147], v[66:69]
    v_lshlrev_b32_sdwa v96, 3, v118 dst_sel:DWORD dst_unused:UNUSED_PAD src0_sel:DWORD src1_sel:WORD_0
    v_lshlrev_b32_sdwa v98, 3, v118 dst_sel:DWORD dst_unused:UNUSED_PAD src0_sel:DWORD src1_sel:WORD_1
    ds_read_b64 v[96:97], v96
    ds_read_b64 v[98:99], v98
    v_mfma_f32_16x16x32_bf16 v[112:115], v[76:79], v[148:151], v[112:115]
    v_lshlrev_b32_sdwa v100, 3, v119 dst_sel:DWORD dst_unused:UNUSED_PAD src0_sel:DWORD src1_sel:WORD_0
    v_lshlrev_b32_sdwa v102, 3, v119 dst_sel:DWORD dst_unused:UNUSED_PAD src0_sel:DWORD src1_sel:WORD_1
    ds_read_b64 v[100:101], v100
    ds_read_b64 v[102:103], v102
    buffer_load_dwordx4 v[116:119], v71, s[12:15], s20 offen offset:1024 sc1
    s_waitcnt lgkmcnt(9)
    v_add3_u32 v34, v34, v104, v106
    v_add3_u32 v35, v35, v105, v107
    v_add3_u32 v34, v34, v108, v110
    v_add3_u32 v35, v35, v109, v111
    v_mfma_f32_16x16x32_bf16 v[112:115], v[80:83], v[152:155], v[112:115]
    s_waitcnt vmcnt(2)
    v_lshlrev_b32_sdwa v104, 3, v120 dst_sel:DWORD dst_unused:UNUSED_PAD src0_sel:DWORD src1_sel:WORD_0
    v_lshlrev_b32_sdwa v106, 3, v120 dst_sel:DWORD dst_unused:UNUSED_PAD src0_sel:DWORD src1_sel:WORD_1
    ds_read_b64 v[104:105], v104
    ds_read_b64 v[106:107], v106
    v_mfma_f32_16x16x32_bf16 v[112:115], v[84:87], v[156:159], v[112:115]
    v_lshlrev_b32_sdwa v108, 3, v121 dst_sel:DWORD dst_unused:UNUSED_PAD src0_sel:DWORD src1_sel:WORD_0
    v_lshlrev_b32_sdwa v110, 3, v121 dst_sel:DWORD dst_unused:UNUSED_PAD src0_sel:DWORD src1_sel:WORD_1
    ds_read_b64 v[108:109], v108
    ds_read_b64 v[110:111], v110
    s_waitcnt lgkmcnt(8)
    v_add3_u32 v36, v36, v88, v90
    v_add3_u32 v37, v37, v89, v91
    v_add3_u32 v36, v36, v92, v94
    v_add3_u32 v37, v37, v93, v95
    v_perm_b32 v112, v113, v112, s23
    v_perm_b32 v113, v115, v114, s23
    ds_write_b64 v70, v[112:113] offset:128
    v_lshlrev_b32_sdwa v88, 3, v122 dst_sel:DWORD dst_unused:UNUSED_PAD src0_sel:DWORD src1_sel:WORD_0
    v_lshlrev_b32_sdwa v90, 3, v122 dst_sel:DWORD dst_unused:UNUSED_PAD src0_sel:DWORD src1_sel:WORD_1
    ds_read_b64 v[88:89], v88
    ds_read_b64 v[90:91], v90
    v_lshlrev_b32_sdwa v92, 3, v123 dst_sel:DWORD dst_unused:UNUSED_PAD src0_sel:DWORD src1_sel:WORD_0
    v_lshlrev_b32_sdwa v94, 3, v123 dst_sel:DWORD dst_unused:UNUSED_PAD src0_sel:DWORD src1_sel:WORD_1
    ds_read_b64 v[92:93], v92
    ds_read_b64 v[94:95], v94
    buffer_load_dwordx4 v[120:123], v71, s[12:15], s20 offen offset:2048 sc1
    s_waitcnt lgkmcnt(9)
    v_add3_u32 v36, v36, v96, v98
    v_add3_u32 v37, v37, v97, v99
    v_add3_u32 v36, v36, v100, v102
    v_add3_u32 v37, v37, v101, v103
    v_mfma_f32_16x16x32_bf16 v[112:115], v[72:75], v[160:163], v[66:69]
    s_waitcnt vmcnt(2)
    v_lshlrev_b32_sdwa v96, 3, v124 dst_sel:DWORD dst_unused:UNUSED_PAD src0_sel:DWORD src1_sel:WORD_0
    v_lshlrev_b32_sdwa v98, 3, v124 dst_sel:DWORD dst_unused:UNUSED_PAD src0_sel:DWORD src1_sel:WORD_1
    ds_read_b64 v[96:97], v96
    ds_read_b64 v[98:99], v98
    v_mfma_f32_16x16x32_bf16 v[112:115], v[76:79], v[164:167], v[112:115]
    v_lshlrev_b32_sdwa v100, 3, v125 dst_sel:DWORD dst_unused:UNUSED_PAD src0_sel:DWORD src1_sel:WORD_0
    v_lshlrev_b32_sdwa v102, 3, v125 dst_sel:DWORD dst_unused:UNUSED_PAD src0_sel:DWORD src1_sel:WORD_1
    ds_read_b64 v[100:101], v100
    ds_read_b64 v[102:103], v102
    s_waitcnt lgkmcnt(9)
    v_add3_u32 v38, v38, v104, v106
    v_add3_u32 v39, v39, v105, v107
    v_add3_u32 v38, v38, v108, v110
    v_add3_u32 v39, v39, v109, v111
    v_mfma_f32_16x16x32_bf16 v[112:115], v[80:83], v[168:171], v[112:115]
    v_lshlrev_b32_sdwa v104, 3, v126 dst_sel:DWORD dst_unused:UNUSED_PAD src0_sel:DWORD src1_sel:WORD_0
    v_lshlrev_b32_sdwa v106, 3, v126 dst_sel:DWORD dst_unused:UNUSED_PAD src0_sel:DWORD src1_sel:WORD_1
    ds_read_b64 v[104:105], v104
    ds_read_b64 v[106:107], v106
    v_mfma_f32_16x16x32_bf16 v[112:115], v[84:87], v[172:175], v[112:115]
    v_lshlrev_b32_sdwa v108, 3, v127 dst_sel:DWORD dst_unused:UNUSED_PAD src0_sel:DWORD src1_sel:WORD_0
    v_lshlrev_b32_sdwa v110, 3, v127 dst_sel:DWORD dst_unused:UNUSED_PAD src0_sel:DWORD src1_sel:WORD_1
    ds_read_b64 v[108:109], v108
    ds_read_b64 v[110:111], v110
    buffer_load_dwordx4 v[124:127], v71, s[12:15], s20 offen offset:3072 sc1
    s_waitcnt lgkmcnt(8)
    v_add3_u32 v38, v38, v88, v90
    v_add3_u32 v39, v39, v89, v91
    v_add3_u32 v38, v38, v92, v94
    v_add3_u32 v39, v39, v93, v95
    v_perm_b32 v112, v113, v112, s23
    v_perm_b32 v113, v115, v114, s23
    ds_write_b64 v70, v[112:113] offset:256
    s_waitcnt vmcnt(2)
    v_lshlrev_b32_sdwa v88, 3, v116 dst_sel:DWORD dst_unused:UNUSED_PAD src0_sel:DWORD src1_sel:WORD_0
    v_lshlrev_b32_sdwa v90, 3, v116 dst_sel:DWORD dst_unused:UNUSED_PAD src0_sel:DWORD src1_sel:WORD_1
    ds_read_b64 v[88:89], v88
    ds_read_b64 v[90:91], v90
    v_lshlrev_b32_sdwa v92, 3, v117 dst_sel:DWORD dst_unused:UNUSED_PAD src0_sel:DWORD src1_sel:WORD_0
    v_lshlrev_b32_sdwa v94, 3, v117 dst_sel:DWORD dst_unused:UNUSED_PAD src0_sel:DWORD src1_sel:WORD_1
    ds_read_b64 v[92:93], v92
    ds_read_b64 v[94:95], v94
    s_waitcnt lgkmcnt(9)
    v_add3_u32 v40, v40, v96, v98
    v_add3_u32 v41, v41, v97, v99
    v_add3_u32 v40, v40, v100, v102
    v_add3_u32 v41, v41, v101, v103
    v_mfma_f32_16x16x32_bf16 v[112:115], v[72:75], v[176:179], v[66:69]
    v_lshlrev_b32_sdwa v96, 3, v118 dst_sel:DWORD dst_unused:UNUSED_PAD src0_sel:DWORD src1_sel:WORD_0
    v_lshlrev_b32_sdwa v98, 3, v118 dst_sel:DWORD dst_unused:UNUSED_PAD src0_sel:DWORD src1_sel:WORD_1
    ds_read_b64 v[96:97], v96
    ds_read_b64 v[98:99], v98
    v_mfma_f32_16x16x32_bf16 v[112:115], v[76:79], v[180:183], v[112:115]
    v_lshlrev_b32_sdwa v100, 3, v119 dst_sel:DWORD dst_unused:UNUSED_PAD src0_sel:DWORD src1_sel:WORD_0
    v_lshlrev_b32_sdwa v102, 3, v119 dst_sel:DWORD dst_unused:UNUSED_PAD src0_sel:DWORD src1_sel:WORD_1
    ds_read_b64 v[100:101], v100
    ds_read_b64 v[102:103], v102
    s_add_u32 s20, s20, 0x1000
    buffer_load_dwordx4 v[116:119], v71, s[12:15], s20 offen offset:0 sc1
    s_waitcnt lgkmcnt(9)
    v_add3_u32 v40, v40, v104, v106
    v_add3_u32 v41, v41, v105, v107
    v_add3_u32 v40, v40, v108, v110
    v_add3_u32 v41, v41, v109, v111
    v_mfma_f32_16x16x32_bf16 v[112:115], v[80:83], v[184:187], v[112:115]
    s_waitcnt vmcnt(2)
    v_lshlrev_b32_sdwa v104, 3, v120 dst_sel:DWORD dst_unused:UNUSED_PAD src0_sel:DWORD src1_sel:WORD_0
    v_lshlrev_b32_sdwa v106, 3, v120 dst_sel:DWORD dst_unused:UNUSED_PAD src0_sel:DWORD src1_sel:WORD_1
    ds_read_b64 v[104:105], v104
    ds_read_b64 v[106:107], v106
    v_mfma_f32_16x16x32_bf16 v[112:115], v[84:87], v[188:191], v[112:115]
    v_lshlrev_b32_sdwa v108, 3, v121 dst_sel:DWORD dst_unused:UNUSED_PAD src0_sel:DWORD src1_sel:WORD_0
    v_lshlrev_b32_sdwa v110, 3, v121 dst_sel:DWORD dst_unused:UNUSED_PAD src0_sel:DWORD src1_sel:WORD_1
    ds_read_b64 v[108:109], v108
    ds_read_b64 v[110:111], v110
    s_waitcnt lgkmcnt(8)
    v_add3_u32 v42, v42, v88, v90
    v_add3_u32 v43, v43, v89, v91
    v_add3_u32 v42, v42, v92, v94
    v_add3_u32 v43, v43, v93, v95
    v_perm_b32 v112, v113, v112, s23
    v_perm_b32 v113, v115, v114, s23
    ds_write_b64 v70, v[112:113] offset:384
    v_lshlrev_b32_sdwa v88, 3, v122 dst_sel:DWORD dst_unused:UNUSED_PAD src0_sel:DWORD src1_sel:WORD_0
    v_lshlrev_b32_sdwa v90, 3, v122 dst_sel:DWORD dst_unused:UNUSED_PAD src0_sel:DWORD src1_sel:WORD_1
    ds_read_b64 v[88:89], v88
    ds_read_b64 v[90:91], v90
    v_lshlrev_b32_sdwa v92, 3, v123 dst_sel:DWORD dst_unused:UNUSED_PAD src0_sel:DWORD src1_sel:WORD_0
    v_lshlrev_b32_sdwa v94, 3, v123 dst_sel:DWORD dst_unused:UNUSED_PAD src0_sel:DWORD src1_sel:WORD_1
    ds_read_b64 v[92:93], v92
    ds_read_b64 v[94:95], v94
    buffer_load_dwordx4 v[120:123], v71, s[12:15], s20 offen offset:1024 sc1
    s_waitcnt lgkmcnt(9)
    v_add3_u32 v42, v42, v96, v98
    v_add3_u32 v43, v43, v97, v99
    v_add3_u32 v42, v42, v100, v102
    v_add3_u32 v43, v43, v101, v103
    v_mfma_f32_16x16x32_bf16 v[112:115], v[72:75], v[192:195], v[66:69]
    s_waitcnt vmcnt(2)
    v_lshlrev_b32_sdwa v96, 3, v124 dst_sel:DWORD dst_unused:UNUSED_PAD src0_sel:DWORD src1_sel:WORD_0
    v_lshlrev_b32_sdwa v98, 3, v124 dst_sel:DWORD dst_unused:UNUSED_PAD src0_sel:DWORD src1_sel:WORD_1
    ds_read_b64 v[96:97], v96
    ds_read_b64 v[98:99], v98
    v_mfma_f32_16x16x32_bf16 v[112:115], v[76:79], v[196:199], v[112:115]
    v_lshlrev_b32_sdwa v100, 3, v125 dst_sel:DWORD dst_unused:UNUSED_PAD src0_sel:DWORD src1_sel:WORD_0
    v_lshlrev_b32_sdwa v102, 3, v125 dst_sel:DWORD dst_unused:UNUSED_PAD src0_sel:DWORD src1_sel:WORD_1
    ds_read_b64 v[100:101], v100
    ds_read_b64 v[102:103], v102
    s_waitcnt lgkmcnt(9)
    v_add3_u32 v44, v44, v104, v106
    v_add3_u32 v45, v45, v105, v107
    v_add3_u32 v44, v44, v108, v110
    v_add3_u32 v45, v45, v109, v111
    v_mfma_f32_16x16x32_bf16 v[112:115], v[80:83], v[200:203], v[112:115]
    v_lshlrev_b32_sdwa v104, 3, v126 dst_sel:DWORD dst_unused:UNUSED_PAD src0_sel:DWORD src1_sel:WORD_0
    v_lshlrev_b32_sdwa v106, 3, v126 dst_sel:DWORD dst_unused:UNUSED_PAD src0_sel:DWORD src1_sel:WORD_1
    ds_read_b64 v[104:105], v104
    ds_read_b64 v[106:107], v106
    v_mfma_f32_16x16x32_bf16 v[112:115], v[84:87], v[204:207], v[112:115]
    v_lshlrev_b32_sdwa v108, 3, v127 dst_sel:DWORD dst_unused:UNUSED_PAD src0_sel:DWORD src1_sel:WORD_0
    v_lshlrev_b32_sdwa v110, 3, v127 dst_sel:DWORD dst_unused:UNUSED_PAD src0_sel:DWORD src1_sel:WORD_1
    ds_read_b64 v[108:109], v108
    ds_read_b64 v[110:111], v110
    buffer_load_dwordx4 v[124:127], v71, s[12:15], s20 offen offset:2048 sc1
    s_waitcnt lgkmcnt(8)
    v_add3_u32 v44, v44, v88, v90
    v_add3_u32 v45, v45, v89, v91
    v_add3_u32 v44, v44, v92, v94
    v_add3_u32 v45, v45, v93, v95
    v_perm_b32 v112, v113, v112, s23
    v_perm_b32 v113, v115, v114, s23
    ds_write_b64 v70, v[112:113] offset:512
    s_waitcnt vmcnt(2)
    v_lshlrev_b32_sdwa v88, 3, v116 dst_sel:DWORD dst_unused:UNUSED_PAD src0_sel:DWORD src1_sel:WORD_0
    v_lshlrev_b32_sdwa v90, 3, v116 dst_sel:DWORD dst_unused:UNUSED_PAD src0_sel:DWORD src1_sel:WORD_1
    ds_read_b64 v[88:89], v88
    ds_read_b64 v[90:91], v90
    v_lshlrev_b32_sdwa v92, 3, v117 dst_sel:DWORD dst_unused:UNUSED_PAD src0_sel:DWORD src1_sel:WORD_0
    v_lshlrev_b32_sdwa v94, 3, v117 dst_sel:DWORD dst_unused:UNUSED_PAD src0_sel:DWORD src1_sel:WORD_1
    ds_read_b64 v[92:93], v92
    ds_read_b64 v[94:95], v94
    s_waitcnt lgkmcnt(9)
    v_add3_u32 v46, v46, v96, v98
    v_add3_u32 v47, v47, v97, v99
    v_add3_u32 v46, v46, v100, v102
    v_add3_u32 v47, v47, v101, v103
    s_setprio 2
    v_mfma_f32_16x16x32_bf16 v[112:115], v[72:75], v[208:211], v[66:69]
    v_lshlrev_b32_sdwa v96, 3, v118 dst_sel:DWORD dst_unused:UNUSED_PAD src0_sel:DWORD src1_sel:WORD_0
    v_lshlrev_b32_sdwa v98, 3, v118 dst_sel:DWORD dst_unused:UNUSED_PAD src0_sel:DWORD src1_sel:WORD_1
    ds_read_b64 v[96:97], v96
    ds_read_b64 v[98:99], v98
    v_mfma_f32_16x16x32_bf16 v[112:115], v[76:79], v[212:215], v[112:115]
    v_lshlrev_b32_sdwa v100, 3, v119 dst_sel:DWORD dst_unused:UNUSED_PAD src0_sel:DWORD src1_sel:WORD_0
    v_lshlrev_b32_sdwa v102, 3, v119 dst_sel:DWORD dst_unused:UNUSED_PAD src0_sel:DWORD src1_sel:WORD_1
    ds_read_b64 v[100:101], v100
    ds_read_b64 v[102:103], v102
    buffer_load_dwordx4 v[116:119], v71, s[12:15], s20 offen offset:3072 sc1
    s_waitcnt lgkmcnt(9)
    v_add3_u32 v46, v46, v104, v106
    v_add3_u32 v47, v47, v105, v107
    v_add3_u32 v46, v46, v108, v110
    v_add3_u32 v47, v47, v109, v111
    v_mfma_f32_16x16x32_bf16 v[112:115], v[80:83], v[216:219], v[112:115]
    s_waitcnt vmcnt(2)
    v_lshlrev_b32_sdwa v104, 3, v120 dst_sel:DWORD dst_unused:UNUSED_PAD src0_sel:DWORD src1_sel:WORD_0
    v_lshlrev_b32_sdwa v106, 3, v120 dst_sel:DWORD dst_unused:UNUSED_PAD src0_sel:DWORD src1_sel:WORD_1
    ds_read_b64 v[104:105], v104
    ds_read_b64 v[106:107], v106
    v_mfma_f32_16x16x32_bf16 v[112:115], v[84:87], v[220:223], v[112:115]
    v_lshlrev_b32_sdwa v108, 3, v121 dst_sel:DWORD dst_unused:UNUSED_PAD src0_sel:DWORD src1_sel:WORD_0
    v_lshlrev_b32_sdwa v110, 3, v121 dst_sel:DWORD dst_unused:UNUSED_PAD src0_sel:DWORD src1_sel:WORD_1
    ds_read_b64 v[108:109], v108
    ds_read_b64 v[110:111], v110
    s_waitcnt lgkmcnt(8)
    v_add3_u32 v48, v48, v88, v90
    v_add3_u32 v49, v49, v89, v91
    v_add3_u32 v48, v48, v92, v94
    v_add3_u32 v49, v49, v93, v95
    v_perm_b32 v112, v113, v112, s23
    v_perm_b32 v113, v115, v114, s23
    ds_write_b64 v70, v[112:113] offset:640
    v_lshlrev_b32_sdwa v88, 3, v122 dst_sel:DWORD dst_unused:UNUSED_PAD src0_sel:DWORD src1_sel:WORD_0
    v_lshlrev_b32_sdwa v90, 3, v122 dst_sel:DWORD dst_unused:UNUSED_PAD src0_sel:DWORD src1_sel:WORD_1
    ds_read_b64 v[88:89], v88
    ds_read_b64 v[90:91], v90
    v_lshlrev_b32_sdwa v92, 3, v123 dst_sel:DWORD dst_unused:UNUSED_PAD src0_sel:DWORD src1_sel:WORD_0
    v_lshlrev_b32_sdwa v94, 3, v123 dst_sel:DWORD dst_unused:UNUSED_PAD src0_sel:DWORD src1_sel:WORD_1
    ds_read_b64 v[92:93], v92
    ds_read_b64 v[94:95], v94
    s_add_u32 s20, s20, 0x1000
    buffer_load_dwordx4 v[120:123], v71, s[12:15], s20 offen offset:0 sc1
    s_waitcnt lgkmcnt(9)
    v_add3_u32 v48, v48, v96, v98
    v_add3_u32 v49, v49, v97, v99
    v_add3_u32 v48, v48, v100, v102
    v_add3_u32 v49, v49, v101, v103
    v_mfma_f32_16x16x32_bf16 v[112:115], v[72:75], v[224:227], v[66:69]
    s_waitcnt vmcnt(2)
    v_lshlrev_b32_sdwa v96, 3, v124 dst_sel:DWORD dst_unused:UNUSED_PAD src0_sel:DWORD src1_sel:WORD_0
    v_lshlrev_b32_sdwa v98, 3, v124 dst_sel:DWORD dst_unused:UNUSED_PAD src0_sel:DWORD src1_sel:WORD_1
    ds_read_b64 v[96:97], v96
    ds_read_b64 v[98:99], v98
    v_mfma_f32_16x16x32_bf16 v[112:115], v[76:79], v[228:231], v[112:115]
    v_lshlrev_b32_sdwa v100, 3, v125 dst_sel:DWORD dst_unused:UNUSED_PAD src0_sel:DWORD src1_sel:WORD_0
    v_lshlrev_b32_sdwa v102, 3, v125 dst_sel:DWORD dst_unused:UNUSED_PAD src0_sel:DWORD src1_sel:WORD_1
    ds_read_b64 v[100:101], v100
    ds_read_b64 v[102:103], v102
    s_waitcnt lgkmcnt(9)
    v_add3_u32 v50, v50, v104, v106
    v_add3_u32 v51, v51, v105, v107
    v_add3_u32 v50, v50, v108, v110
    v_add3_u32 v51, v51, v109, v111
    v_mfma_f32_16x16x32_bf16 v[112:115], v[80:83], v[232:235], v[112:115]
    v_lshlrev_b32_sdwa v104, 3, v126 dst_sel:DWORD dst_unused:UNUSED_PAD src0_sel:DWORD src1_sel:WORD_0
    v_lshlrev_b32_sdwa v106, 3, v126 dst_sel:DWORD dst_unused:UNUSED_PAD src0_sel:DWORD src1_sel:WORD_1
    ds_read_b64 v[104:105], v104
    ds_read_b64 v[106:107], v106
    v_mfma_f32_16x16x32_bf16 v[112:115], v[84:87], v[236:239], v[112:115]
    v_lshlrev_b32_sdwa v108, 3, v127 dst_sel:DWORD dst_unused:UNUSED_PAD src0_sel:DWORD src1_sel:WORD_0
    v_lshlrev_b32_sdwa v110, 3, v127 dst_sel:DWORD dst_unused:UNUSED_PAD src0_sel:DWORD src1_sel:WORD_1
    ds_read_b64 v[108:109], v108
    ds_read_b64 v[110:111], v110
    buffer_load_dwordx4 v[124:127], v71, s[12:15], s20 offen offset:1024 sc1
    s_waitcnt lgkmcnt(8)
    v_add3_u32 v50, v50, v88, v90
    v_add3_u32 v51, v51, v89, v91
    v_add3_u32 v50, v50, v92, v94
    v_add3_u32 v51, v51, v93, v95
    v_perm_b32 v112, v113, v112, s23
    v_perm_b32 v113, v115, v114, s23
    ds_write_b64 v70, v[112:113] offset:768
    s_waitcnt vmcnt(2)
    v_lshlrev_b32_sdwa v88, 3, v116 dst_sel:DWORD dst_unused:UNUSED_PAD src0_sel:DWORD src1_sel:WORD_0
    v_lshlrev_b32_sdwa v90, 3, v116 dst_sel:DWORD dst_unused:UNUSED_PAD src0_sel:DWORD src1_sel:WORD_1
    ds_read_b64 v[88:89], v88
    ds_read_b64 v[90:91], v90
    v_lshlrev_b32_sdwa v92, 3, v117 dst_sel:DWORD dst_unused:UNUSED_PAD src0_sel:DWORD src1_sel:WORD_0
    v_lshlrev_b32_sdwa v94, 3, v117 dst_sel:DWORD dst_unused:UNUSED_PAD src0_sel:DWORD src1_sel:WORD_1
    ds_read_b64 v[92:93], v92
    ds_read_b64 v[94:95], v94
    s_waitcnt lgkmcnt(9)
    v_add3_u32 v52, v52, v96, v98
    v_add3_u32 v53, v53, v97, v99
    v_add3_u32 v52, v52, v100, v102
    v_add3_u32 v53, v53, v101, v103
    v_mfma_f32_16x16x32_bf16 v[112:115], v[72:75], v[240:243], v[66:69]
    buffer_load_dwordx4 v[72:75], v71, s[12:15], s21 offen offset:0
    v_lshlrev_b32_sdwa v96, 3, v118 dst_sel:DWORD dst_unused:UNUSED_PAD src0_sel:DWORD src1_sel:WORD_0
    v_lshlrev_b32_sdwa v98, 3, v118 dst_sel:DWORD dst_unused:UNUSED_PAD src0_sel:DWORD src1_sel:WORD_1
    ds_read_b64 v[96:97], v96
    ds_read_b64 v[98:99], v98
    v_mfma_f32_16x16x32_bf16 v[112:115], v[76:79], v[244:247], v[112:115]
    buffer_load_dwordx4 v[76:79], v71, s[12:15], s21 offen offset:1024
    v_lshlrev_b32_sdwa v100, 3, v119 dst_sel:DWORD dst_unused:UNUSED_PAD src0_sel:DWORD src1_sel:WORD_0
    v_lshlrev_b32_sdwa v102, 3, v119 dst_sel:DWORD dst_unused:UNUSED_PAD src0_sel:DWORD src1_sel:WORD_1
    ds_read_b64 v[100:101], v100
    ds_read_b64 v[102:103], v102
    buffer_load_dwordx4 v[116:119], v71, s[12:15], s20 offen offset:2048 sc1
    s_waitcnt lgkmcnt(9)
    v_add3_u32 v52, v52, v104, v106
    v_add3_u32 v53, v53, v105, v107
    v_add3_u32 v52, v52, v108, v110
    v_add3_u32 v53, v53, v109, v111
    v_mfma_f32_16x16x32_bf16 v[112:115], v[80:83], v[248:251], v[112:115]
    buffer_load_dwordx4 v[80:83], v71, s[12:15], s19 offen offset:0
    s_waitcnt vmcnt(5)
    v_lshlrev_b32_sdwa v104, 3, v120 dst_sel:DWORD dst_unused:UNUSED_PAD src0_sel:DWORD src1_sel:WORD_0
    v_lshlrev_b32_sdwa v106, 3, v120 dst_sel:DWORD dst_unused:UNUSED_PAD src0_sel:DWORD src1_sel:WORD_1
    ds_read_b64 v[104:105], v104
    ds_read_b64 v[106:107], v106
    v_mfma_f32_16x16x32_bf16 v[112:115], v[84:87], v[252:255], v[112:115]
    buffer_load_dwordx4 v[84:87], v71, s[12:15], s19 offen offset:1024
    s_add_u32 s21, s21, 4096
    s_add_u32 s19, s19, 4096
    v_lshlrev_b32_sdwa v108, 3, v121 dst_sel:DWORD dst_unused:UNUSED_PAD src0_sel:DWORD src1_sel:WORD_0
    v_lshlrev_b32_sdwa v110, 3, v121 dst_sel:DWORD dst_unused:UNUSED_PAD src0_sel:DWORD src1_sel:WORD_1
    ds_read_b64 v[108:109], v108
    ds_read_b64 v[110:111], v110
    s_waitcnt lgkmcnt(8)
    v_add3_u32 v54, v54, v88, v90
    v_add3_u32 v55, v55, v89, v91
    v_add3_u32 v54, v54, v92, v94
    v_add3_u32 v55, v55, v93, v95
    v_perm_b32 v112, v113, v112, s23
    v_perm_b32 v113, v115, v114, s23
    ds_write_b64 v70, v[112:113] offset:896
    s_setprio 1
    v_lshlrev_b32_sdwa v88, 3, v122 dst_sel:DWORD dst_unused:UNUSED_PAD src0_sel:DWORD src1_sel:WORD_0
    v_lshlrev_b32_sdwa v90, 3, v122 dst_sel:DWORD dst_unused:UNUSED_PAD src0_sel:DWORD src1_sel:WORD_1
    ds_read_b64 v[88:89], v88
    ds_read_b64 v[90:91], v90
    v_lshlrev_b32_sdwa v92, 3, v123 dst_sel:DWORD dst_unused:UNUSED_PAD src0_sel:DWORD src1_sel:WORD_0
    v_lshlrev_b32_sdwa v94, 3, v123 dst_sel:DWORD dst_unused:UNUSED_PAD src0_sel:DWORD src1_sel:WORD_1
    ds_read_b64 v[92:93], v92
    ds_read_b64 v[94:95], v94
    buffer_load_dwordx4 v[120:123], v71, s[12:15], s20 offen offset:3072 sc1
    s_waitcnt lgkmcnt(9)
    v_add3_u32 v54, v54, v96, v98
    v_add3_u32 v55, v55, v97, v99
    v_add3_u32 v54, v54, v100, v102
    v_add3_u32 v55, v55, v101, v103
    s_waitcnt vmcnt(6)
    v_lshlrev_b32_sdwa v96, 3, v124 dst_sel:DWORD dst_unused:UNUSED_PAD src0_sel:DWORD src1_sel:WORD_0
    v_lshlrev_b32_sdwa v98, 3, v124 dst_sel:DWORD dst_unused:UNUSED_PAD src0_sel:DWORD src1_sel:WORD_1
    ds_read_b64 v[96:97], v96
    ds_read_b64 v[98:99], v98
    v_lshlrev_b32_sdwa v100, 3, v125 dst_sel:DWORD dst_unused:UNUSED_PAD src0_sel:DWORD src1_sel:WORD_0
    v_lshlrev_b32_sdwa v102, 3, v125 dst_sel:DWORD dst_unused:UNUSED_PAD src0_sel:DWORD src1_sel:WORD_1
    ds_read_b64 v[100:101], v100
    ds_read_b64 v[102:103], v102
    s_waitcnt lgkmcnt(9)
    v_add3_u32 v56, v56, v104, v106
    v_add3_u32 v57, v57, v105, v107
    v_add3_u32 v56, v56, v108, v110
    v_add3_u32 v57, v57, v109, v111
    v_lshlrev_b32_sdwa v104, 3, v126 dst_sel:DWORD dst_unused:UNUSED_PAD src0_sel:DWORD src1_sel:WORD_0
    v_lshlrev_b32_sdwa v106, 3, v126 dst_sel:DWORD dst_unused:UNUSED_PAD src0_sel:DWORD src1_sel:WORD_1
    ds_read_b64 v[104:105], v104
    ds_read_b64 v[106:107], v106
    v_lshlrev_b32_sdwa v108, 3, v127 dst_sel:DWORD dst_unused:UNUSED_PAD src0_sel:DWORD src1_sel:WORD_0
    v_lshlrev_b32_sdwa v110, 3, v127 dst_sel:DWORD dst_unused:UNUSED_PAD src0_sel:DWORD src1_sel:WORD_1
    ds_read_b64 v[108:109], v108
    ds_read_b64 v[110:111], v110
    s_add_u32 s20, s20, 0x1d000
    buffer_load_dwordx4 v[124:127], v71, s[12:15], s20 offen offset:0 sc1
    s_waitcnt lgkmcnt(8)
    v_add3_u32 v56, v56, v88, v90
    v_add3_u32 v57, v57, v89, v91
    v_add3_u32 v56, v56, v92, v94
    v_add3_u32 v57, v57, v93, v95
    s_waitcnt vmcnt(4)
    v_lshlrev_b32_sdwa v88, 3, v116 dst_sel:DWORD dst_unused:UNUSED_PAD src0_sel:DWORD src1_sel:WORD_0
    v_lshlrev_b32_sdwa v90, 3, v116 dst_sel:DWORD dst_unused:UNUSED_PAD src0_sel:DWORD src1_sel:WORD_1
    ds_read_b64 v[88:89], v88
    ds_read_b64 v[90:91], v90
    v_lshlrev_b32_sdwa v92, 3, v117 dst_sel:DWORD dst_unused:UNUSED_PAD src0_sel:DWORD src1_sel:WORD_0
    v_lshlrev_b32_sdwa v94, 3, v117 dst_sel:DWORD dst_unused:UNUSED_PAD src0_sel:DWORD src1_sel:WORD_1
    ds_read_b64 v[92:93], v92
    ds_read_b64 v[94:95], v94
    s_waitcnt lgkmcnt(8)
    v_add3_u32 v58, v58, v96, v98
    v_add3_u32 v59, v59, v97, v99
    v_add3_u32 v58, v58, v100, v102
    v_add3_u32 v59, v59, v101, v103
    v_lshlrev_b32_sdwa v96, 3, v118 dst_sel:DWORD dst_unused:UNUSED_PAD src0_sel:DWORD src1_sel:WORD_0
    v_lshlrev_b32_sdwa v98, 3, v118 dst_sel:DWORD dst_unused:UNUSED_PAD src0_sel:DWORD src1_sel:WORD_1
    ds_read_b64 v[96:97], v96
    ds_read_b64 v[98:99], v98
    v_lshlrev_b32_sdwa v100, 3, v119 dst_sel:DWORD dst_unused:UNUSED_PAD src0_sel:DWORD src1_sel:WORD_0
    v_lshlrev_b32_sdwa v102, 3, v119 dst_sel:DWORD dst_unused:UNUSED_PAD src0_sel:DWORD src1_sel:WORD_1
    ds_read_b64 v[100:101], v100
    ds_read_b64 v[102:103], v102
    buffer_load_dwordx4 v[116:119], v71, s[12:15], s20 offen offset:1024 sc1
    s_waitcnt lgkmcnt(8)
    v_add3_u32 v58, v58, v104, v106
    v_add3_u32 v59, v59, v105, v107
    v_add3_u32 v58, v58, v108, v110
    v_add3_u32 v59, v59, v109, v111
    s_waitcnt vmcnt(2)
    v_lshlrev_b32_sdwa v104, 3, v120 dst_sel:DWORD dst_unused:UNUSED_PAD src0_sel:DWORD src1_sel:WORD_0
    v_lshlrev_b32_sdwa v106, 3, v120 dst_sel:DWORD dst_unused:UNUSED_PAD src0_sel:DWORD src1_sel:WORD_1
    ds_read_b64 v[104:105], v104
    ds_read_b64 v[106:107], v106
    v_lshlrev_b32_sdwa v108, 3, v121 dst_sel:DWORD dst_unused:UNUSED_PAD src0_sel:DWORD src1_sel:WORD_0
    v_lshlrev_b32_sdwa v110, 3, v121 dst_sel:DWORD dst_unused:UNUSED_PAD src0_sel:DWORD src1_sel:WORD_1
    ds_read_b64 v[108:109], v108
    ds_read_b64 v[110:111], v110
    s_waitcnt lgkmcnt(8)
    v_add3_u32 v60, v60, v88, v90
    v_add3_u32 v61, v61, v89, v91
    v_add3_u32 v60, v60, v92, v94
    v_add3_u32 v61, v61, v93, v95
    s_setprio 0
    v_lshlrev_b32_sdwa v88, 3, v122 dst_sel:DWORD dst_unused:UNUSED_PAD src0_sel:DWORD src1_sel:WORD_0
    v_lshlrev_b32_sdwa v90, 3, v122 dst_sel:DWORD dst_unused:UNUSED_PAD src0_sel:DWORD src1_sel:WORD_1
    ds_read_b64 v[88:89], v88
    ds_read_b64 v[90:91], v90
    v_lshlrev_b32_sdwa v92, 3, v123 dst_sel:DWORD dst_unused:UNUSED_PAD src0_sel:DWORD src1_sel:WORD_0
    v_lshlrev_b32_sdwa v94, 3, v123 dst_sel:DWORD dst_unused:UNUSED_PAD src0_sel:DWORD src1_sel:WORD_1
    ds_read_b64 v[92:93], v92
    ds_read_b64 v[94:95], v94
    buffer_load_dwordx4 v[120:123], v71, s[12:15], s20 offen offset:2048 sc1
    s_waitcnt lgkmcnt(8)
    v_add3_u32 v60, v60, v96, v98
    v_add3_u32 v61, v61, v97, v99
    v_add3_u32 v60, v60, v100, v102
    v_add3_u32 v61, v61, v101, v103
    s_waitcnt vmcnt(2)
    v_lshlrev_b32_sdwa v96, 3, v126 dst_sel:DWORD dst_unused:UNUSED_PAD src0_sel:DWORD src1_sel:WORD_0
    v_lshlrev_b32_sdwa v98, 3, v126 dst_sel:DWORD dst_unused:UNUSED_PAD src0_sel:DWORD src1_sel:WORD_1
    ds_read_b64 v[96:97], v96
    ds_read_b64 v[98:99], v98
    v_lshlrev_b32_sdwa v100, 3, v127 dst_sel:DWORD dst_unused:UNUSED_PAD src0_sel:DWORD src1_sel:WORD_0
    v_lshlrev_b32_sdwa v102, 3, v127 dst_sel:DWORD dst_unused:UNUSED_PAD src0_sel:DWORD src1_sel:WORD_1
    ds_read_b64 v[100:101], v100
    ds_read_b64 v[102:103], v102
    s_waitcnt lgkmcnt(8)
    v_add3_u32 v62, v62, v104, v106
    v_add3_u32 v63, v63, v105, v107
    v_add3_u32 v62, v62, v108, v110
    v_add3_u32 v63, v63, v109, v111
    s_barrier
    s_setprio 3
    v_lshlrev_b32_sdwa v104, 3, v124 dst_sel:DWORD dst_unused:UNUSED_PAD src0_sel:DWORD src1_sel:WORD_0
    v_lshlrev_b32_sdwa v106, 3, v124 dst_sel:DWORD dst_unused:UNUSED_PAD src0_sel:DWORD src1_sel:WORD_1
    ds_read_b64 v[104:105], v104
    ds_read_b64 v[106:107], v106
    v_lshlrev_b32_sdwa v108, 3, v125 dst_sel:DWORD dst_unused:UNUSED_PAD src0_sel:DWORD src1_sel:WORD_0
    v_lshlrev_b32_sdwa v110, 3, v125 dst_sel:DWORD dst_unused:UNUSED_PAD src0_sel:DWORD src1_sel:WORD_1
    ds_read_b64 v[108:109], v108
    ds_read_b64 v[110:111], v110
    buffer_load_dwordx4 v[124:127], v71, s[12:15], s20 offen offset:3072 sc1
    s_waitcnt lgkmcnt(8)
    v_add3_u32 v62, v62, v88, v90
    v_add3_u32 v63, v63, v89, v91
    v_add3_u32 v62, v62, v92, v94
    v_add3_u32 v63, v63, v93, v95
    v_mfma_f32_16x16x32_bf16 v[112:115], v[72:75], v[128:131], v[66:69]
    s_waitcnt vmcnt(2)
    v_lshlrev_b32_sdwa v88, 3, v118 dst_sel:DWORD dst_unused:UNUSED_PAD src0_sel:DWORD src1_sel:WORD_0
    v_lshlrev_b32_sdwa v90, 3, v118 dst_sel:DWORD dst_unused:UNUSED_PAD src0_sel:DWORD src1_sel:WORD_1
    ds_read_b64 v[88:89], v88
    ds_read_b64 v[90:91], v90
    v_mfma_f32_16x16x32_bf16 v[112:115], v[76:79], v[132:135], v[112:115]
    v_lshlrev_b32_sdwa v92, 3, v119 dst_sel:DWORD dst_unused:UNUSED_PAD src0_sel:DWORD src1_sel:WORD_0
    v_lshlrev_b32_sdwa v94, 3, v119 dst_sel:DWORD dst_unused:UNUSED_PAD src0_sel:DWORD src1_sel:WORD_1
    ds_read_b64 v[92:93], v92
    ds_read_b64 v[94:95], v94
    s_waitcnt lgkmcnt(8)
    v_add3_u32 v0, v0, v96, v98
    v_add3_u32 v1, v1, v97, v99
    v_add3_u32 v0, v0, v100, v102
    v_add3_u32 v1, v1, v101, v103
    v_mfma_f32_16x16x32_bf16 v[112:115], v[80:83], v[136:139], v[112:115]
    v_lshlrev_b32_sdwa v96, 3, v116 dst_sel:DWORD dst_unused:UNUSED_PAD src0_sel:DWORD src1_sel:WORD_0
    v_lshlrev_b32_sdwa v98, 3, v116 dst_sel:DWORD dst_unused:UNUSED_PAD src0_sel:DWORD src1_sel:WORD_1
    ds_read_b64 v[96:97], v96
    ds_read_b64 v[98:99], v98
    v_mfma_f32_16x16x32_bf16 v[112:115], v[84:87], v[140:143], v[112:115]
    v_lshlrev_b32_sdwa v100, 3, v117 dst_sel:DWORD dst_unused:UNUSED_PAD src0_sel:DWORD src1_sel:WORD_0
    v_lshlrev_b32_sdwa v102, 3, v117 dst_sel:DWORD dst_unused:UNUSED_PAD src0_sel:DWORD src1_sel:WORD_1
    ds_read_b64 v[100:101], v100
    ds_read_b64 v[102:103], v102
    s_add_u32 s20, s20, 0x1000
    buffer_load_dwordx4 v[116:119], v71, s[12:15], s20 offen offset:0 sc1
    s_waitcnt lgkmcnt(8)
    v_add3_u32 v0, v0, v104, v106
    v_add3_u32 v1, v1, v105, v107
    v_add3_u32 v0, v0, v108, v110
    v_add3_u32 v1, v1, v109, v111
    v_perm_b32 v112, v113, v112, s23
    v_perm_b32 v113, v115, v114, s23
    ds_write_b64 v70, v[112:113] offset:32768
    s_waitcnt vmcnt(2)
    v_lshlrev_b32_sdwa v104, 3, v122 dst_sel:DWORD dst_unused:UNUSED_PAD src0_sel:DWORD src1_sel:WORD_0
    v_lshlrev_b32_sdwa v106, 3, v122 dst_sel:DWORD dst_unused:UNUSED_PAD src0_sel:DWORD src1_sel:WORD_1
    ds_read_b64 v[104:105], v104
    ds_read_b64 v[106:107], v106
    v_lshlrev_b32_sdwa v108, 3, v123 dst_sel:DWORD dst_unused:UNUSED_PAD src0_sel:DWORD src1_sel:WORD_0
    v_lshlrev_b32_sdwa v110, 3, v123 dst_sel:DWORD dst_unused:UNUSED_PAD src0_sel:DWORD src1_sel:WORD_1
    ds_read_b64 v[108:109], v108
    ds_read_b64 v[110:111], v110
    s_waitcnt lgkmcnt(9)
    v_add3_u32 v2, v2, v88, v90
    v_add3_u32 v3, v3, v89, v91
    v_add3_u32 v2, v2, v92, v94
    v_add3_u32 v3, v3, v93, v95
    v_mfma_f32_16x16x32_bf16 v[112:115], v[72:75], v[144:147], v[66:69]
    v_lshlrev_b32_sdwa v88, 3, v120 dst_sel:DWORD dst_unused:UNUSED_PAD src0_sel:DWORD src1_sel:WORD_0
    v_lshlrev_b32_sdwa v90, 3, v120 dst_sel:DWORD dst_unused:UNUSED_PAD src0_sel:DWORD src1_sel:WORD_1
    ds_read_b64 v[88:89], v88
    ds_read_b64 v[90:91], v90
    v_mfma_f32_16x16x32_bf16 v[112:115], v[76:79], v[148:151], v[112:115]
    v_lshlrev_b32_sdwa v92, 3, v121 dst_sel:DWORD dst_unused:UNUSED_PAD src0_sel:DWORD src1_sel:WORD_0
    v_lshlrev_b32_sdwa v94, 3, v121 dst_sel:DWORD dst_unused:UNUSED_PAD src0_sel:DWORD src1_sel:WORD_1
    ds_read_b64 v[92:93], v92
    ds_read_b64 v[94:95], v94
    buffer_load_dwordx4 v[120:123], v71, s[12:15], s20 offen offset:1024 sc1
    s_waitcnt lgkmcnt(9)
    v_add3_u32 v2, v2, v96, v98
    v_add3_u32 v3, v3, v97, v99
    v_add3_u32 v2, v2, v100, v102
    v_add3_u32 v3, v3, v101, v103
    v_mfma_f32_16x16x32_bf16 v[112:115], v[80:83], v[152:155], v[112:115]
    s_waitcnt vmcnt(2)
    v_lshlrev_b32_sdwa v96, 3, v126 dst_sel:DWORD dst_unused:UNUSED_PAD src0_sel:DWORD src1_sel:WORD_0
    v_lshlrev_b32_sdwa v98, 3, v126 dst_sel:DWORD dst_unused:UNUSED_PAD src0_sel:DWORD src1_sel:WORD_1
    ds_read_b64 v[96:97], v96
    ds_read_b64 v[98:99], v98
    v_mfma_f32_16x16x32_bf16 v[112:115], v[84:87], v[156:159], v[112:115]
    v_lshlrev_b32_sdwa v100, 3, v127 dst_sel:DWORD dst_unused:UNUSED_PAD src0_sel:DWORD src1_sel:WORD_0
    v_lshlrev_b32_sdwa v102, 3, v127 dst_sel:DWORD dst_unused:UNUSED_PAD src0_sel:DWORD src1_sel:WORD_1
    ds_read_b64 v[100:101], v100
    ds_read_b64 v[102:103], v102
    s_waitcnt lgkmcnt(8)
    v_add3_u32 v4, v4, v104, v106
    v_add3_u32 v5, v5, v105, v107
    v_add3_u32 v4, v4, v108, v110
    v_add3_u32 v5, v5, v109, v111
    v_perm_b32 v112, v113, v112, s23
    v_perm_b32 v113, v115, v114, s23
    ds_write_b64 v70, v[112:113] offset:32896
    v_lshlrev_b32_sdwa v104, 3, v124 dst_sel:DWORD dst_unused:UNUSED_PAD src0_sel:DWORD src1_sel:WORD_0
    v_lshlrev_b32_sdwa v106, 3, v124 dst_sel:DWORD dst_unused:UNUSED_PAD src0_sel:DWORD src1_sel:WORD_1
    ds_read_b64 v[104:105], v104
    ds_read_b64 v[106:107], v106
    v_lshlrev_b32_sdwa v108, 3, v125 dst_sel:DWORD dst_unused:UNUSED_PAD src0_sel:DWORD src1_sel:WORD_0
    v_lshlrev_b32_sdwa v110, 3, v125 dst_sel:DWORD dst_unused:UNUSED_PAD src0_sel:DWORD src1_sel:WORD_1
    ds_read_b64 v[108:109], v108
    ds_read_b64 v[110:111], v110
    buffer_load_dwordx4 v[124:127], v71, s[12:15], s20 offen offset:2048 sc1
    s_waitcnt lgkmcnt(9)
    v_add3_u32 v4, v4, v88, v90
    v_add3_u32 v5, v5, v89, v91
    v_add3_u32 v4, v4, v92, v94
    v_add3_u32 v5, v5, v93, v95
    v_mfma_f32_16x16x32_bf16 v[112:115], v[72:75], v[160:163], v[66:69]
    s_waitcnt vmcnt(2)
    v_lshlrev_b32_sdwa v88, 3, v118 dst_sel:DWORD dst_unused:UNUSED_PAD src0_sel:DWORD src1_sel:WORD_0
    v_lshlrev_b32_sdwa v90, 3, v118 dst_sel:DWORD dst_unused:UNUSED_PAD src0_sel:DWORD src1_sel:WORD_1
    ds_read_b64 v[88:89], v88
    ds_read_b64 v[90:91], v90
    v_mfma_f32_16x16x32_bf16 v[112:115], v[76:79], v[164:167], v[112:115]
    v_lshlrev_b32_sdwa v92, 3, v119 dst_sel:DWORD dst_unused:UNUSED_PAD src0_sel:DWORD src1_sel:WORD_0
    v_lshlrev_b32_sdwa v94, 3, v119 dst_sel:DWORD dst_unused:UNUSED_PAD src0_sel:DWORD src1_sel:WORD_1
    ds_read_b64 v[92:93], v92
    ds_read_b64 v[94:95], v94
    s_waitcnt lgkmcnt(9)
    v_add3_u32 v6, v6, v96, v98
    v_add3_u32 v7, v7, v97, v99
    v_add3_u32 v6, v6, v100, v102
    v_add3_u32 v7, v7, v101, v103
    v_mfma_f32_16x16x32_bf16 v[112:115], v[80:83], v[168:171], v[112:115]
    v_lshlrev_b32_sdwa v96, 3, v116 dst_sel:DWORD dst_unused:UNUSED_PAD src0_sel:DWORD src1_sel:WORD_0
    v_lshlrev_b32_sdwa v98, 3, v116 dst_sel:DWORD dst_unused:UNUSED_PAD src0_sel:DWORD src1_sel:WORD_1
    ds_read_b64 v[96:97], v96
    ds_read_b64 v[98:99], v98
    v_mfma_f32_16x16x32_bf16 v[112:115], v[84:87], v[172:175], v[112:115]
    v_lshlrev_b32_sdwa v100, 3, v117 dst_sel:DWORD dst_unused:UNUSED_PAD src0_sel:DWORD src1_sel:WORD_0
    v_lshlrev_b32_sdwa v102, 3, v117 dst_sel:DWORD dst_unused:UNUSED_PAD src0_sel:DWORD src1_sel:WORD_1
    ds_read_b64 v[100:101], v100
    ds_read_b64 v[102:103], v102
    buffer_load_dwordx4 v[116:119], v71, s[12:15], s20 offen offset:3072 sc1
    s_waitcnt lgkmcnt(8)
    v_add3_u32 v6, v6, v104, v106
    v_add3_u32 v7, v7, v105, v107
    v_add3_u32 v6, v6, v108, v110
    v_add3_u32 v7, v7, v109, v111
    v_perm_b32 v112, v113, v112, s23
    v_perm_b32 v113, v115, v114, s23
    ds_write_b64 v70, v[112:113] offset:33024
    s_waitcnt vmcnt(2)
    v_lshlrev_b32_sdwa v104, 3, v122 dst_sel:DWORD dst_unused:UNUSED_PAD src0_sel:DWORD src1_sel:WORD_0
    v_lshlrev_b32_sdwa v106, 3, v122 dst_sel:DWORD dst_unused:UNUSED_PAD src0_sel:DWORD src1_sel:WORD_1
    ds_read_b64 v[104:105], v104
    ds_read_b64 v[106:107], v106
    v_lshlrev_b32_sdwa v108, 3, v123 dst_sel:DWORD dst_unused:UNUSED_PAD src0_sel:DWORD src1_sel:WORD_0
    v_lshlrev_b32_sdwa v110, 3, v123 dst_sel:DWORD dst_unused:UNUSED_PAD src0_sel:DWORD src1_sel:WORD_1
    ds_read_b64 v[108:109], v108
    ds_read_b64 v[110:111], v110
    s_waitcnt lgkmcnt(9)
    v_add3_u32 v8, v8, v88, v90
    v_add3_u32 v9, v9, v89, v91
    v_add3_u32 v8, v8, v92, v94
    v_add3_u32 v9, v9, v93, v95
    v_mfma_f32_16x16x32_bf16 v[112:115], v[72:75], v[176:179], v[66:69]
    v_lshlrev_b32_sdwa v88, 3, v120 dst_sel:DWORD dst_unused:UNUSED_PAD src0_sel:DWORD src1_sel:WORD_0
    v_lshlrev_b32_sdwa v90, 3, v120 dst_sel:DWORD dst_unused:UNUSED_PAD src0_sel:DWORD src1_sel:WORD_1
    ds_read_b64 v[88:89], v88
    ds_read_b64 v[90:91], v90
    v_mfma_f32_16x16x32_bf16 v[112:115], v[76:79], v[180:183], v[112:115]
    v_lshlrev_b32_sdwa v92, 3, v121 dst_sel:DWORD dst_unused:UNUSED_PAD src0_sel:DWORD src1_sel:WORD_0
    v_lshlrev_b32_sdwa v94, 3, v121 dst_sel:DWORD dst_unused:UNUSED_PAD src0_sel:DWORD src1_sel:WORD_1
    ds_read_b64 v[92:93], v92
    ds_read_b64 v[94:95], v94
    s_add_u32 s20, s20, 0x1000
    buffer_load_dwordx4 v[120:123], v71, s[12:15], s20 offen offset:0 sc1
    s_waitcnt lgkmcnt(9)
    v_add3_u32 v8, v8, v96, v98
    v_add3_u32 v9, v9, v97, v99
    v_add3_u32 v8, v8, v100, v102
    v_add3_u32 v9, v9, v101, v103
    v_mfma_f32_16x16x32_bf16 v[112:115], v[80:83], v[184:187], v[112:115]
    s_waitcnt vmcnt(2)
    v_lshlrev_b32_sdwa v96, 3, v126 dst_sel:DWORD dst_unused:UNUSED_PAD src0_sel:DWORD src1_sel:WORD_0
    v_lshlrev_b32_sdwa v98, 3, v126 dst_sel:DWORD dst_unused:UNUSED_PAD src0_sel:DWORD src1_sel:WORD_1
    ds_read_b64 v[96:97], v96
    ds_read_b64 v[98:99], v98
    v_mfma_f32_16x16x32_bf16 v[112:115], v[84:87], v[188:191], v[112:115]
    v_lshlrev_b32_sdwa v100, 3, v127 dst_sel:DWORD dst_unused:UNUSED_PAD src0_sel:DWORD src1_sel:WORD_0
    v_lshlrev_b32_sdwa v102, 3, v127 dst_sel:DWORD dst_unused:UNUSED_PAD src0_sel:DWORD src1_sel:WORD_1
    ds_read_b64 v[100:101], v100
    ds_read_b64 v[102:103], v102
    s_waitcnt lgkmcnt(8)
    v_add3_u32 v10, v10, v104, v106
    v_add3_u32 v11, v11, v105, v107
    v_add3_u32 v10, v10, v108, v110
    v_add3_u32 v11, v11, v109, v111
    v_perm_b32 v112, v113, v112, s23
    v_perm_b32 v113, v115, v114, s23
    ds_write_b64 v70, v[112:113] offset:33152
    v_lshlrev_b32_sdwa v104, 3, v124 dst_sel:DWORD dst_unused:UNUSED_PAD src0_sel:DWORD src1_sel:WORD_0
    v_lshlrev_b32_sdwa v106, 3, v124 dst_sel:DWORD dst_unused:UNUSED_PAD src0_sel:DWORD src1_sel:WORD_1
    ds_read_b64 v[104:105], v104
    ds_read_b64 v[106:107], v106
    v_lshlrev_b32_sdwa v108, 3, v125 dst_sel:DWORD dst_unused:UNUSED_PAD src0_sel:DWORD src1_sel:WORD_0
    v_lshlrev_b32_sdwa v110, 3, v125 dst_sel:DWORD dst_unused:UNUSED_PAD src0_sel:DWORD src1_sel:WORD_1
    ds_read_b64 v[108:109], v108
    ds_read_b64 v[110:111], v110
    buffer_load_dwordx4 v[124:127], v71, s[12:15], s20 offen offset:1024 sc1
    s_waitcnt lgkmcnt(9)
    v_add3_u32 v10, v10, v88, v90
    v_add3_u32 v11, v11, v89, v91
    v_add3_u32 v10, v10, v92, v94
    v_add3_u32 v11, v11, v93, v95
    v_mfma_f32_16x16x32_bf16 v[112:115], v[72:75], v[192:195], v[66:69]
    s_waitcnt vmcnt(2)
    v_lshlrev_b32_sdwa v88, 3, v118 dst_sel:DWORD dst_unused:UNUSED_PAD src0_sel:DWORD src1_sel:WORD_0
    v_lshlrev_b32_sdwa v90, 3, v118 dst_sel:DWORD dst_unused:UNUSED_PAD src0_sel:DWORD src1_sel:WORD_1
    ds_read_b64 v[88:89], v88
    ds_read_b64 v[90:91], v90
    v_mfma_f32_16x16x32_bf16 v[112:115], v[76:79], v[196:199], v[112:115]
    v_lshlrev_b32_sdwa v92, 3, v119 dst_sel:DWORD dst_unused:UNUSED_PAD src0_sel:DWORD src1_sel:WORD_0
    v_lshlrev_b32_sdwa v94, 3, v119 dst_sel:DWORD dst_unused:UNUSED_PAD src0_sel:DWORD src1_sel:WORD_1
    ds_read_b64 v[92:93], v92
    ds_read_b64 v[94:95], v94
    s_waitcnt lgkmcnt(9)
    v_add3_u32 v12, v12, v96, v98
    v_add3_u32 v13, v13, v97, v99
    v_add3_u32 v12, v12, v100, v102
    v_add3_u32 v13, v13, v101, v103
    v_mfma_f32_16x16x32_bf16 v[112:115], v[80:83], v[200:203], v[112:115]
    v_lshlrev_b32_sdwa v96, 3, v116 dst_sel:DWORD dst_unused:UNUSED_PAD src0_sel:DWORD src1_sel:WORD_0
    v_lshlrev_b32_sdwa v98, 3, v116 dst_sel:DWORD dst_unused:UNUSED_PAD src0_sel:DWORD src1_sel:WORD_1
    ds_read_b64 v[96:97], v96
    ds_read_b64 v[98:99], v98
    v_mfma_f32_16x16x32_bf16 v[112:115], v[84:87], v[204:207], v[112:115]
    v_lshlrev_b32_sdwa v100, 3, v117 dst_sel:DWORD dst_unused:UNUSED_PAD src0_sel:DWORD src1_sel:WORD_0
    v_lshlrev_b32_sdwa v102, 3, v117 dst_sel:DWORD dst_unused:UNUSED_PAD src0_sel:DWORD src1_sel:WORD_1
    ds_read_b64 v[100:101], v100
    ds_read_b64 v[102:103], v102
    buffer_load_dwordx4 v[116:119], v71, s[12:15], s20 offen offset:2048 sc1
    s_waitcnt lgkmcnt(8)
    v_add3_u32 v12, v12, v104, v106
    v_add3_u32 v13, v13, v105, v107
    v_add3_u32 v12, v12, v108, v110
    v_add3_u32 v13, v13, v109, v111
    v_perm_b32 v112, v113, v112, s23
    v_perm_b32 v113, v115, v114, s23
    ds_write_b64 v70, v[112:113] offset:33280
    s_waitcnt vmcnt(2)
    v_lshlrev_b32_sdwa v104, 3, v122 dst_sel:DWORD dst_unused:UNUSED_PAD src0_sel:DWORD src1_sel:WORD_0
    v_lshlrev_b32_sdwa v106, 3, v122 dst_sel:DWORD dst_unused:UNUSED_PAD src0_sel:DWORD src1_sel:WORD_1
    ds_read_b64 v[104:105], v104
    ds_read_b64 v[106:107], v106
    v_lshlrev_b32_sdwa v108, 3, v123 dst_sel:DWORD dst_unused:UNUSED_PAD src0_sel:DWORD src1_sel:WORD_0
    v_lshlrev_b32_sdwa v110, 3, v123 dst_sel:DWORD dst_unused:UNUSED_PAD src0_sel:DWORD src1_sel:WORD_1
    ds_read_b64 v[108:109], v108
    ds_read_b64 v[110:111], v110
    s_waitcnt lgkmcnt(9)
    v_add3_u32 v14, v14, v88, v90
    v_add3_u32 v15, v15, v89, v91
    v_add3_u32 v14, v14, v92, v94
    v_add3_u32 v15, v15, v93, v95
    s_setprio 2
    v_mfma_f32_16x16x32_bf16 v[112:115], v[72:75], v[208:211], v[66:69]
    v_lshlrev_b32_sdwa v88, 3, v120 dst_sel:DWORD dst_unused:UNUSED_PAD src0_sel:DWORD src1_sel:WORD_0
    v_lshlrev_b32_sdwa v90, 3, v120 dst_sel:DWORD dst_unused:UNUSED_PAD src0_sel:DWORD src1_sel:WORD_1
    ds_read_b64 v[88:89], v88
    ds_read_b64 v[90:91], v90
    v_mfma_f32_16x16x32_bf16 v[112:115], v[76:79], v[212:215], v[112:115]
    v_lshlrev_b32_sdwa v92, 3, v121 dst_sel:DWORD dst_unused:UNUSED_PAD src0_sel:DWORD src1_sel:WORD_0
    v_lshlrev_b32_sdwa v94, 3, v121 dst_sel:DWORD dst_unused:UNUSED_PAD src0_sel:DWORD src1_sel:WORD_1
    ds_read_b64 v[92:93], v92
    ds_read_b64 v[94:95], v94
    buffer_load_dwordx4 v[120:123], v71, s[12:15], s20 offen offset:3072 sc1
    s_waitcnt lgkmcnt(9)
    v_add3_u32 v14, v14, v96, v98
    v_add3_u32 v15, v15, v97, v99
    v_add3_u32 v14, v14, v100, v102
    v_add3_u32 v15, v15, v101, v103
    v_mfma_f32_16x16x32_bf16 v[112:115], v[80:83], v[216:219], v[112:115]
    s_waitcnt vmcnt(2)
    v_lshlrev_b32_sdwa v96, 3, v126 dst_sel:DWORD dst_unused:UNUSED_PAD src0_sel:DWORD src1_sel:WORD_0
    v_lshlrev_b32_sdwa v98, 3, v126 dst_sel:DWORD dst_unused:UNUSED_PAD src0_sel:DWORD src1_sel:WORD_1
    ds_read_b64 v[96:97], v96
    ds_read_b64 v[98:99], v98
    v_mfma_f32_16x16x32_bf16 v[112:115], v[84:87], v[220:223], v[112:115]
    v_lshlrev_b32_sdwa v100, 3, v127 dst_sel:DWORD dst_unused:UNUSED_PAD src0_sel:DWORD src1_sel:WORD_0
    v_lshlrev_b32_sdwa v102, 3, v127 dst_sel:DWORD dst_unused:UNUSED_PAD src0_sel:DWORD src1_sel:WORD_1
    ds_read_b64 v[100:101], v100
    ds_read_b64 v[102:103], v102
    s_waitcnt lgkmcnt(8)
    v_add3_u32 v16, v16, v104, v106
    v_add3_u32 v17, v17, v105, v107
    v_add3_u32 v16, v16, v108, v110
    v_add3_u32 v17, v17, v109, v111
    v_perm_b32 v112, v113, v112, s23
    v_perm_b32 v113, v115, v114, s23
    ds_write_b64 v70, v[112:113] offset:33408
    v_lshlrev_b32_sdwa v104, 3, v124 dst_sel:DWORD dst_unused:UNUSED_PAD src0_sel:DWORD src1_sel:WORD_0
    v_lshlrev_b32_sdwa v106, 3, v124 dst_sel:DWORD dst_unused:UNUSED_PAD src0_sel:DWORD src1_sel:WORD_1
    ds_read_b64 v[104:105], v104
    ds_read_b64 v[106:107], v106
    v_lshlrev_b32_sdwa v108, 3, v125 dst_sel:DWORD dst_unused:UNUSED_PAD src0_sel:DWORD src1_sel:WORD_0
    v_lshlrev_b32_sdwa v110, 3, v125 dst_sel:DWORD dst_unused:UNUSED_PAD src0_sel:DWORD src1_sel:WORD_1
    ds_read_b64 v[108:109], v108
    ds_read_b64 v[110:111], v110
    s_add_u32 s20, s20, 0x1000
    buffer_load_dwordx4 v[124:127], v71, s[12:15], s20 offen offset:0 sc1
    s_waitcnt lgkmcnt(9)
    v_add3_u32 v16, v16, v88, v90
    v_add3_u32 v17, v17, v89, v91
    v_add3_u32 v16, v16, v92, v94
    v_add3_u32 v17, v17, v93, v95
    v_mfma_f32_16x16x32_bf16 v[112:115], v[72:75], v[224:227], v[66:69]
    s_waitcnt vmcnt(2)
    v_lshlrev_b32_sdwa v88, 3, v118 dst_sel:DWORD dst_unused:UNUSED_PAD src0_sel:DWORD src1_sel:WORD_0
    v_lshlrev_b32_sdwa v90, 3, v118 dst_sel:DWORD dst_unused:UNUSED_PAD src0_sel:DWORD src1_sel:WORD_1
    ds_read_b64 v[88:89], v88
    ds_read_b64 v[90:91], v90
    v_mfma_f32_16x16x32_bf16 v[112:115], v[76:79], v[228:231], v[112:115]
    v_lshlrev_b32_sdwa v92, 3, v119 dst_sel:DWORD dst_unused:UNUSED_PAD src0_sel:DWORD src1_sel:WORD_0
    v_lshlrev_b32_sdwa v94, 3, v119 dst_sel:DWORD dst_unused:UNUSED_PAD src0_sel:DWORD src1_sel:WORD_1
    ds_read_b64 v[92:93], v92
    ds_read_b64 v[94:95], v94
    s_waitcnt lgkmcnt(9)
    v_add3_u32 v18, v18, v96, v98
    v_add3_u32 v19, v19, v97, v99
    v_add3_u32 v18, v18, v100, v102
    v_add3_u32 v19, v19, v101, v103
    v_mfma_f32_16x16x32_bf16 v[112:115], v[80:83], v[232:235], v[112:115]
    v_lshlrev_b32_sdwa v96, 3, v116 dst_sel:DWORD dst_unused:UNUSED_PAD src0_sel:DWORD src1_sel:WORD_0
    v_lshlrev_b32_sdwa v98, 3, v116 dst_sel:DWORD dst_unused:UNUSED_PAD src0_sel:DWORD src1_sel:WORD_1
    ds_read_b64 v[96:97], v96
    ds_read_b64 v[98:99], v98
    v_mfma_f32_16x16x32_bf16 v[112:115], v[84:87], v[236:239], v[112:115]
    v_lshlrev_b32_sdwa v100, 3, v117 dst_sel:DWORD dst_unused:UNUSED_PAD src0_sel:DWORD src1_sel:WORD_0
    v_lshlrev_b32_sdwa v102, 3, v117 dst_sel:DWORD dst_unused:UNUSED_PAD src0_sel:DWORD src1_sel:WORD_1
    ds_read_b64 v[100:101], v100
    ds_read_b64 v[102:103], v102
    buffer_load_dwordx4 v[116:119], v71, s[12:15], s20 offen offset:1024 sc1
    s_waitcnt lgkmcnt(8)
    v_add3_u32 v18, v18, v104, v106
    v_add3_u32 v19, v19, v105, v107
    v_add3_u32 v18, v18, v108, v110
    v_add3_u32 v19, v19, v109, v111
    v_perm_b32 v112, v113, v112, s23
    v_perm_b32 v113, v115, v114, s23
    ds_write_b64 v70, v[112:113] offset:33536
    s_waitcnt vmcnt(2)
    v_lshlrev_b32_sdwa v104, 3, v122 dst_sel:DWORD dst_unused:UNUSED_PAD src0_sel:DWORD src1_sel:WORD_0
    v_lshlrev_b32_sdwa v106, 3, v122 dst_sel:DWORD dst_unused:UNUSED_PAD src0_sel:DWORD src1_sel:WORD_1
    ds_read_b64 v[104:105], v104
    ds_read_b64 v[106:107], v106
    v_lshlrev_b32_sdwa v108, 3, v123 dst_sel:DWORD dst_unused:UNUSED_PAD src0_sel:DWORD src1_sel:WORD_0
    v_lshlrev_b32_sdwa v110, 3, v123 dst_sel:DWORD dst_unused:UNUSED_PAD src0_sel:DWORD src1_sel:WORD_1
    ds_read_b64 v[108:109], v108
    ds_read_b64 v[110:111], v110
    s_waitcnt lgkmcnt(9)
    v_add3_u32 v20, v20, v88, v90
    v_add3_u32 v21, v21, v89, v91
    v_add3_u32 v20, v20, v92, v94
    v_add3_u32 v21, v21, v93, v95
    v_mfma_f32_16x16x32_bf16 v[112:115], v[72:75], v[240:243], v[66:69]
    buffer_load_dwordx4 v[72:75], v71, s[12:15], s21 offen offset:0
    v_lshlrev_b32_sdwa v88, 3, v120 dst_sel:DWORD dst_unused:UNUSED_PAD src0_sel:DWORD src1_sel:WORD_0
    v_lshlrev_b32_sdwa v90, 3, v120 dst_sel:DWORD dst_unused:UNUSED_PAD src0_sel:DWORD src1_sel:WORD_1
    ds_read_b64 v[88:89], v88
    ds_read_b64 v[90:91], v90
    v_mfma_f32_16x16x32_bf16 v[112:115], v[76:79], v[244:247], v[112:115]
    buffer_load_dwordx4 v[76:79], v71, s[12:15], s21 offen offset:1024
    v_lshlrev_b32_sdwa v92, 3, v121 dst_sel:DWORD dst_unused:UNUSED_PAD src0_sel:DWORD src1_sel:WORD_0
    v_lshlrev_b32_sdwa v94, 3, v121 dst_sel:DWORD dst_unused:UNUSED_PAD src0_sel:DWORD src1_sel:WORD_1
    ds_read_b64 v[92:93], v92
    ds_read_b64 v[94:95], v94
    buffer_load_dwordx4 v[120:123], v71, s[12:15], s20 offen offset:2048 sc1
    s_waitcnt lgkmcnt(9)
    v_add3_u32 v20, v20, v96, v98
    v_add3_u32 v21, v21, v97, v99
    v_add3_u32 v20, v20, v100, v102
    v_add3_u32 v21, v21, v101, v103
    v_mfma_f32_16x16x32_bf16 v[112:115], v[80:83], v[248:251], v[112:115]
    buffer_load_dwordx4 v[80:83], v71, s[12:15], s19 offen offset:0
    s_waitcnt vmcnt(5)
    v_lshlrev_b32_sdwa v96, 3, v126 dst_sel:DWORD dst_unused:UNUSED_PAD src0_sel:DWORD src1_sel:WORD_0
    v_lshlrev_b32_sdwa v98, 3, v126 dst_sel:DWORD dst_unused:UNUSED_PAD src0_sel:DWORD src1_sel:WORD_1
    ds_read_b64 v[96:97], v96
    ds_read_b64 v[98:99], v98
    v_mfma_f32_16x16x32_bf16 v[112:115], v[84:87], v[252:255], v[112:115]
    buffer_load_dwordx4 v[84:87], v71, s[12:15], s19 offen offset:1024
    s_add_u32 s21, s21, 4096
    s_add_u32 s19, s19, 4096
    v_lshlrev_b32_sdwa v100, 3, v127 dst_sel:DWORD dst_unused:UNUSED_PAD src0_sel:DWORD src1_sel:WORD_0
    v_lshlrev_b32_sdwa v102, 3, v127 dst_sel:DWORD dst_unused:UNUSED_PAD src0_sel:DWORD src1_sel:WORD_1
    ds_read_b64 v[100:101], v100
    ds_read_b64 v[102:103], v102
    s_waitcnt lgkmcnt(8)
    v_add3_u32 v22, v22, v104, v106
    v_add3_u32 v23, v23, v105, v107
    v_add3_u32 v22, v22, v108, v110
    v_add3_u32 v23, v23, v109, v111
    v_perm_b32 v112, v113, v112, s23
    v_perm_b32 v113, v115, v114, s23
    ds_write_b64 v70, v[112:113] offset:33664
    s_setprio 1
    v_lshlrev_b32_sdwa v104, 3, v124 dst_sel:DWORD dst_unused:UNUSED_PAD src0_sel:DWORD src1_sel:WORD_0
    v_lshlrev_b32_sdwa v106, 3, v124 dst_sel:DWORD dst_unused:UNUSED_PAD src0_sel:DWORD src1_sel:WORD_1
    ds_read_b64 v[104:105], v104
    ds_read_b64 v[106:107], v106
    v_lshlrev_b32_sdwa v108, 3, v125 dst_sel:DWORD dst_unused:UNUSED_PAD src0_sel:DWORD src1_sel:WORD_0
    v_lshlrev_b32_sdwa v110, 3, v125 dst_sel:DWORD dst_unused:UNUSED_PAD src0_sel:DWORD src1_sel:WORD_1
    ds_read_b64 v[108:109], v108
    ds_read_b64 v[110:111], v110
    buffer_load_dwordx4 v[124:127], v71, s[12:15], s20 offen offset:3072 sc1
    s_waitcnt lgkmcnt(9)
    v_add3_u32 v22, v22, v88, v90
    v_add3_u32 v23, v23, v89, v91
    v_add3_u32 v22, v22, v92, v94
    v_add3_u32 v23, v23, v93, v95
    s_waitcnt vmcnt(6)
    v_lshlrev_b32_sdwa v88, 3, v118 dst_sel:DWORD dst_unused:UNUSED_PAD src0_sel:DWORD src1_sel:WORD_0
    v_lshlrev_b32_sdwa v90, 3, v118 dst_sel:DWORD dst_unused:UNUSED_PAD src0_sel:DWORD src1_sel:WORD_1
    ds_read_b64 v[88:89], v88
    ds_read_b64 v[90:91], v90
    v_lshlrev_b32_sdwa v92, 3, v119 dst_sel:DWORD dst_unused:UNUSED_PAD src0_sel:DWORD src1_sel:WORD_0
    v_lshlrev_b32_sdwa v94, 3, v119 dst_sel:DWORD dst_unused:UNUSED_PAD src0_sel:DWORD src1_sel:WORD_1
    ds_read_b64 v[92:93], v92
    ds_read_b64 v[94:95], v94
    s_waitcnt lgkmcnt(9)
    v_add3_u32 v24, v24, v96, v98
    v_add3_u32 v25, v25, v97, v99
    v_add3_u32 v24, v24, v100, v102
    v_add3_u32 v25, v25, v101, v103
    v_lshlrev_b32_sdwa v96, 3, v116 dst_sel:DWORD dst_unused:UNUSED_PAD src0_sel:DWORD src1_sel:WORD_0
    v_lshlrev_b32_sdwa v98, 3, v116 dst_sel:DWORD dst_unused:UNUSED_PAD src0_sel:DWORD src1_sel:WORD_1
    ds_read_b64 v[96:97], v96
    ds_read_b64 v[98:99], v98
    v_lshlrev_b32_sdwa v100, 3, v117 dst_sel:DWORD dst_unused:UNUSED_PAD src0_sel:DWORD src1_sel:WORD_0
    v_lshlrev_b32_sdwa v102, 3, v117 dst_sel:DWORD dst_unused:UNUSED_PAD src0_sel:DWORD src1_sel:WORD_1
    ds_read_b64 v[100:101], v100
    ds_read_b64 v[102:103], v102
    s_add_u32 s20, s20, 0x1d000
    buffer_load_dwordx4 v[116:119], v71, s[12:15], s20 offen offset:0 sc1
    s_waitcnt lgkmcnt(8)
    v_add3_u32 v24, v24, v104, v106
    v_add3_u32 v25, v25, v105, v107
    v_add3_u32 v24, v24, v108, v110
    v_add3_u32 v25, v25, v109, v111
    s_waitcnt vmcnt(4)
    v_lshlrev_b32_sdwa v104, 3, v122 dst_sel:DWORD dst_unused:UNUSED_PAD src0_sel:DWORD src1_sel:WORD_0
    v_lshlrev_b32_sdwa v106, 3, v122 dst_sel:DWORD dst_unused:UNUSED_PAD src0_sel:DWORD src1_sel:WORD_1
    ds_read_b64 v[104:105], v104
    ds_read_b64 v[106:107], v106
    v_lshlrev_b32_sdwa v108, 3, v123 dst_sel:DWORD dst_unused:UNUSED_PAD src0_sel:DWORD src1_sel:WORD_0
    v_lshlrev_b32_sdwa v110, 3, v123 dst_sel:DWORD dst_unused:UNUSED_PAD src0_sel:DWORD src1_sel:WORD_1
    ds_read_b64 v[108:109], v108
    ds_read_b64 v[110:111], v110
    s_waitcnt lgkmcnt(8)
    v_add3_u32 v26, v26, v88, v90
    v_add3_u32 v27, v27, v89, v91
    v_add3_u32 v26, v26, v92, v94
    v_add3_u32 v27, v27, v93, v95
    v_lshlrev_b32_sdwa v88, 3, v120 dst_sel:DWORD dst_unused:UNUSED_PAD src0_sel:DWORD src1_sel:WORD_0
    v_lshlrev_b32_sdwa v90, 3, v120 dst_sel:DWORD dst_unused:UNUSED_PAD src0_sel:DWORD src1_sel:WORD_1
    ds_read_b64 v[88:89], v88
    ds_read_b64 v[90:91], v90
    v_lshlrev_b32_sdwa v92, 3, v121 dst_sel:DWORD dst_unused:UNUSED_PAD src0_sel:DWORD src1_sel:WORD_0
    v_lshlrev_b32_sdwa v94, 3, v121 dst_sel:DWORD dst_unused:UNUSED_PAD src0_sel:DWORD src1_sel:WORD_1
    ds_read_b64 v[92:93], v92
    ds_read_b64 v[94:95], v94
    buffer_load_dwordx4 v[120:123], v71, s[12:15], s20 offen offset:1024 sc1
    s_waitcnt lgkmcnt(8)
    v_add3_u32 v26, v26, v96, v98
    v_add3_u32 v27, v27, v97, v99
    v_add3_u32 v26, v26, v100, v102
    v_add3_u32 v27, v27, v101, v103
    s_waitcnt vmcnt(2)
    v_lshlrev_b32_sdwa v96, 3, v126 dst_sel:DWORD dst_unused:UNUSED_PAD src0_sel:DWORD src1_sel:WORD_0
    v_lshlrev_b32_sdwa v98, 3, v126 dst_sel:DWORD dst_unused:UNUSED_PAD src0_sel:DWORD src1_sel:WORD_1
    ds_read_b64 v[96:97], v96
    ds_read_b64 v[98:99], v98
    v_lshlrev_b32_sdwa v100, 3, v127 dst_sel:DWORD dst_unused:UNUSED_PAD src0_sel:DWORD src1_sel:WORD_0
    v_lshlrev_b32_sdwa v102, 3, v127 dst_sel:DWORD dst_unused:UNUSED_PAD src0_sel:DWORD src1_sel:WORD_1
    ds_read_b64 v[100:101], v100
    ds_read_b64 v[102:103], v102
    s_waitcnt lgkmcnt(8)
    v_add3_u32 v28, v28, v104, v106
    v_add3_u32 v29, v29, v105, v107
    v_add3_u32 v28, v28, v108, v110
    v_add3_u32 v29, v29, v109, v111
    s_setprio 0
    v_lshlrev_b32_sdwa v104, 3, v124 dst_sel:DWORD dst_unused:UNUSED_PAD src0_sel:DWORD src1_sel:WORD_0
    v_lshlrev_b32_sdwa v106, 3, v124 dst_sel:DWORD dst_unused:UNUSED_PAD src0_sel:DWORD src1_sel:WORD_1
    ds_read_b64 v[104:105], v104
    ds_read_b64 v[106:107], v106
    v_lshlrev_b32_sdwa v108, 3, v125 dst_sel:DWORD dst_unused:UNUSED_PAD src0_sel:DWORD src1_sel:WORD_0
    v_lshlrev_b32_sdwa v110, 3, v125 dst_sel:DWORD dst_unused:UNUSED_PAD src0_sel:DWORD src1_sel:WORD_1
    ds_read_b64 v[108:109], v108
    ds_read_b64 v[110:111], v110
    buffer_load_dwordx4 v[124:127], v71, s[12:15], s20 offen offset:2048 sc1
    s_waitcnt lgkmcnt(8)
    v_add3_u32 v28, v28, v88, v90
    v_add3_u32 v29, v29, v89, v91
    v_add3_u32 v28, v28, v92, v94
    v_add3_u32 v29, v29, v93, v95
    s_waitcnt vmcnt(2)
    v_lshlrev_b32_sdwa v88, 3, v116 dst_sel:DWORD dst_unused:UNUSED_PAD src0_sel:DWORD src1_sel:WORD_0
    v_lshlrev_b32_sdwa v90, 3, v116 dst_sel:DWORD dst_unused:UNUSED_PAD src0_sel:DWORD src1_sel:WORD_1
    ds_read_b64 v[88:89], v88
    ds_read_b64 v[90:91], v90
    v_lshlrev_b32_sdwa v92, 3, v117 dst_sel:DWORD dst_unused:UNUSED_PAD src0_sel:DWORD src1_sel:WORD_0
    v_lshlrev_b32_sdwa v94, 3, v117 dst_sel:DWORD dst_unused:UNUSED_PAD src0_sel:DWORD src1_sel:WORD_1
    ds_read_b64 v[92:93], v92
    ds_read_b64 v[94:95], v94
    s_waitcnt lgkmcnt(8)
    v_add3_u32 v30, v30, v96, v98
    v_add3_u32 v31, v31, v97, v99
    v_add3_u32 v30, v30, v100, v102
    v_add3_u32 v31, v31, v101, v103
    s_barrier
    s_setprio 3
    v_lshlrev_b32_sdwa v96, 3, v118 dst_sel:DWORD dst_unused:UNUSED_PAD src0_sel:DWORD src1_sel:WORD_0
    v_lshlrev_b32_sdwa v98, 3, v118 dst_sel:DWORD dst_unused:UNUSED_PAD src0_sel:DWORD src1_sel:WORD_1
    ds_read_b64 v[96:97], v96
    ds_read_b64 v[98:99], v98
    v_lshlrev_b32_sdwa v100, 3, v119 dst_sel:DWORD dst_unused:UNUSED_PAD src0_sel:DWORD src1_sel:WORD_0
    v_lshlrev_b32_sdwa v102, 3, v119 dst_sel:DWORD dst_unused:UNUSED_PAD src0_sel:DWORD src1_sel:WORD_1
    ds_read_b64 v[100:101], v100
    ds_read_b64 v[102:103], v102
    buffer_load_dwordx4 v[116:119], v71, s[12:15], s20 offen offset:3072 sc1
    s_waitcnt lgkmcnt(8)
    v_add3_u32 v30, v30, v104, v106
    v_add3_u32 v31, v31, v105, v107
    v_add3_u32 v30, v30, v108, v110
    v_add3_u32 v31, v31, v109, v111
    v_mfma_f32_16x16x32_bf16 v[112:115], v[72:75], v[128:131], v[66:69]
    s_waitcnt vmcnt(2)
    v_lshlrev_b32_sdwa v104, 3, v120 dst_sel:DWORD dst_unused:UNUSED_PAD src0_sel:DWORD src1_sel:WORD_0
    v_lshlrev_b32_sdwa v106, 3, v120 dst_sel:DWORD dst_unused:UNUSED_PAD src0_sel:DWORD src1_sel:WORD_1
    ds_read_b64 v[104:105], v104
    ds_read_b64 v[106:107], v106
    v_mfma_f32_16x16x32_bf16 v[112:115], v[76:79], v[132:135], v[112:115]
    v_add_u32 v70, 0x10000, v70
    v_lshlrev_b32_sdwa v108, 3, v121 dst_sel:DWORD dst_unused:UNUSED_PAD src0_sel:DWORD src1_sel:WORD_0
    v_lshlrev_b32_sdwa v110, 3, v121 dst_sel:DWORD dst_unused:UNUSED_PAD src0_sel:DWORD src1_sel:WORD_1
    ds_read_b64 v[108:109], v108
    ds_read_b64 v[110:111], v110
    s_waitcnt lgkmcnt(8)
    v_add3_u32 v32, v32, v88, v90
    v_add3_u32 v33, v33, v89, v91
    v_add3_u32 v32, v32, v92, v94
    v_add3_u32 v33, v33, v93, v95
    v_mfma_f32_16x16x32_bf16 v[112:115], v[80:83], v[136:139], v[112:115]
    v_lshlrev_b32_sdwa v88, 3, v122 dst_sel:DWORD dst_unused:UNUSED_PAD src0_sel:DWORD src1_sel:WORD_0
    v_lshlrev_b32_sdwa v90, 3, v122 dst_sel:DWORD dst_unused:UNUSED_PAD src0_sel:DWORD src1_sel:WORD_1
    ds_read_b64 v[88:89], v88
    ds_read_b64 v[90:91], v90
    v_mfma_f32_16x16x32_bf16 v[112:115], v[84:87], v[140:143], v[112:115]
    v_lshlrev_b32_sdwa v92, 3, v123 dst_sel:DWORD dst_unused:UNUSED_PAD src0_sel:DWORD src1_sel:WORD_0
    v_lshlrev_b32_sdwa v94, 3, v123 dst_sel:DWORD dst_unused:UNUSED_PAD src0_sel:DWORD src1_sel:WORD_1
    ds_read_b64 v[92:93], v92
    ds_read_b64 v[94:95], v94
    s_add_u32 s20, s20, 0x1000
    buffer_load_dwordx4 v[120:123], v71, s[12:15], s20 offen offset:0 sc1
    s_waitcnt lgkmcnt(8)
    v_add3_u32 v32, v32, v96, v98
    v_add3_u32 v33, v33, v97, v99
    v_add3_u32 v32, v32, v100, v102
    v_add3_u32 v33, v33, v101, v103
    v_perm_b32 v112, v113, v112, s23
    v_perm_b32 v113, v115, v114, s23
    ds_write_b64 v70, v[112:113] offset:0
    s_waitcnt vmcnt(2)
    v_lshlrev_b32_sdwa v96, 3, v124 dst_sel:DWORD dst_unused:UNUSED_PAD src0_sel:DWORD src1_sel:WORD_0
    v_lshlrev_b32_sdwa v98, 3, v124 dst_sel:DWORD dst_unused:UNUSED_PAD src0_sel:DWORD src1_sel:WORD_1
    ds_read_b64 v[96:97], v96
    ds_read_b64 v[98:99], v98
    v_lshlrev_b32_sdwa v100, 3, v125 dst_sel:DWORD dst_unused:UNUSED_PAD src0_sel:DWORD src1_sel:WORD_0
    v_lshlrev_b32_sdwa v102, 3, v125 dst_sel:DWORD dst_unused:UNUSED_PAD src0_sel:DWORD src1_sel:WORD_1
    ds_read_b64 v[100:101], v100
    ds_read_b64 v[102:103], v102
    s_waitcnt lgkmcnt(9)
    v_add3_u32 v34, v34, v104, v106
    v_add3_u32 v35, v35, v105, v107
    v_add3_u32 v34, v34, v108, v110
    v_add3_u32 v35, v35, v109, v111
    v_mfma_f32_16x16x32_bf16 v[112:115], v[72:75], v[144:147], v[66:69]
    v_lshlrev_b32_sdwa v104, 3, v126 dst_sel:DWORD dst_unused:UNUSED_PAD src0_sel:DWORD src1_sel:WORD_0
    v_lshlrev_b32_sdwa v106, 3, v126 dst_sel:DWORD dst_unused:UNUSED_PAD src0_sel:DWORD src1_sel:WORD_1
    ds_read_b64 v[104:105], v104
    ds_read_b64 v[106:107], v106
    v_mfma_f32_16x16x32_bf16 v[112:115], v[76:79], v[148:151], v[112:115]
    v_lshlrev_b32_sdwa v108, 3, v127 dst_sel:DWORD dst_unused:UNUSED_PAD src0_sel:DWORD src1_sel:WORD_0
    v_lshlrev_b32_sdwa v110, 3, v127 dst_sel:DWORD dst_unused:UNUSED_PAD src0_sel:DWORD src1_sel:WORD_1
    ds_read_b64 v[108:109], v108
    ds_read_b64 v[110:111], v110
    buffer_load_dwordx4 v[124:127], v71, s[12:15], s20 offen offset:1024 sc1
    s_waitcnt lgkmcnt(9)
    v_add3_u32 v34, v34, v88, v90
    v_add3_u32 v35, v35, v89, v91
    v_add3_u32 v34, v34, v92, v94
    v_add3_u32 v35, v35, v93, v95
    v_mfma_f32_16x16x32_bf16 v[112:115], v[80:83], v[152:155], v[112:115]
    s_waitcnt vmcnt(2)
    v_lshlrev_b32_sdwa v88, 3, v116 dst_sel:DWORD dst_unused:UNUSED_PAD src0_sel:DWORD src1_sel:WORD_0
    v_lshlrev_b32_sdwa v90, 3, v116 dst_sel:DWORD dst_unused:UNUSED_PAD src0_sel:DWORD src1_sel:WORD_1
    ds_read_b64 v[88:89], v88
    ds_read_b64 v[90:91], v90
    v_mfma_f32_16x16x32_bf16 v[112:115], v[84:87], v[156:159], v[112:115]
    v_lshlrev_b32_sdwa v92, 3, v117 dst_sel:DWORD dst_unused:UNUSED_PAD src0_sel:DWORD src1_sel:WORD_0
    v_lshlrev_b32_sdwa v94, 3, v117 dst_sel:DWORD dst_unused:UNUSED_PAD src0_sel:DWORD src1_sel:WORD_1
    ds_read_b64 v[92:93], v92
    ds_read_b64 v[94:95], v94
    s_waitcnt lgkmcnt(8)
    v_add3_u32 v36, v36, v96, v98
    v_add3_u32 v37, v37, v97, v99
    v_add3_u32 v36, v36, v100, v102
    v_add3_u32 v37, v37, v101, v103
    v_perm_b32 v112, v113, v112, s23
    v_perm_b32 v113, v115, v114, s23
    ds_write_b64 v70, v[112:113] offset:128
    v_lshlrev_b32_sdwa v96, 3, v118 dst_sel:DWORD dst_unused:UNUSED_PAD src0_sel:DWORD src1_sel:WORD_0
    v_lshlrev_b32_sdwa v98, 3, v118 dst_sel:DWORD dst_unused:UNUSED_PAD src0_sel:DWORD src1_sel:WORD_1
    ds_read_b64 v[96:97], v96
    ds_read_b64 v[98:99], v98
    v_lshlrev_b32_sdwa v100, 3, v119 dst_sel:DWORD dst_unused:UNUSED_PAD src0_sel:DWORD src1_sel:WORD_0
    v_lshlrev_b32_sdwa v102, 3, v119 dst_sel:DWORD dst_unused:UNUSED_PAD src0_sel:DWORD src1_sel:WORD_1
    ds_read_b64 v[100:101], v100
    ds_read_b64 v[102:103], v102
    buffer_load_dwordx4 v[116:119], v71, s[12:15], s20 offen offset:2048 sc1
    s_waitcnt lgkmcnt(9)
    v_add3_u32 v36, v36, v104, v106
    v_add3_u32 v37, v37, v105, v107
    v_add3_u32 v36, v36, v108, v110
    v_add3_u32 v37, v37, v109, v111
    v_mfma_f32_16x16x32_bf16 v[112:115], v[72:75], v[160:163], v[66:69]
    s_waitcnt vmcnt(2)
    v_lshlrev_b32_sdwa v104, 3, v120 dst_sel:DWORD dst_unused:UNUSED_PAD src0_sel:DWORD src1_sel:WORD_0
    v_lshlrev_b32_sdwa v106, 3, v120 dst_sel:DWORD dst_unused:UNUSED_PAD src0_sel:DWORD src1_sel:WORD_1
    ds_read_b64 v[104:105], v104
    ds_read_b64 v[106:107], v106
    v_mfma_f32_16x16x32_bf16 v[112:115], v[76:79], v[164:167], v[112:115]
    v_lshlrev_b32_sdwa v108, 3, v121 dst_sel:DWORD dst_unused:UNUSED_PAD src0_sel:DWORD src1_sel:WORD_0
    v_lshlrev_b32_sdwa v110, 3, v121 dst_sel:DWORD dst_unused:UNUSED_PAD src0_sel:DWORD src1_sel:WORD_1
    ds_read_b64 v[108:109], v108
    ds_read_b64 v[110:111], v110
    s_waitcnt lgkmcnt(9)
    v_add3_u32 v38, v38, v88, v90
    v_add3_u32 v39, v39, v89, v91
    v_add3_u32 v38, v38, v92, v94
    v_add3_u32 v39, v39, v93, v95
    v_mfma_f32_16x16x32_bf16 v[112:115], v[80:83], v[168:171], v[112:115]
    v_lshlrev_b32_sdwa v88, 3, v122 dst_sel:DWORD dst_unused:UNUSED_PAD src0_sel:DWORD src1_sel:WORD_0
    v_lshlrev_b32_sdwa v90, 3, v122 dst_sel:DWORD dst_unused:UNUSED_PAD src0_sel:DWORD src1_sel:WORD_1
    ds_read_b64 v[88:89], v88
    ds_read_b64 v[90:91], v90
    v_mfma_f32_16x16x32_bf16 v[112:115], v[84:87], v[172:175], v[112:115]
    v_lshlrev_b32_sdwa v92, 3, v123 dst_sel:DWORD dst_unused:UNUSED_PAD src0_sel:DWORD src1_sel:WORD_0
    v_lshlrev_b32_sdwa v94, 3, v123 dst_sel:DWORD dst_unused:UNUSED_PAD src0_sel:DWORD src1_sel:WORD_1
    ds_read_b64 v[92:93], v92
    ds_read_b64 v[94:95], v94
    buffer_load_dwordx4 v[120:123], v71, s[12:15], s20 offen offset:3072 sc1
    s_waitcnt lgkmcnt(8)
    v_add3_u32 v38, v38, v96, v98
    v_add3_u32 v39, v39, v97, v99
    v_add3_u32 v38, v38, v100, v102
    v_add3_u32 v39, v39, v101, v103
    v_perm_b32 v112, v113, v112, s23
    v_perm_b32 v113, v115, v114, s23
    ds_write_b64 v70, v[112:113] offset:256
    s_waitcnt vmcnt(2)
    v_lshlrev_b32_sdwa v96, 3, v124 dst_sel:DWORD dst_unused:UNUSED_PAD src0_sel:DWORD src1_sel:WORD_0
    v_lshlrev_b32_sdwa v98, 3, v124 dst_sel:DWORD dst_unused:UNUSED_PAD src0_sel:DWORD src1_sel:WORD_1
    ds_read_b64 v[96:97], v96
    ds_read_b64 v[98:99], v98
    v_lshlrev_b32_sdwa v100, 3, v125 dst_sel:DWORD dst_unused:UNUSED_PAD src0_sel:DWORD src1_sel:WORD_0
    v_lshlrev_b32_sdwa v102, 3, v125 dst_sel:DWORD dst_unused:UNUSED_PAD src0_sel:DWORD src1_sel:WORD_1
    ds_read_b64 v[100:101], v100
    ds_read_b64 v[102:103], v102
    s_waitcnt lgkmcnt(9)
    v_add3_u32 v40, v40, v104, v106
    v_add3_u32 v41, v41, v105, v107
    v_add3_u32 v40, v40, v108, v110
    v_add3_u32 v41, v41, v109, v111
    v_mfma_f32_16x16x32_bf16 v[112:115], v[72:75], v[176:179], v[66:69]
    v_lshlrev_b32_sdwa v104, 3, v126 dst_sel:DWORD dst_unused:UNUSED_PAD src0_sel:DWORD src1_sel:WORD_0
    v_lshlrev_b32_sdwa v106, 3, v126 dst_sel:DWORD dst_unused:UNUSED_PAD src0_sel:DWORD src1_sel:WORD_1
    ds_read_b64 v[104:105], v104
    ds_read_b64 v[106:107], v106
    v_mfma_f32_16x16x32_bf16 v[112:115], v[76:79], v[180:183], v[112:115]
    v_lshlrev_b32_sdwa v108, 3, v127 dst_sel:DWORD dst_unused:UNUSED_PAD src0_sel:DWORD src1_sel:WORD_0
    v_lshlrev_b32_sdwa v110, 3, v127 dst_sel:DWORD dst_unused:UNUSED_PAD src0_sel:DWORD src1_sel:WORD_1
    ds_read_b64 v[108:109], v108
    ds_read_b64 v[110:111], v110
    s_add_u32 s20, s20, 0x1000
    buffer_load_dwordx4 v[124:127], v71, s[12:15], s20 offen offset:0 sc1
    s_waitcnt lgkmcnt(9)
    v_add3_u32 v40, v40, v88, v90
    v_add3_u32 v41, v41, v89, v91
    v_add3_u32 v40, v40, v92, v94
    v_add3_u32 v41, v41, v93, v95
    v_mfma_f32_16x16x32_bf16 v[112:115], v[80:83], v[184:187], v[112:115]
    s_waitcnt vmcnt(2)
    v_lshlrev_b32_sdwa v88, 3, v116 dst_sel:DWORD dst_unused:UNUSED_PAD src0_sel:DWORD src1_sel:WORD_0
    v_lshlrev_b32_sdwa v90, 3, v116 dst_sel:DWORD dst_unused:UNUSED_PAD src0_sel:DWORD src1_sel:WORD_1
    ds_read_b64 v[88:89], v88
    ds_read_b64 v[90:91], v90
    v_mfma_f32_16x16x32_bf16 v[112:115], v[84:87], v[188:191], v[112:115]
    v_lshlrev_b32_sdwa v92, 3, v117 dst_sel:DWORD dst_unused:UNUSED_PAD src0_sel:DWORD src1_sel:WORD_0
    v_lshlrev_b32_sdwa v94, 3, v117 dst_sel:DWORD dst_unused:UNUSED_PAD src0_sel:DWORD src1_sel:WORD_1
    ds_read_b64 v[92:93], v92
    ds_read_b64 v[94:95], v94
    s_waitcnt lgkmcnt(8)
    v_add3_u32 v42, v42, v96, v98
    v_add3_u32 v43, v43, v97, v99
    v_add3_u32 v42, v42, v100, v102
    v_add3_u32 v43, v43, v101, v103
    v_perm_b32 v112, v113, v112, s23
    v_perm_b32 v113, v115, v114, s23
    ds_write_b64 v70, v[112:113] offset:384
    v_lshlrev_b32_sdwa v96, 3, v118 dst_sel:DWORD dst_unused:UNUSED_PAD src0_sel:DWORD src1_sel:WORD_0
    v_lshlrev_b32_sdwa v98, 3, v118 dst_sel:DWORD dst_unused:UNUSED_PAD src0_sel:DWORD src1_sel:WORD_1
    ds_read_b64 v[96:97], v96
    ds_read_b64 v[98:99], v98
    v_lshlrev_b32_sdwa v100, 3, v119 dst_sel:DWORD dst_unused:UNUSED_PAD src0_sel:DWORD src1_sel:WORD_0
    v_lshlrev_b32_sdwa v102, 3, v119 dst_sel:DWORD dst_unused:UNUSED_PAD src0_sel:DWORD src1_sel:WORD_1
    ds_read_b64 v[100:101], v100
    ds_read_b64 v[102:103], v102
    buffer_load_dwordx4 v[116:119], v71, s[12:15], s20 offen offset:1024 sc1
    s_waitcnt lgkmcnt(9)
    v_add3_u32 v42, v42, v104, v106
    v_add3_u32 v43, v43, v105, v107
    v_add3_u32 v42, v42, v108, v110
    v_add3_u32 v43, v43, v109, v111
    v_mfma_f32_16x16x32_bf16 v[112:115], v[72:75], v[192:195], v[66:69]
    s_waitcnt vmcnt(2)
    v_lshlrev_b32_sdwa v104, 3, v120 dst_sel:DWORD dst_unused:UNUSED_PAD src0_sel:DWORD src1_sel:WORD_0
    v_lshlrev_b32_sdwa v106, 3, v120 dst_sel:DWORD dst_unused:UNUSED_PAD src0_sel:DWORD src1_sel:WORD_1
    ds_read_b64 v[104:105], v104
    ds_read_b64 v[106:107], v106
    v_mfma_f32_16x16x32_bf16 v[112:115], v[76:79], v[196:199], v[112:115]
    v_lshlrev_b32_sdwa v108, 3, v121 dst_sel:DWORD dst_unused:UNUSED_PAD src0_sel:DWORD src1_sel:WORD_0
    v_lshlrev_b32_sdwa v110, 3, v121 dst_sel:DWORD dst_unused:UNUSED_PAD src0_sel:DWORD src1_sel:WORD_1
    ds_read_b64 v[108:109], v108
    ds_read_b64 v[110:111], v110
    s_waitcnt lgkmcnt(9)
    v_add3_u32 v44, v44, v88, v90
    v_add3_u32 v45, v45, v89, v91
    v_add3_u32 v44, v44, v92, v94
    v_add3_u32 v45, v45, v93, v95
    v_mfma_f32_16x16x32_bf16 v[112:115], v[80:83], v[200:203], v[112:115]
    v_lshlrev_b32_sdwa v88, 3, v122 dst_sel:DWORD dst_unused:UNUSED_PAD src0_sel:DWORD src1_sel:WORD_0
    v_lshlrev_b32_sdwa v90, 3, v122 dst_sel:DWORD dst_unused:UNUSED_PAD src0_sel:DWORD src1_sel:WORD_1
    ds_read_b64 v[88:89], v88
    ds_read_b64 v[90:91], v90
    v_mfma_f32_16x16x32_bf16 v[112:115], v[84:87], v[204:207], v[112:115]
    v_lshlrev_b32_sdwa v92, 3, v123 dst_sel:DWORD dst_unused:UNUSED_PAD src0_sel:DWORD src1_sel:WORD_0
    v_lshlrev_b32_sdwa v94, 3, v123 dst_sel:DWORD dst_unused:UNUSED_PAD src0_sel:DWORD src1_sel:WORD_1
    ds_read_b64 v[92:93], v92
    ds_read_b64 v[94:95], v94
    buffer_load_dwordx4 v[120:123], v71, s[12:15], s20 offen offset:2048 sc1
    s_waitcnt lgkmcnt(8)
    v_add3_u32 v44, v44, v96, v98
    v_add3_u32 v45, v45, v97, v99
    v_add3_u32 v44, v44, v100, v102
    v_add3_u32 v45, v45, v101, v103
    v_perm_b32 v112, v113, v112, s23
    v_perm_b32 v113, v115, v114, s23
    ds_write_b64 v70, v[112:113] offset:512
    s_waitcnt vmcnt(2)
    v_lshlrev_b32_sdwa v96, 3, v124 dst_sel:DWORD dst_unused:UNUSED_PAD src0_sel:DWORD src1_sel:WORD_0
    v_lshlrev_b32_sdwa v98, 3, v124 dst_sel:DWORD dst_unused:UNUSED_PAD src0_sel:DWORD src1_sel:WORD_1
    ds_read_b64 v[96:97], v96
    ds_read_b64 v[98:99], v98
    v_lshlrev_b32_sdwa v100, 3, v125 dst_sel:DWORD dst_unused:UNUSED_PAD src0_sel:DWORD src1_sel:WORD_0
    v_lshlrev_b32_sdwa v102, 3, v125 dst_sel:DWORD dst_unused:UNUSED_PAD src0_sel:DWORD src1_sel:WORD_1
    ds_read_b64 v[100:101], v100
    ds_read_b64 v[102:103], v102
    s_waitcnt lgkmcnt(9)
    v_add3_u32 v46, v46, v104, v106
    v_add3_u32 v47, v47, v105, v107
    v_add3_u32 v46, v46, v108, v110
    v_add3_u32 v47, v47, v109, v111
    s_setprio 2
    v_mfma_f32_16x16x32_bf16 v[112:115], v[72:75], v[208:211], v[66:69]
    v_lshlrev_b32_sdwa v104, 3, v126 dst_sel:DWORD dst_unused:UNUSED_PAD src0_sel:DWORD src1_sel:WORD_0
    v_lshlrev_b32_sdwa v106, 3, v126 dst_sel:DWORD dst_unused:UNUSED_PAD src0_sel:DWORD src1_sel:WORD_1
    ds_read_b64 v[104:105], v104
    ds_read_b64 v[106:107], v106
    v_mfma_f32_16x16x32_bf16 v[112:115], v[76:79], v[212:215], v[112:115]
    v_lshlrev_b32_sdwa v108, 3, v127 dst_sel:DWORD dst_unused:UNUSED_PAD src0_sel:DWORD src1_sel:WORD_0
    v_lshlrev_b32_sdwa v110, 3, v127 dst_sel:DWORD dst_unused:UNUSED_PAD src0_sel:DWORD src1_sel:WORD_1
    ds_read_b64 v[108:109], v108
    ds_read_b64 v[110:111], v110
    buffer_load_dwordx4 v[124:127], v71, s[12:15], s20 offen offset:3072 sc1
    s_waitcnt lgkmcnt(9)
    v_add3_u32 v46, v46, v88, v90
    v_add3_u32 v47, v47, v89, v91
    v_add3_u32 v46, v46, v92, v94
    v_add3_u32 v47, v47, v93, v95
    v_mfma_f32_16x16x32_bf16 v[112:115], v[80:83], v[216:219], v[112:115]
    s_waitcnt vmcnt(2)
    v_lshlrev_b32_sdwa v88, 3, v116 dst_sel:DWORD dst_unused:UNUSED_PAD src0_sel:DWORD src1_sel:WORD_0
    v_lshlrev_b32_sdwa v90, 3, v116 dst_sel:DWORD dst_unused:UNUSED_PAD src0_sel:DWORD src1_sel:WORD_1
    ds_read_b64 v[88:89], v88
    ds_read_b64 v[90:91], v90
    v_mfma_f32_16x16x32_bf16 v[112:115], v[84:87], v[220:223], v[112:115]
    v_lshlrev_b32_sdwa v92, 3, v117 dst_sel:DWORD dst_unused:UNUSED_PAD src0_sel:DWORD src1_sel:WORD_0
    v_lshlrev_b32_sdwa v94, 3, v117 dst_sel:DWORD dst_unused:UNUSED_PAD src0_sel:DWORD src1_sel:WORD_1
    ds_read_b64 v[92:93], v92
    ds_read_b64 v[94:95], v94
    s_waitcnt lgkmcnt(8)
    v_add3_u32 v48, v48, v96, v98
    v_add3_u32 v49, v49, v97, v99
    v_add3_u32 v48, v48, v100, v102
    v_add3_u32 v49, v49, v101, v103
    v_perm_b32 v112, v113, v112, s23
    v_perm_b32 v113, v115, v114, s23
    ds_write_b64 v70, v[112:113] offset:640
    v_lshlrev_b32_sdwa v96, 3, v118 dst_sel:DWORD dst_unused:UNUSED_PAD src0_sel:DWORD src1_sel:WORD_0
    v_lshlrev_b32_sdwa v98, 3, v118 dst_sel:DWORD dst_unused:UNUSED_PAD src0_sel:DWORD src1_sel:WORD_1
    ds_read_b64 v[96:97], v96
    ds_read_b64 v[98:99], v98
    v_lshlrev_b32_sdwa v100, 3, v119 dst_sel:DWORD dst_unused:UNUSED_PAD src0_sel:DWORD src1_sel:WORD_0
    v_lshlrev_b32_sdwa v102, 3, v119 dst_sel:DWORD dst_unused:UNUSED_PAD src0_sel:DWORD src1_sel:WORD_1
    ds_read_b64 v[100:101], v100
    ds_read_b64 v[102:103], v102
    s_add_u32 s20, s20, 0x1000
    buffer_load_dwordx4 v[116:119], v71, s[12:15], s20 offen offset:0 sc1
    s_waitcnt lgkmcnt(9)
    v_add3_u32 v48, v48, v104, v106
    v_add3_u32 v49, v49, v105, v107
    v_add3_u32 v48, v48, v108, v110
    v_add3_u32 v49, v49, v109, v111
    v_mfma_f32_16x16x32_bf16 v[112:115], v[72:75], v[224:227], v[66:69]
    s_waitcnt vmcnt(2)
    v_lshlrev_b32_sdwa v104, 3, v120 dst_sel:DWORD dst_unused:UNUSED_PAD src0_sel:DWORD src1_sel:WORD_0
    v_lshlrev_b32_sdwa v106, 3, v120 dst_sel:DWORD dst_unused:UNUSED_PAD src0_sel:DWORD src1_sel:WORD_1
    ds_read_b64 v[104:105], v104
    ds_read_b64 v[106:107], v106
    v_mfma_f32_16x16x32_bf16 v[112:115], v[76:79], v[228:231], v[112:115]
    v_lshlrev_b32_sdwa v108, 3, v121 dst_sel:DWORD dst_unused:UNUSED_PAD src0_sel:DWORD src1_sel:WORD_0
    v_lshlrev_b32_sdwa v110, 3, v121 dst_sel:DWORD dst_unused:UNUSED_PAD src0_sel:DWORD src1_sel:WORD_1
    ds_read_b64 v[108:109], v108
    ds_read_b64 v[110:111], v110
    s_waitcnt lgkmcnt(9)
    v_add3_u32 v50, v50, v88, v90
    v_add3_u32 v51, v51, v89, v91
    v_add3_u32 v50, v50, v92, v94
    v_add3_u32 v51, v51, v93, v95
    v_mfma_f32_16x16x32_bf16 v[112:115], v[80:83], v[232:235], v[112:115]
    v_lshlrev_b32_sdwa v88, 3, v122 dst_sel:DWORD dst_unused:UNUSED_PAD src0_sel:DWORD src1_sel:WORD_0
    v_lshlrev_b32_sdwa v90, 3, v122 dst_sel:DWORD dst_unused:UNUSED_PAD src0_sel:DWORD src1_sel:WORD_1
    ds_read_b64 v[88:89], v88
    ds_read_b64 v[90:91], v90
    v_mfma_f32_16x16x32_bf16 v[112:115], v[84:87], v[236:239], v[112:115]
    v_lshlrev_b32_sdwa v92, 3, v123 dst_sel:DWORD dst_unused:UNUSED_PAD src0_sel:DWORD src1_sel:WORD_0
    v_lshlrev_b32_sdwa v94, 3, v123 dst_sel:DWORD dst_unused:UNUSED_PAD src0_sel:DWORD src1_sel:WORD_1
    ds_read_b64 v[92:93], v92
    ds_read_b64 v[94:95], v94
    buffer_load_dwordx4 v[120:123], v71, s[12:15], s20 offen offset:1024 sc1
    s_waitcnt lgkmcnt(8)
    v_add3_u32 v50, v50, v96, v98
    v_add3_u32 v51, v51, v97, v99
    v_add3_u32 v50, v50, v100, v102
    v_add3_u32 v51, v51, v101, v103
    v_perm_b32 v112, v113, v112, s23
    v_perm_b32 v113, v115, v114, s23
    ds_write_b64 v70, v[112:113] offset:768
    s_waitcnt vmcnt(2)
    v_lshlrev_b32_sdwa v96, 3, v124 dst_sel:DWORD dst_unused:UNUSED_PAD src0_sel:DWORD src1_sel:WORD_0
    v_lshlrev_b32_sdwa v98, 3, v124 dst_sel:DWORD dst_unused:UNUSED_PAD src0_sel:DWORD src1_sel:WORD_1
    ds_read_b64 v[96:97], v96
    ds_read_b64 v[98:99], v98
    v_lshlrev_b32_sdwa v100, 3, v125 dst_sel:DWORD dst_unused:UNUSED_PAD src0_sel:DWORD src1_sel:WORD_0
    v_lshlrev_b32_sdwa v102, 3, v125 dst_sel:DWORD dst_unused:UNUSED_PAD src0_sel:DWORD src1_sel:WORD_1
    ds_read_b64 v[100:101], v100
    ds_read_b64 v[102:103], v102
    s_waitcnt lgkmcnt(9)
    v_add3_u32 v52, v52, v104, v106
    v_add3_u32 v53, v53, v105, v107
    v_add3_u32 v52, v52, v108, v110
    v_add3_u32 v53, v53, v109, v111
    v_mfma_f32_16x16x32_bf16 v[112:115], v[72:75], v[240:243], v[66:69]
    buffer_load_dwordx4 v[72:75], v71, s[12:15], s21 offen offset:0
    v_lshlrev_b32_sdwa v104, 3, v126 dst_sel:DWORD dst_unused:UNUSED_PAD src0_sel:DWORD src1_sel:WORD_0
    v_lshlrev_b32_sdwa v106, 3, v126 dst_sel:DWORD dst_unused:UNUSED_PAD src0_sel:DWORD src1_sel:WORD_1
    ds_read_b64 v[104:105], v104
    ds_read_b64 v[106:107], v106
    v_mfma_f32_16x16x32_bf16 v[112:115], v[76:79], v[244:247], v[112:115]
    buffer_load_dwordx4 v[76:79], v71, s[12:15], s21 offen offset:1024
    v_lshlrev_b32_sdwa v108, 3, v127 dst_sel:DWORD dst_unused:UNUSED_PAD src0_sel:DWORD src1_sel:WORD_0
    v_lshlrev_b32_sdwa v110, 3, v127 dst_sel:DWORD dst_unused:UNUSED_PAD src0_sel:DWORD src1_sel:WORD_1
    ds_read_b64 v[108:109], v108
    ds_read_b64 v[110:111], v110
    buffer_load_dwordx4 v[124:127], v71, s[12:15], s20 offen offset:2048 sc1
    s_waitcnt lgkmcnt(9)
    v_add3_u32 v52, v52, v88, v90
    v_add3_u32 v53, v53, v89, v91
    v_add3_u32 v52, v52, v92, v94
    v_add3_u32 v53, v53, v93, v95
    v_mfma_f32_16x16x32_bf16 v[112:115], v[80:83], v[248:251], v[112:115]
    buffer_load_dwordx4 v[80:83], v71, s[12:15], s19 offen offset:0
    s_waitcnt vmcnt(5)
    v_lshlrev_b32_sdwa v88, 3, v116 dst_sel:DWORD dst_unused:UNUSED_PAD src0_sel:DWORD src1_sel:WORD_0
    v_lshlrev_b32_sdwa v90, 3, v116 dst_sel:DWORD dst_unused:UNUSED_PAD src0_sel:DWORD src1_sel:WORD_1
    ds_read_b64 v[88:89], v88
    ds_read_b64 v[90:91], v90
    v_mfma_f32_16x16x32_bf16 v[112:115], v[84:87], v[252:255], v[112:115]
    buffer_load_dwordx4 v[84:87], v71, s[12:15], s19 offen offset:1024
    s_add_u32 s21, s21, 4096
    s_add_u32 s19, s19, 4096
    v_lshlrev_b32_sdwa v92, 3, v117 dst_sel:DWORD dst_unused:UNUSED_PAD src0_sel:DWORD src1_sel:WORD_0
    v_lshlrev_b32_sdwa v94, 3, v117 dst_sel:DWORD dst_unused:UNUSED_PAD src0_sel:DWORD src1_sel:WORD_1
    ds_read_b64 v[92:93], v92
    ds_read_b64 v[94:95], v94
    s_waitcnt lgkmcnt(8)
    v_add3_u32 v54, v54, v96, v98
    v_add3_u32 v55, v55, v97, v99
    v_add3_u32 v54, v54, v100, v102
    v_add3_u32 v55, v55, v101, v103
    v_perm_b32 v112, v113, v112, s23
    v_perm_b32 v113, v115, v114, s23
    ds_write_b64 v70, v[112:113] offset:896
    s_setprio 1
    v_lshlrev_b32_sdwa v96, 3, v118 dst_sel:DWORD dst_unused:UNUSED_PAD src0_sel:DWORD src1_sel:WORD_0
    v_lshlrev_b32_sdwa v98, 3, v118 dst_sel:DWORD dst_unused:UNUSED_PAD src0_sel:DWORD src1_sel:WORD_1
    ds_read_b64 v[96:97], v96
    ds_read_b64 v[98:99], v98
    v_lshlrev_b32_sdwa v100, 3, v119 dst_sel:DWORD dst_unused:UNUSED_PAD src0_sel:DWORD src1_sel:WORD_0
    v_lshlrev_b32_sdwa v102, 3, v119 dst_sel:DWORD dst_unused:UNUSED_PAD src0_sel:DWORD src1_sel:WORD_1
    ds_read_b64 v[100:101], v100
    ds_read_b64 v[102:103], v102
    buffer_load_dwordx4 v[116:119], v71, s[12:15], s20 offen offset:3072 sc1
    s_waitcnt lgkmcnt(9)
    v_add3_u32 v54, v54, v104, v106
    v_add3_u32 v55, v55, v105, v107
    v_add3_u32 v54, v54, v108, v110
    v_add3_u32 v55, v55, v109, v111
    s_waitcnt vmcnt(6)
    v_lshlrev_b32_sdwa v104, 3, v120 dst_sel:DWORD dst_unused:UNUSED_PAD src0_sel:DWORD src1_sel:WORD_0
    v_lshlrev_b32_sdwa v106, 3, v120 dst_sel:DWORD dst_unused:UNUSED_PAD src0_sel:DWORD src1_sel:WORD_1
    ds_read_b64 v[104:105], v104
    ds_read_b64 v[106:107], v106
    v_lshlrev_b32_sdwa v108, 3, v121 dst_sel:DWORD dst_unused:UNUSED_PAD src0_sel:DWORD src1_sel:WORD_0
    v_lshlrev_b32_sdwa v110, 3, v121 dst_sel:DWORD dst_unused:UNUSED_PAD src0_sel:DWORD src1_sel:WORD_1
    ds_read_b64 v[108:109], v108
    ds_read_b64 v[110:111], v110
    s_waitcnt lgkmcnt(9)
    v_add3_u32 v56, v56, v88, v90
    v_add3_u32 v57, v57, v89, v91
    v_add3_u32 v56, v56, v92, v94
    v_add3_u32 v57, v57, v93, v95
    v_lshlrev_b32_sdwa v88, 3, v122 dst_sel:DWORD dst_unused:UNUSED_PAD src0_sel:DWORD src1_sel:WORD_0
    v_lshlrev_b32_sdwa v90, 3, v122 dst_sel:DWORD dst_unused:UNUSED_PAD src0_sel:DWORD src1_sel:WORD_1
    ds_read_b64 v[88:89], v88
    ds_read_b64 v[90:91], v90
    v_lshlrev_b32_sdwa v92, 3, v123 dst_sel:DWORD dst_unused:UNUSED_PAD src0_sel:DWORD src1_sel:WORD_0
    v_lshlrev_b32_sdwa v94, 3, v123 dst_sel:DWORD dst_unused:UNUSED_PAD src0_sel:DWORD src1_sel:WORD_1
    ds_read_b64 v[92:93], v92
    ds_read_b64 v[94:95], v94
    s_add_u32 s20, s20, 0x1d000
    buffer_load_dwordx4 v[120:123], v71, s[12:15], s20 offen offset:0 sc1
    s_waitcnt lgkmcnt(8)
    v_add3_u32 v56, v56, v96, v98
    v_add3_u32 v57, v57, v97, v99
    v_add3_u32 v56, v56, v100, v102
    v_add3_u32 v57, v57, v101, v103
    s_waitcnt vmcnt(4)
    v_lshlrev_b32_sdwa v96, 3, v124 dst_sel:DWORD dst_unused:UNUSED_PAD src0_sel:DWORD src1_sel:WORD_0
    v_lshlrev_b32_sdwa v98, 3, v124 dst_sel:DWORD dst_unused:UNUSED_PAD src0_sel:DWORD src1_sel:WORD_1
    ds_read_b64 v[96:97], v96
    ds_read_b64 v[98:99], v98
    v_lshlrev_b32_sdwa v100, 3, v125 dst_sel:DWORD dst_unused:UNUSED_PAD src0_sel:DWORD src1_sel:WORD_0
    v_lshlrev_b32_sdwa v102, 3, v125 dst_sel:DWORD dst_unused:UNUSED_PAD src0_sel:DWORD src1_sel:WORD_1
    ds_read_b64 v[100:101], v100
    ds_read_b64 v[102:103], v102
    s_waitcnt lgkmcnt(8)
    v_add3_u32 v58, v58, v104, v106
    v_add3_u32 v59, v59, v105, v107
    v_add3_u32 v58, v58, v108, v110
    v_add3_u32 v59, v59, v109, v111
    v_lshlrev_b32_sdwa v104, 3, v126 dst_sel:DWORD dst_unused:UNUSED_PAD src0_sel:DWORD src1_sel:WORD_0
    v_lshlrev_b32_sdwa v106, 3, v126 dst_sel:DWORD dst_unused:UNUSED_PAD src0_sel:DWORD src1_sel:WORD_1
    ds_read_b64 v[104:105], v104
    ds_read_b64 v[106:107], v106
    v_lshlrev_b32_sdwa v108, 3, v127 dst_sel:DWORD dst_unused:UNUSED_PAD src0_sel:DWORD src1_sel:WORD_0
    v_lshlrev_b32_sdwa v110, 3, v127 dst_sel:DWORD dst_unused:UNUSED_PAD src0_sel:DWORD src1_sel:WORD_1
    ds_read_b64 v[108:109], v108
    ds_read_b64 v[110:111], v110
    buffer_load_dwordx4 v[124:127], v71, s[12:15], s20 offen offset:1024 sc1
    s_waitcnt lgkmcnt(8)
    v_add3_u32 v58, v58, v88, v90
    v_add3_u32 v59, v59, v89, v91
    v_add3_u32 v58, v58, v92, v94
    v_add3_u32 v59, v59, v93, v95
    s_waitcnt vmcnt(2)
    v_lshlrev_b32_sdwa v88, 3, v116 dst_sel:DWORD dst_unused:UNUSED_PAD src0_sel:DWORD src1_sel:WORD_0
    v_lshlrev_b32_sdwa v90, 3, v116 dst_sel:DWORD dst_unused:UNUSED_PAD src0_sel:DWORD src1_sel:WORD_1
    ds_read_b64 v[88:89], v88
    ds_read_b64 v[90:91], v90
    v_lshlrev_b32_sdwa v92, 3, v117 dst_sel:DWORD dst_unused:UNUSED_PAD src0_sel:DWORD src1_sel:WORD_0
    v_lshlrev_b32_sdwa v94, 3, v117 dst_sel:DWORD dst_unused:UNUSED_PAD src0_sel:DWORD src1_sel:WORD_1
    ds_read_b64 v[92:93], v92
    ds_read_b64 v[94:95], v94
    s_waitcnt lgkmcnt(8)
    v_add3_u32 v60, v60, v96, v98
    v_add3_u32 v61, v61, v97, v99
    v_add3_u32 v60, v60, v100, v102
    v_add3_u32 v61, v61, v101, v103
    s_setprio 0
    v_lshlrev_b32_sdwa v96, 3, v118 dst_sel:DWORD dst_unused:UNUSED_PAD src0_sel:DWORD src1_sel:WORD_0
    v_lshlrev_b32_sdwa v98, 3, v118 dst_sel:DWORD dst_unused:UNUSED_PAD src0_sel:DWORD src1_sel:WORD_1
    ds_read_b64 v[96:97], v96
    ds_read_b64 v[98:99], v98
    v_lshlrev_b32_sdwa v100, 3, v119 dst_sel:DWORD dst_unused:UNUSED_PAD src0_sel:DWORD src1_sel:WORD_0
    v_lshlrev_b32_sdwa v102, 3, v119 dst_sel:DWORD dst_unused:UNUSED_PAD src0_sel:DWORD src1_sel:WORD_1
    ds_read_b64 v[100:101], v100
    ds_read_b64 v[102:103], v102
    buffer_load_dwordx4 v[116:119], v71, s[12:15], s20 offen offset:2048 sc1
    s_waitcnt lgkmcnt(8)
    v_add3_u32 v60, v60, v104, v106
    v_add3_u32 v61, v61, v105, v107
    v_add3_u32 v60, v60, v108, v110
    v_add3_u32 v61, v61, v109, v111
    s_waitcnt vmcnt(2)
    v_lshlrev_b32_sdwa v104, 3, v122 dst_sel:DWORD dst_unused:UNUSED_PAD src0_sel:DWORD src1_sel:WORD_0
    v_lshlrev_b32_sdwa v106, 3, v122 dst_sel:DWORD dst_unused:UNUSED_PAD src0_sel:DWORD src1_sel:WORD_1
    ds_read_b64 v[104:105], v104
    ds_read_b64 v[106:107], v106
    v_lshlrev_b32_sdwa v108, 3, v123 dst_sel:DWORD dst_unused:UNUSED_PAD src0_sel:DWORD src1_sel:WORD_0
    v_lshlrev_b32_sdwa v110, 3, v123 dst_sel:DWORD dst_unused:UNUSED_PAD src0_sel:DWORD src1_sel:WORD_1
    ds_read_b64 v[108:109], v108
    ds_read_b64 v[110:111], v110
    s_waitcnt lgkmcnt(8)
    v_add3_u32 v62, v62, v88, v90
    v_add3_u32 v63, v63, v89, v91
    v_add3_u32 v62, v62, v92, v94
    v_add3_u32 v63, v63, v93, v95
    s_barrier
    s_setprio 3
    v_lshlrev_b32_sdwa v88, 3, v120 dst_sel:DWORD dst_unused:UNUSED_PAD src0_sel:DWORD src1_sel:WORD_0
    v_lshlrev_b32_sdwa v90, 3, v120 dst_sel:DWORD dst_unused:UNUSED_PAD src0_sel:DWORD src1_sel:WORD_1
    ds_read_b64 v[88:89], v88
    ds_read_b64 v[90:91], v90
    v_lshlrev_b32_sdwa v92, 3, v121 dst_sel:DWORD dst_unused:UNUSED_PAD src0_sel:DWORD src1_sel:WORD_0
    v_lshlrev_b32_sdwa v94, 3, v121 dst_sel:DWORD dst_unused:UNUSED_PAD src0_sel:DWORD src1_sel:WORD_1
    ds_read_b64 v[92:93], v92
    ds_read_b64 v[94:95], v94
    buffer_load_dwordx4 v[120:123], v71, s[12:15], s20 offen offset:3072 sc1
    s_waitcnt lgkmcnt(8)
    v_add3_u32 v62, v62, v96, v98
    v_add3_u32 v63, v63, v97, v99
    v_add3_u32 v62, v62, v100, v102
    v_add3_u32 v63, v63, v101, v103
    v_mfma_f32_16x16x32_bf16 v[112:115], v[72:75], v[128:131], v[66:69]
    s_waitcnt vmcnt(2)
    v_lshlrev_b32_sdwa v96, 3, v126 dst_sel:DWORD dst_unused:UNUSED_PAD src0_sel:DWORD src1_sel:WORD_0
    v_lshlrev_b32_sdwa v98, 3, v126 dst_sel:DWORD dst_unused:UNUSED_PAD src0_sel:DWORD src1_sel:WORD_1
    ds_read_b64 v[96:97], v96
    ds_read_b64 v[98:99], v98
    v_mfma_f32_16x16x32_bf16 v[112:115], v[76:79], v[132:135], v[112:115]
    v_lshlrev_b32_sdwa v100, 3, v127 dst_sel:DWORD dst_unused:UNUSED_PAD src0_sel:DWORD src1_sel:WORD_0
    v_lshlrev_b32_sdwa v102, 3, v127 dst_sel:DWORD dst_unused:UNUSED_PAD src0_sel:DWORD src1_sel:WORD_1
    ds_read_b64 v[100:101], v100
    ds_read_b64 v[102:103], v102
    s_waitcnt lgkmcnt(8)
    v_add3_u32 v0, v0, v104, v106
    v_add3_u32 v1, v1, v105, v107
    v_add3_u32 v0, v0, v108, v110
    v_add3_u32 v1, v1, v109, v111
    v_mfma_f32_16x16x32_bf16 v[112:115], v[80:83], v[136:139], v[112:115]
    v_lshlrev_b32_sdwa v104, 3, v124 dst_sel:DWORD dst_unused:UNUSED_PAD src0_sel:DWORD src1_sel:WORD_0
    v_lshlrev_b32_sdwa v106, 3, v124 dst_sel:DWORD dst_unused:UNUSED_PAD src0_sel:DWORD src1_sel:WORD_1
    ds_read_b64 v[104:105], v104
    ds_read_b64 v[106:107], v106
    v_mfma_f32_16x16x32_bf16 v[112:115], v[84:87], v[140:143], v[112:115]
    v_lshlrev_b32_sdwa v108, 3, v125 dst_sel:DWORD dst_unused:UNUSED_PAD src0_sel:DWORD src1_sel:WORD_0
    v_lshlrev_b32_sdwa v110, 3, v125 dst_sel:DWORD dst_unused:UNUSED_PAD src0_sel:DWORD src1_sel:WORD_1
    ds_read_b64 v[108:109], v108
    ds_read_b64 v[110:111], v110
    s_add_u32 s20, s20, 0x1000
    buffer_load_dwordx4 v[124:127], v71, s[12:15], s20 offen offset:0 sc1
    s_waitcnt lgkmcnt(8)
    v_add3_u32 v0, v0, v88, v90
    v_add3_u32 v1, v1, v89, v91
    v_add3_u32 v0, v0, v92, v94
    v_add3_u32 v1, v1, v93, v95
    v_perm_b32 v112, v113, v112, s23
    v_perm_b32 v113, v115, v114, s23
    ds_write_b64 v70, v[112:113] offset:32768
    s_waitcnt vmcnt(2)
    v_lshlrev_b32_sdwa v88, 3, v118 dst_sel:DWORD dst_unused:UNUSED_PAD src0_sel:DWORD src1_sel:WORD_0
    v_lshlrev_b32_sdwa v90, 3, v118 dst_sel:DWORD dst_unused:UNUSED_PAD src0_sel:DWORD src1_sel:WORD_1
    ds_read_b64 v[88:89], v88
    ds_read_b64 v[90:91], v90
    v_lshlrev_b32_sdwa v92, 3, v119 dst_sel:DWORD dst_unused:UNUSED_PAD src0_sel:DWORD src1_sel:WORD_0
    v_lshlrev_b32_sdwa v94, 3, v119 dst_sel:DWORD dst_unused:UNUSED_PAD src0_sel:DWORD src1_sel:WORD_1
    ds_read_b64 v[92:93], v92
    ds_read_b64 v[94:95], v94
    s_waitcnt lgkmcnt(9)
    v_add3_u32 v2, v2, v96, v98
    v_add3_u32 v3, v3, v97, v99
    v_add3_u32 v2, v2, v100, v102
    v_add3_u32 v3, v3, v101, v103
    v_mfma_f32_16x16x32_bf16 v[112:115], v[72:75], v[144:147], v[66:69]
    v_lshlrev_b32_sdwa v96, 3, v116 dst_sel:DWORD dst_unused:UNUSED_PAD src0_sel:DWORD src1_sel:WORD_0
    v_lshlrev_b32_sdwa v98, 3, v116 dst_sel:DWORD dst_unused:UNUSED_PAD src0_sel:DWORD src1_sel:WORD_1
    ds_read_b64 v[96:97], v96
    ds_read_b64 v[98:99], v98
    v_mfma_f32_16x16x32_bf16 v[112:115], v[76:79], v[148:151], v[112:115]
    v_lshlrev_b32_sdwa v100, 3, v117 dst_sel:DWORD dst_unused:UNUSED_PAD src0_sel:DWORD src1_sel:WORD_0
    v_lshlrev_b32_sdwa v102, 3, v117 dst_sel:DWORD dst_unused:UNUSED_PAD src0_sel:DWORD src1_sel:WORD_1
    ds_read_b64 v[100:101], v100
    ds_read_b64 v[102:103], v102
    buffer_load_dwordx4 v[116:119], v71, s[12:15], s20 offen offset:1024 sc1
    s_waitcnt lgkmcnt(9)
    v_add3_u32 v2, v2, v104, v106
    v_add3_u32 v3, v3, v105, v107
    v_add3_u32 v2, v2, v108, v110
    v_add3_u32 v3, v3, v109, v111
    v_mfma_f32_16x16x32_bf16 v[112:115], v[80:83], v[152:155], v[112:115]
    s_waitcnt vmcnt(2)
    v_lshlrev_b32_sdwa v104, 3, v122 dst_sel:DWORD dst_unused:UNUSED_PAD src0_sel:DWORD src1_sel:WORD_0
    v_lshlrev_b32_sdwa v106, 3, v122 dst_sel:DWORD dst_unused:UNUSED_PAD src0_sel:DWORD src1_sel:WORD_1
    ds_read_b64 v[104:105], v104
    ds_read_b64 v[106:107], v106
    v_mfma_f32_16x16x32_bf16 v[112:115], v[84:87], v[156:159], v[112:115]
    v_lshlrev_b32_sdwa v108, 3, v123 dst_sel:DWORD dst_unused:UNUSED_PAD src0_sel:DWORD src1_sel:WORD_0
    v_lshlrev_b32_sdwa v110, 3, v123 dst_sel:DWORD dst_unused:UNUSED_PAD src0_sel:DWORD src1_sel:WORD_1
    ds_read_b64 v[108:109], v108
    ds_read_b64 v[110:111], v110
    s_waitcnt lgkmcnt(8)
    v_add3_u32 v4, v4, v88, v90
    v_add3_u32 v5, v5, v89, v91
    v_add3_u32 v4, v4, v92, v94
    v_add3_u32 v5, v5, v93, v95
    v_perm_b32 v112, v113, v112, s23
    v_perm_b32 v113, v115, v114, s23
    ds_write_b64 v70, v[112:113] offset:32896
    v_lshlrev_b32_sdwa v88, 3, v120 dst_sel:DWORD dst_unused:UNUSED_PAD src0_sel:DWORD src1_sel:WORD_0
    v_lshlrev_b32_sdwa v90, 3, v120 dst_sel:DWORD dst_unused:UNUSED_PAD src0_sel:DWORD src1_sel:WORD_1
    ds_read_b64 v[88:89], v88
    ds_read_b64 v[90:91], v90
    v_lshlrev_b32_sdwa v92, 3, v121 dst_sel:DWORD dst_unused:UNUSED_PAD src0_sel:DWORD src1_sel:WORD_0
    v_lshlrev_b32_sdwa v94, 3, v121 dst_sel:DWORD dst_unused:UNUSED_PAD src0_sel:DWORD src1_sel:WORD_1
    ds_read_b64 v[92:93], v92
    ds_read_b64 v[94:95], v94
    buffer_load_dwordx4 v[120:123], v71, s[12:15], s20 offen offset:2048 sc1
    s_waitcnt lgkmcnt(9)
    v_add3_u32 v4, v4, v96, v98
    v_add3_u32 v5, v5, v97, v99
    v_add3_u32 v4, v4, v100, v102
    v_add3_u32 v5, v5, v101, v103
    v_mfma_f32_16x16x32_bf16 v[112:115], v[72:75], v[160:163], v[66:69]
    s_waitcnt vmcnt(2)
    v_lshlrev_b32_sdwa v96, 3, v126 dst_sel:DWORD dst_unused:UNUSED_PAD src0_sel:DWORD src1_sel:WORD_0
    v_lshlrev_b32_sdwa v98, 3, v126 dst_sel:DWORD dst_unused:UNUSED_PAD src0_sel:DWORD src1_sel:WORD_1
    ds_read_b64 v[96:97], v96
    ds_read_b64 v[98:99], v98
    v_mfma_f32_16x16x32_bf16 v[112:115], v[76:79], v[164:167], v[112:115]
    v_lshlrev_b32_sdwa v100, 3, v127 dst_sel:DWORD dst_unused:UNUSED_PAD src0_sel:DWORD src1_sel:WORD_0
    v_lshlrev_b32_sdwa v102, 3, v127 dst_sel:DWORD dst_unused:UNUSED_PAD src0_sel:DWORD src1_sel:WORD_1
    ds_read_b64 v[100:101], v100
    ds_read_b64 v[102:103], v102
    s_waitcnt lgkmcnt(9)
    v_add3_u32 v6, v6, v104, v106
    v_add3_u32 v7, v7, v105, v107
    v_add3_u32 v6, v6, v108, v110
    v_add3_u32 v7, v7, v109, v111
    v_mfma_f32_16x16x32_bf16 v[112:115], v[80:83], v[168:171], v[112:115]
    v_lshlrev_b32_sdwa v104, 3, v124 dst_sel:DWORD dst_unused:UNUSED_PAD src0_sel:DWORD src1_sel:WORD_0
    v_lshlrev_b32_sdwa v106, 3, v124 dst_sel:DWORD dst_unused:UNUSED_PAD src0_sel:DWORD src1_sel:WORD_1
    ds_read_b64 v[104:105], v104
    ds_read_b64 v[106:107], v106
    v_mfma_f32_16x16x32_bf16 v[112:115], v[84:87], v[172:175], v[112:115]
    v_lshlrev_b32_sdwa v108, 3, v125 dst_sel:DWORD dst_unused:UNUSED_PAD src0_sel:DWORD src1_sel:WORD_0
    v_lshlrev_b32_sdwa v110, 3, v125 dst_sel:DWORD dst_unused:UNUSED_PAD src0_sel:DWORD src1_sel:WORD_1
    ds_read_b64 v[108:109], v108
    ds_read_b64 v[110:111], v110
    buffer_load_dwordx4 v[124:127], v71, s[12:15], s20 offen offset:3072 sc1
    s_waitcnt lgkmcnt(8)
    v_add3_u32 v6, v6, v88, v90
    v_add3_u32 v7, v7, v89, v91
    v_add3_u32 v6, v6, v92, v94
    v_add3_u32 v7, v7, v93, v95
    v_perm_b32 v112, v113, v112, s23
    v_perm_b32 v113, v115, v114, s23
    ds_write_b64 v70, v[112:113] offset:33024
    s_waitcnt vmcnt(2)
    v_lshlrev_b32_sdwa v88, 3, v118 dst_sel:DWORD dst_unused:UNUSED_PAD src0_sel:DWORD src1_sel:WORD_0
    v_lshlrev_b32_sdwa v90, 3, v118 dst_sel:DWORD dst_unused:UNUSED_PAD src0_sel:DWORD src1_sel:WORD_1
    ds_read_b64 v[88:89], v88
    ds_read_b64 v[90:91], v90
    v_lshlrev_b32_sdwa v92, 3, v119 dst_sel:DWORD dst_unused:UNUSED_PAD src0_sel:DWORD src1_sel:WORD_0
    v_lshlrev_b32_sdwa v94, 3, v119 dst_sel:DWORD dst_unused:UNUSED_PAD src0_sel:DWORD src1_sel:WORD_1
    ds_read_b64 v[92:93], v92
    ds_read_b64 v[94:95], v94
    s_waitcnt lgkmcnt(9)
    v_add3_u32 v8, v8, v96, v98
    v_add3_u32 v9, v9, v97, v99
    v_add3_u32 v8, v8, v100, v102
    v_add3_u32 v9, v9, v101, v103
    v_mfma_f32_16x16x32_bf16 v[112:115], v[72:75], v[176:179], v[66:69]
    v_lshlrev_b32_sdwa v96, 3, v116 dst_sel:DWORD dst_unused:UNUSED_PAD src0_sel:DWORD src1_sel:WORD_0
    v_lshlrev_b32_sdwa v98, 3, v116 dst_sel:DWORD dst_unused:UNUSED_PAD src0_sel:DWORD src1_sel:WORD_1
    ds_read_b64 v[96:97], v96
    ds_read_b64 v[98:99], v98
    v_mfma_f32_16x16x32_bf16 v[112:115], v[76:79], v[180:183], v[112:115]
    v_lshlrev_b32_sdwa v100, 3, v117 dst_sel:DWORD dst_unused:UNUSED_PAD src0_sel:DWORD src1_sel:WORD_0
    v_lshlrev_b32_sdwa v102, 3, v117 dst_sel:DWORD dst_unused:UNUSED_PAD src0_sel:DWORD src1_sel:WORD_1
    ds_read_b64 v[100:101], v100
    ds_read_b64 v[102:103], v102
    s_add_u32 s20, s20, 0x1000
    buffer_load_dwordx4 v[116:119], v71, s[12:15], s20 offen offset:0 sc1
    s_waitcnt lgkmcnt(9)
    v_add3_u32 v8, v8, v104, v106
    v_add3_u32 v9, v9, v105, v107
    v_add3_u32 v8, v8, v108, v110
    v_add3_u32 v9, v9, v109, v111
    v_mfma_f32_16x16x32_bf16 v[112:115], v[80:83], v[184:187], v[112:115]
    s_waitcnt vmcnt(2)
    v_lshlrev_b32_sdwa v104, 3, v122 dst_sel:DWORD dst_unused:UNUSED_PAD src0_sel:DWORD src1_sel:WORD_0
    v_lshlrev_b32_sdwa v106, 3, v122 dst_sel:DWORD dst_unused:UNUSED_PAD src0_sel:DWORD src1_sel:WORD_1
    ds_read_b64 v[104:105], v104
    ds_read_b64 v[106:107], v106
    v_mfma_f32_16x16x32_bf16 v[112:115], v[84:87], v[188:191], v[112:115]
    v_lshlrev_b32_sdwa v108, 3, v123 dst_sel:DWORD dst_unused:UNUSED_PAD src0_sel:DWORD src1_sel:WORD_0
    v_lshlrev_b32_sdwa v110, 3, v123 dst_sel:DWORD dst_unused:UNUSED_PAD src0_sel:DWORD src1_sel:WORD_1
    ds_read_b64 v[108:109], v108
    ds_read_b64 v[110:111], v110
    s_waitcnt lgkmcnt(8)
    v_add3_u32 v10, v10, v88, v90
    v_add3_u32 v11, v11, v89, v91
    v_add3_u32 v10, v10, v92, v94
    v_add3_u32 v11, v11, v93, v95
    v_perm_b32 v112, v113, v112, s23
    v_perm_b32 v113, v115, v114, s23
    ds_write_b64 v70, v[112:113] offset:33152
    v_lshlrev_b32_sdwa v88, 3, v120 dst_sel:DWORD dst_unused:UNUSED_PAD src0_sel:DWORD src1_sel:WORD_0
    v_lshlrev_b32_sdwa v90, 3, v120 dst_sel:DWORD dst_unused:UNUSED_PAD src0_sel:DWORD src1_sel:WORD_1
    ds_read_b64 v[88:89], v88
    ds_read_b64 v[90:91], v90
    v_lshlrev_b32_sdwa v92, 3, v121 dst_sel:DWORD dst_unused:UNUSED_PAD src0_sel:DWORD src1_sel:WORD_0
    v_lshlrev_b32_sdwa v94, 3, v121 dst_sel:DWORD dst_unused:UNUSED_PAD src0_sel:DWORD src1_sel:WORD_1
    ds_read_b64 v[92:93], v92
    ds_read_b64 v[94:95], v94
    buffer_load_dwordx4 v[120:123], v71, s[12:15], s20 offen offset:1024 sc1
    s_waitcnt lgkmcnt(9)
    v_add3_u32 v10, v10, v96, v98
    v_add3_u32 v11, v11, v97, v99
    v_add3_u32 v10, v10, v100, v102
    v_add3_u32 v11, v11, v101, v103
    v_mfma_f32_16x16x32_bf16 v[112:115], v[72:75], v[192:195], v[66:69]
    s_waitcnt vmcnt(2)
    v_lshlrev_b32_sdwa v96, 3, v126 dst_sel:DWORD dst_unused:UNUSED_PAD src0_sel:DWORD src1_sel:WORD_0
    v_lshlrev_b32_sdwa v98, 3, v126 dst_sel:DWORD dst_unused:UNUSED_PAD src0_sel:DWORD src1_sel:WORD_1
    ds_read_b64 v[96:97], v96
    ds_read_b64 v[98:99], v98
    v_mfma_f32_16x16x32_bf16 v[112:115], v[76:79], v[196:199], v[112:115]
    v_lshlrev_b32_sdwa v100, 3, v127 dst_sel:DWORD dst_unused:UNUSED_PAD src0_sel:DWORD src1_sel:WORD_0
    v_lshlrev_b32_sdwa v102, 3, v127 dst_sel:DWORD dst_unused:UNUSED_PAD src0_sel:DWORD src1_sel:WORD_1
    ds_read_b64 v[100:101], v100
    ds_read_b64 v[102:103], v102
    s_waitcnt lgkmcnt(9)
    v_add3_u32 v12, v12, v104, v106
    v_add3_u32 v13, v13, v105, v107
    v_add3_u32 v12, v12, v108, v110
    v_add3_u32 v13, v13, v109, v111
    v_mfma_f32_16x16x32_bf16 v[112:115], v[80:83], v[200:203], v[112:115]
    v_lshlrev_b32_sdwa v104, 3, v124 dst_sel:DWORD dst_unused:UNUSED_PAD src0_sel:DWORD src1_sel:WORD_0
    v_lshlrev_b32_sdwa v106, 3, v124 dst_sel:DWORD dst_unused:UNUSED_PAD src0_sel:DWORD src1_sel:WORD_1
    ds_read_b64 v[104:105], v104
    ds_read_b64 v[106:107], v106
    v_mfma_f32_16x16x32_bf16 v[112:115], v[84:87], v[204:207], v[112:115]
    v_lshlrev_b32_sdwa v108, 3, v125 dst_sel:DWORD dst_unused:UNUSED_PAD src0_sel:DWORD src1_sel:WORD_0
    v_lshlrev_b32_sdwa v110, 3, v125 dst_sel:DWORD dst_unused:UNUSED_PAD src0_sel:DWORD src1_sel:WORD_1
    ds_read_b64 v[108:109], v108
    ds_read_b64 v[110:111], v110
    buffer_load_dwordx4 v[124:127], v71, s[12:15], s20 offen offset:2048 sc1
    s_waitcnt lgkmcnt(8)
    v_add3_u32 v12, v12, v88, v90
    v_add3_u32 v13, v13, v89, v91
    v_add3_u32 v12, v12, v92, v94
    v_add3_u32 v13, v13, v93, v95
    v_perm_b32 v112, v113, v112, s23
    v_perm_b32 v113, v115, v114, s23
    ds_write_b64 v70, v[112:113] offset:33280
    s_waitcnt vmcnt(2)
    v_lshlrev_b32_sdwa v88, 3, v118 dst_sel:DWORD dst_unused:UNUSED_PAD src0_sel:DWORD src1_sel:WORD_0
    v_lshlrev_b32_sdwa v90, 3, v118 dst_sel:DWORD dst_unused:UNUSED_PAD src0_sel:DWORD src1_sel:WORD_1
    ds_read_b64 v[88:89], v88
    ds_read_b64 v[90:91], v90
    v_lshlrev_b32_sdwa v92, 3, v119 dst_sel:DWORD dst_unused:UNUSED_PAD src0_sel:DWORD src1_sel:WORD_0
    v_lshlrev_b32_sdwa v94, 3, v119 dst_sel:DWORD dst_unused:UNUSED_PAD src0_sel:DWORD src1_sel:WORD_1
    ds_read_b64 v[92:93], v92
    ds_read_b64 v[94:95], v94
    s_waitcnt lgkmcnt(9)
    v_add3_u32 v14, v14, v96, v98
    v_add3_u32 v15, v15, v97, v99
    v_add3_u32 v14, v14, v100, v102
    v_add3_u32 v15, v15, v101, v103
    s_setprio 2
    v_mfma_f32_16x16x32_bf16 v[112:115], v[72:75], v[208:211], v[66:69]
    v_lshlrev_b32_sdwa v96, 3, v116 dst_sel:DWORD dst_unused:UNUSED_PAD src0_sel:DWORD src1_sel:WORD_0
    v_lshlrev_b32_sdwa v98, 3, v116 dst_sel:DWORD dst_unused:UNUSED_PAD src0_sel:DWORD src1_sel:WORD_1
    ds_read_b64 v[96:97], v96
    ds_read_b64 v[98:99], v98
    v_mfma_f32_16x16x32_bf16 v[112:115], v[76:79], v[212:215], v[112:115]
    v_lshlrev_b32_sdwa v100, 3, v117 dst_sel:DWORD dst_unused:UNUSED_PAD src0_sel:DWORD src1_sel:WORD_0
    v_lshlrev_b32_sdwa v102, 3, v117 dst_sel:DWORD dst_unused:UNUSED_PAD src0_sel:DWORD src1_sel:WORD_1
    ds_read_b64 v[100:101], v100
    ds_read_b64 v[102:103], v102
    buffer_load_dwordx4 v[116:119], v71, s[12:15], s20 offen offset:3072 sc1
    s_waitcnt lgkmcnt(9)
    v_add3_u32 v14, v14, v104, v106
    v_add3_u32 v15, v15, v105, v107
    v_add3_u32 v14, v14, v108, v110
    v_add3_u32 v15, v15, v109, v111
    v_mfma_f32_16x16x32_bf16 v[112:115], v[80:83], v[216:219], v[112:115]
    s_waitcnt vmcnt(2)
    v_lshlrev_b32_sdwa v104, 3, v122 dst_sel:DWORD dst_unused:UNUSED_PAD src0_sel:DWORD src1_sel:WORD_0
    v_lshlrev_b32_sdwa v106, 3, v122 dst_sel:DWORD dst_unused:UNUSED_PAD src0_sel:DWORD src1_sel:WORD_1
    ds_read_b64 v[104:105], v104
    ds_read_b64 v[106:107], v106
    v_mfma_f32_16x16x32_bf16 v[112:115], v[84:87], v[220:223], v[112:115]
    v_lshlrev_b32_sdwa v108, 3, v123 dst_sel:DWORD dst_unused:UNUSED_PAD src0_sel:DWORD src1_sel:WORD_0
    v_lshlrev_b32_sdwa v110, 3, v123 dst_sel:DWORD dst_unused:UNUSED_PAD src0_sel:DWORD src1_sel:WORD_1
    ds_read_b64 v[108:109], v108
    ds_read_b64 v[110:111], v110
    s_waitcnt lgkmcnt(8)
    v_add3_u32 v16, v16, v88, v90
    v_add3_u32 v17, v17, v89, v91
    v_add3_u32 v16, v16, v92, v94
    v_add3_u32 v17, v17, v93, v95
    v_perm_b32 v112, v113, v112, s23
    v_perm_b32 v113, v115, v114, s23
    ds_write_b64 v70, v[112:113] offset:33408
    v_lshlrev_b32_sdwa v88, 3, v120 dst_sel:DWORD dst_unused:UNUSED_PAD src0_sel:DWORD src1_sel:WORD_0
    v_lshlrev_b32_sdwa v90, 3, v120 dst_sel:DWORD dst_unused:UNUSED_PAD src0_sel:DWORD src1_sel:WORD_1
    ds_read_b64 v[88:89], v88
    ds_read_b64 v[90:91], v90
    v_lshlrev_b32_sdwa v92, 3, v121 dst_sel:DWORD dst_unused:UNUSED_PAD src0_sel:DWORD src1_sel:WORD_0
    v_lshlrev_b32_sdwa v94, 3, v121 dst_sel:DWORD dst_unused:UNUSED_PAD src0_sel:DWORD src1_sel:WORD_1
    ds_read_b64 v[92:93], v92
    ds_read_b64 v[94:95], v94
    s_add_u32 s20, s20, 0x1000
    buffer_load_dwordx4 v[120:123], v71, s[12:15], s20 offen offset:0 sc1
    s_waitcnt lgkmcnt(9)
    v_add3_u32 v16, v16, v96, v98
    v_add3_u32 v17, v17, v97, v99
    v_add3_u32 v16, v16, v100, v102
    v_add3_u32 v17, v17, v101, v103
    v_mfma_f32_16x16x32_bf16 v[112:115], v[72:75], v[224:227], v[66:69]
    s_waitcnt vmcnt(2)
    v_lshlrev_b32_sdwa v96, 3, v126 dst_sel:DWORD dst_unused:UNUSED_PAD src0_sel:DWORD src1_sel:WORD_0
    v_lshlrev_b32_sdwa v98, 3, v126 dst_sel:DWORD dst_unused:UNUSED_PAD src0_sel:DWORD src1_sel:WORD_1
    ds_read_b64 v[96:97], v96
    ds_read_b64 v[98:99], v98
    v_mfma_f32_16x16x32_bf16 v[112:115], v[76:79], v[228:231], v[112:115]
    v_lshlrev_b32_sdwa v100, 3, v127 dst_sel:DWORD dst_unused:UNUSED_PAD src0_sel:DWORD src1_sel:WORD_0
    v_lshlrev_b32_sdwa v102, 3, v127 dst_sel:DWORD dst_unused:UNUSED_PAD src0_sel:DWORD src1_sel:WORD_1
    ds_read_b64 v[100:101], v100
    ds_read_b64 v[102:103], v102
    s_waitcnt lgkmcnt(9)
    v_add3_u32 v18, v18, v104, v106
    v_add3_u32 v19, v19, v105, v107
    v_add3_u32 v18, v18, v108, v110
    v_add3_u32 v19, v19, v109, v111
    v_mfma_f32_16x16x32_bf16 v[112:115], v[80:83], v[232:235], v[112:115]
    v_lshlrev_b32_sdwa v104, 3, v124 dst_sel:DWORD dst_unused:UNUSED_PAD src0_sel:DWORD src1_sel:WORD_0
    v_lshlrev_b32_sdwa v106, 3, v124 dst_sel:DWORD dst_unused:UNUSED_PAD src0_sel:DWORD src1_sel:WORD_1
    ds_read_b64 v[104:105], v104
    ds_read_b64 v[106:107], v106
    v_mfma_f32_16x16x32_bf16 v[112:115], v[84:87], v[236:239], v[112:115]
    v_lshlrev_b32_sdwa v108, 3, v125 dst_sel:DWORD dst_unused:UNUSED_PAD src0_sel:DWORD src1_sel:WORD_0
    v_lshlrev_b32_sdwa v110, 3, v125 dst_sel:DWORD dst_unused:UNUSED_PAD src0_sel:DWORD src1_sel:WORD_1
    ds_read_b64 v[108:109], v108
    ds_read_b64 v[110:111], v110
    buffer_load_dwordx4 v[124:127], v71, s[12:15], s20 offen offset:1024 sc1
    s_waitcnt lgkmcnt(8)
    v_add3_u32 v18, v18, v88, v90
    v_add3_u32 v19, v19, v89, v91
    v_add3_u32 v18, v18, v92, v94
    v_add3_u32 v19, v19, v93, v95
    v_perm_b32 v112, v113, v112, s23
    v_perm_b32 v113, v115, v114, s23
    ds_write_b64 v70, v[112:113] offset:33536
    s_waitcnt vmcnt(2)
    v_lshlrev_b32_sdwa v88, 3, v118 dst_sel:DWORD dst_unused:UNUSED_PAD src0_sel:DWORD src1_sel:WORD_0
    v_lshlrev_b32_sdwa v90, 3, v118 dst_sel:DWORD dst_unused:UNUSED_PAD src0_sel:DWORD src1_sel:WORD_1
    ds_read_b64 v[88:89], v88
    ds_read_b64 v[90:91], v90
    v_lshlrev_b32_sdwa v92, 3, v119 dst_sel:DWORD dst_unused:UNUSED_PAD src0_sel:DWORD src1_sel:WORD_0
    v_lshlrev_b32_sdwa v94, 3, v119 dst_sel:DWORD dst_unused:UNUSED_PAD src0_sel:DWORD src1_sel:WORD_1
    ds_read_b64 v[92:93], v92
    ds_read_b64 v[94:95], v94
    s_waitcnt lgkmcnt(9)
    v_add3_u32 v20, v20, v96, v98
    v_add3_u32 v21, v21, v97, v99
    v_add3_u32 v20, v20, v100, v102
    v_add3_u32 v21, v21, v101, v103
    v_mfma_f32_16x16x32_bf16 v[112:115], v[72:75], v[240:243], v[66:69]
    buffer_load_dwordx4 v[72:75], v71, s[12:15], s21 offen offset:0
    v_lshlrev_b32_sdwa v96, 3, v116 dst_sel:DWORD dst_unused:UNUSED_PAD src0_sel:DWORD src1_sel:WORD_0
    v_lshlrev_b32_sdwa v98, 3, v116 dst_sel:DWORD dst_unused:UNUSED_PAD src0_sel:DWORD src1_sel:WORD_1
    ds_read_b64 v[96:97], v96
    ds_read_b64 v[98:99], v98
    v_mfma_f32_16x16x32_bf16 v[112:115], v[76:79], v[244:247], v[112:115]
    buffer_load_dwordx4 v[76:79], v71, s[12:15], s21 offen offset:1024
    v_lshlrev_b32_sdwa v100, 3, v117 dst_sel:DWORD dst_unused:UNUSED_PAD src0_sel:DWORD src1_sel:WORD_0
    v_lshlrev_b32_sdwa v102, 3, v117 dst_sel:DWORD dst_unused:UNUSED_PAD src0_sel:DWORD src1_sel:WORD_1
    ds_read_b64 v[100:101], v100
    ds_read_b64 v[102:103], v102
    buffer_load_dwordx4 v[116:119], v71, s[12:15], s20 offen offset:2048 sc1
    s_waitcnt lgkmcnt(9)
    v_add3_u32 v20, v20, v104, v106
    v_add3_u32 v21, v21, v105, v107
    v_add3_u32 v20, v20, v108, v110
    v_add3_u32 v21, v21, v109, v111
    v_mfma_f32_16x16x32_bf16 v[112:115], v[80:83], v[248:251], v[112:115]
    buffer_load_dwordx4 v[80:83], v71, s[12:15], s19 offen offset:0
    s_waitcnt vmcnt(5)
    v_lshlrev_b32_sdwa v104, 3, v122 dst_sel:DWORD dst_unused:UNUSED_PAD src0_sel:DWORD src1_sel:WORD_0
    v_lshlrev_b32_sdwa v106, 3, v122 dst_sel:DWORD dst_unused:UNUSED_PAD src0_sel:DWORD src1_sel:WORD_1
    ds_read_b64 v[104:105], v104
    ds_read_b64 v[106:107], v106
    v_mfma_f32_16x16x32_bf16 v[112:115], v[84:87], v[252:255], v[112:115]
    buffer_load_dwordx4 v[84:87], v71, s[12:15], s19 offen offset:1024
    s_add_u32 s21, s21, 4096
    s_add_u32 s19, s19, 4096
    v_lshlrev_b32_sdwa v108, 3, v123 dst_sel:DWORD dst_unused:UNUSED_PAD src0_sel:DWORD src1_sel:WORD_0
    v_lshlrev_b32_sdwa v110, 3, v123 dst_sel:DWORD dst_unused:UNUSED_PAD src0_sel:DWORD src1_sel:WORD_1
    ds_read_b64 v[108:109], v108
    ds_read_b64 v[110:111], v110
    s_waitcnt lgkmcnt(8)
    v_add3_u32 v22, v22, v88, v90
    v_add3_u32 v23, v23, v89, v91
    v_add3_u32 v22, v22, v92, v94
    v_add3_u32 v23, v23, v93, v95
    v_perm_b32 v112, v113, v112, s23
    v_perm_b32 v113, v115, v114, s23
    ds_write_b64 v70, v[112:113] offset:33664
    s_setprio 1
    v_lshlrev_b32_sdwa v88, 3, v120 dst_sel:DWORD dst_unused:UNUSED_PAD src0_sel:DWORD src1_sel:WORD_0
    v_lshlrev_b32_sdwa v90, 3, v120 dst_sel:DWORD dst_unused:UNUSED_PAD src0_sel:DWORD src1_sel:WORD_1
    ds_read_b64 v[88:89], v88
    ds_read_b64 v[90:91], v90
    v_lshlrev_b32_sdwa v92, 3, v121 dst_sel:DWORD dst_unused:UNUSED_PAD src0_sel:DWORD src1_sel:WORD_0
    v_lshlrev_b32_sdwa v94, 3, v121 dst_sel:DWORD dst_unused:UNUSED_PAD src0_sel:DWORD src1_sel:WORD_1
    ds_read_b64 v[92:93], v92
    ds_read_b64 v[94:95], v94
    buffer_load_dwordx4 v[120:123], v71, s[12:15], s20 offen offset:3072 sc1
    s_waitcnt lgkmcnt(9)
    v_add3_u32 v22, v22, v96, v98
    v_add3_u32 v23, v23, v97, v99
    v_add3_u32 v22, v22, v100, v102
    v_add3_u32 v23, v23, v101, v103
    s_waitcnt vmcnt(6)
    v_lshlrev_b32_sdwa v96, 3, v126 dst_sel:DWORD dst_unused:UNUSED_PAD src0_sel:DWORD src1_sel:WORD_0
    v_lshlrev_b32_sdwa v98, 3, v126 dst_sel:DWORD dst_unused:UNUSED_PAD src0_sel:DWORD src1_sel:WORD_1
    ds_read_b64 v[96:97], v96
    ds_read_b64 v[98:99], v98
    v_lshlrev_b32_sdwa v100, 3, v127 dst_sel:DWORD dst_unused:UNUSED_PAD src0_sel:DWORD src1_sel:WORD_0
    v_lshlrev_b32_sdwa v102, 3, v127 dst_sel:DWORD dst_unused:UNUSED_PAD src0_sel:DWORD src1_sel:WORD_1
    ds_read_b64 v[100:101], v100
    ds_read_b64 v[102:103], v102
    s_waitcnt lgkmcnt(9)
    v_add3_u32 v24, v24, v104, v106
    v_add3_u32 v25, v25, v105, v107
    v_add3_u32 v24, v24, v108, v110
    v_add3_u32 v25, v25, v109, v111
    v_lshlrev_b32_sdwa v104, 3, v124 dst_sel:DWORD dst_unused:UNUSED_PAD src0_sel:DWORD src1_sel:WORD_0
    v_lshlrev_b32_sdwa v106, 3, v124 dst_sel:DWORD dst_unused:UNUSED_PAD src0_sel:DWORD src1_sel:WORD_1
    ds_read_b64 v[104:105], v104
    ds_read_b64 v[106:107], v106
    v_lshlrev_b32_sdwa v108, 3, v125 dst_sel:DWORD dst_unused:UNUSED_PAD src0_sel:DWORD src1_sel:WORD_0
    v_lshlrev_b32_sdwa v110, 3, v125 dst_sel:DWORD dst_unused:UNUSED_PAD src0_sel:DWORD src1_sel:WORD_1
    ds_read_b64 v[108:109], v108
    ds_read_b64 v[110:111], v110
    s_add_u32 s20, s20, 0x1d000
    buffer_load_dwordx4 v[124:127], v71, s[12:15], s20 offen offset:0 sc1
    s_waitcnt lgkmcnt(8)
    v_add3_u32 v24, v24, v88, v90
    v_add3_u32 v25, v25, v89, v91
    v_add3_u32 v24, v24, v92, v94
    v_add3_u32 v25, v25, v93, v95
    s_waitcnt vmcnt(4)
    v_lshlrev_b32_sdwa v88, 3, v118 dst_sel:DWORD dst_unused:UNUSED_PAD src0_sel:DWORD src1_sel:WORD_0
    v_lshlrev_b32_sdwa v90, 3, v118 dst_sel:DWORD dst_unused:UNUSED_PAD src0_sel:DWORD src1_sel:WORD_1
    ds_read_b64 v[88:89], v88
    ds_read_b64 v[90:91], v90
    v_lshlrev_b32_sdwa v92, 3, v119 dst_sel:DWORD dst_unused:UNUSED_PAD src0_sel:DWORD src1_sel:WORD_0
    v_lshlrev_b32_sdwa v94, 3, v119 dst_sel:DWORD dst_unused:UNUSED_PAD src0_sel:DWORD src1_sel:WORD_1
    ds_read_b64 v[92:93], v92
    ds_read_b64 v[94:95], v94
    s_waitcnt lgkmcnt(8)
    v_add3_u32 v26, v26, v96, v98
    v_add3_u32 v27, v27, v97, v99
    v_add3_u32 v26, v26, v100, v102
    v_add3_u32 v27, v27, v101, v103
    v_lshlrev_b32_sdwa v96, 3, v116 dst_sel:DWORD dst_unused:UNUSED_PAD src0_sel:DWORD src1_sel:WORD_0
    v_lshlrev_b32_sdwa v98, 3, v116 dst_sel:DWORD dst_unused:UNUSED_PAD src0_sel:DWORD src1_sel:WORD_1
    ds_read_b64 v[96:97], v96
    ds_read_b64 v[98:99], v98
    v_lshlrev_b32_sdwa v100, 3, v117 dst_sel:DWORD dst_unused:UNUSED_PAD src0_sel:DWORD src1_sel:WORD_0
    v_lshlrev_b32_sdwa v102, 3, v117 dst_sel:DWORD dst_unused:UNUSED_PAD src0_sel:DWORD src1_sel:WORD_1
    ds_read_b64 v[100:101], v100
    ds_read_b64 v[102:103], v102
    buffer_load_dwordx4 v[116:119], v71, s[12:15], s20 offen offset:1024 sc1
    s_waitcnt lgkmcnt(8)
    v_add3_u32 v26, v26, v104, v106
    v_add3_u32 v27, v27, v105, v107
    v_add3_u32 v26, v26, v108, v110
    v_add3_u32 v27, v27, v109, v111
    s_waitcnt vmcnt(2)
    v_lshlrev_b32_sdwa v104, 3, v122 dst_sel:DWORD dst_unused:UNUSED_PAD src0_sel:DWORD src1_sel:WORD_0
    v_lshlrev_b32_sdwa v106, 3, v122 dst_sel:DWORD dst_unused:UNUSED_PAD src0_sel:DWORD src1_sel:WORD_1
    ds_read_b64 v[104:105], v104
    ds_read_b64 v[106:107], v106
    v_lshlrev_b32_sdwa v108, 3, v123 dst_sel:DWORD dst_unused:UNUSED_PAD src0_sel:DWORD src1_sel:WORD_0
    v_lshlrev_b32_sdwa v110, 3, v123 dst_sel:DWORD dst_unused:UNUSED_PAD src0_sel:DWORD src1_sel:WORD_1
    ds_read_b64 v[108:109], v108
    ds_read_b64 v[110:111], v110
    s_waitcnt lgkmcnt(8)
    v_add3_u32 v28, v28, v88, v90
    v_add3_u32 v29, v29, v89, v91
    v_add3_u32 v28, v28, v92, v94
    v_add3_u32 v29, v29, v93, v95
    s_setprio 0
    v_lshlrev_b32_sdwa v88, 3, v120 dst_sel:DWORD dst_unused:UNUSED_PAD src0_sel:DWORD src1_sel:WORD_0
    v_lshlrev_b32_sdwa v90, 3, v120 dst_sel:DWORD dst_unused:UNUSED_PAD src0_sel:DWORD src1_sel:WORD_1
    ds_read_b64 v[88:89], v88
    ds_read_b64 v[90:91], v90
    v_lshlrev_b32_sdwa v92, 3, v121 dst_sel:DWORD dst_unused:UNUSED_PAD src0_sel:DWORD src1_sel:WORD_0
    v_lshlrev_b32_sdwa v94, 3, v121 dst_sel:DWORD dst_unused:UNUSED_PAD src0_sel:DWORD src1_sel:WORD_1
    ds_read_b64 v[92:93], v92
    ds_read_b64 v[94:95], v94
    buffer_load_dwordx4 v[120:123], v71, s[12:15], s20 offen offset:2048 sc1
    s_waitcnt lgkmcnt(8)
    v_add3_u32 v28, v28, v96, v98
    v_add3_u32 v29, v29, v97, v99
    v_add3_u32 v28, v28, v100, v102
    v_add3_u32 v29, v29, v101, v103
    s_waitcnt vmcnt(2)
    v_lshlrev_b32_sdwa v96, 3, v124 dst_sel:DWORD dst_unused:UNUSED_PAD src0_sel:DWORD src1_sel:WORD_0
    v_lshlrev_b32_sdwa v98, 3, v124 dst_sel:DWORD dst_unused:UNUSED_PAD src0_sel:DWORD src1_sel:WORD_1
    ds_read_b64 v[96:97], v96
    ds_read_b64 v[98:99], v98
    v_lshlrev_b32_sdwa v100, 3, v125 dst_sel:DWORD dst_unused:UNUSED_PAD src0_sel:DWORD src1_sel:WORD_0
    v_lshlrev_b32_sdwa v102, 3, v125 dst_sel:DWORD dst_unused:UNUSED_PAD src0_sel:DWORD src1_sel:WORD_1
    ds_read_b64 v[100:101], v100
    ds_read_b64 v[102:103], v102
    s_waitcnt lgkmcnt(8)
    v_add3_u32 v30, v30, v104, v106
    v_add3_u32 v31, v31, v105, v107
    v_add3_u32 v30, v30, v108, v110
    v_add3_u32 v31, v31, v109, v111
    s_waitcnt lgkmcnt(4)
    s_barrier
    s_setprio 3
    v_lshlrev_b32_sdwa v104, 3, v126 dst_sel:DWORD dst_unused:UNUSED_PAD src0_sel:DWORD src1_sel:WORD_0
    v_lshlrev_b32_sdwa v106, 3, v126 dst_sel:DWORD dst_unused:UNUSED_PAD src0_sel:DWORD src1_sel:WORD_1
    ds_read_b64 v[104:105], v104
    ds_read_b64 v[106:107], v106
    v_lshlrev_b32_sdwa v108, 3, v127 dst_sel:DWORD dst_unused:UNUSED_PAD src0_sel:DWORD src1_sel:WORD_0
    v_lshlrev_b32_sdwa v110, 3, v127 dst_sel:DWORD dst_unused:UNUSED_PAD src0_sel:DWORD src1_sel:WORD_1
    ds_read_b64 v[108:109], v108
    ds_read_b64 v[110:111], v110
    buffer_load_dwordx4 v[124:127], v71, s[12:15], s20 offen offset:3072 sc1
    v_add3_u32 v30, v30, v88, v90
    v_add3_u32 v31, v31, v89, v91
    v_add3_u32 v30, v30, v92, v94
    v_add3_u32 v31, v31, v93, v95
    v_mfma_f32_16x16x32_bf16 v[112:115], v[72:75], v[128:131], v[66:69]
    v_mfma_f32_16x16x32_bf16 v[112:115], v[76:79], v[132:135], v[112:115]
    v_add_u32 v70, 0x10000, v70
    s_waitcnt vmcnt(2)
    v_lshlrev_b32_sdwa v88, 3, v116 dst_sel:DWORD dst_unused:UNUSED_PAD src0_sel:DWORD src1_sel:WORD_0
    v_lshlrev_b32_sdwa v90, 3, v116 dst_sel:DWORD dst_unused:UNUSED_PAD src0_sel:DWORD src1_sel:WORD_1
    ds_read_b64 v[88:89], v88
    ds_read_b64 v[90:91], v90
    v_mfma_f32_16x16x32_bf16 v[112:115], v[80:83], v[136:139], v[112:115]
    v_mfma_f32_16x16x32_bf16 v[112:115], v[84:87], v[140:143], v[112:115]
    v_lshlrev_b32_sdwa v92, 3, v117 dst_sel:DWORD dst_unused:UNUSED_PAD src0_sel:DWORD src1_sel:WORD_0
    v_lshlrev_b32_sdwa v94, 3, v117 dst_sel:DWORD dst_unused:UNUSED_PAD src0_sel:DWORD src1_sel:WORD_1
    ds_read_b64 v[92:93], v92
    ds_read_b64 v[94:95], v94
    s_waitcnt lgkmcnt(8)
    v_add3_u32 v32, v32, v96, v98
    v_add3_u32 v33, v33, v97, v99
    v_add3_u32 v32, v32, v100, v102
    v_add3_u32 v33, v33, v101, v103
    v_perm_b32 v112, v113, v112, s23
    v_perm_b32 v113, v115, v114, s23
    ds_write_b64 v70, v[112:113] offset:0
    v_mfma_f32_16x16x32_bf16 v[112:115], v[72:75], v[144:147], v[66:69]
    v_mfma_f32_16x16x32_bf16 v[112:115], v[76:79], v[148:151], v[112:115]
    v_lshlrev_b32_sdwa v96, 3, v118 dst_sel:DWORD dst_unused:UNUSED_PAD src0_sel:DWORD src1_sel:WORD_0
    v_lshlrev_b32_sdwa v98, 3, v118 dst_sel:DWORD dst_unused:UNUSED_PAD src0_sel:DWORD src1_sel:WORD_1
    ds_read_b64 v[96:97], v96
    ds_read_b64 v[98:99], v98
    v_mfma_f32_16x16x32_bf16 v[112:115], v[80:83], v[152:155], v[112:115]
    v_mfma_f32_16x16x32_bf16 v[112:115], v[84:87], v[156:159], v[112:115]
    v_lshlrev_b32_sdwa v100, 3, v119 dst_sel:DWORD dst_unused:UNUSED_PAD src0_sel:DWORD src1_sel:WORD_0
    v_lshlrev_b32_sdwa v102, 3, v119 dst_sel:DWORD dst_unused:UNUSED_PAD src0_sel:DWORD src1_sel:WORD_1
    ds_read_b64 v[100:101], v100
    ds_read_b64 v[102:103], v102
    s_add_u32 s20, s20, 0x1000
    buffer_load_dwordx4 v[116:119], v71, s[12:15], s20 offen offset:0 sc1
    s_waitcnt lgkmcnt(9)
    v_add3_u32 v32, v32, v104, v106
    v_add3_u32 v33, v33, v105, v107
    v_add3_u32 v32, v32, v108, v110
    v_add3_u32 v33, v33, v109, v111
    v_perm_b32 v112, v113, v112, s23
    v_perm_b32 v113, v115, v114, s23
    ds_write_b64 v70, v[112:113] offset:128
    v_mfma_f32_16x16x32_bf16 v[112:115], v[72:75], v[160:163], v[66:69]
    v_mfma_f32_16x16x32_bf16 v[112:115], v[76:79], v[164:167], v[112:115]
    s_waitcnt vmcnt(2)
    v_lshlrev_b32_sdwa v104, 3, v120 dst_sel:DWORD dst_unused:UNUSED_PAD src0_sel:DWORD src1_sel:WORD_0
    v_lshlrev_b32_sdwa v106, 3, v120 dst_sel:DWORD dst_unused:UNUSED_PAD src0_sel:DWORD src1_sel:WORD_1
    ds_read_b64 v[104:105], v104
    ds_read_b64 v[106:107], v106
    v_mfma_f32_16x16x32_bf16 v[112:115], v[80:83], v[168:171], v[112:115]
    v_mfma_f32_16x16x32_bf16 v[112:115], v[84:87], v[172:175], v[112:115]
    v_lshlrev_b32_sdwa v108, 3, v121 dst_sel:DWORD dst_unused:UNUSED_PAD src0_sel:DWORD src1_sel:WORD_0
    v_lshlrev_b32_sdwa v110, 3, v121 dst_sel:DWORD dst_unused:UNUSED_PAD src0_sel:DWORD src1_sel:WORD_1
    ds_read_b64 v[108:109], v108
    ds_read_b64 v[110:111], v110
    s_waitcnt lgkmcnt(10)
    v_add3_u32 v34, v34, v88, v90
    v_add3_u32 v35, v35, v89, v91
    v_add3_u32 v34, v34, v92, v94
    v_add3_u32 v35, v35, v93, v95
    v_perm_b32 v112, v113, v112, s23
    v_perm_b32 v113, v115, v114, s23
    ds_write_b64 v70, v[112:113] offset:256
    v_mfma_f32_16x16x32_bf16 v[112:115], v[72:75], v[176:179], v[66:69]
    v_mfma_f32_16x16x32_bf16 v[112:115], v[76:79], v[180:183], v[112:115]
    v_lshlrev_b32_sdwa v88, 3, v122 dst_sel:DWORD dst_unused:UNUSED_PAD src0_sel:DWORD src1_sel:WORD_0
    v_lshlrev_b32_sdwa v90, 3, v122 dst_sel:DWORD dst_unused:UNUSED_PAD src0_sel:DWORD src1_sel:WORD_1
    ds_read_b64 v[88:89], v88
    ds_read_b64 v[90:91], v90
    v_mfma_f32_16x16x32_bf16 v[112:115], v[80:83], v[184:187], v[112:115]
    v_mfma_f32_16x16x32_bf16 v[112:115], v[84:87], v[188:191], v[112:115]
    v_lshlrev_b32_sdwa v92, 3, v123 dst_sel:DWORD dst_unused:UNUSED_PAD src0_sel:DWORD src1_sel:WORD_0
    v_lshlrev_b32_sdwa v94, 3, v123 dst_sel:DWORD dst_unused:UNUSED_PAD src0_sel:DWORD src1_sel:WORD_1
    ds_read_b64 v[92:93], v92
    ds_read_b64 v[94:95], v94
    buffer_load_dwordx4 v[120:123], v71, s[12:15], s20 offen offset:1024 sc1
    s_waitcnt lgkmcnt(10)
    v_add3_u32 v34, v34, v96, v98
    v_add3_u32 v35, v35, v97, v99
    v_add3_u32 v34, v34, v100, v102
    v_add3_u32 v35, v35, v101, v103
    v_perm_b32 v112, v113, v112, s23
    v_perm_b32 v113, v115, v114, s23
    ds_write_b64 v70, v[112:113] offset:384
    v_mfma_f32_16x16x32_bf16 v[112:115], v[72:75], v[192:195], v[66:69]
    v_mfma_f32_16x16x32_bf16 v[112:115], v[76:79], v[196:199], v[112:115]
    s_waitcnt vmcnt(2)
    v_lshlrev_b32_sdwa v96, 3, v124 dst_sel:DWORD dst_unused:UNUSED_PAD src0_sel:DWORD src1_sel:WORD_0
    v_lshlrev_b32_sdwa v98, 3, v124 dst_sel:DWORD dst_unused:UNUSED_PAD src0_sel:DWORD src1_sel:WORD_1
    ds_read_b64 v[96:97], v96
    ds_read_b64 v[98:99], v98
    v_mfma_f32_16x16x32_bf16 v[112:115], v[80:83], v[200:203], v[112:115]
    v_mfma_f32_16x16x32_bf16 v[112:115], v[84:87], v[204:207], v[112:115]
    v_lshlrev_b32_sdwa v100, 3, v125 dst_sel:DWORD dst_unused:UNUSED_PAD src0_sel:DWORD src1_sel:WORD_0
    v_lshlrev_b32_sdwa v102, 3, v125 dst_sel:DWORD dst_unused:UNUSED_PAD src0_sel:DWORD src1_sel:WORD_1
    ds_read_b64 v[100:101], v100
    ds_read_b64 v[102:103], v102
    s_waitcnt lgkmcnt(10)
    v_add3_u32 v36, v36, v104, v106
    v_add3_u32 v37, v37, v105, v107
    v_add3_u32 v36, v36, v108, v110
    v_add3_u32 v37, v37, v109, v111
    v_perm_b32 v112, v113, v112, s23
    v_perm_b32 v113, v115, v114, s23
    ds_write_b64 v70, v[112:113] offset:512
    v_mfma_f32_16x16x32_bf16 v[112:115], v[72:75], v[208:211], v[66:69]
    v_mfma_f32_16x16x32_bf16 v[112:115], v[76:79], v[212:215], v[112:115]
    v_lshlrev_b32_sdwa v104, 3, v126 dst_sel:DWORD dst_unused:UNUSED_PAD src0_sel:DWORD src1_sel:WORD_0
    v_lshlrev_b32_sdwa v106, 3, v126 dst_sel:DWORD dst_unused:UNUSED_PAD src0_sel:DWORD src1_sel:WORD_1
    ds_read_b64 v[104:105], v104
    ds_read_b64 v[106:107], v106
    v_mfma_f32_16x16x32_bf16 v[112:115], v[80:83], v[216:219], v[112:115]
    v_mfma_f32_16x16x32_bf16 v[112:115], v[84:87], v[220:223], v[112:115]
    v_lshlrev_b32_sdwa v108, 3, v127 dst_sel:DWORD dst_unused:UNUSED_PAD src0_sel:DWORD src1_sel:WORD_0
    v_lshlrev_b32_sdwa v110, 3, v127 dst_sel:DWORD dst_unused:UNUSED_PAD src0_sel:DWORD src1_sel:WORD_1
    ds_read_b64 v[108:109], v108
    ds_read_b64 v[110:111], v110
    buffer_load_dwordx4 v[124:127], v71, s[12:15], s20 offen offset:2048 sc1
    s_waitcnt lgkmcnt(10)
    v_add3_u32 v36, v36, v88, v90
    v_add3_u32 v37, v37, v89, v91
    v_add3_u32 v36, v36, v92, v94
    v_add3_u32 v37, v37, v93, v95
    v_perm_b32 v112, v113, v112, s23
    v_perm_b32 v113, v115, v114, s23
    ds_write_b64 v70, v[112:113] offset:640
    v_mfma_f32_16x16x32_bf16 v[112:115], v[72:75], v[224:227], v[66:69]
    v_mfma_f32_16x16x32_bf16 v[112:115], v[76:79], v[228:231], v[112:115]
    s_waitcnt vmcnt(2)
    v_lshlrev_b32_sdwa v88, 3, v116 dst_sel:DWORD dst_unused:UNUSED_PAD src0_sel:DWORD src1_sel:WORD_0
    v_lshlrev_b32_sdwa v90, 3, v116 dst_sel:DWORD dst_unused:UNUSED_PAD src0_sel:DWORD src1_sel:WORD_1
    ds_read_b64 v[88:89], v88
    ds_read_b64 v[90:91], v90
    v_mfma_f32_16x16x32_bf16 v[112:115], v[80:83], v[232:235], v[112:115]
    v_mfma_f32_16x16x32_bf16 v[112:115], v[84:87], v[236:239], v[112:115]
    v_lshlrev_b32_sdwa v92, 3, v117 dst_sel:DWORD dst_unused:UNUSED_PAD src0_sel:DWORD src1_sel:WORD_0
    v_lshlrev_b32_sdwa v94, 3, v117 dst_sel:DWORD dst_unused:UNUSED_PAD src0_sel:DWORD src1_sel:WORD_1
    ds_read_b64 v[92:93], v92
    ds_read_b64 v[94:95], v94
    s_waitcnt lgkmcnt(10)
    v_add3_u32 v38, v38, v96, v98
    v_add3_u32 v39, v39, v97, v99
    v_add3_u32 v38, v38, v100, v102
    v_add3_u32 v39, v39, v101, v103
    v_perm_b32 v112, v113, v112, s23
    v_perm_b32 v113, v115, v114, s23
    ds_write_b64 v70, v[112:113] offset:768
    v_mfma_f32_16x16x32_bf16 v[112:115], v[72:75], v[240:243], v[66:69]
    buffer_load_dwordx4 v[72:75], v71, s[12:15], s21 offen offset:0
    v_mfma_f32_16x16x32_bf16 v[112:115], v[76:79], v[244:247], v[112:115]
    buffer_load_dwordx4 v[76:79], v71, s[12:15], s21 offen offset:1024
    v_lshlrev_b32_sdwa v96, 3, v118 dst_sel:DWORD dst_unused:UNUSED_PAD src0_sel:DWORD src1_sel:WORD_0
    v_lshlrev_b32_sdwa v98, 3, v118 dst_sel:DWORD dst_unused:UNUSED_PAD src0_sel:DWORD src1_sel:WORD_1
    ds_read_b64 v[96:97], v96
    ds_read_b64 v[98:99], v98
    v_mfma_f32_16x16x32_bf16 v[112:115], v[80:83], v[248:251], v[112:115]
    buffer_load_dwordx4 v[80:83], v71, s[12:15], s19 offen offset:0
    v_mfma_f32_16x16x32_bf16 v[112:115], v[84:87], v[252:255], v[112:115]
    buffer_load_dwordx4 v[84:87], v71, s[12:15], s19 offen offset:1024
    s_add_u32 s21, s21, 4096
    s_add_u32 s19, s19, 4096
    v_lshlrev_b32_sdwa v100, 3, v119 dst_sel:DWORD dst_unused:UNUSED_PAD src0_sel:DWORD src1_sel:WORD_0
    v_lshlrev_b32_sdwa v102, 3, v119 dst_sel:DWORD dst_unused:UNUSED_PAD src0_sel:DWORD src1_sel:WORD_1
    ds_read_b64 v[100:101], v100
    ds_read_b64 v[102:103], v102
    buffer_load_dwordx4 v[116:119], v71, s[12:15], s20 offen offset:3072 sc1
    s_waitcnt lgkmcnt(10)
    v_add3_u32 v38, v38, v104, v106
    v_add3_u32 v39, v39, v105, v107
    v_add3_u32 v38, v38, v108, v110
    v_add3_u32 v39, v39, v109, v111
    v_perm_b32 v112, v113, v112, s23
    v_perm_b32 v113, v115, v114, s23
    ds_write_b64 v70, v[112:113] offset:896
    s_waitcnt vmcnt(6)
    v_lshlrev_b32_sdwa v104, 3, v120 dst_sel:DWORD dst_unused:UNUSED_PAD src0_sel:DWORD src1_sel:WORD_0
    v_lshlrev_b32_sdwa v106, 3, v120 dst_sel:DWORD dst_unused:UNUSED_PAD src0_sel:DWORD src1_sel:WORD_1
    ds_read_b64 v[104:105], v104
    ds_read_b64 v[106:107], v106
    v_lshlrev_b32_sdwa v108, 3, v121 dst_sel:DWORD dst_unused:UNUSED_PAD src0_sel:DWORD src1_sel:WORD_0
    v_lshlrev_b32_sdwa v110, 3, v121 dst_sel:DWORD dst_unused:UNUSED_PAD src0_sel:DWORD src1_sel:WORD_1
    ds_read_b64 v[108:109], v108
    ds_read_b64 v[110:111], v110
    s_waitcnt lgkmcnt(10)
    v_add3_u32 v40, v40, v88, v90
    v_add3_u32 v41, v41, v89, v91
    v_add3_u32 v40, v40, v92, v94
    v_add3_u32 v41, v41, v93, v95
    v_lshlrev_b32_sdwa v88, 3, v122 dst_sel:DWORD dst_unused:UNUSED_PAD src0_sel:DWORD src1_sel:WORD_0
    v_lshlrev_b32_sdwa v90, 3, v122 dst_sel:DWORD dst_unused:UNUSED_PAD src0_sel:DWORD src1_sel:WORD_1
    ds_read_b64 v[88:89], v88
    ds_read_b64 v[90:91], v90
    v_lshlrev_b32_sdwa v92, 3, v123 dst_sel:DWORD dst_unused:UNUSED_PAD src0_sel:DWORD src1_sel:WORD_0
    v_lshlrev_b32_sdwa v94, 3, v123 dst_sel:DWORD dst_unused:UNUSED_PAD src0_sel:DWORD src1_sel:WORD_1
    ds_read_b64 v[92:93], v92
    ds_read_b64 v[94:95], v94
    s_add_u32 s20, s20, 0x1000
    buffer_load_dwordx4 v[120:123], v71, s[12:15], s20 offen offset:0 sc1
    s_waitcnt lgkmcnt(9)
    v_add3_u32 v40, v40, v96, v98
    v_add3_u32 v41, v41, v97, v99
    v_add3_u32 v40, v40, v100, v102
    v_add3_u32 v41, v41, v101, v103
    s_waitcnt vmcnt(6)
    v_lshlrev_b32_sdwa v96, 3, v124 dst_sel:DWORD dst_unused:UNUSED_PAD src0_sel:DWORD src1_sel:WORD_0
    v_lshlrev_b32_sdwa v98, 3, v124 dst_sel:DWORD dst_unused:UNUSED_PAD src0_sel:DWORD src1_sel:WORD_1
    ds_read_b64 v[96:97], v96
    ds_read_b64 v[98:99], v98
    v_lshlrev_b32_sdwa v100, 3, v125 dst_sel:DWORD dst_unused:UNUSED_PAD src0_sel:DWORD src1_sel:WORD_0
    v_lshlrev_b32_sdwa v102, 3, v125 dst_sel:DWORD dst_unused:UNUSED_PAD src0_sel:DWORD src1_sel:WORD_1
    ds_read_b64 v[100:101], v100
    ds_read_b64 v[102:103], v102
    s_waitcnt lgkmcnt(8)
    v_add3_u32 v42, v42, v104, v106
    v_add3_u32 v43, v43, v105, v107
    v_add3_u32 v42, v42, v108, v110
    v_add3_u32 v43, v43, v109, v111
    v_lshlrev_b32_sdwa v104, 3, v126 dst_sel:DWORD dst_unused:UNUSED_PAD src0_sel:DWORD src1_sel:WORD_0
    v_lshlrev_b32_sdwa v106, 3, v126 dst_sel:DWORD dst_unused:UNUSED_PAD src0_sel:DWORD src1_sel:WORD_1
    ds_read_b64 v[104:105], v104
    ds_read_b64 v[106:107], v106
    v_lshlrev_b32_sdwa v108, 3, v127 dst_sel:DWORD dst_unused:UNUSED_PAD src0_sel:DWORD src1_sel:WORD_0
    v_lshlrev_b32_sdwa v110, 3, v127 dst_sel:DWORD dst_unused:UNUSED_PAD src0_sel:DWORD src1_sel:WORD_1
    ds_read_b64 v[108:109], v108
    ds_read_b64 v[110:111], v110
    buffer_load_dwordx4 v[124:127], v71, s[12:15], s20 offen offset:1024 sc1
    s_waitcnt lgkmcnt(8)
    v_add3_u32 v42, v42, v88, v90
    v_add3_u32 v43, v43, v89, v91
    v_add3_u32 v42, v42, v92, v94
    v_add3_u32 v43, v43, v93, v95
    s_waitcnt vmcnt(2)
    v_lshlrev_b32_sdwa v88, 3, v116 dst_sel:DWORD dst_unused:UNUSED_PAD src0_sel:DWORD src1_sel:WORD_0
    v_lshlrev_b32_sdwa v90, 3, v116 dst_sel:DWORD dst_unused:UNUSED_PAD src0_sel:DWORD src1_sel:WORD_1
    ds_read_b64 v[88:89], v88
    ds_read_b64 v[90:91], v90
    v_lshlrev_b32_sdwa v92, 3, v117 dst_sel:DWORD dst_unused:UNUSED_PAD src0_sel:DWORD src1_sel:WORD_0
    v_lshlrev_b32_sdwa v94, 3, v117 dst_sel:DWORD dst_unused:UNUSED_PAD src0_sel:DWORD src1_sel:WORD_1
    ds_read_b64 v[92:93], v92
    ds_read_b64 v[94:95], v94
    s_waitcnt lgkmcnt(8)
    v_add3_u32 v44, v44, v96, v98
    v_add3_u32 v45, v45, v97, v99
    v_add3_u32 v44, v44, v100, v102
    v_add3_u32 v45, v45, v101, v103
    v_lshlrev_b32_sdwa v96, 3, v118 dst_sel:DWORD dst_unused:UNUSED_PAD src0_sel:DWORD src1_sel:WORD_0
    v_lshlrev_b32_sdwa v98, 3, v118 dst_sel:DWORD dst_unused:UNUSED_PAD src0_sel:DWORD src1_sel:WORD_1
    ds_read_b64 v[96:97], v96
    ds_read_b64 v[98:99], v98
    v_lshlrev_b32_sdwa v100, 3, v119 dst_sel:DWORD dst_unused:UNUSED_PAD src0_sel:DWORD src1_sel:WORD_0
    v_lshlrev_b32_sdwa v102, 3, v119 dst_sel:DWORD dst_unused:UNUSED_PAD src0_sel:DWORD src1_sel:WORD_1
    ds_read_b64 v[100:101], v100
    ds_read_b64 v[102:103], v102
    buffer_load_dwordx4 v[116:119], v71, s[12:15], s20 offen offset:2048 sc1
    s_waitcnt lgkmcnt(8)
    v_add3_u32 v44, v44, v104, v106
    v_add3_u32 v45, v45, v105, v107
    v_add3_u32 v44, v44, v108, v110
    v_add3_u32 v45, v45, v109, v111
    s_setprio 2
    s_waitcnt vmcnt(2)
    v_lshlrev_b32_sdwa v104, 3, v120 dst_sel:DWORD dst_unused:UNUSED_PAD src0_sel:DWORD src1_sel:WORD_0
    v_lshlrev_b32_sdwa v106, 3, v120 dst_sel:DWORD dst_unused:UNUSED_PAD src0_sel:DWORD src1_sel:WORD_1
    ds_read_b64 v[104:105], v104
    ds_read_b64 v[106:107], v106
    v_lshlrev_b32_sdwa v108, 3, v121 dst_sel:DWORD dst_unused:UNUSED_PAD src0_sel:DWORD src1_sel:WORD_0
    v_lshlrev_b32_sdwa v110, 3, v121 dst_sel:DWORD dst_unused:UNUSED_PAD src0_sel:DWORD src1_sel:WORD_1
    ds_read_b64 v[108:109], v108
    ds_read_b64 v[110:111], v110
    s_waitcnt lgkmcnt(8)
    v_add3_u32 v46, v46, v88, v90
    v_add3_u32 v47, v47, v89, v91
    v_add3_u32 v46, v46, v92, v94
    v_add3_u32 v47, v47, v93, v95
    v_lshlrev_b32_sdwa v88, 3, v122 dst_sel:DWORD dst_unused:UNUSED_PAD src0_sel:DWORD src1_sel:WORD_0
    v_lshlrev_b32_sdwa v90, 3, v122 dst_sel:DWORD dst_unused:UNUSED_PAD src0_sel:DWORD src1_sel:WORD_1
    ds_read_b64 v[88:89], v88
    ds_read_b64 v[90:91], v90
    v_lshlrev_b32_sdwa v92, 3, v123 dst_sel:DWORD dst_unused:UNUSED_PAD src0_sel:DWORD src1_sel:WORD_0
    v_lshlrev_b32_sdwa v94, 3, v123 dst_sel:DWORD dst_unused:UNUSED_PAD src0_sel:DWORD src1_sel:WORD_1
    ds_read_b64 v[92:93], v92
    ds_read_b64 v[94:95], v94
    buffer_load_dwordx4 v[120:123], v71, s[12:15], s20 offen offset:3072 sc1
    s_waitcnt lgkmcnt(8)
    v_add3_u32 v46, v46, v96, v98
    v_add3_u32 v47, v47, v97, v99
    v_add3_u32 v46, v46, v100, v102
    v_add3_u32 v47, v47, v101, v103
    s_waitcnt vmcnt(2)
    v_lshlrev_b32_sdwa v96, 3, v124 dst_sel:DWORD dst_unused:UNUSED_PAD src0_sel:DWORD src1_sel:WORD_0
    v_lshlrev_b32_sdwa v98, 3, v124 dst_sel:DWORD dst_unused:UNUSED_PAD src0_sel:DWORD src1_sel:WORD_1
    ds_read_b64 v[96:97], v96
    ds_read_b64 v[98:99], v98
    v_lshlrev_b32_sdwa v100, 3, v125 dst_sel:DWORD dst_unused:UNUSED_PAD src0_sel:DWORD src1_sel:WORD_0
    v_lshlrev_b32_sdwa v102, 3, v125 dst_sel:DWORD dst_unused:UNUSED_PAD src0_sel:DWORD src1_sel:WORD_1
    ds_read_b64 v[100:101], v100
    ds_read_b64 v[102:103], v102
    s_waitcnt lgkmcnt(8)
    v_add3_u32 v48, v48, v104, v106
    v_add3_u32 v49, v49, v105, v107
    v_add3_u32 v48, v48, v108, v110
    v_add3_u32 v49, v49, v109, v111
    v_lshlrev_b32_sdwa v104, 3, v126 dst_sel:DWORD dst_unused:UNUSED_PAD src0_sel:DWORD src1_sel:WORD_0
    v_lshlrev_b32_sdwa v106, 3, v126 dst_sel:DWORD dst_unused:UNUSED_PAD src0_sel:DWORD src1_sel:WORD_1
    ds_read_b64 v[104:105], v104
    ds_read_b64 v[106:107], v106
    v_lshlrev_b32_sdwa v108, 3, v127 dst_sel:DWORD dst_unused:UNUSED_PAD src0_sel:DWORD src1_sel:WORD_0
    v_lshlrev_b32_sdwa v110, 3, v127 dst_sel:DWORD dst_unused:UNUSED_PAD src0_sel:DWORD src1_sel:WORD_1
    ds_read_b64 v[108:109], v108
    ds_read_b64 v[110:111], v110
    s_add_u32 s20, s20, 0x1000
    buffer_load_dwordx4 v[124:127], v71, s[12:15], s20 offen offset:0 sc1
    s_waitcnt lgkmcnt(8)
    v_add3_u32 v48, v48, v88, v90
    v_add3_u32 v49, v49, v89, v91
    v_add3_u32 v48, v48, v92, v94
    v_add3_u32 v49, v49, v93, v95
    s_waitcnt vmcnt(2)
    v_lshlrev_b32_sdwa v88, 3, v116 dst_sel:DWORD dst_unused:UNUSED_PAD src0_sel:DWORD src1_sel:WORD_0
    v_lshlrev_b32_sdwa v90, 3, v116 dst_sel:DWORD dst_unused:UNUSED_PAD src0_sel:DWORD src1_sel:WORD_1
    ds_read_b64 v[88:89], v88
    ds_read_b64 v[90:91], v90
    v_lshlrev_b32_sdwa v92, 3, v117 dst_sel:DWORD dst_unused:UNUSED_PAD src0_sel:DWORD src1_sel:WORD_0
    v_lshlrev_b32_sdwa v94, 3, v117 dst_sel:DWORD dst_unused:UNUSED_PAD src0_sel:DWORD src1_sel:WORD_1
    ds_read_b64 v[92:93], v92
    ds_read_b64 v[94:95], v94
    s_waitcnt lgkmcnt(8)
    v_add3_u32 v50, v50, v96, v98
    v_add3_u32 v51, v51, v97, v99
    v_add3_u32 v50, v50, v100, v102
    v_add3_u32 v51, v51, v101, v103
    v_lshlrev_b32_sdwa v96, 3, v118 dst_sel:DWORD dst_unused:UNUSED_PAD src0_sel:DWORD src1_sel:WORD_0
    v_lshlrev_b32_sdwa v98, 3, v118 dst_sel:DWORD dst_unused:UNUSED_PAD src0_sel:DWORD src1_sel:WORD_1
    ds_read_b64 v[96:97], v96
    ds_read_b64 v[98:99], v98
    v_lshlrev_b32_sdwa v100, 3, v119 dst_sel:DWORD dst_unused:UNUSED_PAD src0_sel:DWORD src1_sel:WORD_0
    v_lshlrev_b32_sdwa v102, 3, v119 dst_sel:DWORD dst_unused:UNUSED_PAD src0_sel:DWORD src1_sel:WORD_1
    ds_read_b64 v[100:101], v100
    ds_read_b64 v[102:103], v102
    buffer_load_dwordx4 v[116:119], v71, s[12:15], s20 offen offset:1024 sc1
    s_waitcnt lgkmcnt(8)
    v_add3_u32 v50, v50, v104, v106
    v_add3_u32 v51, v51, v105, v107
    v_add3_u32 v50, v50, v108, v110
    v_add3_u32 v51, v51, v109, v111
    v_mfma_f32_16x16x32_bf16 v[112:115], v[72:75], v[128:131], v[66:69]
    v_mfma_f32_16x16x32_bf16 v[112:115], v[76:79], v[132:135], v[112:115]
    v_add_u32 v70, 0xfffe0000, v70
    s_waitcnt vmcnt(2)
    v_lshlrev_b32_sdwa v104, 3, v120 dst_sel:DWORD dst_unused:UNUSED_PAD src0_sel:DWORD src1_sel:WORD_0
    v_lshlrev_b32_sdwa v106, 3, v120 dst_sel:DWORD dst_unused:UNUSED_PAD src0_sel:DWORD src1_sel:WORD_1
    ds_read_b64 v[104:105], v104
    ds_read_b64 v[106:107], v106
    v_mfma_f32_16x16x32_bf16 v[112:115], v[80:83], v[136:139], v[112:115]
    v_mfma_f32_16x16x32_bf16 v[112:115], v[84:87], v[140:143], v[112:115]
    v_lshlrev_b32_sdwa v108, 3, v121 dst_sel:DWORD dst_unused:UNUSED_PAD src0_sel:DWORD src1_sel:WORD_0
    v_lshlrev_b32_sdwa v110, 3, v121 dst_sel:DWORD dst_unused:UNUSED_PAD src0_sel:DWORD src1_sel:WORD_1
    ds_read_b64 v[108:109], v108
    ds_read_b64 v[110:111], v110
    s_waitcnt lgkmcnt(8)
    v_add3_u32 v52, v52, v88, v90
    v_add3_u32 v53, v53, v89, v91
    v_add3_u32 v52, v52, v92, v94
    v_add3_u32 v53, v53, v93, v95
    v_perm_b32 v112, v113, v112, s23
    v_perm_b32 v113, v115, v114, s23
    ds_write_b64 v70, v[112:113] offset:0
    v_mfma_f32_16x16x32_bf16 v[112:115], v[72:75], v[144:147], v[66:69]
    v_mfma_f32_16x16x32_bf16 v[112:115], v[76:79], v[148:151], v[112:115]
    v_lshlrev_b32_sdwa v88, 3, v122 dst_sel:DWORD dst_unused:UNUSED_PAD src0_sel:DWORD src1_sel:WORD_0
    v_lshlrev_b32_sdwa v90, 3, v122 dst_sel:DWORD dst_unused:UNUSED_PAD src0_sel:DWORD src1_sel:WORD_1
    ds_read_b64 v[88:89], v88
    ds_read_b64 v[90:91], v90
    v_mfma_f32_16x16x32_bf16 v[112:115], v[80:83], v[152:155], v[112:115]
    v_mfma_f32_16x16x32_bf16 v[112:115], v[84:87], v[156:159], v[112:115]
    v_lshlrev_b32_sdwa v92, 3, v123 dst_sel:DWORD dst_unused:UNUSED_PAD src0_sel:DWORD src1_sel:WORD_0
    v_lshlrev_b32_sdwa v94, 3, v123 dst_sel:DWORD dst_unused:UNUSED_PAD src0_sel:DWORD src1_sel:WORD_1
    ds_read_b64 v[92:93], v92
    ds_read_b64 v[94:95], v94
    buffer_load_dwordx4 v[120:123], v71, s[12:15], s20 offen offset:2048 sc1
    s_waitcnt lgkmcnt(9)
    v_add3_u32 v52, v52, v96, v98
    v_add3_u32 v53, v53, v97, v99
    v_add3_u32 v52, v52, v100, v102
    v_add3_u32 v53, v53, v101, v103
    v_perm_b32 v112, v113, v112, s23
    v_perm_b32 v113, v115, v114, s23
    ds_write_b64 v70, v[112:113] offset:128
    s_setprio 1
    v_mfma_f32_16x16x32_bf16 v[112:115], v[72:75], v[160:163], v[66:69]
    v_mfma_f32_16x16x32_bf16 v[112:115], v[76:79], v[164:167], v[112:115]
    s_waitcnt vmcnt(2)
    v_lshlrev_b32_sdwa v96, 3, v124 dst_sel:DWORD dst_unused:UNUSED_PAD src0_sel:DWORD src1_sel:WORD_0
    v_lshlrev_b32_sdwa v98, 3, v124 dst_sel:DWORD dst_unused:UNUSED_PAD src0_sel:DWORD src1_sel:WORD_1
    ds_read_b64 v[96:97], v96
    ds_read_b64 v[98:99], v98
    v_mfma_f32_16x16x32_bf16 v[112:115], v[80:83], v[168:171], v[112:115]
    v_mfma_f32_16x16x32_bf16 v[112:115], v[84:87], v[172:175], v[112:115]
    v_lshlrev_b32_sdwa v100, 3, v125 dst_sel:DWORD dst_unused:UNUSED_PAD src0_sel:DWORD src1_sel:WORD_0
    v_lshlrev_b32_sdwa v102, 3, v125 dst_sel:DWORD dst_unused:UNUSED_PAD src0_sel:DWORD src1_sel:WORD_1
    ds_read_b64 v[100:101], v100
    ds_read_b64 v[102:103], v102
    s_waitcnt lgkmcnt(10)
    v_add3_u32 v54, v54, v104, v106
    v_add3_u32 v55, v55, v105, v107
    v_add3_u32 v54, v54, v108, v110
    v_add3_u32 v55, v55, v109, v111
    v_perm_b32 v112, v113, v112, s23
    v_perm_b32 v113, v115, v114, s23
    ds_write_b64 v70, v[112:113] offset:256
    v_mfma_f32_16x16x32_bf16 v[112:115], v[72:75], v[176:179], v[66:69]
    v_mfma_f32_16x16x32_bf16 v[112:115], v[76:79], v[180:183], v[112:115]
    v_lshlrev_b32_sdwa v104, 3, v126 dst_sel:DWORD dst_unused:UNUSED_PAD src0_sel:DWORD src1_sel:WORD_0
    v_lshlrev_b32_sdwa v106, 3, v126 dst_sel:DWORD dst_unused:UNUSED_PAD src0_sel:DWORD src1_sel:WORD_1
    ds_read_b64 v[104:105], v104
    ds_read_b64 v[106:107], v106
    v_mfma_f32_16x16x32_bf16 v[112:115], v[80:83], v[184:187], v[112:115]
    v_mfma_f32_16x16x32_bf16 v[112:115], v[84:87], v[188:191], v[112:115]
    v_lshlrev_b32_sdwa v108, 3, v127 dst_sel:DWORD dst_unused:UNUSED_PAD src0_sel:DWORD src1_sel:WORD_0
    v_lshlrev_b32_sdwa v110, 3, v127 dst_sel:DWORD dst_unused:UNUSED_PAD src0_sel:DWORD src1_sel:WORD_1
    ds_read_b64 v[108:109], v108
    ds_read_b64 v[110:111], v110
    buffer_load_dwordx4 v[124:127], v71, s[12:15], s20 offen offset:3072 sc1
    s_waitcnt lgkmcnt(10)
    v_add3_u32 v54, v54, v88, v90
    v_add3_u32 v55, v55, v89, v91
    v_add3_u32 v54, v54, v92, v94
    v_add3_u32 v55, v55, v93, v95
    v_perm_b32 v112, v113, v112, s23
    v_perm_b32 v113, v115, v114, s23
    ds_write_b64 v70, v[112:113] offset:384
    v_mfma_f32_16x16x32_bf16 v[112:115], v[72:75], v[192:195], v[66:69]
    v_mfma_f32_16x16x32_bf16 v[112:115], v[76:79], v[196:199], v[112:115]
    s_waitcnt vmcnt(2)
    v_lshlrev_b32_sdwa v88, 3, v116 dst_sel:DWORD dst_unused:UNUSED_PAD src0_sel:DWORD src1_sel:WORD_0
    v_lshlrev_b32_sdwa v90, 3, v116 dst_sel:DWORD dst_unused:UNUSED_PAD src0_sel:DWORD src1_sel:WORD_1
    ds_read_b64 v[88:89], v88
    ds_read_b64 v[90:91], v90
    v_mfma_f32_16x16x32_bf16 v[112:115], v[80:83], v[200:203], v[112:115]
    v_mfma_f32_16x16x32_bf16 v[112:115], v[84:87], v[204:207], v[112:115]
    v_lshlrev_b32_sdwa v92, 3, v117 dst_sel:DWORD dst_unused:UNUSED_PAD src0_sel:DWORD src1_sel:WORD_0
    v_lshlrev_b32_sdwa v94, 3, v117 dst_sel:DWORD dst_unused:UNUSED_PAD src0_sel:DWORD src1_sel:WORD_1
    ds_read_b64 v[92:93], v92
    ds_read_b64 v[94:95], v94
    s_waitcnt lgkmcnt(10)
    v_add3_u32 v56, v56, v96, v98
    v_add3_u32 v57, v57, v97, v99
    v_add3_u32 v56, v56, v100, v102
    v_add3_u32 v57, v57, v101, v103
    v_perm_b32 v112, v113, v112, s23
    v_perm_b32 v113, v115, v114, s23
    ds_write_b64 v70, v[112:113] offset:512
    v_mfma_f32_16x16x32_bf16 v[112:115], v[72:75], v[208:211], v[66:69]
    v_mfma_f32_16x16x32_bf16 v[112:115], v[76:79], v[212:215], v[112:115]
    v_lshlrev_b32_sdwa v96, 3, v118 dst_sel:DWORD dst_unused:UNUSED_PAD src0_sel:DWORD src1_sel:WORD_0
    v_lshlrev_b32_sdwa v98, 3, v118 dst_sel:DWORD dst_unused:UNUSED_PAD src0_sel:DWORD src1_sel:WORD_1
    ds_read_b64 v[96:97], v96
    ds_read_b64 v[98:99], v98
    v_mfma_f32_16x16x32_bf16 v[112:115], v[80:83], v[216:219], v[112:115]
    v_mfma_f32_16x16x32_bf16 v[112:115], v[84:87], v[220:223], v[112:115]
    v_lshlrev_b32_sdwa v100, 3, v119 dst_sel:DWORD dst_unused:UNUSED_PAD src0_sel:DWORD src1_sel:WORD_0
    v_lshlrev_b32_sdwa v102, 3, v119 dst_sel:DWORD dst_unused:UNUSED_PAD src0_sel:DWORD src1_sel:WORD_1
    ds_read_b64 v[100:101], v100
    ds_read_b64 v[102:103], v102
    s_add_u32 s20, s20, 0x3d000
    buffer_load_dwordx4 v[116:119], v71, s[12:15], s20 offen offset:0 sc1
    s_waitcnt lgkmcnt(10)
    v_add3_u32 v56, v56, v104, v106
    v_add3_u32 v57, v57, v105, v107
    v_add3_u32 v56, v56, v108, v110
    v_add3_u32 v57, v57, v109, v111
    v_perm_b32 v112, v113, v112, s23
    v_perm_b32 v113, v115, v114, s23
    ds_write_b64 v70, v[112:113] offset:640
    v_mfma_f32_16x16x32_bf16 v[112:115], v[72:75], v[224:227], v[66:69]
    v_mfma_f32_16x16x32_bf16 v[112:115], v[76:79], v[228:231], v[112:115]
    s_waitcnt vmcnt(2)
    v_lshlrev_b32_sdwa v104, 3, v120 dst_sel:DWORD dst_unused:UNUSED_PAD src0_sel:DWORD src1_sel:WORD_0
    v_lshlrev_b32_sdwa v106, 3, v120 dst_sel:DWORD dst_unused:UNUSED_PAD src0_sel:DWORD src1_sel:WORD_1
    ds_read_b64 v[104:105], v104
    ds_read_b64 v[106:107], v106
    v_mfma_f32_16x16x32_bf16 v[112:115], v[80:83], v[232:235], v[112:115]
    v_mfma_f32_16x16x32_bf16 v[112:115], v[84:87], v[236:239], v[112:115]
    v_lshlrev_b32_sdwa v108, 3, v121 dst_sel:DWORD dst_unused:UNUSED_PAD src0_sel:DWORD src1_sel:WORD_0
    v_lshlrev_b32_sdwa v110, 3, v121 dst_sel:DWORD dst_unused:UNUSED_PAD src0_sel:DWORD src1_sel:WORD_1
    ds_read_b64 v[108:109], v108
    ds_read_b64 v[110:111], v110
    s_waitcnt lgkmcnt(10)
    v_add3_u32 v58, v58, v88, v90
    v_add3_u32 v59, v59, v89, v91
    v_add3_u32 v58, v58, v92, v94
    v_add3_u32 v59, v59, v93, v95
    v_perm_b32 v112, v113, v112, s23
    v_perm_b32 v113, v115, v114, s23
    ds_write_b64 v70, v[112:113] offset:768
    v_mfma_f32_16x16x32_bf16 v[112:115], v[72:75], v[240:243], v[66:69]
    buffer_load_dwordx4 v[72:75], v71, s[12:15], s21 offen offset:0
    v_mfma_f32_16x16x32_bf16 v[112:115], v[76:79], v[244:247], v[112:115]
    buffer_load_dwordx4 v[76:79], v71, s[12:15], s21 offen offset:1024
    v_lshlrev_b32_sdwa v88, 3, v122 dst_sel:DWORD dst_unused:UNUSED_PAD src0_sel:DWORD src1_sel:WORD_0
    v_lshlrev_b32_sdwa v90, 3, v122 dst_sel:DWORD dst_unused:UNUSED_PAD src0_sel:DWORD src1_sel:WORD_1
    ds_read_b64 v[88:89], v88
    ds_read_b64 v[90:91], v90
    v_mfma_f32_16x16x32_bf16 v[112:115], v[80:83], v[248:251], v[112:115]
    buffer_load_dwordx4 v[80:83], v71, s[12:15], s19 offen offset:0
    v_mfma_f32_16x16x32_bf16 v[112:115], v[84:87], v[252:255], v[112:115]
    buffer_load_dwordx4 v[84:87], v71, s[12:15], s19 offen offset:1024
    s_add_u32 s21, s21, s22
    s_add_u32 s19, s19, s22
    v_lshlrev_b32_sdwa v92, 3, v123 dst_sel:DWORD dst_unused:UNUSED_PAD src0_sel:DWORD src1_sel:WORD_0
    v_lshlrev_b32_sdwa v94, 3, v123 dst_sel:DWORD dst_unused:UNUSED_PAD src0_sel:DWORD src1_sel:WORD_1
    ds_read_b64 v[92:93], v92
    ds_read_b64 v[94:95], v94
    buffer_load_dwordx4 v[120:123], v71, s[12:15], s20 offen offset:1024 sc1
    s_waitcnt lgkmcnt(10)
    v_add3_u32 v58, v58, v96, v98
    v_add3_u32 v59, v59, v97, v99
    v_add3_u32 v58, v58, v100, v102
    v_add3_u32 v59, v59, v101, v103
    v_perm_b32 v112, v113, v112, s23
    v_perm_b32 v113, v115, v114, s23
    ds_write_b64 v70, v[112:113] offset:896
    s_setprio 0
    s_waitcnt vmcnt(6)
    v_lshlrev_b32_sdwa v96, 3, v124 dst_sel:DWORD dst_unused:UNUSED_PAD src0_sel:DWORD src1_sel:WORD_0
    v_lshlrev_b32_sdwa v98, 3, v124 dst_sel:DWORD dst_unused:UNUSED_PAD src0_sel:DWORD src1_sel:WORD_1
    ds_read_b64 v[96:97], v96
    ds_read_b64 v[98:99], v98
    v_lshlrev_b32_sdwa v100, 3, v125 dst_sel:DWORD dst_unused:UNUSED_PAD src0_sel:DWORD src1_sel:WORD_0
    v_lshlrev_b32_sdwa v102, 3, v125 dst_sel:DWORD dst_unused:UNUSED_PAD src0_sel:DWORD src1_sel:WORD_1
    ds_read_b64 v[100:101], v100
    ds_read_b64 v[102:103], v102
    s_waitcnt lgkmcnt(10)
    v_add3_u32 v60, v60, v104, v106
    v_add3_u32 v61, v61, v105, v107
    v_add3_u32 v60, v60, v108, v110
    v_add3_u32 v61, v61, v109, v111
    v_lshlrev_b32_sdwa v104, 3, v126 dst_sel:DWORD dst_unused:UNUSED_PAD src0_sel:DWORD src1_sel:WORD_0
    v_lshlrev_b32_sdwa v106, 3, v126 dst_sel:DWORD dst_unused:UNUSED_PAD src0_sel:DWORD src1_sel:WORD_1
    ds_read_b64 v[104:105], v104
    ds_read_b64 v[106:107], v106
    v_lshlrev_b32_sdwa v108, 3, v127 dst_sel:DWORD dst_unused:UNUSED_PAD src0_sel:DWORD src1_sel:WORD_0
    v_lshlrev_b32_sdwa v110, 3, v127 dst_sel:DWORD dst_unused:UNUSED_PAD src0_sel:DWORD src1_sel:WORD_1
    ds_read_b64 v[108:109], v108
    ds_read_b64 v[110:111], v110
    buffer_load_dwordx4 v[124:127], v71, s[12:15], s20 offen offset:2048 sc1
    s_waitcnt lgkmcnt(9)
    v_add3_u32 v60, v60, v88, v90
    v_add3_u32 v61, v61, v89, v91
    v_add3_u32 v60, v60, v92, v94
    v_add3_u32 v61, v61, v93, v95
    s_waitcnt lgkmcnt(0)
    s_barrier
    s_setprio 3
    s_waitcnt vmcnt(6)
    v_lshlrev_b32_sdwa v88, 3, v116 dst_sel:DWORD dst_unused:UNUSED_PAD src0_sel:DWORD src1_sel:WORD_0
    v_lshlrev_b32_sdwa v90, 3, v116 dst_sel:DWORD dst_unused:UNUSED_PAD src0_sel:DWORD src1_sel:WORD_1
    ds_read_b64 v[88:89], v88
    ds_read_b64 v[90:91], v90
    v_lshlrev_b32_sdwa v92, 3, v117 dst_sel:DWORD dst_unused:UNUSED_PAD src0_sel:DWORD src1_sel:WORD_0
    v_lshlrev_b32_sdwa v94, 3, v117 dst_sel:DWORD dst_unused:UNUSED_PAD src0_sel:DWORD src1_sel:WORD_1
    ds_read_b64 v[92:93], v92
    ds_read_b64 v[94:95], v94
    v_add3_u32 v62, v62, v96, v98
    v_add3_u32 v63, v63, v97, v99
    v_add3_u32 v62, v62, v100, v102
    v_add3_u32 v63, v63, v101, v103
    v_lshlrev_b32_sdwa v96, 3, v118 dst_sel:DWORD dst_unused:UNUSED_PAD src0_sel:DWORD src1_sel:WORD_0
    v_lshlrev_b32_sdwa v98, 3, v118 dst_sel:DWORD dst_unused:UNUSED_PAD src0_sel:DWORD src1_sel:WORD_1
    ds_read_b64 v[96:97], v96
    ds_read_b64 v[98:99], v98
    v_lshlrev_b32_sdwa v100, 3, v119 dst_sel:DWORD dst_unused:UNUSED_PAD src0_sel:DWORD src1_sel:WORD_0
    v_lshlrev_b32_sdwa v102, 3, v119 dst_sel:DWORD dst_unused:UNUSED_PAD src0_sel:DWORD src1_sel:WORD_1
    ds_read_b64 v[100:101], v100
    ds_read_b64 v[102:103], v102
    buffer_load_dwordx4 v[116:119], v71, s[12:15], s20 offen offset:3072 sc1
    v_add3_u32 v62, v62, v104, v106
    v_add3_u32 v63, v63, v105, v107
    v_add3_u32 v62, v62, v108, v110
    v_add3_u32 v63, v63, v109, v111
    s_waitcnt vmcnt(2)
    v_lshlrev_b32_sdwa v104, 3, v120 dst_sel:DWORD dst_unused:UNUSED_PAD src0_sel:DWORD src1_sel:WORD_0
    v_lshlrev_b32_sdwa v106, 3, v120 dst_sel:DWORD dst_unused:UNUSED_PAD src0_sel:DWORD src1_sel:WORD_1
    ds_read_b64 v[104:105], v104
    ds_read_b64 v[106:107], v106
    v_lshlrev_b32_sdwa v108, 3, v121 dst_sel:DWORD dst_unused:UNUSED_PAD src0_sel:DWORD src1_sel:WORD_0
    v_lshlrev_b32_sdwa v110, 3, v121 dst_sel:DWORD dst_unused:UNUSED_PAD src0_sel:DWORD src1_sel:WORD_1
    ds_read_b64 v[108:109], v108
    ds_read_b64 v[110:111], v110
    s_waitcnt lgkmcnt(8)
    v_add3_u32 v32, v32, v88, v90
    v_add3_u32 v33, v33, v89, v91
    v_add3_u32 v32, v32, v92, v94
    v_add3_u32 v33, v33, v93, v95
    v_lshlrev_b32_sdwa v88, 3, v122 dst_sel:DWORD dst_unused:UNUSED_PAD src0_sel:DWORD src1_sel:WORD_0
    v_lshlrev_b32_sdwa v90, 3, v122 dst_sel:DWORD dst_unused:UNUSED_PAD src0_sel:DWORD src1_sel:WORD_1
    ds_read_b64 v[88:89], v88
    ds_read_b64 v[90:91], v90
    v_lshlrev_b32_sdwa v92, 3, v123 dst_sel:DWORD dst_unused:UNUSED_PAD src0_sel:DWORD src1_sel:WORD_0
    v_lshlrev_b32_sdwa v94, 3, v123 dst_sel:DWORD dst_unused:UNUSED_PAD src0_sel:DWORD src1_sel:WORD_1
    ds_read_b64 v[92:93], v92
    ds_read_b64 v[94:95], v94
    s_add_u32 s20, s20, 0x1000
    buffer_load_dwordx4 v[120:123], v71, s[12:15], s20 offen offset:0 sc1
    s_waitcnt lgkmcnt(8)
    v_add3_u32 v32, v32, v96, v98
    v_add3_u32 v33, v33, v97, v99
    v_add3_u32 v32, v32, v100, v102
    v_add3_u32 v33, v33, v101, v103
    s_waitcnt vmcnt(2)
    v_lshlrev_b32_sdwa v96, 3, v124 dst_sel:DWORD dst_unused:UNUSED_PAD src0_sel:DWORD src1_sel:WORD_0
    v_lshlrev_b32_sdwa v98, 3, v124 dst_sel:DWORD dst_unused:UNUSED_PAD src0_sel:DWORD src1_sel:WORD_1
    ds_read_b64 v[96:97], v96
    ds_read_b64 v[98:99], v98
    v_lshlrev_b32_sdwa v100, 3, v125 dst_sel:DWORD dst_unused:UNUSED_PAD src0_sel:DWORD src1_sel:WORD_0
    v_lshlrev_b32_sdwa v102, 3, v125 dst_sel:DWORD dst_unused:UNUSED_PAD src0_sel:DWORD src1_sel:WORD_1
    ds_read_b64 v[100:101], v100
    ds_read_b64 v[102:103], v102
    s_waitcnt lgkmcnt(8)
    v_add3_u32 v34, v34, v104, v106
    v_add3_u32 v35, v35, v105, v107
    v_add3_u32 v34, v34, v108, v110
    v_add3_u32 v35, v35, v109, v111
    v_lshlrev_b32_sdwa v104, 3, v126 dst_sel:DWORD dst_unused:UNUSED_PAD src0_sel:DWORD src1_sel:WORD_0
    v_lshlrev_b32_sdwa v106, 3, v126 dst_sel:DWORD dst_unused:UNUSED_PAD src0_sel:DWORD src1_sel:WORD_1
    ds_read_b64 v[104:105], v104
    ds_read_b64 v[106:107], v106
    v_lshlrev_b32_sdwa v108, 3, v127 dst_sel:DWORD dst_unused:UNUSED_PAD src0_sel:DWORD src1_sel:WORD_0
    v_lshlrev_b32_sdwa v110, 3, v127 dst_sel:DWORD dst_unused:UNUSED_PAD src0_sel:DWORD src1_sel:WORD_1
    ds_read_b64 v[108:109], v108
    ds_read_b64 v[110:111], v110
    buffer_load_dwordx4 v[124:127], v71, s[12:15], s20 offen offset:1024 sc1
    s_waitcnt lgkmcnt(8)
    v_add3_u32 v34, v34, v88, v90
    v_add3_u32 v35, v35, v89, v91
    v_add3_u32 v34, v34, v92, v94
    v_add3_u32 v35, v35, v93, v95
    s_waitcnt vmcnt(2)
    v_lshlrev_b32_sdwa v88, 3, v116 dst_sel:DWORD dst_unused:UNUSED_PAD src0_sel:DWORD src1_sel:WORD_0
    v_lshlrev_b32_sdwa v90, 3, v116 dst_sel:DWORD dst_unused:UNUSED_PAD src0_sel:DWORD src1_sel:WORD_1
    ds_read_b64 v[88:89], v88
    ds_read_b64 v[90:91], v90
    v_lshlrev_b32_sdwa v92, 3, v117 dst_sel:DWORD dst_unused:UNUSED_PAD src0_sel:DWORD src1_sel:WORD_0
    v_lshlrev_b32_sdwa v94, 3, v117 dst_sel:DWORD dst_unused:UNUSED_PAD src0_sel:DWORD src1_sel:WORD_1
    ds_read_b64 v[92:93], v92
    ds_read_b64 v[94:95], v94
    s_waitcnt lgkmcnt(8)
    v_add3_u32 v36, v36, v96, v98
    v_add3_u32 v37, v37, v97, v99
    v_add3_u32 v36, v36, v100, v102
    v_add3_u32 v37, v37, v101, v103
    v_lshlrev_b32_sdwa v96, 3, v118 dst_sel:DWORD dst_unused:UNUSED_PAD src0_sel:DWORD src1_sel:WORD_0
    v_lshlrev_b32_sdwa v98, 3, v118 dst_sel:DWORD dst_unused:UNUSED_PAD src0_sel:DWORD src1_sel:WORD_1
    ds_read_b64 v[96:97], v96
    ds_read_b64 v[98:99], v98
    v_lshlrev_b32_sdwa v100, 3, v119 dst_sel:DWORD dst_unused:UNUSED_PAD src0_sel:DWORD src1_sel:WORD_0
    v_lshlrev_b32_sdwa v102, 3, v119 dst_sel:DWORD dst_unused:UNUSED_PAD src0_sel:DWORD src1_sel:WORD_1
    ds_read_b64 v[100:101], v100
    ds_read_b64 v[102:103], v102
    buffer_load_dwordx4 v[116:119], v71, s[12:15], s20 offen offset:2048 sc1
    s_waitcnt lgkmcnt(8)
    v_add3_u32 v36, v36, v104, v106
    v_add3_u32 v37, v37, v105, v107
    v_add3_u32 v36, v36, v108, v110
    v_add3_u32 v37, v37, v109, v111
    v_mfma_f32_16x16x32_bf16 v[112:115], v[72:75], v[128:131], v[66:69]
    s_waitcnt vmcnt(2)
    v_lshlrev_b32_sdwa v104, 3, v120 dst_sel:DWORD dst_unused:UNUSED_PAD src0_sel:DWORD src1_sel:WORD_0
    v_lshlrev_b32_sdwa v106, 3, v120 dst_sel:DWORD dst_unused:UNUSED_PAD src0_sel:DWORD src1_sel:WORD_1
    ds_read_b64 v[104:105], v104
    ds_read_b64 v[106:107], v106
    v_mfma_f32_16x16x32_bf16 v[112:115], v[76:79], v[132:135], v[112:115]
    v_lshlrev_b32_sdwa v108, 3, v121 dst_sel:DWORD dst_unused:UNUSED_PAD src0_sel:DWORD src1_sel:WORD_0
    v_lshlrev_b32_sdwa v110, 3, v121 dst_sel:DWORD dst_unused:UNUSED_PAD src0_sel:DWORD src1_sel:WORD_1
    ds_read_b64 v[108:109], v108
    ds_read_b64 v[110:111], v110
    s_waitcnt lgkmcnt(8)
    v_add3_u32 v38, v38, v88, v90
    v_add3_u32 v39, v39, v89, v91
    v_add3_u32 v38, v38, v92, v94
    v_add3_u32 v39, v39, v93, v95
    v_mfma_f32_16x16x32_bf16 v[112:115], v[80:83], v[136:139], v[112:115]
    v_lshlrev_b32_sdwa v88, 3, v122 dst_sel:DWORD dst_unused:UNUSED_PAD src0_sel:DWORD src1_sel:WORD_0
    v_lshlrev_b32_sdwa v90, 3, v122 dst_sel:DWORD dst_unused:UNUSED_PAD src0_sel:DWORD src1_sel:WORD_1
    ds_read_b64 v[88:89], v88
    ds_read_b64 v[90:91], v90
    v_mfma_f32_16x16x32_bf16 v[112:115], v[84:87], v[140:143], v[112:115]
    v_lshlrev_b32_sdwa v92, 3, v123 dst_sel:DWORD dst_unused:UNUSED_PAD src0_sel:DWORD src1_sel:WORD_0
    v_lshlrev_b32_sdwa v94, 3, v123 dst_sel:DWORD dst_unused:UNUSED_PAD src0_sel:DWORD src1_sel:WORD_1
    ds_read_b64 v[92:93], v92
    ds_read_b64 v[94:95], v94
    buffer_load_dwordx4 v[120:123], v71, s[12:15], s20 offen offset:3072 sc1
    s_waitcnt lgkmcnt(8)
    v_add3_u32 v38, v38, v96, v98
    v_add3_u32 v39, v39, v97, v99
    v_add3_u32 v38, v38, v100, v102
    v_add3_u32 v39, v39, v101, v103
    v_perm_b32 v112, v113, v112, s23
    v_perm_b32 v113, v115, v114, s23
    ds_write_b64 v70, v[112:113] offset:32768
    s_waitcnt vmcnt(2)
    v_lshlrev_b32_sdwa v96, 3, v124 dst_sel:DWORD dst_unused:UNUSED_PAD src0_sel:DWORD src1_sel:WORD_0
    v_lshlrev_b32_sdwa v98, 3, v124 dst_sel:DWORD dst_unused:UNUSED_PAD src0_sel:DWORD src1_sel:WORD_1
    ds_read_b64 v[96:97], v96
    ds_read_b64 v[98:99], v98
    v_lshlrev_b32_sdwa v100, 3, v125 dst_sel:DWORD dst_unused:UNUSED_PAD src0_sel:DWORD src1_sel:WORD_0
    v_lshlrev_b32_sdwa v102, 3, v125 dst_sel:DWORD dst_unused:UNUSED_PAD src0_sel:DWORD src1_sel:WORD_1
    ds_read_b64 v[100:101], v100
    ds_read_b64 v[102:103], v102
    s_waitcnt lgkmcnt(9)
    v_add3_u32 v40, v40, v104, v106
    v_add3_u32 v41, v41, v105, v107
    v_add3_u32 v40, v40, v108, v110
    v_add3_u32 v41, v41, v109, v111
    v_mfma_f32_16x16x32_bf16 v[112:115], v[72:75], v[144:147], v[66:69]
    v_lshlrev_b32_sdwa v104, 3, v126 dst_sel:DWORD dst_unused:UNUSED_PAD src0_sel:DWORD src1_sel:WORD_0
    v_lshlrev_b32_sdwa v106, 3, v126 dst_sel:DWORD dst_unused:UNUSED_PAD src0_sel:DWORD src1_sel:WORD_1
    ds_read_b64 v[104:105], v104
    ds_read_b64 v[106:107], v106
    v_mfma_f32_16x16x32_bf16 v[112:115], v[76:79], v[148:151], v[112:115]
    v_lshlrev_b32_sdwa v108, 3, v127 dst_sel:DWORD dst_unused:UNUSED_PAD src0_sel:DWORD src1_sel:WORD_0
    v_lshlrev_b32_sdwa v110, 3, v127 dst_sel:DWORD dst_unused:UNUSED_PAD src0_sel:DWORD src1_sel:WORD_1
    ds_read_b64 v[108:109], v108
    ds_read_b64 v[110:111], v110
    s_add_u32 s20, s20, 0x1000
    buffer_load_dwordx4 v[124:127], v71, s[12:15], s20 offen offset:0 sc1
    s_waitcnt lgkmcnt(9)
    v_add3_u32 v40, v40, v88, v90
    v_add3_u32 v41, v41, v89, v91
    v_add3_u32 v40, v40, v92, v94
    v_add3_u32 v41, v41, v93, v95
    s_lshl_b32 s28, s38, 16
    s_and_b32 s29, s38, 0xffff0000
    v_mfma_f32_16x16x32_bf16 v[112:115], v[80:83], v[152:155], v[112:115]
    s_waitcnt vmcnt(2)
    v_lshlrev_b32_sdwa v88, 3, v116 dst_sel:DWORD dst_unused:UNUSED_PAD src0_sel:DWORD src1_sel:WORD_0
    v_lshlrev_b32_sdwa v90, 3, v116 dst_sel:DWORD dst_unused:UNUSED_PAD src0_sel:DWORD src1_sel:WORD_1
    ds_read_b64 v[88:89], v88
    ds_read_b64 v[90:91], v90
    v_mfma_f32_16x16x32_bf16 v[112:115], v[84:87], v[156:159], v[112:115]
    v_lshlrev_b32_sdwa v92, 3, v117 dst_sel:DWORD dst_unused:UNUSED_PAD src0_sel:DWORD src1_sel:WORD_0
    v_lshlrev_b32_sdwa v94, 3, v117 dst_sel:DWORD dst_unused:UNUSED_PAD src0_sel:DWORD src1_sel:WORD_1
    ds_read_b64 v[92:93], v92
    ds_read_b64 v[94:95], v94
    s_waitcnt lgkmcnt(8)
    v_add3_u32 v42, v42, v96, v98
    v_add3_u32 v43, v43, v97, v99
    v_add3_u32 v42, v42, v100, v102
    v_add3_u32 v43, v43, v101, v103
    v_perm_b32 v112, v113, v112, s23
    v_perm_b32 v113, v115, v114, s23
    ds_write_b64 v70, v[112:113] offset:32896
    s_lshl_b32 s30, s39, 16
    s_and_b32 s31, s39, 0xffff0000
    v_lshlrev_b32_sdwa v96, 3, v118 dst_sel:DWORD dst_unused:UNUSED_PAD src0_sel:DWORD src1_sel:WORD_0
    v_lshlrev_b32_sdwa v98, 3, v118 dst_sel:DWORD dst_unused:UNUSED_PAD src0_sel:DWORD src1_sel:WORD_1
    ds_read_b64 v[96:97], v96
    ds_read_b64 v[98:99], v98
    v_lshlrev_b32_sdwa v100, 3, v119 dst_sel:DWORD dst_unused:UNUSED_PAD src0_sel:DWORD src1_sel:WORD_0
    v_lshlrev_b32_sdwa v102, 3, v119 dst_sel:DWORD dst_unused:UNUSED_PAD src0_sel:DWORD src1_sel:WORD_1
    ds_read_b64 v[100:101], v100
    ds_read_b64 v[102:103], v102
    buffer_load_dwordx4 v[116:119], v71, s[12:15], s20 offen offset:1024 sc1
    s_waitcnt lgkmcnt(9)
    v_add3_u32 v42, v42, v104, v106
    v_add3_u32 v43, v43, v105, v107
    v_add3_u32 v42, v42, v108, v110
    v_add3_u32 v43, v43, v109, v111
    s_lshl1_add_u32 s35, s33, s34
    s_lshl3_add_u32 s35, s35, s3
    v_mfma_f32_16x16x32_bf16 v[112:115], v[72:75], v[160:163], v[66:69]
    s_waitcnt vmcnt(2)
    v_lshlrev_b32_sdwa v104, 3, v120 dst_sel:DWORD dst_unused:UNUSED_PAD src0_sel:DWORD src1_sel:WORD_0
    v_lshlrev_b32_sdwa v106, 3, v120 dst_sel:DWORD dst_unused:UNUSED_PAD src0_sel:DWORD src1_sel:WORD_1
    ds_read_b64 v[104:105], v104
    ds_read_b64 v[106:107], v106
    v_mfma_f32_16x16x32_bf16 v[112:115], v[76:79], v[164:167], v[112:115]
    v_lshlrev_b32_sdwa v108, 3, v121 dst_sel:DWORD dst_unused:UNUSED_PAD src0_sel:DWORD src1_sel:WORD_0
    v_lshlrev_b32_sdwa v110, 3, v121 dst_sel:DWORD dst_unused:UNUSED_PAD src0_sel:DWORD src1_sel:WORD_1
    ds_read_b64 v[108:109], v108
    ds_read_b64 v[110:111], v110
    s_waitcnt lgkmcnt(9)
    v_add3_u32 v44, v44, v88, v90
    v_add3_u32 v45, v45, v89, v91
    v_add3_u32 v44, v44, v92, v94
    v_add3_u32 v45, v45, v93, v95
    s_lshl_b32 s35, s35, 12
    s_and_b32 s64, s48, 1
    v_mfma_f32_16x16x32_bf16 v[112:115], v[80:83], v[168:171], v[112:115]
    v_lshlrev_b32_sdwa v88, 3, v122 dst_sel:DWORD dst_unused:UNUSED_PAD src0_sel:DWORD src1_sel:WORD_0
    v_lshlrev_b32_sdwa v90, 3, v122 dst_sel:DWORD dst_unused:UNUSED_PAD src0_sel:DWORD src1_sel:WORD_1
    ds_read_b64 v[88:89], v88
    ds_read_b64 v[90:91], v90
    v_mfma_f32_16x16x32_bf16 v[112:115], v[84:87], v[172:175], v[112:115]
    v_lshlrev_b32_sdwa v92, 3, v123 dst_sel:DWORD dst_unused:UNUSED_PAD src0_sel:DWORD src1_sel:WORD_0
    v_lshlrev_b32_sdwa v94, 3, v123 dst_sel:DWORD dst_unused:UNUSED_PAD src0_sel:DWORD src1_sel:WORD_1
    ds_read_b64 v[92:93], v92
    ds_read_b64 v[94:95], v94
    buffer_load_dwordx4 v[120:123], v71, s[12:15], s20 offen offset:2048 sc1
    s_waitcnt lgkmcnt(8)
    v_add3_u32 v44, v44, v96, v98
    v_add3_u32 v45, v45, v97, v99
    v_add3_u32 v44, v44, v100, v102
    v_add3_u32 v45, v45, v101, v103
    v_perm_b32 v112, v113, v112, s23
    v_perm_b32 v113, v115, v114, s23
    ds_write_b64 v70, v[112:113] offset:33024
    s_setprio 2
    s_lshl_b32 s64, s64, 25
    s_add_u32 s35, s35, s64
    s_waitcnt vmcnt(2)
    v_lshlrev_b32_sdwa v96, 3, v124 dst_sel:DWORD dst_unused:UNUSED_PAD src0_sel:DWORD src1_sel:WORD_0
    v_lshlrev_b32_sdwa v98, 3, v124 dst_sel:DWORD dst_unused:UNUSED_PAD src0_sel:DWORD src1_sel:WORD_1
    ds_read_b64 v[96:97], v96
    ds_read_b64 v[98:99], v98
    v_lshlrev_b32_sdwa v100, 3, v125 dst_sel:DWORD dst_unused:UNUSED_PAD src0_sel:DWORD src1_sel:WORD_0
    v_lshlrev_b32_sdwa v102, 3, v125 dst_sel:DWORD dst_unused:UNUSED_PAD src0_sel:DWORD src1_sel:WORD_1
    ds_read_b64 v[100:101], v100
    ds_read_b64 v[102:103], v102
    s_waitcnt lgkmcnt(9)
    v_add3_u32 v46, v46, v104, v106
    v_add3_u32 v47, v47, v105, v107
    v_add3_u32 v46, v46, v108, v110
    v_add3_u32 v47, v47, v109, v111
    s_add_u32 s35, s35, 20971520
    s_and_b32 s57, s57, 0xffff
    v_mfma_f32_16x16x32_bf16 v[112:115], v[72:75], v[176:179], v[66:69]
    v_lshlrev_b32_sdwa v104, 3, v126 dst_sel:DWORD dst_unused:UNUSED_PAD src0_sel:DWORD src1_sel:WORD_0
    v_lshlrev_b32_sdwa v106, 3, v126 dst_sel:DWORD dst_unused:UNUSED_PAD src0_sel:DWORD src1_sel:WORD_1
    ds_read_b64 v[104:105], v104
    ds_read_b64 v[106:107], v106
    v_mfma_f32_16x16x32_bf16 v[112:115], v[76:79], v[180:183], v[112:115]
    v_lshlrev_b32_sdwa v108, 3, v127 dst_sel:DWORD dst_unused:UNUSED_PAD src0_sel:DWORD src1_sel:WORD_0
    v_lshlrev_b32_sdwa v110, 3, v127 dst_sel:DWORD dst_unused:UNUSED_PAD src0_sel:DWORD src1_sel:WORD_1
    ds_read_b64 v[108:109], v108
    ds_read_b64 v[110:111], v110
    buffer_load_dwordx4 v[124:127], v71, s[12:15], s20 offen offset:3072 sc1
    s_waitcnt lgkmcnt(9)
    v_add3_u32 v46, v46, v88, v90
    v_add3_u32 v47, v47, v89, v91
    v_add3_u32 v46, v46, v92, v94
    v_add3_u32 v47, v47, v93, v95
    s_mov_b32 s58, 2
    s_mov_b32 s59, 0x00020000
    v_mfma_f32_16x16x32_bf16 v[112:115], v[80:83], v[184:187], v[112:115]
    s_waitcnt vmcnt(2)
    v_lshlrev_b32_sdwa v88, 3, v116 dst_sel:DWORD dst_unused:UNUSED_PAD src0_sel:DWORD src1_sel:WORD_0
    v_lshlrev_b32_sdwa v90, 3, v116 dst_sel:DWORD dst_unused:UNUSED_PAD src0_sel:DWORD src1_sel:WORD_1
    ds_read_b64 v[88:89], v88
    ds_read_b64 v[90:91], v90
    v_mfma_f32_16x16x32_bf16 v[112:115], v[84:87], v[188:191], v[112:115]
    v_lshlrev_b32_sdwa v92, 3, v117 dst_sel:DWORD dst_unused:UNUSED_PAD src0_sel:DWORD src1_sel:WORD_0
    v_lshlrev_b32_sdwa v94, 3, v117 dst_sel:DWORD dst_unused:UNUSED_PAD src0_sel:DWORD src1_sel:WORD_1
    ds_read_b64 v[92:93], v92
    ds_read_b64 v[94:95], v94
    s_waitcnt lgkmcnt(8)
    v_add3_u32 v48, v48, v96, v98
    v_add3_u32 v49, v49, v97, v99
    v_add3_u32 v48, v48, v100, v102
    v_add3_u32 v49, v49, v101, v103
    v_perm_b32 v112, v113, v112, s23
    v_perm_b32 v113, v115, v114, s23
    ds_write_b64 v70, v[112:113] offset:33152
    s_and_b32 s61, s61, 0xffff
    s_mov_b32 s62, 32768
    v_lshlrev_b32_sdwa v96, 3, v118 dst_sel:DWORD dst_unused:UNUSED_PAD src0_sel:DWORD src1_sel:WORD_0
    v_lshlrev_b32_sdwa v98, 3, v118 dst_sel:DWORD dst_unused:UNUSED_PAD src0_sel:DWORD src1_sel:WORD_1
    ds_read_b64 v[96:97], v96
    ds_read_b64 v[98:99], v98
    v_lshlrev_b32_sdwa v100, 3, v119 dst_sel:DWORD dst_unused:UNUSED_PAD src0_sel:DWORD src1_sel:WORD_0
    v_lshlrev_b32_sdwa v102, 3, v119 dst_sel:DWORD dst_unused:UNUSED_PAD src0_sel:DWORD src1_sel:WORD_1
    ds_read_b64 v[100:101], v100
    ds_read_b64 v[102:103], v102
    s_add_u32 s20, s20, 0x1000
    buffer_load_dwordx4 v[116:119], v71, s[12:15], s20 offen offset:0 sc1
    s_waitcnt lgkmcnt(9)
    v_add3_u32 v48, v48, v104, v106
    v_add3_u32 v49, v49, v105, v107
    v_add3_u32 v48, v48, v108, v110
    v_add3_u32 v49, v49, v109, v111
    s_mov_b32 s63, 0x00020000
    s_xor_b32 s64, s34, 1
    v_mfma_f32_16x16x32_bf16 v[112:115], v[72:75], v[192:195], v[66:69]
    s_waitcnt vmcnt(2)
    v_lshlrev_b32_sdwa v104, 3, v120 dst_sel:DWORD dst_unused:UNUSED_PAD src0_sel:DWORD src1_sel:WORD_0
    v_lshlrev_b32_sdwa v106, 3, v120 dst_sel:DWORD dst_unused:UNUSED_PAD src0_sel:DWORD src1_sel:WORD_1
    ds_read_b64 v[104:105], v104
    ds_read_b64 v[106:107], v106
    v_mfma_f32_16x16x32_bf16 v[112:115], v[76:79], v[196:199], v[112:115]
    v_lshlrev_b32_sdwa v108, 3, v121 dst_sel:DWORD dst_unused:UNUSED_PAD src0_sel:DWORD src1_sel:WORD_0
    v_lshlrev_b32_sdwa v110, 3, v121 dst_sel:DWORD dst_unused:UNUSED_PAD src0_sel:DWORD src1_sel:WORD_1
    ds_read_b64 v[108:109], v108
    ds_read_b64 v[110:111], v110
    s_waitcnt lgkmcnt(9)
    v_add3_u32 v50, v50, v88, v90
    v_add3_u32 v51, v51, v89, v91
    v_add3_u32 v50, v50, v92, v94
    v_add3_u32 v51, v51, v93, v95
    s_lshl_b32 s64, s64, 7
    s_add_u32 s64, s64, s33
    v_mfma_f32_16x16x32_bf16 v[112:115], v[80:83], v[200:203], v[112:115]
    v_lshlrev_b32_sdwa v88, 3, v122 dst_sel:DWORD dst_unused:UNUSED_PAD src0_sel:DWORD src1_sel:WORD_0
    v_lshlrev_b32_sdwa v90, 3, v122 dst_sel:DWORD dst_unused:UNUSED_PAD src0_sel:DWORD src1_sel:WORD_1
    ds_read_b64 v[88:89], v88
    ds_read_b64 v[90:91], v90
    v_mfma_f32_16x16x32_bf16 v[112:115], v[84:87], v[204:207], v[112:115]
    v_lshlrev_b32_sdwa v92, 3, v123 dst_sel:DWORD dst_unused:UNUSED_PAD src0_sel:DWORD src1_sel:WORD_0
    v_lshlrev_b32_sdwa v94, 3, v123 dst_sel:DWORD dst_unused:UNUSED_PAD src0_sel:DWORD src1_sel:WORD_1
    ds_read_b64 v[92:93], v92
    ds_read_b64 v[94:95], v94
    buffer_load_dwordx4 v[120:123], v71, s[12:15], s20 offen offset:1024 sc1
    s_waitcnt lgkmcnt(8)
    v_add3_u32 v50, v50, v96, v98
    v_add3_u32 v51, v51, v97, v99
    v_add3_u32 v50, v50, v100, v102
    v_add3_u32 v51, v51, v101, v103
    v_perm_b32 v112, v113, v112, s23
    v_perm_b32 v113, v115, v114, s23
    ds_write_b64 v70, v[112:113] offset:33280
    s_lshl_b32 s65, s3, 20
    s_add_u32 s66, s65, 1048576
    s_waitcnt vmcnt(2)
    v_lshlrev_b32_sdwa v96, 3, v124 dst_sel:DWORD dst_unused:UNUSED_PAD src0_sel:DWORD src1_sel:WORD_0
    v_lshlrev_b32_sdwa v98, 3, v124 dst_sel:DWORD dst_unused:UNUSED_PAD src0_sel:DWORD src1_sel:WORD_1
    ds_read_b64 v[96:97], v96
    ds_read_b64 v[98:99], v98
    v_lshlrev_b32_sdwa v100, 3, v125 dst_sel:DWORD dst_unused:UNUSED_PAD src0_sel:DWORD src1_sel:WORD_0
    v_lshlrev_b32_sdwa v102, 3, v125 dst_sel:DWORD dst_unused:UNUSED_PAD src0_sel:DWORD src1_sel:WORD_1
    ds_read_b64 v[100:101], v100
    ds_read_b64 v[102:103], v102
    s_waitcnt lgkmcnt(9)
    v_add3_u32 v52, v52, v104, v106
    v_add3_u32 v53, v53, v105, v107
    v_add3_u32 v52, v52, v108, v110
    v_add3_u32 v53, v53, v109, v111
    s_lshl_b32 s67, s3, 14
    s_add_u32 s67, s67, 8000
    v_mfma_f32_16x16x32_bf16 v[112:115], v[72:75], v[208:211], v[66:69]
    v_lshlrev_b32_sdwa v104, 3, v126 dst_sel:DWORD dst_unused:UNUSED_PAD src0_sel:DWORD src1_sel:WORD_0
    v_lshlrev_b32_sdwa v106, 3, v126 dst_sel:DWORD dst_unused:UNUSED_PAD src0_sel:DWORD src1_sel:WORD_1
    ds_read_b64 v[104:105], v104
    ds_read_b64 v[106:107], v106
    v_mfma_f32_16x16x32_bf16 v[112:115], v[76:79], v[212:215], v[112:115]
    v_lshlrev_b32_sdwa v108, 3, v127 dst_sel:DWORD dst_unused:UNUSED_PAD src0_sel:DWORD src1_sel:WORD_0
    v_lshlrev_b32_sdwa v110, 3, v127 dst_sel:DWORD dst_unused:UNUSED_PAD src0_sel:DWORD src1_sel:WORD_1
    ds_read_b64 v[108:109], v108
    ds_read_b64 v[110:111], v110
    buffer_load_dwordx4 v[124:127], v71, s[12:15], s20 offen offset:2048 sc1
    s_waitcnt lgkmcnt(9)
    v_add3_u32 v52, v52, v88, v90
    v_add3_u32 v53, v53, v89, v91
    v_add3_u32 v52, v52, v92, v94
    v_add3_u32 v53, v53, v93, v95
    s_setprio 1
    s_lshl_b32 s68, s64, 7
    s_lshl_b32 s69, s64, 8
    v_mfma_f32_16x16x32_bf16 v[112:115], v[80:83], v[216:219], v[112:115]
    s_waitcnt vmcnt(2)
    v_lshlrev_b32_sdwa v88, 3, v116 dst_sel:DWORD dst_unused:UNUSED_PAD src0_sel:DWORD src1_sel:WORD_0
    v_lshlrev_b32_sdwa v90, 3, v116 dst_sel:DWORD dst_unused:UNUSED_PAD src0_sel:DWORD src1_sel:WORD_1
    ds_read_b64 v[88:89], v88
    ds_read_b64 v[90:91], v90
    v_mfma_f32_16x16x32_bf16 v[112:115], v[84:87], v[220:223], v[112:115]
    v_lshlrev_b32_sdwa v92, 3, v117 dst_sel:DWORD dst_unused:UNUSED_PAD src0_sel:DWORD src1_sel:WORD_0
    v_lshlrev_b32_sdwa v94, 3, v117 dst_sel:DWORD dst_unused:UNUSED_PAD src0_sel:DWORD src1_sel:WORD_1
    ds_read_b64 v[92:93], v92
    ds_read_b64 v[94:95], v94
    s_waitcnt lgkmcnt(8)
    v_add3_u32 v54, v54, v96, v98
    v_add3_u32 v55, v55, v97, v99
    v_add3_u32 v54, v54, v100, v102
    v_add3_u32 v55, v55, v101, v103
    v_perm_b32 v112, v113, v112, s23
    v_perm_b32 v113, v115, v114, s23
    ds_write_b64 v70, v[112:113] offset:33408
    s_add_u32 s69, s69, s65
    s_add_u32 s69, s69, 20971520
    v_lshlrev_b32_sdwa v96, 3, v118 dst_sel:DWORD dst_unused:UNUSED_PAD src0_sel:DWORD src1_sel:WORD_0
    v_lshlrev_b32_sdwa v98, 3, v118 dst_sel:DWORD dst_unused:UNUSED_PAD src0_sel:DWORD src1_sel:WORD_1
    ds_read_b64 v[96:97], v96
    ds_read_b64 v[98:99], v98
    v_lshlrev_b32_sdwa v100, 3, v119 dst_sel:DWORD dst_unused:UNUSED_PAD src0_sel:DWORD src1_sel:WORD_0
    v_lshlrev_b32_sdwa v102, 3, v119 dst_sel:DWORD dst_unused:UNUSED_PAD src0_sel:DWORD src1_sel:WORD_1
    ds_read_b64 v[100:101], v100
    ds_read_b64 v[102:103], v102
    buffer_load_dwordx4 v[116:119], v71, s[12:15], s20 offen offset:3072 sc1
    s_waitcnt lgkmcnt(9)
    v_add3_u32 v54, v54, v104, v106
    v_add3_u32 v55, v55, v105, v107
    v_add3_u32 v54, v54, v108, v110
    v_add3_u32 v55, v55, v109, v111
    s_mov_b32 s42, 0
    s_mov_b32 s43, 0
    v_mfma_f32_16x16x32_bf16 v[112:115], v[72:75], v[224:227], v[66:69]
    s_waitcnt vmcnt(2)
    v_lshlrev_b32_sdwa v104, 3, v120 dst_sel:DWORD dst_unused:UNUSED_PAD src0_sel:DWORD src1_sel:WORD_0
    v_lshlrev_b32_sdwa v106, 3, v120 dst_sel:DWORD dst_unused:UNUSED_PAD src0_sel:DWORD src1_sel:WORD_1
    ds_read_b64 v[104:105], v104
    ds_read_b64 v[106:107], v106
    v_mfma_f32_16x16x32_bf16 v[112:115], v[76:79], v[228:231], v[112:115]
    v_lshlrev_b32_sdwa v108, 3, v121 dst_sel:DWORD dst_unused:UNUSED_PAD src0_sel:DWORD src1_sel:WORD_0
    v_lshlrev_b32_sdwa v110, 3, v121 dst_sel:DWORD dst_unused:UNUSED_PAD src0_sel:DWORD src1_sel:WORD_1
    ds_read_b64 v[108:109], v108
    ds_read_b64 v[110:111], v110
    s_waitcnt lgkmcnt(9)
    v_add3_u32 v56, v56, v88, v90
    v_add3_u32 v57, v57, v89, v91
    v_add3_u32 v56, v56, v92, v94
    v_add3_u32 v57, v57, v93, v95
    s_add_u32 s17, s16, 4096
    s_add_u32 s32, s18, 4096
    v_mfma_f32_16x16x32_bf16 v[112:115], v[80:83], v[232:235], v[112:115]
    v_lshlrev_b32_sdwa v88, 3, v122 dst_sel:DWORD dst_unused:UNUSED_PAD src0_sel:DWORD src1_sel:WORD_0
    v_lshlrev_b32_sdwa v90, 3, v122 dst_sel:DWORD dst_unused:UNUSED_PAD src0_sel:DWORD src1_sel:WORD_1
    ds_read_b64 v[88:89], v88
    ds_read_b64 v[90:91], v90
    v_mfma_f32_16x16x32_bf16 v[112:115], v[84:87], v[236:239], v[112:115]
    v_lshlrev_b32_sdwa v92, 3, v123 dst_sel:DWORD dst_unused:UNUSED_PAD src0_sel:DWORD src1_sel:WORD_0
    v_lshlrev_b32_sdwa v94, 3, v123 dst_sel:DWORD dst_unused:UNUSED_PAD src0_sel:DWORD src1_sel:WORD_1
    ds_read_b64 v[92:93], v92
    ds_read_b64 v[94:95], v94
    s_add_u32 s20, s20, 0x3d000
    buffer_load_dwordx4 v[120:123], v71, s[12:15], s20 offen offset:0 sc1
    s_waitcnt lgkmcnt(8)
    v_add3_u32 v56, v56, v96, v98
    v_add3_u32 v57, v57, v97, v99
    v_add3_u32 v56, v56, v100, v102
    v_add3_u32 v57, v57, v101, v103
    v_perm_b32 v112, v113, v112, s23
    v_perm_b32 v113, v115, v114, s23
    ds_write_b64 v70, v[112:113] offset:33536
    s_add_u32 s40, s26, 0x4a800000
    s_min_u32 s27, s40, 0x7f000000
    s_waitcnt vmcnt(2)
    v_lshlrev_b32_sdwa v96, 3, v124 dst_sel:DWORD dst_unused:UNUSED_PAD src0_sel:DWORD src1_sel:WORD_0
    v_lshlrev_b32_sdwa v98, 3, v124 dst_sel:DWORD dst_unused:UNUSED_PAD src0_sel:DWORD src1_sel:WORD_1
    ds_read_b64 v[96:97], v96
    ds_read_b64 v[98:99], v98
    v_lshlrev_b32_sdwa v100, 3, v125 dst_sel:DWORD dst_unused:UNUSED_PAD src0_sel:DWORD src1_sel:WORD_0
    v_lshlrev_b32_sdwa v102, 3, v125 dst_sel:DWORD dst_unused:UNUSED_PAD src0_sel:DWORD src1_sel:WORD_1
    ds_read_b64 v[100:101], v100
    ds_read_b64 v[102:103], v102
    s_waitcnt lgkmcnt(9)
    v_add3_u32 v58, v58, v104, v106
    v_add3_u32 v59, v59, v105, v107
    v_add3_u32 v58, v58, v108, v110
    v_add3_u32 v59, v59, v109, v111
    s_sub_u32 s40, s40, s27
    s_lshr_b32 s40, s40, 23
    v_mfma_f32_16x16x32_bf16 v[112:115], v[72:75], v[240:243], v[66:69]
    v_lshlrev_b32_sdwa v104, 3, v126 dst_sel:DWORD dst_unused:UNUSED_PAD src0_sel:DWORD src1_sel:WORD_0
    v_lshlrev_b32_sdwa v106, 3, v126 dst_sel:DWORD dst_unused:UNUSED_PAD src0_sel:DWORD src1_sel:WORD_1
    ds_read_b64 v[104:105], v104
    ds_read_b64 v[106:107], v106
    v_mfma_f32_16x16x32_bf16 v[112:115], v[76:79], v[244:247], v[112:115]
    v_lshlrev_b32_sdwa v108, 3, v127 dst_sel:DWORD dst_unused:UNUSED_PAD src0_sel:DWORD src1_sel:WORD_0
    v_lshlrev_b32_sdwa v110, 3, v127 dst_sel:DWORD dst_unused:UNUSED_PAD src0_sel:DWORD src1_sel:WORD_1
    ds_read_b64 v[108:109], v108
    ds_read_b64 v[110:111], v110
    buffer_load_dwordx4 v[72:75], v71, s[12:15], s20 offen offset:1024 sc1
    s_waitcnt lgkmcnt(9)
    v_add3_u32 v58, v58, v88, v90
    v_add3_u32 v59, v59, v89, v91
    v_add3_u32 v58, v58, v92, v94
    v_add3_u32 v59, v59, v93, v95
    s_setprio 0
    s_mul_i32 s41, s40, 3
    s_sub_u32 s49, 0, s40
    v_mfma_f32_16x16x32_bf16 v[112:115], v[80:83], v[248:251], v[112:115]
    s_waitcnt vmcnt(2)
    v_lshlrev_b32_sdwa v88, 3, v116 dst_sel:DWORD dst_unused:UNUSED_PAD src0_sel:DWORD src1_sel:WORD_0
    v_lshlrev_b32_sdwa v90, 3, v116 dst_sel:DWORD dst_unused:UNUSED_PAD src0_sel:DWORD src1_sel:WORD_1
    ds_read_b64 v[88:89], v88
    ds_read_b64 v[90:91], v90
    v_mfma_f32_16x16x32_bf16 v[112:115], v[84:87], v[252:255], v[112:115]
    v_lshlrev_b32_sdwa v92, 3, v117 dst_sel:DWORD dst_unused:UNUSED_PAD src0_sel:DWORD src1_sel:WORD_0
    v_lshlrev_b32_sdwa v94, 3, v117 dst_sel:DWORD dst_unused:UNUSED_PAD src0_sel:DWORD src1_sel:WORD_1
    ds_read_b64 v[92:93], v92
    ds_read_b64 v[94:95], v94
    buffer_load_dwordx4 v[76:79], v71, s[12:15], s20 offen offset:2048 sc1
    s_waitcnt lgkmcnt(8)
    v_add3_u32 v60, v60, v96, v98
    v_add3_u32 v61, v61, v97, v99
    v_add3_u32 v60, v60, v100, v102
    v_add3_u32 v61, v61, v101, v103
    v_perm_b32 v112, v113, v112, s23
    v_perm_b32 v113, v115, v114, s23
    ds_write_b64 v70, v[112:113] offset:33664
    s_setreg_imm32_b32 hwreg(HW_REG_MODE, 4, 2), 3
    v_lshlrev_b32_sdwa v96, 3, v118 dst_sel:DWORD dst_unused:UNUSED_PAD src0_sel:DWORD src1_sel:WORD_0
    v_lshlrev_b32_sdwa v98, 3, v118 dst_sel:DWORD dst_unused:UNUSED_PAD src0_sel:DWORD src1_sel:WORD_1
    ds_read_b64 v[96:97], v96
    ds_read_b64 v[98:99], v98
    v_lshlrev_b32_sdwa v100, 3, v119 dst_sel:DWORD dst_unused:UNUSED_PAD src0_sel:DWORD src1_sel:WORD_0
    v_lshlrev_b32_sdwa v102, 3, v119 dst_sel:DWORD dst_unused:UNUSED_PAD src0_sel:DWORD src1_sel:WORD_1
    ds_read_b64 v[100:101], v100
    ds_read_b64 v[102:103], v102
    buffer_load_dwordx4 v[124:127], v71, s[12:15], s20 offen offset:3072 sc1
    s_waitcnt lgkmcnt(9)
    v_add3_u32 v60, v60, v104, v106
    v_add3_u32 v61, v61, v105, v107
    v_add3_u32 v60, v60, v108, v110
    v_add3_u32 v61, v61, v109, v111
    s_waitcnt lgkmcnt(4)
    s_barrier
    s_setprio 3
    s_waitcnt vmcnt(3)
    v_lshlrev_b32_sdwa v104, 3, v120 dst_sel:DWORD dst_unused:UNUSED_PAD src0_sel:DWORD src1_sel:WORD_0
    v_lshlrev_b32_sdwa v106, 3, v120 dst_sel:DWORD dst_unused:UNUSED_PAD src0_sel:DWORD src1_sel:WORD_1
    ds_read_b64 v[104:105], v104
    ds_read_b64 v[106:107], v106
    v_lshlrev_b32_sdwa v108, 3, v121 dst_sel:DWORD dst_unused:UNUSED_PAD src0_sel:DWORD src1_sel:WORD_0
    v_lshlrev_b32_sdwa v110, 3, v121 dst_sel:DWORD dst_unused:UNUSED_PAD src0_sel:DWORD src1_sel:WORD_1
    ds_read_b64 v[108:109], v108
    ds_read_b64 v[110:111], v110
    s_add_u32 s20, s20, 0x1000
    buffer_load_dwordx4 v[80:83], v71, s[12:15], s20 offen offset:0 sc1
    v_add3_u32 v62, v62, v88, v90
    v_add3_u32 v63, v63, v89, v91
    v_add3_u32 v62, v62, v92, v94
    v_add3_u32 v63, v63, v93, v95
    v_lshlrev_b32_sdwa v88, 3, v122 dst_sel:DWORD dst_unused:UNUSED_PAD src0_sel:DWORD src1_sel:WORD_0
    v_lshlrev_b32_sdwa v90, 3, v122 dst_sel:DWORD dst_unused:UNUSED_PAD src0_sel:DWORD src1_sel:WORD_1
    ds_read_b64 v[88:89], v88
    ds_read_b64 v[90:91], v90
    v_lshlrev_b32_sdwa v92, 3, v123 dst_sel:DWORD dst_unused:UNUSED_PAD src0_sel:DWORD src1_sel:WORD_0
    v_lshlrev_b32_sdwa v94, 3, v123 dst_sel:DWORD dst_unused:UNUSED_PAD src0_sel:DWORD src1_sel:WORD_1
    ds_read_b64 v[92:93], v92
    ds_read_b64 v[94:95], v94
    buffer_load_dwordx4 v[84:87], v71, s[12:15], s20 offen offset:1024 sc1
    s_waitcnt lgkmcnt(8)
    v_add3_u32 v62, v62, v96, v98
    v_add3_u32 v63, v63, v97, v99
    v_add3_u32 v62, v62, v100, v102
    v_add3_u32 v63, v63, v101, v103
    s_waitcnt vmcnt(4)
    v_lshlrev_b32_sdwa v96, 3, v72 dst_sel:DWORD dst_unused:UNUSED_PAD src0_sel:DWORD src1_sel:WORD_0
    v_lshlrev_b32_sdwa v98, 3, v72 dst_sel:DWORD dst_unused:UNUSED_PAD src0_sel:DWORD src1_sel:WORD_1
    ds_read_b64 v[96:97], v96
    ds_read_b64 v[98:99], v98
    v_lshlrev_b32_sdwa v100, 3, v73 dst_sel:DWORD dst_unused:UNUSED_PAD src0_sel:DWORD src1_sel:WORD_0
    v_lshlrev_b32_sdwa v102, 3, v73 dst_sel:DWORD dst_unused:UNUSED_PAD src0_sel:DWORD src1_sel:WORD_1
    ds_read_b64 v[100:101], v100
    ds_read_b64 v[102:103], v102
    buffer_load_dwordx4 v[116:119], v71, s[12:15], s20 offen offset:2048 sc1
    s_waitcnt lgkmcnt(8)
    v_add3_u32 v32, v32, v104, v106
    v_add3_u32 v33, v33, v105, v107
    v_add3_u32 v32, v32, v108, v110
    v_add3_u32 v33, v33, v109, v111
    v_lshlrev_b32_sdwa v104, 3, v74 dst_sel:DWORD dst_unused:UNUSED_PAD src0_sel:DWORD src1_sel:WORD_0
    v_lshlrev_b32_sdwa v106, 3, v74 dst_sel:DWORD dst_unused:UNUSED_PAD src0_sel:DWORD src1_sel:WORD_1
    ds_read_b64 v[104:105], v104
    ds_read_b64 v[106:107], v106
    v_lshlrev_b32_sdwa v108, 3, v75 dst_sel:DWORD dst_unused:UNUSED_PAD src0_sel:DWORD src1_sel:WORD_0
    v_lshlrev_b32_sdwa v110, 3, v75 dst_sel:DWORD dst_unused:UNUSED_PAD src0_sel:DWORD src1_sel:WORD_1
    ds_read_b64 v[108:109], v108
    ds_read_b64 v[110:111], v110
    buffer_load_dwordx4 v[120:123], v71, s[12:15], s20 offen offset:3072 sc1
    s_waitcnt lgkmcnt(8)
    v_add3_u32 v32, v32, v88, v90
    v_add3_u32 v33, v33, v89, v91
    v_add3_u32 v32, v32, v92, v94
    v_add3_u32 v33, v33, v93, v95
    s_waitcnt vmcnt(5)
    v_lshlrev_b32_sdwa v88, 3, v76 dst_sel:DWORD dst_unused:UNUSED_PAD src0_sel:DWORD src1_sel:WORD_0
    v_lshlrev_b32_sdwa v90, 3, v76 dst_sel:DWORD dst_unused:UNUSED_PAD src0_sel:DWORD src1_sel:WORD_1
    ds_read_b64 v[88:89], v88
    ds_read_b64 v[90:91], v90
    v_lshlrev_b32_sdwa v92, 3, v77 dst_sel:DWORD dst_unused:UNUSED_PAD src0_sel:DWORD src1_sel:WORD_0
    v_lshlrev_b32_sdwa v94, 3, v77 dst_sel:DWORD dst_unused:UNUSED_PAD src0_sel:DWORD src1_sel:WORD_1
    ds_read_b64 v[92:93], v92
    ds_read_b64 v[94:95], v94
    s_add_u32 s20, s20, 0x1000
    buffer_load_dwordx4 v[72:75], v71, s[12:15], s20 offen offset:0 sc1
    s_waitcnt lgkmcnt(8)
    v_add3_u32 v34, v34, v96, v98
    v_add3_u32 v35, v35, v97, v99
    v_add3_u32 v34, v34, v100, v102
    v_add3_u32 v35, v35, v101, v103
    v_lshlrev_b32_sdwa v96, 3, v78 dst_sel:DWORD dst_unused:UNUSED_PAD src0_sel:DWORD src1_sel:WORD_0
    v_lshlrev_b32_sdwa v98, 3, v78 dst_sel:DWORD dst_unused:UNUSED_PAD src0_sel:DWORD src1_sel:WORD_1
    ds_read_b64 v[96:97], v96
    ds_read_b64 v[98:99], v98
    v_lshlrev_b32_sdwa v100, 3, v79 dst_sel:DWORD dst_unused:UNUSED_PAD src0_sel:DWORD src1_sel:WORD_0
    v_lshlrev_b32_sdwa v102, 3, v79 dst_sel:DWORD dst_unused:UNUSED_PAD src0_sel:DWORD src1_sel:WORD_1
    ds_read_b64 v[100:101], v100
    ds_read_b64 v[102:103], v102
    buffer_load_dwordx4 v[76:79], v71, s[12:15], s20 offen offset:1024 sc1
    s_waitcnt lgkmcnt(8)
    v_add3_u32 v34, v34, v104, v106
    v_add3_u32 v35, v35, v105, v107
    v_add3_u32 v34, v34, v108, v110
    v_add3_u32 v35, v35, v109, v111
    s_waitcnt vmcnt(6)
    v_lshlrev_b32_sdwa v104, 3, v124 dst_sel:DWORD dst_unused:UNUSED_PAD src0_sel:DWORD src1_sel:WORD_0
    v_lshlrev_b32_sdwa v106, 3, v124 dst_sel:DWORD dst_unused:UNUSED_PAD src0_sel:DWORD src1_sel:WORD_1
    ds_read_b64 v[104:105], v104
    ds_read_b64 v[106:107], v106
    v_lshlrev_b32_sdwa v108, 3, v125 dst_sel:DWORD dst_unused:UNUSED_PAD src0_sel:DWORD src1_sel:WORD_0
    v_lshlrev_b32_sdwa v110, 3, v125 dst_sel:DWORD dst_unused:UNUSED_PAD src0_sel:DWORD src1_sel:WORD_1
    ds_read_b64 v[108:109], v108
    ds_read_b64 v[110:111], v110
    buffer_store_dwordx4 v[32:35], v71, s[12:15], s16 offen offset:0 sc1
    s_waitcnt lgkmcnt(8)
    v_add3_u32 v36, v36, v88, v90
    v_add3_u32 v37, v37, v89, v91
    v_add3_u32 v36, v36, v92, v94
    v_add3_u32 v37, v37, v93, v95
    v_lshlrev_b32_sdwa v88, 3, v126 dst_sel:DWORD dst_unused:UNUSED_PAD src0_sel:DWORD src1_sel:WORD_0
    v_lshlrev_b32_sdwa v90, 3, v126 dst_sel:DWORD dst_unused:UNUSED_PAD src0_sel:DWORD src1_sel:WORD_1
    ds_read_b64 v[88:89], v88
    ds_read_b64 v[90:91], v90
    v_lshlrev_b32_sdwa v92, 3, v127 dst_sel:DWORD dst_unused:UNUSED_PAD src0_sel:DWORD src1_sel:WORD_0
    v_lshlrev_b32_sdwa v94, 3, v127 dst_sel:DWORD dst_unused:UNUSED_PAD src0_sel:DWORD src1_sel:WORD_1
    ds_read_b64 v[92:93], v92
    ds_read_b64 v[94:95], v94
    buffer_load_dwordx4 v[32:35], v71, s[12:15], s20 offen offset:2048 sc1
    s_waitcnt lgkmcnt(8)
    v_add3_u32 v36, v36, v96, v98
    v_add3_u32 v37, v37, v97, v99
    v_add3_u32 v36, v36, v100, v102
    v_add3_u32 v37, v37, v101, v103
    s_waitcnt vmcnt(7)
    v_lshlrev_b32_sdwa v96, 3, v80 dst_sel:DWORD dst_unused:UNUSED_PAD src0_sel:DWORD src1_sel:WORD_0
    v_lshlrev_b32_sdwa v98, 3, v80 dst_sel:DWORD dst_unused:UNUSED_PAD src0_sel:DWORD src1_sel:WORD_1
    ds_read_b64 v[96:97], v96
    ds_read_b64 v[98:99], v98
    v_lshlrev_b32_sdwa v100, 3, v81 dst_sel:DWORD dst_unused:UNUSED_PAD src0_sel:DWORD src1_sel:WORD_0
    v_lshlrev_b32_sdwa v102, 3, v81 dst_sel:DWORD dst_unused:UNUSED_PAD src0_sel:DWORD src1_sel:WORD_1
    ds_read_b64 v[100:101], v100
    ds_read_b64 v[102:103], v102
    buffer_load_dwordx4 v[124:127], v71, s[12:15], s20 offen offset:3072 sc1
    s_waitcnt lgkmcnt(8)
    v_add3_u32 v38, v38, v104, v106
    v_add3_u32 v39, v39, v105, v107
    v_add3_u32 v38, v38, v108, v110
    v_add3_u32 v39, v39, v109, v111
    v_lshlrev_b32_sdwa v104, 3, v82 dst_sel:DWORD dst_unused:UNUSED_PAD src0_sel:DWORD src1_sel:WORD_0
    v_lshlrev_b32_sdwa v106, 3, v82 dst_sel:DWORD dst_unused:UNUSED_PAD src0_sel:DWORD src1_sel:WORD_1
    ds_read_b64 v[104:105], v104
    ds_read_b64 v[106:107], v106
    v_lshlrev_b32_sdwa v108, 3, v83 dst_sel:DWORD dst_unused:UNUSED_PAD src0_sel:DWORD src1_sel:WORD_0
    v_lshlrev_b32_sdwa v110, 3, v83 dst_sel:DWORD dst_unused:UNUSED_PAD src0_sel:DWORD src1_sel:WORD_1
    ds_read_b64 v[108:109], v108
    ds_read_b64 v[110:111], v110
    s_waitcnt lgkmcnt(8)
    v_add3_u32 v38, v38, v88, v90
    v_add3_u32 v39, v39, v89, v91
    v_add3_u32 v38, v38, v92, v94
    v_add3_u32 v39, v39, v93, v95
    s_waitcnt vmcnt(7)
    v_lshlrev_b32_sdwa v88, 3, v84 dst_sel:DWORD dst_unused:UNUSED_PAD src0_sel:DWORD src1_sel:WORD_0
    v_lshlrev_b32_sdwa v90, 3, v84 dst_sel:DWORD dst_unused:UNUSED_PAD src0_sel:DWORD src1_sel:WORD_1
    ds_read_b64 v[88:89], v88
    ds_read_b64 v[90:91], v90
    v_lshlrev_b32_sdwa v92, 3, v85 dst_sel:DWORD dst_unused:UNUSED_PAD src0_sel:DWORD src1_sel:WORD_0
    v_lshlrev_b32_sdwa v94, 3, v85 dst_sel:DWORD dst_unused:UNUSED_PAD src0_sel:DWORD src1_sel:WORD_1
    ds_read_b64 v[92:93], v92
    ds_read_b64 v[94:95], v94
    s_add_u32 s20, s20, 0x1000
    buffer_load_dwordx4 v[80:83], v71, s[12:15], s20 offen offset:0 sc1
    s_waitcnt lgkmcnt(8)
    v_add3_u32 v40, v40, v96, v98
    v_add3_u32 v41, v41, v97, v99
    v_add3_u32 v40, v40, v100, v102
    v_add3_u32 v41, v41, v101, v103
    v_lshlrev_b32_sdwa v96, 3, v86 dst_sel:DWORD dst_unused:UNUSED_PAD src0_sel:DWORD src1_sel:WORD_0
    v_lshlrev_b32_sdwa v98, 3, v86 dst_sel:DWORD dst_unused:UNUSED_PAD src0_sel:DWORD src1_sel:WORD_1
    ds_read_b64 v[96:97], v96
    ds_read_b64 v[98:99], v98
    v_lshlrev_b32_sdwa v100, 3, v87 dst_sel:DWORD dst_unused:UNUSED_PAD src0_sel:DWORD src1_sel:WORD_0
    v_lshlrev_b32_sdwa v102, 3, v87 dst_sel:DWORD dst_unused:UNUSED_PAD src0_sel:DWORD src1_sel:WORD_1
    ds_read_b64 v[100:101], v100
    ds_read_b64 v[102:103], v102
    s_waitcnt lgkmcnt(8)
    v_add3_u32 v40, v40, v104, v106
    v_add3_u32 v41, v41, v105, v107
    v_add3_u32 v40, v40, v108, v110
    v_add3_u32 v41, v41, v109, v111
    s_waitcnt vmcnt(7)
    v_lshlrev_b32_sdwa v104, 3, v116 dst_sel:DWORD dst_unused:UNUSED_PAD src0_sel:DWORD src1_sel:WORD_0
    v_lshlrev_b32_sdwa v106, 3, v116 dst_sel:DWORD dst_unused:UNUSED_PAD src0_sel:DWORD src1_sel:WORD_1
    ds_read_b64 v[104:105], v104
    ds_read_b64 v[106:107], v106
    v_lshlrev_b32_sdwa v108, 3, v117 dst_sel:DWORD dst_unused:UNUSED_PAD src0_sel:DWORD src1_sel:WORD_0
    v_lshlrev_b32_sdwa v110, 3, v117 dst_sel:DWORD dst_unused:UNUSED_PAD src0_sel:DWORD src1_sel:WORD_1
    ds_read_b64 v[108:109], v108
    ds_read_b64 v[110:111], v110
    buffer_load_dwordx4 v[84:87], v71, s[12:15], s20 offen offset:1024 sc1
    s_waitcnt lgkmcnt(8)
    v_add3_u32 v42, v42, v88, v90
    v_add3_u32 v43, v43, v89, v91
    v_add3_u32 v42, v42, v92, v94
    v_add3_u32 v43, v43, v93, v95
    v_lshlrev_b32_sdwa v88, 3, v118 dst_sel:DWORD dst_unused:UNUSED_PAD src0_sel:DWORD src1_sel:WORD_0
    v_lshlrev_b32_sdwa v90, 3, v118 dst_sel:DWORD dst_unused:UNUSED_PAD src0_sel:DWORD src1_sel:WORD_1
    ds_read_b64 v[88:89], v88
    ds_read_b64 v[90:91], v90
    v_lshlrev_b32_sdwa v92, 3, v119 dst_sel:DWORD dst_unused:UNUSED_PAD src0_sel:DWORD src1_sel:WORD_0
    v_lshlrev_b32_sdwa v94, 3, v119 dst_sel:DWORD dst_unused:UNUSED_PAD src0_sel:DWORD src1_sel:WORD_1
    ds_read_b64 v[92:93], v92
    ds_read_b64 v[94:95], v94
    s_waitcnt lgkmcnt(8)
    v_add3_u32 v42, v42, v96, v98
    v_add3_u32 v43, v43, v97, v99
    v_add3_u32 v42, v42, v100, v102
    v_add3_u32 v43, v43, v101, v103
    s_waitcnt vmcnt(7)
    v_lshlrev_b32_sdwa v96, 3, v120 dst_sel:DWORD dst_unused:UNUSED_PAD src0_sel:DWORD src1_sel:WORD_0
    v_lshlrev_b32_sdwa v98, 3, v120 dst_sel:DWORD dst_unused:UNUSED_PAD src0_sel:DWORD src1_sel:WORD_1
    ds_read_b64 v[96:97], v96
    ds_read_b64 v[98:99], v98
    v_lshlrev_b32_sdwa v100, 3, v121 dst_sel:DWORD dst_unused:UNUSED_PAD src0_sel:DWORD src1_sel:WORD_0
    v_lshlrev_b32_sdwa v102, 3, v121 dst_sel:DWORD dst_unused:UNUSED_PAD src0_sel:DWORD src1_sel:WORD_1
    ds_read_b64 v[100:101], v100
    ds_read_b64 v[102:103], v102
    buffer_load_dwordx4 v[116:119], v71, s[12:15], s20 offen offset:2048 sc1
    buffer_store_dwordx4 v[36:39], v71, s[12:15], s16 offen offset:1024 sc1
    s_waitcnt lgkmcnt(8)
    v_add3_u32 v44, v44, v104, v106
    v_add3_u32 v45, v45, v105, v107
    v_add3_u32 v44, v44, v108, v110
    v_add3_u32 v45, v45, v109, v111
    v_lshlrev_b32_sdwa v104, 3, v122 dst_sel:DWORD dst_unused:UNUSED_PAD src0_sel:DWORD src1_sel:WORD_0
    v_lshlrev_b32_sdwa v106, 3, v122 dst_sel:DWORD dst_unused:UNUSED_PAD src0_sel:DWORD src1_sel:WORD_1
    ds_read_b64 v[104:105], v104
    ds_read_b64 v[106:107], v106
    v_lshlrev_b32_sdwa v108, 3, v123 dst_sel:DWORD dst_unused:UNUSED_PAD src0_sel:DWORD src1_sel:WORD_0
    v_lshlrev_b32_sdwa v110, 3, v123 dst_sel:DWORD dst_unused:UNUSED_PAD src0_sel:DWORD src1_sel:WORD_1
    ds_read_b64 v[108:109], v108
    ds_read_b64 v[110:111], v110
    s_waitcnt lgkmcnt(8)
    v_add3_u32 v44, v44, v88, v90
    v_add3_u32 v45, v45, v89, v91
    v_add3_u32 v44, v44, v92, v94
    v_add3_u32 v45, v45, v93, v95
    s_waitcnt vmcnt(8)
    v_lshlrev_b32_sdwa v88, 3, v72 dst_sel:DWORD dst_unused:UNUSED_PAD src0_sel:DWORD src1_sel:WORD_0
    v_lshlrev_b32_sdwa v90, 3, v72 dst_sel:DWORD dst_unused:UNUSED_PAD src0_sel:DWORD src1_sel:WORD_1
    ds_read_b64 v[88:89], v88
    ds_read_b64 v[90:91], v90
    v_lshlrev_b32_sdwa v92, 3, v73 dst_sel:DWORD dst_unused:UNUSED_PAD src0_sel:DWORD src1_sel:WORD_0
    v_lshlrev_b32_sdwa v94, 3, v73 dst_sel:DWORD dst_unused:UNUSED_PAD src0_sel:DWORD src1_sel:WORD_1
    ds_read_b64 v[92:93], v92
    ds_read_b64 v[94:95], v94
    buffer_load_dwordx4 v[36:39], v71, s[12:15], s20 offen offset:3072 sc1
    s_waitcnt lgkmcnt(8)
    v_add3_u32 v46, v46, v96, v98
    v_add3_u32 v47, v47, v97, v99
    v_add3_u32 v46, v46, v100, v102
    v_add3_u32 v47, v47, v101, v103
    v_lshlrev_b32_sdwa v96, 3, v74 dst_sel:DWORD dst_unused:UNUSED_PAD src0_sel:DWORD src1_sel:WORD_0
    v_lshlrev_b32_sdwa v98, 3, v74 dst_sel:DWORD dst_unused:UNUSED_PAD src0_sel:DWORD src1_sel:WORD_1
    ds_read_b64 v[96:97], v96
    ds_read_b64 v[98:99], v98
    v_lshlrev_b32_sdwa v100, 3, v75 dst_sel:DWORD dst_unused:UNUSED_PAD src0_sel:DWORD src1_sel:WORD_0
    v_lshlrev_b32_sdwa v102, 3, v75 dst_sel:DWORD dst_unused:UNUSED_PAD src0_sel:DWORD src1_sel:WORD_1
    ds_read_b64 v[100:101], v100
    ds_read_b64 v[102:103], v102
    s_waitcnt lgkmcnt(8)
    v_add3_u32 v46, v46, v104, v106
    v_add3_u32 v47, v47, v105, v107
    v_add3_u32 v46, v46, v108, v110
    v_add3_u32 v47, v47, v109, v111
    s_waitcnt vmcnt(8)
    v_lshlrev_b32_sdwa v104, 3, v76 dst_sel:DWORD dst_unused:UNUSED_PAD src0_sel:DWORD src1_sel:WORD_0
    v_lshlrev_b32_sdwa v106, 3, v76 dst_sel:DWORD dst_unused:UNUSED_PAD src0_sel:DWORD src1_sel:WORD_1
    ds_read_b64 v[104:105], v104
    ds_read_b64 v[106:107], v106
    v_lshlrev_b32_sdwa v108, 3, v77 dst_sel:DWORD dst_unused:UNUSED_PAD src0_sel:DWORD src1_sel:WORD_0
    v_lshlrev_b32_sdwa v110, 3, v77 dst_sel:DWORD dst_unused:UNUSED_PAD src0_sel:DWORD src1_sel:WORD_1
    ds_read_b64 v[108:109], v108
    ds_read_b64 v[110:111], v110
    s_add_u32 s20, s20, 0xfff9d000
    buffer_load_dwordx4 v[120:123], v71, s[12:15], s20 offen offset:0 sc1
    s_waitcnt lgkmcnt(8)
    v_add3_u32 v48, v48, v88, v90
    v_add3_u32 v49, v49, v89, v91
    v_add3_u32 v48, v48, v92, v94
    v_add3_u32 v49, v49, v93, v95
    v_lshlrev_b32_sdwa v88, 3, v78 dst_sel:DWORD dst_unused:UNUSED_PAD src0_sel:DWORD src1_sel:WORD_0
    v_lshlrev_b32_sdwa v90, 3, v78 dst_sel:DWORD dst_unused:UNUSED_PAD src0_sel:DWORD src1_sel:WORD_1
    ds_read_b64 v[88:89], v88
    ds_read_b64 v[90:91], v90
    v_lshlrev_b32_sdwa v92, 3, v79 dst_sel:DWORD dst_unused:UNUSED_PAD src0_sel:DWORD src1_sel:WORD_0
    v_lshlrev_b32_sdwa v94, 3, v79 dst_sel:DWORD dst_unused:UNUSED_PAD src0_sel:DWORD src1_sel:WORD_1
    ds_read_b64 v[92:93], v92
    ds_read_b64 v[94:95], v94
    s_waitcnt lgkmcnt(8)
    v_add3_u32 v48, v48, v96, v98
    v_add3_u32 v49, v49, v97, v99
    v_add3_u32 v48, v48, v100, v102
    v_add3_u32 v49, v49, v101, v103
    s_waitcnt vmcnt(7)
    v_lshlrev_b32_sdwa v96, 3, v32 dst_sel:DWORD dst_unused:UNUSED_PAD src0_sel:DWORD src1_sel:WORD_0
    v_lshlrev_b32_sdwa v98, 3, v32 dst_sel:DWORD dst_unused:UNUSED_PAD src0_sel:DWORD src1_sel:WORD_1
    ds_read_b64 v[96:97], v96
    ds_read_b64 v[98:99], v98
    v_lshlrev_b32_sdwa v100, 3, v33 dst_sel:DWORD dst_unused:UNUSED_PAD src0_sel:DWORD src1_sel:WORD_0
    v_lshlrev_b32_sdwa v102, 3, v33 dst_sel:DWORD dst_unused:UNUSED_PAD src0_sel:DWORD src1_sel:WORD_1
    ds_read_b64 v[100:101], v100
    ds_read_b64 v[102:103], v102
    buffer_load_dwordx4 v[72:75], v71, s[12:15], s20 offen offset:1024 sc1
    s_waitcnt lgkmcnt(8)
    v_add3_u32 v50, v50, v104, v106
    v_add3_u32 v51, v51, v105, v107
    v_add3_u32 v50, v50, v108, v110
    v_add3_u32 v51, v51, v109, v111
    v_lshlrev_b32_sdwa v104, 3, v34 dst_sel:DWORD dst_unused:UNUSED_PAD src0_sel:DWORD src1_sel:WORD_0
    v_lshlrev_b32_sdwa v106, 3, v34 dst_sel:DWORD dst_unused:UNUSED_PAD src0_sel:DWORD src1_sel:WORD_1
    ds_read_b64 v[104:105], v104
    ds_read_b64 v[106:107], v106
    v_lshlrev_b32_sdwa v108, 3, v35 dst_sel:DWORD dst_unused:UNUSED_PAD src0_sel:DWORD src1_sel:WORD_0
    v_lshlrev_b32_sdwa v110, 3, v35 dst_sel:DWORD dst_unused:UNUSED_PAD src0_sel:DWORD src1_sel:WORD_1
    ds_read_b64 v[108:109], v108
    ds_read_b64 v[110:111], v110
    s_waitcnt lgkmcnt(8)
    v_add3_u32 v50, v50, v88, v90
    v_add3_u32 v51, v51, v89, v91
    v_add3_u32 v50, v50, v92, v94
    v_add3_u32 v51, v51, v93, v95
    s_waitcnt vmcnt(7)
    v_lshlrev_b32_sdwa v88, 3, v124 dst_sel:DWORD dst_unused:UNUSED_PAD src0_sel:DWORD src1_sel:WORD_0
    v_lshlrev_b32_sdwa v90, 3, v124 dst_sel:DWORD dst_unused:UNUSED_PAD src0_sel:DWORD src1_sel:WORD_1
    ds_read_b64 v[88:89], v88
    ds_read_b64 v[90:91], v90
    v_lshlrev_b32_sdwa v92, 3, v125 dst_sel:DWORD dst_unused:UNUSED_PAD src0_sel:DWORD src1_sel:WORD_0
    v_lshlrev_b32_sdwa v94, 3, v125 dst_sel:DWORD dst_unused:UNUSED_PAD src0_sel:DWORD src1_sel:WORD_1
    ds_read_b64 v[92:93], v92
    ds_read_b64 v[94:95], v94
    buffer_load_dwordx4 v[76:79], v71, s[12:15], s20 offen offset:2048 sc1
    buffer_store_dwordx4 v[40:43], v71, s[12:15], s16 offen offset:2048 sc1
    s_waitcnt lgkmcnt(8)
    v_add3_u32 v52, v52, v96, v98
    v_add3_u32 v53, v53, v97, v99
    v_add3_u32 v52, v52, v100, v102
    v_add3_u32 v53, v53, v101, v103
    v_lshlrev_b32_sdwa v96, 3, v126 dst_sel:DWORD dst_unused:UNUSED_PAD src0_sel:DWORD src1_sel:WORD_0
    v_lshlrev_b32_sdwa v98, 3, v126 dst_sel:DWORD dst_unused:UNUSED_PAD src0_sel:DWORD src1_sel:WORD_1
    ds_read_b64 v[96:97], v96
    ds_read_b64 v[98:99], v98
    v_lshlrev_b32_sdwa v100, 3, v127 dst_sel:DWORD dst_unused:UNUSED_PAD src0_sel:DWORD src1_sel:WORD_0
    v_lshlrev_b32_sdwa v102, 3, v127 dst_sel:DWORD dst_unused:UNUSED_PAD src0_sel:DWORD src1_sel:WORD_1
    ds_read_b64 v[100:101], v100
    ds_read_b64 v[102:103], v102
    s_waitcnt lgkmcnt(8)
    v_add3_u32 v52, v52, v104, v106
    v_add3_u32 v53, v53, v105, v107
    v_add3_u32 v52, v52, v108, v110
    v_add3_u32 v53, v53, v109, v111
    s_waitcnt vmcnt(8)
    v_lshlrev_b32_sdwa v104, 3, v80 dst_sel:DWORD dst_unused:UNUSED_PAD src0_sel:DWORD src1_sel:WORD_0
    v_lshlrev_b32_sdwa v106, 3, v80 dst_sel:DWORD dst_unused:UNUSED_PAD src0_sel:DWORD src1_sel:WORD_1
    ds_read_b64 v[104:105], v104
    ds_read_b64 v[106:107], v106
    v_lshlrev_b32_sdwa v108, 3, v81 dst_sel:DWORD dst_unused:UNUSED_PAD src0_sel:DWORD src1_sel:WORD_0
    v_lshlrev_b32_sdwa v110, 3, v81 dst_sel:DWORD dst_unused:UNUSED_PAD src0_sel:DWORD src1_sel:WORD_1
    ds_read_b64 v[108:109], v108
    ds_read_b64 v[110:111], v110
    buffer_load_dwordx4 v[32:35], v71, s[12:15], s20 offen offset:3072 sc1
    s_waitcnt lgkmcnt(8)
    v_add3_u32 v54, v54, v88, v90
    v_add3_u32 v55, v55, v89, v91
    v_add3_u32 v54, v54, v92, v94
    v_add3_u32 v55, v55, v93, v95
    v_lshlrev_b32_sdwa v88, 3, v82 dst_sel:DWORD dst_unused:UNUSED_PAD src0_sel:DWORD src1_sel:WORD_0
    v_lshlrev_b32_sdwa v90, 3, v82 dst_sel:DWORD dst_unused:UNUSED_PAD src0_sel:DWORD src1_sel:WORD_1
    ds_read_b64 v[88:89], v88
    ds_read_b64 v[90:91], v90
    v_lshlrev_b32_sdwa v92, 3, v83 dst_sel:DWORD dst_unused:UNUSED_PAD src0_sel:DWORD src1_sel:WORD_0
    v_lshlrev_b32_sdwa v94, 3, v83 dst_sel:DWORD dst_unused:UNUSED_PAD src0_sel:DWORD src1_sel:WORD_1
    ds_read_b64 v[92:93], v92
    ds_read_b64 v[94:95], v94
    buffer_load_dwordx4 v[80:83], v71, s[12:15], s19 offen offset:0
    s_waitcnt lgkmcnt(8)
    v_add3_u32 v54, v54, v96, v98
    v_add3_u32 v55, v55, v97, v99
    v_add3_u32 v54, v54, v100, v102
    v_add3_u32 v55, v55, v101, v103
    s_waitcnt vmcnt(9)
    v_lshlrev_b32_sdwa v96, 3, v84 dst_sel:DWORD dst_unused:UNUSED_PAD src0_sel:DWORD src1_sel:WORD_0
    v_lshlrev_b32_sdwa v98, 3, v84 dst_sel:DWORD dst_unused:UNUSED_PAD src0_sel:DWORD src1_sel:WORD_1
    ds_read_b64 v[96:97], v96
    ds_read_b64 v[98:99], v98
    v_lshlrev_b32_sdwa v100, 3, v85 dst_sel:DWORD dst_unused:UNUSED_PAD src0_sel:DWORD src1_sel:WORD_0
    v_lshlrev_b32_sdwa v102, 3, v85 dst_sel:DWORD dst_unused:UNUSED_PAD src0_sel:DWORD src1_sel:WORD_1
    ds_read_b64 v[100:101], v100
    ds_read_b64 v[102:103], v102
    s_add_u32 s20, s20, 0x1000
    buffer_load_dwordx4 v[40:43], v71, s[12:15], s20 offen offset:0 sc1
    s_waitcnt lgkmcnt(8)
    v_add3_u32 v56, v56, v104, v106
    v_add3_u32 v57, v57, v105, v107
    v_add3_u32 v56, v56, v108, v110
    v_add3_u32 v57, v57, v109, v111
    v_lshlrev_b32_sdwa v104, 3, v86 dst_sel:DWORD dst_unused:UNUSED_PAD src0_sel:DWORD src1_sel:WORD_0
    v_lshlrev_b32_sdwa v106, 3, v86 dst_sel:DWORD dst_unused:UNUSED_PAD src0_sel:DWORD src1_sel:WORD_1
    ds_read_b64 v[104:105], v104
    ds_read_b64 v[106:107], v106
    v_lshlrev_b32_sdwa v108, 3, v87 dst_sel:DWORD dst_unused:UNUSED_PAD src0_sel:DWORD src1_sel:WORD_0
    v_lshlrev_b32_sdwa v110, 3, v87 dst_sel:DWORD dst_unused:UNUSED_PAD src0_sel:DWORD src1_sel:WORD_1
    ds_read_b64 v[108:109], v108
    ds_read_b64 v[110:111], v110
    buffer_load_dwordx4 v[84:87], v71, s[12:15], s19 offen offset:1024
    s_waitcnt lgkmcnt(8)
    v_add3_u32 v56, v56, v88, v90
    v_add3_u32 v57, v57, v89, v91
    v_add3_u32 v56, v56, v92, v94
    v_add3_u32 v57, v57, v93, v95
    s_waitcnt vmcnt(10)
    v_lshlrev_b32_sdwa v88, 3, v116 dst_sel:DWORD dst_unused:UNUSED_PAD src0_sel:DWORD src1_sel:WORD_0
    v_lshlrev_b32_sdwa v90, 3, v116 dst_sel:DWORD dst_unused:UNUSED_PAD src0_sel:DWORD src1_sel:WORD_1
    ds_read_b64 v[88:89], v88
    ds_read_b64 v[90:91], v90
    v_lshlrev_b32_sdwa v92, 3, v117 dst_sel:DWORD dst_unused:UNUSED_PAD src0_sel:DWORD src1_sel:WORD_0
    v_lshlrev_b32_sdwa v94, 3, v117 dst_sel:DWORD dst_unused:UNUSED_PAD src0_sel:DWORD src1_sel:WORD_1
    ds_read_b64 v[92:93], v92
    ds_read_b64 v[94:95], v94
    buffer_load_dwordx4 v[124:127], v71, s[12:15], s20 offen offset:1024 sc1
    s_waitcnt lgkmcnt(8)
    v_add3_u32 v58, v58, v96, v98
    v_add3_u32 v59, v59, v97, v99
    v_add3_u32 v58, v58, v100, v102
    v_add3_u32 v59, v59, v101, v103
    v_lshlrev_b32_sdwa v96, 3, v118 dst_sel:DWORD dst_unused:UNUSED_PAD src0_sel:DWORD src1_sel:WORD_0
    v_lshlrev_b32_sdwa v98, 3, v118 dst_sel:DWORD dst_unused:UNUSED_PAD src0_sel:DWORD src1_sel:WORD_1
    ds_read_b64 v[96:97], v96
    ds_read_b64 v[98:99], v98
    v_lshlrev_b32_sdwa v100, 3, v119 dst_sel:DWORD dst_unused:UNUSED_PAD src0_sel:DWORD src1_sel:WORD_0
    v_lshlrev_b32_sdwa v102, 3, v119 dst_sel:DWORD dst_unused:UNUSED_PAD src0_sel:DWORD src1_sel:WORD_1
    ds_read_b64 v[100:101], v100
    ds_read_b64 v[102:103], v102
    s_waitcnt lgkmcnt(8)
    v_add3_u32 v58, v58, v104, v106
    v_add3_u32 v59, v59, v105, v107
    v_add3_u32 v58, v58, v108, v110
    v_add3_u32 v59, v59, v109, v111
    s_waitcnt vmcnt(9)
    v_lshlrev_b32_sdwa v104, 3, v36 dst_sel:DWORD dst_unused:UNUSED_PAD src0_sel:DWORD src1_sel:WORD_0
    v_lshlrev_b32_sdwa v106, 3, v36 dst_sel:DWORD dst_unused:UNUSED_PAD src0_sel:DWORD src1_sel:WORD_1
    ds_read_b64 v[104:105], v104
    ds_read_b64 v[106:107], v106
    v_lshlrev_b32_sdwa v108, 3, v37 dst_sel:DWORD dst_unused:UNUSED_PAD src0_sel:DWORD src1_sel:WORD_0
    v_lshlrev_b32_sdwa v110, 3, v37 dst_sel:DWORD dst_unused:UNUSED_PAD src0_sel:DWORD src1_sel:WORD_1
    ds_read_b64 v[108:109], v108
    ds_read_b64 v[110:111], v110
    buffer_load_dwordx4 v[116:119], v71, s[12:15], s20 offen offset:2048 sc1
    buffer_store_dwordx4 v[44:47], v71, s[12:15], s16 offen offset:3072 sc1
    s_waitcnt lgkmcnt(8)
    v_add3_u32 v60, v60, v88, v90
    v_add3_u32 v61, v61, v89, v91
    v_add3_u32 v60, v60, v92, v94
    v_add3_u32 v61, v61, v93, v95
    v_lshlrev_b32_sdwa v88, 3, v38 dst_sel:DWORD dst_unused:UNUSED_PAD src0_sel:DWORD src1_sel:WORD_0
    v_lshlrev_b32_sdwa v90, 3, v38 dst_sel:DWORD dst_unused:UNUSED_PAD src0_sel:DWORD src1_sel:WORD_1
    ds_read_b64 v[88:89], v88
    ds_read_b64 v[90:91], v90
    v_lshlrev_b32_sdwa v92, 3, v39 dst_sel:DWORD dst_unused:UNUSED_PAD src0_sel:DWORD src1_sel:WORD_0
    v_lshlrev_b32_sdwa v94, 3, v39 dst_sel:DWORD dst_unused:UNUSED_PAD src0_sel:DWORD src1_sel:WORD_1
    ds_read_b64 v[92:93], v92
    ds_read_b64 v[94:95], v94
    s_waitcnt lgkmcnt(8)
    v_add3_u32 v60, v60, v96, v98
    v_add3_u32 v61, v61, v97, v99
    v_add3_u32 v60, v60, v100, v102
    v_add3_u32 v61, v61, v101, v103
    s_waitcnt vmcnt(10)
    v_lshlrev_b32_sdwa v96, 3, v120 dst_sel:DWORD dst_unused:UNUSED_PAD src0_sel:DWORD src1_sel:WORD_0
    v_lshlrev_b32_sdwa v98, 3, v120 dst_sel:DWORD dst_unused:UNUSED_PAD src0_sel:DWORD src1_sel:WORD_1
    ds_read_b64 v[96:97], v96
    ds_read_b64 v[98:99], v98
    v_lshlrev_b32_sdwa v100, 3, v121 dst_sel:DWORD dst_unused:UNUSED_PAD src0_sel:DWORD src1_sel:WORD_0
    v_lshlrev_b32_sdwa v102, 3, v121 dst_sel:DWORD dst_unused:UNUSED_PAD src0_sel:DWORD src1_sel:WORD_1
    ds_read_b64 v[100:101], v100
    ds_read_b64 v[102:103], v102
    buffer_load_dwordx4 v[44:47], v71, s[12:15], s20 offen offset:3072 sc1
    s_waitcnt lgkmcnt(8)
    v_add3_u32 v62, v62, v104, v106
    v_add3_u32 v63, v63, v105, v107
    v_add3_u32 v62, v62, v108, v110
    v_add3_u32 v63, v63, v109, v111
    v_lshlrev_b32_sdwa v104, 3, v122 dst_sel:DWORD dst_unused:UNUSED_PAD src0_sel:DWORD src1_sel:WORD_0
    v_lshlrev_b32_sdwa v106, 3, v122 dst_sel:DWORD dst_unused:UNUSED_PAD src0_sel:DWORD src1_sel:WORD_1
    ds_read_b64 v[104:105], v104
    ds_read_b64 v[106:107], v106
    v_lshlrev_b32_sdwa v108, 3, v123 dst_sel:DWORD dst_unused:UNUSED_PAD src0_sel:DWORD src1_sel:WORD_0
    v_lshlrev_b32_sdwa v110, 3, v123 dst_sel:DWORD dst_unused:UNUSED_PAD src0_sel:DWORD src1_sel:WORD_1
    ds_read_b64 v[108:109], v108
    ds_read_b64 v[110:111], v110
    s_waitcnt lgkmcnt(8)
    v_add3_u32 v62, v62, v88, v90
    v_add3_u32 v63, v63, v89, v91
    v_add3_u32 v62, v62, v92, v94
    v_add3_u32 v63, v63, v93, v95
    s_waitcnt vmcnt(10)
    v_lshlrev_b32_sdwa v88, 3, v72 dst_sel:DWORD dst_unused:UNUSED_PAD src0_sel:DWORD src1_sel:WORD_0
    v_lshlrev_b32_sdwa v90, 3, v72 dst_sel:DWORD dst_unused:UNUSED_PAD src0_sel:DWORD src1_sel:WORD_1
    ds_read_b64 v[88:89], v88
    ds_read_b64 v[90:91], v90
    v_lshlrev_b32_sdwa v92, 3, v73 dst_sel:DWORD dst_unused:UNUSED_PAD src0_sel:DWORD src1_sel:WORD_0
    v_lshlrev_b32_sdwa v94, 3, v73 dst_sel:DWORD dst_unused:UNUSED_PAD src0_sel:DWORD src1_sel:WORD_1
    ds_read_b64 v[92:93], v92
    ds_read_b64 v[94:95], v94
    s_add_u32 s20, s20, 0x1000
    buffer_load_dwordx4 v[36:39], v71, s[12:15], s20 offen offset:0 sc1
    s_waitcnt lgkmcnt(8)
    v_add3_u32 v0, v0, v96, v98
    v_add3_u32 v1, v1, v97, v99
    v_add3_u32 v0, v0, v100, v102
    v_add3_u32 v1, v1, v101, v103
    v_lshlrev_b32_sdwa v96, 3, v74 dst_sel:DWORD dst_unused:UNUSED_PAD src0_sel:DWORD src1_sel:WORD_0
    v_lshlrev_b32_sdwa v98, 3, v74 dst_sel:DWORD dst_unused:UNUSED_PAD src0_sel:DWORD src1_sel:WORD_1
    ds_read_b64 v[96:97], v96
    ds_read_b64 v[98:99], v98
    v_lshlrev_b32_sdwa v100, 3, v75 dst_sel:DWORD dst_unused:UNUSED_PAD src0_sel:DWORD src1_sel:WORD_0
    v_lshlrev_b32_sdwa v102, 3, v75 dst_sel:DWORD dst_unused:UNUSED_PAD src0_sel:DWORD src1_sel:WORD_1
    ds_read_b64 v[100:101], v100
    ds_read_b64 v[102:103], v102
    buffer_load_dwordx4 v[72:75], v71, s[12:15], s21 offen offset:0
    s_waitcnt lgkmcnt(8)
    v_add3_u32 v0, v0, v104, v106
    v_add3_u32 v1, v1, v105, v107
    v_add3_u32 v0, v0, v108, v110
    v_add3_u32 v1, v1, v109, v111
    s_waitcnt vmcnt(11)
    v_lshlrev_b32_sdwa v104, 3, v76 dst_sel:DWORD dst_unused:UNUSED_PAD src0_sel:DWORD src1_sel:WORD_0
    v_lshlrev_b32_sdwa v106, 3, v76 dst_sel:DWORD dst_unused:UNUSED_PAD src0_sel:DWORD src1_sel:WORD_1
    ds_read_b64 v[104:105], v104
    ds_read_b64 v[106:107], v106
    v_lshlrev_b32_sdwa v108, 3, v77 dst_sel:DWORD dst_unused:UNUSED_PAD src0_sel:DWORD src1_sel:WORD_0
    v_lshlrev_b32_sdwa v110, 3, v77 dst_sel:DWORD dst_unused:UNUSED_PAD src0_sel:DWORD src1_sel:WORD_1
    ds_read_b64 v[108:109], v108
    ds_read_b64 v[110:111], v110
    buffer_load_dwordx4 v[120:123], v71, s[12:15], s20 offen offset:1024 sc1
    s_waitcnt lgkmcnt(8)
    v_add3_u32 v2, v2, v88, v90
    v_add3_u32 v3, v3, v89, v91
    v_add3_u32 v2, v2, v92, v94
    v_add3_u32 v3, v3, v93, v95
    v_lshlrev_b32_sdwa v88, 3, v78 dst_sel:DWORD dst_unused:UNUSED_PAD src0_sel:DWORD src1_sel:WORD_0
    v_lshlrev_b32_sdwa v90, 3, v78 dst_sel:DWORD dst_unused:UNUSED_PAD src0_sel:DWORD src1_sel:WORD_1
    ds_read_b64 v[88:89], v88
    ds_read_b64 v[90:91], v90
    v_lshlrev_b32_sdwa v92, 3, v79 dst_sel:DWORD dst_unused:UNUSED_PAD src0_sel:DWORD src1_sel:WORD_0
    v_lshlrev_b32_sdwa v94, 3, v79 dst_sel:DWORD dst_unused:UNUSED_PAD src0_sel:DWORD src1_sel:WORD_1
    ds_read_b64 v[92:93], v92
    ds_read_b64 v[94:95], v94
    buffer_load_dwordx4 v[76:79], v71, s[12:15], s21 offen offset:1024
    s_waitcnt lgkmcnt(8)
    v_add3_u32 v2, v2, v96, v98
    v_add3_u32 v3, v3, v97, v99
    v_add3_u32 v2, v2, v100, v102
    v_add3_u32 v3, v3, v101, v103
    s_waitcnt vmcnt(11)
    v_lshlrev_b32_sdwa v96, 3, v32 dst_sel:DWORD dst_unused:UNUSED_PAD src0_sel:DWORD src1_sel:WORD_0
    v_lshlrev_b32_sdwa v98, 3, v32 dst_sel:DWORD dst_unused:UNUSED_PAD src0_sel:DWORD src1_sel:WORD_1
    ds_read_b64 v[96:97], v96
    ds_read_b64 v[98:99], v98
    v_lshlrev_b32_sdwa v100, 3, v33 dst_sel:DWORD dst_unused:UNUSED_PAD src0_sel:DWORD src1_sel:WORD_0
    v_lshlrev_b32_sdwa v102, 3, v33 dst_sel:DWORD dst_unused:UNUSED_PAD src0_sel:DWORD src1_sel:WORD_1
    ds_read_b64 v[100:101], v100
    ds_read_b64 v[102:103], v102
    buffer_store_dwordx4 v[48:51], v71, s[12:15], s17 offen offset:0 sc1
    s_waitcnt lgkmcnt(8)
    v_add3_u32 v4, v4, v104, v106
    v_add3_u32 v5, v5, v105, v107
    v_add3_u32 v4, v4, v108, v110
    v_add3_u32 v5, v5, v109, v111
    v_lshlrev_b32_sdwa v104, 3, v34 dst_sel:DWORD dst_unused:UNUSED_PAD src0_sel:DWORD src1_sel:WORD_0
    v_lshlrev_b32_sdwa v106, 3, v34 dst_sel:DWORD dst_unused:UNUSED_PAD src0_sel:DWORD src1_sel:WORD_1
    ds_read_b64 v[104:105], v104
    ds_read_b64 v[106:107], v106
    v_mov_b32 v48, 0xc7800000
    v_mov_b32 v50, s27
    v_lshlrev_b32_sdwa v108, 3, v35 dst_sel:DWORD dst_unused:UNUSED_PAD src0_sel:DWORD src1_sel:WORD_0
    v_lshlrev_b32_sdwa v110, 3, v35 dst_sel:DWORD dst_unused:UNUSED_PAD src0_sel:DWORD src1_sel:WORD_1
    ds_read_b64 v[108:109], v108
    ds_read_b64 v[110:111], v110
    buffer_load_dwordx4 v[32:35], v71, s[12:15], s20 offen offset:2048 sc1
    s_waitcnt lgkmcnt(8)
    v_add3_u32 v4, v4, v88, v90
    v_add3_u32 v5, v5, v89, v91
    v_add3_u32 v4, v4, v92, v94
    v_add3_u32 v5, v5, v93, v95
    s_waitcnt vmcnt(11)
    v_lshlrev_b32_sdwa v88, 3, v40 dst_sel:DWORD dst_unused:UNUSED_PAD src0_sel:DWORD src1_sel:WORD_0
    v_lshlrev_b32_sdwa v90, 3, v40 dst_sel:DWORD dst_unused:UNUSED_PAD src0_sel:DWORD src1_sel:WORD_1
    ds_read_b64 v[88:89], v88
    ds_read_b64 v[90:91], v90
    v_mov_b32 v51, s27
    v_mov_b32 v49, 0xff7fffff
    v_lshlrev_b32_sdwa v92, 3, v41 dst_sel:DWORD dst_unused:UNUSED_PAD src0_sel:DWORD src1_sel:WORD_0
    v_lshlrev_b32_sdwa v94, 3, v41 dst_sel:DWORD dst_unused:UNUSED_PAD src0_sel:DWORD src1_sel:WORD_1
    ds_read_b64 v[92:93], v92
    ds_read_b64 v[94:95], v94
    s_waitcnt lgkmcnt(8)
    v_add3_u32 v6, v6, v96, v98
    v_add3_u32 v7, v7, v97, v99
    v_add3_u32 v6, v6, v100, v102
    v_add3_u32 v7, v7, v101, v103
    v_lshlrev_b32_sdwa v96, 3, v42 dst_sel:DWORD dst_unused:UNUSED_PAD src0_sel:DWORD src1_sel:WORD_0
    v_lshlrev_b32_sdwa v98, 3, v42 dst_sel:DWORD dst_unused:UNUSED_PAD src0_sel:DWORD src1_sel:WORD_1
    ds_read_b64 v[96:97], v96
    ds_read_b64 v[98:99], v98
    v_lshlrev_b32_sdwa v100, 3, v43 dst_sel:DWORD dst_unused:UNUSED_PAD src0_sel:DWORD src1_sel:WORD_0
    v_lshlrev_b32_sdwa v102, 3, v43 dst_sel:DWORD dst_unused:UNUSED_PAD src0_sel:DWORD src1_sel:WORD_1
    ds_read_b64 v[100:101], v100
    ds_read_b64 v[102:103], v102
    buffer_load_dwordx4 v[40:43], v71, s[12:15], s20 offen offset:3072 sc1
    s_waitcnt lgkmcnt(8)
    v_add3_u32 v6, v6, v104, v106
    v_add3_u32 v7, v7, v105, v107
    v_add3_u32 v6, v6, v108, v110
    v_add3_u32 v7, v7, v109, v111
    s_waitcnt vmcnt(10)
    v_lshlrev_b32_sdwa v104, 3, v124 dst_sel:DWORD dst_unused:UNUSED_PAD src0_sel:DWORD src1_sel:WORD_0
    v_lshlrev_b32_sdwa v106, 3, v124 dst_sel:DWORD dst_unused:UNUSED_PAD src0_sel:DWORD src1_sel:WORD_1
    ds_read_b64 v[104:105], v104
    ds_read_b64 v[106:107], v106
    v_lshlrev_b32_sdwa v108, 3, v125 dst_sel:DWORD dst_unused:UNUSED_PAD src0_sel:DWORD src1_sel:WORD_0
    v_lshlrev_b32_sdwa v110, 3, v125 dst_sel:DWORD dst_unused:UNUSED_PAD src0_sel:DWORD src1_sel:WORD_1
    ds_read_b64 v[108:109], v108
    ds_read_b64 v[110:111], v110
    s_waitcnt lgkmcnt(8)
    v_add3_u32 v8, v8, v88, v90
    v_add3_u32 v9, v9, v89, v91
    v_add3_u32 v8, v8, v92, v94
    v_add3_u32 v9, v9, v93, v95
    v_lshlrev_b32_sdwa v88, 3, v126 dst_sel:DWORD dst_unused:UNUSED_PAD src0_sel:DWORD src1_sel:WORD_0
    v_lshlrev_b32_sdwa v90, 3, v126 dst_sel:DWORD dst_unused:UNUSED_PAD src0_sel:DWORD src1_sel:WORD_1
    ds_read_b64 v[88:89], v88
    ds_read_b64 v[90:91], v90
    v_lshlrev_b32_sdwa v92, 3, v127 dst_sel:DWORD dst_unused:UNUSED_PAD src0_sel:DWORD src1_sel:WORD_0
    v_lshlrev_b32_sdwa v94, 3, v127 dst_sel:DWORD dst_unused:UNUSED_PAD src0_sel:DWORD src1_sel:WORD_1
    ds_read_b64 v[92:93], v92
    ds_read_b64 v[94:95], v94
    s_add_u32 s20, s20, 0x1000
    buffer_load_dwordx4 v[124:127], v71, s[12:15], s20 offen offset:0 sc1
    s_waitcnt lgkmcnt(8)
    v_add3_u32 v8, v8, v96, v98
    v_add3_u32 v9, v9, v97, v99
    v_add3_u32 v8, v8, v100, v102
    v_add3_u32 v9, v9, v101, v103
    s_waitcnt vmcnt(10)
    v_lshlrev_b32_sdwa v96, 3, v116 dst_sel:DWORD dst_unused:UNUSED_PAD src0_sel:DWORD src1_sel:WORD_0
    v_lshlrev_b32_sdwa v98, 3, v116 dst_sel:DWORD dst_unused:UNUSED_PAD src0_sel:DWORD src1_sel:WORD_1
    ds_read_b64 v[96:97], v96
    ds_read_b64 v[98:99], v98
    v_lshlrev_b32_sdwa v100, 3, v117 dst_sel:DWORD dst_unused:UNUSED_PAD src0_sel:DWORD src1_sel:WORD_0
    v_lshlrev_b32_sdwa v102, 3, v117 dst_sel:DWORD dst_unused:UNUSED_PAD src0_sel:DWORD src1_sel:WORD_1
    ds_read_b64 v[100:101], v100
    ds_read_b64 v[102:103], v102
    s_waitcnt lgkmcnt(8)
    v_add3_u32 v10, v10, v104, v106
    v_add3_u32 v11, v11, v105, v107
    v_add3_u32 v10, v10, v108, v110
    v_add3_u32 v11, v11, v109, v111
    v_lshlrev_b32_sdwa v104, 3, v118 dst_sel:DWORD dst_unused:UNUSED_PAD src0_sel:DWORD src1_sel:WORD_0
    v_lshlrev_b32_sdwa v106, 3, v118 dst_sel:DWORD dst_unused:UNUSED_PAD src0_sel:DWORD src1_sel:WORD_1
    ds_read_b64 v[104:105], v104
    ds_read_b64 v[106:107], v106
    v_lshlrev_b32_sdwa v108, 3, v119 dst_sel:DWORD dst_unused:UNUSED_PAD src0_sel:DWORD src1_sel:WORD_0
    v_lshlrev_b32_sdwa v110, 3, v119 dst_sel:DWORD dst_unused:UNUSED_PAD src0_sel:DWORD src1_sel:WORD_1
    ds_read_b64 v[108:109], v108
    ds_read_b64 v[110:111], v110
    buffer_load_dwordx4 v[116:119], v71, s[12:15], s20 offen offset:1024 sc1
    s_waitcnt lgkmcnt(8)
    v_add3_u32 v10, v10, v88, v90
    v_add3_u32 v11, v11, v89, v91
    v_add3_u32 v10, v10, v92, v94
    v_add3_u32 v11, v11, v93, v95
    s_waitcnt vmcnt(9)
    v_lshlrev_b32_sdwa v88, 3, v44 dst_sel:DWORD dst_unused:UNUSED_PAD src0_sel:DWORD src1_sel:WORD_0
    v_lshlrev_b32_sdwa v90, 3, v44 dst_sel:DWORD dst_unused:UNUSED_PAD src0_sel:DWORD src1_sel:WORD_1
    ds_read_b64 v[88:89], v88
    ds_read_b64 v[90:91], v90
    v_lshlrev_b32_sdwa v92, 3, v45 dst_sel:DWORD dst_unused:UNUSED_PAD src0_sel:DWORD src1_sel:WORD_0
    v_lshlrev_b32_sdwa v94, 3, v45 dst_sel:DWORD dst_unused:UNUSED_PAD src0_sel:DWORD src1_sel:WORD_1
    ds_read_b64 v[92:93], v92
    ds_read_b64 v[94:95], v94
    v_mov_b32 v64, 1
    s_mov_b64 exec, 1
    buffer_store_dword v64, off, s[12:15], s46 sc1
    s_mov_b64 exec, -1
    buffer_store_dwordx4 v[52:55], v71, s[12:15], s17 offen offset:1024 sc1
    s_waitcnt lgkmcnt(8)
    v_add3_u32 v12, v12, v96, v98
    v_add3_u32 v13, v13, v97, v99
    v_add3_u32 v12, v12, v100, v102
    v_add3_u32 v13, v13, v101, v103
    v_lshlrev_b32_sdwa v96, 3, v46 dst_sel:DWORD dst_unused:UNUSED_PAD src0_sel:DWORD src1_sel:WORD_0
    v_lshlrev_b32_sdwa v98, 3, v46 dst_sel:DWORD dst_unused:UNUSED_PAD src0_sel:DWORD src1_sel:WORD_1
    ds_read_b64 v[96:97], v96
    ds_read_b64 v[98:99], v98
    v_lshlrev_b32 v52, 16, s36
    v_mov_b32_sdwa v53, s36 dst_sel:WORD_1 dst_unused:UNUSED_PAD src0_sel:WORD_1
    v_lshlrev_b32_sdwa v100, 3, v47 dst_sel:DWORD dst_unused:UNUSED_PAD src0_sel:DWORD src1_sel:WORD_0
    v_lshlrev_b32_sdwa v102, 3, v47 dst_sel:DWORD dst_unused:UNUSED_PAD src0_sel:DWORD src1_sel:WORD_1
    ds_read_b64 v[100:101], v100
    ds_read_b64 v[102:103], v102
    buffer_load_dwordx4 v[44:47], v71, s[12:15], s20 offen offset:2048 sc1
    s_waitcnt lgkmcnt(8)
    v_add3_u32 v12, v12, v104, v106
    v_add3_u32 v13, v13, v105, v107
    v_add3_u32 v12, v12, v108, v110
    v_add3_u32 v13, v13, v109, v111
    s_waitcnt vmcnt(11)
    v_lshlrev_b32_sdwa v104, 3, v36 dst_sel:DWORD dst_unused:UNUSED_PAD src0_sel:DWORD src1_sel:WORD_0
    v_lshlrev_b32_sdwa v106, 3, v36 dst_sel:DWORD dst_unused:UNUSED_PAD src0_sel:DWORD src1_sel:WORD_1
    ds_read_b64 v[104:105], v104
    ds_read_b64 v[106:107], v106
    v_lshlrev_b32 v54, 16, s37
    v_mov_b32_sdwa v55, s37 dst_sel:WORD_1 dst_unused:UNUSED_PAD src0_sel:WORD_1
    v_lshlrev_b32_sdwa v108, 3, v37 dst_sel:DWORD dst_unused:UNUSED_PAD src0_sel:DWORD src1_sel:WORD_0
    v_lshlrev_b32_sdwa v110, 3, v37 dst_sel:DWORD dst_unused:UNUSED_PAD src0_sel:DWORD src1_sel:WORD_1
    ds_read_b64 v[108:109], v108
    ds_read_b64 v[110:111], v110
    s_waitcnt lgkmcnt(8)
    v_add3_u32 v14, v14, v88, v90
    v_add3_u32 v15, v15, v89, v91
    v_add3_u32 v14, v14, v92, v94
    v_add3_u32 v15, v15, v93, v95
    s_setprio 2
    v_lshlrev_b32_sdwa v88, 3, v38 dst_sel:DWORD dst_unused:UNUSED_PAD src0_sel:DWORD src1_sel:WORD_0
    v_lshlrev_b32_sdwa v90, 3, v38 dst_sel:DWORD dst_unused:UNUSED_PAD src0_sel:DWORD src1_sel:WORD_1
    ds_read_b64 v[88:89], v88
    ds_read_b64 v[90:91], v90
    v_fmac_f32 v52, s26, v48
    v_fmac_f32 v53, s26, v48
    v_lshlrev_b32_sdwa v92, 3, v39 dst_sel:DWORD dst_unused:UNUSED_PAD src0_sel:DWORD src1_sel:WORD_0
    v_lshlrev_b32_sdwa v94, 3, v39 dst_sel:DWORD dst_unused:UNUSED_PAD src0_sel:DWORD src1_sel:WORD_1
    ds_read_b64 v[92:93], v92
    ds_read_b64 v[94:95], v94
    buffer_load_dwordx4 v[36:39], v71, s[12:15], s20 offen offset:3072 sc1
    s_waitcnt lgkmcnt(8)
    v_add3_u32 v14, v14, v96, v98
    v_add3_u32 v15, v15, v97, v99
    v_add3_u32 v14, v14, v100, v102
    v_add3_u32 v15, v15, v101, v103
    s_waitcnt vmcnt(10)
    v_lshlrev_b32_sdwa v96, 3, v120 dst_sel:DWORD dst_unused:UNUSED_PAD src0_sel:DWORD src1_sel:WORD_0
    v_lshlrev_b32_sdwa v98, 3, v120 dst_sel:DWORD dst_unused:UNUSED_PAD src0_sel:DWORD src1_sel:WORD_1
    ds_read_b64 v[96:97], v96
    ds_read_b64 v[98:99], v98
    v_fmac_f32 v54, s26, v48
    v_fmac_f32 v55, s26, v48
    v_lshlrev_b32_sdwa v100, 3, v121 dst_sel:DWORD dst_unused:UNUSED_PAD src0_sel:DWORD src1_sel:WORD_0
    v_lshlrev_b32_sdwa v102, 3, v121 dst_sel:DWORD dst_unused:UNUSED_PAD src0_sel:DWORD src1_sel:WORD_1
    ds_read_b64 v[100:101], v100
    ds_read_b64 v[102:103], v102
    s_waitcnt lgkmcnt(8)
    v_add3_u32 v16, v16, v104, v106
    v_add3_u32 v17, v17, v105, v107
    v_add3_u32 v16, v16, v108, v110
    v_add3_u32 v17, v17, v109, v111
    v_lshlrev_b32_sdwa v104, 3, v122 dst_sel:DWORD dst_unused:UNUSED_PAD src0_sel:DWORD src1_sel:WORD_0
    v_lshlrev_b32_sdwa v106, 3, v122 dst_sel:DWORD dst_unused:UNUSED_PAD src0_sel:DWORD src1_sel:WORD_1
    ds_read_b64 v[104:105], v104
    ds_read_b64 v[106:107], v106
    v_ldexp_f32 v52, v52, s49
    v_ldexp_f32 v53, v53, s49
    v_lshlrev_b32_sdwa v108, 3, v123 dst_sel:DWORD dst_unused:UNUSED_PAD src0_sel:DWORD src1_sel:WORD_0
    v_lshlrev_b32_sdwa v110, 3, v123 dst_sel:DWORD dst_unused:UNUSED_PAD src0_sel:DWORD src1_sel:WORD_1
    ds_read_b64 v[108:109], v108
    ds_read_b64 v[110:111], v110
    s_add_u32 s20, s20, 0x3d000
    buffer_load_dwordx4 v[120:123], v71, s[12:15], s20 offen offset:0 sc1
    s_waitcnt lgkmcnt(8)
    v_add3_u32 v16, v16, v88, v90
    v_add3_u32 v17, v17, v89, v91
    v_add3_u32 v16, v16, v92, v94
    v_add3_u32 v17, v17, v93, v95
    s_waitcnt vmcnt(8)
    v_lshlrev_b32_sdwa v88, 3, v32 dst_sel:DWORD dst_unused:UNUSED_PAD src0_sel:DWORD src1_sel:WORD_0
    v_lshlrev_b32_sdwa v90, 3, v32 dst_sel:DWORD dst_unused:UNUSED_PAD src0_sel:DWORD src1_sel:WORD_1
    ds_read_b64 v[88:89], v88
    ds_read_b64 v[90:91], v90
    v_ldexp_f32 v54, v54, s49
    v_ldexp_f32 v55, v55, s49
    v_lshlrev_b32_sdwa v92, 3, v33 dst_sel:DWORD dst_unused:UNUSED_PAD src0_sel:DWORD src1_sel:WORD_0
    v_lshlrev_b32_sdwa v94, 3, v33 dst_sel:DWORD dst_unused:UNUSED_PAD src0_sel:DWORD src1_sel:WORD_1
    ds_read_b64 v[92:93], v92
    ds_read_b64 v[94:95], v94
    s_waitcnt lgkmcnt(8)
    v_add3_u32 v18, v18, v96, v98
    v_add3_u32 v19, v19, v97, v99
    v_add3_u32 v18, v18, v100, v102
    v_add3_u32 v19, v19, v101, v103
    v_lshlrev_b32_sdwa v96, 3, v34 dst_sel:DWORD dst_unused:UNUSED_PAD src0_sel:DWORD src1_sel:WORD_0
    v_lshlrev_b32_sdwa v98, 3, v34 dst_sel:DWORD dst_unused:UNUSED_PAD src0_sel:DWORD src1_sel:WORD_1
    ds_read_b64 v[96:97], v96
    ds_read_b64 v[98:99], v98
    v_lshlrev_b32_sdwa v100, 3, v35 dst_sel:DWORD dst_unused:UNUSED_PAD src0_sel:DWORD src1_sel:WORD_0
    v_lshlrev_b32_sdwa v102, 3, v35 dst_sel:DWORD dst_unused:UNUSED_PAD src0_sel:DWORD src1_sel:WORD_1
    ds_read_b64 v[100:101], v100
    ds_read_b64 v[102:103], v102
    buffer_load_dwordx4 v[32:35], v71, s[12:15], s20 offen offset:2048 sc1
    s_waitcnt lgkmcnt(8)
    v_add3_u32 v18, v18, v104, v106
    v_add3_u32 v19, v19, v105, v107
    v_add3_u32 v18, v18, v108, v110
    v_add3_u32 v19, v19, v109, v111
    s_waitcnt vmcnt(8)
    v_lshlrev_b32_sdwa v104, 3, v40 dst_sel:DWORD dst_unused:UNUSED_PAD src0_sel:DWORD src1_sel:WORD_0
    v_lshlrev_b32_sdwa v106, 3, v40 dst_sel:DWORD dst_unused:UNUSED_PAD src0_sel:DWORD src1_sel:WORD_1
    ds_read_b64 v[104:105], v104
    ds_read_b64 v[106:107], v106
    v_lshlrev_b32_sdwa v108, 3, v41 dst_sel:DWORD dst_unused:UNUSED_PAD src0_sel:DWORD src1_sel:WORD_0
    v_lshlrev_b32_sdwa v110, 3, v41 dst_sel:DWORD dst_unused:UNUSED_PAD src0_sel:DWORD src1_sel:WORD_1
    ds_read_b64 v[108:109], v108
    ds_read_b64 v[110:111], v110
    buffer_store_dwordx4 v[56:59], v71, s[12:15], s17 offen offset:2048 sc1
    s_waitcnt lgkmcnt(8)
    v_add3_u32 v20, v20, v88, v90
    v_add3_u32 v21, v21, v89, v91
    v_add3_u32 v20, v20, v92, v94
    v_add3_u32 v21, v21, v93, v95
    v_lshlrev_b32_sdwa v88, 3, v42 dst_sel:DWORD dst_unused:UNUSED_PAD src0_sel:DWORD src1_sel:WORD_0
    v_lshlrev_b32_sdwa v90, 3, v42 dst_sel:DWORD dst_unused:UNUSED_PAD src0_sel:DWORD src1_sel:WORD_1
    ds_read_b64 v[88:89], v88
    ds_read_b64 v[90:91], v90
    v_rcp_f32 v56, s28
    v_rcp_f32 v57, s29
    v_lshlrev_b32_sdwa v92, 3, v43 dst_sel:DWORD dst_unused:UNUSED_PAD src0_sel:DWORD src1_sel:WORD_0
    v_lshlrev_b32_sdwa v94, 3, v43 dst_sel:DWORD dst_unused:UNUSED_PAD src0_sel:DWORD src1_sel:WORD_1
    ds_read_b64 v[92:93], v92
    ds_read_b64 v[94:95], v94
    s_add_u32 s20, s20, 0x1000
    buffer_load_dwordx4 v[40:43], v71, s[12:15], s20 offen offset:0 sc1
    s_waitcnt lgkmcnt(8)
    v_add3_u32 v20, v20, v96, v98
    v_add3_u32 v21, v21, v97, v99
    v_add3_u32 v20, v20, v100, v102
    v_add3_u32 v21, v21, v101, v103
    s_waitcnt vmcnt(9)
    v_lshlrev_b32_sdwa v96, 3, v124 dst_sel:DWORD dst_unused:UNUSED_PAD src0_sel:DWORD src1_sel:WORD_0
    v_lshlrev_b32_sdwa v98, 3, v124 dst_sel:DWORD dst_unused:UNUSED_PAD src0_sel:DWORD src1_sel:WORD_1
    ds_read_b64 v[96:97], v96
    ds_read_b64 v[98:99], v98
    v_rcp_f32 v58, s30
    v_rcp_f32 v59, s31
    v_lshlrev_b32_sdwa v100, 3, v125 dst_sel:DWORD dst_unused:UNUSED_PAD src0_sel:DWORD src1_sel:WORD_0
    v_lshlrev_b32_sdwa v102, 3, v125 dst_sel:DWORD dst_unused:UNUSED_PAD src0_sel:DWORD src1_sel:WORD_1
    ds_read_b64 v[100:101], v100
    ds_read_b64 v[102:103], v102
    s_waitcnt lgkmcnt(8)
    v_add3_u32 v22, v22, v104, v106
    v_add3_u32 v23, v23, v105, v107
    v_add3_u32 v22, v22, v108, v110
    v_add3_u32 v23, v23, v109, v111
    s_setprio 1
    v_lshlrev_b32_sdwa v104, 3, v126 dst_sel:DWORD dst_unused:UNUSED_PAD src0_sel:DWORD src1_sel:WORD_0
    v_lshlrev_b32_sdwa v106, 3, v126 dst_sel:DWORD dst_unused:UNUSED_PAD src0_sel:DWORD src1_sel:WORD_1
    ds_read_b64 v[104:105], v104
    ds_read_b64 v[106:107], v106
    v_ldexp_f32 v56, v56, s49
    v_ldexp_f32 v57, v57, s49
    v_lshlrev_b32_sdwa v108, 3, v127 dst_sel:DWORD dst_unused:UNUSED_PAD src0_sel:DWORD src1_sel:WORD_0
    v_lshlrev_b32_sdwa v110, 3, v127 dst_sel:DWORD dst_unused:UNUSED_PAD src0_sel:DWORD src1_sel:WORD_1
    ds_read_b64 v[108:109], v108
    ds_read_b64 v[110:111], v110
    buffer_load_dwordx4 v[124:127], v71, s[12:15], s20 offen offset:2048 sc1
    s_waitcnt lgkmcnt(8)
    v_add3_u32 v22, v22, v88, v90
    v_add3_u32 v23, v23, v89, v91
    v_add3_u32 v22, v22, v92, v94
    v_add3_u32 v23, v23, v93, v95
    s_waitcnt vmcnt(9)
    v_lshlrev_b32_sdwa v88, 3, v116 dst_sel:DWORD dst_unused:UNUSED_PAD src0_sel:DWORD src1_sel:WORD_0
    v_lshlrev_b32_sdwa v90, 3, v116 dst_sel:DWORD dst_unused:UNUSED_PAD src0_sel:DWORD src1_sel:WORD_1
    ds_read_b64 v[88:89], v88
    ds_read_b64 v[90:91], v90
    v_ldexp_f32 v58, v58, s49
    v_ldexp_f32 v59, v59, s49
    v_lshlrev_b32_sdwa v92, 3, v117 dst_sel:DWORD dst_unused:UNUSED_PAD src0_sel:DWORD src1_sel:WORD_0
    v_lshlrev_b32_sdwa v94, 3, v117 dst_sel:DWORD dst_unused:UNUSED_PAD src0_sel:DWORD src1_sel:WORD_1
    ds_read_b64 v[92:93], v92
    ds_read_b64 v[94:95], v94
    s_waitcnt lgkmcnt(8)
    v_add3_u32 v24, v24, v96, v98
    v_add3_u32 v25, v25, v97, v99
    v_add3_u32 v24, v24, v100, v102
    v_add3_u32 v25, v25, v101, v103
    v_lshlrev_b32_sdwa v96, 3, v118 dst_sel:DWORD dst_unused:UNUSED_PAD src0_sel:DWORD src1_sel:WORD_0
    v_lshlrev_b32_sdwa v98, 3, v118 dst_sel:DWORD dst_unused:UNUSED_PAD src0_sel:DWORD src1_sel:WORD_1
    ds_read_b64 v[96:97], v96
    ds_read_b64 v[98:99], v98
    v_med3_f32 v56, v56, -v49, v49
    v_med3_f32 v57, v57, -v49, v49
    v_lshlrev_b32_sdwa v100, 3, v119 dst_sel:DWORD dst_unused:UNUSED_PAD src0_sel:DWORD src1_sel:WORD_0
    v_lshlrev_b32_sdwa v102, 3, v119 dst_sel:DWORD dst_unused:UNUSED_PAD src0_sel:DWORD src1_sel:WORD_1
    ds_read_b64 v[100:101], v100
    ds_read_b64 v[102:103], v102
    s_add_u32 s20, s20, 0x1000
    buffer_load_dwordx4 v[116:119], v71, s[12:15], s20 offen offset:0 sc1
    s_waitcnt lgkmcnt(8)
    v_add3_u32 v24, v24, v104, v106
    v_add3_u32 v25, v25, v105, v107
    v_add3_u32 v24, v24, v108, v110
    v_add3_u32 v25, v25, v109, v111
    s_waitcnt vmcnt(7)
    v_lshlrev_b32_sdwa v104, 3, v44 dst_sel:DWORD dst_unused:UNUSED_PAD src0_sel:DWORD src1_sel:WORD_0
    v_lshlrev_b32_sdwa v106, 3, v44 dst_sel:DWORD dst_unused:UNUSED_PAD src0_sel:DWORD src1_sel:WORD_1
    ds_read_b64 v[104:105], v104
    ds_read_b64 v[106:107], v106
    v_med3_f32 v58, v58, -v49, v49
    v_med3_f32 v59, v59, -v49, v49
    v_lshlrev_b32_sdwa v108, 3, v45 dst_sel:DWORD dst_unused:UNUSED_PAD src0_sel:DWORD src1_sel:WORD_0
    v_lshlrev_b32_sdwa v110, 3, v45 dst_sel:DWORD dst_unused:UNUSED_PAD src0_sel:DWORD src1_sel:WORD_1
    ds_read_b64 v[108:109], v108
    ds_read_b64 v[110:111], v110
    s_mov_b64 exec, 1
    buffer_load_dword v65, off, s[12:15], s47 sc1
    s_mov_b64 exec, -1
    s_waitcnt lgkmcnt(8)
    v_add3_u32 v26, v26, v88, v90
    v_add3_u32 v27, v27, v89, v91
    v_add3_u32 v26, v26, v92, v94
    v_add3_u32 v27, v27, v93, v95
    v_lshlrev_b32_sdwa v88, 3, v46 dst_sel:DWORD dst_unused:UNUSED_PAD src0_sel:DWORD src1_sel:WORD_0
    v_lshlrev_b32_sdwa v90, 3, v46 dst_sel:DWORD dst_unused:UNUSED_PAD src0_sel:DWORD src1_sel:WORD_1
    ds_read_b64 v[88:89], v88
    ds_read_b64 v[90:91], v90
    v_lshlrev_b32_sdwa v92, 3, v47 dst_sel:DWORD dst_unused:UNUSED_PAD src0_sel:DWORD src1_sel:WORD_0
    v_lshlrev_b32_sdwa v94, 3, v47 dst_sel:DWORD dst_unused:UNUSED_PAD src0_sel:DWORD src1_sel:WORD_1
    ds_read_b64 v[92:93], v92
    ds_read_b64 v[94:95], v94
    buffer_load_dwordx4 v[44:47], v71, s[12:15], s20 offen offset:2048 sc1
    s_waitcnt lgkmcnt(8)
    v_add3_u32 v26, v26, v96, v98
    v_add3_u32 v27, v27, v97, v99
    v_add3_u32 v26, v26, v100, v102
    v_add3_u32 v27, v27, v101, v103
    s_waitcnt vmcnt(8)
    v_lshlrev_b32_sdwa v96, 3, v36 dst_sel:DWORD dst_unused:UNUSED_PAD src0_sel:DWORD src1_sel:WORD_0
    v_lshlrev_b32_sdwa v98, 3, v36 dst_sel:DWORD dst_unused:UNUSED_PAD src0_sel:DWORD src1_sel:WORD_1
    ds_read_b64 v[96:97], v96
    ds_read_b64 v[98:99], v98
    v_lshlrev_b32_sdwa v100, 3, v37 dst_sel:DWORD dst_unused:UNUSED_PAD src0_sel:DWORD src1_sel:WORD_0
    v_lshlrev_b32_sdwa v102, 3, v37 dst_sel:DWORD dst_unused:UNUSED_PAD src0_sel:DWORD src1_sel:WORD_1
    ds_read_b64 v[100:101], v100
    ds_read_b64 v[102:103], v102
    buffer_store_dwordx4 v[60:63], v71, s[12:15], s17 offen offset:3072 sc1
    s_cmp_eq_u32 s48, 1
    s_cbranch_scc1 k1_kernel_solo2
    s_waitcnt lgkmcnt(8)
    v_add3_u32 v28, v28, v104, v106
    v_add3_u32 v29, v29, v105, v107
    v_add3_u32 v28, v28, v108, v110
    v_add3_u32 v29, v29, v109, v111
    s_setprio 0
    v_lshlrev_b32_sdwa v104, 3, v38 dst_sel:DWORD dst_unused:UNUSED_PAD src0_sel:DWORD src1_sel:WORD_0
    v_lshlrev_b32_sdwa v106, 3, v38 dst_sel:DWORD dst_unused:UNUSED_PAD src0_sel:DWORD src1_sel:WORD_1
    ds_read_b64 v[104:105], v104
    ds_read_b64 v[106:107], v106
    v_mov_b32 v60, 0xbdd2d3e8
    v_mov_b32 v62, 0xc0135761
    v_lshlrev_b32_sdwa v108, 3, v39 dst_sel:DWORD dst_unused:UNUSED_PAD src0_sel:DWORD src1_sel:WORD_0
    v_lshlrev_b32_sdwa v110, 3, v39 dst_sel:DWORD dst_unused:UNUSED_PAD src0_sel:DWORD src1_sel:WORD_1
    ds_read_b64 v[108:109], v108
    ds_read_b64 v[110:111], v110
    s_add_u32 s20, s20, 0x1000
    buffer_load_dwordx4 v[36:39], v71, s[12:15], s20 offen offset:0 sc1
    s_waitcnt lgkmcnt(8)
    v_add3_u32 v28, v28, v88, v90
    v_add3_u32 v29, v29, v89, v91
    v_add3_u32 v28, v28, v92, v94
    v_add3_u32 v29, v29, v93, v95
    v_mfma_f32_16x16x32_bf16 v[112:115], v[72:75], v[128:131], v[66:69]
    s_waitcnt vmcnt(9)
    v_lshlrev_b32_sdwa v88, 3, v120 dst_sel:DWORD dst_unused:UNUSED_PAD src0_sel:DWORD src1_sel:WORD_0
    v_lshlrev_b32_sdwa v90, 3, v120 dst_sel:DWORD dst_unused:UNUSED_PAD src0_sel:DWORD src1_sel:WORD_1
    ds_read_b64 v[88:89], v88
    ds_read_b64 v[90:91], v90
    v_mfma_f32_16x16x32_bf16 v[112:115], v[76:79], v[132:135], v[112:115]
    v_add_u32 v70, 0x10000, v70
    v_ldexp_f32 v60, v60, s41
    v_ldexp_f32 v62, v62, s40
    v_lshlrev_b32_sdwa v92, 3, v121 dst_sel:DWORD dst_unused:UNUSED_PAD src0_sel:DWORD src1_sel:WORD_0
    v_lshlrev_b32_sdwa v94, 3, v121 dst_sel:DWORD dst_unused:UNUSED_PAD src0_sel:DWORD src1_sel:WORD_1
    ds_read_b64 v[92:93], v92
    ds_read_b64 v[94:95], v94
    s_waitcnt lgkmcnt(8)
    v_add3_u32 v30, v30, v96, v98
    v_add3_u32 v31, v31, v97, v99
    v_add3_u32 v30, v30, v100, v102
    v_add3_u32 v31, v31, v101, v103
    s_waitcnt lgkmcnt(4)
    s_barrier
    s_setprio 3
    v_mfma_f32_16x16x32_bf16 v[112:115], v[80:83], v[136:139], v[112:115]
    v_lshlrev_b32_sdwa v96, 3, v122 dst_sel:DWORD dst_unused:UNUSED_PAD src0_sel:DWORD src1_sel:WORD_0
    v_lshlrev_b32_sdwa v98, 3, v122 dst_sel:DWORD dst_unused:UNUSED_PAD src0_sel:DWORD src1_sel:WORD_1
    ds_read_b64 v[96:97], v96
    ds_read_b64 v[98:99], v98
    v_mfma_f32_16x16x32_bf16 v[112:115], v[84:87], v[140:143], v[112:115]
    v_max_f32 v60, v60, v49
    v_mov_b32 v63, v62
    v_lshlrev_b32_sdwa v100, 3, v123 dst_sel:DWORD dst_unused:UNUSED_PAD src0_sel:DWORD src1_sel:WORD_0
    v_lshlrev_b32_sdwa v102, 3, v123 dst_sel:DWORD dst_unused:UNUSED_PAD src0_sel:DWORD src1_sel:WORD_1
    ds_read_b64 v[100:101], v100
    ds_read_b64 v[102:103], v102
    buffer_load_dwordx4 v[120:123], v71, s[12:15], s20 offen offset:2048 sc1
    v_add3_u32 v30, v30, v104, v106
    v_add3_u32 v31, v31, v105, v107
    v_add3_u32 v30, v30, v108, v110
    v_add3_u32 v31, v31, v109, v111
    v_perm_b32 v112, v113, v112, s23
    v_perm_b32 v113, v115, v114, s23
    ds_write_b64 v70, v[112:113] offset:0
    v_mfma_f32_16x16x32_bf16 v[112:115], v[72:75], v[144:147], v[66:69]
    s_waitcnt vmcnt(9)
    v_lshlrev_b32_sdwa v104, 3, v32 dst_sel:DWORD dst_unused:UNUSED_PAD src0_sel:DWORD src1_sel:WORD_0
    v_lshlrev_b32_sdwa v106, 3, v32 dst_sel:DWORD dst_unused:UNUSED_PAD src0_sel:DWORD src1_sel:WORD_1
    ds_read_b64 v[104:105], v104
    ds_read_b64 v[106:107], v106
    v_mfma_f32_16x16x32_bf16 v[112:115], v[76:79], v[148:151], v[112:115]
    v_mov_b32 v61, v60
    v_lshlrev_b32_sdwa v108, 3, v33 dst_sel:DWORD dst_unused:UNUSED_PAD src0_sel:DWORD src1_sel:WORD_0
    v_lshlrev_b32_sdwa v110, 3, v33 dst_sel:DWORD dst_unused:UNUSED_PAD src0_sel:DWORD src1_sel:WORD_1
    ds_read_b64 v[108:109], v108
    ds_read_b64 v[110:111], v110
    s_waitcnt lgkmcnt(9)
    v_add3_u32 v0, v0, v88, v90
    v_add3_u32 v1, v1, v89, v91
    v_add3_u32 v0, v0, v92, v94
    v_add3_u32 v1, v1, v93, v95
    v_mfma_f32_16x16x32_bf16 v[112:115], v[80:83], v[152:155], v[112:115]
    v_lshlrev_b32_sdwa v88, 3, v34 dst_sel:DWORD dst_unused:UNUSED_PAD src0_sel:DWORD src1_sel:WORD_0
    v_lshlrev_b32_sdwa v90, 3, v34 dst_sel:DWORD dst_unused:UNUSED_PAD src0_sel:DWORD src1_sel:WORD_1
    ds_read_b64 v[88:89], v88
    ds_read_b64 v[90:91], v90
    v_mfma_f32_16x16x32_bf16 v[112:115], v[84:87], v[156:159], v[112:115]
    v_lshlrev_b32_sdwa v92, 3, v35 dst_sel:DWORD dst_unused:UNUSED_PAD src0_sel:DWORD src1_sel:WORD_0
    v_lshlrev_b32_sdwa v94, 3, v35 dst_sel:DWORD dst_unused:UNUSED_PAD src0_sel:DWORD src1_sel:WORD_1
    ds_read_b64 v[92:93], v92
    ds_read_b64 v[94:95], v94
    s_add_u32 s20, s20, 0x3d000
    buffer_load_dwordx4 v[32:35], v71, s[12:15], s20 offen offset:0 sc1
    s_waitcnt lgkmcnt(9)
    v_add3_u32 v0, v0, v96, v98
    v_add3_u32 v1, v1, v97, v99
    v_add3_u32 v0, v0, v100, v102
    v_add3_u32 v1, v1, v101, v103
    v_perm_b32 v112, v113, v112, s23
    v_perm_b32 v113, v115, v114, s23
    ds_write_b64 v70, v[112:113] offset:128
    v_mfma_f32_16x16x32_bf16 v[112:115], v[72:75], v[160:163], v[66:69]
    s_waitcnt vmcnt(8)
    v_lshlrev_b32_sdwa v96, 3, v40 dst_sel:DWORD dst_unused:UNUSED_PAD src0_sel:DWORD src1_sel:WORD_0
    v_lshlrev_b32_sdwa v98, 3, v40 dst_sel:DWORD dst_unused:UNUSED_PAD src0_sel:DWORD src1_sel:WORD_1
    ds_read_b64 v[96:97], v96
    ds_read_b64 v[98:99], v98
    v_mfma_f32_16x16x32_bf16 v[112:115], v[76:79], v[164:167], v[112:115]
    v_lshlrev_b32_sdwa v100, 3, v41 dst_sel:DWORD dst_unused:UNUSED_PAD src0_sel:DWORD src1_sel:WORD_0
    v_lshlrev_b32_sdwa v102, 3, v41 dst_sel:DWORD dst_unused:UNUSED_PAD src0_sel:DWORD src1_sel:WORD_1
    ds_read_b64 v[100:101], v100
    ds_read_b64 v[102:103], v102
    s_waitcnt vmcnt(5)
    v_readfirstlane_b32 s44, v65
    s_cmp_le_u32 s44, 0
    s_cbranch_scc1 k1_kernel_xw0
k1_kernel_xb0:
    buffer_load_dwordx4 v[128:131], v71, s[12:15], s18 offen offset:0 sc1
    s_waitcnt lgkmcnt(9)
    v_add3_u32 v4, v4, v104, v106
    v_add3_u32 v5, v5, v105, v107
    v_add3_u32 v4, v4, v108, v110
    v_add3_u32 v5, v5, v109, v111
    v_mfma_f32_16x16x32_bf16 v[112:115], v[80:83], v[168:171], v[112:115]
    v_lshlrev_b32_sdwa v104, 3, v42 dst_sel:DWORD dst_unused:UNUSED_PAD src0_sel:DWORD src1_sel:WORD_0
    v_lshlrev_b32_sdwa v106, 3, v42 dst_sel:DWORD dst_unused:UNUSED_PAD src0_sel:DWORD src1_sel:WORD_1
    ds_read_b64 v[104:105], v104
    ds_read_b64 v[106:107], v106
    v_mfma_f32_16x16x32_bf16 v[112:115], v[84:87], v[172:175], v[112:115]
    v_lshlrev_b32_sdwa v108, 3, v43 dst_sel:DWORD dst_unused:UNUSED_PAD src0_sel:DWORD src1_sel:WORD_0
    v_lshlrev_b32_sdwa v110, 3, v43 dst_sel:DWORD dst_unused:UNUSED_PAD src0_sel:DWORD src1_sel:WORD_1
    ds_read_b64 v[108:109], v108
    ds_read_b64 v[110:111], v110
    s_add_u32 s20, s20, 0xfffc0400
    buffer_load_dwordx4 v[40:43], v71, s[12:15], s20 offen offset:0 sc1
    s_waitcnt lgkmcnt(9)
    v_add3_u32 v4, v4, v88, v90
    v_add3_u32 v5, v5, v89, v91
    v_add3_u32 v4, v4, v92, v94
    v_add3_u32 v5, v5, v93, v95
    v_perm_b32 v112, v113, v112, s23
    v_perm_b32 v113, v115, v114, s23
    ds_write_b64 v70, v[112:113] offset:256
    v_mfma_f32_16x16x32_bf16 v[112:115], v[72:75], v[176:179], v[66:69]
    v_lshlrev_b32_sdwa v88, 3, v124 dst_sel:DWORD dst_unused:UNUSED_PAD src0_sel:DWORD src1_sel:WORD_0
    v_lshlrev_b32_sdwa v90, 3, v124 dst_sel:DWORD dst_unused:UNUSED_PAD src0_sel:DWORD src1_sel:WORD_1
    ds_read_b64 v[88:89], v88
    ds_read_b64 v[90:91], v90
    v_mfma_f32_16x16x32_bf16 v[112:115], v[76:79], v[180:183], v[112:115]
    v_lshlrev_b32_sdwa v92, 3, v125 dst_sel:DWORD dst_unused:UNUSED_PAD src0_sel:DWORD src1_sel:WORD_0
    v_lshlrev_b32_sdwa v94, 3, v125 dst_sel:DWORD dst_unused:UNUSED_PAD src0_sel:DWORD src1_sel:WORD_1
    ds_read_b64 v[92:93], v92
    ds_read_b64 v[94:95], v94
    s_waitcnt lgkmcnt(9)
    v_add3_u32 v8, v8, v96, v98
    v_add3_u32 v9, v9, v97, v99
    v_add3_u32 v8, v8, v100, v102
    v_add3_u32 v9, v9, v101, v103
    v_mfma_f32_16x16x32_bf16 v[112:115], v[80:83], v[184:187], v[112:115]
    v_lshlrev_b32_sdwa v96, 3, v126 dst_sel:DWORD dst_unused:UNUSED_PAD src0_sel:DWORD src1_sel:WORD_0
    v_lshlrev_b32_sdwa v98, 3, v126 dst_sel:DWORD dst_unused:UNUSED_PAD src0_sel:DWORD src1_sel:WORD_1
    ds_read_b64 v[96:97], v96
    ds_read_b64 v[98:99], v98
    v_mfma_f32_16x16x32_bf16 v[112:115], v[84:87], v[188:191], v[112:115]
    v_lshlrev_b32_sdwa v100, 3, v127 dst_sel:DWORD dst_unused:UNUSED_PAD src0_sel:DWORD src1_sel:WORD_0
    v_lshlrev_b32_sdwa v102, 3, v127 dst_sel:DWORD dst_unused:UNUSED_PAD src0_sel:DWORD src1_sel:WORD_1
    ds_read_b64 v[100:101], v100
    ds_read_b64 v[102:103], v102
    s_add_u32 s20, s20, 0x40000
    buffer_load_dwordx4 v[124:127], v71, s[12:15], s20 offen offset:0 sc1
    s_waitcnt lgkmcnt(9)
    v_add3_u32 v8, v8, v104, v106
    v_add3_u32 v9, v9, v105, v107
    v_add3_u32 v8, v8, v108, v110
    v_add3_u32 v9, v9, v109, v111
    v_perm_b32 v112, v113, v112, s23
    v_perm_b32 v113, v115, v114, s23
    ds_write_b64 v70, v[112:113] offset:384
    s_setprio 1
    v_mfma_f32_16x16x32_bf16 v[112:115], v[72:75], v[192:195], v[66:69]
    v_lshlrev_b32_sdwa v104, 3, v116 dst_sel:DWORD dst_unused:UNUSED_PAD src0_sel:DWORD src1_sel:WORD_0
    v_lshlrev_b32_sdwa v106, 3, v116 dst_sel:DWORD dst_unused:UNUSED_PAD src0_sel:DWORD src1_sel:WORD_1
    ds_read_b64 v[104:105], v104
    ds_read_b64 v[106:107], v106
    v_mfma_f32_16x16x32_bf16 v[112:115], v[76:79], v[196:199], v[112:115]
    v_lshlrev_b32_sdwa v108, 3, v117 dst_sel:DWORD dst_unused:UNUSED_PAD src0_sel:DWORD src1_sel:WORD_0
    v_lshlrev_b32_sdwa v110, 3, v117 dst_sel:DWORD dst_unused:UNUSED_PAD src0_sel:DWORD src1_sel:WORD_1
    ds_read_b64 v[108:109], v108
    ds_read_b64 v[110:111], v110
    s_waitcnt lgkmcnt(9)
    v_add3_u32 v12, v12, v88, v90
    v_add3_u32 v13, v13, v89, v91
    v_add3_u32 v12, v12, v92, v94
    v_add3_u32 v13, v13, v93, v95
    v_mfma_f32_16x16x32_bf16 v[112:115], v[80:83], v[200:203], v[112:115]
    v_lshlrev_b32_sdwa v88, 3, v118 dst_sel:DWORD dst_unused:UNUSED_PAD src0_sel:DWORD src1_sel:WORD_0
    v_lshlrev_b32_sdwa v90, 3, v118 dst_sel:DWORD dst_unused:UNUSED_PAD src0_sel:DWORD src1_sel:WORD_1
    ds_read_b64 v[88:89], v88
    ds_read_b64 v[90:91], v90
    v_mfma_f32_16x16x32_bf16 v[112:115], v[84:87], v[204:207], v[112:115]
    v_lshlrev_b32_sdwa v92, 3, v119 dst_sel:DWORD dst_unused:UNUSED_PAD src0_sel:DWORD src1_sel:WORD_0
    v_lshlrev_b32_sdwa v94, 3, v119 dst_sel:DWORD dst_unused:UNUSED_PAD src0_sel:DWORD src1_sel:WORD_1
    ds_read_b64 v[92:93], v92
    ds_read_b64 v[94:95], v94
    buffer_load_dwordx4 v[116:119], v71, s[12:15], s20 offen offset:1024 sc1
    s_waitcnt lgkmcnt(9)
    v_add3_u32 v12, v12, v96, v98
    v_add3_u32 v13, v13, v97, v99
    v_add3_u32 v12, v12, v100, v102
    v_add3_u32 v13, v13, v101, v103
    v_perm_b32 v112, v113, v112, s23
    v_perm_b32 v113, v115, v114, s23
    ds_write_b64 v70, v[112:113] offset:512
    v_mfma_f32_16x16x32_bf16 v[112:115], v[72:75], v[208:211], v[66:69]
    s_waitcnt vmcnt(8)
    v_lshlrev_b32_sdwa v96, 3, v44 dst_sel:DWORD dst_unused:UNUSED_PAD src0_sel:DWORD src1_sel:WORD_0
    v_lshlrev_b32_sdwa v98, 3, v44 dst_sel:DWORD dst_unused:UNUSED_PAD src0_sel:DWORD src1_sel:WORD_1
    ds_read_b64 v[96:97], v96
    ds_read_b64 v[98:99], v98
    v_mfma_f32_16x16x32_bf16 v[112:115], v[76:79], v[212:215], v[112:115]
    v_lshlrev_b32_sdwa v100, 3, v45 dst_sel:DWORD dst_unused:UNUSED_PAD src0_sel:DWORD src1_sel:WORD_0
    v_lshlrev_b32_sdwa v102, 3, v45 dst_sel:DWORD dst_unused:UNUSED_PAD src0_sel:DWORD src1_sel:WORD_1
    ds_read_b64 v[100:101], v100
    ds_read_b64 v[102:103], v102
    buffer_load_dwordx4 v[132:135], v71, s[12:15], s18 offen offset:1024 sc1
    s_waitcnt lgkmcnt(9)
    v_add3_u32 v16, v16, v104, v106
    v_add3_u32 v17, v17, v105, v107
    v_add3_u32 v16, v16, v108, v110
    v_add3_u32 v17, v17, v109, v111
    v_mfma_f32_16x16x32_bf16 v[112:115], v[80:83], v[216:219], v[112:115]
    v_lshlrev_b32_sdwa v104, 3, v46 dst_sel:DWORD dst_unused:UNUSED_PAD src0_sel:DWORD src1_sel:WORD_0
    v_lshlrev_b32_sdwa v106, 3, v46 dst_sel:DWORD dst_unused:UNUSED_PAD src0_sel:DWORD src1_sel:WORD_1
    ds_read_b64 v[104:105], v104
    ds_read_b64 v[106:107], v106
    v_mfma_f32_16x16x32_bf16 v[112:115], v[84:87], v[220:223], v[112:115]
    v_lshlrev_b32_sdwa v108, 3, v47 dst_sel:DWORD dst_unused:UNUSED_PAD src0_sel:DWORD src1_sel:WORD_0
    v_lshlrev_b32_sdwa v110, 3, v47 dst_sel:DWORD dst_unused:UNUSED_PAD src0_sel:DWORD src1_sel:WORD_1
    ds_read_b64 v[108:109], v108
    ds_read_b64 v[110:111], v110
    s_add_u32 s20, s20, 0xfffc0800
    buffer_load_dwordx4 v[44:47], v71, s[12:15], s20 offen offset:0 sc1
    s_waitcnt lgkmcnt(9)
    v_add3_u32 v16, v16, v88, v90
    v_add3_u32 v17, v17, v89, v91
    v_add3_u32 v16, v16, v92, v94
    v_add3_u32 v17, v17, v93, v95
    v_perm_b32 v112, v113, v112, s23
    v_perm_b32 v113, v115, v114, s23
    ds_write_b64 v70, v[112:113] offset:640
    v_mfma_f32_16x16x32_bf16 v[112:115], v[72:75], v[224:227], v[66:69]
    s_waitcnt vmcnt(8)
    v_lshlrev_b32_sdwa v88, 3, v36 dst_sel:DWORD dst_unused:UNUSED_PAD src0_sel:DWORD src1_sel:WORD_0
    v_lshlrev_b32_sdwa v90, 3, v36 dst_sel:DWORD dst_unused:UNUSED_PAD src0_sel:DWORD src1_sel:WORD_1
    ds_read_b64 v[88:89], v88
    ds_read_b64 v[90:91], v90
    v_mfma_f32_16x16x32_bf16 v[112:115], v[76:79], v[228:231], v[112:115]
    v_lshlrev_b32_sdwa v92, 3, v37 dst_sel:DWORD dst_unused:UNUSED_PAD src0_sel:DWORD src1_sel:WORD_0
    v_lshlrev_b32_sdwa v94, 3, v37 dst_sel:DWORD dst_unused:UNUSED_PAD src0_sel:DWORD src1_sel:WORD_1
    ds_read_b64 v[92:93], v92
    ds_read_b64 v[94:95], v94
    v_mov_b32 v64, 2
    s_mov_b64 exec, 1
    buffer_store_dword v64, off, s[12:15], s46 sc1
    s_mov_b64 exec, -1
    s_waitcnt lgkmcnt(9)
    v_add3_u32 v20, v20, v96, v98
    v_add3_u32 v21, v21, v97, v99
    v_add3_u32 v20, v20, v100, v102
    v_add3_u32 v21, v21, v101, v103
    v_mfma_f32_16x16x32_bf16 v[112:115], v[80:83], v[232:235], v[112:115]
    v_lshlrev_b32_sdwa v96, 3, v38 dst_sel:DWORD dst_unused:UNUSED_PAD src0_sel:DWORD src1_sel:WORD_0
    v_lshlrev_b32_sdwa v98, 3, v38 dst_sel:DWORD dst_unused:UNUSED_PAD src0_sel:DWORD src1_sel:WORD_1
    ds_read_b64 v[96:97], v96
    ds_read_b64 v[98:99], v98
    v_mfma_f32_16x16x32_bf16 v[112:115], v[84:87], v[236:239], v[112:115]
    v_lshlrev_b32_sdwa v100, 3, v39 dst_sel:DWORD dst_unused:UNUSED_PAD src0_sel:DWORD src1_sel:WORD_0
    v_lshlrev_b32_sdwa v102, 3, v39 dst_sel:DWORD dst_unused:UNUSED_PAD src0_sel:DWORD src1_sel:WORD_1
    ds_read_b64 v[100:101], v100
    ds_read_b64 v[102:103], v102
    s_add_u32 s20, s20, 0x40000
    buffer_load_dwordx4 v[36:39], v71, s[12:15], s20 offen offset:0 sc1
    s_waitcnt lgkmcnt(9)
    v_add3_u32 v20, v20, v104, v106
    v_add3_u32 v21, v21, v105, v107
    v_add3_u32 v20, v20, v108, v110
    v_add3_u32 v21, v21, v109, v111
    v_perm_b32 v112, v113, v112, s23
    v_perm_b32 v113, v115, v114, s23
    ds_write_b64 v70, v[112:113] offset:768
    s_setprio 0
    v_mfma_f32_16x16x32_bf16 v[112:115], v[72:75], v[240:243], v[66:69]
    s_waitcnt vmcnt(9)
    v_lshlrev_b32_sdwa v104, 3, v120 dst_sel:DWORD dst_unused:UNUSED_PAD src0_sel:DWORD src1_sel:WORD_0
    v_lshlrev_b32_sdwa v106, 3, v120 dst_sel:DWORD dst_unused:UNUSED_PAD src0_sel:DWORD src1_sel:WORD_1
    ds_read_b64 v[104:105], v104
    ds_read_b64 v[106:107], v106
    v_mfma_f32_16x16x32_bf16 v[112:115], v[76:79], v[244:247], v[112:115]
    v_lshlrev_b32_sdwa v108, 3, v121 dst_sel:DWORD dst_unused:UNUSED_PAD src0_sel:DWORD src1_sel:WORD_0
    v_lshlrev_b32_sdwa v110, 3, v121 dst_sel:DWORD dst_unused:UNUSED_PAD src0_sel:DWORD src1_sel:WORD_1
    ds_read_b64 v[108:109], v108
    ds_read_b64 v[110:111], v110
    s_waitcnt lgkmcnt(9)
    v_add3_u32 v24, v24, v88, v90
    v_add3_u32 v25, v25, v89, v91
    v_add3_u32 v24, v24, v92, v94
    v_add3_u32 v25, v25, v93, v95
    v_mfma_f32_16x16x32_bf16 v[112:115], v[80:83], v[248:251], v[112:115]
    v_lshlrev_b32_sdwa v88, 3, v122 dst_sel:DWORD dst_unused:UNUSED_PAD src0_sel:DWORD src1_sel:WORD_0
    v_lshlrev_b32_sdwa v90, 3, v122 dst_sel:DWORD dst_unused:UNUSED_PAD src0_sel:DWORD src1_sel:WORD_1
    ds_read_b64 v[88:89], v88
    ds_read_b64 v[90:91], v90
    v_mfma_f32_16x16x32_bf16 v[112:115], v[84:87], v[252:255], v[112:115]
    v_lshlrev_b32_sdwa v92, 3, v123 dst_sel:DWORD dst_unused:UNUSED_PAD src0_sel:DWORD src1_sel:WORD_0
    v_lshlrev_b32_sdwa v94, 3, v123 dst_sel:DWORD dst_unused:UNUSED_PAD src0_sel:DWORD src1_sel:WORD_1
    ds_read_b64 v[92:93], v92
    ds_read_b64 v[94:95], v94
    buffer_load_dwordx4 v[120:123], v71, s[12:15], s20 offen offset:1024 sc1
    s_waitcnt lgkmcnt(9)
    v_add3_u32 v24, v24, v96, v98
    v_add3_u32 v25, v25, v97, v99
    v_add3_u32 v24, v24, v100, v102
    v_add3_u32 v25, v25, v101, v103
    v_perm_b32 v112, v113, v112, s23
    v_perm_b32 v113, v115, v114, s23
    ds_write_b64 v70, v[112:113] offset:896
    s_waitcnt lgkmcnt(0)
    s_barrier
    s_setprio 3
    v_mov_b32 v73, 0
    v_lshrrev_b32 v76, 2, v71
    v_mov_b32 v79, 0
    v_and_b32 v75, 0xf0, v71
    v_lshrrev_b32 v80, 8, v71
    s_waitcnt vmcnt(9)
    v_lshlrev_b32_sdwa v96, 3, v32 dst_sel:DWORD dst_unused:UNUSED_PAD src0_sel:DWORD src1_sel:WORD_0
    v_lshlrev_b32_sdwa v98, 3, v32 dst_sel:DWORD dst_unused:UNUSED_PAD src0_sel:DWORD src1_sel:WORD_1
    ds_read_b64 v[96:97], v96
    ds_read_b64 v[98:99], v98
    v_lshl_add_u32 v74, v80, 16, v75
    v_lshl_add_u32 v75, v80, 2, v75
    v_lshrrev_b32 v77, 9, v71
    v_mul_u32_u24 v77, 8064, v77
    v_add3_u32 v77, v77, v76, s67
    v_lshlrev_b32_sdwa v100, 3, v33 dst_sel:DWORD dst_unused:UNUSED_PAD src0_sel:DWORD src1_sel:WORD_0
    v_lshlrev_b32_sdwa v102, 3, v33 dst_sel:DWORD dst_unused:UNUSED_PAD src0_sel:DWORD src1_sel:WORD_1
    ds_read_b64 v[100:101], v100
    ds_read_b64 v[102:103], v102
    buffer_load_dwordx4 v[136:139], v71, s[12:15], s18 offen offset:2048 sc1
    s_add_u32 s20, s20, 0xfffc0800
    buffer_load_dwordx4 v[160:163], v71, s[12:15], s20 offen offset:0 sc1
    v_add3_u32 v28, v28, v104, v106
    v_add3_u32 v29, v29, v105, v107
    v_add3_u32 v28, v28, v108, v110
    v_add3_u32 v29, v29, v109, v111
    v_lshrrev_b32 v78, 1, v75
    v_lshlrev_b32_sdwa v104, 3, v34 dst_sel:DWORD dst_unused:UNUSED_PAD src0_sel:DWORD src1_sel:WORD_0
    v_lshlrev_b32_sdwa v106, 3, v34 dst_sel:DWORD dst_unused:UNUSED_PAD src0_sel:DWORD src1_sel:WORD_1
    ds_read_b64 v[104:105], v104
    ds_read_b64 v[106:107], v106
    v_lshlrev_b32_sdwa v108, 3, v35 dst_sel:DWORD dst_unused:UNUSED_PAD src0_sel:DWORD src1_sel:WORD_0
    v_lshlrev_b32_sdwa v110, 3, v35 dst_sel:DWORD dst_unused:UNUSED_PAD src0_sel:DWORD src1_sel:WORD_1
    ds_read_b64 v[108:109], v108
    ds_read_b64 v[110:111], v110
    v_add3_u32 v28, v28, v88, v90
    v_add3_u32 v29, v29, v89, v91
    v_add3_u32 v28, v28, v92, v94
    v_add3_u32 v29, v29, v93, v95
    s_waitcnt vmcnt(9)
    v_lshlrev_b32_sdwa v88, 3, v40 dst_sel:DWORD dst_unused:UNUSED_PAD src0_sel:DWORD src1_sel:WORD_0
    v_lshlrev_b32_sdwa v90, 3, v40 dst_sel:DWORD dst_unused:UNUSED_PAD src0_sel:DWORD src1_sel:WORD_1
    ds_read_b64 v[88:89], v88
    ds_read_b64 v[90:91], v90
    v_lshlrev_b32_sdwa v92, 3, v41 dst_sel:DWORD dst_unused:UNUSED_PAD src0_sel:DWORD src1_sel:WORD_0
    v_lshlrev_b32_sdwa v94, 3, v41 dst_sel:DWORD dst_unused:UNUSED_PAD src0_sel:DWORD src1_sel:WORD_1
    ds_read_b64 v[92:93], v92
    ds_read_b64 v[94:95], v94
    s_add_u32 s20, s20, 0x40000
    buffer_load_dwordx4 v[164:167], v71, s[12:15], s20 offen offset:0 sc1
    s_waitcnt lgkmcnt(8)
    v_add3_u32 v0, v0, v96, v98
    v_add3_u32 v1, v1, v97, v99
    v_add3_u32 v0, v0, v100, v102
    v_add3_u32 v1, v1, v101, v103
    v_lshlrev_b32_sdwa v96, 3, v42 dst_sel:DWORD dst_unused:UNUSED_PAD src0_sel:DWORD src1_sel:WORD_0
    v_lshlrev_b32_sdwa v98, 3, v42 dst_sel:DWORD dst_unused:UNUSED_PAD src0_sel:DWORD src1_sel:WORD_1
    ds_read_b64 v[96:97], v96
    ds_read_b64 v[98:99], v98
    v_lshlrev_b32_sdwa v100, 3, v43 dst_sel:DWORD dst_unused:UNUSED_PAD src0_sel:DWORD src1_sel:WORD_0
    v_lshlrev_b32_sdwa v102, 3, v43 dst_sel:DWORD dst_unused:UNUSED_PAD src0_sel:DWORD src1_sel:WORD_1
    ds_read_b64 v[100:101], v100
    ds_read_b64 v[102:103], v102
    s_waitcnt lgkmcnt(8)
    v_add3_u32 v0, v0, v104, v106
    v_add3_u32 v1, v1, v105, v107
    v_add3_u32 v0, v0, v108, v110
    v_add3_u32 v1, v1, v109, v111
    s_waitcnt vmcnt(9)
    v_lshlrev_b32_sdwa v104, 3, v124 dst_sel:DWORD dst_unused:UNUSED_PAD src0_sel:DWORD src1_sel:WORD_0
    v_lshlrev_b32_sdwa v106, 3, v124 dst_sel:DWORD dst_unused:UNUSED_PAD src0_sel:DWORD src1_sel:WORD_1
    ds_read_b64 v[104:105], v104
    ds_read_b64 v[106:107], v106
    v_add_u32_sdwa v188, v0, v128 dst_sel:DWORD dst_unused:UNUSED_PAD src0_sel:WORD_0 src1_sel:WORD_0
    v_add_u32_sdwa v189, v0, v128 dst_sel:DWORD dst_unused:UNUSED_PAD src0_sel:WORD_1 src1_sel:WORD_1
    v_add_u32_sdwa v190, v1, v129 dst_sel:DWORD dst_unused:UNUSED_PAD src0_sel:WORD_0 src1_sel:WORD_0
    v_add_u32_sdwa v191, v1, v129 dst_sel:DWORD dst_unused:UNUSED_PAD src0_sel:WORD_1 src1_sel:WORD_1
    v_pk_fma_f32 v[188:189], v[188:189], v[50:51], v[52:53]
    v_lshlrev_b32_sdwa v108, 3, v125 dst_sel:DWORD dst_unused:UNUSED_PAD src0_sel:DWORD src1_sel:WORD_0
    v_lshlrev_b32_sdwa v110, 3, v125 dst_sel:DWORD dst_unused:UNUSED_PAD src0_sel:DWORD src1_sel:WORD_1
    ds_read_b64 v[108:109], v108
    ds_read_b64 v[110:111], v110
    s_mov_b64 exec, 1
    buffer_load_dword v65, off, s[12:15], s47 sc1
    s_mov_b64 exec, -1
    buffer_load_dwordx4 v[168:171], v71, s[12:15], s20 offen offset:1024 sc1
    s_waitcnt lgkmcnt(8)
    v_add3_u32 v2, v2, v88, v90
    v_add3_u32 v3, v3, v89, v91
    v_add3_u32 v2, v2, v92, v94
    v_add3_u32 v3, v3, v93, v95
    v_pk_fma_f32 v[190:191], v[190:191], v[50:51], v[54:55]
    v_pk_mul_f32 v[224:225], v[188:189], v[188:189]
    v_pk_mul_f32 v[226:227], v[190:191], v[190:191]
    v_pk_fma_f32 v[224:225], v[224:225], v[60:61], v[62:63]
    v_pk_fma_f32 v[226:227], v[226:227], v[60:61], v[62:63]
    v_lshlrev_b32_sdwa v88, 3, v126 dst_sel:DWORD dst_unused:UNUSED_PAD src0_sel:DWORD src1_sel:WORD_0
    v_lshlrev_b32_sdwa v90, 3, v126 dst_sel:DWORD dst_unused:UNUSED_PAD src0_sel:DWORD src1_sel:WORD_1
    ds_read_b64 v[88:89], v88
    ds_read_b64 v[90:91], v90
    v_pk_mul_f32 v[224:225], v[224:225], v[188:189]
    v_pk_mul_f32 v[226:227], v[226:227], v[190:191]
    v_exp_f32 v224, v224
    v_exp_f32 v225, v225
    v_exp_f32 v226, v226
    v_lshlrev_b32_sdwa v92, 3, v127 dst_sel:DWORD dst_unused:UNUSED_PAD src0_sel:DWORD src1_sel:WORD_0
    v_lshlrev_b32_sdwa v94, 3, v127 dst_sel:DWORD dst_unused:UNUSED_PAD src0_sel:DWORD src1_sel:WORD_1
    ds_read_b64 v[92:93], v92
    ds_read_b64 v[94:95], v94
    s_waitcnt lgkmcnt(8)
    v_add3_u32 v2, v2, v96, v98
    v_add3_u32 v3, v3, v97, v99
    v_add3_u32 v2, v2, v100, v102
    v_add3_u32 v3, v3, v101, v103
    v_exp_f32 v227, v227
    v_pk_fma_f32 v[224:225], v[224:225], v[56:57], v[56:57]
    s_waitcnt vmcnt(10)
    v_lshlrev_b32_sdwa v96, 3, v116 dst_sel:DWORD dst_unused:UNUSED_PAD src0_sel:DWORD src1_sel:WORD_0
    v_lshlrev_b32_sdwa v98, 3, v116 dst_sel:DWORD dst_unused:UNUSED_PAD src0_sel:DWORD src1_sel:WORD_1
    ds_read_b64 v[96:97], v96
    ds_read_b64 v[98:99], v98
    v_rcp_f32 v224, v224
    v_pk_fma_f32 v[226:227], v[226:227], v[58:59], v[58:59]
    v_rcp_f32 v225, v225
    v_rcp_f32 v226, v226
    v_rcp_f32 v227, v227
    v_lshlrev_b32_sdwa v100, 3, v117 dst_sel:DWORD dst_unused:UNUSED_PAD src0_sel:DWORD src1_sel:WORD_0
    v_lshlrev_b32_sdwa v102, 3, v117 dst_sel:DWORD dst_unused:UNUSED_PAD src0_sel:DWORD src1_sel:WORD_1
    ds_read_b64 v[100:101], v100
    ds_read_b64 v[102:103], v102
    buffer_load_dwordx4 v[140:143], v71, s[12:15], s18 offen offset:3072 sc1
    s_add_u32 s20, s20, 0xfffc0800
    buffer_load_dwordx4 v[172:175], v71, s[12:15], s20 offen offset:0 sc1
    s_waitcnt lgkmcnt(8)
    v_add3_u32 v2, v2, v104, v106
    v_add3_u32 v3, v3, v105, v107
    v_add3_u32 v2, v2, v108, v110
    v_add3_u32 v3, v3, v109, v111
    v_pk_mul_f32 v[228:229], v[188:189], v[224:225]
    v_lshlrev_b32_sdwa v104, 3, v118 dst_sel:DWORD dst_unused:UNUSED_PAD src0_sel:DWORD src1_sel:WORD_0
    v_lshlrev_b32_sdwa v106, 3, v118 dst_sel:DWORD dst_unused:UNUSED_PAD src0_sel:DWORD src1_sel:WORD_1
    ds_read_b64 v[104:105], v104
    ds_read_b64 v[106:107], v106
    v_pk_fma_f32 v[228:229], v[190:191], v[226:227], v[228:229]
    v_lshlrev_b32_sdwa v108, 3, v119 dst_sel:DWORD dst_unused:UNUSED_PAD src0_sel:DWORD src1_sel:WORD_0
    v_lshlrev_b32_sdwa v110, 3, v119 dst_sel:DWORD dst_unused:UNUSED_PAD src0_sel:DWORD src1_sel:WORD_1
    ds_read_b64 v[108:109], v108
    ds_read_b64 v[110:111], v110
    s_waitcnt lgkmcnt(8)
    v_add3_u32 v2, v2, v88, v90
    v_add3_u32 v3, v3, v89, v91
    v_add3_u32 v2, v2, v92, v94
    v_add3_u32 v3, v3, v93, v95
    v_add_f32 v228, v228, v229
    v_add_u32_sdwa v192, v2, v130 dst_sel:DWORD dst_unused:UNUSED_PAD src0_sel:WORD_0 src1_sel:WORD_0
    buffer_store_dword v228, v76, s[12:15], s35 offen offset:0 sc1
    v_add_u32_sdwa v193, v2, v130 dst_sel:DWORD dst_unused:UNUSED_PAD src0_sel:WORD_1 src1_sel:WORD_1
    v_add_u32_sdwa v194, v3, v131 dst_sel:DWORD dst_unused:UNUSED_PAD src0_sel:WORD_0 src1_sel:WORD_0
    s_waitcnt vmcnt(11)
    v_lshlrev_b32_sdwa v88, 3, v44 dst_sel:DWORD dst_unused:UNUSED_PAD src0_sel:DWORD src1_sel:WORD_0
    v_lshlrev_b32_sdwa v90, 3, v44 dst_sel:DWORD dst_unused:UNUSED_PAD src0_sel:DWORD src1_sel:WORD_1
    ds_read_b64 v[88:89], v88
    ds_read_b64 v[90:91], v90
    v_add_u32_sdwa v195, v3, v131 dst_sel:DWORD dst_unused:UNUSED_PAD src0_sel:WORD_1 src1_sel:WORD_1
    v_pk_fma_f32 v[192:193], v[192:193], v[50:51], v[52:53]
    v_pk_fma_f32 v[194:195], v[194:195], v[50:51], v[54:55]
    v_pk_mul_f32 v[230:231], v[192:193], v[192:193]
    v_pk_mul_f32 v[232:233], v[194:195], v[194:195]
    v_lshlrev_b32_sdwa v92, 3, v45 dst_sel:DWORD dst_unused:UNUSED_PAD src0_sel:DWORD src1_sel:WORD_0
    v_lshlrev_b32_sdwa v94, 3, v45 dst_sel:DWORD dst_unused:UNUSED_PAD src0_sel:DWORD src1_sel:WORD_1
    ds_read_b64 v[92:93], v92
    ds_read_b64 v[94:95], v94
    s_add_u32 s20, s20, 0x40000
    buffer_load_dwordx4 v[32:35], v71, s[12:15], s20 offen offset:0 sc1
    s_waitcnt lgkmcnt(8)
    v_add3_u32 v4, v4, v96, v98
    v_add3_u32 v5, v5, v97, v99
    v_add3_u32 v4, v4, v100, v102
    v_add3_u32 v5, v5, v101, v103
    v_pk_fma_f32 v[230:231], v[230:231], v[60:61], v[62:63]
    v_pk_fma_f32 v[232:233], v[232:233], v[60:61], v[62:63]
    v_pk_mul_f32 v[230:231], v[230:231], v[192:193]
    v_pk_mul_f32 v[232:233], v[232:233], v[194:195]
    v_exp_f32 v230, v230
    v_lshlrev_b32_sdwa v96, 3, v46 dst_sel:DWORD dst_unused:UNUSED_PAD src0_sel:DWORD src1_sel:WORD_0
    v_lshlrev_b32_sdwa v98, 3, v46 dst_sel:DWORD dst_unused:UNUSED_PAD src0_sel:DWORD src1_sel:WORD_1
    ds_read_b64 v[96:97], v96
    ds_read_b64 v[98:99], v98
    v_exp_f32 v231, v231
    v_exp_f32 v232, v232
    v_exp_f32 v233, v233
    v_pk_fma_f32 v[230:231], v[230:231], v[56:57], v[56:57]
    v_lshlrev_b32_sdwa v100, 3, v47 dst_sel:DWORD dst_unused:UNUSED_PAD src0_sel:DWORD src1_sel:WORD_0
    v_lshlrev_b32_sdwa v102, 3, v47 dst_sel:DWORD dst_unused:UNUSED_PAD src0_sel:DWORD src1_sel:WORD_1
    ds_read_b64 v[100:101], v100
    ds_read_b64 v[102:103], v102
    s_waitcnt lgkmcnt(8)
    v_add3_u32 v4, v4, v104, v106
    v_add3_u32 v5, v5, v105, v107
    v_add3_u32 v4, v4, v108, v110
    v_add3_u32 v5, v5, v109, v111
    v_rcp_f32 v230, v230
    v_pk_fma_f32 v[232:233], v[232:233], v[58:59], v[58:59]
    v_add_u32_sdwa v196, v4, v132 dst_sel:DWORD dst_unused:UNUSED_PAD src0_sel:WORD_0 src1_sel:WORD_0
    v_rcp_f32 v231, v231
    v_add_u32_sdwa v197, v4, v132 dst_sel:DWORD dst_unused:UNUSED_PAD src0_sel:WORD_1 src1_sel:WORD_1
    s_waitcnt vmcnt(10)
    v_lshlrev_b32_sdwa v104, 3, v36 dst_sel:DWORD dst_unused:UNUSED_PAD src0_sel:DWORD src1_sel:WORD_0
    v_lshlrev_b32_sdwa v106, 3, v36 dst_sel:DWORD dst_unused:UNUSED_PAD src0_sel:DWORD src1_sel:WORD_1
    ds_read_b64 v[104:105], v104
    ds_read_b64 v[106:107], v106
    v_rcp_f32 v232, v232
    v_pk_mul_f32 v[234:235], v[192:193], v[230:231]
    v_add_u32_sdwa v198, v5, v133 dst_sel:DWORD dst_unused:UNUSED_PAD src0_sel:WORD_0 src1_sel:WORD_0
    v_rcp_f32 v233, v233
    v_add_u32_sdwa v199, v5, v133 dst_sel:DWORD dst_unused:UNUSED_PAD src0_sel:WORD_1 src1_sel:WORD_1
    v_lshlrev_b32_sdwa v108, 3, v37 dst_sel:DWORD dst_unused:UNUSED_PAD src0_sel:DWORD src1_sel:WORD_0
    v_lshlrev_b32_sdwa v110, 3, v37 dst_sel:DWORD dst_unused:UNUSED_PAD src0_sel:DWORD src1_sel:WORD_1
    ds_read_b64 v[108:109], v108
    ds_read_b64 v[110:111], v110
    buffer_load_dwordx4 v[40:43], v71, s[12:15], s20 offen offset:1024 sc1
    s_waitcnt lgkmcnt(8)
    v_add3_u32 v6, v6, v88, v90
    v_add3_u32 v7, v7, v89, v91
    v_add3_u32 v6, v6, v92, v94
    v_add3_u32 v7, v7, v93, v95
    v_pk_fma_f32 v[234:235], v[194:195], v[232:233], v[234:235]
    v_pk_fma_f32 v[196:197], v[196:197], v[50:51], v[52:53]
    v_add_f32 v234, v234, v235
    v_pk_fma_f32 v[198:199], v[198:199], v[50:51], v[54:55]
    buffer_store_dword v234, v76, s[12:15], s35 offen offset:256 sc1
    v_lshlrev_b32_sdwa v88, 3, v38 dst_sel:DWORD dst_unused:UNUSED_PAD src0_sel:DWORD src1_sel:WORD_0
    v_lshlrev_b32_sdwa v90, 3, v38 dst_sel:DWORD dst_unused:UNUSED_PAD src0_sel:DWORD src1_sel:WORD_1
    ds_read_b64 v[88:89], v88
    ds_read_b64 v[90:91], v90
    v_pk_mul_f32 v[236:237], v[196:197], v[196:197]
    v_pk_mul_f32 v[238:239], v[198:199], v[198:199]
    v_pk_fma_f32 v[236:237], v[236:237], v[60:61], v[62:63]
    v_pk_fma_f32 v[238:239], v[238:239], v[60:61], v[62:63]
    v_pk_mul_f32 v[236:237], v[236:237], v[196:197]
    v_lshlrev_b32_sdwa v92, 3, v39 dst_sel:DWORD dst_unused:UNUSED_PAD src0_sel:DWORD src1_sel:WORD_0
    v_lshlrev_b32_sdwa v94, 3, v39 dst_sel:DWORD dst_unused:UNUSED_PAD src0_sel:DWORD src1_sel:WORD_1
    ds_read_b64 v[92:93], v92
    ds_read_b64 v[94:95], v94
    s_waitcnt lgkmcnt(8)
    v_add3_u32 v6, v6, v96, v98
    v_add3_u32 v7, v7, v97, v99
    v_add3_u32 v6, v6, v100, v102
    v_add3_u32 v7, v7, v101, v103
    v_exp_f32 v236, v236
    v_pk_mul_f32 v[238:239], v[238:239], v[198:199]
    v_exp_f32 v237, v237
    v_exp_f32 v238, v238
    v_exp_f32 v239, v239
    s_waitcnt vmcnt(11)
    v_lshlrev_b32_sdwa v96, 3, v120 dst_sel:DWORD dst_unused:UNUSED_PAD src0_sel:DWORD src1_sel:WORD_0
    v_lshlrev_b32_sdwa v98, 3, v120 dst_sel:DWORD dst_unused:UNUSED_PAD src0_sel:DWORD src1_sel:WORD_1
    ds_read_b64 v[96:97], v96
    ds_read_b64 v[98:99], v98
    v_pk_fma_f32 v[236:237], v[236:237], v[56:57], v[56:57]
    v_pk_fma_f32 v[238:239], v[238:239], v[58:59], v[58:59]
    v_rcp_f32 v236, v236
    v_rcp_f32 v237, v237
    v_rcp_f32 v238, v238
    v_lshlrev_b32_sdwa v100, 3, v121 dst_sel:DWORD dst_unused:UNUSED_PAD src0_sel:DWORD src1_sel:WORD_0
    v_lshlrev_b32_sdwa v102, 3, v121 dst_sel:DWORD dst_unused:UNUSED_PAD src0_sel:DWORD src1_sel:WORD_1
    ds_read_b64 v[100:101], v100
    ds_read_b64 v[102:103], v102
    s_waitcnt vmcnt(7)
    v_readfirstlane_b32 s44, v65
    s_cmp_le_u32 s44, 1
    s_cbranch_scc1 k1_kernel_xw1
k1_kernel_xb1:
    buffer_load_dwordx4 v[144:147], v71, s[12:15], s32 offen offset:0 sc1
    s_add_u32 s20, s20, 0xfffc0800
    buffer_load_dwordx4 v[124:127], v71, s[12:15], s20 offen offset:0 sc1
    s_waitcnt lgkmcnt(8)
    v_add3_u32 v6, v6, v104, v106
    v_add3_u32 v7, v7, v105, v107
    v_add3_u32 v6, v6, v108, v110
    v_add3_u32 v7, v7, v109, v111
    v_rcp_f32 v239, v239
    v_pk_mul_f32 v[240:241], v[196:197], v[236:237]
    v_lshlrev_b32_sdwa v104, 3, v122 dst_sel:DWORD dst_unused:UNUSED_PAD src0_sel:DWORD src1_sel:WORD_0
    v_lshlrev_b32_sdwa v106, 3, v122 dst_sel:DWORD dst_unused:UNUSED_PAD src0_sel:DWORD src1_sel:WORD_1
    ds_read_b64 v[104:105], v104
    ds_read_b64 v[106:107], v106
    v_pk_fma_f32 v[240:241], v[198:199], v[238:239], v[240:241]
    v_lshlrev_b32_sdwa v108, 3, v123 dst_sel:DWORD dst_unused:UNUSED_PAD src0_sel:DWORD src1_sel:WORD_0
    v_lshlrev_b32_sdwa v110, 3, v123 dst_sel:DWORD dst_unused:UNUSED_PAD src0_sel:DWORD src1_sel:WORD_1
    ds_read_b64 v[108:109], v108
    ds_read_b64 v[110:111], v110
    s_waitcnt lgkmcnt(8)
    v_add3_u32 v6, v6, v88, v90
    v_add3_u32 v7, v7, v89, v91
    v_add3_u32 v6, v6, v92, v94
    v_add3_u32 v7, v7, v93, v95
    v_add_f32 v240, v240, v241
    v_add_u32_sdwa v200, v6, v134 dst_sel:DWORD dst_unused:UNUSED_PAD src0_sel:WORD_0 src1_sel:WORD_0
    buffer_store_dword v240, v76, s[12:15], s35 offen offset:512 sc1
    v_add_u32_sdwa v201, v6, v134 dst_sel:DWORD dst_unused:UNUSED_PAD src0_sel:WORD_1 src1_sel:WORD_1
    v_add_u32_sdwa v202, v7, v135 dst_sel:DWORD dst_unused:UNUSED_PAD src0_sel:WORD_0 src1_sel:WORD_0
    v_lshlrev_b32_sdwa v88, 3, v160 dst_sel:DWORD dst_unused:UNUSED_PAD src0_sel:DWORD src1_sel:WORD_0
    v_lshlrev_b32_sdwa v90, 3, v160 dst_sel:DWORD dst_unused:UNUSED_PAD src0_sel:DWORD src1_sel:WORD_1
    ds_read_b64 v[88:89], v88
    ds_read_b64 v[90:91], v90
    v_add_u32_sdwa v203, v7, v135 dst_sel:DWORD dst_unused:UNUSED_PAD src0_sel:WORD_1 src1_sel:WORD_1
    v_pk_fma_f32 v[200:201], v[200:201], v[50:51], v[52:53]
    v_pk_fma_f32 v[202:203], v[202:203], v[50:51], v[54:55]
    v_pk_mul_f32 v[242:243], v[200:201], v[200:201]
    v_pk_mul_f32 v[244:245], v[202:203], v[202:203]
    v_lshlrev_b32_sdwa v92, 3, v161 dst_sel:DWORD dst_unused:UNUSED_PAD src0_sel:DWORD src1_sel:WORD_0
    v_lshlrev_b32_sdwa v94, 3, v161 dst_sel:DWORD dst_unused:UNUSED_PAD src0_sel:DWORD src1_sel:WORD_1
    ds_read_b64 v[92:93], v92
    ds_read_b64 v[94:95], v94
    s_add_u32 s20, s20, 0x40000
    buffer_load_dwordx4 v[116:119], v71, s[12:15], s20 offen offset:0 sc1
    s_waitcnt lgkmcnt(8)
    v_add3_u32 v8, v8, v96, v98
    v_add3_u32 v9, v9, v97, v99
    v_add3_u32 v8, v8, v100, v102
    v_add3_u32 v9, v9, v101, v103
    v_pk_fma_f32 v[242:243], v[242:243], v[60:61], v[62:63]
    v_pk_fma_f32 v[244:245], v[244:245], v[60:61], v[62:63]
    v_pk_mul_f32 v[242:243], v[242:243], v[200:201]
    v_pk_mul_f32 v[244:245], v[244:245], v[202:203]
    v_exp_f32 v242, v242
    v_lshlrev_b32_sdwa v96, 3, v162 dst_sel:DWORD dst_unused:UNUSED_PAD src0_sel:DWORD src1_sel:WORD_0
    v_lshlrev_b32_sdwa v98, 3, v162 dst_sel:DWORD dst_unused:UNUSED_PAD src0_sel:DWORD src1_sel:WORD_1
    ds_read_b64 v[96:97], v96
    ds_read_b64 v[98:99], v98
    v_exp_f32 v243, v243
    v_exp_f32 v244, v244
    v_exp_f32 v245, v245
    v_pk_fma_f32 v[242:243], v[242:243], v[56:57], v[56:57]
    v_lshlrev_b32_sdwa v100, 3, v163 dst_sel:DWORD dst_unused:UNUSED_PAD src0_sel:DWORD src1_sel:WORD_0
    v_lshlrev_b32_sdwa v102, 3, v163 dst_sel:DWORD dst_unused:UNUSED_PAD src0_sel:DWORD src1_sel:WORD_1
    ds_read_b64 v[100:101], v100
    ds_read_b64 v[102:103], v102
    s_waitcnt lgkmcnt(8)
    v_add3_u32 v8, v8, v104, v106
    v_add3_u32 v9, v9, v105, v107
    v_add3_u32 v8, v8, v108, v110
    v_add3_u32 v9, v9, v109, v111
    v_rcp_f32 v242, v242
    v_pk_fma_f32 v[244:245], v[244:245], v[58:59], v[58:59]
    v_add_u32_sdwa v204, v8, v136 dst_sel:DWORD dst_unused:UNUSED_PAD src0_sel:WORD_0 src1_sel:WORD_0
    v_rcp_f32 v243, v243
    v_add_u32_sdwa v205, v8, v136 dst_sel:DWORD dst_unused:UNUSED_PAD src0_sel:WORD_1 src1_sel:WORD_1
    v_lshlrev_b32_sdwa v104, 3, v164 dst_sel:DWORD dst_unused:UNUSED_PAD src0_sel:DWORD src1_sel:WORD_0
    v_lshlrev_b32_sdwa v106, 3, v164 dst_sel:DWORD dst_unused:UNUSED_PAD src0_sel:DWORD src1_sel:WORD_1
    ds_read_b64 v[104:105], v104
    ds_read_b64 v[106:107], v106
    v_rcp_f32 v244, v244
    v_pk_mul_f32 v[246:247], v[200:201], v[242:243]
    v_add_u32_sdwa v206, v9, v137 dst_sel:DWORD dst_unused:UNUSED_PAD src0_sel:WORD_0 src1_sel:WORD_0
    v_rcp_f32 v245, v245
    v_add_u32_sdwa v207, v9, v137 dst_sel:DWORD dst_unused:UNUSED_PAD src0_sel:WORD_1 src1_sel:WORD_1
    v_lshlrev_b32_sdwa v108, 3, v165 dst_sel:DWORD dst_unused:UNUSED_PAD src0_sel:DWORD src1_sel:WORD_0
    v_lshlrev_b32_sdwa v110, 3, v165 dst_sel:DWORD dst_unused:UNUSED_PAD src0_sel:DWORD src1_sel:WORD_1
    ds_read_b64 v[108:109], v108
    ds_read_b64 v[110:111], v110
    buffer_load_dwordx4 v[44:47], v71, s[12:15], s20 offen offset:1024 sc1
    s_waitcnt lgkmcnt(8)
    v_add3_u32 v10, v10, v88, v90
    v_add3_u32 v11, v11, v89, v91
    v_add3_u32 v10, v10, v92, v94
    v_add3_u32 v11, v11, v93, v95
    v_pk_fma_f32 v[246:247], v[202:203], v[244:245], v[246:247]
    v_pk_fma_f32 v[204:205], v[204:205], v[50:51], v[52:53]
    v_add_f32 v246, v246, v247
    v_pk_fma_f32 v[206:207], v[206:207], v[50:51], v[54:55]
    buffer_store_dword v246, v76, s[12:15], s35 offen offset:768 sc1
    v_lshlrev_b32_sdwa v88, 3, v166 dst_sel:DWORD dst_unused:UNUSED_PAD src0_sel:DWORD src1_sel:WORD_0
    v_lshlrev_b32_sdwa v90, 3, v166 dst_sel:DWORD dst_unused:UNUSED_PAD src0_sel:DWORD src1_sel:WORD_1
    ds_read_b64 v[88:89], v88
    ds_read_b64 v[90:91], v90
    v_pk_mul_f32 v[248:249], v[204:205], v[204:205]
    v_pk_mul_f32 v[250:251], v[206:207], v[206:207]
    v_pk_fma_f32 v[248:249], v[248:249], v[60:61], v[62:63]
    v_pk_fma_f32 v[250:251], v[250:251], v[60:61], v[62:63]
    v_pk_mul_f32 v[248:249], v[248:249], v[204:205]
    v_lshlrev_b32_sdwa v92, 3, v167 dst_sel:DWORD dst_unused:UNUSED_PAD src0_sel:DWORD src1_sel:WORD_0
    v_lshlrev_b32_sdwa v94, 3, v167 dst_sel:DWORD dst_unused:UNUSED_PAD src0_sel:DWORD src1_sel:WORD_1
    ds_read_b64 v[92:93], v92
    ds_read_b64 v[94:95], v94
    s_waitcnt lgkmcnt(8)
    v_add3_u32 v10, v10, v96, v98
    v_add3_u32 v11, v11, v97, v99
    v_add3_u32 v10, v10, v100, v102
    v_add3_u32 v11, v11, v101, v103
    v_exp_f32 v248, v248
    v_pk_mul_f32 v[250:251], v[250:251], v[206:207]
    v_exp_f32 v249, v249
    v_exp_f32 v250, v250
    v_exp_f32 v251, v251
    s_waitcnt vmcnt(12)
    v_lshlrev_b32_sdwa v96, 3, v168 dst_sel:DWORD dst_unused:UNUSED_PAD src0_sel:DWORD src1_sel:WORD_0
    v_lshlrev_b32_sdwa v98, 3, v168 dst_sel:DWORD dst_unused:UNUSED_PAD src0_sel:DWORD src1_sel:WORD_1
    ds_read_b64 v[96:97], v96
    ds_read_b64 v[98:99], v98
    v_pk_fma_f32 v[248:249], v[248:249], v[56:57], v[56:57]
    v_pk_fma_f32 v[250:251], v[250:251], v[58:59], v[58:59]
    v_rcp_f32 v248, v248
    v_rcp_f32 v249, v249
    v_rcp_f32 v250, v250
    v_lshlrev_b32_sdwa v100, 3, v169 dst_sel:DWORD dst_unused:UNUSED_PAD src0_sel:DWORD src1_sel:WORD_0
    v_lshlrev_b32_sdwa v102, 3, v169 dst_sel:DWORD dst_unused:UNUSED_PAD src0_sel:DWORD src1_sel:WORD_1
    ds_read_b64 v[100:101], v100
    ds_read_b64 v[102:103], v102
    buffer_load_dwordx4 v[148:151], v71, s[12:15], s32 offen offset:1024 sc1
    s_add_u32 s20, s20, 0xfffc0800
    buffer_load_dwordx4 v[36:39], v71, s[12:15], s20 offen offset:0 sc1
    s_waitcnt lgkmcnt(8)
    v_add3_u32 v10, v10, v104, v106
    v_add3_u32 v11, v11, v105, v107
    v_add3_u32 v10, v10, v108, v110
    v_add3_u32 v11, v11, v109, v111
    v_rcp_f32 v251, v251
    v_pk_mul_f32 v[252:253], v[204:205], v[248:249]
    v_lshlrev_b32_sdwa v104, 3, v170 dst_sel:DWORD dst_unused:UNUSED_PAD src0_sel:DWORD src1_sel:WORD_0
    v_lshlrev_b32_sdwa v106, 3, v170 dst_sel:DWORD dst_unused:UNUSED_PAD src0_sel:DWORD src1_sel:WORD_1
    ds_read_b64 v[104:105], v104
    ds_read_b64 v[106:107], v106
    v_pk_fma_f32 v[252:253], v[206:207], v[250:251], v[252:253]
    v_lshlrev_b32_sdwa v108, 3, v171 dst_sel:DWORD dst_unused:UNUSED_PAD src0_sel:DWORD src1_sel:WORD_0
    v_lshlrev_b32_sdwa v110, 3, v171 dst_sel:DWORD dst_unused:UNUSED_PAD src0_sel:DWORD src1_sel:WORD_1
    ds_read_b64 v[108:109], v108
    ds_read_b64 v[110:111], v110
    s_waitcnt lgkmcnt(8)
    v_add3_u32 v10, v10, v88, v90
    v_add3_u32 v11, v11, v89, v91
    v_add3_u32 v10, v10, v92, v94
    v_add3_u32 v11, v11, v93, v95
    v_add_f32 v252, v252, v253
    v_add_u32_sdwa v188, v10, v138 dst_sel:DWORD dst_unused:UNUSED_PAD src0_sel:WORD_0 src1_sel:WORD_0
    buffer_store_dword v252, v76, s[12:15], s35 offen offset:1024 sc1
    v_add_u32_sdwa v189, v10, v138 dst_sel:DWORD dst_unused:UNUSED_PAD src0_sel:WORD_1 src1_sel:WORD_1
    v_add_u32_sdwa v190, v11, v139 dst_sel:DWORD dst_unused:UNUSED_PAD src0_sel:WORD_0 src1_sel:WORD_0
    s_waitcnt vmcnt(13)
    v_lshlrev_b32_sdwa v88, 3, v172 dst_sel:DWORD dst_unused:UNUSED_PAD src0_sel:DWORD src1_sel:WORD_0
    v_lshlrev_b32_sdwa v90, 3, v172 dst_sel:DWORD dst_unused:UNUSED_PAD src0_sel:DWORD src1_sel:WORD_1
    ds_read_b64 v[88:89], v88
    ds_read_b64 v[90:91], v90
    v_add_u32_sdwa v191, v11, v139 dst_sel:DWORD dst_unused:UNUSED_PAD src0_sel:WORD_1 src1_sel:WORD_1
    v_pk_fma_f32 v[188:189], v[188:189], v[50:51], v[52:53]
    v_pk_fma_f32 v[190:191], v[190:191], v[50:51], v[54:55]
    v_pk_mul_f32 v[224:225], v[188:189], v[188:189]
    v_pk_mul_f32 v[226:227], v[190:191], v[190:191]
    v_lshlrev_b32_sdwa v92, 3, v173 dst_sel:DWORD dst_unused:UNUSED_PAD src0_sel:DWORD src1_sel:WORD_0
    v_lshlrev_b32_sdwa v94, 3, v173 dst_sel:DWORD dst_unused:UNUSED_PAD src0_sel:DWORD src1_sel:WORD_1
    ds_read_b64 v[92:93], v92
    ds_read_b64 v[94:95], v94
    s_add_u32 s20, s20, 0x40000
    buffer_load_dwordx4 v[120:123], v71, s[12:15], s20 offen offset:0 sc1
    s_waitcnt lgkmcnt(8)
    v_add3_u32 v12, v12, v96, v98
    v_add3_u32 v13, v13, v97, v99
    v_add3_u32 v12, v12, v100, v102
    v_add3_u32 v13, v13, v101, v103
    v_pk_fma_f32 v[224:225], v[224:225], v[60:61], v[62:63]
    v_pk_fma_f32 v[226:227], v[226:227], v[60:61], v[62:63]
    v_pk_mul_f32 v[224:225], v[224:225], v[188:189]
    v_pk_mul_f32 v[226:227], v[226:227], v[190:191]
    v_exp_f32 v224, v224
    v_lshlrev_b32_sdwa v96, 3, v174 dst_sel:DWORD dst_unused:UNUSED_PAD src0_sel:DWORD src1_sel:WORD_0
    v_lshlrev_b32_sdwa v98, 3, v174 dst_sel:DWORD dst_unused:UNUSED_PAD src0_sel:DWORD src1_sel:WORD_1
    ds_read_b64 v[96:97], v96
    ds_read_b64 v[98:99], v98
    v_exp_f32 v225, v225
    v_exp_f32 v226, v226
    v_exp_f32 v227, v227
    v_pk_fma_f32 v[224:225], v[224:225], v[56:57], v[56:57]
    v_lshlrev_b32_sdwa v100, 3, v175 dst_sel:DWORD dst_unused:UNUSED_PAD src0_sel:DWORD src1_sel:WORD_0
    v_lshlrev_b32_sdwa v102, 3, v175 dst_sel:DWORD dst_unused:UNUSED_PAD src0_sel:DWORD src1_sel:WORD_1
    ds_read_b64 v[100:101], v100
    ds_read_b64 v[102:103], v102
    s_waitcnt lgkmcnt(8)
    v_add3_u32 v12, v12, v104, v106
    v_add3_u32 v13, v13, v105, v107
    v_add3_u32 v12, v12, v108, v110
    v_add3_u32 v13, v13, v109, v111
    v_rcp_f32 v224, v224
    v_pk_fma_f32 v[226:227], v[226:227], v[58:59], v[58:59]
    v_add_u32_sdwa v192, v12, v140 dst_sel:DWORD dst_unused:UNUSED_PAD src0_sel:WORD_0 src1_sel:WORD_0
    v_rcp_f32 v225, v225
    v_add_u32_sdwa v193, v12, v140 dst_sel:DWORD dst_unused:UNUSED_PAD src0_sel:WORD_1 src1_sel:WORD_1
    s_waitcnt vmcnt(12)
    v_lshlrev_b32_sdwa v104, 3, v32 dst_sel:DWORD dst_unused:UNUSED_PAD src0_sel:DWORD src1_sel:WORD_0
    v_lshlrev_b32_sdwa v106, 3, v32 dst_sel:DWORD dst_unused:UNUSED_PAD src0_sel:DWORD src1_sel:WORD_1
    ds_read_b64 v[104:105], v104
    ds_read_b64 v[106:107], v106
    v_rcp_f32 v226, v226
    v_pk_mul_f32 v[228:229], v[188:189], v[224:225]
    v_add_u32_sdwa v194, v13, v141 dst_sel:DWORD dst_unused:UNUSED_PAD src0_sel:WORD_0 src1_sel:WORD_0
    v_rcp_f32 v227, v227
    v_add_u32_sdwa v195, v13, v141 dst_sel:DWORD dst_unused:UNUSED_PAD src0_sel:WORD_1 src1_sel:WORD_1
    v_lshlrev_b32_sdwa v108, 3, v33 dst_sel:DWORD dst_unused:UNUSED_PAD src0_sel:DWORD src1_sel:WORD_0
    v_lshlrev_b32_sdwa v110, 3, v33 dst_sel:DWORD dst_unused:UNUSED_PAD src0_sel:DWORD src1_sel:WORD_1
    ds_read_b64 v[108:109], v108
    ds_read_b64 v[110:111], v110
    buffer_load_dwordx4 v[160:163], v71, s[12:15], s20 offen offset:1024 sc1
    s_waitcnt lgkmcnt(8)
    v_add3_u32 v14, v14, v88, v90
    v_add3_u32 v15, v15, v89, v91
    v_add3_u32 v14, v14, v92, v94
    v_add3_u32 v15, v15, v93, v95
    s_setprio 2
    v_pk_fma_f32 v[228:229], v[190:191], v[226:227], v[228:229]
    v_pk_fma_f32 v[192:193], v[192:193], v[50:51], v[52:53]
    v_add_f32 v228, v228, v229
    v_pk_fma_f32 v[194:195], v[194:195], v[50:51], v[54:55]
    buffer_store_dword v228, v76, s[12:15], s35 offen offset:1280 sc1
    v_lshlrev_b32_sdwa v88, 3, v34 dst_sel:DWORD dst_unused:UNUSED_PAD src0_sel:DWORD src1_sel:WORD_0
    v_lshlrev_b32_sdwa v90, 3, v34 dst_sel:DWORD dst_unused:UNUSED_PAD src0_sel:DWORD src1_sel:WORD_1
    ds_read_b64 v[88:89], v88
    ds_read_b64 v[90:91], v90
    v_pk_mul_f32 v[230:231], v[192:193], v[192:193]
    v_pk_mul_f32 v[232:233], v[194:195], v[194:195]
    v_pk_fma_f32 v[230:231], v[230:231], v[60:61], v[62:63]
    v_pk_fma_f32 v[232:233], v[232:233], v[60:61], v[62:63]
    v_pk_mul_f32 v[230:231], v[230:231], v[192:193]
    v_lshlrev_b32_sdwa v92, 3, v35 dst_sel:DWORD dst_unused:UNUSED_PAD src0_sel:DWORD src1_sel:WORD_0
    v_lshlrev_b32_sdwa v94, 3, v35 dst_sel:DWORD dst_unused:UNUSED_PAD src0_sel:DWORD src1_sel:WORD_1
    ds_read_b64 v[92:93], v92
    ds_read_b64 v[94:95], v94
    s_waitcnt lgkmcnt(8)
    v_add3_u32 v14, v14, v96, v98
    v_add3_u32 v15, v15, v97, v99
    v_add3_u32 v14, v14, v100, v102
    v_add3_u32 v15, v15, v101, v103
    v_exp_f32 v230, v230
    v_pk_mul_f32 v[232:233], v[232:233], v[194:195]
    v_exp_f32 v231, v231
    v_exp_f32 v232, v232
    v_exp_f32 v233, v233
    s_waitcnt vmcnt(13)
    v_lshlrev_b32_sdwa v96, 3, v40 dst_sel:DWORD dst_unused:UNUSED_PAD src0_sel:DWORD src1_sel:WORD_0
    v_lshlrev_b32_sdwa v98, 3, v40 dst_sel:DWORD dst_unused:UNUSED_PAD src0_sel:DWORD src1_sel:WORD_1
    ds_read_b64 v[96:97], v96
    ds_read_b64 v[98:99], v98
    v_pk_fma_f32 v[230:231], v[230:231], v[56:57], v[56:57]
    v_pk_fma_f32 v[232:233], v[232:233], v[58:59], v[58:59]
    v_rcp_f32 v230, v230
    v_rcp_f32 v231, v231
    v_rcp_f32 v232, v232
    v_lshlrev_b32_sdwa v100, 3, v41 dst_sel:DWORD dst_unused:UNUSED_PAD src0_sel:DWORD src1_sel:WORD_0
    v_lshlrev_b32_sdwa v102, 3, v41 dst_sel:DWORD dst_unused:UNUSED_PAD src0_sel:DWORD src1_sel:WORD_1
    ds_read_b64 v[100:101], v100
    ds_read_b64 v[102:103], v102
    buffer_load_dwordx4 v[152:155], v71, s[12:15], s32 offen offset:2048 sc1
    s_add_u32 s20, s20, 0xfffc0800
    buffer_load_dwordx4 v[164:167], v71, s[12:15], s20 offen offset:0 sc1
    s_waitcnt lgkmcnt(8)
    v_add3_u32 v14, v14, v104, v106
    v_add3_u32 v15, v15, v105, v107
    v_add3_u32 v14, v14, v108, v110
    v_add3_u32 v15, v15, v109, v111
    v_rcp_f32 v233, v233
    v_pk_mul_f32 v[234:235], v[192:193], v[230:231]
    v_lshlrev_b32_sdwa v104, 3, v42 dst_sel:DWORD dst_unused:UNUSED_PAD src0_sel:DWORD src1_sel:WORD_0
    v_lshlrev_b32_sdwa v106, 3, v42 dst_sel:DWORD dst_unused:UNUSED_PAD src0_sel:DWORD src1_sel:WORD_1
    ds_read_b64 v[104:105], v104
    ds_read_b64 v[106:107], v106
    v_pk_fma_f32 v[234:235], v[194:195], v[232:233], v[234:235]
    v_lshlrev_b32_sdwa v108, 3, v43 dst_sel:DWORD dst_unused:UNUSED_PAD src0_sel:DWORD src1_sel:WORD_0
    v_lshlrev_b32_sdwa v110, 3, v43 dst_sel:DWORD dst_unused:UNUSED_PAD src0_sel:DWORD src1_sel:WORD_1
    ds_read_b64 v[108:109], v108
    ds_read_b64 v[110:111], v110
    s_waitcnt lgkmcnt(8)
    v_add3_u32 v14, v14, v88, v90
    v_add3_u32 v15, v15, v89, v91
    v_add3_u32 v14, v14, v92, v94
    v_add3_u32 v15, v15, v93, v95
    v_add_f32 v234, v234, v235
    v_add_u32_sdwa v196, v14, v142 dst_sel:DWORD dst_unused:UNUSED_PAD src0_sel:WORD_0 src1_sel:WORD_0
    buffer_store_dword v234, v76, s[12:15], s35 offen offset:1536 sc1
    v_add_u32_sdwa v197, v14, v142 dst_sel:DWORD dst_unused:UNUSED_PAD src0_sel:WORD_1 src1_sel:WORD_1
    v_add_u32_sdwa v198, v15, v143 dst_sel:DWORD dst_unused:UNUSED_PAD src0_sel:WORD_0 src1_sel:WORD_0
    s_waitcnt vmcnt(13)
    v_lshlrev_b32_sdwa v88, 3, v124 dst_sel:DWORD dst_unused:UNUSED_PAD src0_sel:DWORD src1_sel:WORD_0
    v_lshlrev_b32_sdwa v90, 3, v124 dst_sel:DWORD dst_unused:UNUSED_PAD src0_sel:DWORD src1_sel:WORD_1
    ds_read_b64 v[88:89], v88
    ds_read_b64 v[90:91], v90
    v_add_u32_sdwa v199, v15, v143 dst_sel:DWORD dst_unused:UNUSED_PAD src0_sel:WORD_1 src1_sel:WORD_1
    v_pk_fma_f32 v[196:197], v[196:197], v[50:51], v[52:53]
    v_pk_fma_f32 v[198:199], v[198:199], v[50:51], v[54:55]
    v_pk_mul_f32 v[236:237], v[196:197], v[196:197]
    v_pk_mul_f32 v[238:239], v[198:199], v[198:199]
    v_lshlrev_b32_sdwa v92, 3, v125 dst_sel:DWORD dst_unused:UNUSED_PAD src0_sel:DWORD src1_sel:WORD_0
    v_lshlrev_b32_sdwa v94, 3, v125 dst_sel:DWORD dst_unused:UNUSED_PAD src0_sel:DWORD src1_sel:WORD_1
    ds_read_b64 v[92:93], v92
    ds_read_b64 v[94:95], v94
    s_add_u32 s20, s20, 0x40000
    buffer_load_dwordx4 v[168:171], v71, s[12:15], s20 offen offset:0 sc1
    s_waitcnt lgkmcnt(8)
    v_add3_u32 v16, v16, v96, v98
    v_add3_u32 v17, v17, v97, v99
    v_add3_u32 v16, v16, v100, v102
    v_add3_u32 v17, v17, v101, v103
    v_pk_fma_f32 v[236:237], v[236:237], v[60:61], v[62:63]
    v_pk_fma_f32 v[238:239], v[238:239], v[60:61], v[62:63]
    v_pk_mul_f32 v[236:237], v[236:237], v[196:197]
    v_pk_mul_f32 v[238:239], v[238:239], v[198:199]
    v_exp_f32 v236, v236
    v_lshlrev_b32_sdwa v96, 3, v126 dst_sel:DWORD dst_unused:UNUSED_PAD src0_sel:DWORD src1_sel:WORD_0
    v_lshlrev_b32_sdwa v98, 3, v126 dst_sel:DWORD dst_unused:UNUSED_PAD src0_sel:DWORD src1_sel:WORD_1
    ds_read_b64 v[96:97], v96
    ds_read_b64 v[98:99], v98
    v_exp_f32 v237, v237
    v_exp_f32 v238, v238
    v_exp_f32 v239, v239
    v_pk_fma_f32 v[236:237], v[236:237], v[56:57], v[56:57]
    v_lshlrev_b32_sdwa v100, 3, v127 dst_sel:DWORD dst_unused:UNUSED_PAD src0_sel:DWORD src1_sel:WORD_0
    v_lshlrev_b32_sdwa v102, 3, v127 dst_sel:DWORD dst_unused:UNUSED_PAD src0_sel:DWORD src1_sel:WORD_1
    ds_read_b64 v[100:101], v100
    ds_read_b64 v[102:103], v102
    s_waitcnt lgkmcnt(8)
    v_add3_u32 v16, v16, v104, v106
    v_add3_u32 v17, v17, v105, v107
    v_add3_u32 v16, v16, v108, v110
    v_add3_u32 v17, v17, v109, v111
    v_rcp_f32 v236, v236
    v_pk_fma_f32 v[238:239], v[238:239], v[58:59], v[58:59]
    v_add_u32_sdwa v200, v16, v144 dst_sel:DWORD dst_unused:UNUSED_PAD src0_sel:WORD_0 src1_sel:WORD_0
    v_rcp_f32 v237, v237
    v_add_u32_sdwa v201, v16, v144 dst_sel:DWORD dst_unused:UNUSED_PAD src0_sel:WORD_1 src1_sel:WORD_1
    s_waitcnt vmcnt(12)
    v_lshlrev_b32_sdwa v104, 3, v116 dst_sel:DWORD dst_unused:UNUSED_PAD src0_sel:DWORD src1_sel:WORD_0
    v_lshlrev_b32_sdwa v106, 3, v116 dst_sel:DWORD dst_unused:UNUSED_PAD src0_sel:DWORD src1_sel:WORD_1
    ds_read_b64 v[104:105], v104
    ds_read_b64 v[106:107], v106
    v_rcp_f32 v238, v238
    v_pk_mul_f32 v[240:241], v[196:197], v[236:237]
    v_add_u32_sdwa v202, v17, v145 dst_sel:DWORD dst_unused:UNUSED_PAD src0_sel:WORD_0 src1_sel:WORD_0
    v_rcp_f32 v239, v239
    v_add_u32_sdwa v203, v17, v145 dst_sel:DWORD dst_unused:UNUSED_PAD src0_sel:WORD_1 src1_sel:WORD_1
    v_lshlrev_b32_sdwa v108, 3, v117 dst_sel:DWORD dst_unused:UNUSED_PAD src0_sel:DWORD src1_sel:WORD_0
    v_lshlrev_b32_sdwa v110, 3, v117 dst_sel:DWORD dst_unused:UNUSED_PAD src0_sel:DWORD src1_sel:WORD_1
    ds_read_b64 v[108:109], v108
    ds_read_b64 v[110:111], v110
    buffer_load_dwordx4 v[172:175], v71, s[12:15], s20 offen offset:1024 sc1
    s_waitcnt lgkmcnt(8)
    v_add3_u32 v18, v18, v88, v90
    v_add3_u32 v19, v19, v89, v91
    v_add3_u32 v18, v18, v92, v94
    v_add3_u32 v19, v19, v93, v95
    v_pk_fma_f32 v[240:241], v[198:199], v[238:239], v[240:241]
    v_pk_fma_f32 v[200:201], v[200:201], v[50:51], v[52:53]
    v_add_f32 v240, v240, v241
    v_pk_fma_f32 v[202:203], v[202:203], v[50:51], v[54:55]
    buffer_store_dword v240, v76, s[12:15], s35 offen offset:1792 sc1
    v_lshlrev_b32_sdwa v88, 3, v118 dst_sel:DWORD dst_unused:UNUSED_PAD src0_sel:DWORD src1_sel:WORD_0
    v_lshlrev_b32_sdwa v90, 3, v118 dst_sel:DWORD dst_unused:UNUSED_PAD src0_sel:DWORD src1_sel:WORD_1
    ds_read_b64 v[88:89], v88
    ds_read_b64 v[90:91], v90
    v_pk_mul_f32 v[242:243], v[200:201], v[200:201]
    v_pk_mul_f32 v[244:245], v[202:203], v[202:203]
    v_pk_fma_f32 v[242:243], v[242:243], v[60:61], v[62:63]
    v_pk_fma_f32 v[244:245], v[244:245], v[60:61], v[62:63]
    v_pk_mul_f32 v[242:243], v[242:243], v[200:201]
    v_lshlrev_b32_sdwa v92, 3, v119 dst_sel:DWORD dst_unused:UNUSED_PAD src0_sel:DWORD src1_sel:WORD_0
    v_lshlrev_b32_sdwa v94, 3, v119 dst_sel:DWORD dst_unused:UNUSED_PAD src0_sel:DWORD src1_sel:WORD_1
    ds_read_b64 v[92:93], v92
    ds_read_b64 v[94:95], v94
    s_waitcnt lgkmcnt(8)
    v_add3_u32 v18, v18, v96, v98
    v_add3_u32 v19, v19, v97, v99
    v_add3_u32 v18, v18, v100, v102
    v_add3_u32 v19, v19, v101, v103
    v_exp_f32 v242, v242
    v_pk_mul_f32 v[244:245], v[244:245], v[202:203]
    v_exp_f32 v243, v243
    v_exp_f32 v244, v244
    v_exp_f32 v245, v245
    s_waitcnt vmcnt(13)
    v_lshlrev_b32_sdwa v96, 3, v44 dst_sel:DWORD dst_unused:UNUSED_PAD src0_sel:DWORD src1_sel:WORD_0
    v_lshlrev_b32_sdwa v98, 3, v44 dst_sel:DWORD dst_unused:UNUSED_PAD src0_sel:DWORD src1_sel:WORD_1
    ds_read_b64 v[96:97], v96
    ds_read_b64 v[98:99], v98
    v_pk_fma_f32 v[242:243], v[242:243], v[56:57], v[56:57]
    v_pk_fma_f32 v[244:245], v[244:245], v[58:59], v[58:59]
    v_rcp_f32 v242, v242
    v_rcp_f32 v243, v243
    v_rcp_f32 v244, v244
    v_lshlrev_b32_sdwa v100, 3, v45 dst_sel:DWORD dst_unused:UNUSED_PAD src0_sel:DWORD src1_sel:WORD_0
    v_lshlrev_b32_sdwa v102, 3, v45 dst_sel:DWORD dst_unused:UNUSED_PAD src0_sel:DWORD src1_sel:WORD_1
    ds_read_b64 v[100:101], v100
    ds_read_b64 v[102:103], v102
    buffer_load_dwordx4 v[156:159], v71, s[12:15], s32 offen offset:3072 sc1
    s_add_u32 s20, s20, 0xfffc0800
    buffer_load_dwordx4 v[32:35], v71, s[12:15], s20 offen offset:0 sc1
    s_waitcnt lgkmcnt(8)
    v_add3_u32 v18, v18, v104, v106
    v_add3_u32 v19, v19, v105, v107
    v_add3_u32 v18, v18, v108, v110
    v_add3_u32 v19, v19, v109, v111
    v_rcp_f32 v245, v245
    v_pk_mul_f32 v[246:247], v[200:201], v[242:243]
    v_lshlrev_b32_sdwa v104, 3, v46 dst_sel:DWORD dst_unused:UNUSED_PAD src0_sel:DWORD src1_sel:WORD_0
    v_lshlrev_b32_sdwa v106, 3, v46 dst_sel:DWORD dst_unused:UNUSED_PAD src0_sel:DWORD src1_sel:WORD_1
    ds_read_b64 v[104:105], v104
    ds_read_b64 v[106:107], v106
    v_pk_fma_f32 v[246:247], v[202:203], v[244:245], v[246:247]
    v_lshlrev_b32_sdwa v108, 3, v47 dst_sel:DWORD dst_unused:UNUSED_PAD src0_sel:DWORD src1_sel:WORD_0
    v_lshlrev_b32_sdwa v110, 3, v47 dst_sel:DWORD dst_unused:UNUSED_PAD src0_sel:DWORD src1_sel:WORD_1
    ds_read_b64 v[108:109], v108
    ds_read_b64 v[110:111], v110
    s_waitcnt lgkmcnt(8)
    v_add3_u32 v18, v18, v88, v90
    v_add3_u32 v19, v19, v89, v91
    v_add3_u32 v18, v18, v92, v94
    v_add3_u32 v19, v19, v93, v95
    v_add_f32 v246, v246, v247
    v_add_u32_sdwa v204, v18, v146 dst_sel:DWORD dst_unused:UNUSED_PAD src0_sel:WORD_0 src1_sel:WORD_0
    buffer_store_dword v246, v76, s[12:15], s35 offen offset:2048 sc1
    v_add_u32_sdwa v205, v18, v146 dst_sel:DWORD dst_unused:UNUSED_PAD src0_sel:WORD_1 src1_sel:WORD_1
    v_add_u32_sdwa v206, v19, v147 dst_sel:DWORD dst_unused:UNUSED_PAD src0_sel:WORD_0 src1_sel:WORD_0
    s_waitcnt vmcnt(13)
    v_lshlrev_b32_sdwa v88, 3, v36 dst_sel:DWORD dst_unused:UNUSED_PAD src0_sel:DWORD src1_sel:WORD_0
    v_lshlrev_b32_sdwa v90, 3, v36 dst_sel:DWORD dst_unused:UNUSED_PAD src0_sel:DWORD src1_sel:WORD_1
    ds_read_b64 v[88:89], v88
    ds_read_b64 v[90:91], v90
    v_add_u32_sdwa v207, v19, v147 dst_sel:DWORD dst_unused:UNUSED_PAD src0_sel:WORD_1 src1_sel:WORD_1
    v_pk_fma_f32 v[204:205], v[204:205], v[50:51], v[52:53]
    v_pk_fma_f32 v[206:207], v[206:207], v[50:51], v[54:55]
    v_pk_mul_f32 v[248:249], v[204:205], v[204:205]
    v_pk_mul_f32 v[250:251], v[206:207], v[206:207]
    v_lshlrev_b32_sdwa v92, 3, v37 dst_sel:DWORD dst_unused:UNUSED_PAD src0_sel:DWORD src1_sel:WORD_0
    v_lshlrev_b32_sdwa v94, 3, v37 dst_sel:DWORD dst_unused:UNUSED_PAD src0_sel:DWORD src1_sel:WORD_1
    ds_read_b64 v[92:93], v92
    ds_read_b64 v[94:95], v94
    s_add_u32 s20, s20, 0x40000
    buffer_load_dwordx4 v[40:43], v71, s[12:15], s20 offen offset:0 sc1
    s_waitcnt lgkmcnt(8)
    v_add3_u32 v20, v20, v96, v98
    v_add3_u32 v21, v21, v97, v99
    v_add3_u32 v20, v20, v100, v102
    v_add3_u32 v21, v21, v101, v103
    v_pk_fma_f32 v[248:249], v[248:249], v[60:61], v[62:63]
    v_pk_fma_f32 v[250:251], v[250:251], v[60:61], v[62:63]
    v_pk_mul_f32 v[248:249], v[248:249], v[204:205]
    v_pk_mul_f32 v[250:251], v[250:251], v[206:207]
    v_exp_f32 v248, v248
    v_lshlrev_b32_sdwa v96, 3, v38 dst_sel:DWORD dst_unused:UNUSED_PAD src0_sel:DWORD src1_sel:WORD_0
    v_lshlrev_b32_sdwa v98, 3, v38 dst_sel:DWORD dst_unused:UNUSED_PAD src0_sel:DWORD src1_sel:WORD_1
    ds_read_b64 v[96:97], v96
    ds_read_b64 v[98:99], v98
    v_exp_f32 v249, v249
    v_exp_f32 v250, v250
    v_exp_f32 v251, v251
    v_pk_fma_f32 v[248:249], v[248:249], v[56:57], v[56:57]
    v_lshlrev_b32_sdwa v100, 3, v39 dst_sel:DWORD dst_unused:UNUSED_PAD src0_sel:DWORD src1_sel:WORD_0
    v_lshlrev_b32_sdwa v102, 3, v39 dst_sel:DWORD dst_unused:UNUSED_PAD src0_sel:DWORD src1_sel:WORD_1
    ds_read_b64 v[100:101], v100
    ds_read_b64 v[102:103], v102
    s_waitcnt lgkmcnt(8)
    v_add3_u32 v20, v20, v104, v106
    v_add3_u32 v21, v21, v105, v107
    v_add3_u32 v20, v20, v108, v110
    v_add3_u32 v21, v21, v109, v111
    v_rcp_f32 v248, v248
    v_pk_fma_f32 v[250:251], v[250:251], v[58:59], v[58:59]
    v_add_u32_sdwa v188, v20, v148 dst_sel:DWORD dst_unused:UNUSED_PAD src0_sel:WORD_0 src1_sel:WORD_0
    v_rcp_f32 v249, v249
    v_add_u32_sdwa v189, v20, v148 dst_sel:DWORD dst_unused:UNUSED_PAD src0_sel:WORD_1 src1_sel:WORD_1
    s_waitcnt vmcnt(12)
    v_lshlrev_b32_sdwa v104, 3, v120 dst_sel:DWORD dst_unused:UNUSED_PAD src0_sel:DWORD src1_sel:WORD_0
    v_lshlrev_b32_sdwa v106, 3, v120 dst_sel:DWORD dst_unused:UNUSED_PAD src0_sel:DWORD src1_sel:WORD_1
    ds_read_b64 v[104:105], v104
    ds_read_b64 v[106:107], v106
    v_rcp_f32 v250, v250
    v_pk_mul_f32 v[252:253], v[204:205], v[248:249]
    v_add_u32_sdwa v190, v21, v149 dst_sel:DWORD dst_unused:UNUSED_PAD src0_sel:WORD_0 src1_sel:WORD_0
    v_rcp_f32 v251, v251
    v_add_u32_sdwa v191, v21, v149 dst_sel:DWORD dst_unused:UNUSED_PAD src0_sel:WORD_1 src1_sel:WORD_1
    v_lshlrev_b32_sdwa v108, 3, v121 dst_sel:DWORD dst_unused:UNUSED_PAD src0_sel:DWORD src1_sel:WORD_0
    v_lshlrev_b32_sdwa v110, 3, v121 dst_sel:DWORD dst_unused:UNUSED_PAD src0_sel:DWORD src1_sel:WORD_1
    ds_read_b64 v[108:109], v108
    ds_read_b64 v[110:111], v110
    s_waitcnt lgkmcnt(8)
    v_add3_u32 v22, v22, v88, v90
    v_add3_u32 v23, v23, v89, v91
    v_add3_u32 v22, v22, v92, v94
    v_add3_u32 v23, v23, v93, v95
    v_pk_fma_f32 v[252:253], v[206:207], v[250:251], v[252:253]
    v_pk_fma_f32 v[188:189], v[188:189], v[50:51], v[52:53]
    v_add_f32 v252, v252, v253
    v_pk_fma_f32 v[190:191], v[190:191], v[50:51], v[54:55]
    buffer_store_dword v252, v76, s[12:15], s35 offen offset:2304 sc1
    v_lshlrev_b32_sdwa v88, 3, v122 dst_sel:DWORD dst_unused:UNUSED_PAD src0_sel:DWORD src1_sel:WORD_0
    v_lshlrev_b32_sdwa v90, 3, v122 dst_sel:DWORD dst_unused:UNUSED_PAD src0_sel:DWORD src1_sel:WORD_1
    ds_read_b64 v[88:89], v88
    ds_read_b64 v[90:91], v90
    v_pk_mul_f32 v[224:225], v[188:189], v[188:189]
    v_pk_mul_f32 v[226:227], v[190:191], v[190:191]
    v_pk_fma_f32 v[224:225], v[224:225], v[60:61], v[62:63]
    v_pk_fma_f32 v[226:227], v[226:227], v[60:61], v[62:63]
    v_pk_mul_f32 v[224:225], v[224:225], v[188:189]
    v_lshlrev_b32_sdwa v92, 3, v123 dst_sel:DWORD dst_unused:UNUSED_PAD src0_sel:DWORD src1_sel:WORD_0
    v_lshlrev_b32_sdwa v94, 3, v123 dst_sel:DWORD dst_unused:UNUSED_PAD src0_sel:DWORD src1_sel:WORD_1
    ds_read_b64 v[92:93], v92
    ds_read_b64 v[94:95], v94
    s_waitcnt lgkmcnt(8)
    v_add3_u32 v22, v22, v96, v98
    v_add3_u32 v23, v23, v97, v99
    v_add3_u32 v22, v22, v100, v102
    v_add3_u32 v23, v23, v101, v103
    v_exp_f32 v224, v224
    v_pk_mul_f32 v[226:227], v[226:227], v[190:191]
    v_exp_f32 v225, v225
    v_exp_f32 v226, v226
    v_exp_f32 v227, v227
    s_waitcnt vmcnt(12)
    v_lshlrev_b32_sdwa v96, 3, v160 dst_sel:DWORD dst_unused:UNUSED_PAD src0_sel:DWORD src1_sel:WORD_0
    v_lshlrev_b32_sdwa v98, 3, v160 dst_sel:DWORD dst_unused:UNUSED_PAD src0_sel:DWORD src1_sel:WORD_1
    ds_read_b64 v[96:97], v96
    ds_read_b64 v[98:99], v98
    v_pk_fma_f32 v[224:225], v[224:225], v[56:57], v[56:57]
    v_pk_fma_f32 v[226:227], v[226:227], v[58:59], v[58:59]
    v_rcp_f32 v224, v224
    v_rcp_f32 v225, v225
    v_rcp_f32 v226, v226
    v_lshlrev_b32_sdwa v100, 3, v161 dst_sel:DWORD dst_unused:UNUSED_PAD src0_sel:DWORD src1_sel:WORD_0
    v_lshlrev_b32_sdwa v102, 3, v161 dst_sel:DWORD dst_unused:UNUSED_PAD src0_sel:DWORD src1_sel:WORD_1
    ds_read_b64 v[100:101], v100
    ds_read_b64 v[102:103], v102
    s_waitcnt lgkmcnt(8)
    v_add3_u32 v22, v22, v104, v106
    v_add3_u32 v23, v23, v105, v107
    v_add3_u32 v22, v22, v108, v110
    v_add3_u32 v23, v23, v109, v111
    v_rcp_f32 v227, v227
    v_pk_mul_f32 v[228:229], v[188:189], v[224:225]
    v_lshlrev_b32_sdwa v104, 3, v162 dst_sel:DWORD dst_unused:UNUSED_PAD src0_sel:DWORD src1_sel:WORD_0
    v_lshlrev_b32_sdwa v106, 3, v162 dst_sel:DWORD dst_unused:UNUSED_PAD src0_sel:DWORD src1_sel:WORD_1
    ds_read_b64 v[104:105], v104
    ds_read_b64 v[106:107], v106
    v_pk_fma_f32 v[228:229], v[190:191], v[226:227], v[228:229]
    v_lshlrev_b32_sdwa v108, 3, v163 dst_sel:DWORD dst_unused:UNUSED_PAD src0_sel:DWORD src1_sel:WORD_0
    v_lshlrev_b32_sdwa v110, 3, v163 dst_sel:DWORD dst_unused:UNUSED_PAD src0_sel:DWORD src1_sel:WORD_1
    ds_read_b64 v[108:109], v108
    ds_read_b64 v[110:111], v110
    s_waitcnt lgkmcnt(8)
    v_add3_u32 v22, v22, v88, v90
    v_add3_u32 v23, v23, v89, v91
    v_add3_u32 v22, v22, v92, v94
    v_add3_u32 v23, v23, v93, v95
    v_add_f32 v228, v228, v229
    v_add_u32_sdwa v192, v22, v150 dst_sel:DWORD dst_unused:UNUSED_PAD src0_sel:WORD_0 src1_sel:WORD_0
    buffer_store_dword v228, v76, s[12:15], s35 offen offset:2560 sc1
    v_add_u32_sdwa v193, v22, v150 dst_sel:DWORD dst_unused:UNUSED_PAD src0_sel:WORD_1 src1_sel:WORD_1
    v_add_u32_sdwa v194, v23, v151 dst_sel:DWORD dst_unused:UNUSED_PAD src0_sel:WORD_0 src1_sel:WORD_0
    s_waitcnt vmcnt(10)
    v_lshlrev_b32_sdwa v88, 3, v164 dst_sel:DWORD dst_unused:UNUSED_PAD src0_sel:DWORD src1_sel:WORD_0
    v_lshlrev_b32_sdwa v90, 3, v164 dst_sel:DWORD dst_unused:UNUSED_PAD src0_sel:DWORD src1_sel:WORD_1
    ds_read_b64 v[88:89], v88
    ds_read_b64 v[90:91], v90
    v_add_u32_sdwa v195, v23, v151 dst_sel:DWORD dst_unused:UNUSED_PAD src0_sel:WORD_1 src1_sel:WORD_1
    v_pk_fma_f32 v[192:193], v[192:193], v[50:51], v[52:53]
    v_pk_fma_f32 v[194:195], v[194:195], v[50:51], v[54:55]
    v_pk_mul_f32 v[230:231], v[192:193], v[192:193]
    v_pk_mul_f32 v[232:233], v[194:195], v[194:195]
    v_lshlrev_b32_sdwa v92, 3, v165 dst_sel:DWORD dst_unused:UNUSED_PAD src0_sel:DWORD src1_sel:WORD_0
    v_lshlrev_b32_sdwa v94, 3, v165 dst_sel:DWORD dst_unused:UNUSED_PAD src0_sel:DWORD src1_sel:WORD_1
    ds_read_b64 v[92:93], v92
    ds_read_b64 v[94:95], v94
    s_waitcnt lgkmcnt(8)
    v_add3_u32 v24, v24, v96, v98
    v_add3_u32 v25, v25, v97, v99
    v_add3_u32 v24, v24, v100, v102
    v_add3_u32 v25, v25, v101, v103
    s_setprio 1
    v_pk_fma_f32 v[230:231], v[230:231], v[60:61], v[62:63]
    v_pk_fma_f32 v[232:233], v[232:233], v[60:61], v[62:63]
    v_pk_mul_f32 v[230:231], v[230:231], v[192:193]
    v_pk_mul_f32 v[232:233], v[232:233], v[194:195]
    v_exp_f32 v230, v230
    v_lshlrev_b32_sdwa v96, 3, v166 dst_sel:DWORD dst_unused:UNUSED_PAD src0_sel:DWORD src1_sel:WORD_0
    v_lshlrev_b32_sdwa v98, 3, v166 dst_sel:DWORD dst_unused:UNUSED_PAD src0_sel:DWORD src1_sel:WORD_1
    ds_read_b64 v[96:97], v96
    ds_read_b64 v[98:99], v98
    v_exp_f32 v231, v231
    v_exp_f32 v232, v232
    v_exp_f32 v233, v233
    v_pk_fma_f32 v[230:231], v[230:231], v[56:57], v[56:57]
    v_lshlrev_b32_sdwa v100, 3, v167 dst_sel:DWORD dst_unused:UNUSED_PAD src0_sel:DWORD src1_sel:WORD_0
    v_lshlrev_b32_sdwa v102, 3, v167 dst_sel:DWORD dst_unused:UNUSED_PAD src0_sel:DWORD src1_sel:WORD_1
    ds_read_b64 v[100:101], v100
    ds_read_b64 v[102:103], v102
    s_waitcnt lgkmcnt(8)
    v_add3_u32 v24, v24, v104, v106
    v_add3_u32 v25, v25, v105, v107
    v_add3_u32 v24, v24, v108, v110
    v_add3_u32 v25, v25, v109, v111
    v_rcp_f32 v230, v230
    v_pk_fma_f32 v[232:233], v[232:233], v[58:59], v[58:59]
    v_add_u32_sdwa v196, v24, v152 dst_sel:DWORD dst_unused:UNUSED_PAD src0_sel:WORD_0 src1_sel:WORD_0
    v_rcp_f32 v231, v231
    v_add_u32_sdwa v197, v24, v152 dst_sel:DWORD dst_unused:UNUSED_PAD src0_sel:WORD_1 src1_sel:WORD_1
    s_waitcnt vmcnt(8)
    v_lshlrev_b32_sdwa v104, 3, v168 dst_sel:DWORD dst_unused:UNUSED_PAD src0_sel:DWORD src1_sel:WORD_0
    v_lshlrev_b32_sdwa v106, 3, v168 dst_sel:DWORD dst_unused:UNUSED_PAD src0_sel:DWORD src1_sel:WORD_1
    ds_read_b64 v[104:105], v104
    ds_read_b64 v[106:107], v106
    v_rcp_f32 v232, v232
    v_pk_mul_f32 v[234:235], v[192:193], v[230:231]
    v_add_u32_sdwa v198, v25, v153 dst_sel:DWORD dst_unused:UNUSED_PAD src0_sel:WORD_0 src1_sel:WORD_0
    v_rcp_f32 v233, v233
    v_add_u32_sdwa v199, v25, v153 dst_sel:DWORD dst_unused:UNUSED_PAD src0_sel:WORD_1 src1_sel:WORD_1
    v_lshlrev_b32_sdwa v108, 3, v169 dst_sel:DWORD dst_unused:UNUSED_PAD src0_sel:DWORD src1_sel:WORD_0
    v_lshlrev_b32_sdwa v110, 3, v169 dst_sel:DWORD dst_unused:UNUSED_PAD src0_sel:DWORD src1_sel:WORD_1
    ds_read_b64 v[108:109], v108
    ds_read_b64 v[110:111], v110
    s_waitcnt lgkmcnt(8)
    v_add3_u32 v26, v26, v88, v90
    v_add3_u32 v27, v27, v89, v91
    v_add3_u32 v26, v26, v92, v94
    v_add3_u32 v27, v27, v93, v95
    v_pk_fma_f32 v[234:235], v[194:195], v[232:233], v[234:235]
    v_pk_fma_f32 v[196:197], v[196:197], v[50:51], v[52:53]
    v_add_f32 v234, v234, v235
    v_pk_fma_f32 v[198:199], v[198:199], v[50:51], v[54:55]
    buffer_store_dword v234, v76, s[12:15], s35 offen offset:2816 sc1
    v_lshlrev_b32_sdwa v88, 3, v170 dst_sel:DWORD dst_unused:UNUSED_PAD src0_sel:DWORD src1_sel:WORD_0
    v_lshlrev_b32_sdwa v90, 3, v170 dst_sel:DWORD dst_unused:UNUSED_PAD src0_sel:DWORD src1_sel:WORD_1
    ds_read_b64 v[88:89], v88
    ds_read_b64 v[90:91], v90
    v_pk_mul_f32 v[236:237], v[196:197], v[196:197]
    v_pk_mul_f32 v[238:239], v[198:199], v[198:199]
    v_pk_fma_f32 v[236:237], v[236:237], v[60:61], v[62:63]
    v_pk_fma_f32 v[238:239], v[238:239], v[60:61], v[62:63]
    v_pk_mul_f32 v[236:237], v[236:237], v[196:197]
    v_lshlrev_b32_sdwa v92, 3, v171 dst_sel:DWORD dst_unused:UNUSED_PAD src0_sel:DWORD src1_sel:WORD_0
    v_lshlrev_b32_sdwa v94, 3, v171 dst_sel:DWORD dst_unused:UNUSED_PAD src0_sel:DWORD src1_sel:WORD_1
    ds_read_b64 v[92:93], v92
    ds_read_b64 v[94:95], v94
    s_waitcnt lgkmcnt(8)
    v_add3_u32 v26, v26, v96, v98
    v_add3_u32 v27, v27, v97, v99
    v_add3_u32 v26, v26, v100, v102
    v_add3_u32 v27, v27, v101, v103
    v_exp_f32 v236, v236
    v_pk_mul_f32 v[238:239], v[238:239], v[198:199]
    v_exp_f32 v237, v237
    v_exp_f32 v238, v238
    v_exp_f32 v239, v239
    s_waitcnt vmcnt(8)
    v_lshlrev_b32_sdwa v96, 3, v172 dst_sel:DWORD dst_unused:UNUSED_PAD src0_sel:DWORD src1_sel:WORD_0
    v_lshlrev_b32_sdwa v98, 3, v172 dst_sel:DWORD dst_unused:UNUSED_PAD src0_sel:DWORD src1_sel:WORD_1
    ds_read_b64 v[96:97], v96
    ds_read_b64 v[98:99], v98
    v_pk_fma_f32 v[236:237], v[236:237], v[56:57], v[56:57]
    v_pk_fma_f32 v[238:239], v[238:239], v[58:59], v[58:59]
    v_rcp_f32 v236, v236
    v_rcp_f32 v237, v237
    v_rcp_f32 v238, v238
    v_lshlrev_b32_sdwa v100, 3, v173 dst_sel:DWORD dst_unused:UNUSED_PAD src0_sel:DWORD src1_sel:WORD_0
    v_lshlrev_b32_sdwa v102, 3, v173 dst_sel:DWORD dst_unused:UNUSED_PAD src0_sel:DWORD src1_sel:WORD_1
    ds_read_b64 v[100:101], v100
    ds_read_b64 v[102:103], v102
    s_waitcnt lgkmcnt(8)
    v_add3_u32 v26, v26, v104, v106
    v_add3_u32 v27, v27, v105, v107
    v_add3_u32 v26, v26, v108, v110
    v_add3_u32 v27, v27, v109, v111
    buffer_load_dword v72, v76, s[52:55], 0 offen offset:32 sc1
    buffer_load_short_d16_hi v73, v79, s[56:59], 0 offen
    buffer_load_ushort v81, v78, s[60:63], s68 offen
    buffer_load_dword v82, v79, s[12:15], s69 offen sc1
    v_rcp_f32 v239, v239
    v_lshlrev_b32_sdwa v104, 3, v174 dst_sel:DWORD dst_unused:UNUSED_PAD src0_sel:DWORD src1_sel:WORD_0
    v_lshlrev_b32_sdwa v106, 3, v174 dst_sel:DWORD dst_unused:UNUSED_PAD src0_sel:DWORD src1_sel:WORD_1
    ds_read_b64 v[104:105], v104
    ds_read_b64 v[106:107], v106
    v_pk_mul_f32 v[240:241], v[196:197], v[236:237]
    v_lshlrev_b32_sdwa v108, 3, v175 dst_sel:DWORD dst_unused:UNUSED_PAD src0_sel:DWORD src1_sel:WORD_0
    v_lshlrev_b32_sdwa v110, 3, v175 dst_sel:DWORD dst_unused:UNUSED_PAD src0_sel:DWORD src1_sel:WORD_1
    ds_read_b64 v[108:109], v108
    ds_read_b64 v[110:111], v110
    s_waitcnt lgkmcnt(8)
    v_add3_u32 v26, v26, v88, v90
    v_add3_u32 v27, v27, v89, v91
    v_add3_u32 v26, v26, v92, v94
    v_add3_u32 v27, v27, v93, v95
    v_pk_fma_f32 v[240:241], v[198:199], v[238:239], v[240:241]
    v_add_u32_sdwa v200, v26, v154 dst_sel:DWORD dst_unused:UNUSED_PAD src0_sel:WORD_0 src1_sel:WORD_0
    v_add_f32 v240, v240, v241
    v_add_u32_sdwa v201, v26, v154 dst_sel:DWORD dst_unused:UNUSED_PAD src0_sel:WORD_1 src1_sel:WORD_1
    buffer_store_dword v240, v76, s[12:15], s35 offen offset:3072 sc1
    s_waitcnt vmcnt(10)
    v_lshlrev_b32_sdwa v88, 3, v32 dst_sel:DWORD dst_unused:UNUSED_PAD src0_sel:DWORD src1_sel:WORD_0
    v_lshlrev_b32_sdwa v90, 3, v32 dst_sel:DWORD dst_unused:UNUSED_PAD src0_sel:DWORD src1_sel:WORD_1
    ds_read_b64 v[88:89], v88
    ds_read_b64 v[90:91], v90
    v_add_u32_sdwa v202, v27, v155 dst_sel:DWORD dst_unused:UNUSED_PAD src0_sel:WORD_0 src1_sel:WORD_0
    v_add_u32_sdwa v203, v27, v155 dst_sel:DWORD dst_unused:UNUSED_PAD src0_sel:WORD_1 src1_sel:WORD_1
    v_pk_fma_f32 v[200:201], v[200:201], v[50:51], v[52:53]
    v_pk_fma_f32 v[202:203], v[202:203], v[50:51], v[54:55]
    v_pk_mul_f32 v[242:243], v[200:201], v[200:201]
    v_lshlrev_b32_sdwa v92, 3, v33 dst_sel:DWORD dst_unused:UNUSED_PAD src0_sel:DWORD src1_sel:WORD_0
    v_lshlrev_b32_sdwa v94, 3, v33 dst_sel:DWORD dst_unused:UNUSED_PAD src0_sel:DWORD src1_sel:WORD_1
    ds_read_b64 v[92:93], v92
    ds_read_b64 v[94:95], v94
    s_waitcnt lgkmcnt(8)
    v_add3_u32 v28, v28, v96, v98
    v_add3_u32 v29, v29, v97, v99
    v_add3_u32 v28, v28, v100, v102
    v_add3_u32 v29, v29, v101, v103
    v_pk_fma_f32 v[242:243], v[242:243], v[60:61], v[62:63]
    v_pk_mul_f32 v[244:245], v[202:203], v[202:203]
    v_pk_mul_f32 v[242:243], v[242:243], v[200:201]
    v_pk_fma_f32 v[244:245], v[244:245], v[60:61], v[62:63]
    v_exp_f32 v242, v242
    v_lshlrev_b32_sdwa v96, 3, v34 dst_sel:DWORD dst_unused:UNUSED_PAD src0_sel:DWORD src1_sel:WORD_0
    v_lshlrev_b32_sdwa v98, 3, v34 dst_sel:DWORD dst_unused:UNUSED_PAD src0_sel:DWORD src1_sel:WORD_1
    ds_read_b64 v[96:97], v96
    ds_read_b64 v[98:99], v98
    v_exp_f32 v243, v243
    v_pk_mul_f32 v[244:245], v[244:245], v[202:203]
    v_lshlrev_b32_sdwa v100, 3, v35 dst_sel:DWORD dst_unused:UNUSED_PAD src0_sel:DWORD src1_sel:WORD_0
    v_lshlrev_b32_sdwa v102, 3, v35 dst_sel:DWORD dst_unused:UNUSED_PAD src0_sel:DWORD src1_sel:WORD_1
    ds_read_b64 v[100:101], v100
    ds_read_b64 v[102:103], v102
    s_waitcnt lgkmcnt(8)
    v_add3_u32 v28, v28, v104, v106
    v_add3_u32 v29, v29, v105, v107
    v_add3_u32 v28, v28, v108, v110
    v_add3_u32 v29, v29, v109, v111
    v_exp_f32 v244, v244
    v_pk_fma_f32 v[242:243], v[242:243], v[56:57], v[56:57]
    v_add_u32_sdwa v204, v28, v156 dst_sel:DWORD dst_unused:UNUSED_PAD src0_sel:WORD_0 src1_sel:WORD_0
    v_rcp_f32 v242, v242
    v_add_u32_sdwa v205, v28, v156 dst_sel:DWORD dst_unused:UNUSED_PAD src0_sel:WORD_1 src1_sel:WORD_1
    s_waitcnt vmcnt(8)
    v_lshlrev_b32_sdwa v104, 3, v40 dst_sel:DWORD dst_unused:UNUSED_PAD src0_sel:DWORD src1_sel:WORD_0
    v_lshlrev_b32_sdwa v106, 3, v40 dst_sel:DWORD dst_unused:UNUSED_PAD src0_sel:DWORD src1_sel:WORD_1
    ds_read_b64 v[104:105], v104
    ds_read_b64 v[106:107], v106
    v_rcp_f32 v243, v243
    v_add_u32_sdwa v206, v29, v157 dst_sel:DWORD dst_unused:UNUSED_PAD src0_sel:WORD_0 src1_sel:WORD_0
    v_add_u32_sdwa v207, v29, v157 dst_sel:DWORD dst_unused:UNUSED_PAD src0_sel:WORD_1 src1_sel:WORD_1
    v_exp_f32 v245, v245
    v_pk_mul_f32 v[246:247], v[200:201], v[242:243]
    v_lshlrev_b32_sdwa v108, 3, v41 dst_sel:DWORD dst_unused:UNUSED_PAD src0_sel:DWORD src1_sel:WORD_0
    v_lshlrev_b32_sdwa v110, 3, v41 dst_sel:DWORD dst_unused:UNUSED_PAD src0_sel:DWORD src1_sel:WORD_1
    ds_read_b64 v[108:109], v108
    ds_read_b64 v[110:111], v110
    s_waitcnt lgkmcnt(8)
    v_add3_u32 v30, v30, v88, v90
    v_add3_u32 v31, v31, v89, v91
    v_add3_u32 v30, v30, v92, v94
    v_add3_u32 v31, v31, v93, v95
    s_setprio 0
    v_pk_fma_f32 v[244:245], v[244:245], v[58:59], v[58:59]
    v_pk_fma_f32 v[204:205], v[204:205], v[50:51], v[52:53]
    v_rcp_f32 v244, v244
    v_pk_fma_f32 v[206:207], v[206:207], v[50:51], v[54:55]
    v_pk_mul_f32 v[248:249], v[204:205], v[204:205]
    v_lshlrev_b32_sdwa v88, 3, v42 dst_sel:DWORD dst_unused:UNUSED_PAD src0_sel:DWORD src1_sel:WORD_0
    v_lshlrev_b32_sdwa v90, 3, v42 dst_sel:DWORD dst_unused:UNUSED_PAD src0_sel:DWORD src1_sel:WORD_1
    ds_read_b64 v[88:89], v88
    ds_read_b64 v[90:91], v90
    v_rcp_f32 v245, v245
    v_pk_fma_f32 v[248:249], v[248:249], v[60:61], v[62:63]
    v_pk_mul_f32 v[250:251], v[206:207], v[206:207]
    v_pk_fma_f32 v[246:247], v[202:203], v[244:245], v[246:247]
    v_pk_mul_f32 v[248:249], v[248:249], v[204:205]
    v_lshlrev_b32_sdwa v92, 3, v43 dst_sel:DWORD dst_unused:UNUSED_PAD src0_sel:DWORD src1_sel:WORD_0
    v_lshlrev_b32_sdwa v94, 3, v43 dst_sel:DWORD dst_unused:UNUSED_PAD src0_sel:DWORD src1_sel:WORD_1
    ds_read_b64 v[92:93], v92
    ds_read_b64 v[94:95], v94
    s_waitcnt lgkmcnt(8)
    v_add3_u32 v30, v30, v96, v98
    v_add3_u32 v31, v31, v97, v99
    v_add3_u32 v30, v30, v100, v102
    v_add3_u32 v31, v31, v101, v103
    v_exp_f32 v248, v248
    v_add_f32 v246, v246, v247
    v_pk_fma_f32 v[250:251], v[250:251], v[60:61], v[62:63]
    v_exp_f32 v249, v249
    buffer_store_dword v246, v76, s[12:15], s35 offen offset:3328 sc1
    v_pk_mul_f32 v[250:251], v[250:251], v[206:207]
    v_pk_fma_f32 v[248:249], v[248:249], v[56:57], v[56:57]
    v_exp_f32 v250, v250
    v_rcp_f32 v248, v248
    v_rcp_f32 v249, v249
    s_waitcnt lgkmcnt(4)
    v_add3_u32 v30, v30, v104, v106
    v_add3_u32 v31, v31, v105, v107
    v_add3_u32 v30, v30, v108, v110
    v_add3_u32 v31, v31, v109, v111
    v_exp_f32 v251, v251
    v_pk_mul_f32 v[252:253], v[204:205], v[248:249]
    s_waitcnt lgkmcnt(0)
    v_add3_u32 v30, v30, v88, v90
    v_add3_u32 v31, v31, v89, v91
    v_add3_u32 v30, v30, v92, v94
    v_add3_u32 v31, v31, v93, v95
    v_pk_fma_f32 v[250:251], v[250:251], v[58:59], v[58:59]
    v_add_u32_sdwa v188, v30, v158 dst_sel:DWORD dst_unused:UNUSED_PAD src0_sel:WORD_0 src1_sel:WORD_0
    v_rcp_f32 v250, v250
    v_add_u32_sdwa v189, v30, v158 dst_sel:DWORD dst_unused:UNUSED_PAD src0_sel:WORD_1 src1_sel:WORD_1
    v_add_u32_sdwa v190, v31, v159 dst_sel:DWORD dst_unused:UNUSED_PAD src0_sel:WORD_0 src1_sel:WORD_0
    v_rcp_f32 v251, v251
    v_add_u32_sdwa v191, v31, v159 dst_sel:DWORD dst_unused:UNUSED_PAD src0_sel:WORD_1 src1_sel:WORD_1
    v_pk_fma_f32 v[188:189], v[188:189], v[50:51], v[52:53]
    v_pk_fma_f32 v[252:253], v[206:207], v[250:251], v[252:253]
    v_pk_fma_f32 v[190:191], v[190:191], v[50:51], v[54:55]
    v_add_f32 v252, v252, v253
    v_pk_mul_f32 v[224:225], v[188:189], v[188:189]
    buffer_store_dword v252, v76, s[12:15], s35 offen offset:3584 sc1
    v_pk_fma_f32 v[224:225], v[224:225], v[60:61], v[62:63]
    v_pk_mul_f32 v[226:227], v[190:191], v[190:191]
    v_pk_mul_f32 v[224:225], v[224:225], v[188:189]
    v_pk_fma_f32 v[226:227], v[226:227], v[60:61], v[62:63]
    v_exp_f32 v224, v224
    v_pk_mul_f32 v[226:227], v[226:227], v[190:191]
    v_exp_f32 v225, v225
    v_exp_f32 v226, v226
    v_exp_f32 v227, v227
    v_pk_fma_f32 v[224:225], v[224:225], v[56:57], v[56:57]
    s_nop 0
    v_rcp_f32 v224, v224
    v_pk_fma_f32 v[226:227], v[226:227], v[58:59], v[58:59]
    v_rcp_f32 v225, v225
    v_rcp_f32 v226, v226
    v_rcp_f32 v227, v227
    v_pk_mul_f32 v[228:229], v[188:189], v[224:225]
    s_nop 0
    v_pk_fma_f32 v[228:229], v[190:191], v[226:227], v[228:229]
    s_nop 0
    v_add_f32 v228, v228, v229
    s_nop 0
    buffer_store_dword v228, v76, s[12:15], s35 offen offset:3840 sc1
    s_waitcnt vmcnt(4)

    v_cmp_ne_u32 vcc, 128, v72
    s_and_b32 s44, vcc_hi, 0x1
    s_and_b32 s45, vcc_lo, 0x1
    s_or_b32 s45, s45, s44
    s_cbranch_scc1 k1_kernel_rslow

k1_kernel_rjob:

    s_lshl_b32 s67, s64, 8
    s_add_u32 s68, s67, 29360128
    s_add_u32 s69, s68, 65536
    s_add_u32 s67, s67, 20971520

k1_kernel_rgrp:

    s_add_u32 s70, s67, s65
    s_add_u32 s71, s70, 262144
    s_add_u32 s72, s70, 524288
    s_add_u32 s73, s70, 786432
    s_add_u32 s65, s65, 1048576

    buffer_load_dwordx4 v[0:3], v74, s[12:15], s70 offen sc1
    buffer_load_dwordx4 v[4:7], v74, s[12:15], s71 offen sc1
    buffer_load_dwordx4 v[8:11], v74, s[12:15], s72 offen sc1
    buffer_load_dwordx4 v[12:15], v74, s[12:15], s73 offen sc1
    buffer_load_dword v16, v75, s[12:15], s68 offen sc1
    buffer_load_dword v17, v75, s[12:15], s69 offen sc1
    s_branch k1_kernel_rchk
k1_kernel_rpoll:
    s_mov_b64 exec, s[74:75]
    s_cbranch_execz k1_kernel_rsk0
    buffer_load_dwordx4 v[0:3], v74, s[12:15], s70 offen sc1
k1_kernel_rsk0:
    s_mov_b64 exec, s[76:77]
    s_cbranch_execz k1_kernel_rsk1
    buffer_load_dwordx4 v[4:7], v74, s[12:15], s71 offen sc1
k1_kernel_rsk1:
    s_mov_b64 exec, s[78:79]
    s_cbranch_execz k1_kernel_rsk2
    buffer_load_dwordx4 v[8:11], v74, s[12:15], s72 offen sc1
k1_kernel_rsk2:
    s_mov_b64 exec, s[80:81]
    s_cbranch_execz k1_kernel_rsk3
    buffer_load_dwordx4 v[12:15], v74, s[12:15], s73 offen sc1
k1_kernel_rsk3:
    s_mov_b64 exec, -1
k1_kernel_rchk:
    s_waitcnt vmcnt(0)
k1_kernel_rchk0:
    v_max3_u32 v20, v0, v1, v2
    v_max3_u32 v21, v4, v5, v6
    v_max3_u32 v22, v8, v9, v10
    v_max3_u32 v23, v12, v13, v14
    v_max_u32 v20, v20, v3
    v_max_u32 v21, v21, v7
    v_max_u32 v22, v22, v11
    v_max_u32 v23, v23, v15
    v_cmp_eq_u32 s[74:75], -1, v20
    v_cmp_eq_u32 s[76:77], -1, v21
    v_cmp_eq_u32 s[78:79], -1, v22
    v_cmp_eq_u32 s[80:81], -1, v23

    v_pk_add_f32 v[26:27], v[0:1], v[4:5]
    v_pk_add_f32 v[28:29], v[2:3], v[6:7]
    v_pk_add_f32 v[30:31], v[8:9], v[12:13]
    v_pk_add_f32 v[32:33], v[10:11], v[14:15]
    s_or_b64 s[82:83], s[74:75], s[76:77]
    s_or_b64 s[84:85], s[78:79], s[80:81]
    v_pk_add_f32 v[26:27], v[26:27], v[30:31]
    v_pk_add_f32 v[28:29], v[28:29], v[32:33]
    s_or_b64 s[82:83], s[82:83], s[84:85]
    s_cbranch_scc1 k1_kernel_rpoll
    v_permlane32_swap_b32 v26, v28
    v_permlane32_swap_b32 v27, v29
    s_cmp_lt_u32 s65, s66
    s_nop 0
    v_pk_add_f32 v[26:27], v[26:27], v[28:29]
    s_nop 1
    v_permlane16_swap_b32 v26, v27
    s_nop 1
    v_add_f32 v26, v26, v27
    v_add_f32 v79, v79, v26
    s_cbranch_scc1 k1_kernel_rgrp
    s_cmp_lg_u32 s43, 0
    s_cbranch_scc1 k1_kernel_rpn
    ds_write_b32 v77, v79
    v_add_u32 v21, 0x10000, v77
    s_cmp_lg_u32 s3, 0
    s_waitcnt lgkmcnt(0)
    s_barrier
    s_cbranch_scc1 k1_kernel_rend

    ds_read2st64_b32 v[40:41], v77 offset0:0 offset1:64
    ds_read2st64_b32 v[42:43], v77 offset0:128 offset1:192
    ds_read2st64_b32 v[44:45], v21 offset0:0 offset1:64
    ds_read2st64_b32 v[46:47], v21 offset0:128 offset1:192

    s_waitcnt lgkmcnt(2)
    v_pk_add_f32 v[26:27], v[40:41], v[42:43]
    v_max3_u32 v20, v41, v42, v43
    s_waitcnt lgkmcnt(0)
    v_pk_add_f32 v[28:29], v[44:45], v[46:47]
    v_max3_u32 v20, v20, v44, v45
    v_pk_add_f32 v[26:27], v[26:27], v[28:29]
    v_max3_u32 v20, v20, v46, v47
    v_add_f32 v79, v26, v27
    v_cmp_eq_u32 vcc, -1, v20
    s_cbranch_vccnz k1_kernel_rnext

k1_kernel_rpn:

    v_max_u32 v20, v16, v17
    v_add_f32 v21, v16, v17
    v_cmp_eq_u32 vcc, -1, v20
    v_cvt_pk_bf16_f32 v21, v79, v21
    s_cbranch_vccnz k1_kernel_rpn2
    v_lshlrev_b32 v22, 16, v21
    v_and_b32 v21, 0xffff0000, v21
    v_add_f32 v22, v22, v73
    v_cvt_pk_bf16_f32 v22, v22, v22
    v_lshlrev_b32 v22, 16, v22
    v_add_f32 v22, v22, v21
    s_lshl_b32 s45, s64, 7
    v_cvt_pk_bf16_f32 v22, v22, v22
    buffer_store_short v22, v78, s[60:63], s45 offen

k1_kernel_rnext:

    v_cmp_ne_u32 vcc, 0, v72
    s_and_b32 s45, vcc_lo, 0xff00
    s_cbranch_scc1 k1_kernel_rmore

k1_kernel_rend:
    s_endpgm
k1_kernel_rpn2:
    buffer_load_dword v16, v75, s[12:15], s68 offen sc1
    buffer_load_dword v17, v75, s[12:15], s69 offen sc1
    s_waitcnt vmcnt(0)
    s_branch k1_kernel_rpn
k1_kernel_rmore:

    s_ff1_i32_b32 s45, s45
    s_mov_b32 s43, 1
    s_mov_b32 s65, 0
    s_mov_b32 s66, 8388608
    v_readlane_b32 s44, v72, s45
    v_mov_b32 v79, 0
    s_mov_b32 m0, s45
    s_ff1_i32_b32 s64, s44
    s_bitset0_b32 s44, s64
    s_sub_u32 s45, s45, 8
    s_lshl_b32 s45, s45, 5
    s_add_u32 s64, s64, s45
    v_writelane_b32 v72, s44, m0
    s_branch k1_kernel_rjob

k1_kernel_rslow:
    s_lshl_b32 s65, s3, 20
    buffer_load_dword v72, v76, s[52:55], 0 offen offset:32 sc1
    s_waitcnt vmcnt(0)

    v_cmp_ne_u32 vcc, 128, v72
    s_and_b32 s44, vcc_hi, 0x1
    s_and_b32 s45, vcc_lo, 0x1
    s_or_b32 s45, s45, s44
    s_cbranch_scc0 k1_kernel_rjob

    s_add_u32 s42, s42, 1
    s_cmp_lt_u32 s42, 200
    s_cbranch_scc1 k1_kernel_rslow
    s_lshl_b32 s44, 1, s64
    s_lshr_b32 s45, s64, 5
    s_lshl_b32 s45, s45, 2
    v_mov_b32 v20, s44
    s_mov_b64 exec, 1
    buffer_atomic_or v20, v76, s[52:55], s45 offen offset:64 sc0
    s_mov_b64 exec, -1
    s_waitcnt vmcnt(0)
    buffer_load_dword v72, v76, s[52:55], 0 offen offset:32 sc1
    s_waitcnt vmcnt(0)

    v_cmp_ne_u32 vcc, 128, v72
    s_and_b32 s44, vcc_hi, 0x1
    s_and_b32 s45, vcc_lo, 0x1
    s_or_b32 s45, s45, s44
    s_cbranch_scc0 k1_kernel_rjob

    v_mov_b32 v20, -1
    ds_write_b32 v77, v20
    s_waitcnt lgkmcnt(0)
    s_endpgm

k1_kernel_xw0:

    buffer_load_dword v65, off, s[12:15], s47 sc1
    s_waitcnt vmcnt(0)
    v_readfirstlane_b32 s44, v65
    s_cmp_le_u32 s44, 0
    s_cbranch_scc1 k1_kernel_xw0
    s_branch k1_kernel_xb0

k1_kernel_xw1:

    buffer_load_dword v65, off, s[12:15], s47 sc1
    s_waitcnt vmcnt(0)
    v_readfirstlane_b32 s44, v65
    s_cmp_le_u32 s44, 1
    s_cbranch_scc1 k1_kernel_xw1
    s_branch k1_kernel_xb1

k1_kernel_scr0:
    s_sleep 8
    v_bfe_u32 v84, v71, 2, 7
    s_mov_b32 s35, 15466496
    buffer_load_dwordx4 v[72:75], v71, s[12:15], s35 offen offset:0 sc1
    buffer_load_dwordx4 v[76:79], v71, s[12:15], s35 offen offset:1024 sc1
    buffer_load_dwordx4 v[80:83], v71, s[12:15], s35 offen offset:2048 sc1
    buffer_load_dword v84, v84, s[12:15], s35 offen offset:3584 sc1
    s_waitcnt vmcnt(0)
    s_branch k1_kernel_scb0

k1_kernel_solo1:
    s_mov_b32 s48, 1
    s_add_u32 s16, s16, 33554432
    s_add_u32 s46, s46, 33554432
    s_mov_b32 s18, s16
    s_mov_b32 s47, s46
    s_xor_b32 s49, s34, 1
    s_branch k1_kernel_solo3
k1_kernel_solo2:
    s_mov_b32 s48, 2
    s_waitcnt vmcnt(0)
    v_mov_b32 v0, 2
    buffer_store_dword v0, off, s[12:15], s46 sc1

    s_lshl_b32 s16, s2, 3
    s_add_u32 s16, s16, s3
    s_lshl_b32 s46, s16, 7
    s_mul_i32 s16, s16, 8448
    s_add_u32 s46, s46, 30408704
    s_add_u32 s16, s16, 67108864

    s_mov_b32 s49, s34
k1_kernel_solo3:
    s_load_dwordx2 s[4:5], s[0:1], 8
    s_mov_b32 s6, 256000
    s_mov_b32 s7, 0x00020000

    s_mul_i32 s21, s33, 102656
    s_mul_i32 s35, s49, 49152
    s_sub_u32 s22, 53248, s35
    s_add_u32 s21, s21, s35
    s_lshl_b32 s35, s50, 11
    s_xor_b32 s19, s35, 2048
    s_add_u32 s19, s19, s21
    s_add_u32 s21, s21, s35
    s_mul_i32 s20, s49, 1703936
    s_add_u32 s20, s20, 16777216
    s_lshl_b32 s35, s3, 14
    s_add_u32 s20, s20, s35

    s_waitcnt vmcnt(0) lgkmcnt(0)
    s_and_b32 s5, s5, 0xffff
    s_barrier
    v_bfe_u32 v1, v71, 4, 4
    v_lshrrev_b32 v2, 8, v71
    v_lshlrev_b32 v65, 8, v1
    v_lshl_add_u32 v65, v2, 4, v65
    v_and_b32 v70, 0x7fff, v70
    v_mov_b32 v64, v70
    s_add_u32 s44, s26, 0x7c00080
    v_mov_b32 v66, s44
    v_mov_b32 v67, s44
    v_mov_b32 v68, s44
    v_mov_b32 v69, s44
    s_lshl_b32 s44, s3, 15
    s_lshl_b32 s45, s50, 7
    s_add_u32 s44, s44, s45
    s_xor_b32 s45, s44, 128

    buffer_load_dwordx4 v[128:131], v65, s[4:7], s44 offen offset:0
    buffer_load_dwordx4 v[132:135], v65, s[4:7], s44 offen offset:64
    buffer_load_dwordx4 v[136:139], v65, s[4:7], s45 offen offset:0
    buffer_load_dwordx4 v[140:143], v65, s[4:7], s45 offen offset:64
    s_add_u32 s44, s44, 4096
    s_add_u32 s45, s45, 4096
    buffer_load_dwordx4 v[144:147], v65, s[4:7], s44 offen offset:0
    buffer_load_dwordx4 v[148:151], v65, s[4:7], s44 offen offset:64
    buffer_load_dwordx4 v[152:155], v65, s[4:7], s45 offen offset:0
    buffer_load_dwordx4 v[156:159], v65, s[4:7], s45 offen offset:64
    s_add_u32 s44, s44, 4096
    s_add_u32 s45, s45, 4096
    buffer_load_dwordx4 v[160:163], v65, s[4:7], s44 offen offset:0
    buffer_load_dwordx4 v[164:167], v65, s[4:7], s44 offen offset:64
    buffer_load_dwordx4 v[168:171], v65, s[4:7], s45 offen offset:0
    buffer_load_dwordx4 v[172:175], v65, s[4:7], s45 offen offset:64
    s_add_u32 s44, s44, 4096
    s_add_u32 s45, s45, 4096
    buffer_load_dwordx4 v[176:179], v65, s[4:7], s44 offen offset:0
    buffer_load_dwordx4 v[180:183], v65, s[4:7], s44 offen offset:64
    buffer_load_dwordx4 v[184:187], v65, s[4:7], s45 offen offset:0
    buffer_load_dwordx4 v[188:191], v65, s[4:7], s45 offen offset:64
    s_add_u32 s44, s44, 4096
    s_add_u32 s45, s45, 4096
    buffer_load_dwordx4 v[192:195], v65, s[4:7], s44 offen offset:0
    buffer_load_dwordx4 v[196:199], v65, s[4:7], s44 offen offset:64
    buffer_load_dwordx4 v[200:203], v65, s[4:7], s45 offen offset:0
    buffer_load_dwordx4 v[204:207], v65, s[4:7], s45 offen offset:64
    s_add_u32 s44, s44, 4096
    s_add_u32 s45, s45, 4096
    buffer_load_dwordx4 v[208:211], v65, s[4:7], s44 offen offset:0
    buffer_load_dwordx4 v[212:215], v65, s[4:7], s44 offen offset:64
    buffer_load_dwordx4 v[216:219], v65, s[4:7], s45 offen offset:0
    buffer_load_dwordx4 v[220:223], v65, s[4:7], s45 offen offset:64
    s_add_u32 s44, s44, 4096
    s_add_u32 s45, s45, 4096
    buffer_load_dwordx4 v[224:227], v65, s[4:7], s44 offen offset:0
    buffer_load_dwordx4 v[228:231], v65, s[4:7], s44 offen offset:64
    buffer_load_dwordx4 v[232:235], v65, s[4:7], s45 offen offset:0
    buffer_load_dwordx4 v[236:239], v65, s[4:7], s45 offen offset:64
    s_add_u32 s44, s44, 4096
    s_add_u32 s45, s45, 4096
    buffer_load_dwordx4 v[240:243], v65, s[4:7], s44 offen offset:0
    buffer_load_dwordx4 v[244:247], v65, s[4:7], s44 offen offset:64
    buffer_load_dwordx4 v[248:251], v65, s[4:7], s45 offen offset:0
    buffer_load_dwordx4 v[252:255], v65, s[4:7], s45 offen offset:64
    s_add_u32 s44, s44, 4096
    s_add_u32 s45, s45, 4096
    buffer_load_dwordx4 v[0:3], v71, s[12:15], s21 offen offset:0
    buffer_load_dwordx4 v[4:7], v71, s[12:15], s21 offen offset:1024
    buffer_load_dwordx4 v[8:11], v71, s[12:15], s19 offen offset:0
    buffer_load_dwordx4 v[12:15], v71, s[12:15], s19 offen offset:1024
    s_add_u32 s21, s21, 4096
    s_add_u32 s19, s19, 4096
    buffer_load_dwordx4 v[16:19], v71, s[12:15], s21 offen offset:0
    buffer_load_dwordx4 v[20:23], v71, s[12:15], s21 offen offset:1024
    buffer_load_dwordx4 v[24:27], v71, s[12:15], s19 offen offset:0
    buffer_load_dwordx4 v[28:31], v71, s[12:15], s19 offen offset:1024
    s_add_u32 s21, s21, 4096
    s_add_u32 s19, s19, 4096
    buffer_load_dwordx4 v[32:35], v71, s[12:15], s21 offen offset:0
    buffer_load_dwordx4 v[36:39], v71, s[12:15], s21 offen offset:1024
    buffer_load_dwordx4 v[40:43], v71, s[12:15], s19 offen offset:0
    buffer_load_dwordx4 v[44:47], v71, s[12:15], s19 offen offset:1024
    s_add_u32 s21, s21, 4096
    s_add_u32 s19, s19, 4096
    buffer_load_dwordx4 v[72:75], v71, s[12:15], s21 offen offset:0
    buffer_load_dwordx4 v[76:79], v71, s[12:15], s21 offen offset:1024
    buffer_load_dwordx4 v[80:83], v71, s[12:15], s19 offen offset:0
    buffer_load_dwordx4 v[84:87], v71, s[12:15], s19 offen offset:1024
    s_add_u32 s21, s21, 4096
    s_add_u32 s19, s19, 4096
    buffer_load_dwordx2 v[116:117], v71, s[12:15], s20 offen offset:0 sc1
    buffer_load_dwordx2 v[118:119], v71, s[12:15], s20 offen offset:1024 sc1
    buffer_load_dwordx2 v[120:121], v71, s[12:15], s20 offen offset:2048 sc1
    buffer_load_dwordx2 v[122:123], v71, s[12:15], s20 offen offset:3072 sc1
    s_add_u32 s20, s20, 4096
    buffer_load_dwordx2 v[124:125], v71, s[12:15], s20 offen offset:0 sc1
    buffer_load_dwordx2 v[126:127], v71, s[12:15], s20 offen offset:1024 sc1
    s_waitcnt vmcnt(0)
    v_mfma_f32_16x16x32_bf16 v[96:99], v[0:3], v[128:131], v[66:69]
    v_mfma_f32_16x16x32_bf16 v[100:103], v[0:3], v[144:147], v[66:69]
    v_mfma_f32_16x16x32_bf16 v[96:99], v[4:7], v[132:135], v[96:99]
    v_mfma_f32_16x16x32_bf16 v[100:103], v[4:7], v[148:151], v[100:103]
    v_mfma_f32_16x16x32_bf16 v[96:99], v[8:11], v[136:139], v[96:99]
    v_mfma_f32_16x16x32_bf16 v[100:103], v[8:11], v[152:155], v[100:103]
    v_mfma_f32_16x16x32_bf16 v[96:99], v[12:15], v[140:143], v[96:99]
    v_mfma_f32_16x16x32_bf16 v[100:103], v[12:15], v[156:159], v[100:103]
    v_mfma_f32_16x16x32_bf16 v[104:107], v[0:3], v[160:163], v[66:69]
    v_mfma_f32_16x16x32_bf16 v[108:111], v[0:3], v[176:179], v[66:69]
    v_mfma_f32_16x16x32_bf16 v[104:107], v[4:7], v[164:167], v[104:107]
    v_perm_b32 v96, v97, v96, s23
    v_mfma_f32_16x16x32_bf16 v[108:111], v[4:7], v[180:183], v[108:111]
    v_perm_b32 v97, v99, v98, s23
    v_mfma_f32_16x16x32_bf16 v[104:107], v[8:11], v[168:171], v[104:107]
    ds_write_b64 v64, v[96:97] offset:0
    v_mfma_f32_16x16x32_bf16 v[108:111], v[8:11], v[184:187], v[108:111]
    v_perm_b32 v100, v101, v100, s23
    v_mfma_f32_16x16x32_bf16 v[104:107], v[12:15], v[172:175], v[104:107]
    v_perm_b32 v101, v103, v102, s23
    v_mfma_f32_16x16x32_bf16 v[108:111], v[12:15], v[188:191], v[108:111]
    ds_write_b64 v64, v[100:101] offset:128
    v_mfma_f32_16x16x32_bf16 v[88:91], v[0:3], v[192:195], v[66:69]
    v_mfma_f32_16x16x32_bf16 v[92:95], v[0:3], v[208:211], v[66:69]
    v_mfma_f32_16x16x32_bf16 v[88:91], v[4:7], v[196:199], v[88:91]
    v_perm_b32 v104, v105, v104, s23
    v_mfma_f32_16x16x32_bf16 v[92:95], v[4:7], v[212:215], v[92:95]
    v_perm_b32 v105, v107, v106, s23
    v_mfma_f32_16x16x32_bf16 v[88:91], v[8:11], v[200:203], v[88:91]
    ds_write_b64 v64, v[104:105] offset:256
    v_mfma_f32_16x16x32_bf16 v[92:95], v[8:11], v[216:219], v[92:95]
    v_perm_b32 v108, v109, v108, s23
    v_mfma_f32_16x16x32_bf16 v[88:91], v[12:15], v[204:207], v[88:91]
    v_perm_b32 v109, v111, v110, s23
    v_mfma_f32_16x16x32_bf16 v[92:95], v[12:15], v[220:223], v[92:95]
    ds_write_b64 v64, v[108:109] offset:384
    v_mfma_f32_16x16x32_bf16 v[96:99], v[0:3], v[224:227], v[66:69]
    v_mfma_f32_16x16x32_bf16 v[100:103], v[0:3], v[240:243], v[66:69]
    v_mfma_f32_16x16x32_bf16 v[96:99], v[4:7], v[228:231], v[96:99]
    v_perm_b32 v88, v89, v88, s23
    v_mfma_f32_16x16x32_bf16 v[100:103], v[4:7], v[244:247], v[100:103]
    v_perm_b32 v89, v91, v90, s23
    v_mfma_f32_16x16x32_bf16 v[96:99], v[8:11], v[232:235], v[96:99]
    ds_write_b64 v64, v[88:89] offset:512
    v_mfma_f32_16x16x32_bf16 v[100:103], v[8:11], v[248:251], v[100:103]
    v_perm_b32 v92, v93, v92, s23
    v_mfma_f32_16x16x32_bf16 v[96:99], v[12:15], v[236:239], v[96:99]
    v_perm_b32 v93, v95, v94, s23
    v_mfma_f32_16x16x32_bf16 v[100:103], v[12:15], v[252:255], v[100:103]
    ds_write_b64 v64, v[92:93] offset:640
    s_nop 7
    v_perm_b32 v96, v97, v96, s23
    v_perm_b32 v97, v99, v98, s23
    ds_write_b64 v64, v[96:97] offset:768
    v_perm_b32 v100, v101, v100, s23
    v_perm_b32 v101, v103, v102, s23
    ds_write_b64 v64, v[100:101] offset:896
    v_add_u32 v64, 0x8000, v64
    v_mfma_f32_16x16x32_bf16 v[104:107], v[16:19], v[128:131], v[66:69]
    v_mfma_f32_16x16x32_bf16 v[108:111], v[16:19], v[144:147], v[66:69]
    v_mfma_f32_16x16x32_bf16 v[104:107], v[20:23], v[132:135], v[104:107]
    v_mfma_f32_16x16x32_bf16 v[108:111], v[20:23], v[148:151], v[108:111]
    v_mfma_f32_16x16x32_bf16 v[104:107], v[24:27], v[136:139], v[104:107]
    v_mfma_f32_16x16x32_bf16 v[108:111], v[24:27], v[152:155], v[108:111]
    v_mfma_f32_16x16x32_bf16 v[104:107], v[28:31], v[140:143], v[104:107]
    v_mfma_f32_16x16x32_bf16 v[108:111], v[28:31], v[156:159], v[108:111]
    v_mfma_f32_16x16x32_bf16 v[88:91], v[16:19], v[160:163], v[66:69]
    v_mfma_f32_16x16x32_bf16 v[92:95], v[16:19], v[176:179], v[66:69]
    v_mfma_f32_16x16x32_bf16 v[88:91], v[20:23], v[164:167], v[88:91]
    v_perm_b32 v104, v105, v104, s23
    v_mfma_f32_16x16x32_bf16 v[92:95], v[20:23], v[180:183], v[92:95]
    v_perm_b32 v105, v107, v106, s23
    v_mfma_f32_16x16x32_bf16 v[88:91], v[24:27], v[168:171], v[88:91]
    ds_write_b64 v64, v[104:105] offset:0
    v_mfma_f32_16x16x32_bf16 v[92:95], v[24:27], v[184:187], v[92:95]
    v_perm_b32 v108, v109, v108, s23
    v_mfma_f32_16x16x32_bf16 v[88:91], v[28:31], v[172:175], v[88:91]
    v_perm_b32 v109, v111, v110, s23
    v_mfma_f32_16x16x32_bf16 v[92:95], v[28:31], v[188:191], v[92:95]
    ds_write_b64 v64, v[108:109] offset:128
    v_mfma_f32_16x16x32_bf16 v[96:99], v[16:19], v[192:195], v[66:69]
    v_mfma_f32_16x16x32_bf16 v[100:103], v[16:19], v[208:211], v[66:69]
    v_mfma_f32_16x16x32_bf16 v[96:99], v[20:23], v[196:199], v[96:99]
    v_perm_b32 v88, v89, v88, s23
    v_mfma_f32_16x16x32_bf16 v[100:103], v[20:23], v[212:215], v[100:103]
    v_perm_b32 v89, v91, v90, s23
    v_mfma_f32_16x16x32_bf16 v[96:99], v[24:27], v[200:203], v[96:99]
    ds_write_b64 v64, v[88:89] offset:256
    v_mfma_f32_16x16x32_bf16 v[100:103], v[24:27], v[216:219], v[100:103]
    v_perm_b32 v92, v93, v92, s23
    v_mfma_f32_16x16x32_bf16 v[96:99], v[28:31], v[204:207], v[96:99]
    v_perm_b32 v93, v95, v94, s23
    v_mfma_f32_16x16x32_bf16 v[100:103], v[28:31], v[220:223], v[100:103]
    ds_write_b64 v64, v[92:93] offset:384
    v_mfma_f32_16x16x32_bf16 v[104:107], v[16:19], v[224:227], v[66:69]
    v_mfma_f32_16x16x32_bf16 v[108:111], v[16:19], v[240:243], v[66:69]
    v_mfma_f32_16x16x32_bf16 v[104:107], v[20:23], v[228:231], v[104:107]
    v_perm_b32 v96, v97, v96, s23
    v_mfma_f32_16x16x32_bf16 v[108:111], v[20:23], v[244:247], v[108:111]
    v_perm_b32 v97, v99, v98, s23
    v_mfma_f32_16x16x32_bf16 v[104:107], v[24:27], v[232:235], v[104:107]
    ds_write_b64 v64, v[96:97] offset:512
    v_mfma_f32_16x16x32_bf16 v[108:111], v[24:27], v[248:251], v[108:111]
    v_perm_b32 v100, v101, v100, s23
    v_mfma_f32_16x16x32_bf16 v[104:107], v[28:31], v[236:239], v[104:107]
    v_perm_b32 v101, v103, v102, s23
    v_mfma_f32_16x16x32_bf16 v[108:111], v[28:31], v[252:255], v[108:111]
    ds_write_b64 v64, v[100:101] offset:640
    s_nop 7
    v_perm_b32 v104, v105, v104, s23
    v_perm_b32 v105, v107, v106, s23
    ds_write_b64 v64, v[104:105] offset:768
    v_perm_b32 v108, v109, v108, s23
    v_perm_b32 v109, v111, v110, s23
    ds_write_b64 v64, v[108:109] offset:896
    v_add_u32 v64, 0x8000, v64
    v_mfma_f32_16x16x32_bf16 v[88:91], v[32:35], v[128:131], v[66:69]
    v_mfma_f32_16x16x32_bf16 v[92:95], v[32:35], v[144:147], v[66:69]
    v_mfma_f32_16x16x32_bf16 v[88:91], v[36:39], v[132:135], v[88:91]
    v_mfma_f32_16x16x32_bf16 v[92:95], v[36:39], v[148:151], v[92:95]
    v_mfma_f32_16x16x32_bf16 v[88:91], v[40:43], v[136:139], v[88:91]
    v_mfma_f32_16x16x32_bf16 v[92:95], v[40:43], v[152:155], v[92:95]
    v_mfma_f32_16x16x32_bf16 v[88:91], v[44:47], v[140:143], v[88:91]
    v_mfma_f32_16x16x32_bf16 v[92:95], v[44:47], v[156:159], v[92:95]
    v_mfma_f32_16x16x32_bf16 v[96:99], v[32:35], v[160:163], v[66:69]
    v_mfma_f32_16x16x32_bf16 v[100:103], v[32:35], v[176:179], v[66:69]
    v_mfma_f32_16x16x32_bf16 v[96:99], v[36:39], v[164:167], v[96:99]
    v_perm_b32 v88, v89, v88, s23
    v_mfma_f32_16x16x32_bf16 v[100:103], v[36:39], v[180:183], v[100:103]
    v_perm_b32 v89, v91, v90, s23
    v_mfma_f32_16x16x32_bf16 v[96:99], v[40:43], v[168:171], v[96:99]
    ds_write_b64 v64, v[88:89] offset:0
    v_mfma_f32_16x16x32_bf16 v[100:103], v[40:43], v[184:187], v[100:103]
    v_perm_b32 v92, v93, v92, s23
    v_mfma_f32_16x16x32_bf16 v[96:99], v[44:47], v[172:175], v[96:99]
    v_perm_b32 v93, v95, v94, s23
    v_mfma_f32_16x16x32_bf16 v[100:103], v[44:47], v[188:191], v[100:103]
    ds_write_b64 v64, v[92:93] offset:128
    v_mfma_f32_16x16x32_bf16 v[104:107], v[32:35], v[192:195], v[66:69]
    v_mfma_f32_16x16x32_bf16 v[108:111], v[32:35], v[208:211], v[66:69]
    v_mfma_f32_16x16x32_bf16 v[104:107], v[36:39], v[196:199], v[104:107]
    v_perm_b32 v96, v97, v96, s23
    v_mfma_f32_16x16x32_bf16 v[108:111], v[36:39], v[212:215], v[108:111]
    v_perm_b32 v97, v99, v98, s23
    v_mfma_f32_16x16x32_bf16 v[104:107], v[40:43], v[200:203], v[104:107]
    ds_write_b64 v64, v[96:97] offset:256
    v_mfma_f32_16x16x32_bf16 v[108:111], v[40:43], v[216:219], v[108:111]
    v_perm_b32 v100, v101, v100, s23
    v_mfma_f32_16x16x32_bf16 v[104:107], v[44:47], v[204:207], v[104:107]
    v_perm_b32 v101, v103, v102, s23
    v_mfma_f32_16x16x32_bf16 v[108:111], v[44:47], v[220:223], v[108:111]
    ds_write_b64 v64, v[100:101] offset:384
    v_mfma_f32_16x16x32_bf16 v[88:91], v[32:35], v[224:227], v[66:69]
    v_mfma_f32_16x16x32_bf16 v[92:95], v[32:35], v[240:243], v[66:69]
    v_mfma_f32_16x16x32_bf16 v[88:91], v[36:39], v[228:231], v[88:91]
    v_perm_b32 v104, v105, v104, s23
    v_mfma_f32_16x16x32_bf16 v[92:95], v[36:39], v[244:247], v[92:95]
    v_perm_b32 v105, v107, v106, s23
    v_mfma_f32_16x16x32_bf16 v[88:91], v[40:43], v[232:235], v[88:91]
    ds_write_b64 v64, v[104:105] offset:512
    v_mfma_f32_16x16x32_bf16 v[92:95], v[40:43], v[248:251], v[92:95]
    v_perm_b32 v108, v109, v108, s23
    v_mfma_f32_16x16x32_bf16 v[88:91], v[44:47], v[236:239], v[88:91]
    v_perm_b32 v109, v111, v110, s23
    v_mfma_f32_16x16x32_bf16 v[92:95], v[44:47], v[252:255], v[92:95]
    ds_write_b64 v64, v[108:109] offset:640
    s_nop 7
    v_perm_b32 v88, v89, v88, s23
    v_perm_b32 v89, v91, v90, s23
    ds_write_b64 v64, v[88:89] offset:768
    v_perm_b32 v92, v93, v92, s23
    v_perm_b32 v93, v95, v94, s23
    ds_write_b64 v64, v[92:93] offset:896
    v_add_u32 v64, 0x8000, v64

    s_mov_b32 s64, 0
    s_cmp_eq_u32 s3, 7
    s_cbranch_scc1 k1_kernel_k2w
    s_branch k1_kernel_k2j

k1_kernel_end:
    s_endpgm
k1_kernel_main:
    s_setprio 3
    s_mov_b32 s16, s4
    s_and_b32 s17, s5, 0xffff
    s_mov_b32 s20, s6
    s_and_b32 s21, s7, 0xffff
    s_mov_b32 s28, s10
    s_and_b32 s29, s11, 0xffff
    s_mov_b32 s32, s12
    s_and_b32 s33, s13, 0xffff
    s_and_b32 s13, s13, 0xffff
    s_and_b32 s53, s53, 0xffff

    v_and_b32 v5, 15, v255
    v_lshrrev_b32 v6, 4, v255
    v_and_b32 v7, 3, v255
    v_bfe_u32 v8, v255, 2, 2
    v_lshl_add_u32 v9, v7, 2, v8
    v_cmp_eq_u32 s[46:47], 0, v7
    s_movk_i32 s45, 200
    v_mov_b32 v10, 144384
    v_mad_u32_u24 v11, v9, s45, v10
    v_and_b32 v213, 48, v255
    v_add_u32 v128, v11, v213
    v_mul_u32_u24 v12, 6400, v6
    v_add_u32 v132, v11, v12
    v_and_b32 v12, 16, v255
    v_add_u32 v10, v10, v12
    v_add_u32 v11, v11, v12
    v_and_b32 v12, 32, v255
    v_mul_u32_u24 v12, 100, v12
    v_add_u32 v131, v11, v12
    v_and_b32 v12, 8, v255
    v_lshl_add_u32 v13, v7, 1, v12
    v_and_b32 v14, 1, v8
    v_add_u32 v13, v13, v14
    v_lshrrev_b32 v14, 5, v255
    v_lshl_add_u32 v14, v13, 1, v14
    v_mad_u32_u24 v129, v14, s45, v10
    v_lshl_add_u32 v130, v12, 2, v129
    v_lshlrev_b32 v15, 2, v6
    v_sub_u32 v13, v13, v15
    v_lshrrev_b32 v14, 1, v9
    v_sub_u32 v14, v14, v15
    v_sub_u32 v15, v5, v15
    v_and_b32 v12, 1, v9
    v_lshlrev_b32 v12, 4, v12
    v_mov_b32 v16, 0x3f80
    v_lshlrev_b32 v12, v12, v16
    v_mov_b32 v17, 0x3f800000

    v_cmp_eq_u32 vcc, 0, v13
    v_cndmask_b32 v120, 0, v16, vcc
    v_cmp_eq_u32 vcc, 0, v14
    v_cndmask_b32 v112, 0, v12, vcc
    v_cmp_eq_u32 vcc, -8, v14
    v_cndmask_b32 v116, 0, v12, vcc
    v_cmp_eq_u32 vcc, 0, v15
    v_cndmask_b32 v200, 0, v17, vcc
    v_lshlrev_b32 v124, 16, v120

    v_cmp_eq_u32 vcc, 1, v13
    v_cndmask_b32 v121, 0, v16, vcc
    v_cmp_eq_u32 vcc, 1, v14
    v_cndmask_b32 v113, 0, v12, vcc
    v_cmp_eq_u32 vcc, -7, v14
    v_cndmask_b32 v117, 0, v12, vcc
    v_cmp_eq_u32 vcc, 1, v15
    v_cndmask_b32 v201, 0, v17, vcc
    v_lshlrev_b32 v125, 16, v121

    v_cmp_eq_u32 vcc, 2, v13
    v_cndmask_b32 v122, 0, v16, vcc
    v_cmp_eq_u32 vcc, 2, v14
    v_cndmask_b32 v114, 0, v12, vcc
    v_cmp_eq_u32 vcc, -6, v14
    v_cndmask_b32 v118, 0, v12, vcc
    v_cmp_eq_u32 vcc, 2, v15
    v_cndmask_b32 v202, 0, v17, vcc
    v_lshlrev_b32 v126, 16, v122

    v_cmp_eq_u32 vcc, 3, v13
    v_cndmask_b32 v123, 0, v16, vcc
    v_cmp_eq_u32 vcc, 3, v14
    v_cndmask_b32 v115, 0, v12, vcc
    v_cmp_eq_u32 vcc, -5, v14
    v_cndmask_b32 v119, 0, v12, vcc
    v_cmp_eq_u32 vcc, 3, v15
    v_cndmask_b32 v203, 0, v17, vcc
    v_lshlrev_b32 v127, 16, v123

    s_mul_i32 s45, s3, 36864
    s_add_u32 s45, s45, 128
    s_movk_i32 s57, 144
    v_mov_b32 v10, s45
    v_mad_u32_u24 v214, v5, s57, v10
    v_mad_u32_u24 v218, v255, s57, v10
    v_add_u32 v218, 12, v218
    v_cmp_lt_u32 vcc, 25, v255
    v_subrev_u32 v11, 26, v255
    v_cndmask_b32 v11, v255, v11, vcc
    v_add_u32 v12, 2304, v10
    v_cndmask_b32 v10, v10, v12, vcc
    v_and_b32 v12, 3, v11
    v_mad_u32_u24 v10, v12, s57, v10
    v_lshrrev_b32 v11, 2, v11
    v_lshl_add_u32 v215, v11, 1, v10
    v_cmp_gt_u32 vcc, 52, v255
    v_add_u32 v11, 2304, v218
    v_cndmask_b32 v215, v11, v215, vcc
    v_mov_b32 v216, 0xdddddddd
    v_mov_b32 v219, 1000
    s_mov_b32 s60, 0xff00ff00
    s_mov_b32 s61, 0xff00ff00
    s_mov_b32 s62, -1
    s_mov_b32 s63, 0xffff

    s_waitcnt vmcnt(3)

    s_mov_b64 exec, 1
    ds_add_u32 v252, v253 offset:0
    s_mov_b64 exec, -1

k1_kernel_wf1:

    ds_read_b32 v251, v252 offset:0
    s_waitcnt lgkmcnt(0)
    v_readfirstlane_b32 s45, v251
    s_cmp_lt_u32 s45, 4
    s_cbranch_scc1 k1_kernel_wf1

    v_mov_b32 v72, 0
    v_mov_b32 v73, 0
    v_mov_b32 v74, 0
    v_mov_b32 v75, 0
    s_mov_b64 exec, s[62:63]
    ds_read_b64 v[72:73], v132 offset:192
    ds_read_b64 v[74:75], v132 offset:3392
    s_mov_b64 exec, -1
    ds_read_b64 v[76:77], v128 offset:16160
    ds_read_b64 v[78:79], v128 offset:16168
    ds_read_b64 v[80:81], v128 offset:0
    ds_read_b64 v[82:83], v128 offset:8
    ds_read_b64 v[84:85], v131 offset:0
    ds_read_b64 v[86:87], v131 offset:8
    s_waitcnt vmcnt(2)
    s_waitcnt lgkmcnt(4)
    v_mfma_f32_16x16x32_bf16 v[64:67], v[112:115], v[72:75], 0
    ds_read_b64 v[88:89], v128 offset:3232
    ds_read_b64 v[90:91], v128 offset:3240
    v_mfma_f32_16x16x32_bf16 v[68:71], v[116:119], v[72:75], 0
    v_mfma_f32_16x16x32_bf16 v[60:63], v[112:115], v[76:79], 0
    v_mfma_f32_16x16x32_bf16 v[64:67], v[232:235], v[112:115], v[64:67]
    v_mov_b32 v92, 0
    v_mov_b32 v93, 0
    v_mov_b32 v94, 0
    v_mov_b32 v95, 0
    s_mov_b64 exec, s[60:61]
    ds_read_b64 v[92:93], v129 offset:3232
    ds_read_b64 v[94:95], v129 offset:3240
    s_mov_b64 exec, -1
    v_mfma_f32_16x16x32_bf16 v[68:71], v[232:235], v[116:119], v[68:71]
    s_waitcnt lgkmcnt(4)
    v_mfma_f32_16x16x32_bf16 v[0:3], v[112:115], v[80:83], 0
    ds_read_b64 v[72:73], v128 offset:64
    ds_read_b64 v[74:75], v128 offset:72
    v_mfma_f32_16x16x32_bf16 v[4:7], v[116:119], v[80:83], 0
    v_mfma_f32_16x16x32_bf16 v[4:7], v[84:87], v[116:119], v[4:7]
    v_cndmask_b32 v70, 0, v70, s[46:47]
    ds_read_b64 v[76:77], v131 offset:6400
    ds_read_b64 v[78:79], v131 offset:6408
    s_waitcnt lgkmcnt(4)
    v_mfma_f32_16x16x32_bf16 v[96:99], v[120:123], v[88:91], 0
    ds_read_b64 v[80:81], v128 offset:9632
    ds_read_b64 v[82:83], v128 offset:9640
    v_mfma_f32_16x16x32_bf16 v[100:103], v[124:127], v[88:91], 0
    v_mfma_f32_16x16x32_bf16 v[96:99], v[92:95], v[112:115], v[96:99]
    v_mfma_f32_16x16x32_bf16 v[100:103], v[92:95], v[116:119], v[100:103]
    ds_read_b64 v[84:85], v129 offset:3296
    ds_read_b64 v[86:87], v129 offset:3304
    s_waitcnt lgkmcnt(4)
    v_mfma_f32_16x16x32_bf16 v[12:15], v[112:115], v[72:75], 0
    ds_read_b64 v[88:89], v128 offset:6464
    ds_read_b64 v[90:91], v128 offset:6472
    v_mfma_f32_16x16x32_bf16 v[16:19], v[116:119], v[72:75], 0
    v_cvt_pk_bf16_f32 v8, v96, v97
    v_cvt_pk_bf16_f32 v9, v98, v99
    v_mfma_f32_16x16x32_bf16 v[12:15], v[76:79], v[112:115], v[12:15]
    v_cvt_pk_bf16_f32 v10, v100, v101
    v_cvt_pk_bf16_f32 v11, v102, v103
    v_mfma_f32_16x16x32_bf16 v[16:19], v[76:79], v[116:119], v[16:19]
    ds_read_b64 v[92:93], v128 offset:9696
    ds_read_b64 v[94:95], v128 offset:9704
    s_waitcnt lgkmcnt(4)
    v_mfma_f32_16x16x32_bf16 v[96:99], v[120:123], v[80:83], 0
    ds_read_b64 v[72:73], v128 offset:128
    ds_read_b64 v[74:75], v128 offset:136
    v_mfma_f32_16x16x32_bf16 v[100:103], v[124:127], v[80:83], 0
    v_mfma_f32_16x16x32_bf16 v[96:99], v[84:87], v[112:115], v[96:99]
    v_mfma_f32_16x16x32_bf16 v[100:103], v[84:87], v[116:119], v[100:103]
    ds_read_b64 v[76:77], v129 offset:12800
    ds_read_b64 v[78:79], v129 offset:12808
    s_waitcnt lgkmcnt(4)
    v_mfma_f32_16x16x32_bf16 v[24:27], v[112:115], v[88:91], 0
    ds_read_b64 v[80:81], v128 offset:3328
    ds_read_b64 v[82:83], v128 offset:3336
    v_mfma_f32_16x16x32_bf16 v[28:31], v[112:115], v[92:95], 0
    v_cvt_pk_bf16_f32 v20, v96, v97
    v_cvt_pk_bf16_f32 v21, v98, v99
    s_nop 3
    v_cvt_pk_bf16_f32 v22, v100, v101
    v_cvt_pk_bf16_f32 v23, v102, v103
    ds_read_b64 v[84:85], v131 offset:12832
    ds_read_b64 v[86:87], v131 offset:12840
    s_waitcnt lgkmcnt(4)
    v_mfma_f32_16x16x32_bf16 v[96:99], v[120:123], v[72:75], 0
    ds_read_b64 v[88:89], v128 offset:6528
    ds_read_b64 v[90:91], v128 offset:6536
    v_mfma_f32_16x16x32_bf16 v[100:103], v[124:127], v[72:75], 0
    v_mfma_f32_16x16x32_bf16 v[96:99], v[76:79], v[112:115], v[96:99]
    v_mfma_f32_16x16x32_bf16 v[100:103], v[76:79], v[116:119], v[100:103]
    ds_read_b64 v[92:93], v129 offset:12864
    ds_read_b64 v[94:95], v129 offset:12872
    s_waitcnt lgkmcnt(4)
    v_mfma_f32_16x16x32_bf16 v[36:39], v[112:115], v[80:83], 0
    ds_read_b64 v[72:73], v128 offset:9728
    ds_read_b64 v[74:75], v128 offset:9736
    v_mfma_f32_16x16x32_bf16 v[40:43], v[116:119], v[80:83], 0
    v_cvt_pk_bf16_f32 v32, v96, v97
    v_cvt_pk_bf16_f32 v33, v98, v99
    v_mfma_f32_16x16x32_bf16 v[36:39], v[84:87], v[112:115], v[36:39]
    v_cvt_pk_bf16_f32 v34, v100, v101
    v_cvt_pk_bf16_f32 v35, v102, v103
    v_mfma_f32_16x16x32_bf16 v[40:43], v[84:87], v[116:119], v[40:43]
    ds_read_b64 v[76:77], v131 offset:12896
    ds_read_b64 v[78:79], v131 offset:12904
    s_waitcnt lgkmcnt(4)
    v_mfma_f32_16x16x32_bf16 v[96:99], v[120:123], v[88:91], 0
    ds_read_b64 v[80:81], v128 offset:12928
    ds_read_b64 v[82:83], v128 offset:12936
    v_mfma_f32_16x16x32_bf16 v[100:103], v[124:127], v[88:91], 0
    v_mfma_f32_16x16x32_bf16 v[96:99], v[92:95], v[112:115], v[96:99]
    v_mfma_f32_16x16x32_bf16 v[100:103], v[92:95], v[116:119], v[100:103]
    v_mov_b32 v84, 0
    v_mov_b32 v85, 0
    v_mov_b32 v86, 0
    v_mov_b32 v87, 0
    s_mov_b64 exec, s[60:61]
    ds_read_b64 v[84:85], v129 offset:12928
    ds_read_b64 v[86:87], v129 offset:12936
    s_mov_b64 exec, -1
    s_waitcnt lgkmcnt(4)
    v_mfma_f32_16x16x32_bf16 v[48:51], v[112:115], v[72:75], 0
    v_mfma_f32_16x16x32_bf16 v[52:55], v[116:119], v[72:75], 0
    v_cvt_pk_bf16_f32 v44, v96, v97
    v_cvt_pk_bf16_f32 v45, v98, v99
    v_mfma_f32_16x16x32_bf16 v[48:51], v[76:79], v[112:115], v[48:51]
    v_cvt_pk_bf16_f32 v46, v100, v101
    v_cvt_pk_bf16_f32 v47, v102, v103
    v_mfma_f32_16x16x32_bf16 v[52:55], v[76:79], v[116:119], v[52:55]
    s_waitcnt lgkmcnt(0)

    s_mov_b64 exec, 1
    ds_add_u32 v252, v253 offset:12
    s_mov_b64 exec, -1

    v_mfma_f32_16x16x32_bf16 v[96:99], v[120:123], v[80:83], 0
    v_mfma_f32_16x16x32_bf16 v[100:103], v[124:127], v[80:83], 0
    v_mfma_f32_16x16x32_bf16 v[96:99], v[84:87], v[112:115], v[96:99]
    v_mfma_f32_16x16x32_bf16 v[100:103], v[84:87], v[116:119], v[100:103]
    s_nop 7
    v_cvt_pk_bf16_f32 v56, v96, v97
    v_cvt_pk_bf16_f32 v57, v98, v99
    v_cvt_pk_bf16_f32 v58, v100, v101
    v_cvt_pk_bf16_f32 v59, v102, v103

    v_mov_b32_dpp v71, v70 row_shr:1 row_mask:0xf bank_mask:0xf bound_ctrl:0
    ds_write_b32 v218, v219
    v_and_b32 v217, 1, v255
    v_lshlrev_b32 v248, 1, v213
    v_lshl_add_u32 v248, v217, 2, v248
    v_mul_u32_u24 v208, 0xaaaa, v217
    v_mov_b32 v217, 0
    s_mov_b32 vcc_lo, 0x01010101
    s_mov_b32 vcc_hi, 0x01010101
    s_movk_i32 s58, 7

    v_mov_b64 v[172:173], 0
    v_mov_b64 v[176:177], 0
    v_mov_b64 v[180:181], 0
    v_mov_b64 v[184:185], 0
    v_mov_b64 v[188:189], 0
    v_mov_b64 v[192:193], 0
    v_mov_b64 v[196:197], 0
    v_mov_b64 v[198:199], 0
    s_waitcnt vmcnt(1)
    ds_write_b16 v215, v240 offset:0
    ds_write_b16 v215, v241 offset:576
    ds_write_b16 v215, v242 offset:1152
    ds_write_b16 v215, v243 offset:1728
    v_add_u32 v250, 0x4444, v208
    ds_read_b128 v[204:207], v214 offset:0
k1_kernel_wf2:

    ds_read_b32 v251, v252 offset:16
    s_waitcnt lgkmcnt(0)
    v_readfirstlane_b32 s45, v251
    s_cmp_lt_u32 s45, 4
    s_cbranch_scc1 k1_kernel_wf2

    s_setprio 2
    v_mad_u32_u16 v76, v204, s57, v213 op_sel:[0,0,0,0]
    ds_read_b128 v[72:75], v76 offset:0
    ds_read_b128 v[76:79], v76 offset:64
    v_mad_u32_u16 v84, v204, s57, v213 op_sel:[1,0,0,0]
    ds_read_b128 v[80:83], v84 offset:0
    ds_read_b128 v[84:87], v84 offset:64
    v_mad_u32_u16 v92, v205, s57, v213 op_sel:[0,0,0,0]
    ds_read_b128 v[88:91], v92 offset:0
    ds_read_b128 v[92:95], v92 offset:64
    v_mad_u32_u16 v100, v205, s57, v213 op_sel:[1,0,0,0]
    ds_read_b128 v[96:99], v100 offset:0
    ds_read_b128 v[100:103], v100 offset:64
    v_mad_u32_u16 v108, v206, s57, v213 op_sel:[0,0,0,0]
    ds_read_b128 v[104:107], v108 offset:0
    ds_read_b128 v[108:111], v108 offset:64
    buffer_load_dwordx4 v[240:243], v249, s[16:19], s74 offen offset:0
    s_waitcnt lgkmcnt(4)
    v_mad_u32_u16 v116, v206, s57, v213 op_sel:[1,0,0,0]
    ds_read_b128 v[112:115], v116 offset:0
k1_kernel_loop:
    v_mfma_f32_16x16x32_bf16 v[124:127], v[72:75], v[72:75], 0
    ds_read_b128 v[116:119], v116 offset:64
    v_mad_u32_u16 v122, v207, s57, v248 op_sel:[0,0,0,0]
    ds_read2_b32 v[120:121], v122 offset0:0 offset1:2
    v_mfma_f32_16x16x32_bf16 v[124:127], v[76:79], v[76:79], v[124:127]
    ds_read2_b32 v[122:123], v122 offset0:4 offset1:6
    ds_read_b128 v[204:207], v214 offset:2304
    v_mfma_f32_16x16x32_bf16 v[128:131], v[80:83], v[72:75], 0
    v_fmac_f32 v217, v189, v68
    v_fmac_f32 v217, v196, v200
    v_mfma_f32_16x16x32_bf16 v[128:131], v[84:87], v[76:79], v[128:131]
    v_fmac_f32 v217, v192, v69
    v_fmac_f32 v217, v197, v201
    v_mfma_f32_16x16x32_bf16 v[132:135], v[80:83], v[80:83], 0
    v_fmac_f32 v217, v193, v69
    v_fmac_f32 v217, v198, v202
    v_mfma_f32_16x16x32_bf16 v[132:135], v[84:87], v[84:87], v[132:135]
    v_fmac_f32 v217, v199, v203
    v_fmac_f32 v209, v153, v53
    v_mfma_f32_16x16x32_bf16 v[136:139], v[88:91], v[80:83], 0
    v_fmac_f32 v208, v154, v54
    v_fmac_f32 v209, v155, v55
    v_mfma_f32_16x16x32_bf16 v[136:139], v[92:95], v[84:87], v[136:139]
    v_fmac_f32 v208, v164, v60
    v_fmac_f32 v209, v165, v61
    v_mfma_f32_16x16x32_bf16 v[140:143], v[88:91], v[72:75], 0
    v_fmac_f32 v208, v166, v62
    v_fmac_f32 v209, v167, v63
    v_mfma_f32_16x16x32_bf16 v[140:143], v[92:95], v[76:79], v[140:143]
    s_waitcnt lgkmcnt(7)
    v_add_f32 v209, v209, v217
    v_smfmac_f32_16x16x64_bf16 v[196:199], v[8:11], v[132:139], v216
    v_fmac_f32 v208, v168, v70
    v_mfma_f32_16x16x32_bf16 v[144:147], v[96:99], v[72:75], 0
    v_fmac_f32 v208, v169, v71
    v_add_f32 v211, v208, v209
    v_mfma_f32_16x16x32_bf16 v[144:147], v[100:103], v[76:79], v[144:147]
    v_fma_f32 v208, v124, v0, -v217
    v_mul_f32 v209, v125, v1
    v_mfma_f32_16x16x32_bf16 v[148:151], v[80:83], v[96:99], 0
    v_fmac_f32 v208, v126, v2
    v_fmac_f32 v209, v127, v3
    v_mfma_f32_16x16x32_bf16 v[148:151], v[84:87], v[100:103], v[148:151]
    v_fmac_f32 v208, v128, v4
    v_fmac_f32 v209, v129, v5
    v_mfma_f32_16x16x32_bf16 v[152:155], v[88:91], v[96:99], 0
    v_fmac_f32 v208, v130, v6
    v_fmac_f32 v209, v131, v7
    v_mfma_f32_16x16x32_bf16 v[152:155], v[92:95], v[100:103], v[152:155]
    v_fmac_f32 v208, v140, v12
    v_fmac_f32 v209, v141, v13
    v_mfma_f32_16x16x32_bf16 v[156:159], v[88:91], v[88:91], 0
    v_fmac_f32 v208, v142, v14
    v_fmac_f32 v209, v143, v15
    v_mfma_f32_16x16x32_bf16 v[156:159], v[92:95], v[92:95], v[156:159]
    v_fmac_f32 v208, v144, v16
    v_fmac_f32 v209, v145, v17
    v_smfmac_f32_16x16x64_bf16 v[196:199], v[20:23], v[148:155], v216
    v_fmac_f32 v208, v146, v18
    v_mfma_f32_16x16x32_bf16 v[160:163], v[96:99], v[96:99], 0
    s_waitcnt lgkmcnt(0)
    v_fmac_f32 v209, v147, v19
    v_mfma_f32_16x16x32_bf16 v[160:163], v[100:103], v[100:103], v[160:163]
    v_fmac_f32 v208, v156, v24
    v_fmac_f32 v209, v157, v25
    v_mfma_f32_16x16x32_bf16 v[124:127], v[104:107], v[72:75], 0
    v_fmac_f32 v208, v158, v26
    v_fmac_f32 v209, v159, v27
    v_mfma_f32_16x16x32_bf16 v[124:127], v[108:111], v[76:79], v[124:127]
    v_permlane32_swap_b32 v210, v211
    s_waitcnt vmcnt(1)
    v_mfma_f32_16x16x32_bf16 v[128:131], v[112:115], v[72:75], 0
    v_fmac_f32 v208, v160, v28
    v_fmac_f32 v209, v161, v29
    v_mfma_f32_16x16x32_bf16 v[128:131], v[116:119], v[76:79], v[128:131]
    v_fmac_f32 v208, v162, v30
    v_fmac_f32 v209, v163, v31
    v_smfmac_f32_16x16x64_bf16 v[172:175], v[120:123], v[72:79], v250
    v_mad_u32_u16 v76, v204, s57, v213 op_sel:[0,0,0,0]
    v_mfma_f32_16x16x32_bf16 v[132:135], v[104:107], v[80:83], 0
    ds_read_b128 v[72:75], v76 offset:0
    ds_read_b128 v[76:79], v76 offset:64
    v_smfmac_f32_16x16x64_bf16 v[196:199], v[32:35], v[124:131], v216
    v_add_f32 v219, v210, v211
    v_mfma_f32_16x16x32_bf16 v[132:135], v[108:111], v[84:87], v[132:135]
    v_mul_f32 v217, v172, v64
    ds_write_b16 v215, v244 offset:4608
    v_mfma_f32_16x16x32_bf16 v[136:139], v[112:115], v[80:83], 0
    v_fmac_f32 v217, v173, v64
    ds_write_b16 v215, v245 offset:5184
    v_mfma_f32_16x16x32_bf16 v[136:139], v[116:119], v[84:87], v[136:139]
    ds_write_b16 v215, v246 offset:5760
    ds_write_b16 v215, v247 offset:6336
    v_smfmac_f32_16x16x64_bf16 v[176:179], v[120:123], v[80:87], v250
    v_mad_u32_u16 v84, v204, s57, v213 op_sel:[1,0,0,0]
    v_mfma_f32_16x16x32_bf16 v[140:143], v[104:107], v[88:91], 0
    ds_read_b128 v[80:83], v84 offset:0
    ds_read_b128 v[84:87], v84 offset:64
    v_mfma_f32_16x16x32_bf16 v[140:143], v[108:111], v[92:95], v[140:143]
    v_fmac_f32 v208, v132, v36
    v_fmac_f32 v209, v133, v37
    v_mfma_f32_16x16x32_bf16 v[144:147], v[112:115], v[88:91], 0
    v_fmac_f32 v217, v176, v65
    v_fmac_f32 v208, v134, v38
    v_mfma_f32_16x16x32_bf16 v[144:147], v[116:119], v[92:95], v[144:147]
    v_fmac_f32 v217, v177, v65
    v_fmac_f32 v209, v135, v39
    v_smfmac_f32_16x16x64_bf16 v[180:183], v[120:123], v[88:95], v250
    v_mad_u32_u16 v92, v205, s57, v213 op_sel:[0,0,0,0]
    v_mfma_f32_16x16x32_bf16 v[148:151], v[104:107], v[96:99], 0
    ds_read_b128 v[88:91], v92 offset:0
    ds_read_b128 v[92:95], v92 offset:64
    v_smfmac_f32_16x16x64_bf16 v[196:199], v[44:47], v[140:147], v216
    v_fmac_f32 v208, v136, v40
    v_mfma_f32_16x16x32_bf16 v[148:151], v[108:111], v[100:103], v[148:151]
    v_fmac_f32 v217, v180, v66
    v_fmac_f32 v209, v137, v41
    v_mfma_f32_16x16x32_bf16 v[152:155], v[112:115], v[96:99], 0
    v_fmac_f32 v217, v181, v66
    v_fmac_f32 v208, v138, v42
    v_mfma_f32_16x16x32_bf16 v[152:155], v[116:119], v[100:103], v[152:155]
    v_fmac_f32 v209, v139, v43
    buffer_load_dwordx4 v[244:247], v249, s[16:19], s74 offen offset:800
    v_smfmac_f32_16x16x64_bf16 v[184:187], v[120:123], v[96:103], v250
    v_mad_u32_u16 v100, v205, s57, v213 op_sel:[1,0,0,0]
    v_mfma_f32_16x16x32_bf16 v[156:159], v[104:107], v[104:107], 0
    ds_read_b128 v[96:99], v100 offset:0
    ds_read_b128 v[100:103], v100 offset:64
    v_mfma_f32_16x16x32_bf16 v[156:159], v[108:111], v[108:111], v[156:159]
    v_fmac_f32 v208, v148, v48
    v_fmac_f32 v209, v149, v49
    v_mfma_f32_16x16x32_bf16 v[160:163], v[112:115], v[104:107], 0
    v_fmac_f32 v217, v184, v67
    v_fmac_f32 v208, v150, v50
    v_mfma_f32_16x16x32_bf16 v[160:163], v[116:119], v[108:111], v[160:163]
    v_fmac_f32 v217, v185, v67
    v_fmac_f32 v209, v151, v51
    v_smfmac_f32_16x16x64_bf16 v[188:191], v[120:123], v[104:111], v250
    v_mad_u32_u16 v108, v206, s57, v213 op_sel:[0,0,0,0]
    v_mfma_f32_16x16x32_bf16 v[164:167], v[112:115], v[112:115], 0
    ds_read_b128 v[104:107], v108 offset:0
    ds_read_b128 v[108:111], v108 offset:64
    v_smfmac_f32_16x16x64_bf16 v[196:199], v[56:59], v[156:163], v216
    s_waitcnt lgkmcnt(4)
    v_mfma_f32_16x16x32_bf16 v[164:167], v[116:119], v[116:119], v[164:167]
    v_fmac_f32 v217, v188, v68
    v_fmac_f32 v208, v152, v52
    v_smfmac_f32_16x16x64_bf16 v[192:195], v[120:123], v[112:119], v250
    v_mad_u32_u16 v116, v206, s57, v213 op_sel:[1,0,0,0]
    v_mfma_f32_16x16x32_bf16 v[168:171], v[120:123], v[120:123], 0
    ds_read_b128 v[112:115], v116 offset:0
    v_mfma_f32_16x16x32_bf16 v[124:127], v[72:75], v[72:75], 0
    ds_read_b128 v[116:119], v116 offset:64
    v_mad_u32_u16 v122, v207, s57, v248 op_sel:[0,0,0,0]
    ds_read2_b32 v[120:121], v122 offset0:0 offset1:2
    v_mfma_f32_16x16x32_bf16 v[124:127], v[76:79], v[76:79], v[124:127]
    ds_read2_b32 v[122:123], v122 offset0:4 offset1:6
    ds_read_b128 v[204:207], v214 offset:4608
    v_mfma_f32_16x16x32_bf16 v[128:131], v[80:83], v[72:75], 0
    v_fmac_f32 v217, v189, v68
    v_fmac_f32 v217, v196, v200
    v_mfma_f32_16x16x32_bf16 v[128:131], v[84:87], v[76:79], v[128:131]
    v_fmac_f32 v217, v192, v69
    v_fmac_f32 v217, v197, v201
    v_mfma_f32_16x16x32_bf16 v[132:135], v[80:83], v[80:83], 0
    v_fmac_f32 v217, v193, v69
    v_fmac_f32 v217, v198, v202
    v_mfma_f32_16x16x32_bf16 v[132:135], v[84:87], v[84:87], v[132:135]
    v_fmac_f32 v217, v199, v203
    v_fmac_f32 v209, v153, v53
    v_mfma_f32_16x16x32_bf16 v[136:139], v[88:91], v[80:83], 0
    v_fmac_f32 v208, v154, v54
    v_fmac_f32 v209, v155, v55
    v_mfma_f32_16x16x32_bf16 v[136:139], v[92:95], v[84:87], v[136:139]
    v_fmac_f32 v208, v164, v60
    v_fmac_f32 v209, v165, v61
    v_mfma_f32_16x16x32_bf16 v[140:143], v[88:91], v[72:75], 0
    v_fmac_f32 v208, v166, v62
    v_fmac_f32 v209, v167, v63
    v_mfma_f32_16x16x32_bf16 v[140:143], v[92:95], v[76:79], v[140:143]
    s_waitcnt lgkmcnt(7)
    v_add_f32 v209, v209, v217
    v_smfmac_f32_16x16x64_bf16 v[196:199], v[8:11], v[132:139], v216
    v_fmac_f32 v208, v168, v70
    v_mfma_f32_16x16x32_bf16 v[144:147], v[96:99], v[72:75], 0
    v_fmac_f32 v208, v169, v71
    v_add_f32 v210, v208, v209
    v_mfma_f32_16x16x32_bf16 v[144:147], v[100:103], v[76:79], v[144:147]
    v_fma_f32 v208, v124, v0, -v217
    v_mul_f32 v209, v125, v1
    v_mfma_f32_16x16x32_bf16 v[148:151], v[80:83], v[96:99], 0
    v_fmac_f32 v208, v126, v2
    v_fmac_f32 v209, v127, v3
    v_mfma_f32_16x16x32_bf16 v[148:151], v[84:87], v[100:103], v[148:151]
    v_fmac_f32 v208, v128, v4
    v_fmac_f32 v209, v129, v5
    v_mfma_f32_16x16x32_bf16 v[152:155], v[88:91], v[96:99], 0
    v_fmac_f32 v208, v130, v6
    v_fmac_f32 v209, v131, v7
    v_mfma_f32_16x16x32_bf16 v[152:155], v[92:95], v[100:103], v[152:155]
    v_fmac_f32 v208, v140, v12
    v_fmac_f32 v209, v141, v13
    v_mfma_f32_16x16x32_bf16 v[156:159], v[88:91], v[88:91], 0
    v_fmac_f32 v208, v142, v14
    v_fmac_f32 v209, v143, v15
    v_mfma_f32_16x16x32_bf16 v[156:159], v[92:95], v[92:95], v[156:159]
    v_fmac_f32 v208, v144, v16
    v_fmac_f32 v209, v145, v17
    v_smfmac_f32_16x16x64_bf16 v[196:199], v[20:23], v[148:155], v216
    v_fmac_f32 v208, v146, v18
    v_mfma_f32_16x16x32_bf16 v[160:163], v[96:99], v[96:99], 0
    s_waitcnt lgkmcnt(0)
    v_fmac_f32 v209, v147, v19
    v_mfma_f32_16x16x32_bf16 v[160:163], v[100:103], v[100:103], v[160:163]
    v_fmac_f32 v208, v156, v24
    v_fmac_f32 v209, v157, v25
    v_mfma_f32_16x16x32_bf16 v[124:127], v[104:107], v[72:75], 0
    v_fmac_f32 v208, v158, v26
    v_fmac_f32 v209, v159, v27
    v_mfma_f32_16x16x32_bf16 v[124:127], v[108:111], v[76:79], v[124:127]
    v_permlane16_swap_b32 v218, v219
    s_add_u32 s74, s74, s77
    v_mfma_f32_16x16x32_bf16 v[128:131], v[112:115], v[72:75], 0
    v_fmac_f32 v208, v160, v28
    v_fmac_f32 v209, v161, v29
    v_mfma_f32_16x16x32_bf16 v[128:131], v[116:119], v[76:79], v[128:131]
    v_fmac_f32 v208, v162, v30
    v_fmac_f32 v209, v163, v31
    v_smfmac_f32_16x16x64_bf16 v[172:175], v[120:123], v[72:79], v250
    v_mad_u32_u16 v76, v204, s57, v213 op_sel:[0,0,0,0]
    v_mfma_f32_16x16x32_bf16 v[132:135], v[104:107], v[80:83], 0
    ds_read_b128 v[72:75], v76 offset:0
    ds_read_b128 v[76:79], v76 offset:64
    v_smfmac_f32_16x16x64_bf16 v[196:199], v[32:35], v[124:131], v216
    v_add_f32 v220, v218, v219
    v_mfma_f32_16x16x32_bf16 v[132:135], v[108:111], v[84:87], v[132:135]
    v_mul_f32 v217, v172, v64
    s_min_i32 s74, s74, s79
    v_mfma_f32_16x16x32_bf16 v[136:139], v[112:115], v[80:83], 0
    v_fmac_f32 v217, v173, v64
    s_max_i32 s74, s74, s78
    v_mfma_f32_16x16x32_bf16 v[136:139], v[116:119], v[84:87], v[136:139]
    v_smfmac_f32_16x16x64_bf16 v[176:179], v[120:123], v[80:87], v250
    v_mad_u32_u16 v84, v204, s57, v213 op_sel:[1,0,0,0]
    v_mfma_f32_16x16x32_bf16 v[140:143], v[104:107], v[88:91], 0
    ds_read_b128 v[80:83], v84 offset:0
    ds_read_b128 v[84:87], v84 offset:64
    v_mfma_f32_16x16x32_bf16 v[140:143], v[108:111], v[92:95], v[140:143]
    v_fmac_f32 v208, v132, v36
    v_fmac_f32 v209, v133, v37
    v_mfma_f32_16x16x32_bf16 v[144:147], v[112:115], v[88:91], 0
    v_fmac_f32 v217, v176, v65
    v_fmac_f32 v208, v134, v38
    v_mfma_f32_16x16x32_bf16 v[144:147], v[116:119], v[92:95], v[144:147]
    v_fmac_f32 v217, v177, v65
    v_fmac_f32 v209, v135, v39
    v_smfmac_f32_16x16x64_bf16 v[180:183], v[120:123], v[88:95], v250
    v_mad_u32_u16 v92, v205, s57, v213 op_sel:[0,0,0,0]
    v_mfma_f32_16x16x32_bf16 v[148:151], v[104:107], v[96:99], 0
    ds_read_b128 v[88:91], v92 offset:0
    ds_read_b128 v[92:95], v92 offset:64
    v_smfmac_f32_16x16x64_bf16 v[196:199], v[44:47], v[140:147], v216
    v_fmac_f32 v208, v136, v40
    v_mfma_f32_16x16x32_bf16 v[148:151], v[108:111], v[100:103], v[148:151]
    v_fmac_f32 v217, v180, v66
    v_fmac_f32 v209, v137, v41
    v_mfma_f32_16x16x32_bf16 v[152:155], v[112:115], v[96:99], 0
    v_fmac_f32 v217, v181, v66
    v_fmac_f32 v208, v138, v42
    v_mfma_f32_16x16x32_bf16 v[152:155], v[116:119], v[100:103], v[152:155]
    v_fmac_f32 v209, v139, v43
    v_smfmac_f32_16x16x64_bf16 v[184:187], v[120:123], v[96:103], v250
    v_mad_u32_u16 v100, v205, s57, v213 op_sel:[1,0,0,0]
    v_mfma_f32_16x16x32_bf16 v[156:159], v[104:107], v[104:107], 0
    ds_read_b128 v[96:99], v100 offset:0
    ds_read_b128 v[100:103], v100 offset:64
    v_mfma_f32_16x16x32_bf16 v[156:159], v[108:111], v[108:111], v[156:159]
    v_fmac_f32 v208, v148, v48
    v_fmac_f32 v209, v149, v49
    v_mfma_f32_16x16x32_bf16 v[160:163], v[112:115], v[104:107], 0
    v_fmac_f32 v217, v184, v67
    v_fmac_f32 v208, v150, v50
    v_mfma_f32_16x16x32_bf16 v[160:163], v[116:119], v[108:111], v[160:163]
    v_fmac_f32 v217, v185, v67
    v_fmac_f32 v209, v151, v51
    v_smfmac_f32_16x16x64_bf16 v[188:191], v[120:123], v[104:111], v250
    v_mad_u32_u16 v108, v206, s57, v213 op_sel:[0,0,0,0]
    v_mfma_f32_16x16x32_bf16 v[164:167], v[112:115], v[112:115], 0
    ds_read_b128 v[104:107], v108 offset:0
    ds_read_b128 v[108:111], v108 offset:64
    v_smfmac_f32_16x16x64_bf16 v[196:199], v[56:59], v[156:163], v216
    s_waitcnt lgkmcnt(4)
    v_mfma_f32_16x16x32_bf16 v[164:167], v[116:119], v[116:119], v[164:167]
    v_fmac_f32 v217, v188, v68
    v_fmac_f32 v208, v152, v52
    v_smfmac_f32_16x16x64_bf16 v[192:195], v[120:123], v[112:119], v250
    v_mad_u32_u16 v116, v206, s57, v213 op_sel:[1,0,0,0]
    v_mfma_f32_16x16x32_bf16 v[168:171], v[120:123], v[120:123], 0
    ds_read_b128 v[112:115], v116 offset:0
    v_mfma_f32_16x16x32_bf16 v[124:127], v[72:75], v[72:75], 0
    ds_read_b128 v[116:119], v116 offset:64
    v_mad_u32_u16 v122, v207, s57, v248 op_sel:[0,0,0,0]
    ds_read2_b32 v[120:121], v122 offset0:0 offset1:2
    v_mfma_f32_16x16x32_bf16 v[124:127], v[76:79], v[76:79], v[124:127]
    ds_read2_b32 v[122:123], v122 offset0:4 offset1:6
    ds_read_b128 v[204:207], v214 offset:6912
    v_mfma_f32_16x16x32_bf16 v[128:131], v[80:83], v[72:75], 0
    v_fmac_f32 v217, v189, v68
    v_fmac_f32 v217, v196, v200
    v_mfma_f32_16x16x32_bf16 v[128:131], v[84:87], v[76:79], v[128:131]
    v_fmac_f32 v217, v192, v69
    v_fmac_f32 v217, v197, v201
    v_mfma_f32_16x16x32_bf16 v[132:135], v[80:83], v[80:83], 0
    v_fmac_f32 v217, v193, v69
    v_fmac_f32 v217, v198, v202
    v_mfma_f32_16x16x32_bf16 v[132:135], v[84:87], v[84:87], v[132:135]
    v_fmac_f32 v217, v199, v203
    v_fmac_f32 v209, v153, v53
    v_mfma_f32_16x16x32_bf16 v[136:139], v[88:91], v[80:83], 0
    v_fmac_f32 v208, v154, v54
    v_fmac_f32 v209, v155, v55
    v_mfma_f32_16x16x32_bf16 v[136:139], v[92:95], v[84:87], v[136:139]
    v_fmac_f32 v208, v164, v60
    v_fmac_f32 v209, v165, v61
    v_mfma_f32_16x16x32_bf16 v[140:143], v[88:91], v[72:75], 0
    v_fmac_f32 v208, v166, v62
    v_fmac_f32 v209, v167, v63
    v_mfma_f32_16x16x32_bf16 v[140:143], v[92:95], v[76:79], v[140:143]
    s_waitcnt lgkmcnt(7)
    v_add_f32 v209, v209, v217
    v_smfmac_f32_16x16x64_bf16 v[196:199], v[8:11], v[132:139], v216
    v_fmac_f32 v208, v168, v70
    v_mfma_f32_16x16x32_bf16 v[144:147], v[96:99], v[72:75], 0
    v_fmac_f32 v208, v169, v71
    v_add_f32 v211, v208, v209
    v_mfma_f32_16x16x32_bf16 v[144:147], v[100:103], v[76:79], v[144:147]
    v_fma_f32 v208, v124, v0, -v217
    v_mul_f32 v209, v125, v1
    v_mfma_f32_16x16x32_bf16 v[148:151], v[80:83], v[96:99], 0
    v_fmac_f32 v208, v126, v2
    v_fmac_f32 v209, v127, v3
    v_mfma_f32_16x16x32_bf16 v[148:151], v[84:87], v[100:103], v[148:151]
    v_fmac_f32 v208, v128, v4
    v_fmac_f32 v209, v129, v5
    v_mfma_f32_16x16x32_bf16 v[152:155], v[88:91], v[96:99], 0
    v_fmac_f32 v208, v130, v6
    v_fmac_f32 v209, v131, v7
    v_mfma_f32_16x16x32_bf16 v[152:155], v[92:95], v[100:103], v[152:155]
    v_fmac_f32 v208, v140, v12
    v_fmac_f32 v209, v141, v13
    v_mfma_f32_16x16x32_bf16 v[156:159], v[88:91], v[88:91], 0
    v_fmac_f32 v208, v142, v14
    v_fmac_f32 v209, v143, v15
    v_mfma_f32_16x16x32_bf16 v[156:159], v[92:95], v[92:95], v[156:159]
    v_fmac_f32 v208, v144, v16
    v_fmac_f32 v209, v145, v17
    v_smfmac_f32_16x16x64_bf16 v[196:199], v[20:23], v[148:155], v216
    v_fmac_f32 v208, v146, v18
    v_mfma_f32_16x16x32_bf16 v[160:163], v[96:99], v[96:99], 0
    s_waitcnt lgkmcnt(0)
    v_fmac_f32 v209, v147, v19
    v_mfma_f32_16x16x32_bf16 v[160:163], v[100:103], v[100:103], v[160:163]
    v_fmac_f32 v208, v156, v24
    v_fmac_f32 v209, v157, v25
    v_mfma_f32_16x16x32_bf16 v[124:127], v[104:107], v[72:75], 0
    v_fmac_f32 v208, v158, v26
    v_fmac_f32 v209, v159, v27
    v_mfma_f32_16x16x32_bf16 v[124:127], v[108:111], v[76:79], v[124:127]
    v_permlane32_swap_b32 v210, v211
    s_waitcnt vmcnt(1)
    v_mfma_f32_16x16x32_bf16 v[128:131], v[112:115], v[72:75], 0
    v_fmac_f32 v208, v160, v28
    v_fmac_f32 v209, v161, v29
    v_mfma_f32_16x16x32_bf16 v[128:131], v[116:119], v[76:79], v[128:131]
    v_fmac_f32 v208, v162, v30
    v_fmac_f32 v209, v163, v31
    v_smfmac_f32_16x16x64_bf16 v[172:175], v[120:123], v[72:79], v250
    v_mad_u32_u16 v76, v204, s57, v213 op_sel:[0,0,0,0]
    v_mfma_f32_16x16x32_bf16 v[132:135], v[104:107], v[80:83], 0
    ds_read_b128 v[72:75], v76 offset:0
    ds_read_b128 v[76:79], v76 offset:64
    v_smfmac_f32_16x16x64_bf16 v[196:199], v[32:35], v[124:131], v216
    v_add_f32 v218, v210, v211
    v_mfma_f32_16x16x32_bf16 v[132:135], v[108:111], v[84:87], v[132:135]
    v_mul_f32 v217, v172, v64
    ds_write_b16 v215, v240 offset:0
    v_mfma_f32_16x16x32_bf16 v[136:139], v[112:115], v[80:83], 0
    v_fmac_f32 v217, v173, v64
    ds_write_b16 v215, v241 offset:576
    v_mfma_f32_16x16x32_bf16 v[136:139], v[116:119], v[84:87], v[136:139]
    ds_write_b16 v215, v242 offset:1152
    ds_write_b16 v215, v243 offset:1728
    v_smfmac_f32_16x16x64_bf16 v[176:179], v[120:123], v[80:87], v250
    v_mad_u32_u16 v84, v204, s57, v213 op_sel:[1,0,0,0]
    v_mfma_f32_16x16x32_bf16 v[140:143], v[104:107], v[88:91], 0
    ds_read_b128 v[80:83], v84 offset:0
    ds_read_b128 v[84:87], v84 offset:64
    v_mfma_f32_16x16x32_bf16 v[140:143], v[108:111], v[92:95], v[140:143]
    v_fmac_f32 v208, v132, v36
    v_fmac_f32 v209, v133, v37
    v_mfma_f32_16x16x32_bf16 v[144:147], v[112:115], v[88:91], 0
    v_fmac_f32 v217, v176, v65
    v_fmac_f32 v208, v134, v38
    v_mfma_f32_16x16x32_bf16 v[144:147], v[116:119], v[92:95], v[144:147]
    v_fmac_f32 v217, v177, v65
    v_fmac_f32 v209, v135, v39
    v_smfmac_f32_16x16x64_bf16 v[180:183], v[120:123], v[88:95], v250
    v_mad_u32_u16 v92, v205, s57, v213 op_sel:[0,0,0,0]
    v_mfma_f32_16x16x32_bf16 v[148:151], v[104:107], v[96:99], 0
    ds_read_b128 v[88:91], v92 offset:0
    ds_read_b128 v[92:95], v92 offset:64
    v_smfmac_f32_16x16x64_bf16 v[196:199], v[44:47], v[140:147], v216
    v_fmac_f32 v208, v136, v40
    v_mfma_f32_16x16x32_bf16 v[148:151], v[108:111], v[100:103], v[148:151]
    v_fmac_f32 v217, v180, v66
    v_fmac_f32 v209, v137, v41
    v_mfma_f32_16x16x32_bf16 v[152:155], v[112:115], v[96:99], 0
    v_fmac_f32 v217, v181, v66
    v_fmac_f32 v208, v138, v42
    v_mfma_f32_16x16x32_bf16 v[152:155], v[116:119], v[100:103], v[152:155]
    v_fmac_f32 v209, v139, v43
    buffer_load_dwordx4 v[240:243], v249, s[16:19], s74 offen offset:0
    v_smfmac_f32_16x16x64_bf16 v[184:187], v[120:123], v[96:103], v250
    v_mad_u32_u16 v100, v205, s57, v213 op_sel:[1,0,0,0]
    v_mfma_f32_16x16x32_bf16 v[156:159], v[104:107], v[104:107], 0
    ds_read_b128 v[96:99], v100 offset:0
    ds_read_b128 v[100:103], v100 offset:64
    v_mfma_f32_16x16x32_bf16 v[156:159], v[108:111], v[108:111], v[156:159]
    v_fmac_f32 v208, v148, v48
    v_fmac_f32 v209, v149, v49
    v_mfma_f32_16x16x32_bf16 v[160:163], v[112:115], v[104:107], 0
    v_fmac_f32 v217, v184, v67
    v_fmac_f32 v208, v150, v50
    v_mfma_f32_16x16x32_bf16 v[160:163], v[116:119], v[108:111], v[160:163]
    v_fmac_f32 v217, v185, v67
    v_fmac_f32 v209, v151, v51
    v_smfmac_f32_16x16x64_bf16 v[188:191], v[120:123], v[104:111], v250
    v_mad_u32_u16 v108, v206, s57, v213 op_sel:[0,0,0,0]
    v_mfma_f32_16x16x32_bf16 v[164:167], v[112:115], v[112:115], 0
    ds_read_b128 v[104:107], v108 offset:0
    ds_read_b128 v[108:111], v108 offset:64
    v_smfmac_f32_16x16x64_bf16 v[196:199], v[56:59], v[156:163], v216
    s_waitcnt lgkmcnt(4)
    v_mfma_f32_16x16x32_bf16 v[164:167], v[116:119], v[116:119], v[164:167]
    v_fmac_f32 v217, v188, v68
    v_fmac_f32 v208, v152, v52
    v_smfmac_f32_16x16x64_bf16 v[192:195], v[120:123], v[112:119], v250
    v_mad_u32_u16 v116, v206, s57, v213 op_sel:[1,0,0,0]
    v_mfma_f32_16x16x32_bf16 v[168:171], v[120:123], v[120:123], 0
    ds_read_b128 v[112:115], v116 offset:0
    v_mfma_f32_16x16x32_bf16 v[124:127], v[72:75], v[72:75], 0
    ds_read_b128 v[116:119], v116 offset:64
    v_mad_u32_u16 v122, v207, s57, v248 op_sel:[0,0,0,0]
    ds_read2_b32 v[120:121], v122 offset0:0 offset1:2
    v_mfma_f32_16x16x32_bf16 v[124:127], v[76:79], v[76:79], v[124:127]
    ds_read2_b32 v[122:123], v122 offset0:4 offset1:6
    ds_read_b128 v[204:207], v214 offset:0
    v_mfma_f32_16x16x32_bf16 v[128:131], v[80:83], v[72:75], 0
    v_fmac_f32 v217, v189, v68
    v_fmac_f32 v217, v196, v200
    v_mfma_f32_16x16x32_bf16 v[128:131], v[84:87], v[76:79], v[128:131]
    v_fmac_f32 v217, v192, v69
    v_fmac_f32 v217, v197, v201
    v_mfma_f32_16x16x32_bf16 v[132:135], v[80:83], v[80:83], 0
    v_fmac_f32 v217, v193, v69
    v_fmac_f32 v217, v198, v202
    v_mfma_f32_16x16x32_bf16 v[132:135], v[84:87], v[84:87], v[132:135]
    v_fmac_f32 v217, v199, v203
    v_fmac_f32 v209, v153, v53
    v_mfma_f32_16x16x32_bf16 v[136:139], v[88:91], v[80:83], 0
    v_fmac_f32 v208, v154, v54
    v_fmac_f32 v209, v155, v55
    v_mfma_f32_16x16x32_bf16 v[136:139], v[92:95], v[84:87], v[136:139]
    v_fmac_f32 v208, v164, v60
    v_fmac_f32 v209, v165, v61
    v_mfma_f32_16x16x32_bf16 v[140:143], v[88:91], v[72:75], 0
    v_fmac_f32 v208, v166, v62
    v_fmac_f32 v209, v167, v63
    v_mfma_f32_16x16x32_bf16 v[140:143], v[92:95], v[76:79], v[140:143]
    s_waitcnt lgkmcnt(7)
    v_add_f32 v209, v209, v217
    v_smfmac_f32_16x16x64_bf16 v[196:199], v[8:11], v[132:139], v216
    v_fmac_f32 v208, v168, v70
    v_mfma_f32_16x16x32_bf16 v[144:147], v[96:99], v[72:75], 0
    v_fmac_f32 v208, v169, v71
    v_add_f32 v210, v208, v209
    v_mfma_f32_16x16x32_bf16 v[144:147], v[100:103], v[76:79], v[144:147]
    v_fma_f32 v208, v124, v0, -v217
    v_mul_f32 v209, v125, v1
    v_mfma_f32_16x16x32_bf16 v[148:151], v[80:83], v[96:99], 0
    v_fmac_f32 v208, v126, v2
    v_fmac_f32 v209, v127, v3
    v_mfma_f32_16x16x32_bf16 v[148:151], v[84:87], v[100:103], v[148:151]
    v_fmac_f32 v208, v128, v4
    v_fmac_f32 v209, v129, v5
    v_mfma_f32_16x16x32_bf16 v[152:155], v[88:91], v[96:99], 0
    v_fmac_f32 v208, v130, v6
    v_fmac_f32 v209, v131, v7
    v_mfma_f32_16x16x32_bf16 v[152:155], v[92:95], v[100:103], v[152:155]
    v_fmac_f32 v208, v140, v12
    v_fmac_f32 v209, v141, v13
    v_mfma_f32_16x16x32_bf16 v[156:159], v[88:91], v[88:91], 0
    v_fmac_f32 v208, v142, v14
    v_fmac_f32 v209, v143, v15
    v_mfma_f32_16x16x32_bf16 v[156:159], v[92:95], v[92:95], v[156:159]
    v_fmac_f32 v208, v144, v16
    v_fmac_f32 v209, v145, v17
    v_smfmac_f32_16x16x64_bf16 v[196:199], v[20:23], v[148:155], v216
    v_fmac_f32 v208, v146, v18
    v_mfma_f32_16x16x32_bf16 v[160:163], v[96:99], v[96:99], 0
    s_waitcnt lgkmcnt(0)
    v_fmac_f32 v209, v147, v19
    v_mfma_f32_16x16x32_bf16 v[160:163], v[100:103], v[100:103], v[160:163]
    v_fmac_f32 v208, v156, v24
    v_fmac_f32 v209, v157, v25
    v_mfma_f32_16x16x32_bf16 v[124:127], v[104:107], v[72:75], 0
    v_fmac_f32 v208, v158, v26
    v_fmac_f32 v209, v159, v27
    v_mfma_f32_16x16x32_bf16 v[124:127], v[108:111], v[76:79], v[124:127]
    v_add_f32_dpp v220, v220, v220 quad_perm:[1,0,3,2] row_mask:0xf bank_mask:0xf
    s_sub_u32 s58, s58, 1
    v_mfma_f32_16x16x32_bf16 v[128:131], v[112:115], v[72:75], 0
    v_fmac_f32 v208, v160, v28
    v_fmac_f32 v209, v161, v29
    v_mfma_f32_16x16x32_bf16 v[128:131], v[116:119], v[76:79], v[128:131]
    v_fmac_f32 v208, v162, v30
    v_fmac_f32 v209, v163, v31
    v_smfmac_f32_16x16x64_bf16 v[172:175], v[120:123], v[72:79], v250
    v_mad_u32_u16 v76, v204, s57, v213 op_sel:[0,0,0,0]
    v_mfma_f32_16x16x32_bf16 v[132:135], v[104:107], v[80:83], 0
    ds_read_b128 v[72:75], v76 offset:0
    ds_read_b128 v[76:79], v76 offset:64
    v_smfmac_f32_16x16x64_bf16 v[196:199], v[32:35], v[124:131], v216
    v_add_f32_dpp v220, v220, v220 quad_perm:[2,3,0,1] row_mask:0xf bank_mask:0xf
    v_mfma_f32_16x16x32_bf16 v[132:135], v[108:111], v[84:87], v[132:135]
    v_mul_f32 v217, v172, v64
    v_mfma_f32_16x16x32_bf16 v[136:139], v[112:115], v[80:83], 0
    v_fmac_f32 v217, v173, v64
    v_add_f32_dpp v220, v220, v220 row_half_mirror row_mask:0xf bank_mask:0xf
    v_mfma_f32_16x16x32_bf16 v[136:139], v[116:119], v[84:87], v[136:139]
    v_smfmac_f32_16x16x64_bf16 v[176:179], v[120:123], v[80:87], v250
    v_mad_u32_u16 v84, v204, s57, v213 op_sel:[1,0,0,0]
    v_mfma_f32_16x16x32_bf16 v[140:143], v[104:107], v[88:91], 0
    ds_read_b128 v[80:83], v84 offset:0
    ds_read_b128 v[84:87], v84 offset:64
    v_mfma_f32_16x16x32_bf16 v[140:143], v[108:111], v[92:95], v[140:143]
    v_fmac_f32 v208, v132, v36
    v_fmac_f32 v209, v133, v37
    v_mfma_f32_16x16x32_bf16 v[144:147], v[112:115], v[88:91], 0
    v_fmac_f32 v217, v176, v65
    v_fmac_f32 v208, v134, v38
    v_mfma_f32_16x16x32_bf16 v[144:147], v[116:119], v[92:95], v[144:147]
    v_fmac_f32 v217, v177, v65
    v_fmac_f32 v209, v135, v39
    v_smfmac_f32_16x16x64_bf16 v[180:183], v[120:123], v[88:95], v250
    v_mad_u32_u16 v92, v205, s57, v213 op_sel:[0,0,0,0]
    v_mfma_f32_16x16x32_bf16 v[148:151], v[104:107], v[96:99], 0
    ds_read_b128 v[88:91], v92 offset:0
    ds_read_b128 v[92:95], v92 offset:64
    v_smfmac_f32_16x16x64_bf16 v[196:199], v[44:47], v[140:147], v216
    v_fmac_f32 v208, v136, v40
    v_mfma_f32_16x16x32_bf16 v[148:151], v[108:111], v[100:103], v[148:151]
    v_fmac_f32 v217, v180, v66
    v_fmac_f32 v209, v137, v41
    v_mfma_f32_16x16x32_bf16 v[152:155], v[112:115], v[96:99], 0
    v_fmac_f32 v217, v181, v66
    v_fmac_f32 v208, v138, v42
    v_mfma_f32_16x16x32_bf16 v[152:155], v[116:119], v[100:103], v[152:155]
    v_fmac_f32 v209, v139, v43
    v_cndmask_b32_dpp v212, v212, v220, vcc row_shr:1 row_mask:0xf bank_mask:0xf bound_ctrl:0
    v_smfmac_f32_16x16x64_bf16 v[184:187], v[120:123], v[96:103], v250
    v_mad_u32_u16 v100, v205, s57, v213 op_sel:[1,0,0,0]
    v_mfma_f32_16x16x32_bf16 v[156:159], v[104:107], v[104:107], 0
    ds_read_b128 v[96:99], v100 offset:0
    ds_read_b128 v[100:103], v100 offset:64
    v_mfma_f32_16x16x32_bf16 v[156:159], v[108:111], v[108:111], v[156:159]
    v_fmac_f32 v208, v148, v48
    v_fmac_f32 v209, v149, v49
    v_mfma_f32_16x16x32_bf16 v[160:163], v[112:115], v[104:107], 0
    v_fmac_f32 v217, v184, v67
    v_fmac_f32 v208, v150, v50
    v_mfma_f32_16x16x32_bf16 v[160:163], v[116:119], v[108:111], v[160:163]
    v_fmac_f32 v217, v185, v67
    v_fmac_f32 v209, v151, v51
    v_smfmac_f32_16x16x64_bf16 v[188:191], v[120:123], v[104:111], v250
    v_mad_u32_u16 v108, v206, s57, v213 op_sel:[0,0,0,0]
    v_mfma_f32_16x16x32_bf16 v[164:167], v[112:115], v[112:115], 0
    ds_read_b128 v[104:107], v108 offset:0
    ds_read_b128 v[108:111], v108 offset:64
    v_smfmac_f32_16x16x64_bf16 v[196:199], v[56:59], v[156:163], v216
    s_waitcnt lgkmcnt(4)
    v_mfma_f32_16x16x32_bf16 v[164:167], v[116:119], v[116:119], v[164:167]
    v_fmac_f32 v217, v188, v68
    v_fmac_f32 v208, v152, v52
    v_smfmac_f32_16x16x64_bf16 v[192:195], v[120:123], v[112:119], v250
    v_mad_u32_u16 v116, v206, s57, v213 op_sel:[1,0,0,0]
    v_mfma_f32_16x16x32_bf16 v[168:171], v[120:123], v[120:123], 0
    ds_read_b128 v[112:115], v116 offset:0
    s_cbranch_scc0 k1_kernel_loop
    ds_read_b32 v43, v252 offset:24
    s_nop 7
    v_fmac_f32 v217, v189, v68
    v_fmac_f32 v217, v196, v200
    v_fmac_f32 v217, v192, v69
    v_fmac_f32 v217, v197, v201
    v_fmac_f32 v217, v193, v69
    v_fmac_f32 v217, v198, v202
    v_fmac_f32 v217, v199, v203
    v_fmac_f32 v209, v153, v53
    v_fmac_f32 v208, v154, v54
    v_fmac_f32 v209, v155, v55
    v_fmac_f32 v208, v164, v60
    v_fmac_f32 v209, v165, v61
    v_fmac_f32 v208, v166, v62
    v_fmac_f32 v209, v167, v63
    v_add_f32 v209, v209, v217
    v_fmac_f32 v208, v168, v70
    v_fmac_f32 v208, v169, v71
    v_add_f32 v211, v208, v209
    v_and_b32 v40, 7, v255
    s_mul_i32 s76, s36, 7
    v_permlane32_swap_b32 v210, v211
    v_add_f32 v219, v210, v211
    s_waitcnt lgkmcnt(0)
    v_lshrrev_b32 v41, 5, v255
    v_permlane16_swap_b32 v218, v219
    v_add_f32 v220, v218, v219
    s_xor_b32 s76, s76, 7
    v_bfe_u32 v42, v255, 4, 1
    v_add_f32_dpp v220, v220, v220 quad_perm:[1,0,3,2] row_mask:0xf bank_mask:0xf
    v_xor_b32 v40, s76, v40
    v_lshl_add_u32 v41, v42, 1, v41
    v_add_f32_dpp v220, v220, v220 quad_perm:[2,3,0,1] row_mask:0xf bank_mask:0xf
    s_lshl_b32 s74, s72, 2
    v_lshl_add_u32 v40, v40, 2, v41
    v_add_f32_dpp v220, v220, v220 row_half_mirror row_mask:0xf bank_mask:0xf
    v_cndmask_b32_dpp v212, v212, v220, vcc row_shr:1 row_mask:0xf bank_mask:0xf bound_ctrl:0
    s_lshl_b32 s76, s36, 16
    v_lshlrev_b32 v113, 2, v40
    v_add_f32_dpp v112, v212, v212 row_ror:8 row_mask:0xf bank_mask:0xf
    s_add_u32 s74, s74, s76
    s_add_u32 s74, s74, 29360128
    v_readfirstlane_b32 s64, v43
    s_waitcnt vmcnt(0)
    v_min_u32 v112, -2, v112
    s_branch k1_kernel_k2
k1_kernel_last:
    s_endpgm
.section .rodata,"a"
.p2align 6
.amdhsa_kernel standalone__deep_cross_pnn__recsys_kernel
  .amdhsa_next_free_vgpr 256
  .amdhsa_next_free_sgpr 102
  .amdhsa_accum_offset 256
  .amdhsa_group_segment_fixed_size 0
  .amdhsa_kernarg_size 80
  .amdhsa_user_sgpr_count 2
  .amdhsa_user_sgpr_kernarg_segment_ptr 1
  .amdhsa_system_sgpr_workgroup_id_x 1
.end_amdhsa_kernel
```
